```python
import torch

def _softmax(x, axis=-1):
    return torch.softmax(x, dim=axis)

def _gelu(x):
    return torch.nn.functional.gelu(x, approximate='tanh')

def _silu(x):
    return torch.nn.functional.silu(x)

def _sigmoid(x):
    return torch.sigmoid(x)

def _layernorm(x, axis=-1, eps=1e-05):
    m = x.mean(dim=axis, keepdim=True)
    v = x.var(dim=axis, keepdim=True, unbiased=False)
    return (x - m) / torch.sqrt(v + eps)

def _scatter_add(tgt, idx, src, axis=0):
    return tgt.clone().index_add_(axis, idx, src)

def _segment_sum(src, seg, n):
    out = torch.zeros((n,) + src.shape[1:], dtype=src.dtype)
    return out.index_add_(0, seg, src)

def _pad(x, pw):
    flat = tuple((v for pair in reversed(pw) for v in pair))
    return torch.nn.functional.pad(x, flat)
kernel_name = 'standalone__neighborhood_nat__vision'

def setup_inputs():

    _w = lambda a: (lambda t: t.to(torch.bfloat16) if t.is_floating_point() else t)(torch.as_tensor(a))
    H = W = 224
    C = 192
    return {'x': _w((lambda *s: torch.randn(*s, dtype=torch.bfloat16) * 0.2)(1, H, W, C)), 'wqkv': _w((lambda *s: torch.randn(*s, dtype=torch.bfloat16) * 0.2)(C, 3 * C)), 'wo': _w((lambda *s: torch.randn(*s, dtype=torch.bfloat16) * 0.05)(C, C))}

def reference(x, wqkv, wo):
    B, H, W, C = x.shape
    ks, dil = (7, 2)
    qkv = x @ wqkv
    q, k, v = (qkv[..., :C].clone(), qkv[..., C:2 * C].clone(), qkv[..., 2 * C:].clone())
    half = (ks - 1) // 2 * dil
    ir = torch.arange(H)
    ic = torch.arange(W)
    off = torch.arange(ks) * dil
    r0 = torch.clip(ir - half, 0, H - 1 - (ks - 1) * dil)
    c0 = torch.clip(ic - half, 0, W - 1 - (ks - 1) * dil)
    ri = r0[:, None] + off[None, :]
    ci = c0[:, None] + off[None, :]
    nidx = (ri[:, None, :, None] * W + ci[None, :, None, :]).reshape(1, H * W * ks * ks, 1)
    kf = k.reshape(B, H * W, C)
    vf = v.reshape(B, H * W, C)
    kn = (lambda x, i, axis: torch.take_along_dim(x, i, dim=axis))(kf, nidx, 1).reshape(B, H * W, ks * ks, C)
    vn = (lambda x, i, axis: torch.take_along_dim(x, i, dim=axis))(vf, nidx, 1).reshape(B, H * W, ks * ks, C)
    qf = q.reshape(B, H * W, C)
    scale = C ** (-0.5)
    logits = torch.einsum('bnc,bnkc->bnk', qf, kn) * scale
    p = _softmax(logits, axis=-1)
    o = torch.einsum('bnk,bnkc->bnc', p, vn) @ wo
    return o.reshape(B, H, W, C)
```

```asm
; @launch kernel=prep_kernel grid=(144,1,1) block=(64,1,1) lds=0
; @launch kernel=main_kernel grid=(256,1,1) block=(512,1,1) lds=163840
.amdgcn_target "amdgcn-amd-amdhsa--gfx950"
.text
.globl prep_kernel
.p2align 8
.type prep_kernel,@function
prep_kernel:
  s_cmp_ge_u32 s2, 144
  s_cbranch_scc1 P_done
  s_load_dwordx4 s[4:7], s[0:1], 8
  s_load_dwordx2 s[8:9], s[0:1], 40
  v_and_b32 v1, 15, v0
  v_lshrrev_b32 v2, 4, v0
  v_lshrrev_b32 v3, 2, v1
  v_lshlrev_b32 v3, 3, v3
  v_and_b32 v4, 3, v1
  v_add_u32 v3, v3, v4
  s_cmp_ge_u32 s2, 72
  s_cselect_b32 s20, 72, 0
  s_sub_u32 s21, s2, s20
  s_mul_hi_u32 s22, s21, 0x15555556
  s_mul_i32 s23, s22, 12
  s_sub_u32 s23, s21, s23
  s_and_b32 s24, s23, 1
  s_lshr_b32 s23, s23, 1
  s_waitcnt lgkmcnt(0)
  s_mov_b32 s12, s4
  s_and_b32 s13, s5, 0xffff
  s_mov_b32 s14, 221184
  s_mov_b32 s15, 0x00020000
  s_mov_b32 s16, s6
  s_and_b32 s17, s7, 0xffff
  s_mov_b32 s18, 73728
  s_mov_b32 s19, 0x00020000
  s_mov_b32 s28, s8
  s_and_b32 s29, s9, 0xffff
  s_mov_b32 s30, 268435456
  s_mov_b32 s31, 0x00020000
  s_lshl_b32 s25, s22, 5
  s_lshl_b32 s26, s24, 2
  s_add_u32 s25, s25, s26
  v_add_u32 v5, s25, v3
  s_lshl_b32 s26, s23, 5
  s_cmp_ge_u32 s2, 72
  s_cbranch_scc1 P_vo
  v_mul_u32_u24 v6, 1152, v5
  v_lshl_add_u32 v6, v2, 4, v6
  buffer_load_dwordx4 v[16:19], v6, s[12:15], 0 offen offset:384
  buffer_load_dwordx4 v[20:23], v6, s[12:15], 0 offen offset:448
  buffer_load_dwordx4 v[24:27], v6, s[12:15], 0 offen offset:512
  buffer_load_dwordx4 v[28:31], v6, s[12:15], 0 offen offset:576
  buffer_load_dwordx4 v[32:35], v6, s[12:15], 0 offen offset:640
  buffer_load_dwordx4 v[36:39], v6, s[12:15], 0 offen offset:704
  v_add_u32 v7, s26, v3
  v_mul_u32_u24 v7, 1152, v7
  v_lshl_add_u32 v7, v2, 4, v7
  v_add_u32 v8, 4608, v7
  s_mov_b32 s27, 1037384597
  s_branch P_common
P_vo:
  v_mul_u32_u24 v6, 3072, v2
  v_lshl_add_u32 v6, v5, 1, v6
  s_mov_b32 s27, 0
  buffer_load_ushort v100, v6, s[16:19], s27 offen offset:0
  buffer_load_ushort v101, v6, s[16:19], s27 offen offset:384
  buffer_load_ushort v102, v6, s[16:19], s27 offen offset:768
  buffer_load_ushort v103, v6, s[16:19], s27 offen offset:1152
  buffer_load_ushort v104, v6, s[16:19], s27 offen offset:1536
  buffer_load_ushort v105, v6, s[16:19], s27 offen offset:1920
  buffer_load_ushort v106, v6, s[16:19], s27 offen offset:2304
  buffer_load_ushort v107, v6, s[16:19], s27 offen offset:2688
  s_mov_b32 s27, 12288
  buffer_load_ushort v108, v6, s[16:19], s27 offen offset:0
  buffer_load_ushort v109, v6, s[16:19], s27 offen offset:384
  buffer_load_ushort v110, v6, s[16:19], s27 offen offset:768
  buffer_load_ushort v111, v6, s[16:19], s27 offen offset:1152
  buffer_load_ushort v112, v6, s[16:19], s27 offen offset:1536
  buffer_load_ushort v113, v6, s[16:19], s27 offen offset:1920
  buffer_load_ushort v114, v6, s[16:19], s27 offen offset:2304
  buffer_load_ushort v115, v6, s[16:19], s27 offen offset:2688
  s_mov_b32 s27, 24576
  buffer_load_ushort v116, v6, s[16:19], s27 offen offset:0
  buffer_load_ushort v117, v6, s[16:19], s27 offen offset:384
  buffer_load_ushort v118, v6, s[16:19], s27 offen offset:768
  buffer_load_ushort v119, v6, s[16:19], s27 offen offset:1152
  buffer_load_ushort v120, v6, s[16:19], s27 offen offset:1536
  buffer_load_ushort v121, v6, s[16:19], s27 offen offset:1920
  buffer_load_ushort v122, v6, s[16:19], s27 offen offset:2304
  buffer_load_ushort v123, v6, s[16:19], s27 offen offset:2688
  s_mov_b32 s27, 36864
  buffer_load_ushort v124, v6, s[16:19], s27 offen offset:0
  buffer_load_ushort v125, v6, s[16:19], s27 offen offset:384
  buffer_load_ushort v126, v6, s[16:19], s27 offen offset:768
  buffer_load_ushort v127, v6, s[16:19], s27 offen offset:1152
  buffer_load_ushort v128, v6, s[16:19], s27 offen offset:1536
  buffer_load_ushort v129, v6, s[16:19], s27 offen offset:1920
  buffer_load_ushort v130, v6, s[16:19], s27 offen offset:2304
  buffer_load_ushort v131, v6, s[16:19], s27 offen offset:2688
  s_mov_b32 s27, 49152
  buffer_load_ushort v132, v6, s[16:19], s27 offen offset:0
  buffer_load_ushort v133, v6, s[16:19], s27 offen offset:384
  buffer_load_ushort v134, v6, s[16:19], s27 offen offset:768
  buffer_load_ushort v135, v6, s[16:19], s27 offen offset:1152
  buffer_load_ushort v136, v6, s[16:19], s27 offen offset:1536
  buffer_load_ushort v137, v6, s[16:19], s27 offen offset:1920
  buffer_load_ushort v138, v6, s[16:19], s27 offen offset:2304
  buffer_load_ushort v139, v6, s[16:19], s27 offen offset:2688
  s_mov_b32 s27, 61440
  buffer_load_ushort v140, v6, s[16:19], s27 offen offset:0
  buffer_load_ushort v141, v6, s[16:19], s27 offen offset:384
  buffer_load_ushort v142, v6, s[16:19], s27 offen offset:768
  buffer_load_ushort v143, v6, s[16:19], s27 offen offset:1152
  buffer_load_ushort v144, v6, s[16:19], s27 offen offset:1536
  buffer_load_ushort v145, v6, s[16:19], s27 offen offset:1920
  buffer_load_ushort v146, v6, s[16:19], s27 offen offset:2304
  buffer_load_ushort v147, v6, s[16:19], s27 offen offset:2688
  s_waitcnt vmcnt(46)
  v_lshl_or_b32 v16, v101, 16, v100
  s_waitcnt vmcnt(44)
  v_lshl_or_b32 v17, v103, 16, v102
  s_waitcnt vmcnt(42)
  v_lshl_or_b32 v18, v105, 16, v104
  s_waitcnt vmcnt(40)
  v_lshl_or_b32 v19, v107, 16, v106
  s_waitcnt vmcnt(38)
  v_lshl_or_b32 v20, v109, 16, v108
  s_waitcnt vmcnt(36)
  v_lshl_or_b32 v21, v111, 16, v110
  s_waitcnt vmcnt(34)
  v_lshl_or_b32 v22, v113, 16, v112
  s_waitcnt vmcnt(32)
  v_lshl_or_b32 v23, v115, 16, v114
  s_waitcnt vmcnt(30)
  v_lshl_or_b32 v24, v117, 16, v116
  s_waitcnt vmcnt(28)
  v_lshl_or_b32 v25, v119, 16, v118
  s_waitcnt vmcnt(26)
  v_lshl_or_b32 v26, v121, 16, v120
  s_waitcnt vmcnt(24)
  v_lshl_or_b32 v27, v123, 16, v122
  s_waitcnt vmcnt(22)
  v_lshl_or_b32 v28, v125, 16, v124
  s_waitcnt vmcnt(20)
  v_lshl_or_b32 v29, v127, 16, v126
  s_waitcnt vmcnt(18)
  v_lshl_or_b32 v30, v129, 16, v128
  s_waitcnt vmcnt(16)
  v_lshl_or_b32 v31, v131, 16, v130
  s_waitcnt vmcnt(14)
  v_lshl_or_b32 v32, v133, 16, v132
  s_waitcnt vmcnt(12)
  v_lshl_or_b32 v33, v135, 16, v134
  s_waitcnt vmcnt(10)
  v_lshl_or_b32 v34, v137, 16, v136
  s_waitcnt vmcnt(8)
  v_lshl_or_b32 v35, v139, 16, v138
  s_waitcnt vmcnt(6)
  v_lshl_or_b32 v36, v141, 16, v140
  s_waitcnt vmcnt(4)
  v_lshl_or_b32 v37, v143, 16, v142
  s_waitcnt vmcnt(2)
  v_lshl_or_b32 v38, v145, 16, v144
  s_waitcnt vmcnt(0)
  v_lshl_or_b32 v39, v147, 16, v146
  v_add_u32 v7, s26, v1
  v_mul_u32_u24 v7, 1152, v7
  v_lshl_add_u32 v7, v2, 4, v7
  v_add_u32 v7, 768, v7
  v_add_u32 v8, 18432, v7
  s_mov_b32 s27, 1.0
P_common:
  buffer_load_dwordx4 v[40:43], v7, s[12:15], 0 offen offset:0
  buffer_load_dwordx4 v[44:47], v7, s[12:15], 0 offen offset:64
  buffer_load_dwordx4 v[48:51], v7, s[12:15], 0 offen offset:128
  buffer_load_dwordx4 v[52:55], v7, s[12:15], 0 offen offset:192
  buffer_load_dwordx4 v[56:59], v7, s[12:15], 0 offen offset:256
  buffer_load_dwordx4 v[60:63], v7, s[12:15], 0 offen offset:320
  buffer_load_dwordx4 v[64:67], v8, s[12:15], 0 offen offset:0
  buffer_load_dwordx4 v[68:71], v8, s[12:15], 0 offen offset:64
  buffer_load_dwordx4 v[72:75], v8, s[12:15], 0 offen offset:128
  buffer_load_dwordx4 v[76:79], v8, s[12:15], 0 offen offset:192
  buffer_load_dwordx4 v[80:83], v8, s[12:15], 0 offen offset:256
  buffer_load_dwordx4 v[84:87], v8, s[12:15], 0 offen offset:320
  s_waitcnt vmcnt(0)
  v_mfma_f32_16x16x32_bf16 v[88:91], v[40:43], v[16:19], 0
  v_mfma_f32_16x16x32_bf16 v[92:95], v[64:67], v[16:19], 0
  v_mfma_f32_16x16x32_bf16 v[88:91], v[44:47], v[20:23], v[88:91]
  v_mfma_f32_16x16x32_bf16 v[92:95], v[68:71], v[20:23], v[92:95]
  v_mfma_f32_16x16x32_bf16 v[88:91], v[48:51], v[24:27], v[88:91]
  v_mfma_f32_16x16x32_bf16 v[92:95], v[72:75], v[24:27], v[92:95]
  v_mfma_f32_16x16x32_bf16 v[88:91], v[52:55], v[28:31], v[88:91]
  v_mfma_f32_16x16x32_bf16 v[92:95], v[76:79], v[28:31], v[92:95]
  v_mfma_f32_16x16x32_bf16 v[88:91], v[56:59], v[32:35], v[88:91]
  v_mfma_f32_16x16x32_bf16 v[92:95], v[80:83], v[32:35], v[92:95]
  v_mfma_f32_16x16x32_bf16 v[88:91], v[60:63], v[36:39], v[88:91]
  v_mfma_f32_16x16x32_bf16 v[92:95], v[84:87], v[36:39], v[92:95]
  s_nop 6
  v_mul_f32 v88, s27, v88
  v_mul_f32 v89, s27, v89
  v_mul_f32 v90, s27, v90
  v_mul_f32 v91, s27, v91
  v_mul_f32 v92, s27, v92
  v_mul_f32 v93, s27, v93
  v_mul_f32 v94, s27, v94
  v_mul_f32 v95, s27, v95
  v_cvt_pk_bf16_f32 v96, v88, v89
  v_cvt_pk_bf16_f32 v97, v90, v91
  v_cvt_pk_bf16_f32 v98, v92, v93
  v_cvt_pk_bf16_f32 v99, v94, v95
  v_lshlrev_b32 v9, 4, v0
  s_lshl_b32 s26, s2, 10
  buffer_store_dwordx4 v[96:99], v9, s[28:31], s26 offen
P_done:
  s_endpgm
.globl main_kernel
.p2align 8
.type main_kernel,@function
main_kernel:
  s_cmp_ge_u32 s2, 256
  s_cbranch_scc1 M_done
  s_load_dwordx2 s[4:5], s[0:1], 0
  s_load_dwordx2 s[6:7], s[0:1], 24
  s_load_dwordx2 s[42:43], s[0:1], 40
  v_lshrrev_b32 v4, 6, v0
  v_and_b32 v1, 63, v0
  v_readfirstlane_b32 s20, v4
  v_lshrrev_b32 v2, 4, v1
  v_and_b32 v3, 15, v1
  s_and_b32 s33, s2, 7
  s_lshr_b32 s34, s2, 3
  s_lshr_b32 s21, s33, 2
  s_bfe_u32 s22, s33, 0x10001
  s_and_b32 s33, s33, 1
  s_lshl_b32 s33, s33, 2
  s_lshr_b32 s23, s34, 3
  s_add_u32 s23, s23, s33
  s_and_b32 s24, s34, 7
  s_mul_i32 s23, s23, 14
  s_mul_i32 s24, s24, 14
  s_mul_i32 s33, s21, 6
  s_add_i32 s25, s23, s33
  s_add_i32 s25, s25, -6
  s_cmp_eq_i32 s25, -6
  s_cselect_b32 s27, 6, 0
  s_cmp_eq_i32 s25, 98
  s_cselect_b32 s28, 7, 13
  s_cselect_b32 s29, 2, 0
  s_sub_i32 s25, s25, s29
  s_mul_i32 s33, s22, 6
  s_add_i32 s34, s24, s33
  s_add_i32 s34, s34, -6
  s_cmp_eq_i32 s34, -6
  s_cselect_b32 s30, 6, 0
  s_cmp_eq_i32 s34, 98
  s_cselect_b32 s31, 7, 13
  s_lshl_b32 s34, s34, 1
  s_add_i32 s34, s34, s22
  s_mul_i32 s26, s34, 384
  v_lshlrev_b32 v230, 4, v1
  s_waitcnt lgkmcnt(0)
  s_mov_b32 s8, s4
  s_and_b32 s9, s5, 0xffff
  s_mov_b32 s10, 19267584
  s_mov_b32 s11, 0x00020000
  s_mov_b32 s12, s6
  s_and_b32 s13, s7, 0xffff
  s_mov_b32 s14, 19267584
  s_mov_b32 s15, 0x00020000
  s_mov_b32 s16, s42
  s_and_b32 s17, s43, 0xffff
  s_mov_b32 s18, 268435456
  s_mov_b32 s19, 0x00020000
  s_mul_i32 s33, s20, 9216
  s_min_u32 s33, s33, 62464
  s_add_u32 s34, s33, 92160
  s_mov_b32 m0, s34
  s_nop 0
  buffer_load_dwordx4 v230, s[16:19], s33 offen offset:0 lds
  buffer_load_dwordx4 v230, s[16:19], s33 offen offset:1024 lds
  buffer_load_dwordx4 v230, s[16:19], s33 offen offset:2048 lds
  s_add_u32 s33, s33, 3072
  s_add_u32 s34, s34, 3072
  s_mov_b32 m0, s34
  s_nop 0
  buffer_load_dwordx4 v230, s[16:19], s33 offen offset:0 lds
  buffer_load_dwordx4 v230, s[16:19], s33 offen offset:1024 lds
  buffer_load_dwordx4 v230, s[16:19], s33 offen offset:2048 lds
  s_add_u32 s33, s33, 3072
  s_add_u32 s34, s34, 3072
  s_mov_b32 m0, s34
  s_nop 0
  buffer_load_dwordx4 v230, s[16:19], s33 offen offset:0 lds
  buffer_load_dwordx4 v230, s[16:19], s33 offen offset:1024 lds
  buffer_load_dwordx4 v230, s[16:19], s33 offen offset:2048 lds
  s_cmp_eq_u32 s20, 7
  s_cbranch_scc1 M_noxq
  v_lshrrev_b32 v4, 3, v3
  s_lshl_b32 s33, s20, 1
  s_add_u32 s34, s33, s23
  v_add_u32 v5, s34, v4
  s_mul_i32 s35, s21, 13
  s_add_i32 s35, s35, -6
  v_lshl_add_u32 v6, v5, 1, s35
  v_add_u32 v7, 112, v5
  v_med3_i32 v5, v6, v5, v7
  v_mul_u32_u24 v5, 224, v5
  v_and_b32 v8, 7, v3
  v_min_u32 v8, 6, v8
  s_mul_i32 s35, s22, 13
  s_add_i32 s35, s35, -6
  s_add_u32 s34, s24, 0
  v_add_u32 v9, s34, v8
  v_lshl_add_u32 v6, v9, 1, s35
  v_add_u32 v7, 112, v9
  v_med3_i32 v9, v6, v9, v7
  v_add_u32 v9, v9, v5
  v_mul_u32_u24 v9, 384, v9
  v_lshl_add_u32 v228, v2, 4, v9
  s_add_u32 s34, s24, 7
  v_add_u32 v9, s34, v8
  v_lshl_add_u32 v6, v9, 1, s35
  v_add_u32 v7, 112, v9
  v_med3_i32 v9, v6, v9, v7
  v_add_u32 v9, v9, v5
  v_mul_u32_u24 v9, 384, v9
  v_lshl_add_u32 v229, v2, 4, v9
  buffer_load_dwordx4 v[16:19], v228, s[8:11], 0 offen offset:0
  buffer_load_dwordx4 v[40:43], v229, s[8:11], 0 offen offset:0
  buffer_load_dwordx4 v[20:23], v228, s[8:11], 0 offen offset:64
  buffer_load_dwordx4 v[44:47], v229, s[8:11], 0 offen offset:64
  buffer_load_dwordx4 v[24:27], v228, s[8:11], 0 offen offset:128
  buffer_load_dwordx4 v[48:51], v229, s[8:11], 0 offen offset:128
  buffer_load_dwordx4 v[28:31], v228, s[8:11], 0 offen offset:192
  buffer_load_dwordx4 v[52:55], v229, s[8:11], 0 offen offset:192
  buffer_load_dwordx4 v[32:35], v228, s[8:11], 0 offen offset:256
  buffer_load_dwordx4 v[56:59], v229, s[8:11], 0 offen offset:256
  buffer_load_dwordx4 v[36:39], v228, s[8:11], 0 offen offset:320
  buffer_load_dwordx4 v[60:63], v229, s[8:11], 0 offen offset:320
  s_mov_b32 s33, 71680
  buffer_load_dwordx4 v[232:235], v230, s[16:19], s33 offen offset:0
  buffer_load_dwordx4 v[236:239], v230, s[16:19], s33 offen offset:1024
M_noxq:
  s_and_b32 s33, s20, 1
  s_lshl_b32 s33, s33, 3
  s_and_b32 s36, s20, 6
  s_or_b32 s33, s33, s36
  v_add_u32 v4, 0, v1
  v_xor_b32 v4, s33, v4
  v_mul_u32_u24 v5, 2731, v4
  v_lshrrev_b32 v5, 16, v5
  v_mul_u32_u24 v5, 384, v5
  v_lshl_add_u32 v4, v4, 4, v5
  v_add_u32 v184, s26, v4
  v_add_u32 v188, 7680, v184
  v_max_i32 v184, 0, v184
  v_add_u32 v4, 60, v1
  v_xor_b32 v4, s33, v4
  v_mul_u32_u24 v5, 2731, v4
  v_lshrrev_b32 v5, 16, v5
  v_mul_u32_u24 v5, 384, v5
  v_lshl_add_u32 v4, v4, 4, v5
  v_add_u32 v185, s26, v4
  v_add_u32 v189, 7680, v185
  v_max_i32 v185, 0, v185
  v_add_u32 v4, 120, v1
  v_xor_b32 v4, s33, v4
  v_mul_u32_u24 v5, 2731, v4
  v_lshrrev_b32 v5, 16, v5
  v_mul_u32_u24 v5, 384, v5
  v_lshl_add_u32 v4, v4, 4, v5
  v_add_u32 v186, s26, v4
  v_add_u32 v190, 7680, v186
  v_max_i32 v186, 0, v186
  v_add_u32 v4, 180, v1
  v_xor_b32 v4, s33, v4
  v_mul_u32_u24 v5, 2731, v4
  v_lshrrev_b32 v5, 16, v5
  v_mul_u32_u24 v5, 384, v5
  v_lshl_add_u32 v4, v4, 4, v5
  v_add_u32 v187, s26, v4
  v_add_u32 v191, 7680, v187
  v_max_i32 v187, 0, v187
  s_add_i32 s34, s25, s20
  s_lshl_b32 s34, s34, 1
  s_add_i32 s34, s34, s21
  s_max_i32 s34, s34, 0
  s_min_i32 s34, s34, 223
  s_mul_i32 s34, s34, 86016
  s_mul_i32 s35, s20, 7680
  s_mov_b32 exec_hi, 0x0fffffff
  s_mov_b32 m0, s35
  s_add_u32 s35, s35, 960
  buffer_load_dwordx4 v184, s[8:11], s34 offen lds
  s_mov_b32 m0, s35
  s_add_u32 s35, s35, 960
  buffer_load_dwordx4 v185, s[8:11], s34 offen lds
  s_mov_b32 m0, s35
  s_add_u32 s35, s35, 960
  buffer_load_dwordx4 v186, s[8:11], s34 offen lds
  s_mov_b32 m0, s35
  s_add_u32 s35, s35, 960
  buffer_load_dwordx4 v187, s[8:11], s34 offen lds
  s_mov_b32 m0, s35
  s_add_u32 s35, s35, 960
  buffer_load_dwordx4 v188, s[8:11], s34 offen lds
  s_mov_b32 m0, s35
  s_add_u32 s35, s35, 960
  buffer_load_dwordx4 v189, s[8:11], s34 offen lds
  s_mov_b32 m0, s35
  s_add_u32 s35, s35, 960
  buffer_load_dwordx4 v190, s[8:11], s34 offen lds
  s_mov_b32 m0, s35
  s_add_u32 s35, s35, 960
  buffer_load_dwordx4 v191, s[8:11], s34 offen lds
  s_mov_b64 exec, -1
  s_and_b32 s35, s20, 3
  s_and_b32 s33, s35, 1
  s_lshl_b32 s33, s33, 3
  s_and_b32 s36, s35, 6
  s_or_b32 s33, s33, s36
  s_lshr_b32 s34, s20, 2
  s_mul_i32 s36, s34, 7680
  v_add_u32 v4, 0, v1
  v_xor_b32 v4, s33, v4
  v_mul_u32_u24 v5, 2731, v4
  v_lshrrev_b32 v5, 16, v5
  v_mul_u32_u24 v5, 384, v5
  v_lshl_add_u32 v4, v4, 4, v5
  v_add_u32 v192, s26, v4
  v_add_u32 v192, s36, v192
  v_max_i32 v192, 0, v192
  v_add_u32 v4, 60, v1
  v_xor_b32 v4, s33, v4
  v_mul_u32_u24 v5, 2731, v4
  v_lshrrev_b32 v5, 16, v5
  v_mul_u32_u24 v5, 384, v5
  v_lshl_add_u32 v4, v4, 4, v5
  v_add_u32 v193, s26, v4
  v_add_u32 v193, s36, v193
  v_max_i32 v193, 0, v193
  v_add_u32 v4, 120, v1
  v_xor_b32 v4, s33, v4
  v_mul_u32_u24 v5, 2731, v4
  v_lshrrev_b32 v5, 16, v5
  v_mul_u32_u24 v5, 384, v5
  v_lshl_add_u32 v4, v4, 4, v5
  v_add_u32 v194, s26, v4
  v_add_u32 v194, s36, v194
  v_max_i32 v194, 0, v194
  v_add_u32 v4, 180, v1
  v_xor_b32 v4, s33, v4
  v_mul_u32_u24 v5, 2731, v4
  v_lshrrev_b32 v5, 16, v5
  v_mul_u32_u24 v5, 384, v5
  v_lshl_add_u32 v4, v4, 4, v5
  v_add_u32 v195, s26, v4
  v_add_u32 v195, s36, v195
  v_max_i32 v195, 0, v195
  s_add_u32 s35, s35, 8
  s_mul_i32 s33, s34, 3840
  s_add_i32 s34, s25, s35
  s_lshl_b32 s34, s34, 1
  s_add_i32 s34, s34, s21
  s_max_i32 s34, s34, 0
  s_min_i32 s34, s34, 223
  s_mul_i32 s34, s34, 86016
  s_mul_i32 s35, s35, 7680
  s_add_u32 s35, s35, s33
  s_mov_b32 exec_hi, 0x0fffffff
  s_mov_b32 m0, s35
  s_add_u32 s35, s35, 960
  buffer_load_dwordx4 v192, s[8:11], s34 offen lds
  s_mov_b32 m0, s35
  s_add_u32 s35, s35, 960
  buffer_load_dwordx4 v193, s[8:11], s34 offen lds
  s_mov_b32 m0, s35
  s_add_u32 s35, s35, 960
  buffer_load_dwordx4 v194, s[8:11], s34 offen lds
  s_mov_b32 m0, s35
  s_add_u32 s35, s35, 960
  buffer_load_dwordx4 v195, s[8:11], s34 offen lds
  s_mov_b64 exec, -1
  s_cmp_eq_u32 s20, 7
  s_cbranch_scc1 M_helper
  s_lshl_b32 s33, s20, 1
  s_max_i32 s32, s33, s27
  s_min_i32 s32, s32, s28
  s_and_b32 s32, s32, -2
  v_lshrrev_b32 v4, 3, v3
  v_add_u32 v4, s33, v4
  v_max_i32 v4, s27, v4
  v_min_i32 v4, s28, v4
  v_subrev_u32 v4, s32, v4
  s_add_u32 s32, s32, s29
  s_mov_b32 s38, 4286578688
  v_and_b32 v5, 1, v2
  v_sub_u32 v6, v5, v4
  v_ashrrev_i32 v242, 31, v6
  v_and_b32 v242, s38, v242
  v_sub_u32 v6, v4, v5
  v_ashrrev_i32 v243, 31, v6
  v_and_b32 v243, s38, v243
  v_and_b32 v4, 7, v3
  v_min_u32 v4, 6, v4
  v_lshrrev_b32 v5, 1, v2
  v_mov_b32 v7, 0x7f
  v_add_u32 v6, 0, v4
  v_max_i32 v6, s30, v6
  v_min_i32 v6, s31, v6
  v_lshlrev_b32 v6, v6, v7
  v_lshrrev_b32 v6, v5, v6
  v_not_b32 v240, v6
  v_add_u32 v6, 7, v4
  v_max_i32 v6, s30, v6
  v_min_i32 v6, s31, v6
  v_lshlrev_b32 v6, v6, v7
  v_lshrrev_b32 v6, v5, v6
  v_not_b32 v241, v6
  v_and_b32 v4, 7, v3
  v_add_u32 v4, s32, v4
  v_and_b32 v5, 1, v4
  v_lshlrev_b32 v5, 3, v5
  v_and_or_b32 v5, v4, 6, v5
  v_mul_u32_u24 v4, 7680, v4
  v_lshrrev_b32 v6, 3, v3
  v_mul_u32_u24 v6, 24, v6
  v_add_u32 v6, v6, v2
  v_add_u32 v7, 0, v6
  v_xor_b32 v7, v7, v5
  v_lshl_add_u32 v216, v7, 4, v4
  v_add_u32 v7, 4, v6
  v_xor_b32 v7, v7, v5
  v_lshl_add_u32 v217, v7, 4, v4
  v_add_u32 v7, 8, v6
  v_xor_b32 v7, v7, v5
  v_lshl_add_u32 v218, v7, 4, v4
  v_add_u32 v7, 12, v6
  v_xor_b32 v7, v7, v5
  v_lshl_add_u32 v219, v7, 4, v4
  v_and_b32 v4, 1, v2
  v_lshlrev_b32 v4, 2, v4
  v_lshrrev_b32 v5, 2, v3
  v_add3_u32 v4, v4, v5, s32
  v_and_b32 v5, 1, v4
  v_lshlrev_b32 v5, 3, v5
  v_and_or_b32 v5, v4, 6, v5
  v_mul_u32_u24 v4, 7680, v4
  v_and_b32 v6, 1, v3
  v_lshl_add_u32 v4, v6, 3, v4
  v_lshrrev_b32 v6, 1, v2
  v_mul_u32_u24 v6, 24, v6
  v_bfe_u32 v7, v3, 1, 1
  v_add_u32 v6, v6, v7
  v_add_u32 v7, 0, v6
  v_xor_b32 v7, v7, v5
  v_lshl_add_u32 v220, v7, 4, v4
  v_add_u32 v7, 2, v6
  v_xor_b32 v7, v7, v5
  v_lshl_add_u32 v221, v7, 4, v4
  v_add_u32 v7, 4, v6
  v_xor_b32 v7, v7, v5
  v_lshl_add_u32 v222, v7, 4, v4
  v_add_u32 v7, 6, v6
  v_xor_b32 v7, v7, v5
  v_lshl_add_u32 v223, v7, 4, v4
  v_add_u32 v7, 8, v6
  v_xor_b32 v7, v7, v5
  v_lshl_add_u32 v224, v7, 4, v4
  v_add_u32 v7, 10, v6
  v_xor_b32 v7, v7, v5
  v_lshl_add_u32 v225, v7, 4, v4
  v_add_u32 v7, 12, v6
  v_xor_b32 v7, v7, v5
  v_lshl_add_u32 v226, v7, 4, v4
  v_add_u32 v7, 14, v6
  v_xor_b32 v7, v7, v5
  v_lshl_add_u32 v227, v7, 4, v4
  v_add_u32 v231, 153600, v230
  v_add_u32 v11, 92160, v230
  s_waitcnt vmcnt(26)
  s_barrier
  ds_read_b128 v[152:155], v11 offset:0
  ds_read_b128 v[156:159], v11 offset:1024
  ds_read_b128 v[160:163], v11 offset:2048
  ds_read_b128 v[164:167], v11 offset:3072
  ds_read_b128 v[168:171], v11 offset:4096
  ds_read_b128 v[172:175], v11 offset:5120
  ds_read_b128 v[176:179], v11 offset:6144
  s_waitcnt vmcnt(25) lgkmcnt(6)
  v_mfma_f32_16x16x32_bf16 v[120:123], v[152:155], v[16:19], 0
  s_waitcnt vmcnt(24)
  v_mfma_f32_16x16x32_bf16 v[128:131], v[152:155], v[40:43], 0
  ds_read_b128 v[180:183], v11 offset:7168
  s_waitcnt lgkmcnt(6)
  v_mfma_f32_16x16x32_bf16 v[124:127], v[156:159], v[16:19], 0
  v_mfma_f32_16x16x32_bf16 v[132:135], v[156:159], v[40:43], 0
  ds_read_b128 v[152:155], v11 offset:8192
  s_waitcnt vmcnt(23) lgkmcnt(6)
  v_mfma_f32_16x16x32_bf16 v[120:123], v[160:163], v[20:23], v[120:123]
  s_waitcnt vmcnt(22)
  v_mfma_f32_16x16x32_bf16 v[128:131], v[160:163], v[44:47], v[128:131]
  ds_read_b128 v[156:159], v11 offset:9216
  s_waitcnt lgkmcnt(6)
  v_mfma_f32_16x16x32_bf16 v[124:127], v[164:167], v[20:23], v[124:127]
  v_mfma_f32_16x16x32_bf16 v[132:135], v[164:167], v[44:47], v[132:135]
  ds_read_b128 v[160:163], v11 offset:10240
  s_waitcnt vmcnt(21) lgkmcnt(6)
  v_mfma_f32_16x16x32_bf16 v[120:123], v[168:171], v[24:27], v[120:123]
  s_waitcnt vmcnt(20)
  v_mfma_f32_16x16x32_bf16 v[128:131], v[168:171], v[48:51], v[128:131]
  ds_read_b128 v[164:167], v11 offset:11264
  s_waitcnt lgkmcnt(6)
  v_mfma_f32_16x16x32_bf16 v[124:127], v[172:175], v[24:27], v[124:127]
  v_mfma_f32_16x16x32_bf16 v[132:135], v[172:175], v[48:51], v[132:135]
  ds_read_b128 v[168:171], v11 offset:12288
  s_waitcnt vmcnt(19) lgkmcnt(6)
  v_mfma_f32_16x16x32_bf16 v[120:123], v[176:179], v[28:31], v[120:123]
  s_waitcnt vmcnt(18)
  v_mfma_f32_16x16x32_bf16 v[128:131], v[176:179], v[52:55], v[128:131]
  ds_read_b128 v[172:175], v11 offset:13312
  s_waitcnt lgkmcnt(6)
  v_mfma_f32_16x16x32_bf16 v[124:127], v[180:183], v[28:31], v[124:127]
  v_mfma_f32_16x16x32_bf16 v[132:135], v[180:183], v[52:55], v[132:135]
  ds_read_b128 v[176:179], v11 offset:14336
  s_waitcnt vmcnt(17) lgkmcnt(6)
  v_mfma_f32_16x16x32_bf16 v[120:123], v[152:155], v[32:35], v[120:123]
  s_waitcnt vmcnt(16)
  v_mfma_f32_16x16x32_bf16 v[128:131], v[152:155], v[56:59], v[128:131]
  ds_read_b128 v[180:183], v11 offset:15360
  s_waitcnt lgkmcnt(6)
  v_mfma_f32_16x16x32_bf16 v[124:127], v[156:159], v[32:35], v[124:127]
  v_mfma_f32_16x16x32_bf16 v[132:135], v[156:159], v[56:59], v[132:135]
  ds_read_b128 v[152:155], v11 offset:16384
  s_waitcnt vmcnt(15) lgkmcnt(6)
  v_mfma_f32_16x16x32_bf16 v[120:123], v[160:163], v[36:39], v[120:123]
  s_waitcnt vmcnt(14)
  v_mfma_f32_16x16x32_bf16 v[128:131], v[160:163], v[60:63], v[128:131]
  ds_read_b128 v[156:159], v11 offset:17408
  s_waitcnt lgkmcnt(6)
  v_mfma_f32_16x16x32_bf16 v[124:127], v[164:167], v[36:39], v[124:127]
  v_mfma_f32_16x16x32_bf16 v[132:135], v[164:167], v[60:63], v[132:135]
  ds_read_b128 v[160:163], v11 offset:18432
  s_waitcnt lgkmcnt(6)
  v_mfma_f32_16x16x32_bf16 v[136:139], v[168:171], v[16:19], 0
  v_mfma_f32_16x16x32_bf16 v[144:147], v[168:171], v[40:43], 0
  ds_read_b128 v[164:167], v11 offset:19456
  s_waitcnt lgkmcnt(6)
  v_mfma_f32_16x16x32_bf16 v[140:143], v[172:175], v[16:19], 0
  v_mfma_f32_16x16x32_bf16 v[148:151], v[172:175], v[40:43], 0
  ds_read_b128 v[168:171], v11 offset:20480
  s_waitcnt lgkmcnt(6)
  v_mfma_f32_16x16x32_bf16 v[136:139], v[176:179], v[20:23], v[136:139]
  v_mfma_f32_16x16x32_bf16 v[144:147], v[176:179], v[44:47], v[144:147]
  ds_read_b128 v[172:175], v11 offset:21504
  s_waitcnt lgkmcnt(6)
  v_mfma_f32_16x16x32_bf16 v[140:143], v[180:183], v[20:23], v[140:143]
  v_cvt_pk_bf16_f32 v72, v120, v121
  v_cvt_pk_bf16_f32 v73, v122, v123
  v_mfma_f32_16x16x32_bf16 v[148:151], v[180:183], v[44:47], v[148:151]
  v_cvt_pk_bf16_f32 v74, v124, v125
  v_cvt_pk_bf16_f32 v75, v126, v127
  ds_read_b128 v[176:179], v11 offset:22528
  s_waitcnt lgkmcnt(6)
  v_mfma_f32_16x16x32_bf16 v[136:139], v[152:155], v[24:27], v[136:139]
  v_cvt_pk_bf16_f32 v96, v128, v129
  v_cvt_pk_bf16_f32 v97, v130, v131
  v_mfma_f32_16x16x32_bf16 v[144:147], v[152:155], v[48:51], v[144:147]
  v_cvt_pk_bf16_f32 v98, v132, v133
  v_cvt_pk_bf16_f32 v99, v134, v135
  ds_read_b128 v[180:183], v11 offset:23552
  s_waitcnt lgkmcnt(6)
  v_mfma_f32_16x16x32_bf16 v[140:143], v[156:159], v[24:27], v[140:143]
  v_mfma_f32_16x16x32_bf16 v[148:151], v[156:159], v[48:51], v[148:151]
  ds_read_b128 v[152:155], v11 offset:24576
  s_waitcnt lgkmcnt(6)
  v_mfma_f32_16x16x32_bf16 v[136:139], v[160:163], v[28:31], v[136:139]
  v_mfma_f32_16x16x32_bf16 v[144:147], v[160:163], v[52:55], v[144:147]
  ds_read_b128 v[156:159], v11 offset:25600
  s_waitcnt lgkmcnt(6)
  v_mfma_f32_16x16x32_bf16 v[140:143], v[164:167], v[28:31], v[140:143]
  v_mfma_f32_16x16x32_bf16 v[148:151], v[164:167], v[52:55], v[148:151]
  ds_read_b128 v[160:163], v11 offset:26624
  s_waitcnt lgkmcnt(6)
  v_mfma_f32_16x16x32_bf16 v[136:139], v[168:171], v[32:35], v[136:139]
  v_mfma_f32_16x16x32_bf16 v[144:147], v[168:171], v[56:59], v[144:147]
  ds_read_b128 v[164:167], v11 offset:27648
  s_waitcnt lgkmcnt(6)
  v_mfma_f32_16x16x32_bf16 v[140:143], v[172:175], v[32:35], v[140:143]
  v_mfma_f32_16x16x32_bf16 v[148:151], v[172:175], v[56:59], v[148:151]
  ds_read_b128 v[168:171], v11 offset:28672
  s_waitcnt lgkmcnt(6)
  v_mfma_f32_16x16x32_bf16 v[136:139], v[176:179], v[36:39], v[136:139]
  v_mfma_f32_16x16x32_bf16 v[144:147], v[176:179], v[60:63], v[144:147]
  ds_read_b128 v[172:175], v11 offset:29696
  s_waitcnt lgkmcnt(6)
  v_mfma_f32_16x16x32_bf16 v[140:143], v[180:183], v[36:39], v[140:143]
  v_mfma_f32_16x16x32_bf16 v[148:151], v[180:183], v[60:63], v[148:151]
  s_barrier
  ds_read_b128 v[176:179], v11 offset:30720
  s_waitcnt lgkmcnt(6)
  v_mfma_f32_16x16x32_bf16 v[120:123], v[152:155], v[16:19], 0
  v_mfma_f32_16x16x32_bf16 v[128:131], v[152:155], v[40:43], 0
  ds_read_b128 v[180:183], v11 offset:31744
  s_waitcnt lgkmcnt(6)
  v_mfma_f32_16x16x32_bf16 v[124:127], v[156:159], v[16:19], 0
  v_mfma_f32_16x16x32_bf16 v[132:135], v[156:159], v[40:43], 0
  ds_read_b128 v[152:155], v11 offset:32768
  s_waitcnt lgkmcnt(6)
  v_mfma_f32_16x16x32_bf16 v[120:123], v[160:163], v[20:23], v[120:123]
  v_mfma_f32_16x16x32_bf16 v[128:131], v[160:163], v[44:47], v[128:131]
  ds_read_b128 v[156:159], v11 offset:33792
  s_waitcnt lgkmcnt(6)
  v_mfma_f32_16x16x32_bf16 v[124:127], v[164:167], v[20:23], v[124:127]
  v_cvt_pk_bf16_f32 v76, v136, v137
  v_cvt_pk_bf16_f32 v77, v138, v139
  v_mfma_f32_16x16x32_bf16 v[132:135], v[164:167], v[44:47], v[132:135]
  v_cvt_pk_bf16_f32 v78, v140, v141
  v_cvt_pk_bf16_f32 v79, v142, v143
  ds_read_b128 v[160:163], v11 offset:34816
  s_waitcnt lgkmcnt(6)
  v_mfma_f32_16x16x32_bf16 v[120:123], v[168:171], v[24:27], v[120:123]
  v_cvt_pk_bf16_f32 v100, v144, v145
  v_cvt_pk_bf16_f32 v101, v146, v147
  v_mfma_f32_16x16x32_bf16 v[128:131], v[168:171], v[48:51], v[128:131]
  v_cvt_pk_bf16_f32 v102, v148, v149
  v_cvt_pk_bf16_f32 v103, v150, v151
  ds_read_b128 v[164:167], v11 offset:35840
  s_waitcnt lgkmcnt(6)
  v_mfma_f32_16x16x32_bf16 v[124:127], v[172:175], v[24:27], v[124:127]
  v_mfma_f32_16x16x32_bf16 v[132:135], v[172:175], v[48:51], v[132:135]
  ds_read_b128 v[168:171], v11 offset:36864
  s_waitcnt lgkmcnt(6)
  v_mfma_f32_16x16x32_bf16 v[120:123], v[176:179], v[28:31], v[120:123]
  v_mfma_f32_16x16x32_bf16 v[128:131], v[176:179], v[52:55], v[128:131]
  ds_read_b128 v[172:175], v11 offset:37888
  s_waitcnt lgkmcnt(6)
  v_mfma_f32_16x16x32_bf16 v[124:127], v[180:183], v[28:31], v[124:127]
  v_mfma_f32_16x16x32_bf16 v[132:135], v[180:183], v[52:55], v[132:135]
  ds_read_b128 v[176:179], v11 offset:38912
  s_waitcnt lgkmcnt(6)
  v_mfma_f32_16x16x32_bf16 v[120:123], v[152:155], v[32:35], v[120:123]
  v_mfma_f32_16x16x32_bf16 v[128:131], v[152:155], v[56:59], v[128:131]
  ds_read_b128 v[180:183], v11 offset:39936
  s_waitcnt lgkmcnt(6)
  v_mfma_f32_16x16x32_bf16 v[124:127], v[156:159], v[32:35], v[124:127]
  v_mfma_f32_16x16x32_bf16 v[132:135], v[156:159], v[56:59], v[132:135]
  ds_read_b128 v[152:155], v11 offset:40960
  s_waitcnt lgkmcnt(6)
  v_mfma_f32_16x16x32_bf16 v[120:123], v[160:163], v[36:39], v[120:123]
  v_mfma_f32_16x16x32_bf16 v[128:131], v[160:163], v[60:63], v[128:131]
  ds_read_b128 v[156:159], v11 offset:41984
  s_waitcnt lgkmcnt(6)
  v_mfma_f32_16x16x32_bf16 v[124:127], v[164:167], v[36:39], v[124:127]
  v_mfma_f32_16x16x32_bf16 v[132:135], v[164:167], v[60:63], v[132:135]
  ds_read_b128 v[160:163], v11 offset:43008
  s_waitcnt lgkmcnt(6)
  v_mfma_f32_16x16x32_bf16 v[136:139], v[168:171], v[16:19], 0
  v_mfma_f32_16x16x32_bf16 v[144:147], v[168:171], v[40:43], 0
  ds_read_b128 v[164:167], v11 offset:44032
  s_waitcnt lgkmcnt(6)
  v_mfma_f32_16x16x32_bf16 v[140:143], v[172:175], v[16:19], 0
  v_mfma_f32_16x16x32_bf16 v[148:151], v[172:175], v[40:43], 0
  ds_read_b128 v[168:171], v11 offset:45056
  s_waitcnt lgkmcnt(6)
  v_mfma_f32_16x16x32_bf16 v[136:139], v[176:179], v[20:23], v[136:139]
  v_mfma_f32_16x16x32_bf16 v[144:147], v[176:179], v[44:47], v[144:147]
  ds_read_b128 v[172:175], v11 offset:46080
  s_waitcnt lgkmcnt(6)
  v_mfma_f32_16x16x32_bf16 v[140:143], v[180:183], v[20:23], v[140:143]
  v_cvt_pk_bf16_f32 v80, v120, v121
  v_cvt_pk_bf16_f32 v81, v122, v123
  v_mfma_f32_16x16x32_bf16 v[148:151], v[180:183], v[44:47], v[148:151]
  v_cvt_pk_bf16_f32 v82, v124, v125
  v_cvt_pk_bf16_f32 v83, v126, v127
  ds_read_b128 v[176:179], v11 offset:47104
  s_waitcnt lgkmcnt(6)
  v_mfma_f32_16x16x32_bf16 v[136:139], v[152:155], v[24:27], v[136:139]
  v_cvt_pk_bf16_f32 v104, v128, v129
  v_cvt_pk_bf16_f32 v105, v130, v131
  v_mfma_f32_16x16x32_bf16 v[144:147], v[152:155], v[48:51], v[144:147]
  v_cvt_pk_bf16_f32 v106, v132, v133
  v_cvt_pk_bf16_f32 v107, v134, v135
  ds_read_b128 v[180:183], v11 offset:48128
  s_waitcnt lgkmcnt(6)
  v_mfma_f32_16x16x32_bf16 v[140:143], v[156:159], v[24:27], v[140:143]
  v_mfma_f32_16x16x32_bf16 v[148:151], v[156:159], v[48:51], v[148:151]
  ds_read_b128 v[152:155], v11 offset:49152
  s_waitcnt lgkmcnt(6)
  v_mfma_f32_16x16x32_bf16 v[136:139], v[160:163], v[28:31], v[136:139]
  v_mfma_f32_16x16x32_bf16 v[144:147], v[160:163], v[52:55], v[144:147]
  ds_read_b128 v[156:159], v11 offset:50176
  s_waitcnt lgkmcnt(6)
  v_mfma_f32_16x16x32_bf16 v[140:143], v[164:167], v[28:31], v[140:143]
  v_mfma_f32_16x16x32_bf16 v[148:151], v[164:167], v[52:55], v[148:151]
  ds_read_b128 v[160:163], v11 offset:51200
  s_waitcnt lgkmcnt(6)
  v_mfma_f32_16x16x32_bf16 v[136:139], v[168:171], v[32:35], v[136:139]
  v_mfma_f32_16x16x32_bf16 v[144:147], v[168:171], v[56:59], v[144:147]
  ds_read_b128 v[164:167], v11 offset:52224
  s_waitcnt lgkmcnt(6)
  v_mfma_f32_16x16x32_bf16 v[140:143], v[172:175], v[32:35], v[140:143]
  v_mfma_f32_16x16x32_bf16 v[148:151], v[172:175], v[56:59], v[148:151]
  ds_read_b128 v[168:171], v11 offset:53248
  s_waitcnt lgkmcnt(6)
  v_mfma_f32_16x16x32_bf16 v[136:139], v[176:179], v[36:39], v[136:139]
  v_mfma_f32_16x16x32_bf16 v[144:147], v[176:179], v[60:63], v[144:147]
  ds_read_b128 v[172:175], v11 offset:54272
  s_waitcnt lgkmcnt(6)
  v_mfma_f32_16x16x32_bf16 v[140:143], v[180:183], v[36:39], v[140:143]
  v_mfma_f32_16x16x32_bf16 v[148:151], v[180:183], v[60:63], v[148:151]
  s_waitcnt vmcnt(0)
  s_barrier
  ds_read_b128 v[176:179], v11 offset:55296
  s_waitcnt lgkmcnt(6)
  v_mfma_f32_16x16x32_bf16 v[120:123], v[152:155], v[16:19], 0
  v_mfma_f32_16x16x32_bf16 v[128:131], v[152:155], v[40:43], 0
  ds_read_b128 v[180:183], v11 offset:56320
  s_waitcnt lgkmcnt(6)
  v_mfma_f32_16x16x32_bf16 v[124:127], v[156:159], v[16:19], 0
  v_mfma_f32_16x16x32_bf16 v[132:135], v[156:159], v[40:43], 0
  ds_read_b128 v[152:155], v11 offset:57344
  s_waitcnt lgkmcnt(6)
  v_mfma_f32_16x16x32_bf16 v[120:123], v[160:163], v[20:23], v[120:123]
  v_mfma_f32_16x16x32_bf16 v[128:131], v[160:163], v[44:47], v[128:131]
  ds_read_b128 v[156:159], v11 offset:58368
  s_waitcnt lgkmcnt(6)
  v_mfma_f32_16x16x32_bf16 v[124:127], v[164:167], v[20:23], v[124:127]
  v_cvt_pk_bf16_f32 v84, v136, v137
  v_cvt_pk_bf16_f32 v85, v138, v139
  v_mfma_f32_16x16x32_bf16 v[132:135], v[164:167], v[44:47], v[132:135]
  v_cvt_pk_bf16_f32 v86, v140, v141
  v_cvt_pk_bf16_f32 v87, v142, v143
  ds_read_b128 v[160:163], v11 offset:59392
  s_waitcnt lgkmcnt(6)
  v_mfma_f32_16x16x32_bf16 v[120:123], v[168:171], v[24:27], v[120:123]
  v_cvt_pk_bf16_f32 v108, v144, v145
  v_cvt_pk_bf16_f32 v109, v146, v147
  v_mfma_f32_16x16x32_bf16 v[128:131], v[168:171], v[48:51], v[128:131]
  v_cvt_pk_bf16_f32 v110, v148, v149
  v_cvt_pk_bf16_f32 v111, v150, v151
  ds_read_b128 v[164:167], v11 offset:60416
  s_waitcnt lgkmcnt(6)
  v_mfma_f32_16x16x32_bf16 v[124:127], v[172:175], v[24:27], v[124:127]
  v_mfma_f32_16x16x32_bf16 v[132:135], v[172:175], v[48:51], v[132:135]
  ds_read_b128 v[168:171], v231 offset:0
  s_waitcnt lgkmcnt(6)
  v_mfma_f32_16x16x32_bf16 v[120:123], v[176:179], v[28:31], v[120:123]
  v_mfma_f32_16x16x32_bf16 v[128:131], v[176:179], v[52:55], v[128:131]
  ds_read_b128 v[172:175], v231 offset:1024
  s_waitcnt lgkmcnt(6)
  v_mfma_f32_16x16x32_bf16 v[124:127], v[180:183], v[28:31], v[124:127]
  v_mfma_f32_16x16x32_bf16 v[132:135], v[180:183], v[52:55], v[132:135]
  ds_read_b128 v[176:179], v231 offset:2048
  s_waitcnt lgkmcnt(6)
  v_mfma_f32_16x16x32_bf16 v[120:123], v[152:155], v[32:35], v[120:123]
  v_mfma_f32_16x16x32_bf16 v[128:131], v[152:155], v[56:59], v[128:131]
  ds_read_b128 v[180:183], v231 offset:3072
  s_waitcnt lgkmcnt(6)
  v_mfma_f32_16x16x32_bf16 v[124:127], v[156:159], v[32:35], v[124:127]
  v_mfma_f32_16x16x32_bf16 v[132:135], v[156:159], v[56:59], v[132:135]
  ds_read_b128 v[152:155], v231 offset:4096
  s_waitcnt lgkmcnt(6)
  v_mfma_f32_16x16x32_bf16 v[120:123], v[160:163], v[36:39], v[120:123]
  v_mfma_f32_16x16x32_bf16 v[128:131], v[160:163], v[60:63], v[128:131]
  ds_read_b128 v[156:159], v231 offset:5120
  s_waitcnt lgkmcnt(6)
  v_mfma_f32_16x16x32_bf16 v[124:127], v[164:167], v[36:39], v[124:127]
  v_mfma_f32_16x16x32_bf16 v[132:135], v[164:167], v[60:63], v[132:135]
  ds_read_b128 v[160:163], v231 offset:6144
  s_waitcnt lgkmcnt(6)
  v_mfma_f32_16x16x32_bf16 v[136:139], v[168:171], v[16:19], 0
  v_mfma_f32_16x16x32_bf16 v[144:147], v[168:171], v[40:43], 0
  ds_read_b128 v[164:167], v231 offset:7168
  s_waitcnt lgkmcnt(6)
  v_mfma_f32_16x16x32_bf16 v[140:143], v[172:175], v[16:19], 0
  v_mfma_f32_16x16x32_bf16 v[148:151], v[172:175], v[40:43], 0
  ds_read_b128 v[168:171], v231 offset:8192
  s_waitcnt lgkmcnt(6)
  v_mfma_f32_16x16x32_bf16 v[136:139], v[176:179], v[20:23], v[136:139]
  v_mfma_f32_16x16x32_bf16 v[144:147], v[176:179], v[44:47], v[144:147]
  ds_read_b128 v[172:175], v231 offset:9216
  s_waitcnt lgkmcnt(6)
  v_mfma_f32_16x16x32_bf16 v[140:143], v[180:183], v[20:23], v[140:143]
  v_cvt_pk_bf16_f32 v88, v120, v121
  v_cvt_pk_bf16_f32 v89, v122, v123
  v_mfma_f32_16x16x32_bf16 v[148:151], v[180:183], v[44:47], v[148:151]
  v_cvt_pk_bf16_f32 v90, v124, v125
  v_cvt_pk_bf16_f32 v91, v126, v127
  s_waitcnt lgkmcnt(5)
  v_mfma_f32_16x16x32_bf16 v[136:139], v[152:155], v[24:27], v[136:139]
  v_cvt_pk_bf16_f32 v112, v128, v129
  v_cvt_pk_bf16_f32 v113, v130, v131
  v_mfma_f32_16x16x32_bf16 v[144:147], v[152:155], v[48:51], v[144:147]
  v_cvt_pk_bf16_f32 v114, v132, v133
  v_cvt_pk_bf16_f32 v115, v134, v135
  s_waitcnt lgkmcnt(4)
  v_mfma_f32_16x16x32_bf16 v[140:143], v[156:159], v[24:27], v[140:143]
  v_mfma_f32_16x16x32_bf16 v[148:151], v[156:159], v[48:51], v[148:151]
  s_waitcnt lgkmcnt(3)
  v_mfma_f32_16x16x32_bf16 v[136:139], v[160:163], v[28:31], v[136:139]
  v_mfma_f32_16x16x32_bf16 v[144:147], v[160:163], v[52:55], v[144:147]
  s_waitcnt lgkmcnt(2)
  v_mfma_f32_16x16x32_bf16 v[140:143], v[164:167], v[28:31], v[140:143]
  v_mfma_f32_16x16x32_bf16 v[148:151], v[164:167], v[52:55], v[148:151]
  s_waitcnt lgkmcnt(1)
  v_mfma_f32_16x16x32_bf16 v[136:139], v[168:171], v[32:35], v[136:139]
  v_mfma_f32_16x16x32_bf16 v[144:147], v[168:171], v[56:59], v[144:147]
  s_waitcnt lgkmcnt(0)
  v_mfma_f32_16x16x32_bf16 v[140:143], v[172:175], v[32:35], v[140:143]
  v_mfma_f32_16x16x32_bf16 v[148:151], v[172:175], v[56:59], v[148:151]
  v_mfma_f32_16x16x32_bf16 v[136:139], v[232:235], v[36:39], v[136:139]
  v_mfma_f32_16x16x32_bf16 v[144:147], v[232:235], v[60:63], v[144:147]
  v_mfma_f32_16x16x32_bf16 v[140:143], v[236:239], v[36:39], v[140:143]
  v_mfma_f32_16x16x32_bf16 v[148:151], v[236:239], v[60:63], v[148:151]
  s_barrier
  s_mov_b32 s33, 145408
  buffer_load_dwordx4 v[232:235], v230, s[16:19], s33 offen offset:0
  buffer_load_dwordx4 v[236:239], v230, s[16:19], s33 offen offset:1024
  s_cmp_lt_u32 s20, 4
  s_cbranch_scc1 M_e1
  s_barrier
  s_branch M_e1b
M_e1:
  s_setprio 1
M_e1b:
  v_cvt_pk_bf16_f32 v92, v136, v137
  v_cvt_pk_bf16_f32 v93, v138, v139
  v_cvt_pk_bf16_f32 v94, v140, v141
  v_cvt_pk_bf16_f32 v95, v142, v143
  v_cvt_pk_bf16_f32 v116, v144, v145
  v_cvt_pk_bf16_f32 v117, v146, v147
  v_cvt_pk_bf16_f32 v118, v148, v149
  v_cvt_pk_bf16_f32 v119, v150, v151
  ds_read_b128 v[152:155], v216 offset:0
  ds_read_b128 v[156:159], v216 offset:2304
  ds_read_b128 v[160:163], v217 offset:0
  ds_read_b128 v[164:167], v217 offset:2304
  ds_read_b128 v[168:171], v218 offset:0
  ds_read_b128 v[172:175], v218 offset:2304
  ds_read_b128 v[176:179], v219 offset:0
  v_bfe_i32 v18, v240, 0, 1
  v_and_b32 v17, s38, v18
  v_and_b32 v18, s38, v18
  v_or_b32 v16, v17, v242
  v_or_b32 v19, v17, v243
  v_bfe_i32 v30, v240, 6, 1
  v_and_b32 v29, s38, v30
  v_and_b32 v30, s38, v30
  v_or_b32 v28, v29, v242
  v_or_b32 v31, v29, v243
  v_bfe_i32 v46, v241, 6, 1
  v_and_b32 v45, s38, v46
  v_and_b32 v46, s38, v46
  v_or_b32 v44, v45, v242
  v_or_b32 v47, v45, v243
  ds_read_b128 v[180:183], v219 offset:2304
  s_waitcnt lgkmcnt(7)
  v_mfma_f32_16x16x32_bf16 v[16:19], v[152:155], v[72:75], v[16:19]
  v_bfe_i32 v22, v240, 2, 1
  ds_read_b128 v[152:155], v216 offset:256
  s_waitcnt lgkmcnt(7)
  v_mfma_f32_16x16x32_bf16 v[28:31], v[156:159], v[72:75], v[28:31]
  v_and_b32 v21, s38, v22
  v_mfma_f32_16x16x32_bf16 v[44:47], v[156:159], v[96:99], v[44:47]
  v_and_b32 v22, s38, v22
  ds_read_b128 v[156:159], v216 offset:2560
  s_waitcnt lgkmcnt(7)
  v_mfma_f32_16x16x32_bf16 v[16:19], v[160:163], v[76:79], v[16:19]
  v_or_b32 v20, v21, v242
  ds_read_b128 v[160:163], v217 offset:256
  s_waitcnt lgkmcnt(7)
  v_mfma_f32_16x16x32_bf16 v[28:31], v[164:167], v[76:79], v[28:31]
  v_or_b32 v23, v21, v243
  v_mfma_f32_16x16x32_bf16 v[44:47], v[164:167], v[100:103], v[44:47]
  v_bfe_i32 v34, v240, 8, 1
  ds_read_b128 v[164:167], v217 offset:2560
  s_waitcnt lgkmcnt(7)
  v_mfma_f32_16x16x32_bf16 v[16:19], v[168:171], v[80:83], v[16:19]
  v_and_b32 v33, s38, v34
  ds_read_b128 v[168:171], v216 offset:768
  s_waitcnt lgkmcnt(7)
  v_mfma_f32_16x16x32_bf16 v[28:31], v[172:175], v[80:83], v[28:31]
  v_and_b32 v34, s38, v34
  v_mfma_f32_16x16x32_bf16 v[44:47], v[172:175], v[104:107], v[44:47]
  v_or_b32 v32, v33, v242
  ds_read_b128 v[172:175], v216 offset:3072
  s_waitcnt lgkmcnt(7)
  v_mfma_f32_16x16x32_bf16 v[16:19], v[176:179], v[84:87], v[16:19]
  v_or_b32 v35, v33, v243
  ds_read_b128 v[176:179], v217 offset:768
  s_waitcnt lgkmcnt(7)
  v_mfma_f32_16x16x32_bf16 v[28:31], v[180:183], v[84:87], v[28:31]
  v_bfe_i32 v50, v241, 8, 1
  v_mfma_f32_16x16x32_bf16 v[44:47], v[180:183], v[108:111], v[44:47]
  v_and_b32 v49, s38, v50
  ds_read_b128 v[180:183], v217 offset:3072
  s_waitcnt lgkmcnt(7)
  v_mfma_f32_16x16x32_bf16 v[16:19], v[152:155], v[88:91], v[16:19]
  v_and_b32 v50, s38, v50
  ds_read_b128 v[152:155], v218 offset:768
  s_waitcnt lgkmcnt(7)
  v_mfma_f32_16x16x32_bf16 v[28:31], v[156:159], v[88:91], v[28:31]
  v_or_b32 v48, v49, v242
  v_mfma_f32_16x16x32_bf16 v[44:47], v[156:159], v[112:115], v[44:47]
  v_or_b32 v51, v49, v243
  ds_read_b128 v[156:159], v218 offset:3072
  s_waitcnt lgkmcnt(7)
  v_mfma_f32_16x16x32_bf16 v[16:19], v[160:163], v[92:95], v[16:19]
  ds_read_b128 v[160:163], v219 offset:768
  s_waitcnt lgkmcnt(7)
  v_mfma_f32_16x16x32_bf16 v[28:31], v[164:167], v[92:95], v[28:31]
  v_mfma_f32_16x16x32_bf16 v[44:47], v[164:167], v[116:119], v[44:47]
  ds_read_b128 v[164:167], v219 offset:3072
  s_waitcnt lgkmcnt(7)
  v_mfma_f32_16x16x32_bf16 v[20:23], v[168:171], v[72:75], v[20:23]
  v_bfe_i32 v26, v240, 4, 1
  ds_read_b128 v[168:171], v216 offset:1024
  s_waitcnt lgkmcnt(7)
  v_mfma_f32_16x16x32_bf16 v[32:35], v[172:175], v[72:75], v[32:35]
  v_and_b32 v25, s38, v26
  v_mfma_f32_16x16x32_bf16 v[48:51], v[172:175], v[96:99], v[48:51]
  v_and_b32 v26, s38, v26
  ds_read_b128 v[172:175], v216 offset:3328
  s_waitcnt lgkmcnt(7)
  v_mfma_f32_16x16x32_bf16 v[20:23], v[176:179], v[76:79], v[20:23]
  v_or_b32 v24, v25, v242
  ds_read_b128 v[176:179], v217 offset:1024
  s_waitcnt lgkmcnt(7)
  v_mfma_f32_16x16x32_bf16 v[32:35], v[180:183], v[76:79], v[32:35]
  v_or_b32 v27, v25, v243
  v_mfma_f32_16x16x32_bf16 v[48:51], v[180:183], v[100:103], v[48:51]
  v_bfe_i32 v38, v240, 10, 1
  ds_read_b128 v[180:183], v217 offset:3328
  s_waitcnt lgkmcnt(7)
  v_mfma_f32_16x16x32_bf16 v[20:23], v[152:155], v[80:83], v[20:23]
  v_and_b32 v37, s38, v38
  ds_read_b128 v[152:155], v216 offset:1536
  s_waitcnt lgkmcnt(7)
  v_mfma_f32_16x16x32_bf16 v[32:35], v[156:159], v[80:83], v[32:35]
  v_and_b32 v38, s38, v38
  v_mfma_f32_16x16x32_bf16 v[48:51], v[156:159], v[104:107], v[48:51]
  v_or_b32 v36, v37, v242
  ds_read_b128 v[156:159], v216 offset:3840
  s_waitcnt lgkmcnt(7)
  v_mfma_f32_16x16x32_bf16 v[20:23], v[160:163], v[84:87], v[20:23]
  v_or_b32 v39, v37, v243
  ds_read_b128 v[160:163], v217 offset:1536
  s_waitcnt lgkmcnt(7)
  v_mfma_f32_16x16x32_bf16 v[32:35], v[164:167], v[84:87], v[32:35]
  v_bfe_i32 v54, v241, 10, 1
  v_mfma_f32_16x16x32_bf16 v[48:51], v[164:167], v[108:111], v[48:51]
  v_and_b32 v53, s38, v54
  ds_read_b128 v[164:167], v217 offset:3840
  s_waitcnt lgkmcnt(7)
  v_mfma_f32_16x16x32_bf16 v[20:23], v[168:171], v[88:91], v[20:23]
  v_and_b32 v54, s38, v54
  ds_read_b128 v[168:171], v218 offset:1536
  s_waitcnt lgkmcnt(7)
  v_mfma_f32_16x16x32_bf16 v[32:35], v[172:175], v[88:91], v[32:35]
  v_or_b32 v52, v53, v242
  v_mfma_f32_16x16x32_bf16 v[48:51], v[172:175], v[112:115], v[48:51]
  v_or_b32 v55, v53, v243
  ds_read_b128 v[172:175], v218 offset:3840
  s_waitcnt lgkmcnt(7)
  v_mfma_f32_16x16x32_bf16 v[20:23], v[176:179], v[92:95], v[20:23]
  ds_read_b128 v[176:179], v219 offset:1536
  s_waitcnt lgkmcnt(7)
  v_mfma_f32_16x16x32_bf16 v[32:35], v[180:183], v[92:95], v[32:35]
  v_mfma_f32_16x16x32_bf16 v[48:51], v[180:183], v[116:119], v[48:51]
  ds_read_b128 v[180:183], v219 offset:3840
  s_waitcnt lgkmcnt(7)
  v_mfma_f32_16x16x32_bf16 v[24:27], v[152:155], v[72:75], v[24:27]
  v_bfe_i32 v62, v241, 14, 1
  ds_read_b128 v[152:155], v216 offset:1792
  s_waitcnt lgkmcnt(7)
  v_mfma_f32_16x16x32_bf16 v[36:39], v[156:159], v[72:75], v[36:39]
  v_and_b32 v61, s38, v62
  v_mfma_f32_16x16x32_bf16 v[52:55], v[156:159], v[96:99], v[52:55]
  v_and_b32 v62, s38, v62
  ds_read_b128 v[156:159], v216 offset:4096
  s_waitcnt lgkmcnt(7)
  v_mfma_f32_16x16x32_bf16 v[24:27], v[160:163], v[76:79], v[24:27]
  v_or_b32 v60, v61, v242
  ds_read_b128 v[160:163], v217 offset:1792
  s_waitcnt lgkmcnt(7)
  v_mfma_f32_16x16x32_bf16 v[36:39], v[164:167], v[76:79], v[36:39]
  v_or_b32 v63, v61, v243
  v_mfma_f32_16x16x32_bf16 v[52:55], v[164:167], v[100:103], v[52:55]
  v_bfe_i32 v42, v240, 12, 1
  ds_read_b128 v[164:167], v217 offset:4096
  s_waitcnt lgkmcnt(7)
  v_mfma_f32_16x16x32_bf16 v[24:27], v[168:171], v[80:83], v[24:27]
  v_and_b32 v41, s38, v42
  ds_read_b128 v[168:171], v216 offset:5376
  s_waitcnt lgkmcnt(7)
  v_mfma_f32_16x16x32_bf16 v[36:39], v[172:175], v[80:83], v[36:39]
  v_and_b32 v42, s38, v42
  v_mfma_f32_16x16x32_bf16 v[52:55], v[172:175], v[104:107], v[52:55]
  v_or_b32 v40, v41, v242
  ds_read_b128 v[172:175], v216 offset:4608
  s_waitcnt lgkmcnt(7)
  v_mfma_f32_16x16x32_bf16 v[24:27], v[176:179], v[84:87], v[24:27]
  v_or_b32 v43, v41, v243
  ds_read_b128 v[176:179], v217 offset:5376
  s_waitcnt lgkmcnt(7)
  v_mfma_f32_16x16x32_bf16 v[36:39], v[180:183], v[84:87], v[36:39]
  v_bfe_i32 v58, v241, 12, 1
  v_mfma_f32_16x16x32_bf16 v[52:55], v[180:183], v[108:111], v[52:55]
  v_and_b32 v57, s38, v58
  ds_read_b128 v[180:183], v217 offset:4608
  s_waitcnt lgkmcnt(7)
  v_mfma_f32_16x16x32_bf16 v[24:27], v[152:155], v[88:91], v[24:27]
  v_and_b32 v58, s38, v58
  ds_read_b128 v[152:155], v218 offset:5376
  s_waitcnt lgkmcnt(7)
  v_mfma_f32_16x16x32_bf16 v[36:39], v[156:159], v[88:91], v[36:39]
  v_or_b32 v56, v57, v242
  v_mfma_f32_16x16x32_bf16 v[52:55], v[156:159], v[112:115], v[52:55]
  v_or_b32 v59, v57, v243
  ds_read_b128 v[156:159], v218 offset:4608
  s_waitcnt lgkmcnt(7)
  v_mfma_f32_16x16x32_bf16 v[24:27], v[160:163], v[92:95], v[24:27]
  ds_read_b128 v[160:163], v219 offset:5376
  s_waitcnt lgkmcnt(7)
  v_mfma_f32_16x16x32_bf16 v[36:39], v[164:167], v[92:95], v[36:39]
  v_mfma_f32_16x16x32_bf16 v[52:55], v[164:167], v[116:119], v[52:55]
  ds_read_b128 v[164:167], v219 offset:4608
  s_waitcnt lgkmcnt(7)
  v_mfma_f32_16x16x32_bf16 v[60:63], v[168:171], v[96:99], v[60:63]
  v_bfe_i32 v66, v241, 16, 1
  ds_read_b128 v[168:171], v216 offset:5632
  s_waitcnt lgkmcnt(7)
  v_mfma_f32_16x16x32_bf16 v[40:43], v[172:175], v[72:75], v[40:43]
  v_and_b32 v65, s38, v66
  v_mfma_f32_16x16x32_bf16 v[56:59], v[172:175], v[96:99], v[56:59]
  v_and_b32 v66, s38, v66
  ds_read_b128 v[172:175], v216 offset:4864
  s_waitcnt lgkmcnt(7)
  v_mfma_f32_16x16x32_bf16 v[60:63], v[176:179], v[100:103], v[60:63]
  v_or_b32 v64, v65, v242
  ds_read_b128 v[176:179], v217 offset:5632
  s_waitcnt lgkmcnt(7)
  v_mfma_f32_16x16x32_bf16 v[40:43], v[180:183], v[76:79], v[40:43]
  v_or_b32 v67, v65, v243
  v_mfma_f32_16x16x32_bf16 v[56:59], v[180:183], v[100:103], v[56:59]
  v_bfe_i32 v70, v241, 18, 1
  ds_read_b128 v[180:183], v217 offset:4864
  s_waitcnt lgkmcnt(7)
  v_mfma_f32_16x16x32_bf16 v[60:63], v[152:155], v[104:107], v[60:63]
  v_and_b32 v69, s38, v70
  ds_read_b128 v[152:155], v216 offset:6144
  s_waitcnt lgkmcnt(7)
  v_mfma_f32_16x16x32_bf16 v[40:43], v[156:159], v[80:83], v[40:43]
  v_and_b32 v70, s38, v70
  v_mfma_f32_16x16x32_bf16 v[56:59], v[156:159], v[104:107], v[56:59]
  v_or_b32 v68, v69, v242
  ds_read_b128 v[156:159], v216 offset:6912
  s_waitcnt lgkmcnt(7)
  v_mfma_f32_16x16x32_bf16 v[60:63], v[160:163], v[108:111], v[60:63]
  v_or_b32 v71, v69, v243
  ds_read_b128 v[160:163], v217 offset:6144
  s_waitcnt lgkmcnt(7)
  v_mfma_f32_16x16x32_bf16 v[40:43], v[164:167], v[84:87], v[40:43]
  v_mfma_f32_16x16x32_bf16 v[56:59], v[164:167], v[108:111], v[56:59]
  ds_read_b128 v[164:167], v217 offset:6912
  s_waitcnt lgkmcnt(7)
  v_mfma_f32_16x16x32_bf16 v[60:63], v[168:171], v[112:115], v[60:63]
  ds_read_b128 v[168:171], v218 offset:6144
  s_waitcnt lgkmcnt(7)
  v_mfma_f32_16x16x32_bf16 v[40:43], v[172:175], v[88:91], v[40:43]
  v_mfma_f32_16x16x32_bf16 v[56:59], v[172:175], v[112:115], v[56:59]
  ds_read_b128 v[172:175], v218 offset:6912
  s_waitcnt lgkmcnt(7)
  v_mfma_f32_16x16x32_bf16 v[60:63], v[176:179], v[116:119], v[60:63]
  ds_read_b128 v[176:179], v219 offset:6144
  s_waitcnt lgkmcnt(7)
  v_mfma_f32_16x16x32_bf16 v[40:43], v[180:183], v[92:95], v[40:43]
  v_mfma_f32_16x16x32_bf16 v[56:59], v[180:183], v[116:119], v[56:59]
  ds_read_b128 v[180:183], v219 offset:6912
  s_waitcnt lgkmcnt(7)
  v_mfma_f32_16x16x32_bf16 v[64:67], v[152:155], v[96:99], v[64:67]
  ds_read_b128 v[152:155], v216 offset:6400
  s_waitcnt lgkmcnt(7)
  v_mfma_f32_16x16x32_bf16 v[68:71], v[156:159], v[96:99], v[68:71]
  ds_read_b128 v[156:159], v216 offset:7168
  s_waitcnt lgkmcnt(7)
  v_mfma_f32_16x16x32_bf16 v[64:67], v[160:163], v[100:103], v[64:67]
  ds_read_b128 v[160:163], v217 offset:6400
  s_waitcnt lgkmcnt(7)
  v_mfma_f32_16x16x32_bf16 v[68:71], v[164:167], v[100:103], v[68:71]
  ds_read_b128 v[164:167], v217 offset:7168
  s_waitcnt lgkmcnt(7)
  v_mfma_f32_16x16x32_bf16 v[64:67], v[168:171], v[104:107], v[64:67]
  s_waitcnt lgkmcnt(6)
  v_mfma_f32_16x16x32_bf16 v[68:71], v[172:175], v[104:107], v[68:71]
  s_waitcnt lgkmcnt(5)
  v_mfma_f32_16x16x32_bf16 v[64:67], v[176:179], v[108:111], v[64:67]
  s_waitcnt lgkmcnt(4)
  v_mfma_f32_16x16x32_bf16 v[68:71], v[180:183], v[108:111], v[68:71]
  s_waitcnt lgkmcnt(3)
  v_mfma_f32_16x16x32_bf16 v[64:67], v[152:155], v[112:115], v[64:67]
  s_waitcnt lgkmcnt(2)
  v_mfma_f32_16x16x32_bf16 v[68:71], v[156:159], v[112:115], v[68:71]
  s_waitcnt lgkmcnt(1)
  v_mfma_f32_16x16x32_bf16 v[64:67], v[160:163], v[116:119], v[64:67]
  s_waitcnt lgkmcnt(0)
  v_mfma_f32_16x16x32_bf16 v[68:71], v[164:167], v[116:119], v[68:71]
  s_cmp_ge_u32 s20, 4
  s_cbranch_scc1 M_l1
  s_barrier
M_l1:
  v_max3_f32 v4, v16, v17, v18
  v_max3_f32 v6, v19, v20, v21
  v_max3_f32 v5, v44, v45, v46
  v_max3_f32 v7, v47, v48, v49
  v_max3_f32 v4, v4, v22, v23
  v_max3_f32 v6, v6, v24, v25
  v_max3_f32 v5, v5, v50, v51
  v_max3_f32 v7, v7, v52, v53
  v_max3_f32 v4, v4, v26, v27
  v_max3_f32 v6, v6, v28, v29
  v_max3_f32 v5, v5, v54, v55
  v_max3_f32 v7, v7, v56, v57
  v_max3_f32 v4, v4, v30, v31
  v_max3_f32 v6, v6, v32, v33
  v_max3_f32 v5, v5, v58, v59
  v_max3_f32 v7, v7, v60, v61
  v_max3_f32 v4, v4, v34, v35
  v_max3_f32 v6, v6, v36, v37
  v_max3_f32 v5, v5, v62, v63
  v_max3_f32 v7, v7, v64, v65
  v_max3_f32 v4, v4, v38, v39
  v_max3_f32 v6, v6, v40, v41
  v_max3_f32 v5, v5, v66, v67
  v_max3_f32 v7, v7, v68, v69
  v_max3_f32 v4, v4, v42, v43
  v_max3_f32 v5, v5, v70, v71
  v_max_f32 v4, v4, v6
  v_max_f32 v5, v5, v7
  v_mov_b32 v6, v4
  v_mov_b32 v7, v5
  s_nop 0
  v_permlane32_swap_b32 v4, v6
  v_permlane32_swap_b32 v5, v7
  v_max_f32 v4, v4, v6
  v_max_f32 v5, v5, v7
  v_mov_b32 v6, v4
  v_mov_b32 v7, v5
  s_nop 0
  v_permlane16_swap_b32 v4, v6
  v_permlane16_swap_b32 v5, v7
  v_max_f32 v4, v4, v6
  v_max_f32 v5, v5, v7
  v_mov_b32 v198, 0
  v_mov_b32 v199, 0
  v_mov_b32 v200, 0
  v_mov_b32 v201, 0
  v_sub_f32 v16, v16, v4
  v_sub_f32 v17, v17, v4
  v_sub_f32 v18, v18, v4
  v_sub_f32 v19, v19, v4
  v_exp_f32 v16, v16
  v_exp_f32 v17, v17
  v_exp_f32 v18, v18
  v_exp_f32 v19, v19
  v_sub_f32 v44, v44, v5
  v_sub_f32 v45, v45, v5
  v_sub_f32 v46, v46, v5
  v_sub_f32 v47, v47, v5
  v_exp_f32 v44, v44
  v_exp_f32 v45, v45
  v_exp_f32 v46, v46
  v_exp_f32 v47, v47
  v_cvt_pk_bf16_f32 v184, v16, v17
  v_cvt_pk_bf16_f32 v185, v18, v19
  v_add_f32 v16, v16, v17
  v_add_f32 v18, v18, v19
  v_add_f32 v8, v16, v18
  v_cvt_pk_bf16_f32 v202, v44, v45
  v_cvt_pk_bf16_f32 v203, v46, v47
  v_add_f32 v44, v44, v45
  v_add_f32 v46, v46, v47
  v_add_f32 v9, v44, v46
  v_sub_f32 v20, v20, v4
  v_sub_f32 v21, v21, v4
  v_sub_f32 v22, v22, v4
  v_sub_f32 v23, v23, v4
  v_exp_f32 v20, v20
  v_exp_f32 v21, v21
  v_exp_f32 v22, v22
  v_exp_f32 v23, v23
  v_sub_f32 v48, v48, v5
  v_sub_f32 v49, v49, v5
  v_sub_f32 v50, v50, v5
  v_sub_f32 v51, v51, v5
  v_exp_f32 v48, v48
  v_exp_f32 v49, v49
  v_exp_f32 v50, v50
  v_exp_f32 v51, v51
  v_cvt_pk_bf16_f32 v186, v20, v21
  v_cvt_pk_bf16_f32 v187, v22, v23
  v_add_f32 v20, v20, v21
  v_add_f32 v22, v22, v23
  v_add_f32 v20, v20, v22
  v_add_f32 v8, v8, v20
  v_cvt_pk_bf16_f32 v204, v48, v49
  v_cvt_pk_bf16_f32 v205, v50, v51
  v_add_f32 v48, v48, v49
  v_add_f32 v50, v50, v51
  v_add_f32 v48, v48, v50
  v_add_f32 v9, v9, v48
  v_sub_f32 v24, v24, v4
  v_sub_f32 v25, v25, v4
  v_sub_f32 v26, v26, v4
  v_sub_f32 v27, v27, v4
  v_exp_f32 v24, v24
  v_exp_f32 v25, v25
  v_exp_f32 v26, v26
  v_exp_f32 v27, v27
  v_sub_f32 v52, v52, v5
  v_sub_f32 v53, v53, v5
  v_sub_f32 v54, v54, v5
  v_sub_f32 v55, v55, v5
  v_exp_f32 v52, v52
  v_exp_f32 v53, v53
  v_exp_f32 v54, v54
  v_exp_f32 v55, v55
  v_cvt_pk_bf16_f32 v188, v24, v25
  v_cvt_pk_bf16_f32 v189, v26, v27
  v_add_f32 v24, v24, v25
  v_add_f32 v26, v26, v27
  v_add_f32 v24, v24, v26
  v_add_f32 v8, v8, v24
  v_cvt_pk_bf16_f32 v206, v52, v53
  v_cvt_pk_bf16_f32 v207, v54, v55
  v_add_f32 v52, v52, v53
  v_add_f32 v54, v54, v55
  v_add_f32 v52, v52, v54
  v_add_f32 v9, v9, v52
  v_sub_f32 v28, v28, v4
  v_sub_f32 v29, v29, v4
  v_sub_f32 v30, v30, v4
  v_sub_f32 v31, v31, v4
  v_exp_f32 v28, v28
  v_exp_f32 v29, v29
  v_exp_f32 v30, v30
  v_exp_f32 v31, v31
  v_sub_f32 v56, v56, v5
  v_sub_f32 v57, v57, v5
  v_sub_f32 v58, v58, v5
  v_sub_f32 v59, v59, v5
  v_exp_f32 v56, v56
  v_exp_f32 v57, v57
  v_exp_f32 v58, v58
  v_exp_f32 v59, v59
  v_cvt_pk_bf16_f32 v190, v28, v29
  v_cvt_pk_bf16_f32 v191, v30, v31
  v_add_f32 v28, v28, v29
  v_add_f32 v30, v30, v31
  v_add_f32 v28, v28, v30
  v_add_f32 v8, v8, v28
  v_cvt_pk_bf16_f32 v208, v56, v57
  v_cvt_pk_bf16_f32 v209, v58, v59
  v_add_f32 v56, v56, v57
  v_add_f32 v58, v58, v59
  v_add_f32 v56, v56, v58
  v_add_f32 v9, v9, v56
  v_sub_f32 v32, v32, v4
  v_sub_f32 v33, v33, v4
  v_sub_f32 v34, v34, v4
  v_sub_f32 v35, v35, v4
  v_exp_f32 v32, v32
  v_exp_f32 v33, v33
  v_exp_f32 v34, v34
  v_exp_f32 v35, v35
  v_sub_f32 v60, v60, v5
  v_sub_f32 v61, v61, v5
  v_sub_f32 v62, v62, v5
  v_sub_f32 v63, v63, v5
  v_exp_f32 v60, v60
  v_exp_f32 v61, v61
  v_exp_f32 v62, v62
  v_exp_f32 v63, v63
  v_cvt_pk_bf16_f32 v192, v32, v33
  v_cvt_pk_bf16_f32 v193, v34, v35
  v_add_f32 v32, v32, v33
  v_add_f32 v34, v34, v35
  v_add_f32 v32, v32, v34
  v_add_f32 v8, v8, v32
  v_cvt_pk_bf16_f32 v210, v60, v61
  v_cvt_pk_bf16_f32 v211, v62, v63
  v_add_f32 v60, v60, v61
  v_add_f32 v62, v62, v63
  v_add_f32 v60, v60, v62
  v_add_f32 v9, v9, v60
  v_sub_f32 v36, v36, v4
  v_sub_f32 v37, v37, v4
  v_sub_f32 v38, v38, v4
  v_sub_f32 v39, v39, v4
  v_exp_f32 v36, v36
  v_exp_f32 v37, v37
  v_exp_f32 v38, v38
  v_exp_f32 v39, v39
  v_sub_f32 v64, v64, v5
  v_sub_f32 v65, v65, v5
  v_sub_f32 v66, v66, v5
  v_sub_f32 v67, v67, v5
  v_exp_f32 v64, v64
  v_exp_f32 v65, v65
  v_exp_f32 v66, v66
  v_exp_f32 v67, v67
  v_cvt_pk_bf16_f32 v194, v36, v37
  v_cvt_pk_bf16_f32 v195, v38, v39
  v_add_f32 v36, v36, v37
  v_add_f32 v38, v38, v39
  v_add_f32 v36, v36, v38
  v_add_f32 v8, v8, v36
  v_cvt_pk_bf16_f32 v212, v64, v65
  v_cvt_pk_bf16_f32 v213, v66, v67
  v_add_f32 v64, v64, v65
  v_add_f32 v66, v66, v67
  v_add_f32 v64, v64, v66
  v_add_f32 v9, v9, v64
  v_sub_f32 v40, v40, v4
  v_sub_f32 v41, v41, v4
  v_sub_f32 v42, v42, v4
  v_sub_f32 v43, v43, v4
  v_exp_f32 v40, v40
  v_exp_f32 v41, v41
  v_exp_f32 v42, v42
  v_exp_f32 v43, v43
  v_sub_f32 v68, v68, v5
  v_sub_f32 v69, v69, v5
  v_sub_f32 v70, v70, v5
  v_sub_f32 v71, v71, v5
  v_exp_f32 v68, v68
  v_exp_f32 v69, v69
  v_exp_f32 v70, v70
  v_exp_f32 v71, v71
  v_cvt_pk_bf16_f32 v196, v40, v41
  v_cvt_pk_bf16_f32 v197, v42, v43
  v_add_f32 v40, v40, v41
  v_add_f32 v42, v42, v43
  v_add_f32 v40, v40, v42
  v_add_f32 v8, v8, v40
  v_cvt_pk_bf16_f32 v214, v68, v69
  v_cvt_pk_bf16_f32 v215, v70, v71
  v_add_f32 v68, v68, v69
  v_add_f32 v70, v70, v71
  v_add_f32 v68, v68, v70
  v_add_f32 v9, v9, v68
  v_mov_b32 v6, v8
  v_mov_b32 v7, v9
  s_nop 0
  v_permlane32_swap_b32 v8, v6
  v_permlane32_swap_b32 v9, v7
  v_add_f32 v8, v8, v6
  v_add_f32 v9, v9, v7
  v_mov_b32 v6, v8
  v_mov_b32 v7, v9
  s_nop 0
  v_permlane16_swap_b32 v8, v6
  v_permlane16_swap_b32 v9, v7
  v_add_f32 v8, v8, v6
  v_add_f32 v9, v9, v7
  v_rcp_f32 v244, v8
  v_rcp_f32 v245, v9
  s_cmp_lt_u32 s20, 4
  s_cbranch_scc1 M_e2
  s_barrier
M_e2:
  ds_read_b64_tr_b16 v[152:153], v220 offset:0
  ds_read_b64_tr_b16 v[154:155], v220 offset:768
  ds_read_b64_tr_b16 v[156:157], v221 offset:0
  ds_read_b64_tr_b16 v[158:159], v221 offset:768
  ds_read_b64_tr_b16 v[160:161], v220 offset:1536
  ds_read_b64_tr_b16 v[162:163], v220 offset:2304
  ds_read_b64_tr_b16 v[164:165], v221 offset:1536
  ds_read_b64_tr_b16 v[166:167], v221 offset:2304
  ds_read_b64_tr_b16 v[168:169], v220 offset:3072
  ds_read_b64_tr_b16 v[170:171], v220 offset:3840
  ds_read_b64_tr_b16 v[172:173], v221 offset:3072
  ds_read_b64_tr_b16 v[174:175], v221 offset:3840
  ds_read_b64_tr_b16 v[176:177], v220 offset:4608
  ds_read_b64_tr_b16 v[178:179], v220 offset:5376
  s_waitcnt lgkmcnt(12)
  v_mfma_f32_16x16x32_bf16 v[120:123], v[152:155], v[184:187], 0
  ds_read_b64_tr_b16 v[180:181], v221 offset:4608
  ds_read_b64_tr_b16 v[182:183], v221 offset:5376
  s_waitcnt lgkmcnt(12)
  v_mfma_f32_16x16x32_bf16 v[124:127], v[156:159], v[184:187], 0
  ds_read_b64_tr_b16 v[152:153], v220 offset:6144
  ds_read_b64_tr_b16 v[154:155], v220 offset:6912
  s_waitcnt lgkmcnt(12)
  v_mfma_f32_16x16x32_bf16 v[120:123], v[160:163], v[188:191], v[120:123]
  v_mfma_f32_16x16x32_bf16 v[128:131], v[160:163], v[200:203], 0
  ds_read_b64_tr_b16 v[156:157], v221 offset:6144
  ds_read_b64_tr_b16 v[158:159], v221 offset:6912
  s_waitcnt lgkmcnt(12)
  v_mfma_f32_16x16x32_bf16 v[124:127], v[164:167], v[188:191], v[124:127]
  v_mfma_f32_16x16x32_bf16 v[132:135], v[164:167], v[200:203], 0
  ds_read_b64_tr_b16 v[160:161], v222 offset:0
  ds_read_b64_tr_b16 v[162:163], v222 offset:768
  s_waitcnt lgkmcnt(12)
  v_mfma_f32_16x16x32_bf16 v[120:123], v[168:171], v[192:195], v[120:123]
  v_mfma_f32_16x16x32_bf16 v[128:131], v[168:171], v[204:207], v[128:131]
  ds_read_b64_tr_b16 v[164:165], v223 offset:0
  ds_read_b64_tr_b16 v[166:167], v223 offset:768
  s_waitcnt lgkmcnt(12)
  v_mfma_f32_16x16x32_bf16 v[124:127], v[172:175], v[192:195], v[124:127]
  v_mfma_f32_16x16x32_bf16 v[132:135], v[172:175], v[204:207], v[132:135]
  ds_read_b64_tr_b16 v[168:169], v222 offset:1536
  ds_read_b64_tr_b16 v[170:171], v222 offset:2304
  s_waitcnt lgkmcnt(12)
  v_mfma_f32_16x16x32_bf16 v[120:123], v[176:179], v[196:199], v[120:123]
  v_mfma_f32_16x16x32_bf16 v[128:131], v[176:179], v[208:211], v[128:131]
  ds_read_b64_tr_b16 v[172:173], v223 offset:1536
  ds_read_b64_tr_b16 v[174:175], v223 offset:2304
  s_waitcnt lgkmcnt(12)
  v_mfma_f32_16x16x32_bf16 v[124:127], v[180:183], v[196:199], v[124:127]
  v_mfma_f32_16x16x32_bf16 v[132:135], v[180:183], v[208:211], v[132:135]
  ds_read_b64_tr_b16 v[176:177], v222 offset:3072
  ds_read_b64_tr_b16 v[178:179], v222 offset:3840
  s_waitcnt lgkmcnt(12)
  v_mfma_f32_16x16x32_bf16 v[128:131], v[152:155], v[212:215], v[128:131]
  ds_read_b64_tr_b16 v[180:181], v223 offset:3072
  ds_read_b64_tr_b16 v[182:183], v223 offset:3840
  s_waitcnt lgkmcnt(12)
  v_mfma_f32_16x16x32_bf16 v[132:135], v[156:159], v[212:215], v[132:135]
  ds_read_b64_tr_b16 v[152:153], v222 offset:4608
  ds_read_b64_tr_b16 v[154:155], v222 offset:5376
  s_waitcnt lgkmcnt(12)
  v_mfma_f32_16x16x32_bf16 v[136:139], v[160:163], v[184:187], 0
  ds_read_b64_tr_b16 v[156:157], v223 offset:4608
  ds_read_b64_tr_b16 v[158:159], v223 offset:5376
  s_waitcnt lgkmcnt(12)
  v_mfma_f32_16x16x32_bf16 v[140:143], v[164:167], v[184:187], 0
  ds_read_b64_tr_b16 v[160:161], v222 offset:6144
  ds_read_b64_tr_b16 v[162:163], v222 offset:6912
  s_waitcnt lgkmcnt(12)
  v_mfma_f32_16x16x32_bf16 v[136:139], v[168:171], v[188:191], v[136:139]
  v_mfma_f32_16x16x32_bf16 v[144:147], v[168:171], v[200:203], 0
  ds_read_b64_tr_b16 v[164:165], v223 offset:6144
  ds_read_b64_tr_b16 v[166:167], v223 offset:6912
  s_waitcnt lgkmcnt(12)
  v_mfma_f32_16x16x32_bf16 v[140:143], v[172:175], v[188:191], v[140:143]
  v_mfma_f32_16x16x32_bf16 v[148:151], v[172:175], v[200:203], 0
  ds_read_b64_tr_b16 v[168:169], v224 offset:0
  ds_read_b64_tr_b16 v[170:171], v224 offset:768
  s_waitcnt lgkmcnt(12)
  v_mfma_f32_16x16x32_bf16 v[136:139], v[176:179], v[192:195], v[136:139]
  v_cvt_pk_bf16_f32 v72, v120, v121
  v_mfma_f32_16x16x32_bf16 v[144:147], v[176:179], v[204:207], v[144:147]
  v_cvt_pk_bf16_f32 v73, v122, v123
  ds_read_b64_tr_b16 v[172:173], v225 offset:0
  ds_read_b64_tr_b16 v[174:175], v225 offset:768
  s_waitcnt lgkmcnt(12)
  v_mfma_f32_16x16x32_bf16 v[140:143], v[180:183], v[192:195], v[140:143]
  v_cvt_pk_bf16_f32 v74, v124, v125
  v_mfma_f32_16x16x32_bf16 v[148:151], v[180:183], v[204:207], v[148:151]
  v_cvt_pk_bf16_f32 v75, v126, v127
  ds_read_b64_tr_b16 v[176:177], v224 offset:1536
  ds_read_b64_tr_b16 v[178:179], v224 offset:2304
  s_waitcnt lgkmcnt(12)
  v_mfma_f32_16x16x32_bf16 v[136:139], v[152:155], v[196:199], v[136:139]
  v_cvt_pk_bf16_f32 v96, v128, v129
  v_mfma_f32_16x16x32_bf16 v[144:147], v[152:155], v[208:211], v[144:147]
  v_cvt_pk_bf16_f32 v97, v130, v131
  ds_read_b64_tr_b16 v[180:181], v225 offset:1536
  ds_read_b64_tr_b16 v[182:183], v225 offset:2304
  s_waitcnt lgkmcnt(12)
  v_mfma_f32_16x16x32_bf16 v[140:143], v[156:159], v[196:199], v[140:143]
  v_cvt_pk_bf16_f32 v98, v132, v133
  v_mfma_f32_16x16x32_bf16 v[148:151], v[156:159], v[208:211], v[148:151]
  v_cvt_pk_bf16_f32 v99, v134, v135
  ds_read_b64_tr_b16 v[152:153], v224 offset:3072
  ds_read_b64_tr_b16 v[154:155], v224 offset:3840
  s_waitcnt lgkmcnt(12)
  v_mfma_f32_16x16x32_bf16 v[144:147], v[160:163], v[212:215], v[144:147]
  ds_read_b64_tr_b16 v[156:157], v225 offset:3072
  ds_read_b64_tr_b16 v[158:159], v225 offset:3840
  s_waitcnt lgkmcnt(12)
  v_mfma_f32_16x16x32_bf16 v[148:151], v[164:167], v[212:215], v[148:151]
  ds_read_b64_tr_b16 v[160:161], v224 offset:4608
  ds_read_b64_tr_b16 v[162:163], v224 offset:5376
  s_waitcnt lgkmcnt(12)
  v_mfma_f32_16x16x32_bf16 v[120:123], v[168:171], v[184:187], 0
  ds_read_b64_tr_b16 v[164:165], v225 offset:4608
  ds_read_b64_tr_b16 v[166:167], v225 offset:5376
  s_waitcnt lgkmcnt(12)
  v_mfma_f32_16x16x32_bf16 v[124:127], v[172:175], v[184:187], 0
  ds_read_b64_tr_b16 v[168:169], v224 offset:6144
  ds_read_b64_tr_b16 v[170:171], v224 offset:6912
  s_waitcnt lgkmcnt(12)
  v_mfma_f32_16x16x32_bf16 v[120:123], v[176:179], v[188:191], v[120:123]
  v_mfma_f32_16x16x32_bf16 v[128:131], v[176:179], v[200:203], 0
  ds_read_b64_tr_b16 v[172:173], v225 offset:6144
  ds_read_b64_tr_b16 v[174:175], v225 offset:6912
  s_waitcnt lgkmcnt(12)
  v_mfma_f32_16x16x32_bf16 v[124:127], v[180:183], v[188:191], v[124:127]
  v_mfma_f32_16x16x32_bf16 v[132:135], v[180:183], v[200:203], 0
  ds_read_b64_tr_b16 v[176:177], v226 offset:0
  ds_read_b64_tr_b16 v[178:179], v226 offset:768
  s_waitcnt lgkmcnt(12)
  v_mfma_f32_16x16x32_bf16 v[120:123], v[152:155], v[192:195], v[120:123]
  v_cvt_pk_bf16_f32 v76, v136, v137
  v_mfma_f32_16x16x32_bf16 v[128:131], v[152:155], v[204:207], v[128:131]
  v_cvt_pk_bf16_f32 v77, v138, v139
  ds_read_b64_tr_b16 v[180:181], v227 offset:0
  ds_read_b64_tr_b16 v[182:183], v227 offset:768
  s_waitcnt lgkmcnt(12)
  v_mfma_f32_16x16x32_bf16 v[124:127], v[156:159], v[192:195], v[124:127]
  v_cvt_pk_bf16_f32 v78, v140, v141
  v_mfma_f32_16x16x32_bf16 v[132:135], v[156:159], v[204:207], v[132:135]
  v_cvt_pk_bf16_f32 v79, v142, v143
  ds_read_b64_tr_b16 v[152:153], v226 offset:1536
  ds_read_b64_tr_b16 v[154:155], v226 offset:2304
  s_waitcnt lgkmcnt(12)
  v_mfma_f32_16x16x32_bf16 v[120:123], v[160:163], v[196:199], v[120:123]
  v_cvt_pk_bf16_f32 v100, v144, v145
  v_mfma_f32_16x16x32_bf16 v[128:131], v[160:163], v[208:211], v[128:131]
  v_cvt_pk_bf16_f32 v101, v146, v147
  ds_read_b64_tr_b16 v[156:157], v227 offset:1536
  ds_read_b64_tr_b16 v[158:159], v227 offset:2304
  s_waitcnt lgkmcnt(12)
  v_mfma_f32_16x16x32_bf16 v[124:127], v[164:167], v[196:199], v[124:127]
  v_cvt_pk_bf16_f32 v102, v148, v149
  v_mfma_f32_16x16x32_bf16 v[132:135], v[164:167], v[208:211], v[132:135]
  v_cvt_pk_bf16_f32 v103, v150, v151
  ds_read_b64_tr_b16 v[160:161], v226 offset:3072
  ds_read_b64_tr_b16 v[162:163], v226 offset:3840
  s_waitcnt lgkmcnt(12)
  v_mfma_f32_16x16x32_bf16 v[128:131], v[168:171], v[212:215], v[128:131]
  ds_read_b64_tr_b16 v[164:165], v227 offset:3072
  ds_read_b64_tr_b16 v[166:167], v227 offset:3840
  s_waitcnt lgkmcnt(12)
  v_mfma_f32_16x16x32_bf16 v[132:135], v[172:175], v[212:215], v[132:135]
  ds_read_b64_tr_b16 v[168:169], v226 offset:4608
  ds_read_b64_tr_b16 v[170:171], v226 offset:5376
  s_waitcnt lgkmcnt(12)
  v_mfma_f32_16x16x32_bf16 v[136:139], v[176:179], v[184:187], 0
  ds_read_b64_tr_b16 v[172:173], v227 offset:4608
  ds_read_b64_tr_b16 v[174:175], v227 offset:5376
  s_waitcnt lgkmcnt(12)
  v_mfma_f32_16x16x32_bf16 v[140:143], v[180:183], v[184:187], 0
  ds_read_b64_tr_b16 v[176:177], v226 offset:6144
  ds_read_b64_tr_b16 v[178:179], v226 offset:6912
  s_waitcnt lgkmcnt(12)
  v_mfma_f32_16x16x32_bf16 v[136:139], v[152:155], v[188:191], v[136:139]
  v_mfma_f32_16x16x32_bf16 v[144:147], v[152:155], v[200:203], 0
  ds_read_b64_tr_b16 v[180:181], v227 offset:6144
  ds_read_b64_tr_b16 v[182:183], v227 offset:6912
  s_waitcnt lgkmcnt(12)
  v_mfma_f32_16x16x32_bf16 v[140:143], v[156:159], v[188:191], v[140:143]
  v_mfma_f32_16x16x32_bf16 v[148:151], v[156:159], v[200:203], 0
  ds_read_b64_tr_b16 v[152:153], v220 offset:256
  ds_read_b64_tr_b16 v[154:155], v220 offset:1024
  s_waitcnt lgkmcnt(12)
  v_mfma_f32_16x16x32_bf16 v[136:139], v[160:163], v[192:195], v[136:139]
  v_cvt_pk_bf16_f32 v80, v120, v121
  v_mfma_f32_16x16x32_bf16 v[144:147], v[160:163], v[204:207], v[144:147]
  v_cvt_pk_bf16_f32 v81, v122, v123
  ds_read_b64_tr_b16 v[156:157], v221 offset:256
  ds_read_b64_tr_b16 v[158:159], v221 offset:1024
  s_waitcnt lgkmcnt(12)
  v_mfma_f32_16x16x32_bf16 v[140:143], v[164:167], v[192:195], v[140:143]
  v_cvt_pk_bf16_f32 v82, v124, v125
  v_mfma_f32_16x16x32_bf16 v[148:151], v[164:167], v[204:207], v[148:151]
  v_cvt_pk_bf16_f32 v83, v126, v127
  ds_read_b64_tr_b16 v[160:161], v220 offset:1792
  ds_read_b64_tr_b16 v[162:163], v220 offset:2560
  s_waitcnt lgkmcnt(12)
  v_mfma_f32_16x16x32_bf16 v[136:139], v[168:171], v[196:199], v[136:139]
  v_cvt_pk_bf16_f32 v104, v128, v129
  v_mfma_f32_16x16x32_bf16 v[144:147], v[168:171], v[208:211], v[144:147]
  v_cvt_pk_bf16_f32 v105, v130, v131
  ds_read_b64_tr_b16 v[164:165], v221 offset:1792
  ds_read_b64_tr_b16 v[166:167], v221 offset:2560
  s_waitcnt lgkmcnt(12)
  v_mfma_f32_16x16x32_bf16 v[140:143], v[172:175], v[196:199], v[140:143]
  v_cvt_pk_bf16_f32 v106, v132, v133
  v_mfma_f32_16x16x32_bf16 v[148:151], v[172:175], v[208:211], v[148:151]
  v_cvt_pk_bf16_f32 v107, v134, v135
  ds_read_b64_tr_b16 v[168:169], v220 offset:3328
  ds_read_b64_tr_b16 v[170:171], v220 offset:4096
  s_waitcnt lgkmcnt(12)
  v_mfma_f32_16x16x32_bf16 v[144:147], v[176:179], v[212:215], v[144:147]
  ds_read_b64_tr_b16 v[172:173], v221 offset:3328
  ds_read_b64_tr_b16 v[174:175], v221 offset:4096
  s_waitcnt lgkmcnt(12)
  v_mfma_f32_16x16x32_bf16 v[148:151], v[180:183], v[212:215], v[148:151]
  ds_read_b64_tr_b16 v[176:177], v220 offset:4864
  ds_read_b64_tr_b16 v[178:179], v220 offset:5632
  s_waitcnt lgkmcnt(12)
  v_mfma_f32_16x16x32_bf16 v[120:123], v[152:155], v[184:187], 0
  ds_read_b64_tr_b16 v[180:181], v221 offset:4864
  ds_read_b64_tr_b16 v[182:183], v221 offset:5632
  s_waitcnt lgkmcnt(12)
  v_mfma_f32_16x16x32_bf16 v[124:127], v[156:159], v[184:187], 0
  ds_read_b64_tr_b16 v[152:153], v220 offset:6400
  ds_read_b64_tr_b16 v[154:155], v220 offset:7168
  s_waitcnt lgkmcnt(12)
  v_mfma_f32_16x16x32_bf16 v[120:123], v[160:163], v[188:191], v[120:123]
  v_mfma_f32_16x16x32_bf16 v[128:131], v[160:163], v[200:203], 0
  ds_read_b64_tr_b16 v[156:157], v221 offset:6400
  ds_read_b64_tr_b16 v[158:159], v221 offset:7168
  s_waitcnt lgkmcnt(12)
  v_mfma_f32_16x16x32_bf16 v[124:127], v[164:167], v[188:191], v[124:127]
  v_mfma_f32_16x16x32_bf16 v[132:135], v[164:167], v[200:203], 0
  ds_read_b64_tr_b16 v[160:161], v222 offset:256
  ds_read_b64_tr_b16 v[162:163], v222 offset:1024
  s_waitcnt lgkmcnt(12)
  v_mfma_f32_16x16x32_bf16 v[120:123], v[168:171], v[192:195], v[120:123]
  v_cvt_pk_bf16_f32 v84, v136, v137
  v_mfma_f32_16x16x32_bf16 v[128:131], v[168:171], v[204:207], v[128:131]
  v_cvt_pk_bf16_f32 v85, v138, v139
  ds_read_b64_tr_b16 v[164:165], v223 offset:256
  ds_read_b64_tr_b16 v[166:167], v223 offset:1024
  s_waitcnt lgkmcnt(12)
  v_mfma_f32_16x16x32_bf16 v[124:127], v[172:175], v[192:195], v[124:127]
  v_cvt_pk_bf16_f32 v86, v140, v141
  v_mfma_f32_16x16x32_bf16 v[132:135], v[172:175], v[204:207], v[132:135]
  v_cvt_pk_bf16_f32 v87, v142, v143
  ds_read_b64_tr_b16 v[168:169], v222 offset:1792
  ds_read_b64_tr_b16 v[170:171], v222 offset:2560
  s_waitcnt lgkmcnt(12)
  v_mfma_f32_16x16x32_bf16 v[120:123], v[176:179], v[196:199], v[120:123]
  v_cvt_pk_bf16_f32 v108, v144, v145
  v_mfma_f32_16x16x32_bf16 v[128:131], v[176:179], v[208:211], v[128:131]
  v_cvt_pk_bf16_f32 v109, v146, v147
  ds_read_b64_tr_b16 v[172:173], v223 offset:1792
  ds_read_b64_tr_b16 v[174:175], v223 offset:2560
  s_waitcnt lgkmcnt(12)
  v_mfma_f32_16x16x32_bf16 v[124:127], v[180:183], v[196:199], v[124:127]
  v_cvt_pk_bf16_f32 v110, v148, v149
  v_mfma_f32_16x16x32_bf16 v[132:135], v[180:183], v[208:211], v[132:135]
  v_cvt_pk_bf16_f32 v111, v150, v151
  ds_read_b64_tr_b16 v[176:177], v222 offset:3328
  ds_read_b64_tr_b16 v[178:179], v222 offset:4096
  s_waitcnt lgkmcnt(12)
  v_mfma_f32_16x16x32_bf16 v[128:131], v[152:155], v[212:215], v[128:131]
  ds_read_b64_tr_b16 v[180:181], v223 offset:3328
  ds_read_b64_tr_b16 v[182:183], v223 offset:4096
  s_waitcnt lgkmcnt(12)
  v_mfma_f32_16x16x32_bf16 v[132:135], v[156:159], v[212:215], v[132:135]
  ds_read_b64_tr_b16 v[152:153], v222 offset:4864
  ds_read_b64_tr_b16 v[154:155], v222 offset:5632
  s_waitcnt lgkmcnt(12)
  v_mfma_f32_16x16x32_bf16 v[136:139], v[160:163], v[184:187], 0
  ds_read_b64_tr_b16 v[156:157], v223 offset:4864
  ds_read_b64_tr_b16 v[158:159], v223 offset:5632
  s_waitcnt lgkmcnt(12)
  v_mfma_f32_16x16x32_bf16 v[140:143], v[164:167], v[184:187], 0
  ds_read_b64_tr_b16 v[160:161], v222 offset:6400
  ds_read_b64_tr_b16 v[162:163], v222 offset:7168
  s_waitcnt lgkmcnt(12)
  v_mfma_f32_16x16x32_bf16 v[136:139], v[168:171], v[188:191], v[136:139]
  v_mfma_f32_16x16x32_bf16 v[144:147], v[168:171], v[200:203], 0
  ds_read_b64_tr_b16 v[164:165], v223 offset:6400
  ds_read_b64_tr_b16 v[166:167], v223 offset:7168
  s_waitcnt lgkmcnt(12)
  v_mfma_f32_16x16x32_bf16 v[140:143], v[172:175], v[188:191], v[140:143]
  v_mfma_f32_16x16x32_bf16 v[148:151], v[172:175], v[200:203], 0
  s_waitcnt lgkmcnt(10)
  v_mfma_f32_16x16x32_bf16 v[136:139], v[176:179], v[192:195], v[136:139]
  v_cvt_pk_bf16_f32 v88, v120, v121
  v_mfma_f32_16x16x32_bf16 v[144:147], v[176:179], v[204:207], v[144:147]
  v_cvt_pk_bf16_f32 v89, v122, v123
  s_waitcnt lgkmcnt(8)
  v_mfma_f32_16x16x32_bf16 v[140:143], v[180:183], v[192:195], v[140:143]
  v_cvt_pk_bf16_f32 v90, v124, v125
  v_mfma_f32_16x16x32_bf16 v[148:151], v[180:183], v[204:207], v[148:151]
  v_cvt_pk_bf16_f32 v91, v126, v127
  s_waitcnt lgkmcnt(6)
  v_mfma_f32_16x16x32_bf16 v[136:139], v[152:155], v[196:199], v[136:139]
  v_cvt_pk_bf16_f32 v112, v128, v129
  v_mfma_f32_16x16x32_bf16 v[144:147], v[152:155], v[208:211], v[144:147]
  v_cvt_pk_bf16_f32 v113, v130, v131
  s_waitcnt lgkmcnt(4)
  v_mfma_f32_16x16x32_bf16 v[140:143], v[156:159], v[196:199], v[140:143]
  v_cvt_pk_bf16_f32 v114, v132, v133
  v_mfma_f32_16x16x32_bf16 v[148:151], v[156:159], v[208:211], v[148:151]
  v_cvt_pk_bf16_f32 v115, v134, v135
  s_waitcnt lgkmcnt(2)
  v_mfma_f32_16x16x32_bf16 v[144:147], v[160:163], v[212:215], v[144:147]
  s_waitcnt lgkmcnt(0)
  v_mfma_f32_16x16x32_bf16 v[148:151], v[164:167], v[212:215], v[148:151]
  s_cmp_ge_u32 s20, 4
  s_cbranch_scc1 M_l2
  s_barrier
  s_setprio 0
M_l2:
  v_cvt_pk_bf16_f32 v92, v136, v137
  v_cvt_pk_bf16_f32 v93, v138, v139
  v_cvt_pk_bf16_f32 v94, v140, v141
  v_cvt_pk_bf16_f32 v95, v142, v143
  v_cvt_pk_bf16_f32 v116, v144, v145
  v_cvt_pk_bf16_f32 v117, v146, v147
  v_cvt_pk_bf16_f32 v118, v148, v149
  v_cvt_pk_bf16_f32 v119, v150, v151
  v_and_b32 v4, 7, v3
  v_cmp_eq_u32 vcc, 7, v4
  v_mov_b32 v5, 0x7ff00000
  s_nop 0
  v_cndmask_b32 v228, v228, v5, vcc
  v_cndmask_b32 v229, v229, v5, vcc
  s_barrier
  ds_read_b128 v[152:155], v230 offset:0
  ds_read_b128 v[156:159], v230 offset:1024
  ds_read_b128 v[160:163], v230 offset:2048
  ds_read_b128 v[164:167], v230 offset:3072
  ds_read_b128 v[168:171], v230 offset:4096
  ds_read_b128 v[172:175], v230 offset:5120
  ds_read_b128 v[176:179], v230 offset:6144
  s_waitcnt lgkmcnt(6)
  v_mfma_f32_16x16x32_bf16 v[120:123], v[152:155], v[72:75], 0
  v_mfma_f32_16x16x32_bf16 v[128:131], v[152:155], v[96:99], 0
  ds_read_b128 v[180:183], v230 offset:7168
  s_waitcnt lgkmcnt(6)
  v_mfma_f32_16x16x32_bf16 v[124:127], v[156:159], v[72:75], 0
  v_mfma_f32_16x16x32_bf16 v[132:135], v[156:159], v[96:99], 0
  ds_read_b128 v[152:155], v230 offset:8192
  s_waitcnt lgkmcnt(6)
  v_mfma_f32_16x16x32_bf16 v[120:123], v[160:163], v[76:79], v[120:123]
  v_mfma_f32_16x16x32_bf16 v[128:131], v[160:163], v[100:103], v[128:131]
  ds_read_b128 v[156:159], v230 offset:9216
  s_waitcnt lgkmcnt(6)
  v_mfma_f32_16x16x32_bf16 v[124:127], v[164:167], v[76:79], v[124:127]
  v_mfma_f32_16x16x32_bf16 v[132:135], v[164:167], v[100:103], v[132:135]
  ds_read_b128 v[160:163], v230 offset:10240
  s_waitcnt lgkmcnt(6)
  v_mfma_f32_16x16x32_bf16 v[120:123], v[168:171], v[80:83], v[120:123]
  v_mfma_f32_16x16x32_bf16 v[128:131], v[168:171], v[104:107], v[128:131]
  ds_read_b128 v[164:167], v230 offset:11264
  s_waitcnt lgkmcnt(6)
  v_mfma_f32_16x16x32_bf16 v[124:127], v[172:175], v[80:83], v[124:127]
  v_mfma_f32_16x16x32_bf16 v[132:135], v[172:175], v[104:107], v[132:135]
  ds_read_b128 v[168:171], v230 offset:12288
  s_waitcnt lgkmcnt(6)
  v_mfma_f32_16x16x32_bf16 v[120:123], v[176:179], v[84:87], v[120:123]
  v_mfma_f32_16x16x32_bf16 v[128:131], v[176:179], v[108:111], v[128:131]
  ds_read_b128 v[172:175], v230 offset:13312
  s_waitcnt lgkmcnt(6)
  v_mfma_f32_16x16x32_bf16 v[124:127], v[180:183], v[84:87], v[124:127]
  v_mfma_f32_16x16x32_bf16 v[132:135], v[180:183], v[108:111], v[132:135]
  ds_read_b128 v[176:179], v230 offset:14336
  s_waitcnt lgkmcnt(6)
  v_mfma_f32_16x16x32_bf16 v[120:123], v[152:155], v[88:91], v[120:123]
  v_mfma_f32_16x16x32_bf16 v[128:131], v[152:155], v[112:115], v[128:131]
  ds_read_b128 v[180:183], v230 offset:15360
  s_waitcnt lgkmcnt(6)
  v_mfma_f32_16x16x32_bf16 v[124:127], v[156:159], v[88:91], v[124:127]
  v_mfma_f32_16x16x32_bf16 v[132:135], v[156:159], v[112:115], v[132:135]
  ds_read_b128 v[152:155], v230 offset:16384
  s_waitcnt lgkmcnt(6)
  v_mfma_f32_16x16x32_bf16 v[120:123], v[160:163], v[92:95], v[120:123]
  v_mfma_f32_16x16x32_bf16 v[128:131], v[160:163], v[116:119], v[128:131]
  ds_read_b128 v[156:159], v230 offset:17408
  s_waitcnt lgkmcnt(6)
  v_mfma_f32_16x16x32_bf16 v[124:127], v[164:167], v[92:95], v[124:127]
  v_mfma_f32_16x16x32_bf16 v[132:135], v[164:167], v[116:119], v[132:135]
  ds_read_b128 v[160:163], v230 offset:18432
  s_waitcnt lgkmcnt(6)
  v_mfma_f32_16x16x32_bf16 v[136:139], v[168:171], v[72:75], 0
  v_mfma_f32_16x16x32_bf16 v[144:147], v[168:171], v[96:99], 0
  ds_read_b128 v[164:167], v230 offset:19456
  s_waitcnt lgkmcnt(6)
  v_mfma_f32_16x16x32_bf16 v[140:143], v[172:175], v[72:75], 0
  v_mfma_f32_16x16x32_bf16 v[148:151], v[172:175], v[96:99], 0
  ds_read_b128 v[168:171], v230 offset:20480
  s_waitcnt lgkmcnt(6)
  v_mfma_f32_16x16x32_bf16 v[136:139], v[176:179], v[76:79], v[136:139]
  v_mfma_f32_16x16x32_bf16 v[144:147], v[176:179], v[100:103], v[144:147]
  ds_read_b128 v[172:175], v230 offset:21504
  s_waitcnt lgkmcnt(6)
  v_mfma_f32_16x16x32_bf16 v[140:143], v[180:183], v[76:79], v[140:143]
  v_mul_f32 v120, v120, v244
  v_mul_f32 v121, v121, v244
  v_mfma_f32_16x16x32_bf16 v[148:151], v[180:183], v[100:103], v[148:151]
  v_mul_f32 v122, v122, v244
  v_mul_f32 v123, v123, v244
  ds_read_b128 v[176:179], v230 offset:22528
  s_waitcnt lgkmcnt(6)
  v_mfma_f32_16x16x32_bf16 v[136:139], v[152:155], v[80:83], v[136:139]
  v_mul_f32 v124, v124, v244
  v_mul_f32 v125, v125, v244
  v_mfma_f32_16x16x32_bf16 v[144:147], v[152:155], v[104:107], v[144:147]
  v_mul_f32 v126, v126, v244
  v_mul_f32 v127, v127, v244
  ds_read_b128 v[180:183], v230 offset:23552
  s_waitcnt lgkmcnt(6)
  v_mfma_f32_16x16x32_bf16 v[140:143], v[156:159], v[80:83], v[140:143]
  v_cvt_pk_bf16_f32 v248, v120, v121
  v_cvt_pk_bf16_f32 v249, v122, v123
  v_mfma_f32_16x16x32_bf16 v[148:151], v[156:159], v[104:107], v[148:151]
  v_cvt_pk_bf16_f32 v250, v124, v125
  v_cvt_pk_bf16_f32 v251, v126, v127
  ds_read_b128 v[152:155], v230 offset:24576
  s_waitcnt lgkmcnt(6)
  v_mfma_f32_16x16x32_bf16 v[136:139], v[160:163], v[84:87], v[136:139]
  buffer_store_dwordx4 v[248:251], v228, s[12:15], 0 offen offset:0
  v_mul_f32 v128, v128, v245
  v_mfma_f32_16x16x32_bf16 v[144:147], v[160:163], v[108:111], v[144:147]
  v_mul_f32 v129, v129, v245
  v_mul_f32 v130, v130, v245
  ds_read_b128 v[156:159], v230 offset:25600
  s_waitcnt lgkmcnt(6)
  v_mfma_f32_16x16x32_bf16 v[140:143], v[164:167], v[84:87], v[140:143]
  v_mul_f32 v131, v131, v245
  v_mul_f32 v132, v132, v245
  v_mfma_f32_16x16x32_bf16 v[148:151], v[164:167], v[108:111], v[148:151]
  v_mul_f32 v133, v133, v245
  v_mul_f32 v134, v134, v245
  ds_read_b128 v[160:163], v230 offset:26624
  s_waitcnt lgkmcnt(6)
  v_mfma_f32_16x16x32_bf16 v[136:139], v[168:171], v[88:91], v[136:139]
  v_mul_f32 v135, v135, v245
  v_cvt_pk_bf16_f32 v252, v128, v129
  v_mfma_f32_16x16x32_bf16 v[144:147], v[168:171], v[112:115], v[144:147]
  v_cvt_pk_bf16_f32 v253, v130, v131
  v_cvt_pk_bf16_f32 v254, v132, v133
  ds_read_b128 v[164:167], v230 offset:27648
  s_waitcnt lgkmcnt(6)
  v_mfma_f32_16x16x32_bf16 v[140:143], v[172:175], v[88:91], v[140:143]
  v_cvt_pk_bf16_f32 v255, v134, v135
  buffer_store_dwordx4 v[252:255], v229, s[12:15], 0 offen offset:0
  v_mfma_f32_16x16x32_bf16 v[148:151], v[172:175], v[112:115], v[148:151]
  ds_read_b128 v[168:171], v230 offset:28672
  s_waitcnt lgkmcnt(6)
  v_mfma_f32_16x16x32_bf16 v[136:139], v[176:179], v[92:95], v[136:139]
  v_mfma_f32_16x16x32_bf16 v[144:147], v[176:179], v[116:119], v[144:147]
  ds_read_b128 v[172:175], v230 offset:29696
  s_waitcnt lgkmcnt(6)
  v_mfma_f32_16x16x32_bf16 v[140:143], v[180:183], v[92:95], v[140:143]
  v_mfma_f32_16x16x32_bf16 v[148:151], v[180:183], v[116:119], v[148:151]
  ds_read_b128 v[176:179], v230 offset:30720
  s_waitcnt lgkmcnt(6)
  v_mfma_f32_16x16x32_bf16 v[120:123], v[152:155], v[72:75], 0
  v_mfma_f32_16x16x32_bf16 v[128:131], v[152:155], v[96:99], 0
  ds_read_b128 v[180:183], v230 offset:31744
  s_waitcnt lgkmcnt(6)
  v_mfma_f32_16x16x32_bf16 v[124:127], v[156:159], v[72:75], 0
  v_mfma_f32_16x16x32_bf16 v[132:135], v[156:159], v[96:99], 0
  ds_read_b128 v[152:155], v230 offset:32768
  s_waitcnt lgkmcnt(6)
  v_mfma_f32_16x16x32_bf16 v[120:123], v[160:163], v[76:79], v[120:123]
  v_mfma_f32_16x16x32_bf16 v[128:131], v[160:163], v[100:103], v[128:131]
  ds_read_b128 v[156:159], v230 offset:33792
  s_waitcnt lgkmcnt(6)
  v_mfma_f32_16x16x32_bf16 v[124:127], v[164:167], v[76:79], v[124:127]
  v_mul_f32 v136, v136, v244
  v_mul_f32 v137, v137, v244
  v_mfma_f32_16x16x32_bf16 v[132:135], v[164:167], v[100:103], v[132:135]
  v_mul_f32 v138, v138, v244
  v_mul_f32 v139, v139, v244
  ds_read_b128 v[160:163], v230 offset:34816
  s_waitcnt lgkmcnt(6)
  v_mfma_f32_16x16x32_bf16 v[120:123], v[168:171], v[80:83], v[120:123]
  v_mul_f32 v140, v140, v244
  v_mul_f32 v141, v141, v244
  v_mfma_f32_16x16x32_bf16 v[128:131], v[168:171], v[104:107], v[128:131]
  v_mul_f32 v142, v142, v244
  v_mul_f32 v143, v143, v244
  ds_read_b128 v[164:167], v230 offset:35840
  s_waitcnt lgkmcnt(6)
  v_mfma_f32_16x16x32_bf16 v[124:127], v[172:175], v[80:83], v[124:127]
  v_cvt_pk_bf16_f32 v248, v136, v137
  v_cvt_pk_bf16_f32 v249, v138, v139
  v_mfma_f32_16x16x32_bf16 v[132:135], v[172:175], v[104:107], v[132:135]
  v_cvt_pk_bf16_f32 v250, v140, v141
  v_cvt_pk_bf16_f32 v251, v142, v143
  ds_read_b128 v[168:171], v230 offset:36864
  s_waitcnt lgkmcnt(6)
  v_mfma_f32_16x16x32_bf16 v[120:123], v[176:179], v[84:87], v[120:123]
  buffer_store_dwordx4 v[248:251], v228, s[12:15], 0 offen offset:64
  v_mul_f32 v144, v144, v245
  v_mfma_f32_16x16x32_bf16 v[128:131], v[176:179], v[108:111], v[128:131]
  v_mul_f32 v145, v145, v245
  v_mul_f32 v146, v146, v245
  ds_read_b128 v[172:175], v230 offset:37888
  s_waitcnt lgkmcnt(6)
  v_mfma_f32_16x16x32_bf16 v[124:127], v[180:183], v[84:87], v[124:127]
  v_mul_f32 v147, v147, v245
  v_mul_f32 v148, v148, v245
  v_mfma_f32_16x16x32_bf16 v[132:135], v[180:183], v[108:111], v[132:135]
  v_mul_f32 v149, v149, v245
  v_mul_f32 v150, v150, v245
  ds_read_b128 v[176:179], v230 offset:38912
  s_waitcnt lgkmcnt(6)
  v_mfma_f32_16x16x32_bf16 v[120:123], v[152:155], v[88:91], v[120:123]
  v_mul_f32 v151, v151, v245
  v_cvt_pk_bf16_f32 v252, v144, v145
  v_mfma_f32_16x16x32_bf16 v[128:131], v[152:155], v[112:115], v[128:131]
  v_cvt_pk_bf16_f32 v253, v146, v147
  v_cvt_pk_bf16_f32 v254, v148, v149
  ds_read_b128 v[180:183], v230 offset:39936
  s_waitcnt lgkmcnt(6)
  v_mfma_f32_16x16x32_bf16 v[124:127], v[156:159], v[88:91], v[124:127]
  v_cvt_pk_bf16_f32 v255, v150, v151
  buffer_store_dwordx4 v[252:255], v229, s[12:15], 0 offen offset:64
  v_mfma_f32_16x16x32_bf16 v[132:135], v[156:159], v[112:115], v[132:135]
  ds_read_b128 v[152:155], v230 offset:40960
  s_waitcnt lgkmcnt(6)
  v_mfma_f32_16x16x32_bf16 v[120:123], v[160:163], v[92:95], v[120:123]
  v_mfma_f32_16x16x32_bf16 v[128:131], v[160:163], v[116:119], v[128:131]
  ds_read_b128 v[156:159], v230 offset:41984
  s_waitcnt lgkmcnt(6)
  v_mfma_f32_16x16x32_bf16 v[124:127], v[164:167], v[92:95], v[124:127]
  v_mfma_f32_16x16x32_bf16 v[132:135], v[164:167], v[116:119], v[132:135]
  ds_read_b128 v[160:163], v230 offset:43008
  s_waitcnt lgkmcnt(6)
  v_mfma_f32_16x16x32_bf16 v[136:139], v[168:171], v[72:75], 0
  v_mfma_f32_16x16x32_bf16 v[144:147], v[168:171], v[96:99], 0
  ds_read_b128 v[164:167], v230 offset:44032
  s_waitcnt lgkmcnt(6)
  v_mfma_f32_16x16x32_bf16 v[140:143], v[172:175], v[72:75], 0
  v_mfma_f32_16x16x32_bf16 v[148:151], v[172:175], v[96:99], 0
  ds_read_b128 v[168:171], v230 offset:45056
  s_waitcnt lgkmcnt(6)
  v_mfma_f32_16x16x32_bf16 v[136:139], v[176:179], v[76:79], v[136:139]
  v_mfma_f32_16x16x32_bf16 v[144:147], v[176:179], v[100:103], v[144:147]
  ds_read_b128 v[172:175], v230 offset:46080
  s_waitcnt lgkmcnt(6)
  v_mfma_f32_16x16x32_bf16 v[140:143], v[180:183], v[76:79], v[140:143]
  v_mul_f32 v120, v120, v244
  v_mul_f32 v121, v121, v244
  v_mfma_f32_16x16x32_bf16 v[148:151], v[180:183], v[100:103], v[148:151]
  v_mul_f32 v122, v122, v244
  v_mul_f32 v123, v123, v244
  ds_read_b128 v[176:179], v230 offset:47104
  s_waitcnt lgkmcnt(6)
  v_mfma_f32_16x16x32_bf16 v[136:139], v[152:155], v[80:83], v[136:139]
  v_mul_f32 v124, v124, v244
  v_mul_f32 v125, v125, v244
  v_mfma_f32_16x16x32_bf16 v[144:147], v[152:155], v[104:107], v[144:147]
  v_mul_f32 v126, v126, v244
  v_mul_f32 v127, v127, v244
  ds_read_b128 v[180:183], v230 offset:48128
  s_waitcnt lgkmcnt(6)
  v_mfma_f32_16x16x32_bf16 v[140:143], v[156:159], v[80:83], v[140:143]
  v_cvt_pk_bf16_f32 v248, v120, v121
  v_cvt_pk_bf16_f32 v249, v122, v123
  v_mfma_f32_16x16x32_bf16 v[148:151], v[156:159], v[104:107], v[148:151]
  v_cvt_pk_bf16_f32 v250, v124, v125
  v_cvt_pk_bf16_f32 v251, v126, v127
  ds_read_b128 v[152:155], v230 offset:49152
  s_waitcnt lgkmcnt(6)
  v_mfma_f32_16x16x32_bf16 v[136:139], v[160:163], v[84:87], v[136:139]
  buffer_store_dwordx4 v[248:251], v228, s[12:15], 0 offen offset:128
  v_mul_f32 v128, v128, v245
  v_mfma_f32_16x16x32_bf16 v[144:147], v[160:163], v[108:111], v[144:147]
  v_mul_f32 v129, v129, v245
  v_mul_f32 v130, v130, v245
  ds_read_b128 v[156:159], v230 offset:50176
  s_waitcnt lgkmcnt(6)
  v_mfma_f32_16x16x32_bf16 v[140:143], v[164:167], v[84:87], v[140:143]
  v_mul_f32 v131, v131, v245
  v_mul_f32 v132, v132, v245
  v_mfma_f32_16x16x32_bf16 v[148:151], v[164:167], v[108:111], v[148:151]
  v_mul_f32 v133, v133, v245
  v_mul_f32 v134, v134, v245
  ds_read_b128 v[160:163], v230 offset:51200
  s_waitcnt lgkmcnt(6)
  v_mfma_f32_16x16x32_bf16 v[136:139], v[168:171], v[88:91], v[136:139]
  v_mul_f32 v135, v135, v245
  v_cvt_pk_bf16_f32 v252, v128, v129
  v_mfma_f32_16x16x32_bf16 v[144:147], v[168:171], v[112:115], v[144:147]
  v_cvt_pk_bf16_f32 v253, v130, v131
  v_cvt_pk_bf16_f32 v254, v132, v133
  ds_read_b128 v[164:167], v230 offset:52224
  s_waitcnt lgkmcnt(6)
  v_mfma_f32_16x16x32_bf16 v[140:143], v[172:175], v[88:91], v[140:143]
  v_cvt_pk_bf16_f32 v255, v134, v135
  buffer_store_dwordx4 v[252:255], v229, s[12:15], 0 offen offset:128
  v_mfma_f32_16x16x32_bf16 v[148:151], v[172:175], v[112:115], v[148:151]
  ds_read_b128 v[168:171], v230 offset:53248
  s_waitcnt lgkmcnt(6)
  v_mfma_f32_16x16x32_bf16 v[136:139], v[176:179], v[92:95], v[136:139]
  v_mfma_f32_16x16x32_bf16 v[144:147], v[176:179], v[116:119], v[144:147]
  ds_read_b128 v[172:175], v230 offset:54272
  s_waitcnt lgkmcnt(6)
  v_mfma_f32_16x16x32_bf16 v[140:143], v[180:183], v[92:95], v[140:143]
  v_mfma_f32_16x16x32_bf16 v[148:151], v[180:183], v[116:119], v[148:151]
  ds_read_b128 v[176:179], v230 offset:55296
  s_waitcnt lgkmcnt(6)
  v_mfma_f32_16x16x32_bf16 v[120:123], v[152:155], v[72:75], 0
  v_mfma_f32_16x16x32_bf16 v[128:131], v[152:155], v[96:99], 0
  ds_read_b128 v[180:183], v230 offset:56320
  s_waitcnt lgkmcnt(6)
  v_mfma_f32_16x16x32_bf16 v[124:127], v[156:159], v[72:75], 0
  v_mfma_f32_16x16x32_bf16 v[132:135], v[156:159], v[96:99], 0
  ds_read_b128 v[152:155], v230 offset:57344
  s_waitcnt lgkmcnt(6)
  v_mfma_f32_16x16x32_bf16 v[120:123], v[160:163], v[76:79], v[120:123]
  v_mfma_f32_16x16x32_bf16 v[128:131], v[160:163], v[100:103], v[128:131]
  ds_read_b128 v[156:159], v230 offset:58368
  s_waitcnt lgkmcnt(6)
  v_mfma_f32_16x16x32_bf16 v[124:127], v[164:167], v[76:79], v[124:127]
  v_mul_f32 v136, v136, v244
  v_mul_f32 v137, v137, v244
  v_mfma_f32_16x16x32_bf16 v[132:135], v[164:167], v[100:103], v[132:135]
  v_mul_f32 v138, v138, v244
  v_mul_f32 v139, v139, v244
  ds_read_b128 v[160:163], v230 offset:59392
  s_waitcnt lgkmcnt(6)
  v_mfma_f32_16x16x32_bf16 v[120:123], v[168:171], v[80:83], v[120:123]
  v_mul_f32 v140, v140, v244
  v_mul_f32 v141, v141, v244
  v_mfma_f32_16x16x32_bf16 v[128:131], v[168:171], v[104:107], v[128:131]
  v_mul_f32 v142, v142, v244
  v_mul_f32 v143, v143, v244
  ds_read_b128 v[164:167], v230 offset:60416
  s_waitcnt lgkmcnt(6)
  v_mfma_f32_16x16x32_bf16 v[124:127], v[172:175], v[80:83], v[124:127]
  v_cvt_pk_bf16_f32 v248, v136, v137
  v_cvt_pk_bf16_f32 v249, v138, v139
  v_mfma_f32_16x16x32_bf16 v[132:135], v[172:175], v[104:107], v[132:135]
  v_cvt_pk_bf16_f32 v250, v140, v141
  v_cvt_pk_bf16_f32 v251, v142, v143
  ds_read_b128 v[168:171], v231 offset:0
  s_waitcnt lgkmcnt(6)
  v_mfma_f32_16x16x32_bf16 v[120:123], v[176:179], v[84:87], v[120:123]
  buffer_store_dwordx4 v[248:251], v228, s[12:15], 0 offen offset:192
  v_mul_f32 v144, v144, v245
  v_mfma_f32_16x16x32_bf16 v[128:131], v[176:179], v[108:111], v[128:131]
  v_mul_f32 v145, v145, v245
  v_mul_f32 v146, v146, v245
  ds_read_b128 v[172:175], v231 offset:1024
  s_waitcnt lgkmcnt(6)
  v_mfma_f32_16x16x32_bf16 v[124:127], v[180:183], v[84:87], v[124:127]
  v_mul_f32 v147, v147, v245
  v_mul_f32 v148, v148, v245
  v_mfma_f32_16x16x32_bf16 v[132:135], v[180:183], v[108:111], v[132:135]
  v_mul_f32 v149, v149, v245
  v_mul_f32 v150, v150, v245
  ds_read_b128 v[176:179], v231 offset:2048
  s_waitcnt lgkmcnt(6)
  v_mfma_f32_16x16x32_bf16 v[120:123], v[152:155], v[88:91], v[120:123]
  v_mul_f32 v151, v151, v245
  v_cvt_pk_bf16_f32 v252, v144, v145
  v_mfma_f32_16x16x32_bf16 v[128:131], v[152:155], v[112:115], v[128:131]
  v_cvt_pk_bf16_f32 v253, v146, v147
  v_cvt_pk_bf16_f32 v254, v148, v149
  ds_read_b128 v[180:183], v231 offset:3072
  s_waitcnt lgkmcnt(6)
  v_mfma_f32_16x16x32_bf16 v[124:127], v[156:159], v[88:91], v[124:127]
  v_cvt_pk_bf16_f32 v255, v150, v151
  buffer_store_dwordx4 v[252:255], v229, s[12:15], 0 offen offset:192
  v_mfma_f32_16x16x32_bf16 v[132:135], v[156:159], v[112:115], v[132:135]
  ds_read_b128 v[152:155], v231 offset:4096
  s_waitcnt lgkmcnt(6)
  v_mfma_f32_16x16x32_bf16 v[120:123], v[160:163], v[92:95], v[120:123]
  v_mfma_f32_16x16x32_bf16 v[128:131], v[160:163], v[116:119], v[128:131]
  ds_read_b128 v[156:159], v231 offset:5120
  s_waitcnt lgkmcnt(6)
  v_mfma_f32_16x16x32_bf16 v[124:127], v[164:167], v[92:95], v[124:127]
  v_mfma_f32_16x16x32_bf16 v[132:135], v[164:167], v[116:119], v[132:135]
  ds_read_b128 v[160:163], v231 offset:6144
  s_waitcnt lgkmcnt(6)
  v_mfma_f32_16x16x32_bf16 v[136:139], v[168:171], v[72:75], 0
  v_mfma_f32_16x16x32_bf16 v[144:147], v[168:171], v[96:99], 0
  ds_read_b128 v[164:167], v231 offset:7168
  s_waitcnt lgkmcnt(6)
  v_mfma_f32_16x16x32_bf16 v[140:143], v[172:175], v[72:75], 0
  v_mfma_f32_16x16x32_bf16 v[148:151], v[172:175], v[96:99], 0
  ds_read_b128 v[168:171], v231 offset:8192
  s_waitcnt lgkmcnt(6)
  v_mfma_f32_16x16x32_bf16 v[136:139], v[176:179], v[76:79], v[136:139]
  v_mfma_f32_16x16x32_bf16 v[144:147], v[176:179], v[100:103], v[144:147]
  ds_read_b128 v[172:175], v231 offset:9216
  s_waitcnt lgkmcnt(6)
  v_mfma_f32_16x16x32_bf16 v[140:143], v[180:183], v[76:79], v[140:143]
  v_mul_f32 v120, v120, v244
  v_mul_f32 v121, v121, v244
  v_mfma_f32_16x16x32_bf16 v[148:151], v[180:183], v[100:103], v[148:151]
  v_mul_f32 v122, v122, v244
  v_mul_f32 v123, v123, v244
  s_waitcnt lgkmcnt(5)
  v_mfma_f32_16x16x32_bf16 v[136:139], v[152:155], v[80:83], v[136:139]
  v_mul_f32 v124, v124, v244
  v_mul_f32 v125, v125, v244
  v_mfma_f32_16x16x32_bf16 v[144:147], v[152:155], v[104:107], v[144:147]
  v_mul_f32 v126, v126, v244
  v_mul_f32 v127, v127, v244
  s_waitcnt lgkmcnt(4)
  v_mfma_f32_16x16x32_bf16 v[140:143], v[156:159], v[80:83], v[140:143]
  v_cvt_pk_bf16_f32 v248, v120, v121
  v_cvt_pk_bf16_f32 v249, v122, v123
  v_mfma_f32_16x16x32_bf16 v[148:151], v[156:159], v[104:107], v[148:151]
  v_cvt_pk_bf16_f32 v250, v124, v125
  v_cvt_pk_bf16_f32 v251, v126, v127
  s_waitcnt lgkmcnt(3)
  v_mfma_f32_16x16x32_bf16 v[136:139], v[160:163], v[84:87], v[136:139]
  buffer_store_dwordx4 v[248:251], v228, s[12:15], 0 offen offset:256
  v_mul_f32 v128, v128, v245
  v_mfma_f32_16x16x32_bf16 v[144:147], v[160:163], v[108:111], v[144:147]
  v_mul_f32 v129, v129, v245
  v_mul_f32 v130, v130, v245
  s_waitcnt lgkmcnt(2)
  v_mfma_f32_16x16x32_bf16 v[140:143], v[164:167], v[84:87], v[140:143]
  v_mul_f32 v131, v131, v245
  v_mul_f32 v132, v132, v245
  v_mfma_f32_16x16x32_bf16 v[148:151], v[164:167], v[108:111], v[148:151]
  v_mul_f32 v133, v133, v245
  v_mul_f32 v134, v134, v245
  s_waitcnt lgkmcnt(1)
  v_mfma_f32_16x16x32_bf16 v[136:139], v[168:171], v[88:91], v[136:139]
  v_mul_f32 v135, v135, v245
  v_cvt_pk_bf16_f32 v252, v128, v129
  v_mfma_f32_16x16x32_bf16 v[144:147], v[168:171], v[112:115], v[144:147]
  v_cvt_pk_bf16_f32 v253, v130, v131
  v_cvt_pk_bf16_f32 v254, v132, v133
  s_waitcnt lgkmcnt(0)
  v_mfma_f32_16x16x32_bf16 v[140:143], v[172:175], v[88:91], v[140:143]
  v_cvt_pk_bf16_f32 v255, v134, v135
  buffer_store_dwordx4 v[252:255], v229, s[12:15], 0 offen offset:256
  v_mfma_f32_16x16x32_bf16 v[148:151], v[172:175], v[112:115], v[148:151]
  s_waitcnt vmcnt(11)
  v_mfma_f32_16x16x32_bf16 v[136:139], v[232:235], v[92:95], v[136:139]
  v_mfma_f32_16x16x32_bf16 v[144:147], v[232:235], v[116:119], v[144:147]
  s_waitcnt vmcnt(10)
  v_mfma_f32_16x16x32_bf16 v[140:143], v[236:239], v[92:95], v[140:143]
  v_mfma_f32_16x16x32_bf16 v[148:151], v[236:239], v[116:119], v[148:151]
  s_nop 3
  v_mul_f32 v136, v136, v244
  v_mul_f32 v137, v137, v244
  v_mul_f32 v138, v138, v244
  v_mul_f32 v139, v139, v244
  v_mul_f32 v140, v140, v244
  v_mul_f32 v141, v141, v244
  v_mul_f32 v142, v142, v244
  v_mul_f32 v143, v143, v244
  v_cvt_pk_bf16_f32 v248, v136, v137
  v_cvt_pk_bf16_f32 v249, v138, v139
  v_cvt_pk_bf16_f32 v250, v140, v141
  v_cvt_pk_bf16_f32 v251, v142, v143
  buffer_store_dwordx4 v[248:251], v228, s[12:15], 0 offen offset:320
  v_mul_f32 v144, v144, v245
  v_mul_f32 v145, v145, v245
  v_mul_f32 v146, v146, v245
  v_mul_f32 v147, v147, v245
  v_mul_f32 v148, v148, v245
  v_mul_f32 v149, v149, v245
  v_mul_f32 v150, v150, v245
  v_mul_f32 v151, v151, v245
  v_cvt_pk_bf16_f32 v252, v144, v145
  v_cvt_pk_bf16_f32 v253, v146, v147
  v_cvt_pk_bf16_f32 v254, v148, v149
  v_cvt_pk_bf16_f32 v255, v150, v151
  buffer_store_dwordx4 v[252:255], v229, s[12:15], 0 offen offset:320
  s_endpgm
M_helper:
  s_waitcnt vmcnt(12)
  s_barrier
  v_add_u32 v4, 0, v1
  v_xor_b32 v4, 4, v4
  v_mul_u32_u24 v5, 2731, v4
  v_lshrrev_b32 v5, 16, v5
  v_mul_u32_u24 v5, 384, v5
  v_lshl_add_u32 v4, v4, 4, v5
  v_add_u32 v16, s26, v4
  v_add_u32 v20, 7680, v16
  v_max_i32 v16, 0, v16
  v_add_u32 v4, 60, v1
  v_xor_b32 v4, 4, v4
  v_mul_u32_u24 v5, 2731, v4
  v_lshrrev_b32 v5, 16, v5
  v_mul_u32_u24 v5, 384, v5
  v_lshl_add_u32 v4, v4, 4, v5
  v_add_u32 v17, s26, v4
  v_add_u32 v21, 7680, v17
  v_max_i32 v17, 0, v17
  v_add_u32 v4, 120, v1
  v_xor_b32 v4, 4, v4
  v_mul_u32_u24 v5, 2731, v4
  v_lshrrev_b32 v5, 16, v5
  v_mul_u32_u24 v5, 384, v5
  v_lshl_add_u32 v4, v4, 4, v5
  v_add_u32 v18, s26, v4
  v_add_u32 v22, 7680, v18
  v_max_i32 v18, 0, v18
  v_add_u32 v4, 180, v1
  v_xor_b32 v4, 4, v4
  v_mul_u32_u24 v5, 2731, v4
  v_lshrrev_b32 v5, 16, v5
  v_mul_u32_u24 v5, 384, v5
  v_lshl_add_u32 v4, v4, 4, v5
  v_add_u32 v19, s26, v4
  v_add_u32 v23, 7680, v19
  v_max_i32 v19, 0, v19
  v_add_u32 v4, 0, v1
  v_xor_b32 v4, 12, v4
  v_mul_u32_u24 v5, 2731, v4
  v_lshrrev_b32 v5, 16, v5
  v_mul_u32_u24 v5, 384, v5
  v_lshl_add_u32 v4, v4, 4, v5
  v_add_u32 v24, s26, v4
  v_add_u32 v28, 7680, v24
  v_max_i32 v24, 0, v24
  v_add_u32 v4, 60, v1
  v_xor_b32 v4, 12, v4
  v_mul_u32_u24 v5, 2731, v4
  v_lshrrev_b32 v5, 16, v5
  v_mul_u32_u24 v5, 384, v5
  v_lshl_add_u32 v4, v4, 4, v5
  v_add_u32 v25, s26, v4
  v_add_u32 v29, 7680, v25
  v_max_i32 v25, 0, v25
  v_add_u32 v4, 120, v1
  v_xor_b32 v4, 12, v4
  v_mul_u32_u24 v5, 2731, v4
  v_lshrrev_b32 v5, 16, v5
  v_mul_u32_u24 v5, 384, v5
  v_lshl_add_u32 v4, v4, 4, v5
  v_add_u32 v26, s26, v4
  v_add_u32 v30, 7680, v26
  v_max_i32 v26, 0, v26
  v_add_u32 v4, 180, v1
  v_xor_b32 v4, 12, v4
  v_mul_u32_u24 v5, 2731, v4
  v_lshrrev_b32 v5, 16, v5
  v_mul_u32_u24 v5, 384, v5
  v_lshl_add_u32 v4, v4, 4, v5
  v_add_u32 v27, s26, v4
  v_add_u32 v31, 7680, v27
  v_max_i32 v27, 0, v27
  v_add_u32 v4, 0, v1
  v_xor_b32 v4, 6, v4
  v_mul_u32_u24 v5, 2731, v4
  v_lshrrev_b32 v5, 16, v5
  v_mul_u32_u24 v5, 384, v5
  v_lshl_add_u32 v4, v4, 4, v5
  v_add_u32 v32, s26, v4
  v_add_u32 v36, 7680, v32
  v_max_i32 v32, 0, v32
  v_add_u32 v4, 60, v1
  v_xor_b32 v4, 6, v4
  v_mul_u32_u24 v5, 2731, v4
  v_lshrrev_b32 v5, 16, v5
  v_mul_u32_u24 v5, 384, v5
  v_lshl_add_u32 v4, v4, 4, v5
  v_add_u32 v33, s26, v4
  v_add_u32 v37, 7680, v33
  v_max_i32 v33, 0, v33
  v_add_u32 v4, 120, v1
  v_xor_b32 v4, 6, v4
  v_mul_u32_u24 v5, 2731, v4
  v_lshrrev_b32 v5, 16, v5
  v_mul_u32_u24 v5, 384, v5
  v_lshl_add_u32 v4, v4, 4, v5
  v_add_u32 v34, s26, v4
  v_add_u32 v38, 7680, v34
  v_max_i32 v34, 0, v34
  v_add_u32 v4, 180, v1
  v_xor_b32 v4, 6, v4
  v_mul_u32_u24 v5, 2731, v4
  v_lshrrev_b32 v5, 16, v5
  v_mul_u32_u24 v5, 384, v5
  v_lshl_add_u32 v4, v4, 4, v5
  v_add_u32 v35, s26, v4
  v_add_u32 v39, 7680, v35
  v_max_i32 v35, 0, v35
  v_add_u32 v4, 0, v1
  v_xor_b32 v4, 14, v4
  v_mul_u32_u24 v5, 2731, v4
  v_lshrrev_b32 v5, 16, v5
  v_mul_u32_u24 v5, 384, v5
  v_lshl_add_u32 v4, v4, 4, v5
  v_add_u32 v40, s26, v4
  v_add_u32 v44, 7680, v40
  v_max_i32 v40, 0, v40
  v_add_u32 v4, 60, v1
  v_xor_b32 v4, 14, v4
  v_mul_u32_u24 v5, 2731, v4
  v_lshrrev_b32 v5, 16, v5
  v_mul_u32_u24 v5, 384, v5
  v_lshl_add_u32 v4, v4, 4, v5
  v_add_u32 v41, s26, v4
  v_add_u32 v45, 7680, v41
  v_max_i32 v41, 0, v41
  v_add_u32 v4, 120, v1
  v_xor_b32 v4, 14, v4
  v_mul_u32_u24 v5, 2731, v4
  v_lshrrev_b32 v5, 16, v5
  v_mul_u32_u24 v5, 384, v5
  v_lshl_add_u32 v4, v4, 4, v5
  v_add_u32 v42, s26, v4
  v_add_u32 v46, 7680, v42
  v_max_i32 v42, 0, v42
  v_add_u32 v4, 180, v1
  v_xor_b32 v4, 14, v4
  v_mul_u32_u24 v5, 2731, v4
  v_lshrrev_b32 v5, 16, v5
  v_mul_u32_u24 v5, 384, v5
  v_lshl_add_u32 v4, v4, 4, v5
  v_add_u32 v43, s26, v4
  v_add_u32 v47, 7680, v43
  v_max_i32 v43, 0, v43
  v_add_u32 v4, 0, v1
  v_xor_b32 v4, 0, v4
  v_mul_u32_u24 v5, 2731, v4
  v_lshrrev_b32 v5, 16, v5
  v_mul_u32_u24 v5, 384, v5
  v_lshl_add_u32 v4, v4, 4, v5
  v_add_u32 v48, s26, v4
  v_add_u32 v52, 7680, v48
  v_max_i32 v48, 0, v48
  v_add_u32 v4, 60, v1
  v_xor_b32 v4, 0, v4
  v_mul_u32_u24 v5, 2731, v4
  v_lshrrev_b32 v5, 16, v5
  v_mul_u32_u24 v5, 384, v5
  v_lshl_add_u32 v4, v4, 4, v5
  v_add_u32 v49, s26, v4
  v_add_u32 v53, 7680, v49
  v_max_i32 v49, 0, v49
  v_add_u32 v4, 120, v1
  v_xor_b32 v4, 0, v4
  v_mul_u32_u24 v5, 2731, v4
  v_lshrrev_b32 v5, 16, v5
  v_mul_u32_u24 v5, 384, v5
  v_lshl_add_u32 v4, v4, 4, v5
  v_add_u32 v50, s26, v4
  v_add_u32 v54, 7680, v50
  v_max_i32 v50, 0, v50
  v_add_u32 v4, 180, v1
  v_xor_b32 v4, 0, v4
  v_mul_u32_u24 v5, 2731, v4
  v_lshrrev_b32 v5, 16, v5
  v_mul_u32_u24 v5, 384, v5
  v_lshl_add_u32 v4, v4, 4, v5
  v_add_u32 v51, s26, v4
  v_add_u32 v55, 7680, v51
  v_max_i32 v51, 0, v51
  v_add_u32 v4, 0, v1
  v_xor_b32 v4, 8, v4
  v_mul_u32_u24 v5, 2731, v4
  v_lshrrev_b32 v5, 16, v5
  v_mul_u32_u24 v5, 384, v5
  v_lshl_add_u32 v4, v4, 4, v5
  v_add_u32 v56, s26, v4
  v_add_u32 v60, 7680, v56
  v_max_i32 v56, 0, v56
  v_add_u32 v4, 60, v1
  v_xor_b32 v4, 8, v4
  v_mul_u32_u24 v5, 2731, v4
  v_lshrrev_b32 v5, 16, v5
  v_mul_u32_u24 v5, 384, v5
  v_lshl_add_u32 v4, v4, 4, v5
  v_add_u32 v57, s26, v4
  v_add_u32 v61, 7680, v57
  v_max_i32 v57, 0, v57
  v_add_u32 v4, 120, v1
  v_xor_b32 v4, 8, v4
  v_mul_u32_u24 v5, 2731, v4
  v_lshrrev_b32 v5, 16, v5
  v_mul_u32_u24 v5, 384, v5
  v_lshl_add_u32 v4, v4, 4, v5
  v_add_u32 v58, s26, v4
  v_add_u32 v62, 7680, v58
  v_max_i32 v58, 0, v58
  v_add_u32 v4, 180, v1
  v_xor_b32 v4, 8, v4
  v_mul_u32_u24 v5, 2731, v4
  v_lshrrev_b32 v5, 16, v5
  v_mul_u32_u24 v5, 384, v5
  v_lshl_add_u32 v4, v4, 4, v5
  v_add_u32 v59, s26, v4
  v_add_u32 v63, 7680, v59
  v_max_i32 v59, 0, v59
  v_add_u32 v4, 0, v1
  v_xor_b32 v4, 2, v4
  v_mul_u32_u24 v5, 2731, v4
  v_lshrrev_b32 v5, 16, v5
  v_mul_u32_u24 v5, 384, v5
  v_lshl_add_u32 v4, v4, 4, v5
  v_add_u32 v64, s26, v4
  v_add_u32 v68, 7680, v64
  v_max_i32 v64, 0, v64
  v_add_u32 v4, 60, v1
  v_xor_b32 v4, 2, v4
  v_mul_u32_u24 v5, 2731, v4
  v_lshrrev_b32 v5, 16, v5
  v_mul_u32_u24 v5, 384, v5
  v_lshl_add_u32 v4, v4, 4, v5
  v_add_u32 v65, s26, v4
  v_add_u32 v69, 7680, v65
  v_max_i32 v65, 0, v65
  v_add_u32 v4, 120, v1
  v_xor_b32 v4, 2, v4
  v_mul_u32_u24 v5, 2731, v4
  v_lshrrev_b32 v5, 16, v5
  v_mul_u32_u24 v5, 384, v5
  v_lshl_add_u32 v4, v4, 4, v5
  v_add_u32 v66, s26, v4
  v_add_u32 v70, 7680, v66
  v_max_i32 v66, 0, v66
  v_add_u32 v4, 180, v1
  v_xor_b32 v4, 2, v4
  v_mul_u32_u24 v5, 2731, v4
  v_lshrrev_b32 v5, 16, v5
  v_mul_u32_u24 v5, 384, v5
  v_lshl_add_u32 v4, v4, 4, v5
  v_add_u32 v67, s26, v4
  v_add_u32 v71, 7680, v67
  v_max_i32 v67, 0, v67
  v_add_u32 v4, 0, v1
  v_xor_b32 v4, 10, v4
  v_mul_u32_u24 v5, 2731, v4
  v_lshrrev_b32 v5, 16, v5
  v_mul_u32_u24 v5, 384, v5
  v_lshl_add_u32 v4, v4, 4, v5
  v_add_u32 v72, s26, v4
  v_add_u32 v76, 7680, v72
  v_max_i32 v72, 0, v72
  v_add_u32 v4, 60, v1
  v_xor_b32 v4, 10, v4
  v_mul_u32_u24 v5, 2731, v4
  v_lshrrev_b32 v5, 16, v5
  v_mul_u32_u24 v5, 384, v5
  v_lshl_add_u32 v4, v4, 4, v5
  v_add_u32 v73, s26, v4
  v_add_u32 v77, 7680, v73
  v_max_i32 v73, 0, v73
  v_add_u32 v4, 120, v1
  v_xor_b32 v4, 10, v4
  v_mul_u32_u24 v5, 2731, v4
  v_lshrrev_b32 v5, 16, v5
  v_mul_u32_u24 v5, 384, v5
  v_lshl_add_u32 v4, v4, 4, v5
  v_add_u32 v74, s26, v4
  v_add_u32 v78, 7680, v74
  v_max_i32 v74, 0, v74
  v_add_u32 v4, 180, v1
  v_xor_b32 v4, 10, v4
  v_mul_u32_u24 v5, 2731, v4
  v_lshrrev_b32 v5, 16, v5
  v_mul_u32_u24 v5, 384, v5
  v_lshl_add_u32 v4, v4, 4, v5
  v_add_u32 v75, s26, v4
  v_add_u32 v79, 7680, v75
  v_max_i32 v75, 0, v75
  s_mov_b32 exec_hi, 0x0fffffff
  s_barrier
  s_add_i32 s34, s25, 12
  s_lshl_b32 s34, s34, 1
  s_add_i32 s34, s34, s21
  s_max_i32 s34, s34, 0
  s_min_i32 s34, s34, 223
  s_mul_i32 s34, s34, 86016
  s_mov_b32 m0, 92160
  s_nop 0
  buffer_load_dwordx4 v16, s[8:11], s34 offen lds
  s_mov_b32 m0, 93120
  s_nop 0
  buffer_load_dwordx4 v17, s[8:11], s34 offen lds
  s_mov_b32 m0, 94080
  s_nop 0
  buffer_load_dwordx4 v18, s[8:11], s34 offen lds
  s_mov_b32 m0, 95040
  s_nop 0
  buffer_load_dwordx4 v19, s[8:11], s34 offen lds
  s_mov_b32 m0, 96000
  s_nop 0
  buffer_load_dwordx4 v20, s[8:11], s34 offen lds
  s_mov_b32 m0, 96960
  s_nop 0
  buffer_load_dwordx4 v21, s[8:11], s34 offen lds
  s_mov_b32 m0, 97920
  s_nop 0
  buffer_load_dwordx4 v22, s[8:11], s34 offen lds
  s_mov_b32 m0, 98880
  s_nop 0
  buffer_load_dwordx4 v23, s[8:11], s34 offen lds
  s_add_i32 s34, s25, 13
  s_lshl_b32 s34, s34, 1
  s_add_i32 s34, s34, s21
  s_max_i32 s34, s34, 0
  s_min_i32 s34, s34, 223
  s_mul_i32 s34, s34, 86016
  s_mov_b32 m0, 99840
  s_nop 0
  buffer_load_dwordx4 v24, s[8:11], s34 offen lds
  s_mov_b32 m0, 100800
  s_nop 0
  buffer_load_dwordx4 v25, s[8:11], s34 offen lds
  s_mov_b32 m0, 101760
  s_nop 0
  buffer_load_dwordx4 v26, s[8:11], s34 offen lds
  s_mov_b32 m0, 102720
  s_nop 0
  buffer_load_dwordx4 v27, s[8:11], s34 offen lds
  s_mov_b32 m0, 103680
  s_nop 0
  buffer_load_dwordx4 v28, s[8:11], s34 offen lds
  s_mov_b32 m0, 104640
  s_nop 0
  buffer_load_dwordx4 v29, s[8:11], s34 offen lds
  s_mov_b32 m0, 105600
  s_nop 0
  buffer_load_dwordx4 v30, s[8:11], s34 offen lds
  s_mov_b32 m0, 106560
  s_nop 0
  buffer_load_dwordx4 v31, s[8:11], s34 offen lds
  s_add_i32 s34, s25, 14
  s_lshl_b32 s34, s34, 1
  s_add_i32 s34, s34, s21
  s_max_i32 s34, s34, 0
  s_min_i32 s34, s34, 223
  s_mul_i32 s34, s34, 86016
  s_mov_b32 m0, 107520
  s_nop 0
  buffer_load_dwordx4 v32, s[8:11], s34 offen lds
  s_mov_b32 m0, 108480
  s_nop 0
  buffer_load_dwordx4 v33, s[8:11], s34 offen lds
  s_mov_b32 m0, 109440
  s_nop 0
  buffer_load_dwordx4 v34, s[8:11], s34 offen lds
  s_mov_b32 m0, 110400
  s_nop 0
  buffer_load_dwordx4 v35, s[8:11], s34 offen lds
  s_mov_b32 m0, 111360
  s_nop 0
  buffer_load_dwordx4 v36, s[8:11], s34 offen lds
  s_mov_b32 m0, 112320
  s_nop 0
  buffer_load_dwordx4 v37, s[8:11], s34 offen lds
  s_mov_b32 m0, 113280
  s_nop 0
  buffer_load_dwordx4 v38, s[8:11], s34 offen lds
  s_mov_b32 m0, 114240
  s_nop 0
  buffer_load_dwordx4 v39, s[8:11], s34 offen lds
  s_barrier
  s_add_i32 s34, s25, 15
  s_lshl_b32 s34, s34, 1
  s_add_i32 s34, s34, s21
  s_max_i32 s34, s34, 0
  s_min_i32 s34, s34, 223
  s_mul_i32 s34, s34, 86016
  s_mov_b32 m0, 115200
  s_nop 0
  buffer_load_dwordx4 v40, s[8:11], s34 offen lds
  s_mov_b32 m0, 116160
  s_nop 0
  buffer_load_dwordx4 v41, s[8:11], s34 offen lds
  s_mov_b32 m0, 117120
  s_nop 0
  buffer_load_dwordx4 v42, s[8:11], s34 offen lds
  s_mov_b32 m0, 118080
  s_nop 0
  buffer_load_dwordx4 v43, s[8:11], s34 offen lds
  s_mov_b32 m0, 119040
  s_nop 0
  buffer_load_dwordx4 v44, s[8:11], s34 offen lds
  s_mov_b32 m0, 120000
  s_nop 0
  buffer_load_dwordx4 v45, s[8:11], s34 offen lds
  s_mov_b32 m0, 120960
  s_nop 0
  buffer_load_dwordx4 v46, s[8:11], s34 offen lds
  s_mov_b32 m0, 121920
  s_nop 0
  buffer_load_dwordx4 v47, s[8:11], s34 offen lds
  s_add_i32 s34, s25, 16
  s_lshl_b32 s34, s34, 1
  s_add_i32 s34, s34, s21
  s_max_i32 s34, s34, 0
  s_min_i32 s34, s34, 223
  s_mul_i32 s34, s34, 86016
  s_mov_b32 m0, 122880
  s_nop 0
  buffer_load_dwordx4 v48, s[8:11], s34 offen lds
  s_mov_b32 m0, 123840
  s_nop 0
  buffer_load_dwordx4 v49, s[8:11], s34 offen lds
  s_mov_b32 m0, 124800
  s_nop 0
  buffer_load_dwordx4 v50, s[8:11], s34 offen lds
  s_mov_b32 m0, 125760
  s_nop 0
  buffer_load_dwordx4 v51, s[8:11], s34 offen lds
  s_mov_b32 m0, 126720
  s_nop 0
  buffer_load_dwordx4 v52, s[8:11], s34 offen lds
  s_mov_b32 m0, 127680
  s_nop 0
  buffer_load_dwordx4 v53, s[8:11], s34 offen lds
  s_mov_b32 m0, 128640
  s_nop 0
  buffer_load_dwordx4 v54, s[8:11], s34 offen lds
  s_mov_b32 m0, 129600
  s_nop 0
  buffer_load_dwordx4 v55, s[8:11], s34 offen lds
  s_add_i32 s34, s25, 17
  s_lshl_b32 s34, s34, 1
  s_add_i32 s34, s34, s21
  s_max_i32 s34, s34, 0
  s_min_i32 s34, s34, 223
  s_mul_i32 s34, s34, 86016
  s_mov_b32 m0, 130560
  s_nop 0
  buffer_load_dwordx4 v56, s[8:11], s34 offen lds
  s_mov_b32 m0, 131520
  s_nop 0
  buffer_load_dwordx4 v57, s[8:11], s34 offen lds
  s_mov_b32 m0, 132480
  s_nop 0
  buffer_load_dwordx4 v58, s[8:11], s34 offen lds
  s_mov_b32 m0, 133440
  s_nop 0
  buffer_load_dwordx4 v59, s[8:11], s34 offen lds
  s_mov_b32 m0, 134400
  s_nop 0
  buffer_load_dwordx4 v60, s[8:11], s34 offen lds
  s_mov_b32 m0, 135360
  s_nop 0
  buffer_load_dwordx4 v61, s[8:11], s34 offen lds
  s_mov_b32 m0, 136320
  s_nop 0
  buffer_load_dwordx4 v62, s[8:11], s34 offen lds
  s_mov_b32 m0, 137280
  s_nop 0
  buffer_load_dwordx4 v63, s[8:11], s34 offen lds
  s_waitcnt vmcnt(0)
  s_barrier
  s_add_i32 s34, s25, 18
  s_lshl_b32 s34, s34, 1
  s_add_i32 s34, s34, s21
  s_max_i32 s34, s34, 0
  s_min_i32 s34, s34, 223
  s_mul_i32 s34, s34, 86016
  s_mov_b32 m0, 138240
  s_nop 0
  buffer_load_dwordx4 v64, s[8:11], s34 offen lds
  s_mov_b32 m0, 139200
  s_nop 0
  buffer_load_dwordx4 v65, s[8:11], s34 offen lds
  s_mov_b32 m0, 140160
  s_nop 0
  buffer_load_dwordx4 v66, s[8:11], s34 offen lds
  s_mov_b32 m0, 141120
  s_nop 0
  buffer_load_dwordx4 v67, s[8:11], s34 offen lds
  s_mov_b32 m0, 142080
  s_nop 0
  buffer_load_dwordx4 v68, s[8:11], s34 offen lds
  s_mov_b32 m0, 143040
  s_nop 0
  buffer_load_dwordx4 v69, s[8:11], s34 offen lds
  s_mov_b32 m0, 144000
  s_nop 0
  buffer_load_dwordx4 v70, s[8:11], s34 offen lds
  s_mov_b32 m0, 144960
  s_nop 0
  buffer_load_dwordx4 v71, s[8:11], s34 offen lds
  s_add_i32 s34, s25, 19
  s_lshl_b32 s34, s34, 1
  s_add_i32 s34, s34, s21
  s_max_i32 s34, s34, 0
  s_min_i32 s34, s34, 223
  s_mul_i32 s34, s34, 86016
  s_mov_b32 m0, 145920
  s_nop 0
  buffer_load_dwordx4 v72, s[8:11], s34 offen lds
  s_mov_b32 m0, 146880
  s_nop 0
  buffer_load_dwordx4 v73, s[8:11], s34 offen lds
  s_mov_b32 m0, 147840
  s_nop 0
  buffer_load_dwordx4 v74, s[8:11], s34 offen lds
  s_mov_b32 m0, 148800
  s_nop 0
  buffer_load_dwordx4 v75, s[8:11], s34 offen lds
  s_mov_b32 m0, 149760
  s_nop 0
  buffer_load_dwordx4 v76, s[8:11], s34 offen lds
  s_mov_b32 m0, 150720
  s_nop 0
  buffer_load_dwordx4 v77, s[8:11], s34 offen lds
  s_mov_b32 m0, 151680
  s_nop 0
  buffer_load_dwordx4 v78, s[8:11], s34 offen lds
  s_mov_b32 m0, 152640
  s_nop 0
  buffer_load_dwordx4 v79, s[8:11], s34 offen lds
  s_mov_b64 exec, -1
  s_mov_b32 m0, 153600
  s_mov_b32 s33, 135168
  buffer_load_dwordx4 v230, s[16:19], s33 offen offset:0 lds
  buffer_load_dwordx4 v230, s[16:19], s33 offen offset:1024 lds
  buffer_load_dwordx4 v230, s[16:19], s33 offen offset:2048 lds
  buffer_load_dwordx4 v230, s[16:19], s33 offen offset:3072 lds
  s_mov_b32 m0, 157696
  s_mov_b32 s33, 139264
  buffer_load_dwordx4 v230, s[16:19], s33 offen offset:0 lds
  buffer_load_dwordx4 v230, s[16:19], s33 offen offset:1024 lds
  buffer_load_dwordx4 v230, s[16:19], s33 offen offset:2048 lds
  buffer_load_dwordx4 v230, s[16:19], s33 offen offset:3072 lds
  s_mov_b32 m0, 161792
  s_mov_b32 s33, 143360
  buffer_load_dwordx4 v230, s[16:19], s33 offen offset:0 lds
  buffer_load_dwordx4 v230, s[16:19], s33 offen offset:1024 lds
  s_waitcnt vmcnt(10)
  s_barrier
  s_barrier
  s_mov_b32 m0, 0
  s_mov_b32 s33, 73728
  buffer_load_dwordx4 v230, s[16:19], s33 offen offset:0 lds
  buffer_load_dwordx4 v230, s[16:19], s33 offen offset:1024 lds
  buffer_load_dwordx4 v230, s[16:19], s33 offen offset:2048 lds
  buffer_load_dwordx4 v230, s[16:19], s33 offen offset:3072 lds
  s_mov_b32 m0, 4096
  s_mov_b32 s33, 77824
  buffer_load_dwordx4 v230, s[16:19], s33 offen offset:0 lds
  buffer_load_dwordx4 v230, s[16:19], s33 offen offset:1024 lds
  buffer_load_dwordx4 v230, s[16:19], s33 offen offset:2048 lds
  buffer_load_dwordx4 v230, s[16:19], s33 offen offset:3072 lds
  s_mov_b32 m0, 8192
  s_mov_b32 s33, 81920
  buffer_load_dwordx4 v230, s[16:19], s33 offen offset:0 lds
  buffer_load_dwordx4 v230, s[16:19], s33 offen offset:1024 lds
  buffer_load_dwordx4 v230, s[16:19], s33 offen offset:2048 lds
  buffer_load_dwordx4 v230, s[16:19], s33 offen offset:3072 lds
  s_mov_b32 m0, 12288
  s_mov_b32 s33, 86016
  buffer_load_dwordx4 v230, s[16:19], s33 offen offset:0 lds
  buffer_load_dwordx4 v230, s[16:19], s33 offen offset:1024 lds
  buffer_load_dwordx4 v230, s[16:19], s33 offen offset:2048 lds
  buffer_load_dwordx4 v230, s[16:19], s33 offen offset:3072 lds
  s_mov_b32 m0, 16384
  s_mov_b32 s33, 90112
  buffer_load_dwordx4 v230, s[16:19], s33 offen offset:0 lds
  buffer_load_dwordx4 v230, s[16:19], s33 offen offset:1024 lds
  buffer_load_dwordx4 v230, s[16:19], s33 offen offset:2048 lds
  buffer_load_dwordx4 v230, s[16:19], s33 offen offset:3072 lds
  s_mov_b32 m0, 20480
  s_mov_b32 s33, 94208
  buffer_load_dwordx4 v230, s[16:19], s33 offen offset:0 lds
  buffer_load_dwordx4 v230, s[16:19], s33 offen offset:1024 lds
  buffer_load_dwordx4 v230, s[16:19], s33 offen offset:2048 lds
  buffer_load_dwordx4 v230, s[16:19], s33 offen offset:3072 lds
  s_mov_b32 m0, 24576
  s_mov_b32 s33, 98304
  buffer_load_dwordx4 v230, s[16:19], s33 offen offset:0 lds
  buffer_load_dwordx4 v230, s[16:19], s33 offen offset:1024 lds
  buffer_load_dwordx4 v230, s[16:19], s33 offen offset:2048 lds
  buffer_load_dwordx4 v230, s[16:19], s33 offen offset:3072 lds
  s_mov_b32 m0, 28672
  s_mov_b32 s33, 102400
  buffer_load_dwordx4 v230, s[16:19], s33 offen offset:0 lds
  buffer_load_dwordx4 v230, s[16:19], s33 offen offset:1024 lds
  buffer_load_dwordx4 v230, s[16:19], s33 offen offset:2048 lds
  buffer_load_dwordx4 v230, s[16:19], s33 offen offset:3072 lds
  s_mov_b32 m0, 32768
  s_mov_b32 s33, 106496
  buffer_load_dwordx4 v230, s[16:19], s33 offen offset:0 lds
  buffer_load_dwordx4 v230, s[16:19], s33 offen offset:1024 lds
  buffer_load_dwordx4 v230, s[16:19], s33 offen offset:2048 lds
  buffer_load_dwordx4 v230, s[16:19], s33 offen offset:3072 lds
  s_mov_b32 m0, 36864
  s_mov_b32 s33, 110592
  buffer_load_dwordx4 v230, s[16:19], s33 offen offset:0 lds
  buffer_load_dwordx4 v230, s[16:19], s33 offen offset:1024 lds
  buffer_load_dwordx4 v230, s[16:19], s33 offen offset:2048 lds
  buffer_load_dwordx4 v230, s[16:19], s33 offen offset:3072 lds
  s_mov_b32 m0, 40960
  s_mov_b32 s33, 114688
  buffer_load_dwordx4 v230, s[16:19], s33 offen offset:0 lds
  buffer_load_dwordx4 v230, s[16:19], s33 offen offset:1024 lds
  buffer_load_dwordx4 v230, s[16:19], s33 offen offset:2048 lds
  buffer_load_dwordx4 v230, s[16:19], s33 offen offset:3072 lds
  s_mov_b32 m0, 45056
  s_mov_b32 s33, 118784
  buffer_load_dwordx4 v230, s[16:19], s33 offen offset:0 lds
  buffer_load_dwordx4 v230, s[16:19], s33 offen offset:1024 lds
  buffer_load_dwordx4 v230, s[16:19], s33 offen offset:2048 lds
  buffer_load_dwordx4 v230, s[16:19], s33 offen offset:3072 lds
  s_mov_b32 m0, 49152
  s_mov_b32 s33, 122880
  buffer_load_dwordx4 v230, s[16:19], s33 offen offset:0 lds
  buffer_load_dwordx4 v230, s[16:19], s33 offen offset:1024 lds
  buffer_load_dwordx4 v230, s[16:19], s33 offen offset:2048 lds
  buffer_load_dwordx4 v230, s[16:19], s33 offen offset:3072 lds
  s_mov_b32 m0, 53248
  s_mov_b32 s33, 126976
  buffer_load_dwordx4 v230, s[16:19], s33 offen offset:0 lds
  buffer_load_dwordx4 v230, s[16:19], s33 offen offset:1024 lds
  buffer_load_dwordx4 v230, s[16:19], s33 offen offset:2048 lds
  buffer_load_dwordx4 v230, s[16:19], s33 offen offset:3072 lds
  s_mov_b32 m0, 57344
  s_mov_b32 s33, 131072
  buffer_load_dwordx4 v230, s[16:19], s33 offen offset:0 lds
  buffer_load_dwordx4 v230, s[16:19], s33 offen offset:1024 lds
  buffer_load_dwordx4 v230, s[16:19], s33 offen offset:2048 lds
  buffer_load_dwordx4 v230, s[16:19], s33 offen offset:3072 lds
  s_waitcnt vmcnt(0)
  s_barrier
M_done:
  s_endpgm
.section .rodata,"a"
.p2align 6
.amdhsa_kernel prep_kernel
  .amdhsa_next_free_vgpr 152
  .amdhsa_next_free_sgpr 102
  .amdhsa_accum_offset 152
  .amdhsa_group_segment_fixed_size 0
  .amdhsa_kernarg_size 48
  .amdhsa_user_sgpr_count 2
  .amdhsa_user_sgpr_kernarg_segment_ptr 1
  .amdhsa_system_sgpr_workgroup_id_x 1
.end_amdhsa_kernel
.p2align 6
.amdhsa_kernel main_kernel
  .amdhsa_next_free_vgpr 256
  .amdhsa_next_free_sgpr 102
  .amdhsa_accum_offset 256
  .amdhsa_group_segment_fixed_size 0
  .amdhsa_kernarg_size 48
  .amdhsa_user_sgpr_count 2
  .amdhsa_user_sgpr_kernarg_segment_ptr 1
  .amdhsa_system_sgpr_workgroup_id_x 1
.end_amdhsa_kernel
```

```asm
; @launch grid=(256,1,1) block=(512,1,1) lds=163840
.amdgcn_target "amdgcn-amd-amdhsa--gfx950"
.text
.globl standalone__neighborhood_nat__vision_kernel
.p2align 8
.type standalone__neighborhood_nat__vision_kernel,@function
standalone__neighborhood_nat__vision_kernel:
  s_cmp_ge_u32 s2, 256
  s_cbranch_scc1 M_done
  s_load_dwordx8 s[4:11], s[0:1], 0
  s_load_dwordx4 s[12:15], s[0:1], 32
  v_lshrrev_b32 v4, 6, v0
  v_and_b32 v1, 63, v0
  v_readfirstlane_b32 s40, v4
  v_lshrrev_b32 v2, 4, v1
  v_and_b32 v3, 15, v1
  v_lshlrev_b32 v252, 4, v1
  v_lshrrev_b32 v4, 4, v1
  v_bfe_u32 v5, v1, 2, 2
  v_lshl_add_u32 v4, v4, 3, v5
  v_mul_u32_u24 v4, 1152, v4
  v_lshrrev_b32 v5, 5, v1
  v_lshlrev_b32 v5, 1, v5
  v_and_b32 v6, 3, v1
  v_xor_b32 v6, v5, v6
  v_lshl_add_u32 v200, v6, 4, v4
  s_and_b32 s55, s2, 7
  s_lshr_b32 s56, s2, 3
  s_lshr_b32 s41, s55, 2
  s_bfe_u32 s42, s55, 0x10001
  s_and_b32 s55, s55, 1
  s_lshl_b32 s55, s55, 2
  s_lshr_b32 s43, s56, 3
  s_add_u32 s43, s43, s55
  s_and_b32 s44, s56, 7
  s_mul_i32 s43, s43, 14
  s_mul_i32 s44, s44, 14
  s_mul_i32 s61, s41, 13
  s_add_i32 s61, s61, -6
  s_mul_i32 s62, s42, 13
  s_add_i32 s62, s62, -6
  s_sub_u32 s53, s40, 1
  s_lshl_b32 s53, s53, 1
  v_lshrrev_b32 v4, 5, v1
  s_add_u32 s58, s43, s53
  v_add_u32 v4, s58, v4
  v_lshl_add_u32 v5, v4, 1, s61
  v_add_u32 v7, 112, v4
  v_med3_i32 v4, v5, v4, v7
  v_mul_u32_u24 v4, 224, v4
  v_bfe_u32 v11, v1, 2, 3
  v_min_u32 v11, 6, v11
  v_add_u32 v11, s44, v11
  v_lshl_add_u32 v5, v11, 1, s62
  v_add_u32 v7, 112, v11
  v_med3_i32 v201, v5, v11, v7
  v_add_u32 v201, v201, v4
  v_mul_u32_u24 v201, 384, v201
  v_lshl_add_u32 v201, v6, 4, v201
  v_add_u32 v11, 7, v11
  v_lshl_add_u32 v5, v11, 1, s62
  v_add_u32 v7, 112, v11
  v_med3_i32 v202, v5, v11, v7
  v_add_u32 v202, v202, v4
  v_mul_u32_u24 v202, 384, v202
  v_lshl_add_u32 v202, v6, 4, v202
  s_waitcnt lgkmcnt(0)
  s_mov_b32 s28, s6
  s_and_b32 s29, s7, 0xffff
  s_mov_b32 s30, 221184
  s_mov_b32 s31, 0x00020000
  s_mov_b32 s16, s4
  s_and_b32 s17, s5, 0xffff
  s_mov_b32 s18, 19267584
  s_mov_b32 s19, 0x00020000
  s_cmp_ge_u32 s40, 4
  s_cbranch_scc1 M_now
  s_cmp_lg_u32 s40, 0
  s_cbranch_scc1 M_nowarm
  s_lshr_b32 s55, s2, 3
  s_mul_i32 s55, s55, 6912
  s_add_u32 s56, s55, 4096
  buffer_load_dwordx4 v[16:19], v252, s[28:31], s55 offen offset:0
  buffer_load_dwordx4 v[20:23], v252, s[28:31], s55 offen offset:1024
  buffer_load_dwordx4 v[24:27], v252, s[28:31], s55 offen offset:2048
  buffer_load_dwordx4 v[28:31], v252, s[28:31], s55 offen offset:3072
  buffer_load_dwordx4 v[32:35], v252, s[28:31], s56 offen offset:0
  buffer_load_dwordx4 v[36:39], v252, s[28:31], s56 offen offset:1024
  buffer_load_dwordx4 v[40:43], v252, s[28:31], s56 offen offset:2048
M_nowarm:
  s_and_b32 s55, s40, 3
  s_mul_i32 s57, s55, 18432
  s_mul_i32 s55, s55, 3
  s_add_u32 s56, s55, 0
  s_lshr_b32 s58, s56, 1
  s_mul_i32 s58, s58, 36864
  s_and_b32 s56, s56, 1
  s_mul_i32 s56, s56, 4608
  s_add_u32 s56, s56, s58
  s_add_u32 m0, s57, 89728
  s_nop 0
  buffer_load_dwordx4 v200, s[28:31], s56 offen offset:384 lds
  s_add_u32 m0, s57, 90688
  s_nop 0
  buffer_load_dwordx4 v200, s[28:31], s56 offen offset:448 lds
  s_add_u32 m0, s57, 91648
  s_nop 0
  buffer_load_dwordx4 v200, s[28:31], s56 offen offset:512 lds
  s_add_u32 m0, s57, 92608
  s_nop 0
  buffer_load_dwordx4 v200, s[28:31], s56 offen offset:576 lds
  s_add_u32 m0, s57, 93568
  s_nop 0
  buffer_load_dwordx4 v200, s[28:31], s56 offen offset:640 lds
  s_add_u32 m0, s57, 94528
  s_nop 0
  buffer_load_dwordx4 v200, s[28:31], s56 offen offset:704 lds
  s_add_u32 s56, s55, 1
  s_lshr_b32 s58, s56, 1
  s_mul_i32 s58, s58, 36864
  s_and_b32 s56, s56, 1
  s_mul_i32 s56, s56, 4608
  s_add_u32 s56, s56, s58
  s_add_u32 m0, s57, 95872
  s_nop 0
  buffer_load_dwordx4 v200, s[28:31], s56 offen offset:384 lds
  s_add_u32 m0, s57, 96832
  s_nop 0
  buffer_load_dwordx4 v200, s[28:31], s56 offen offset:448 lds
  s_add_u32 m0, s57, 97792
  s_nop 0
  buffer_load_dwordx4 v200, s[28:31], s56 offen offset:512 lds
  s_add_u32 m0, s57, 98752
  s_nop 0
  buffer_load_dwordx4 v200, s[28:31], s56 offen offset:576 lds
  s_add_u32 m0, s57, 99712
  s_nop 0
  buffer_load_dwordx4 v200, s[28:31], s56 offen offset:640 lds
  s_add_u32 m0, s57, 100672
  s_nop 0
  buffer_load_dwordx4 v200, s[28:31], s56 offen offset:704 lds
  s_add_u32 s56, s55, 2
  s_lshr_b32 s58, s56, 1
  s_mul_i32 s58, s58, 36864
  s_and_b32 s56, s56, 1
  s_mul_i32 s56, s56, 4608
  s_add_u32 s56, s56, s58
  s_add_u32 m0, s57, 102016
  s_nop 0
  buffer_load_dwordx4 v200, s[28:31], s56 offen offset:384 lds
  s_add_u32 m0, s57, 102976
  s_nop 0
  buffer_load_dwordx4 v200, s[28:31], s56 offen offset:448 lds
  s_add_u32 m0, s57, 103936
  s_nop 0
  buffer_load_dwordx4 v200, s[28:31], s56 offen offset:512 lds
  s_add_u32 m0, s57, 104896
  s_nop 0
  buffer_load_dwordx4 v200, s[28:31], s56 offen offset:576 lds
  s_add_u32 m0, s57, 105856
  s_nop 0
  buffer_load_dwordx4 v200, s[28:31], s56 offen offset:640 lds
  s_add_u32 m0, s57, 106816
  s_nop 0
  buffer_load_dwordx4 v200, s[28:31], s56 offen offset:704 lds
M_now:
  s_mov_b32 s24, s14
  s_and_b32 s25, s15, 0xffff
  s_mov_b32 s26, 268435456
  s_mov_b32 s27, 0x00020000
  s_mov_b32 s20, s10
  s_and_b32 s21, s11, 0xffff
  s_mov_b32 s22, 19267584
  s_mov_b32 s23, 0x00020000
  s_mul_i32 s55, s41, 6
  s_add_i32 s45, s43, s55
  s_add_i32 s45, s45, -6
  s_cmp_eq_i32 s45, -6
  s_cselect_b32 s47, 6, 0
  s_cmp_eq_i32 s45, 98
  s_cselect_b32 s48, 7, 13
  s_cselect_b32 s49, 2, 0
  s_sub_i32 s45, s45, s49
  s_mul_i32 s55, s42, 6
  s_add_i32 s56, s44, s55
  s_add_i32 s56, s56, -6
  s_cmp_eq_i32 s56, -6
  s_cselect_b32 s50, 6, 0
  s_cmp_eq_i32 s56, 98
  s_cselect_b32 s51, 7, 13
  s_lshl_b32 s56, s56, 1
  s_add_i32 s56, s56, s42
  s_mul_i32 s46, s56, 384
  v_lshrrev_b32 v4, 3, v3
  v_lshlrev_b32 v4, 1, v4
  v_xor_b32 v4, v4, v2
  v_lshl_add_u32 v4, v3, 2, v4
  v_lshlrev_b32 v4, 4, v4
  s_lshl_b32 s55, s40, 11
  s_add_u32 s55, s55, 67072
  v_add_u32 v255, s55, v252
  v_add_u32 v0, s55, v4
  s_mul_i32 s57, s40, 18432
  s_add_u32 s57, s57, 90112
  v_add_u32 v184, s57, v4
  v_mov_b32 v195, v4
  v_add_u32 v196, 36864, v4
  s_mul_i32 s55, s40, 3
  s_add_u32 s57, s55, 0
  s_lshr_b32 s58, s57, 1
  s_mul_i32 s58, s58, 12
  s_and_b32 s57, s57, 1
  s_add_u32 s58, s58, s57
  s_lshl_b32 s58, s58, 10
  s_add_u32 s58, s58, 90112
  v_add_u32 v192, s58, v252
  s_add_u32 s57, s55, 1
  s_lshr_b32 s58, s57, 1
  s_mul_i32 s58, s58, 12
  s_and_b32 s57, s57, 1
  s_add_u32 s58, s58, s57
  s_lshl_b32 s58, s58, 10
  s_add_u32 s58, s58, 90112
  v_add_u32 v193, s58, v252
  s_add_u32 s57, s55, 2
  s_lshr_b32 s58, s57, 1
  s_mul_i32 s58, s58, 12
  s_and_b32 s57, s57, 1
  s_add_u32 s58, s58, s57
  s_lshl_b32 s58, s58, 10
  s_add_u32 s58, s58, 90112
  v_add_u32 v194, s58, v252
  s_max_i32 s52, s53, s47
  s_min_i32 s52, s52, s48
  s_and_b32 s52, s52, -2
  v_lshrrev_b32 v4, 3, v3
  v_add_u32 v4, s53, v4
  v_max_i32 v4, s47, v4
  v_min_i32 v4, s48, v4
  v_subrev_u32 v4, s52, v4
  s_add_u32 s52, s52, s49
  s_mov_b32 s54, 4286578688
  s_mov_b32 s63, 1037384597
  v_and_b32 v5, 1, v2
  v_sub_u32 v6, v5, v4
  v_ashrrev_i32 v12, 31, v6
  v_and_b32 v12, s54, v12
  v_sub_u32 v6, v4, v5
  v_ashrrev_i32 v13, 31, v6
  v_and_b32 v13, s54, v13
  v_and_b32 v4, 7, v3
  v_min_u32 v4, 6, v4
  v_lshrrev_b32 v5, 1, v2
  v_mov_b32 v7, 0x7f
  v_add_u32 v6, 0, v4
  v_max_i32 v6, s50, v6
  v_min_i32 v6, s51, v6
  v_lshlrev_b32 v6, v6, v7
  v_lshrrev_b32 v6, v5, v6
  v_not_b32 v14, v6
  v_add_u32 v6, 7, v4
  v_max_i32 v6, s50, v6
  v_min_i32 v6, s51, v6
  v_lshlrev_b32 v6, v6, v7
  v_lshrrev_b32 v6, v5, v6
  v_not_b32 v15, v6
  v_and_b32 v4, 7, v3
  v_add_u32 v4, s52, v4
  v_and_b32 v5, 1, v4
  v_lshlrev_b32 v5, 3, v5
  v_and_or_b32 v5, v4, 6, v5
  v_mul_u32_u24 v4, 7680, v4
  v_lshrrev_b32 v6, 3, v3
  v_mul_u32_u24 v6, 24, v6
  v_add_u32 v6, v6, v2
  v_add_u32 v7, 0, v6
  v_xor_b32 v7, v7, v5
  v_lshl_add_u32 v240, v7, 4, v4
  v_add_u32 v7, 4, v6
  v_xor_b32 v7, v7, v5
  v_lshl_add_u32 v241, v7, 4, v4
  v_add_u32 v7, 8, v6
  v_xor_b32 v7, v7, v5
  v_lshl_add_u32 v242, v7, 4, v4
  v_add_u32 v7, 12, v6
  v_xor_b32 v7, v7, v5
  v_lshl_add_u32 v243, v7, 4, v4
  v_and_b32 v4, 1, v2
  v_lshlrev_b32 v4, 2, v4
  v_lshrrev_b32 v5, 2, v3
  v_add3_u32 v4, v4, v5, s52
  v_and_b32 v5, 1, v4
  v_lshlrev_b32 v5, 3, v5
  v_and_or_b32 v5, v4, 6, v5
  v_mul_u32_u24 v4, 7680, v4
  v_and_b32 v6, 1, v3
  v_lshl_add_u32 v4, v6, 3, v4
  v_lshrrev_b32 v6, 1, v2
  v_mul_u32_u24 v6, 24, v6
  v_bfe_u32 v7, v3, 1, 1
  v_add_u32 v6, v6, v7
  v_add_u32 v7, 0, v6
  v_xor_b32 v7, v7, v5
  v_lshl_add_u32 v244, v7, 4, v4
  v_add_u32 v7, 2, v6
  v_xor_b32 v7, v7, v5
  v_lshl_add_u32 v245, v7, 4, v4
  v_add_u32 v7, 4, v6
  v_xor_b32 v7, v7, v5
  v_lshl_add_u32 v246, v7, 4, v4
  v_add_u32 v7, 6, v6
  v_xor_b32 v7, v7, v5
  v_lshl_add_u32 v247, v7, 4, v4
  v_add_u32 v7, 8, v6
  v_xor_b32 v7, v7, v5
  v_lshl_add_u32 v248, v7, 4, v4
  v_add_u32 v7, 10, v6
  v_xor_b32 v7, v7, v5
  v_lshl_add_u32 v249, v7, 4, v4
  v_add_u32 v7, 12, v6
  v_xor_b32 v7, v7, v5
  v_lshl_add_u32 v250, v7, 4, v4
  v_add_u32 v7, 14, v6
  v_xor_b32 v7, v7, v5
  v_lshl_add_u32 v251, v7, 4, v4
  v_add_u32 v253, 153600, v252
  v_add_u32 v254, 90112, v252
  s_and_b32 s55, s40, 1
  s_lshl_b32 s55, s55, 3
  s_and_b32 s56, s40, 6
  s_or_b32 s55, s55, s56
  v_add_u32 v4, 0, v1
  v_xor_b32 v4, s55, v4
  v_mul_u32_u24 v5, 2731, v4
  v_lshrrev_b32 v5, 16, v5
  v_mul_u32_u24 v5, 384, v5
  v_lshl_add_u32 v4, v4, 4, v5
  v_add_u32 v232, s46, v4
  v_add_u32 v235, 6144, v232
  v_add_u32 v238, 12288, v232
  v_max_i32 v232, 0, v232
  v_add_u32 v4, 64, v1
  v_xor_b32 v4, s55, v4
  v_mul_u32_u24 v5, 2731, v4
  v_lshrrev_b32 v5, 16, v5
  v_mul_u32_u24 v5, 384, v5
  v_lshl_add_u32 v4, v4, 4, v5
  v_add_u32 v233, s46, v4
  v_add_u32 v236, 6144, v233
  v_max_i32 v233, 0, v233
  v_add_u32 v4, 128, v1
  v_xor_b32 v4, s55, v4
  v_mul_u32_u24 v5, 2731, v4
  v_lshrrev_b32 v5, 16, v5
  v_mul_u32_u24 v5, 384, v5
  v_lshl_add_u32 v4, v4, 4, v5
  v_add_u32 v234, s46, v4
  v_add_u32 v237, 6144, v234
  v_max_i32 v234, 0, v234
  v_add_u32 v4, 416, v1
  v_xor_b32 v4, s55, v4
  v_mul_u32_u24 v5, 2731, v4
  v_lshrrev_b32 v5, 16, v5
  v_mul_u32_u24 v5, 384, v5
  v_lshl_add_u32 v4, v4, 4, v5
  v_add_u32 v239, s46, v4
  s_add_u32 s56, s40, 8
  s_add_i32 s100, s45, s56
  s_lshl_b32 s100, s100, 1
  s_add_i32 s100, s100, s41
  s_max_i32 s100, s100, 0
  s_min_i32 s100, s100, 223
  s_mul_i32 s100, s100, 86016
  s_mul_i32 s101, s56, 7680
  s_cmp_lt_u32 s40, 4
  s_cbranch_scc1 M_mw
  s_and_b32 s55, s40, 3
  s_mul_i32 s57, s55, 18432
  s_mul_i32 s55, s55, 3
  s_add_u32 s56, s55, 0
  s_lshr_b32 s58, s56, 1
  s_mul_i32 s58, s58, 36864
  s_and_b32 s56, s56, 1
  s_mul_i32 s56, s56, 4608
  s_add_u32 s56, s56, s58
  s_add_u32 m0, s57, 0
  s_nop 0
  buffer_load_dwordx4 v200, s[28:31], s56 offen offset:0 lds
  s_add_u32 m0, s57, 960
  s_nop 0
  buffer_load_dwordx4 v200, s[28:31], s56 offen offset:64 lds
  s_add_u32 m0, s57, 1920
  s_nop 0
  buffer_load_dwordx4 v200, s[28:31], s56 offen offset:128 lds
  s_add_u32 m0, s57, 2880
  s_nop 0
  buffer_load_dwordx4 v200, s[28:31], s56 offen offset:192 lds
  s_add_u32 m0, s57, 3840
  s_nop 0
  buffer_load_dwordx4 v200, s[28:31], s56 offen offset:256 lds
  s_add_u32 m0, s57, 4800
  s_nop 0
  buffer_load_dwordx4 v200, s[28:31], s56 offen offset:320 lds
  s_add_u32 s56, s55, 1
  s_lshr_b32 s58, s56, 1
  s_mul_i32 s58, s58, 36864
  s_and_b32 s56, s56, 1
  s_mul_i32 s56, s56, 4608
  s_add_u32 s56, s56, s58
  s_add_u32 m0, s57, 6144
  s_nop 0
  buffer_load_dwordx4 v200, s[28:31], s56 offen offset:0 lds
  s_add_u32 m0, s57, 7104
  s_nop 0
  buffer_load_dwordx4 v200, s[28:31], s56 offen offset:64 lds
  s_add_u32 m0, s57, 8064
  s_nop 0
  buffer_load_dwordx4 v200, s[28:31], s56 offen offset:128 lds
  s_add_u32 m0, s57, 9024
  s_nop 0
  buffer_load_dwordx4 v200, s[28:31], s56 offen offset:192 lds
  s_add_u32 m0, s57, 9984
  s_nop 0
  buffer_load_dwordx4 v200, s[28:31], s56 offen offset:256 lds
  s_add_u32 m0, s57, 10944
  s_nop 0
  buffer_load_dwordx4 v200, s[28:31], s56 offen offset:320 lds
  s_add_u32 s56, s55, 2
  s_lshr_b32 s58, s56, 1
  s_mul_i32 s58, s58, 36864
  s_and_b32 s56, s56, 1
  s_mul_i32 s56, s56, 4608
  s_add_u32 s56, s56, s58
  s_add_u32 m0, s57, 12288
  s_nop 0
  buffer_load_dwordx4 v200, s[28:31], s56 offen offset:0 lds
  s_add_u32 m0, s57, 13248
  s_nop 0
  buffer_load_dwordx4 v200, s[28:31], s56 offen offset:64 lds
  s_add_u32 m0, s57, 14208
  s_nop 0
  buffer_load_dwordx4 v200, s[28:31], s56 offen offset:128 lds
  s_add_u32 m0, s57, 15168
  s_nop 0
  buffer_load_dwordx4 v200, s[28:31], s56 offen offset:192 lds
  s_add_u32 m0, s57, 16128
  s_nop 0
  buffer_load_dwordx4 v200, s[28:31], s56 offen offset:256 lds
  s_add_u32 m0, s57, 17088
  s_nop 0
  buffer_load_dwordx4 v200, s[28:31], s56 offen offset:320 lds
  s_barrier
  s_waitcnt vmcnt(0)
  s_barrier
  buffer_load_dwordx4 v[16:19], v201, s[16:19], 0 offen offset:0
  buffer_load_dwordx4 v[40:43], v202, s[16:19], 0 offen offset:0
  buffer_load_dwordx4 v[20:23], v201, s[16:19], 0 offen offset:64
  buffer_load_dwordx4 v[44:47], v202, s[16:19], 0 offen offset:64
  buffer_load_dwordx4 v[24:27], v201, s[16:19], 0 offen offset:128
  buffer_load_dwordx4 v[48:51], v202, s[16:19], 0 offen offset:128
  buffer_load_dwordx4 v[28:31], v201, s[16:19], 0 offen offset:192
  buffer_load_dwordx4 v[52:55], v202, s[16:19], 0 offen offset:192
  buffer_load_dwordx4 v[32:35], v201, s[16:19], 0 offen offset:256
  buffer_load_dwordx4 v[56:59], v202, s[16:19], 0 offen offset:256
  buffer_load_dwordx4 v[36:39], v201, s[16:19], 0 offen offset:320
  buffer_load_dwordx4 v[60:63], v202, s[16:19], 0 offen offset:320
  s_branch M_b0
M_mw:
  s_barrier
  s_cmp_eq_u32 s40, 0
  s_cbranch_scc1 M_nox
  buffer_load_dwordx4 v[16:19], v201, s[16:19], 0 offen offset:0
  buffer_load_dwordx4 v[40:43], v202, s[16:19], 0 offen offset:0
  buffer_load_dwordx4 v[20:23], v201, s[16:19], 0 offen offset:64
  buffer_load_dwordx4 v[44:47], v202, s[16:19], 0 offen offset:64
  buffer_load_dwordx4 v[24:27], v201, s[16:19], 0 offen offset:128
  buffer_load_dwordx4 v[48:51], v202, s[16:19], 0 offen offset:128
  buffer_load_dwordx4 v[28:31], v201, s[16:19], 0 offen offset:192
  buffer_load_dwordx4 v[52:55], v202, s[16:19], 0 offen offset:192
  buffer_load_dwordx4 v[32:35], v201, s[16:19], 0 offen offset:256
  buffer_load_dwordx4 v[56:59], v202, s[16:19], 0 offen offset:256
  buffer_load_dwordx4 v[36:39], v201, s[16:19], 0 offen offset:320
  buffer_load_dwordx4 v[60:63], v202, s[16:19], 0 offen offset:320
  s_waitcnt vmcnt(12)
  s_branch M_nox2
M_nox:
  s_waitcnt vmcnt(0)
M_nox2:
  ds_read_b128 v[64:67], v184 offset:0
  ds_read_b128 v[68:71], v184 offset:1024
  ds_read_b128 v[72:75], v184 offset:2048
  ds_read_b128 v[76:79], v184 offset:3072
  ds_read_b128 v[80:83], v184 offset:4096
  ds_read_b128 v[84:87], v184 offset:5120
  ds_read_b128 v[88:91], v184 offset:6144
  ds_read_b128 v[92:95], v184 offset:7168
  ds_read_b128 v[96:99], v184 offset:8192
  ds_read_b128 v[100:103], v184 offset:9216
  ds_read_b128 v[104:107], v184 offset:10240
  ds_read_b128 v[108:111], v184 offset:11264
  ds_read_b128 v[112:115], v184 offset:12288
  ds_read_b128 v[116:119], v184 offset:13312
  s_waitcnt lgkmcnt(8)
  ds_read_b128 v[120:123], v184 offset:14336
  ds_read_b128 v[124:127], v184 offset:15360
  ds_read_b128 v[128:131], v184 offset:16384
  ds_read_b128 v[132:135], v184 offset:17408
  s_waitcnt lgkmcnt(0)
  s_barrier
  ds_read_b128 v[200:203], v195 offset:0
  ds_read_b128 v[204:207], v195 offset:6144
  ds_read_b128 v[208:211], v195 offset:1024
  ds_read_b128 v[212:215], v195 offset:7168
  ds_read_b128 v[216:219], v195 offset:2048
  ds_read_b128 v[220:223], v195 offset:8192
  s_waitcnt lgkmcnt(5)
  v_mfma_f32_16x16x32_bf16 v[136:139], v[200:203], v[64:67], 0
  ds_read_b128 v[224:227], v195 offset:3072
  v_mfma_f32_16x16x32_bf16 v[144:147], v[200:203], v[88:91], 0
  v_mfma_f32_16x16x32_bf16 v[152:155], v[200:203], v[112:115], 0
  s_waitcnt lgkmcnt(5)
  v_mfma_f32_16x16x32_bf16 v[140:143], v[204:207], v[64:67], 0
  ds_read_b128 v[228:231], v195 offset:9216
  v_mfma_f32_16x16x32_bf16 v[148:151], v[204:207], v[88:91], 0
  v_mfma_f32_16x16x32_bf16 v[156:159], v[204:207], v[112:115], 0
  s_waitcnt lgkmcnt(5)
  v_mfma_f32_16x16x32_bf16 v[136:139], v[208:211], v[68:71], v[136:139]
  ds_read_b128 v[200:203], v195 offset:4096
  v_mfma_f32_16x16x32_bf16 v[144:147], v[208:211], v[92:95], v[144:147]
  v_mfma_f32_16x16x32_bf16 v[152:155], v[208:211], v[116:119], v[152:155]
  s_waitcnt lgkmcnt(5)
  v_mfma_f32_16x16x32_bf16 v[140:143], v[212:215], v[68:71], v[140:143]
  ds_read_b128 v[204:207], v195 offset:10240
  v_mfma_f32_16x16x32_bf16 v[148:151], v[212:215], v[92:95], v[148:151]
  v_mfma_f32_16x16x32_bf16 v[156:159], v[212:215], v[116:119], v[156:159]
  s_waitcnt lgkmcnt(5)
  v_mfma_f32_16x16x32_bf16 v[136:139], v[216:219], v[72:75], v[136:139]
  ds_read_b128 v[208:211], v195 offset:5120
  v_mfma_f32_16x16x32_bf16 v[144:147], v[216:219], v[96:99], v[144:147]
  v_mfma_f32_16x16x32_bf16 v[152:155], v[216:219], v[120:123], v[152:155]
  s_waitcnt lgkmcnt(5)
  v_mfma_f32_16x16x32_bf16 v[140:143], v[220:223], v[72:75], v[140:143]
  ds_read_b128 v[212:215], v195 offset:11264
  v_mfma_f32_16x16x32_bf16 v[148:151], v[220:223], v[96:99], v[148:151]
  v_mfma_f32_16x16x32_bf16 v[156:159], v[220:223], v[120:123], v[156:159]
  s_waitcnt lgkmcnt(5)
  v_mfma_f32_16x16x32_bf16 v[136:139], v[224:227], v[76:79], v[136:139]
  ds_read_b128 v[216:219], v195 offset:12288
  v_mfma_f32_16x16x32_bf16 v[144:147], v[224:227], v[100:103], v[144:147]
  v_mfma_f32_16x16x32_bf16 v[152:155], v[224:227], v[124:127], v[152:155]
  s_waitcnt lgkmcnt(5)
  v_mfma_f32_16x16x32_bf16 v[140:143], v[228:231], v[76:79], v[140:143]
  ds_read_b128 v[220:223], v195 offset:18432
  v_mfma_f32_16x16x32_bf16 v[148:151], v[228:231], v[100:103], v[148:151]
  v_mfma_f32_16x16x32_bf16 v[156:159], v[228:231], v[124:127], v[156:159]
  s_waitcnt lgkmcnt(5)
  v_mfma_f32_16x16x32_bf16 v[136:139], v[200:203], v[80:83], v[136:139]
  ds_read_b128 v[224:227], v195 offset:13312
  v_mfma_f32_16x16x32_bf16 v[144:147], v[200:203], v[104:107], v[144:147]
  v_mfma_f32_16x16x32_bf16 v[152:155], v[200:203], v[128:131], v[152:155]
  s_waitcnt lgkmcnt(5)
  v_mfma_f32_16x16x32_bf16 v[140:143], v[204:207], v[80:83], v[140:143]
  ds_read_b128 v[228:231], v195 offset:19456
  v_mfma_f32_16x16x32_bf16 v[148:151], v[204:207], v[104:107], v[148:151]
  v_mfma_f32_16x16x32_bf16 v[156:159], v[204:207], v[128:131], v[156:159]
  s_waitcnt lgkmcnt(5)
  v_mfma_f32_16x16x32_bf16 v[136:139], v[208:211], v[84:87], v[136:139]
  ds_read_b128 v[200:203], v195 offset:14336
  v_mfma_f32_16x16x32_bf16 v[144:147], v[208:211], v[108:111], v[144:147]
  v_mfma_f32_16x16x32_bf16 v[152:155], v[208:211], v[132:135], v[152:155]
  s_waitcnt lgkmcnt(5)
  v_mfma_f32_16x16x32_bf16 v[140:143], v[212:215], v[84:87], v[140:143]
  ds_read_b128 v[204:207], v195 offset:20480
  v_mfma_f32_16x16x32_bf16 v[148:151], v[212:215], v[108:111], v[148:151]
  v_mfma_f32_16x16x32_bf16 v[156:159], v[212:215], v[132:135], v[156:159]
  s_waitcnt lgkmcnt(5)
  v_mfma_f32_16x16x32_bf16 v[160:163], v[216:219], v[64:67], 0
  ds_read_b128 v[208:211], v195 offset:15360
  v_mfma_f32_16x16x32_bf16 v[168:171], v[216:219], v[88:91], 0
  v_mfma_f32_16x16x32_bf16 v[176:179], v[216:219], v[112:115], 0
  s_waitcnt lgkmcnt(5)
  v_mfma_f32_16x16x32_bf16 v[164:167], v[220:223], v[64:67], 0
  ds_read_b128 v[212:215], v195 offset:21504
  v_cvt_pk_bf16_f32 v184, v136, v137
  v_mfma_f32_16x16x32_bf16 v[172:175], v[220:223], v[88:91], 0
  v_cvt_pk_bf16_f32 v185, v138, v139
  v_cvt_pk_bf16_f32 v186, v140, v141
  v_mfma_f32_16x16x32_bf16 v[180:183], v[220:223], v[112:115], 0
  s_waitcnt lgkmcnt(5)
  v_cvt_pk_bf16_f32 v187, v142, v143
  v_mfma_f32_16x16x32_bf16 v[160:163], v[224:227], v[68:71], v[160:163]
  ds_read_b128 v[216:219], v195 offset:16384
  v_mfma_f32_16x16x32_bf16 v[168:171], v[224:227], v[92:95], v[168:171]
  ds_write_b128 v192, v[184:187] offset:0
  v_mfma_f32_16x16x32_bf16 v[176:179], v[224:227], v[116:119], v[176:179]
  s_waitcnt lgkmcnt(6)
  v_mfma_f32_16x16x32_bf16 v[164:167], v[228:231], v[68:71], v[164:167]
  ds_read_b128 v[220:223], v195 offset:22528
  v_cvt_pk_bf16_f32 v188, v144, v145
  v_mfma_f32_16x16x32_bf16 v[172:175], v[228:231], v[92:95], v[172:175]
  v_cvt_pk_bf16_f32 v189, v146, v147
  v_cvt_pk_bf16_f32 v190, v148, v149
  v_mfma_f32_16x16x32_bf16 v[180:183], v[228:231], v[116:119], v[180:183]
  s_waitcnt lgkmcnt(6)
  v_cvt_pk_bf16_f32 v191, v150, v151
  v_mfma_f32_16x16x32_bf16 v[160:163], v[200:203], v[72:75], v[160:163]
  ds_read_b128 v[224:227], v195 offset:17408
  v_mfma_f32_16x16x32_bf16 v[168:171], v[200:203], v[96:99], v[168:171]
  ds_write_b128 v193, v[188:191] offset:0
  v_mfma_f32_16x16x32_bf16 v[176:179], v[200:203], v[120:123], v[176:179]
  s_waitcnt lgkmcnt(7)
  v_mfma_f32_16x16x32_bf16 v[164:167], v[204:207], v[72:75], v[164:167]
  ds_read_b128 v[228:231], v195 offset:23552
  v_cvt_pk_bf16_f32 v184, v152, v153
  v_mfma_f32_16x16x32_bf16 v[172:175], v[204:207], v[96:99], v[172:175]
  v_cvt_pk_bf16_f32 v185, v154, v155
  v_cvt_pk_bf16_f32 v186, v156, v157
  v_mfma_f32_16x16x32_bf16 v[180:183], v[204:207], v[120:123], v[180:183]
  s_waitcnt lgkmcnt(7)
  v_cvt_pk_bf16_f32 v187, v158, v159
  v_mfma_f32_16x16x32_bf16 v[160:163], v[208:211], v[76:79], v[160:163]
  ds_read_b128 v[200:203], v195 offset:24576
  v_mfma_f32_16x16x32_bf16 v[168:171], v[208:211], v[100:103], v[168:171]
  ds_write_b128 v194, v[184:187] offset:0
  v_mfma_f32_16x16x32_bf16 v[176:179], v[208:211], v[124:127], v[176:179]
  s_waitcnt lgkmcnt(8)
  v_mfma_f32_16x16x32_bf16 v[164:167], v[212:215], v[76:79], v[164:167]
  ds_read_b128 v[204:207], v195 offset:30720
  v_mfma_f32_16x16x32_bf16 v[172:175], v[212:215], v[100:103], v[172:175]
  v_mfma_f32_16x16x32_bf16 v[180:183], v[212:215], v[124:127], v[180:183]
  s_waitcnt lgkmcnt(8)
  v_mfma_f32_16x16x32_bf16 v[160:163], v[216:219], v[80:83], v[160:163]
  ds_read_b128 v[208:211], v195 offset:25600
  v_mfma_f32_16x16x32_bf16 v[168:171], v[216:219], v[104:107], v[168:171]
  v_mfma_f32_16x16x32_bf16 v[176:179], v[216:219], v[128:131], v[176:179]
  s_waitcnt lgkmcnt(7)
  v_mfma_f32_16x16x32_bf16 v[164:167], v[220:223], v[80:83], v[164:167]
  ds_read_b128 v[212:215], v195 offset:31744
  v_mfma_f32_16x16x32_bf16 v[172:175], v[220:223], v[104:107], v[172:175]
  v_mfma_f32_16x16x32_bf16 v[180:183], v[220:223], v[128:131], v[180:183]
  s_waitcnt lgkmcnt(7)
  v_mfma_f32_16x16x32_bf16 v[160:163], v[224:227], v[84:87], v[160:163]
  ds_read_b128 v[216:219], v195 offset:26624
  v_mfma_f32_16x16x32_bf16 v[168:171], v[224:227], v[108:111], v[168:171]
  v_mfma_f32_16x16x32_bf16 v[176:179], v[224:227], v[132:135], v[176:179]
  s_waitcnt lgkmcnt(6)
  v_mfma_f32_16x16x32_bf16 v[164:167], v[228:231], v[84:87], v[164:167]
  ds_read_b128 v[220:223], v195 offset:32768
  v_mfma_f32_16x16x32_bf16 v[172:175], v[228:231], v[108:111], v[172:175]
  v_mfma_f32_16x16x32_bf16 v[180:183], v[228:231], v[132:135], v[180:183]
  s_waitcnt lgkmcnt(6)
  v_mfma_f32_16x16x32_bf16 v[136:139], v[200:203], v[64:67], 0
  ds_read_b128 v[224:227], v195 offset:27648
  v_mfma_f32_16x16x32_bf16 v[144:147], v[200:203], v[88:91], 0
  v_mfma_f32_16x16x32_bf16 v[152:155], v[200:203], v[112:115], 0
  s_waitcnt lgkmcnt(5)
  v_mfma_f32_16x16x32_bf16 v[140:143], v[204:207], v[64:67], 0
  ds_read_b128 v[228:231], v195 offset:33792
  v_cvt_pk_bf16_f32 v184, v160, v161
  v_mfma_f32_16x16x32_bf16 v[148:151], v[204:207], v[88:91], 0
  v_cvt_pk_bf16_f32 v185, v162, v163
  v_cvt_pk_bf16_f32 v186, v164, v165
  v_mfma_f32_16x16x32_bf16 v[156:159], v[204:207], v[112:115], 0
  s_waitcnt lgkmcnt(5)
  v_cvt_pk_bf16_f32 v187, v166, v167
  v_mfma_f32_16x16x32_bf16 v[136:139], v[208:211], v[68:71], v[136:139]
  ds_read_b128 v[200:203], v195 offset:28672
  v_mfma_f32_16x16x32_bf16 v[144:147], v[208:211], v[92:95], v[144:147]
  ds_write_b128 v192, v[184:187] offset:2048
  v_mfma_f32_16x16x32_bf16 v[152:155], v[208:211], v[116:119], v[152:155]
  s_waitcnt lgkmcnt(6)
  v_mfma_f32_16x16x32_bf16 v[140:143], v[212:215], v[68:71], v[140:143]
  ds_read_b128 v[204:207], v195 offset:34816
  v_cvt_pk_bf16_f32 v188, v168, v169
  v_mfma_f32_16x16x32_bf16 v[148:151], v[212:215], v[92:95], v[148:151]
  v_cvt_pk_bf16_f32 v189, v170, v171
  v_cvt_pk_bf16_f32 v190, v172, v173
  v_mfma_f32_16x16x32_bf16 v[156:159], v[212:215], v[116:119], v[156:159]
  s_waitcnt lgkmcnt(6)
  v_cvt_pk_bf16_f32 v191, v174, v175
  v_mfma_f32_16x16x32_bf16 v[136:139], v[216:219], v[72:75], v[136:139]
  ds_read_b128 v[208:211], v195 offset:29696
  v_mfma_f32_16x16x32_bf16 v[144:147], v[216:219], v[96:99], v[144:147]
  ds_write_b128 v193, v[188:191] offset:2048
  v_mfma_f32_16x16x32_bf16 v[152:155], v[216:219], v[120:123], v[152:155]
  s_waitcnt lgkmcnt(7)
  v_mfma_f32_16x16x32_bf16 v[140:143], v[220:223], v[72:75], v[140:143]
  ds_read_b128 v[212:215], v195 offset:35840
  v_cvt_pk_bf16_f32 v184, v176, v177
  v_mfma_f32_16x16x32_bf16 v[148:151], v[220:223], v[96:99], v[148:151]
  v_cvt_pk_bf16_f32 v185, v178, v179
  v_cvt_pk_bf16_f32 v186, v180, v181
  v_mfma_f32_16x16x32_bf16 v[156:159], v[220:223], v[120:123], v[156:159]
  s_waitcnt lgkmcnt(7)
  v_cvt_pk_bf16_f32 v187, v182, v183
  v_mfma_f32_16x16x32_bf16 v[136:139], v[224:227], v[76:79], v[136:139]
  ds_read_b128 v[216:219], v196 offset:0
  v_mfma_f32_16x16x32_bf16 v[144:147], v[224:227], v[100:103], v[144:147]
  ds_write_b128 v194, v[184:187] offset:2048
  v_mfma_f32_16x16x32_bf16 v[152:155], v[224:227], v[124:127], v[152:155]
  s_waitcnt lgkmcnt(8)
  v_mfma_f32_16x16x32_bf16 v[140:143], v[228:231], v[76:79], v[140:143]
  ds_read_b128 v[220:223], v196 offset:6144
  v_mfma_f32_16x16x32_bf16 v[148:151], v[228:231], v[100:103], v[148:151]
  v_mfma_f32_16x16x32_bf16 v[156:159], v[228:231], v[124:127], v[156:159]
  s_waitcnt lgkmcnt(8)
  v_mfma_f32_16x16x32_bf16 v[136:139], v[200:203], v[80:83], v[136:139]
  ds_read_b128 v[224:227], v196 offset:1024
  v_mfma_f32_16x16x32_bf16 v[144:147], v[200:203], v[104:107], v[144:147]
  v_mfma_f32_16x16x32_bf16 v[152:155], v[200:203], v[128:131], v[152:155]
  s_waitcnt lgkmcnt(7)
  v_mfma_f32_16x16x32_bf16 v[140:143], v[204:207], v[80:83], v[140:143]
  ds_read_b128 v[228:231], v196 offset:7168
  v_mfma_f32_16x16x32_bf16 v[148:151], v[204:207], v[104:107], v[148:151]
  v_mfma_f32_16x16x32_bf16 v[156:159], v[204:207], v[128:131], v[156:159]
  s_waitcnt lgkmcnt(7)
  v_mfma_f32_16x16x32_bf16 v[136:139], v[208:211], v[84:87], v[136:139]
  ds_read_b128 v[200:203], v196 offset:2048
  v_mfma_f32_16x16x32_bf16 v[144:147], v[208:211], v[108:111], v[144:147]
  v_mfma_f32_16x16x32_bf16 v[152:155], v[208:211], v[132:135], v[152:155]
  s_waitcnt lgkmcnt(6)
  v_mfma_f32_16x16x32_bf16 v[140:143], v[212:215], v[84:87], v[140:143]
  ds_read_b128 v[204:207], v196 offset:8192
  v_mfma_f32_16x16x32_bf16 v[148:151], v[212:215], v[108:111], v[148:151]
  v_mfma_f32_16x16x32_bf16 v[156:159], v[212:215], v[132:135], v[156:159]
  s_waitcnt lgkmcnt(6)
  v_mfma_f32_16x16x32_bf16 v[160:163], v[216:219], v[64:67], 0
  ds_read_b128 v[208:211], v196 offset:3072
  v_mfma_f32_16x16x32_bf16 v[168:171], v[216:219], v[88:91], 0
  v_mfma_f32_16x16x32_bf16 v[176:179], v[216:219], v[112:115], 0
  s_waitcnt lgkmcnt(5)
  v_mfma_f32_16x16x32_bf16 v[164:167], v[220:223], v[64:67], 0
  ds_read_b128 v[212:215], v196 offset:9216
  v_cvt_pk_bf16_f32 v184, v136, v137
  v_mfma_f32_16x16x32_bf16 v[172:175], v[220:223], v[88:91], 0
  v_cvt_pk_bf16_f32 v185, v138, v139
  v_cvt_pk_bf16_f32 v186, v140, v141
  v_mfma_f32_16x16x32_bf16 v[180:183], v[220:223], v[112:115], 0
  s_waitcnt lgkmcnt(5)
  v_cvt_pk_bf16_f32 v187, v142, v143
  v_mfma_f32_16x16x32_bf16 v[160:163], v[224:227], v[68:71], v[160:163]
  ds_read_b128 v[216:219], v196 offset:4096
  v_mfma_f32_16x16x32_bf16 v[168:171], v[224:227], v[92:95], v[168:171]
  ds_write_b128 v192, v[184:187] offset:4096
  v_mfma_f32_16x16x32_bf16 v[176:179], v[224:227], v[116:119], v[176:179]
  s_waitcnt lgkmcnt(6)
  v_mfma_f32_16x16x32_bf16 v[164:167], v[228:231], v[68:71], v[164:167]
  ds_read_b128 v[220:223], v196 offset:10240
  v_cvt_pk_bf16_f32 v188, v144, v145
  v_mfma_f32_16x16x32_bf16 v[172:175], v[228:231], v[92:95], v[172:175]
  v_cvt_pk_bf16_f32 v189, v146, v147
  v_cvt_pk_bf16_f32 v190, v148, v149
  v_mfma_f32_16x16x32_bf16 v[180:183], v[228:231], v[116:119], v[180:183]
  s_waitcnt lgkmcnt(6)
  v_cvt_pk_bf16_f32 v191, v150, v151
  v_mfma_f32_16x16x32_bf16 v[160:163], v[200:203], v[72:75], v[160:163]
  ds_read_b128 v[224:227], v196 offset:5120
  v_mfma_f32_16x16x32_bf16 v[168:171], v[200:203], v[96:99], v[168:171]
  ds_write_b128 v193, v[188:191] offset:4096
  v_mfma_f32_16x16x32_bf16 v[176:179], v[200:203], v[120:123], v[176:179]
  s_waitcnt lgkmcnt(7)
  v_mfma_f32_16x16x32_bf16 v[164:167], v[204:207], v[72:75], v[164:167]
  ds_read_b128 v[228:231], v196 offset:11264
  v_cvt_pk_bf16_f32 v184, v152, v153
  v_mfma_f32_16x16x32_bf16 v[172:175], v[204:207], v[96:99], v[172:175]
  v_cvt_pk_bf16_f32 v185, v154, v155
  v_cvt_pk_bf16_f32 v186, v156, v157
  v_mfma_f32_16x16x32_bf16 v[180:183], v[204:207], v[120:123], v[180:183]
  s_waitcnt lgkmcnt(7)
  v_cvt_pk_bf16_f32 v187, v158, v159
  v_mfma_f32_16x16x32_bf16 v[160:163], v[208:211], v[76:79], v[160:163]
  ds_read_b128 v[200:203], v196 offset:12288
  v_mfma_f32_16x16x32_bf16 v[168:171], v[208:211], v[100:103], v[168:171]
  ds_write_b128 v194, v[184:187] offset:4096
  v_mfma_f32_16x16x32_bf16 v[176:179], v[208:211], v[124:127], v[176:179]
  s_waitcnt lgkmcnt(8)
  v_mfma_f32_16x16x32_bf16 v[164:167], v[212:215], v[76:79], v[164:167]
  ds_read_b128 v[204:207], v196 offset:18432
  v_mfma_f32_16x16x32_bf16 v[172:175], v[212:215], v[100:103], v[172:175]
  v_mfma_f32_16x16x32_bf16 v[180:183], v[212:215], v[124:127], v[180:183]
  s_waitcnt lgkmcnt(8)
  v_mfma_f32_16x16x32_bf16 v[160:163], v[216:219], v[80:83], v[160:163]
  ds_read_b128 v[208:211], v196 offset:13312
  v_mfma_f32_16x16x32_bf16 v[168:171], v[216:219], v[104:107], v[168:171]
  v_mfma_f32_16x16x32_bf16 v[176:179], v[216:219], v[128:131], v[176:179]
  s_waitcnt lgkmcnt(7)
  v_mfma_f32_16x16x32_bf16 v[164:167], v[220:223], v[80:83], v[164:167]
  ds_read_b128 v[212:215], v196 offset:19456
  v_mfma_f32_16x16x32_bf16 v[172:175], v[220:223], v[104:107], v[172:175]
  v_mfma_f32_16x16x32_bf16 v[180:183], v[220:223], v[128:131], v[180:183]
  s_waitcnt lgkmcnt(7)
  v_mfma_f32_16x16x32_bf16 v[160:163], v[224:227], v[84:87], v[160:163]
  ds_read_b128 v[216:219], v196 offset:14336
  v_mfma_f32_16x16x32_bf16 v[168:171], v[224:227], v[108:111], v[168:171]
  v_mfma_f32_16x16x32_bf16 v[176:179], v[224:227], v[132:135], v[176:179]
  s_waitcnt lgkmcnt(6)
  v_mfma_f32_16x16x32_bf16 v[164:167], v[228:231], v[84:87], v[164:167]
  ds_read_b128 v[220:223], v196 offset:20480
  v_mfma_f32_16x16x32_bf16 v[172:175], v[228:231], v[108:111], v[172:175]
  v_mfma_f32_16x16x32_bf16 v[180:183], v[228:231], v[132:135], v[180:183]
  s_waitcnt lgkmcnt(6)
  v_mfma_f32_16x16x32_bf16 v[136:139], v[200:203], v[64:67], 0
  ds_read_b128 v[224:227], v196 offset:15360
  v_mfma_f32_16x16x32_bf16 v[144:147], v[200:203], v[88:91], 0
  v_mfma_f32_16x16x32_bf16 v[152:155], v[200:203], v[112:115], 0
  s_waitcnt lgkmcnt(5)
  v_mfma_f32_16x16x32_bf16 v[140:143], v[204:207], v[64:67], 0
  ds_read_b128 v[228:231], v196 offset:21504
  v_cvt_pk_bf16_f32 v184, v160, v161
  v_mfma_f32_16x16x32_bf16 v[148:151], v[204:207], v[88:91], 0
  v_cvt_pk_bf16_f32 v185, v162, v163
  v_cvt_pk_bf16_f32 v186, v164, v165
  v_mfma_f32_16x16x32_bf16 v[156:159], v[204:207], v[112:115], 0
  s_waitcnt lgkmcnt(5)
  v_cvt_pk_bf16_f32 v187, v166, v167
  v_mfma_f32_16x16x32_bf16 v[136:139], v[208:211], v[68:71], v[136:139]
  ds_read_b128 v[200:203], v196 offset:16384
  v_mfma_f32_16x16x32_bf16 v[144:147], v[208:211], v[92:95], v[144:147]
  ds_write_b128 v192, v[184:187] offset:6144
  v_mfma_f32_16x16x32_bf16 v[152:155], v[208:211], v[116:119], v[152:155]
  s_waitcnt lgkmcnt(6)
  v_mfma_f32_16x16x32_bf16 v[140:143], v[212:215], v[68:71], v[140:143]
  ds_read_b128 v[204:207], v196 offset:22528
  v_cvt_pk_bf16_f32 v188, v168, v169
  v_mfma_f32_16x16x32_bf16 v[148:151], v[212:215], v[92:95], v[148:151]
  v_cvt_pk_bf16_f32 v189, v170, v171
  v_cvt_pk_bf16_f32 v190, v172, v173
  v_mfma_f32_16x16x32_bf16 v[156:159], v[212:215], v[116:119], v[156:159]
  s_waitcnt lgkmcnt(6)
  v_cvt_pk_bf16_f32 v191, v174, v175
  v_mfma_f32_16x16x32_bf16 v[136:139], v[216:219], v[72:75], v[136:139]
  ds_read_b128 v[208:211], v196 offset:17408
  v_mfma_f32_16x16x32_bf16 v[144:147], v[216:219], v[96:99], v[144:147]
  ds_write_b128 v193, v[188:191] offset:6144
  v_mfma_f32_16x16x32_bf16 v[152:155], v[216:219], v[120:123], v[152:155]
  s_waitcnt lgkmcnt(7)
  v_mfma_f32_16x16x32_bf16 v[140:143], v[220:223], v[72:75], v[140:143]
  ds_read_b128 v[212:215], v196 offset:23552
  v_cvt_pk_bf16_f32 v184, v176, v177
  v_mfma_f32_16x16x32_bf16 v[148:151], v[220:223], v[96:99], v[148:151]
  v_cvt_pk_bf16_f32 v185, v178, v179
  v_cvt_pk_bf16_f32 v186, v180, v181
  v_mfma_f32_16x16x32_bf16 v[156:159], v[220:223], v[120:123], v[156:159]
  s_waitcnt lgkmcnt(7)
  v_cvt_pk_bf16_f32 v187, v182, v183
  v_mfma_f32_16x16x32_bf16 v[136:139], v[224:227], v[76:79], v[136:139]
  ds_read_b128 v[216:219], v196 offset:24576
  v_mfma_f32_16x16x32_bf16 v[144:147], v[224:227], v[100:103], v[144:147]
  ds_write_b128 v194, v[184:187] offset:6144
  v_mfma_f32_16x16x32_bf16 v[152:155], v[224:227], v[124:127], v[152:155]
  s_waitcnt lgkmcnt(8)
  v_mfma_f32_16x16x32_bf16 v[140:143], v[228:231], v[76:79], v[140:143]
  ds_read_b128 v[220:223], v196 offset:30720
  v_mfma_f32_16x16x32_bf16 v[148:151], v[228:231], v[100:103], v[148:151]
  v_mfma_f32_16x16x32_bf16 v[156:159], v[228:231], v[124:127], v[156:159]
  s_waitcnt lgkmcnt(8)
  v_mfma_f32_16x16x32_bf16 v[136:139], v[200:203], v[80:83], v[136:139]
  ds_read_b128 v[224:227], v196 offset:25600
  v_mfma_f32_16x16x32_bf16 v[144:147], v[200:203], v[104:107], v[144:147]
  v_mfma_f32_16x16x32_bf16 v[152:155], v[200:203], v[128:131], v[152:155]
  s_waitcnt lgkmcnt(7)
  v_mfma_f32_16x16x32_bf16 v[140:143], v[204:207], v[80:83], v[140:143]
  ds_read_b128 v[228:231], v196 offset:31744
  v_mfma_f32_16x16x32_bf16 v[148:151], v[204:207], v[104:107], v[148:151]
  v_mfma_f32_16x16x32_bf16 v[156:159], v[204:207], v[128:131], v[156:159]
  s_waitcnt lgkmcnt(7)
  v_mfma_f32_16x16x32_bf16 v[136:139], v[208:211], v[84:87], v[136:139]
  ds_read_b128 v[200:203], v196 offset:26624
  v_mfma_f32_16x16x32_bf16 v[144:147], v[208:211], v[108:111], v[144:147]
  v_mfma_f32_16x16x32_bf16 v[152:155], v[208:211], v[132:135], v[152:155]
  s_waitcnt lgkmcnt(6)
  v_mfma_f32_16x16x32_bf16 v[140:143], v[212:215], v[84:87], v[140:143]
  ds_read_b128 v[204:207], v196 offset:32768
  v_mfma_f32_16x16x32_bf16 v[148:151], v[212:215], v[108:111], v[148:151]
  v_mfma_f32_16x16x32_bf16 v[156:159], v[212:215], v[132:135], v[156:159]
  s_waitcnt lgkmcnt(6)
  v_mfma_f32_16x16x32_bf16 v[160:163], v[216:219], v[64:67], 0
  ds_read_b128 v[208:211], v196 offset:27648
  v_mfma_f32_16x16x32_bf16 v[168:171], v[216:219], v[88:91], 0
  v_mfma_f32_16x16x32_bf16 v[176:179], v[216:219], v[112:115], 0
  s_waitcnt lgkmcnt(5)
  v_mfma_f32_16x16x32_bf16 v[164:167], v[220:223], v[64:67], 0
  ds_read_b128 v[212:215], v196 offset:33792
  v_cvt_pk_bf16_f32 v184, v136, v137
  v_mfma_f32_16x16x32_bf16 v[172:175], v[220:223], v[88:91], 0
  v_cvt_pk_bf16_f32 v185, v138, v139
  v_cvt_pk_bf16_f32 v186, v140, v141
  v_mfma_f32_16x16x32_bf16 v[180:183], v[220:223], v[112:115], 0
  s_waitcnt lgkmcnt(5)
  v_cvt_pk_bf16_f32 v187, v142, v143
  v_mfma_f32_16x16x32_bf16 v[160:163], v[224:227], v[68:71], v[160:163]
  ds_read_b128 v[216:219], v196 offset:28672
  v_mfma_f32_16x16x32_bf16 v[168:171], v[224:227], v[92:95], v[168:171]
  ds_write_b128 v192, v[184:187] offset:8192
  v_mfma_f32_16x16x32_bf16 v[176:179], v[224:227], v[116:119], v[176:179]
  s_waitcnt lgkmcnt(6)
  v_mfma_f32_16x16x32_bf16 v[164:167], v[228:231], v[68:71], v[164:167]
  ds_read_b128 v[220:223], v196 offset:34816
  v_cvt_pk_bf16_f32 v188, v144, v145
  v_mfma_f32_16x16x32_bf16 v[172:175], v[228:231], v[92:95], v[172:175]
  v_cvt_pk_bf16_f32 v189, v146, v147
  v_cvt_pk_bf16_f32 v190, v148, v149
  v_mfma_f32_16x16x32_bf16 v[180:183], v[228:231], v[116:119], v[180:183]
  s_waitcnt lgkmcnt(6)
  v_cvt_pk_bf16_f32 v191, v150, v151
  v_mfma_f32_16x16x32_bf16 v[160:163], v[200:203], v[72:75], v[160:163]
  ds_read_b128 v[224:227], v196 offset:29696
  v_mfma_f32_16x16x32_bf16 v[168:171], v[200:203], v[96:99], v[168:171]
  ds_write_b128 v193, v[188:191] offset:8192
  v_mfma_f32_16x16x32_bf16 v[176:179], v[200:203], v[120:123], v[176:179]
  s_waitcnt lgkmcnt(7)
  v_mfma_f32_16x16x32_bf16 v[164:167], v[204:207], v[72:75], v[164:167]
  ds_read_b128 v[228:231], v196 offset:35840
  v_cvt_pk_bf16_f32 v184, v152, v153
  v_mfma_f32_16x16x32_bf16 v[172:175], v[204:207], v[96:99], v[172:175]
  v_cvt_pk_bf16_f32 v185, v154, v155
  v_cvt_pk_bf16_f32 v186, v156, v157
  v_mfma_f32_16x16x32_bf16 v[180:183], v[204:207], v[120:123], v[180:183]
  s_waitcnt lgkmcnt(7)
  v_cvt_pk_bf16_f32 v187, v158, v159
  v_mfma_f32_16x16x32_bf16 v[160:163], v[208:211], v[76:79], v[160:163]
  v_mfma_f32_16x16x32_bf16 v[168:171], v[208:211], v[100:103], v[168:171]
  ds_write_b128 v194, v[184:187] offset:8192
  v_mfma_f32_16x16x32_bf16 v[176:179], v[208:211], v[124:127], v[176:179]
  s_waitcnt lgkmcnt(7)
  v_mfma_f32_16x16x32_bf16 v[164:167], v[212:215], v[76:79], v[164:167]
  v_mfma_f32_16x16x32_bf16 v[172:175], v[212:215], v[100:103], v[172:175]
  v_mfma_f32_16x16x32_bf16 v[180:183], v[212:215], v[124:127], v[180:183]
  s_waitcnt lgkmcnt(6)
  v_mfma_f32_16x16x32_bf16 v[160:163], v[216:219], v[80:83], v[160:163]
  v_mfma_f32_16x16x32_bf16 v[168:171], v[216:219], v[104:107], v[168:171]
  v_mfma_f32_16x16x32_bf16 v[176:179], v[216:219], v[128:131], v[176:179]
  s_waitcnt lgkmcnt(4)
  v_mfma_f32_16x16x32_bf16 v[164:167], v[220:223], v[80:83], v[164:167]
  v_mfma_f32_16x16x32_bf16 v[172:175], v[220:223], v[104:107], v[172:175]
  v_mfma_f32_16x16x32_bf16 v[180:183], v[220:223], v[128:131], v[180:183]
  s_waitcnt lgkmcnt(3)
  v_mfma_f32_16x16x32_bf16 v[160:163], v[224:227], v[84:87], v[160:163]
  v_mfma_f32_16x16x32_bf16 v[168:171], v[224:227], v[108:111], v[168:171]
  v_mfma_f32_16x16x32_bf16 v[176:179], v[224:227], v[132:135], v[176:179]
  s_waitcnt lgkmcnt(1)
  v_mfma_f32_16x16x32_bf16 v[164:167], v[228:231], v[84:87], v[164:167]
  v_mfma_f32_16x16x32_bf16 v[172:175], v[228:231], v[108:111], v[172:175]
  v_mfma_f32_16x16x32_bf16 v[180:183], v[228:231], v[132:135], v[180:183]
  s_nop 1
  v_cvt_pk_bf16_f32 v184, v160, v161
  v_cvt_pk_bf16_f32 v185, v162, v163
  s_nop 1
  v_cvt_pk_bf16_f32 v186, v164, v165
  v_cvt_pk_bf16_f32 v187, v166, v167
  ds_write_b128 v192, v[184:187] offset:10240
  v_cvt_pk_bf16_f32 v188, v168, v169
  v_cvt_pk_bf16_f32 v189, v170, v171
  v_cvt_pk_bf16_f32 v190, v172, v173
  v_cvt_pk_bf16_f32 v191, v174, v175
  ds_write_b128 v193, v[188:191] offset:10240
  v_cvt_pk_bf16_f32 v184, v176, v177
  v_cvt_pk_bf16_f32 v185, v178, v179
  v_cvt_pk_bf16_f32 v186, v180, v181
  v_cvt_pk_bf16_f32 v187, v182, v183
  ds_write_b128 v194, v[184:187] offset:10240
  s_waitcnt lgkmcnt(0)
M_b0:
  s_barrier
  s_cmp_eq_u32 s40, 0
  s_cbranch_scc1 M_helper
  s_waitcnt vmcnt(10)
  ds_write_b128 v255, v[16:19] offset:0
  ds_write_b128 v255, v[40:43] offset:1024
  ds_read_b128 v[16:19], v0 offset:0
  ds_read_b128 v[40:43], v0 offset:1024
  s_waitcnt vmcnt(8)
  ds_write_b128 v255, v[20:23] offset:0
  ds_write_b128 v255, v[44:47] offset:1024
  ds_read_b128 v[20:23], v0 offset:0
  ds_read_b128 v[44:47], v0 offset:1024
  s_add_u32 s56, s43, s53
  s_mov_b32 s57, 86016
  s_mov_b32 s58, 384
  ds_read_b128 v[200:203], v254 offset:0
  ds_read_b128 v[204:207], v254 offset:1024
  ds_read_b128 v[208:211], v254 offset:2048
  ds_read_b128 v[212:215], v254 offset:3072
  ds_read_b128 v[216:219], v254 offset:4096
  ds_read_b128 v[220:223], v254 offset:5120
  s_waitcnt lgkmcnt(5)
  v_mfma_f32_16x16x32_bf16 v[168:171], v[200:203], v[16:19], 0
  ds_read_b128 v[224:227], v254 offset:6144
  v_bfe_i32 v66, v14, 0, 1
  v_mfma_f32_16x16x32_bf16 v[176:179], v[200:203], v[40:43], 0
  s_waitcnt lgkmcnt(5)
  s_waitcnt vmcnt(6)
  ds_write_b128 v255, v[24:27] offset:0
  ds_write_b128 v255, v[48:51] offset:1024
  v_mfma_f32_16x16x32_bf16 v[172:175], v[204:207], v[16:19], 0
  ds_read_b128 v[228:231], v254 offset:7168
  v_and_b32 v65, s54, v66
  v_mfma_f32_16x16x32_bf16 v[180:183], v[204:207], v[40:43], 0
  s_waitcnt lgkmcnt(7)
  ds_read_b128 v[24:27], v0 offset:0
  ds_read_b128 v[48:51], v0 offset:1024
  v_mfma_f32_16x16x32_bf16 v[168:171], v[208:211], v[20:23], v[168:171]
  ds_read_b128 v[200:203], v254 offset:8192
  v_and_b32 v66, s54, v66
  v_mfma_f32_16x16x32_bf16 v[176:179], v[208:211], v[44:47], v[176:179]
  s_waitcnt lgkmcnt(9)
  s_waitcnt vmcnt(4)
  ds_write_b128 v255, v[28:31] offset:0
  ds_write_b128 v255, v[52:55] offset:1024
  v_mfma_f32_16x16x32_bf16 v[172:175], v[212:215], v[20:23], v[172:175]
  ds_read_b128 v[204:207], v254 offset:9216
  v_or_b32 v64, v65, v12
  v_mfma_f32_16x16x32_bf16 v[180:183], v[212:215], v[44:47], v[180:183]
  s_waitcnt lgkmcnt(5)
  ds_read_b128 v[28:31], v0 offset:0
  ds_read_b128 v[52:55], v0 offset:1024
  v_mfma_f32_16x16x32_bf16 v[168:171], v[216:219], v[24:27], v[168:171]
  s_waitcnt lgkmcnt(6)
  ds_read_b128 v[208:211], v254 offset:10240
  v_or_b32 v67, v65, v13
  v_mfma_f32_16x16x32_bf16 v[176:179], v[216:219], v[48:51], v[176:179]
  s_waitcnt vmcnt(2)
  ds_write_b128 v255, v[32:35] offset:0
  ds_write_b128 v255, v[56:59] offset:1024
  v_mfma_f32_16x16x32_bf16 v[172:175], v[220:223], v[24:27], v[172:175]
  ds_read_b128 v[212:215], v254 offset:11264
  v_bfe_i32 v70, v14, 2, 1
  v_mfma_f32_16x16x32_bf16 v[180:183], v[220:223], v[48:51], v[180:183]
  s_waitcnt lgkmcnt(5)
  ds_read_b128 v[32:35], v0 offset:0
  ds_read_b128 v[56:59], v0 offset:1024
  v_mfma_f32_16x16x32_bf16 v[168:171], v[224:227], v[28:31], v[168:171]
  s_waitcnt lgkmcnt(6)
  ds_read_b128 v[216:219], v254 offset:12288
  v_and_b32 v69, s54, v70
  v_mfma_f32_16x16x32_bf16 v[176:179], v[224:227], v[52:55], v[176:179]
  s_waitcnt vmcnt(0)
  ds_write_b128 v255, v[36:39] offset:0
  ds_write_b128 v255, v[60:63] offset:1024
  v_mfma_f32_16x16x32_bf16 v[172:175], v[228:231], v[28:31], v[172:175]
  ds_read_b128 v[220:223], v254 offset:13312
  v_and_b32 v70, s54, v70
  v_mfma_f32_16x16x32_bf16 v[180:183], v[228:231], v[52:55], v[180:183]
  s_waitcnt lgkmcnt(5)
  ds_read_b128 v[36:39], v0 offset:0
  ds_read_b128 v[60:63], v0 offset:1024
  v_mfma_f32_16x16x32_bf16 v[168:171], v[200:203], v[32:35], v[168:171]
  s_waitcnt lgkmcnt(6)
  ds_read_b128 v[224:227], v254 offset:14336
  v_or_b32 v68, v69, v12
  v_mfma_f32_16x16x32_bf16 v[176:179], v[200:203], v[56:59], v[176:179]
  v_or_b32 v71, v69, v13
  v_bfe_i32 v74, v14, 4, 1
  v_mfma_f32_16x16x32_bf16 v[172:175], v[204:207], v[32:35], v[172:175]
  ds_read_b128 v[228:231], v254 offset:15360
  v_and_b32 v73, s54, v74
  v_mfma_f32_16x16x32_bf16 v[180:183], v[204:207], v[56:59], v[180:183]
  s_waitcnt lgkmcnt(3)
  v_and_b32 v74, s54, v74
  v_or_b32 v72, v73, v12
  v_mfma_f32_16x16x32_bf16 v[168:171], v[208:211], v[36:39], v[168:171]
  s_waitcnt lgkmcnt(2)
  ds_read_b128 v[200:203], v254 offset:16384
  v_or_b32 v75, v73, v13
  v_mfma_f32_16x16x32_bf16 v[176:179], v[208:211], v[60:63], v[176:179]
  v_bfe_i32 v78, v14, 6, 1
  v_and_b32 v77, s54, v78
  v_mfma_f32_16x16x32_bf16 v[172:175], v[212:215], v[36:39], v[172:175]
  ds_read_b128 v[204:207], v254 offset:17408
  v_and_b32 v78, s54, v78
  v_mfma_f32_16x16x32_bf16 v[180:183], v[212:215], v[60:63], v[180:183]
  v_or_b32 v76, v77, v12
  v_or_b32 v79, v77, v13
  v_mfma_f32_16x16x32_bf16 v[184:187], v[216:219], v[16:19], 0
  ds_read_b128 v[208:211], v254 offset:18432
  v_bfe_i32 v82, v14, 8, 1
  v_mfma_f32_16x16x32_bf16 v[192:195], v[216:219], v[40:43], 0
  v_and_b32 v81, s54, v82
  v_and_b32 v82, s54, v82
  v_mfma_f32_16x16x32_bf16 v[188:191], v[220:223], v[16:19], 0
  ds_read_b128 v[212:215], v254 offset:19456
  v_cvt_pk_bf16_f32 v120, v168, v169
  v_mfma_f32_16x16x32_bf16 v[196:199], v[220:223], v[40:43], 0
  s_waitcnt lgkmcnt(5)
  v_cvt_pk_bf16_f32 v121, v170, v171
  v_cvt_pk_bf16_f32 v122, v172, v173
  v_mfma_f32_16x16x32_bf16 v[184:187], v[224:227], v[20:23], v[184:187]
  ds_read_b128 v[216:219], v254 offset:20480
  v_cvt_pk_bf16_f32 v123, v174, v175
  v_mfma_f32_16x16x32_bf16 v[192:195], v[224:227], v[44:47], v[192:195]
  s_waitcnt lgkmcnt(5)
  v_cvt_pk_bf16_f32 v144, v176, v177
  v_cvt_pk_bf16_f32 v145, v178, v179
  v_mfma_f32_16x16x32_bf16 v[188:191], v[228:231], v[20:23], v[188:191]
  ds_read_b128 v[220:223], v254 offset:21504
  v_cvt_pk_bf16_f32 v146, v180, v181
  v_mfma_f32_16x16x32_bf16 v[196:199], v[228:231], v[44:47], v[196:199]
  s_waitcnt lgkmcnt(5)
  v_cvt_pk_bf16_f32 v147, v182, v183
  v_or_b32 v80, v81, v12
  v_mfma_f32_16x16x32_bf16 v[184:187], v[200:203], v[24:27], v[184:187]
  ds_read_b128 v[224:227], v254 offset:22528
  v_or_b32 v83, v81, v13
  v_mfma_f32_16x16x32_bf16 v[192:195], v[200:203], v[48:51], v[192:195]
  s_waitcnt lgkmcnt(5)
  v_bfe_i32 v86, v14, 10, 1
  v_and_b32 v85, s54, v86
  v_mfma_f32_16x16x32_bf16 v[188:191], v[204:207], v[24:27], v[188:191]
  ds_read_b128 v[228:231], v254 offset:23552
  v_and_b32 v86, s54, v86
  v_mfma_f32_16x16x32_bf16 v[196:199], v[204:207], v[48:51], v[196:199]
  s_waitcnt lgkmcnt(5)
  v_or_b32 v84, v85, v12
  v_or_b32 v87, v85, v13
  v_mfma_f32_16x16x32_bf16 v[184:187], v[208:211], v[28:31], v[184:187]
  ds_read_b128 v[200:203], v254 offset:24576
  v_bfe_i32 v90, v14, 12, 1
  v_mfma_f32_16x16x32_bf16 v[192:195], v[208:211], v[52:55], v[192:195]
  s_waitcnt lgkmcnt(5)
  v_and_b32 v89, s54, v90
  v_and_b32 v90, s54, v90
  v_mfma_f32_16x16x32_bf16 v[188:191], v[212:215], v[28:31], v[188:191]
  ds_read_b128 v[204:207], v254 offset:25600
  v_or_b32 v88, v89, v12
  v_mfma_f32_16x16x32_bf16 v[196:199], v[212:215], v[52:55], v[196:199]
  s_waitcnt lgkmcnt(5)
  v_or_b32 v91, v89, v13
  v_bfe_i32 v94, v15, 6, 1
  v_mfma_f32_16x16x32_bf16 v[184:187], v[216:219], v[32:35], v[184:187]
  ds_read_b128 v[208:211], v254 offset:26624
  v_and_b32 v93, s54, v94
  v_mfma_f32_16x16x32_bf16 v[192:195], v[216:219], v[56:59], v[192:195]
  s_waitcnt lgkmcnt(5)
  v_and_b32 v94, s54, v94
  v_or_b32 v92, v93, v12
  v_mfma_f32_16x16x32_bf16 v[188:191], v[220:223], v[32:35], v[188:191]
  ds_read_b128 v[212:215], v254 offset:27648
  v_or_b32 v95, v93, v13
  v_mfma_f32_16x16x32_bf16 v[196:199], v[220:223], v[56:59], v[196:199]
  s_waitcnt lgkmcnt(5)
  v_bfe_i32 v98, v15, 8, 1
  v_and_b32 v97, s54, v98
  v_mfma_f32_16x16x32_bf16 v[184:187], v[224:227], v[36:39], v[184:187]
  ds_read_b128 v[216:219], v254 offset:28672
  v_and_b32 v98, s54, v98
  v_mfma_f32_16x16x32_bf16 v[192:195], v[224:227], v[60:63], v[192:195]
  s_waitcnt lgkmcnt(5)
  v_or_b32 v96, v97, v12
  v_or_b32 v99, v97, v13
  v_mfma_f32_16x16x32_bf16 v[188:191], v[228:231], v[36:39], v[188:191]
  ds_read_b128 v[220:223], v254 offset:29696
  v_bfe_i32 v102, v15, 10, 1
  v_mfma_f32_16x16x32_bf16 v[196:199], v[228:231], v[60:63], v[196:199]
  s_waitcnt lgkmcnt(5)
  v_and_b32 v101, s54, v102
  v_and_b32 v102, s54, v102
  v_mfma_f32_16x16x32_bf16 v[168:171], v[200:203], v[16:19], 0
  ds_read_b128 v[224:227], v254 offset:30720
  v_or_b32 v100, v101, v12
  v_mfma_f32_16x16x32_bf16 v[176:179], v[200:203], v[40:43], 0
  s_waitcnt lgkmcnt(5)
  v_or_b32 v103, v101, v13
  v_bfe_i32 v106, v15, 12, 1
  v_mfma_f32_16x16x32_bf16 v[172:175], v[204:207], v[16:19], 0
  ds_read_b128 v[228:231], v254 offset:31744
  v_cvt_pk_bf16_f32 v124, v184, v185
  v_mfma_f32_16x16x32_bf16 v[180:183], v[204:207], v[40:43], 0
  s_waitcnt lgkmcnt(5)
  v_cvt_pk_bf16_f32 v125, v186, v187
  v_cvt_pk_bf16_f32 v126, v188, v189
  v_mfma_f32_16x16x32_bf16 v[168:171], v[208:211], v[20:23], v[168:171]
  ds_read_b128 v[200:203], v254 offset:32768
  v_cvt_pk_bf16_f32 v127, v190, v191
  v_mfma_f32_16x16x32_bf16 v[176:179], v[208:211], v[44:47], v[176:179]
  s_waitcnt lgkmcnt(5)
  v_cvt_pk_bf16_f32 v148, v192, v193
  v_cvt_pk_bf16_f32 v149, v194, v195
  v_mfma_f32_16x16x32_bf16 v[172:175], v[212:215], v[20:23], v[172:175]
  ds_read_b128 v[204:207], v254 offset:33792
  v_cvt_pk_bf16_f32 v150, v196, v197
  v_mfma_f32_16x16x32_bf16 v[180:183], v[212:215], v[44:47], v[180:183]
  s_waitcnt lgkmcnt(5)
  v_cvt_pk_bf16_f32 v151, v198, v199
  v_and_b32 v105, s54, v106
  v_mfma_f32_16x16x32_bf16 v[168:171], v[216:219], v[24:27], v[168:171]
  ds_read_b128 v[208:211], v254 offset:34816
  v_and_b32 v106, s54, v106
  v_mfma_f32_16x16x32_bf16 v[176:179], v[216:219], v[48:51], v[176:179]
  s_waitcnt lgkmcnt(5)
  v_or_b32 v104, v105, v12
  v_or_b32 v107, v105, v13
  v_mfma_f32_16x16x32_bf16 v[172:175], v[220:223], v[24:27], v[172:175]
  ds_read_b128 v[212:215], v254 offset:35840
  v_bfe_i32 v110, v15, 14, 1
  v_mfma_f32_16x16x32_bf16 v[180:183], v[220:223], v[48:51], v[180:183]
  s_waitcnt lgkmcnt(5)
  v_and_b32 v109, s54, v110
  v_and_b32 v110, s54, v110
  v_mfma_f32_16x16x32_bf16 v[168:171], v[224:227], v[28:31], v[168:171]
  ds_read_b128 v[216:219], v254 offset:36864
  v_or_b32 v108, v109, v12
  v_mfma_f32_16x16x32_bf16 v[176:179], v[224:227], v[52:55], v[176:179]
  s_waitcnt lgkmcnt(5)
  v_or_b32 v111, v109, v13
  v_bfe_i32 v114, v15, 16, 1
  v_mfma_f32_16x16x32_bf16 v[172:175], v[228:231], v[28:31], v[172:175]
  ds_read_b128 v[220:223], v254 offset:37888
  v_and_b32 v113, s54, v114
  v_mfma_f32_16x16x32_bf16 v[180:183], v[228:231], v[52:55], v[180:183]
  s_waitcnt lgkmcnt(5)
  v_and_b32 v114, s54, v114
  v_or_b32 v112, v113, v12
  v_mfma_f32_16x16x32_bf16 v[168:171], v[200:203], v[32:35], v[168:171]
  ds_read_b128 v[224:227], v254 offset:38912
  v_or_b32 v115, v113, v13
  v_mfma_f32_16x16x32_bf16 v[176:179], v[200:203], v[56:59], v[176:179]
  s_waitcnt lgkmcnt(5)
  v_bfe_i32 v118, v15, 18, 1
  v_and_b32 v117, s54, v118
  v_mfma_f32_16x16x32_bf16 v[172:175], v[204:207], v[32:35], v[172:175]
  ds_read_b128 v[228:231], v254 offset:39936
  v_and_b32 v118, s54, v118
  v_mfma_f32_16x16x32_bf16 v[180:183], v[204:207], v[56:59], v[180:183]
  s_waitcnt lgkmcnt(5)
  v_or_b32 v116, v117, v12
  v_or_b32 v119, v117, v13
  v_mfma_f32_16x16x32_bf16 v[168:171], v[208:211], v[36:39], v[168:171]
  ds_read_b128 v[200:203], v254 offset:40960
  v_lshrrev_b32 v140, 1, v2
  v_mfma_f32_16x16x32_bf16 v[176:179], v[208:211], v[60:63], v[176:179]
  s_waitcnt lgkmcnt(5)
  v_add_u32 v140, s56, v140
  v_lshl_add_u32 v141, v140, 1, s61
  v_mfma_f32_16x16x32_bf16 v[172:175], v[212:215], v[36:39], v[172:175]
  ds_read_b128 v[204:207], v254 offset:41984
  v_add_u32 v142, 112, v140
  v_mfma_f32_16x16x32_bf16 v[180:183], v[212:215], v[60:63], v[180:183]
  v_med3_i32 v140, v141, v140, v142
  v_mul_lo_u32 v140, v140, s57
  s_barrier
  s_waitcnt lgkmcnt(5)
  v_mfma_f32_16x16x32_bf16 v[184:187], v[216:219], v[16:19], 0
  ds_read_b128 v[208:211], v254 offset:43008
  s_add_u32 m0, s101, 0
  s_nop 0
  buffer_load_dwordx4 v232, s[16:19], s100 offen lds
  v_mfma_f32_16x16x32_bf16 v[192:195], v[216:219], v[40:43], 0
  s_waitcnt lgkmcnt(5)
  s_add_u32 m0, s101, 1024
  s_nop 0
  buffer_load_dwordx4 v233, s[16:19], s100 offen lds
  s_add_u32 m0, s101, 2048
  s_nop 0
  buffer_load_dwordx4 v234, s[16:19], s100 offen lds
  v_mfma_f32_16x16x32_bf16 v[188:191], v[220:223], v[16:19], 0
  ds_read_b128 v[212:215], v254 offset:44032
  v_cvt_pk_bf16_f32 v128, v168, v169
  v_mfma_f32_16x16x32_bf16 v[196:199], v[220:223], v[40:43], 0
  s_waitcnt lgkmcnt(5)
  v_cvt_pk_bf16_f32 v129, v170, v171
  v_cvt_pk_bf16_f32 v130, v172, v173
  v_mfma_f32_16x16x32_bf16 v[184:187], v[224:227], v[20:23], v[184:187]
  ds_read_b128 v[216:219], v254 offset:45056
  v_cvt_pk_bf16_f32 v131, v174, v175
  v_mfma_f32_16x16x32_bf16 v[192:195], v[224:227], v[44:47], v[192:195]
  s_waitcnt lgkmcnt(5)
  v_cvt_pk_bf16_f32 v152, v176, v177
  v_cvt_pk_bf16_f32 v153, v178, v179
  v_mfma_f32_16x16x32_bf16 v[188:191], v[228:231], v[20:23], v[188:191]
  ds_read_b128 v[220:223], v254 offset:46080
  v_cvt_pk_bf16_f32 v154, v180, v181
  v_mfma_f32_16x16x32_bf16 v[196:199], v[228:231], v[44:47], v[196:199]
  s_waitcnt lgkmcnt(5)
  v_cvt_pk_bf16_f32 v155, v182, v183
  s_add_u32 m0, s101, 3072
  s_nop 0
  buffer_load_dwordx4 v235, s[16:19], s100 offen lds
  v_mfma_f32_16x16x32_bf16 v[184:187], v[200:203], v[24:27], v[184:187]
  ds_read_b128 v[224:227], v254 offset:47104
  s_add_u32 m0, s101, 4096
  s_nop 0
  buffer_load_dwordx4 v236, s[16:19], s100 offen lds
  v_mfma_f32_16x16x32_bf16 v[192:195], v[200:203], v[48:51], v[192:195]
  s_waitcnt lgkmcnt(5)
  s_add_u32 m0, s101, 5120
  s_nop 0
  buffer_load_dwordx4 v237, s[16:19], s100 offen lds
  s_add_u32 m0, s101, 6144
  s_nop 0
  buffer_load_dwordx4 v238, s[16:19], s100 offen lds
  v_mfma_f32_16x16x32_bf16 v[188:191], v[204:207], v[24:27], v[188:191]
  ds_read_b128 v[228:231], v254 offset:48128
  s_add_u32 m0, s101, 6656
  s_nop 0
  buffer_load_dwordx4 v239, s[16:19], s100 offen lds
  v_mfma_f32_16x16x32_bf16 v[196:199], v[204:207], v[48:51], v[196:199]
  s_waitcnt lgkmcnt(5)
  v_lshl_add_u32 v140, v3, 3, v140
  v_and_b32 v143, 1, v2
  v_mfma_f32_16x16x32_bf16 v[184:187], v[208:211], v[28:31], v[184:187]
  ds_read_b128 v[200:203], v254 offset:49152
  v_lshl_add_u32 v164, v143, 2, s44
  v_mfma_f32_16x16x32_bf16 v[192:195], v[208:211], v[52:55], v[192:195]
  s_waitcnt lgkmcnt(5)
  v_lshlrev_b32 v143, 30, v143
  v_add_u32 v4, 0, v164
  v_mfma_f32_16x16x32_bf16 v[188:191], v[212:215], v[28:31], v[188:191]
  ds_read_b128 v[204:207], v254 offset:50176
  v_lshl_add_u32 v141, v4, 1, s62
  v_mfma_f32_16x16x32_bf16 v[196:199], v[212:215], v[52:55], v[196:199]
  s_waitcnt lgkmcnt(5)
  v_add_u32 v142, 112, v4
  v_med3_i32 v4, v141, v4, v142
  v_mfma_f32_16x16x32_bf16 v[184:187], v[216:219], v[32:35], v[184:187]
  ds_read_b128 v[208:211], v254 offset:51200
  v_mad_u32_u24 v4, v4, s58, v140
  v_mfma_f32_16x16x32_bf16 v[192:195], v[216:219], v[56:59], v[192:195]
  s_waitcnt lgkmcnt(5)
  v_add_u32 v5, 1, v164
  v_lshl_add_u32 v141, v5, 1, s62
  v_mfma_f32_16x16x32_bf16 v[188:191], v[220:223], v[32:35], v[188:191]
  ds_read_b128 v[212:215], v254 offset:52224
  v_add_u32 v142, 112, v5
  v_mfma_f32_16x16x32_bf16 v[196:199], v[220:223], v[56:59], v[196:199]
  s_waitcnt lgkmcnt(5)
  v_med3_i32 v5, v141, v5, v142
  v_mad_u32_u24 v5, v5, s58, v140
  v_mfma_f32_16x16x32_bf16 v[184:187], v[224:227], v[36:39], v[184:187]
  ds_read_b128 v[216:219], v254 offset:53248
  v_add_u32 v6, 2, v164
  v_mfma_f32_16x16x32_bf16 v[192:195], v[224:227], v[60:63], v[192:195]
  s_waitcnt lgkmcnt(5)
  v_lshl_add_u32 v141, v6, 1, s62
  v_add_u32 v142, 112, v6
  v_mfma_f32_16x16x32_bf16 v[188:191], v[228:231], v[36:39], v[188:191]
  ds_read_b128 v[220:223], v254 offset:54272
  v_med3_i32 v6, v141, v6, v142
  v_mfma_f32_16x16x32_bf16 v[196:199], v[228:231], v[60:63], v[196:199]
  s_waitcnt lgkmcnt(5)
  v_mad_u32_u24 v6, v6, s58, v140
  v_add_u32 v7, 3, v164
  v_mfma_f32_16x16x32_bf16 v[168:171], v[200:203], v[16:19], 0
  ds_read_b128 v[224:227], v254 offset:55296
  v_lshl_add_u32 v141, v7, 1, s62
  v_mfma_f32_16x16x32_bf16 v[176:179], v[200:203], v[40:43], 0
  s_waitcnt lgkmcnt(5)
  ds_read_b128 v[232:235], v254 offset:61440
  v_add_u32 v142, 112, v7
  v_mfma_f32_16x16x32_bf16 v[172:175], v[204:207], v[16:19], 0
  ds_read_b128 v[228:231], v254 offset:56320
  v_cvt_pk_bf16_f32 v132, v184, v185
  v_mfma_f32_16x16x32_bf16 v[180:183], v[204:207], v[40:43], 0
  s_waitcnt lgkmcnt(6)
  ds_read_b128 v[236:239], v254 offset:62464
  v_cvt_pk_bf16_f32 v133, v186, v187
  v_mfma_f32_16x16x32_bf16 v[168:171], v[208:211], v[20:23], v[168:171]
  ds_read_b128 v[200:203], v254 offset:57344
  v_cvt_pk_bf16_f32 v134, v188, v189
  v_mfma_f32_16x16x32_bf16 v[176:179], v[208:211], v[44:47], v[176:179]
  s_waitcnt lgkmcnt(7)
  v_cvt_pk_bf16_f32 v135, v190, v191
  v_cvt_pk_bf16_f32 v156, v192, v193
  v_mfma_f32_16x16x32_bf16 v[172:175], v[212:215], v[20:23], v[172:175]
  ds_read_b128 v[204:207], v254 offset:58368
  v_cvt_pk_bf16_f32 v157, v194, v195
  v_mfma_f32_16x16x32_bf16 v[180:183], v[212:215], v[44:47], v[180:183]
  s_waitcnt lgkmcnt(7)
  v_cvt_pk_bf16_f32 v158, v196, v197
  v_cvt_pk_bf16_f32 v159, v198, v199
  v_mfma_f32_16x16x32_bf16 v[168:171], v[216:219], v[24:27], v[168:171]
  ds_read_b128 v[208:211], v254 offset:59392
  v_med3_i32 v7, v141, v7, v142
  v_mfma_f32_16x16x32_bf16 v[176:179], v[216:219], v[48:51], v[176:179]
  s_waitcnt lgkmcnt(7)
  v_mad_u32_u24 v7, v7, s58, v140
  v_add_u32 v7, v7, v143
  v_mfma_f32_16x16x32_bf16 v[172:175], v[220:223], v[24:27], v[172:175]
  ds_read_b128 v[212:215], v254 offset:60416
  v_add_u32 v8, 7, v164
  v_mfma_f32_16x16x32_bf16 v[180:183], v[220:223], v[48:51], v[180:183]
  s_waitcnt lgkmcnt(7)
  v_lshl_add_u32 v141, v8, 1, s62
  v_add_u32 v142, 112, v8
  v_mfma_f32_16x16x32_bf16 v[168:171], v[224:227], v[28:31], v[168:171]
  v_med3_i32 v8, v141, v8, v142
  v_mad_u32_u24 v8, v8, s58, v140
  v_mfma_f32_16x16x32_bf16 v[176:179], v[224:227], v[52:55], v[176:179]
  s_waitcnt lgkmcnt(5)
  v_add_u32 v9, 8, v164
  v_lshl_add_u32 v141, v9, 1, s62
  v_mfma_f32_16x16x32_bf16 v[172:175], v[228:231], v[28:31], v[172:175]
  v_add_u32 v142, 112, v9
  v_med3_i32 v9, v141, v9, v142
  v_mfma_f32_16x16x32_bf16 v[180:183], v[228:231], v[52:55], v[180:183]
  s_waitcnt lgkmcnt(3)
  v_mad_u32_u24 v9, v9, s58, v140
  v_add_u32 v10, 9, v164
  v_mfma_f32_16x16x32_bf16 v[168:171], v[200:203], v[32:35], v[168:171]
  ds_read_b128 v[224:227], v253 offset:0
  v_lshl_add_u32 v141, v10, 1, s62
  v_mfma_f32_16x16x32_bf16 v[176:179], v[200:203], v[56:59], v[176:179]
  s_waitcnt lgkmcnt(3)
  v_add_u32 v142, 112, v10
  v_med3_i32 v10, v141, v10, v142
  v_mfma_f32_16x16x32_bf16 v[172:175], v[204:207], v[32:35], v[172:175]
  ds_read_b128 v[228:231], v253 offset:1024
  v_mad_u32_u24 v10, v10, s58, v140
  v_mfma_f32_16x16x32_bf16 v[180:183], v[204:207], v[56:59], v[180:183]
  s_waitcnt lgkmcnt(3)
  v_add_u32 v11, 10, v164
  v_lshl_add_u32 v141, v11, 1, s62
  v_mfma_f32_16x16x32_bf16 v[168:171], v[208:211], v[36:39], v[168:171]
  ds_read_b128 v[200:203], v253 offset:2048
  v_add_u32 v142, 112, v11
  v_mfma_f32_16x16x32_bf16 v[176:179], v[208:211], v[60:63], v[176:179]
  s_waitcnt lgkmcnt(3)
  v_med3_i32 v11, v141, v11, v142
  v_mad_u32_u24 v11, v11, s58, v140
  v_mfma_f32_16x16x32_bf16 v[172:175], v[212:215], v[36:39], v[172:175]
  ds_read_b128 v[204:207], v253 offset:3072
  v_add_u32 v11, v11, v143
  v_mfma_f32_16x16x32_bf16 v[180:183], v[212:215], v[60:63], v[180:183]
  s_waitcnt vmcnt(0)
  s_barrier
  s_setprio 1
  s_cmp_ge_u32 s40, 5
  s_cbranch_scc1 M_e1
  s_setprio 2
M_e1:
  v_mfma_f32_16x16x32_bf16 v[184:187], v[232:235], v[16:19], 0
  ds_read_b128 v[208:211], v253 offset:4096
  v_mfma_f32_16x16x32_bf16 v[192:195], v[232:235], v[40:43], 0
  v_mfma_f32_16x16x32_bf16 v[188:191], v[236:239], v[16:19], 0
  ds_read_b128 v[212:215], v253 offset:5120
  v_cvt_pk_bf16_f32 v136, v168, v169
  v_mfma_f32_16x16x32_bf16 v[196:199], v[236:239], v[40:43], 0
  s_waitcnt lgkmcnt(5)
  v_cvt_pk_bf16_f32 v137, v170, v171
  v_cvt_pk_bf16_f32 v138, v172, v173
  v_mfma_f32_16x16x32_bf16 v[184:187], v[224:227], v[20:23], v[184:187]
  ds_read_b128 v[216:219], v253 offset:6144
  v_cvt_pk_bf16_f32 v139, v174, v175
  v_mfma_f32_16x16x32_bf16 v[192:195], v[224:227], v[44:47], v[192:195]
  s_waitcnt lgkmcnt(5)
  v_cvt_pk_bf16_f32 v160, v176, v177
  v_cvt_pk_bf16_f32 v161, v178, v179
  v_mfma_f32_16x16x32_bf16 v[188:191], v[228:231], v[20:23], v[188:191]
  ds_read_b128 v[220:223], v253 offset:7168
  v_cvt_pk_bf16_f32 v162, v180, v181
  v_mfma_f32_16x16x32_bf16 v[196:199], v[228:231], v[44:47], v[196:199]
  s_waitcnt lgkmcnt(5)
  v_cvt_pk_bf16_f32 v163, v182, v183
  v_mfma_f32_16x16x32_bf16 v[184:187], v[200:203], v[24:27], v[184:187]
  ds_read_b128 v[224:227], v253 offset:8192
  v_mfma_f32_16x16x32_bf16 v[192:195], v[200:203], v[48:51], v[192:195]
  s_waitcnt lgkmcnt(5)
  v_mfma_f32_16x16x32_bf16 v[188:191], v[204:207], v[24:27], v[188:191]
  ds_read_b128 v[228:231], v253 offset:9216
  v_mfma_f32_16x16x32_bf16 v[196:199], v[204:207], v[48:51], v[196:199]
  s_waitcnt lgkmcnt(5)
  v_mfma_f32_16x16x32_bf16 v[184:187], v[208:211], v[28:31], v[184:187]
  v_mfma_f32_16x16x32_bf16 v[192:195], v[208:211], v[52:55], v[192:195]
  s_waitcnt lgkmcnt(4)
  v_mfma_f32_16x16x32_bf16 v[188:191], v[212:215], v[28:31], v[188:191]
  v_mfma_f32_16x16x32_bf16 v[196:199], v[212:215], v[52:55], v[196:199]
  s_waitcnt lgkmcnt(3)
  v_mfma_f32_16x16x32_bf16 v[184:187], v[216:219], v[32:35], v[184:187]
  v_mfma_f32_16x16x32_bf16 v[192:195], v[216:219], v[56:59], v[192:195]
  s_waitcnt lgkmcnt(2)
  v_mfma_f32_16x16x32_bf16 v[188:191], v[220:223], v[32:35], v[188:191]
  v_mfma_f32_16x16x32_bf16 v[196:199], v[220:223], v[56:59], v[196:199]
  s_waitcnt lgkmcnt(1)
  v_mfma_f32_16x16x32_bf16 v[184:187], v[224:227], v[36:39], v[184:187]
  v_mfma_f32_16x16x32_bf16 v[192:195], v[224:227], v[60:63], v[192:195]
  s_waitcnt lgkmcnt(0)
  v_mfma_f32_16x16x32_bf16 v[188:191], v[228:231], v[36:39], v[188:191]
  v_mfma_f32_16x16x32_bf16 v[196:199], v[228:231], v[60:63], v[196:199]
  s_cmp_lt_u32 s40, 5
  s_cbranch_scc1 M_l1
  s_barrier
M_l1:
  ds_read_b128 v[200:203], v240 offset:0
  ds_read_b128 v[204:207], v240 offset:2304
  ds_read_b128 v[208:211], v241 offset:0
  ds_read_b128 v[212:215], v241 offset:2304
  ds_read_b128 v[216:219], v242 offset:0
  ds_read_b128 v[220:223], v242 offset:2304
  ds_read_b128 v[224:227], v243 offset:0
  v_cvt_pk_bf16_f32 v140, v184, v185
  v_cvt_pk_bf16_f32 v141, v186, v187
  v_cvt_pk_bf16_f32 v142, v188, v189
  v_cvt_pk_bf16_f32 v143, v190, v191
  v_cvt_pk_bf16_f32 v164, v192, v193
  v_cvt_pk_bf16_f32 v165, v194, v195
  v_cvt_pk_bf16_f32 v166, v196, v197
  v_cvt_pk_bf16_f32 v167, v198, v199
  s_waitcnt lgkmcnt(6)
  v_mfma_f32_16x16x32_bf16 v[64:67], v[200:203], v[120:123], v[64:67]
  s_waitcnt lgkmcnt(5)
  ds_read_b128 v[228:231], v243 offset:2304
  v_mfma_f32_16x16x32_bf16 v[76:79], v[204:207], v[120:123], v[76:79]
  v_mfma_f32_16x16x32_bf16 v[92:95], v[204:207], v[144:147], v[92:95]
  s_waitcnt lgkmcnt(5)
  ds_read_b128 v[200:203], v240 offset:256
  v_mfma_f32_16x16x32_bf16 v[64:67], v[208:211], v[124:127], v[64:67]
  s_waitcnt lgkmcnt(5)
  ds_read_b128 v[204:207], v240 offset:2560
  v_mfma_f32_16x16x32_bf16 v[76:79], v[212:215], v[124:127], v[76:79]
  v_mfma_f32_16x16x32_bf16 v[92:95], v[212:215], v[148:151], v[92:95]
  s_waitcnt lgkmcnt(5)
  ds_read_b128 v[208:211], v241 offset:256
  v_mfma_f32_16x16x32_bf16 v[64:67], v[216:219], v[128:131], v[64:67]
  s_waitcnt lgkmcnt(5)
  ds_read_b128 v[212:215], v241 offset:2560
  v_mfma_f32_16x16x32_bf16 v[76:79], v[220:223], v[128:131], v[76:79]
  v_mfma_f32_16x16x32_bf16 v[92:95], v[220:223], v[152:155], v[92:95]
  s_waitcnt lgkmcnt(5)
  ds_read_b128 v[216:219], v240 offset:768
  v_mfma_f32_16x16x32_bf16 v[64:67], v[224:227], v[132:135], v[64:67]
  s_waitcnt lgkmcnt(5)
  ds_read_b128 v[220:223], v240 offset:3072
  v_mfma_f32_16x16x32_bf16 v[76:79], v[228:231], v[132:135], v[76:79]
  v_mfma_f32_16x16x32_bf16 v[92:95], v[228:231], v[156:159], v[92:95]
  s_waitcnt lgkmcnt(5)
  ds_read_b128 v[224:227], v241 offset:768
  v_mfma_f32_16x16x32_bf16 v[64:67], v[200:203], v[136:139], v[64:67]
  s_waitcnt lgkmcnt(5)
  ds_read_b128 v[228:231], v241 offset:3072
  v_mfma_f32_16x16x32_bf16 v[76:79], v[204:207], v[136:139], v[76:79]
  v_mfma_f32_16x16x32_bf16 v[92:95], v[204:207], v[160:163], v[92:95]
  s_waitcnt lgkmcnt(5)
  ds_read_b128 v[200:203], v242 offset:768
  v_mfma_f32_16x16x32_bf16 v[64:67], v[208:211], v[140:143], v[64:67]
  s_waitcnt lgkmcnt(5)
  ds_read_b128 v[204:207], v242 offset:3072
  v_mfma_f32_16x16x32_bf16 v[76:79], v[212:215], v[140:143], v[76:79]
  v_mfma_f32_16x16x32_bf16 v[92:95], v[212:215], v[164:167], v[92:95]
  s_waitcnt lgkmcnt(5)
  ds_read_b128 v[208:211], v243 offset:768
  v_mfma_f32_16x16x32_bf16 v[68:71], v[216:219], v[120:123], v[68:71]
  s_waitcnt lgkmcnt(5)
  ds_read_b128 v[212:215], v243 offset:3072
  v_mfma_f32_16x16x32_bf16 v[80:83], v[220:223], v[120:123], v[80:83]
  v_mfma_f32_16x16x32_bf16 v[96:99], v[220:223], v[144:147], v[96:99]
  s_waitcnt lgkmcnt(5)
  ds_read_b128 v[216:219], v240 offset:1024
  v_mfma_f32_16x16x32_bf16 v[68:71], v[224:227], v[124:127], v[68:71]
  s_waitcnt lgkmcnt(5)
  ds_read_b128 v[220:223], v240 offset:3328
  v_mfma_f32_16x16x32_bf16 v[80:83], v[228:231], v[124:127], v[80:83]
  v_mfma_f32_16x16x32_bf16 v[96:99], v[228:231], v[148:151], v[96:99]
  s_waitcnt lgkmcnt(5)
  ds_read_b128 v[224:227], v241 offset:1024
  v_mfma_f32_16x16x32_bf16 v[68:71], v[200:203], v[128:131], v[68:71]
  s_waitcnt lgkmcnt(5)
  ds_read_b128 v[228:231], v241 offset:3328
  v_mfma_f32_16x16x32_bf16 v[80:83], v[204:207], v[128:131], v[80:83]
  v_mfma_f32_16x16x32_bf16 v[96:99], v[204:207], v[152:155], v[96:99]
  s_waitcnt lgkmcnt(5)
  ds_read_b128 v[200:203], v240 offset:1536
  v_mfma_f32_16x16x32_bf16 v[68:71], v[208:211], v[132:135], v[68:71]
  s_waitcnt lgkmcnt(5)
  ds_read_b128 v[204:207], v240 offset:3840
  v_mfma_f32_16x16x32_bf16 v[80:83], v[212:215], v[132:135], v[80:83]
  v_mfma_f32_16x16x32_bf16 v[96:99], v[212:215], v[156:159], v[96:99]
  s_waitcnt lgkmcnt(5)
  ds_read_b128 v[208:211], v241 offset:1536
  v_mfma_f32_16x16x32_bf16 v[68:71], v[216:219], v[136:139], v[68:71]
  s_waitcnt lgkmcnt(5)
  ds_read_b128 v[212:215], v241 offset:3840
  v_mfma_f32_16x16x32_bf16 v[80:83], v[220:223], v[136:139], v[80:83]
  v_mfma_f32_16x16x32_bf16 v[96:99], v[220:223], v[160:163], v[96:99]
  s_waitcnt lgkmcnt(5)
  ds_read_b128 v[216:219], v242 offset:1536
  v_mfma_f32_16x16x32_bf16 v[68:71], v[224:227], v[140:143], v[68:71]
  s_waitcnt lgkmcnt(5)
  ds_read_b128 v[220:223], v242 offset:3840
  v_mfma_f32_16x16x32_bf16 v[80:83], v[228:231], v[140:143], v[80:83]
  v_mfma_f32_16x16x32_bf16 v[96:99], v[228:231], v[164:167], v[96:99]
  s_waitcnt lgkmcnt(5)
  ds_read_b128 v[224:227], v243 offset:1536
  v_mfma_f32_16x16x32_bf16 v[72:75], v[200:203], v[120:123], v[72:75]
  s_waitcnt lgkmcnt(5)
  ds_read_b128 v[228:231], v243 offset:3840
  v_mfma_f32_16x16x32_bf16 v[84:87], v[204:207], v[120:123], v[84:87]
  v_mfma_f32_16x16x32_bf16 v[100:103], v[204:207], v[144:147], v[100:103]
  s_waitcnt lgkmcnt(5)
  ds_read_b128 v[200:203], v240 offset:1792
  v_mfma_f32_16x16x32_bf16 v[72:75], v[208:211], v[124:127], v[72:75]
  s_waitcnt lgkmcnt(5)
  ds_read_b128 v[204:207], v240 offset:4096
  v_mfma_f32_16x16x32_bf16 v[84:87], v[212:215], v[124:127], v[84:87]
  v_mfma_f32_16x16x32_bf16 v[100:103], v[212:215], v[148:151], v[100:103]
  s_waitcnt lgkmcnt(5)
  ds_read_b128 v[208:211], v241 offset:1792
  v_mfma_f32_16x16x32_bf16 v[72:75], v[216:219], v[128:131], v[72:75]
  s_waitcnt lgkmcnt(5)
  ds_read_b128 v[212:215], v241 offset:4096
  v_mfma_f32_16x16x32_bf16 v[84:87], v[220:223], v[128:131], v[84:87]
  v_mfma_f32_16x16x32_bf16 v[100:103], v[220:223], v[152:155], v[100:103]
  s_waitcnt lgkmcnt(5)
  ds_read_b128 v[216:219], v240 offset:5376
  v_mfma_f32_16x16x32_bf16 v[72:75], v[224:227], v[132:135], v[72:75]
  s_waitcnt lgkmcnt(5)
  ds_read_b128 v[220:223], v240 offset:4608
  v_mfma_f32_16x16x32_bf16 v[84:87], v[228:231], v[132:135], v[84:87]
  v_mfma_f32_16x16x32_bf16 v[100:103], v[228:231], v[156:159], v[100:103]
  s_waitcnt lgkmcnt(5)
  ds_read_b128 v[224:227], v241 offset:5376
  v_mfma_f32_16x16x32_bf16 v[72:75], v[200:203], v[136:139], v[72:75]
  s_waitcnt lgkmcnt(5)
  ds_read_b128 v[228:231], v241 offset:4608
  v_mfma_f32_16x16x32_bf16 v[84:87], v[204:207], v[136:139], v[84:87]
  v_mfma_f32_16x16x32_bf16 v[100:103], v[204:207], v[160:163], v[100:103]
  s_waitcnt lgkmcnt(5)
  ds_read_b128 v[200:203], v242 offset:5376
  v_mfma_f32_16x16x32_bf16 v[72:75], v[208:211], v[140:143], v[72:75]
  s_waitcnt lgkmcnt(5)
  ds_read_b128 v[204:207], v242 offset:4608
  v_mfma_f32_16x16x32_bf16 v[84:87], v[212:215], v[140:143], v[84:87]
  v_mfma_f32_16x16x32_bf16 v[100:103], v[212:215], v[164:167], v[100:103]
  s_waitcnt lgkmcnt(5)
  ds_read_b128 v[208:211], v243 offset:5376
  v_mfma_f32_16x16x32_bf16 v[108:111], v[216:219], v[144:147], v[108:111]
  s_waitcnt lgkmcnt(5)
  ds_read_b128 v[212:215], v243 offset:4608
  v_mfma_f32_16x16x32_bf16 v[88:91], v[220:223], v[120:123], v[88:91]
  v_mfma_f32_16x16x32_bf16 v[104:107], v[220:223], v[144:147], v[104:107]
  s_waitcnt lgkmcnt(5)
  ds_read_b128 v[216:219], v240 offset:5632
  v_mfma_f32_16x16x32_bf16 v[108:111], v[224:227], v[148:151], v[108:111]
  s_waitcnt lgkmcnt(5)
  ds_read_b128 v[220:223], v240 offset:4864
  v_mfma_f32_16x16x32_bf16 v[88:91], v[228:231], v[124:127], v[88:91]
  v_mfma_f32_16x16x32_bf16 v[104:107], v[228:231], v[148:151], v[104:107]
  s_waitcnt lgkmcnt(5)
  ds_read_b128 v[224:227], v241 offset:5632
  v_mfma_f32_16x16x32_bf16 v[108:111], v[200:203], v[152:155], v[108:111]
  s_waitcnt lgkmcnt(5)
  ds_read_b128 v[228:231], v241 offset:4864
  v_mfma_f32_16x16x32_bf16 v[88:91], v[204:207], v[128:131], v[88:91]
  v_mfma_f32_16x16x32_bf16 v[104:107], v[204:207], v[152:155], v[104:107]
  s_waitcnt lgkmcnt(5)
  ds_read_b128 v[200:203], v240 offset:6144
  v_mfma_f32_16x16x32_bf16 v[108:111], v[208:211], v[156:159], v[108:111]
  s_waitcnt lgkmcnt(5)
  ds_read_b128 v[204:207], v240 offset:6912
  v_mfma_f32_16x16x32_bf16 v[88:91], v[212:215], v[132:135], v[88:91]
  v_mfma_f32_16x16x32_bf16 v[104:107], v[212:215], v[156:159], v[104:107]
  s_waitcnt lgkmcnt(5)
  ds_read_b128 v[208:211], v241 offset:6144
  v_mfma_f32_16x16x32_bf16 v[108:111], v[216:219], v[160:163], v[108:111]
  s_waitcnt lgkmcnt(5)
  ds_read_b128 v[212:215], v241 offset:6912
  v_mfma_f32_16x16x32_bf16 v[88:91], v[220:223], v[136:139], v[88:91]
  v_mfma_f32_16x16x32_bf16 v[104:107], v[220:223], v[160:163], v[104:107]
  s_waitcnt lgkmcnt(5)
  ds_read_b128 v[216:219], v242 offset:6144
  v_mfma_f32_16x16x32_bf16 v[108:111], v[224:227], v[164:167], v[108:111]
  s_waitcnt lgkmcnt(5)
  ds_read_b128 v[220:223], v242 offset:6912
  v_mfma_f32_16x16x32_bf16 v[88:91], v[228:231], v[140:143], v[88:91]
  v_mfma_f32_16x16x32_bf16 v[104:107], v[228:231], v[164:167], v[104:107]
  s_waitcnt lgkmcnt(5)
  ds_read_b128 v[224:227], v243 offset:6144
  v_mfma_f32_16x16x32_bf16 v[112:115], v[200:203], v[144:147], v[112:115]
  s_waitcnt lgkmcnt(5)
  ds_read_b128 v[228:231], v243 offset:6912
  v_mfma_f32_16x16x32_bf16 v[116:119], v[204:207], v[144:147], v[116:119]
  s_waitcnt lgkmcnt(5)
  ds_read_b128 v[200:203], v240 offset:6400
  v_mfma_f32_16x16x32_bf16 v[112:115], v[208:211], v[148:151], v[112:115]
  s_waitcnt lgkmcnt(5)
  ds_read_b128 v[204:207], v240 offset:7168
  v_mfma_f32_16x16x32_bf16 v[116:119], v[212:215], v[148:151], v[116:119]
  s_waitcnt lgkmcnt(5)
  ds_read_b128 v[208:211], v241 offset:6400
  v_mfma_f32_16x16x32_bf16 v[112:115], v[216:219], v[152:155], v[112:115]
  s_waitcnt lgkmcnt(5)
  ds_read_b128 v[212:215], v241 offset:7168
  v_mfma_f32_16x16x32_bf16 v[116:119], v[220:223], v[152:155], v[116:119]
  s_waitcnt lgkmcnt(5)
  v_mfma_f32_16x16x32_bf16 v[112:115], v[224:227], v[156:159], v[112:115]
  s_waitcnt lgkmcnt(4)
  v_mfma_f32_16x16x32_bf16 v[116:119], v[228:231], v[156:159], v[116:119]
  s_waitcnt lgkmcnt(3)
  v_mfma_f32_16x16x32_bf16 v[112:115], v[200:203], v[160:163], v[112:115]
  s_waitcnt lgkmcnt(2)
  v_mfma_f32_16x16x32_bf16 v[116:119], v[204:207], v[160:163], v[116:119]
  s_waitcnt lgkmcnt(1)
  v_mfma_f32_16x16x32_bf16 v[112:115], v[208:211], v[164:167], v[112:115]
  s_waitcnt lgkmcnt(0)
  v_mfma_f32_16x16x32_bf16 v[116:119], v[212:215], v[164:167], v[116:119]
  s_setprio 0
  v_mov_b32 v30, 0
  v_mov_b32 v31, 0
  v_mov_b32 v32, 0
  v_mov_b32 v33, 0
  v_max3_f32 v12, v64, v65, v66
  v_max3_f32 v14, v67, v68, v69
  v_max3_f32 v13, v92, v93, v94
  v_max3_f32 v15, v95, v96, v97
  v_max3_f32 v12, v12, v70, v71
  v_max3_f32 v14, v14, v72, v73
  v_max3_f32 v13, v13, v98, v99
  v_max3_f32 v15, v15, v100, v101
  v_max3_f32 v12, v12, v74, v75
  v_max3_f32 v14, v14, v76, v77
  v_max3_f32 v13, v13, v102, v103
  v_max3_f32 v15, v15, v104, v105
  v_max3_f32 v12, v12, v78, v79
  v_max3_f32 v14, v14, v80, v81
  v_max3_f32 v13, v13, v106, v107
  v_max3_f32 v15, v15, v108, v109
  v_max3_f32 v12, v12, v82, v83
  v_max3_f32 v14, v14, v84, v85
  v_max3_f32 v13, v13, v110, v111
  v_max3_f32 v15, v15, v112, v113
  v_max3_f32 v12, v12, v86, v87
  v_max3_f32 v14, v14, v88, v89
  v_max3_f32 v13, v13, v114, v115
  v_max3_f32 v15, v15, v116, v117
  v_max3_f32 v12, v12, v90, v91
  v_max3_f32 v13, v13, v118, v119
  v_max_f32 v12, v12, v14
  v_max_f32 v13, v13, v15
  v_mov_b32 v14, v12
  v_mov_b32 v15, v13
  s_nop 0
  v_permlane32_swap_b32 v12, v14
  v_permlane32_swap_b32 v13, v15
  v_max_f32 v12, v12, v14
  v_max_f32 v13, v13, v15
  v_mov_b32 v14, v12
  v_mov_b32 v15, v13
  s_nop 0
  v_permlane16_swap_b32 v12, v14
  v_permlane16_swap_b32 v13, v15
  v_max_f32 v12, v12, v14
  v_max_f32 v13, v13, v15
  v_mul_f32 v12, s63, v12
  v_mul_f32 v13, s63, v13
  s_cmp_ge_u32 s40, 5
  s_cbranch_scc1 M_e2
  s_barrier
M_e2:
  v_fma_f32 v64, v64, s63, -v12
  v_fma_f32 v65, v65, s63, -v12
  v_fma_f32 v66, v66, s63, -v12
  v_fma_f32 v67, v67, s63, -v12
  v_exp_f32 v64, v64
  v_exp_f32 v65, v65
  v_exp_f32 v66, v66
  v_exp_f32 v67, v67
  v_fma_f32 v92, v92, s63, -v13
  v_fma_f32 v93, v93, s63, -v13
  v_fma_f32 v94, v94, s63, -v13
  v_fma_f32 v95, v95, s63, -v13
  v_exp_f32 v92, v92
  v_exp_f32 v93, v93
  v_exp_f32 v94, v94
  v_exp_f32 v95, v95
  v_cvt_pk_bf16_f32 v16, v64, v65
  v_cvt_pk_bf16_f32 v17, v66, v67
  v_cvt_pk_bf16_f32 v34, v92, v93
  v_cvt_pk_bf16_f32 v35, v94, v95
  v_fma_f32 v68, v68, s63, -v12
  v_fma_f32 v69, v69, s63, -v12
  v_fma_f32 v70, v70, s63, -v12
  v_fma_f32 v71, v71, s63, -v12
  v_exp_f32 v68, v68
  v_exp_f32 v69, v69
  v_exp_f32 v70, v70
  v_exp_f32 v71, v71
  v_fma_f32 v96, v96, s63, -v13
  v_fma_f32 v97, v97, s63, -v13
  v_fma_f32 v98, v98, s63, -v13
  v_fma_f32 v99, v99, s63, -v13
  v_exp_f32 v96, v96
  v_exp_f32 v97, v97
  v_exp_f32 v98, v98
  v_exp_f32 v99, v99
  v_cvt_pk_bf16_f32 v18, v68, v69
  v_cvt_pk_bf16_f32 v19, v70, v71
  v_cvt_pk_bf16_f32 v36, v96, v97
  v_cvt_pk_bf16_f32 v37, v98, v99
  v_fma_f32 v72, v72, s63, -v12
  v_fma_f32 v73, v73, s63, -v12
  v_fma_f32 v74, v74, s63, -v12
  v_fma_f32 v75, v75, s63, -v12
  v_exp_f32 v72, v72
  v_exp_f32 v73, v73
  v_exp_f32 v74, v74
  v_exp_f32 v75, v75
  v_fma_f32 v100, v100, s63, -v13
  v_fma_f32 v101, v101, s63, -v13
  v_fma_f32 v102, v102, s63, -v13
  v_fma_f32 v103, v103, s63, -v13
  v_exp_f32 v100, v100
  v_exp_f32 v101, v101
  v_exp_f32 v102, v102
  v_exp_f32 v103, v103
  v_cvt_pk_bf16_f32 v20, v72, v73
  v_cvt_pk_bf16_f32 v21, v74, v75
  v_cvt_pk_bf16_f32 v38, v100, v101
  v_cvt_pk_bf16_f32 v39, v102, v103
  v_fma_f32 v76, v76, s63, -v12
  v_fma_f32 v77, v77, s63, -v12
  v_fma_f32 v78, v78, s63, -v12
  v_fma_f32 v79, v79, s63, -v12
  v_exp_f32 v76, v76
  v_exp_f32 v77, v77
  v_exp_f32 v78, v78
  v_exp_f32 v79, v79
  v_fma_f32 v104, v104, s63, -v13
  v_fma_f32 v105, v105, s63, -v13
  v_fma_f32 v106, v106, s63, -v13
  v_fma_f32 v107, v107, s63, -v13
  v_exp_f32 v104, v104
  v_exp_f32 v105, v105
  v_exp_f32 v106, v106
  v_exp_f32 v107, v107
  v_cvt_pk_bf16_f32 v22, v76, v77
  v_cvt_pk_bf16_f32 v23, v78, v79
  v_cvt_pk_bf16_f32 v40, v104, v105
  v_cvt_pk_bf16_f32 v41, v106, v107
  s_cmp_lt_u32 s40, 5
  s_cbranch_scc1 M_l2
  s_barrier
  s_mov_b32 s55, 10240
  buffer_load_dwordx4 v[232:235], v252, s[24:27], s55 offen offset:0 sc1
  buffer_load_dwordx4 v[236:239], v252, s[24:27], s55 offen offset:1024 sc1
M_l2:
  v_fma_f32 v80, v80, s63, -v12
  v_fma_f32 v81, v81, s63, -v12
  v_fma_f32 v82, v82, s63, -v12
  v_fma_f32 v83, v83, s63, -v12
  v_exp_f32 v80, v80
  v_exp_f32 v81, v81
  v_exp_f32 v82, v82
  v_exp_f32 v83, v83
  v_fma_f32 v108, v108, s63, -v13
  v_fma_f32 v109, v109, s63, -v13
  v_fma_f32 v110, v110, s63, -v13
  v_fma_f32 v111, v111, s63, -v13
  v_exp_f32 v108, v108
  v_exp_f32 v109, v109
  v_exp_f32 v110, v110
  v_exp_f32 v111, v111
  v_cvt_pk_bf16_f32 v24, v80, v81
  v_cvt_pk_bf16_f32 v25, v82, v83
  v_cvt_pk_bf16_f32 v42, v108, v109
  v_cvt_pk_bf16_f32 v43, v110, v111
  v_fma_f32 v84, v84, s63, -v12
  v_fma_f32 v85, v85, s63, -v12
  v_fma_f32 v86, v86, s63, -v12
  v_fma_f32 v87, v87, s63, -v12
  v_exp_f32 v84, v84
  v_exp_f32 v85, v85
  v_exp_f32 v86, v86
  v_exp_f32 v87, v87
  v_fma_f32 v112, v112, s63, -v13
  v_fma_f32 v113, v113, s63, -v13
  v_fma_f32 v114, v114, s63, -v13
  v_fma_f32 v115, v115, s63, -v13
  v_exp_f32 v112, v112
  v_exp_f32 v113, v113
  v_exp_f32 v114, v114
  v_exp_f32 v115, v115
  v_cvt_pk_bf16_f32 v26, v84, v85
  v_cvt_pk_bf16_f32 v27, v86, v87
  v_cvt_pk_bf16_f32 v44, v112, v113
  v_cvt_pk_bf16_f32 v45, v114, v115
  ds_read_b64_tr_b16 v[200:201], v244 offset:0
  ds_read_b64_tr_b16 v[202:203], v244 offset:768
  ds_read_b64_tr_b16 v[204:205], v245 offset:0
  ds_read_b64_tr_b16 v[206:207], v245 offset:768
  ds_read_b64_tr_b16 v[208:209], v244 offset:1536
  ds_read_b64_tr_b16 v[210:211], v244 offset:2304
  ds_read_b64_tr_b16 v[212:213], v245 offset:1536
  ds_read_b64_tr_b16 v[214:215], v245 offset:2304
  ds_read_b64_tr_b16 v[216:217], v244 offset:3072
  ds_read_b64_tr_b16 v[218:219], v244 offset:3840
  ds_read_b64_tr_b16 v[220:221], v245 offset:3072
  ds_read_b64_tr_b16 v[222:223], v245 offset:3840
  v_fma_f32 v88, v88, s63, -v12
  v_fma_f32 v89, v89, s63, -v12
  v_fma_f32 v90, v90, s63, -v12
  v_fma_f32 v91, v91, s63, -v12
  v_exp_f32 v88, v88
  v_exp_f32 v89, v89
  v_exp_f32 v90, v90
  v_exp_f32 v91, v91
  v_fma_f32 v116, v116, s63, -v13
  v_fma_f32 v117, v117, s63, -v13
  v_fma_f32 v118, v118, s63, -v13
  v_fma_f32 v119, v119, s63, -v13
  v_exp_f32 v116, v116
  v_exp_f32 v117, v117
  v_exp_f32 v118, v118
  v_exp_f32 v119, v119
  v_cvt_pk_bf16_f32 v28, v88, v89
  v_cvt_pk_bf16_f32 v29, v90, v91
  v_cvt_pk_bf16_f32 v46, v116, v117
  v_cvt_pk_bf16_f32 v47, v118, v119
  v_mov_b32 v80, 0x3f803f80
  v_mov_b32 v81, 0x3f803f80
  v_mov_b32 v82, 0x3f803f80
  v_mov_b32 v83, 0x3f803f80
  s_setprio 3
  s_waitcnt lgkmcnt(10)
  v_mfma_f32_16x16x32_bf16 v[168:171], v[200:203], v[16:19], 0
  s_waitcnt lgkmcnt(8)
  ds_read_b64_tr_b16 v[224:225], v244 offset:4608
  ds_read_b64_tr_b16 v[226:227], v244 offset:5376
  v_mfma_f32_16x16x32_bf16 v[172:175], v[204:207], v[16:19], 0
  s_waitcnt lgkmcnt(8)
  ds_read_b64_tr_b16 v[228:229], v245 offset:4608
  v_mfma_f32_16x16x32_bf16 v[168:171], v[208:211], v[20:23], v[168:171]
  ds_read_b64_tr_b16 v[230:231], v245 offset:5376
  v_mfma_f32_16x16x32_bf16 v[176:179], v[208:211], v[32:35], 0
  s_waitcnt lgkmcnt(8)
  ds_read_b64_tr_b16 v[200:201], v244 offset:6144
  v_mfma_f32_16x16x32_bf16 v[172:175], v[212:215], v[20:23], v[172:175]
  ds_read_b64_tr_b16 v[202:203], v244 offset:6912
  v_mfma_f32_16x16x32_bf16 v[180:183], v[212:215], v[32:35], 0
  s_waitcnt lgkmcnt(8)
  ds_read_b64_tr_b16 v[204:205], v245 offset:6144
  v_mfma_f32_16x16x32_bf16 v[168:171], v[216:219], v[24:27], v[168:171]
  ds_read_b64_tr_b16 v[206:207], v245 offset:6912
  v_mfma_f32_16x16x32_bf16 v[176:179], v[216:219], v[36:39], v[176:179]
  s_waitcnt lgkmcnt(8)
  ds_read_b64_tr_b16 v[208:209], v246 offset:0
  v_mfma_f32_16x16x32_bf16 v[172:175], v[220:223], v[24:27], v[172:175]
  ds_read_b64_tr_b16 v[210:211], v246 offset:768
  v_mfma_f32_16x16x32_bf16 v[180:183], v[220:223], v[36:39], v[180:183]
  s_waitcnt lgkmcnt(8)
  ds_read_b64_tr_b16 v[212:213], v247 offset:0
  ds_read_b64_tr_b16 v[214:215], v247 offset:768
  v_mfma_f32_16x16x32_bf16 v[168:171], v[224:227], v[28:31], v[168:171]
  ds_read_b64_tr_b16 v[216:217], v246 offset:1536
  v_mfma_f32_16x16x32_bf16 v[176:179], v[224:227], v[40:43], v[176:179]
  s_waitcnt lgkmcnt(9)
  ds_read_b64_tr_b16 v[218:219], v246 offset:2304
  v_mfma_f32_16x16x32_bf16 v[172:175], v[228:231], v[28:31], v[172:175]
  ds_read_b64_tr_b16 v[220:221], v247 offset:1536
  v_mfma_f32_16x16x32_bf16 v[180:183], v[228:231], v[40:43], v[180:183]
  s_waitcnt lgkmcnt(9)
  ds_read_b64_tr_b16 v[222:223], v247 offset:2304
  v_mfma_f32_16x16x32_bf16 v[176:179], v[200:203], v[44:47], v[176:179]
  s_waitcnt lgkmcnt(8)
  ds_read_b64_tr_b16 v[224:225], v246 offset:3072
  v_mfma_f32_16x16x32_bf16 v[180:183], v[204:207], v[44:47], v[180:183]
  s_waitcnt lgkmcnt(7)
  ds_read_b64_tr_b16 v[226:227], v246 offset:3840
  v_mfma_f32_16x16x32_bf16 v[184:187], v[208:211], v[16:19], 0
  s_waitcnt lgkmcnt(6)
  ds_read_b64_tr_b16 v[228:229], v247 offset:3072
  v_mfma_f32_16x16x32_bf16 v[188:191], v[212:215], v[16:19], 0
  ds_read_b64_tr_b16 v[230:231], v247 offset:3840
  v_mfma_f32_16x16x32_bf16 v[56:59], v[16:19], v[80:83], 0
  s_waitcnt lgkmcnt(6)
  ds_read_b64_tr_b16 v[200:201], v246 offset:4608
  v_mfma_f32_16x16x32_bf16 v[184:187], v[216:219], v[20:23], v[184:187]
  ds_read_b64_tr_b16 v[202:203], v246 offset:5376
  ds_read_b64_tr_b16 v[204:205], v247 offset:4608
  v_mfma_f32_16x16x32_bf16 v[192:195], v[216:219], v[32:35], 0
  s_waitcnt lgkmcnt(7)
  ds_read_b64_tr_b16 v[206:207], v247 offset:5376
  v_cvt_pk_bf16_f32 v120, v168, v169
  v_mfma_f32_16x16x32_bf16 v[188:191], v[220:223], v[20:23], v[188:191]
  ds_read_b64_tr_b16 v[208:209], v246 offset:6144
  v_cvt_pk_bf16_f32 v121, v170, v171
  v_mfma_f32_16x16x32_bf16 v[196:199], v[220:223], v[32:35], 0
  s_waitcnt lgkmcnt(7)
  ds_read_b64_tr_b16 v[210:211], v246 offset:6912
  v_cvt_pk_bf16_f32 v122, v172, v173
  v_mfma_f32_16x16x32_bf16 v[184:187], v[224:227], v[24:27], v[184:187]
  ds_read_b64_tr_b16 v[212:213], v247 offset:6144
  v_cvt_pk_bf16_f32 v123, v174, v175
  v_mfma_f32_16x16x32_bf16 v[192:195], v[224:227], v[36:39], v[192:195]
  s_waitcnt lgkmcnt(7)
  ds_read_b64_tr_b16 v[214:215], v247 offset:6912
  v_cvt_pk_bf16_f32 v144, v176, v177
  v_mfma_f32_16x16x32_bf16 v[188:191], v[228:231], v[24:27], v[188:191]
  ds_read_b64_tr_b16 v[216:217], v248 offset:0
  v_cvt_pk_bf16_f32 v145, v178, v179
  v_mfma_f32_16x16x32_bf16 v[196:199], v[228:231], v[36:39], v[196:199]
  s_waitcnt lgkmcnt(7)
  ds_read_b64_tr_b16 v[218:219], v248 offset:768
  v_cvt_pk_bf16_f32 v146, v180, v181
  v_mfma_f32_16x16x32_bf16 v[184:187], v[200:203], v[28:31], v[184:187]
  ds_read_b64_tr_b16 v[220:221], v249 offset:0
  v_cvt_pk_bf16_f32 v147, v182, v183
  v_mfma_f32_16x16x32_bf16 v[192:195], v[200:203], v[40:43], v[192:195]
  s_waitcnt lgkmcnt(7)
  ds_read_b64_tr_b16 v[222:223], v249 offset:768
  v_mfma_f32_16x16x32_bf16 v[188:191], v[204:207], v[28:31], v[188:191]
  ds_read_b64_tr_b16 v[224:225], v248 offset:1536
  ds_read_b64_tr_b16 v[226:227], v248 offset:2304
  v_mfma_f32_16x16x32_bf16 v[196:199], v[204:207], v[40:43], v[196:199]
  s_waitcnt lgkmcnt(8)
  ds_read_b64_tr_b16 v[228:229], v249 offset:1536
  v_mfma_f32_16x16x32_bf16 v[192:195], v[208:211], v[44:47], v[192:195]
  s_waitcnt lgkmcnt(7)
  ds_read_b64_tr_b16 v[230:231], v249 offset:2304
  v_mfma_f32_16x16x32_bf16 v[196:199], v[212:215], v[44:47], v[196:199]
  ds_read_b64_tr_b16 v[200:201], v248 offset:3072
  v_mfma_f32_16x16x32_bf16 v[60:63], v[32:35], v[80:83], 0
  s_waitcnt lgkmcnt(7)
  ds_read_b64_tr_b16 v[202:203], v248 offset:3840
  v_mfma_f32_16x16x32_bf16 v[168:171], v[216:219], v[16:19], 0
  s_waitcnt lgkmcnt(6)
  ds_read_b64_tr_b16 v[204:205], v249 offset:3072
  v_mfma_f32_16x16x32_bf16 v[172:175], v[220:223], v[16:19], 0
  ds_read_b64_tr_b16 v[206:207], v249 offset:3840
  v_mfma_f32_16x16x32_bf16 v[56:59], v[20:23], v[80:83], v[56:59]
  s_waitcnt lgkmcnt(6)
  ds_read_b64_tr_b16 v[208:209], v248 offset:4608
  v_mfma_f32_16x16x32_bf16 v[168:171], v[224:227], v[20:23], v[168:171]
  ds_read_b64_tr_b16 v[210:211], v248 offset:5376
  v_cvt_pk_bf16_f32 v124, v184, v185
  v_mfma_f32_16x16x32_bf16 v[176:179], v[224:227], v[32:35], 0
  s_waitcnt lgkmcnt(6)
  ds_read_b64_tr_b16 v[212:213], v249 offset:4608
  v_cvt_pk_bf16_f32 v125, v186, v187
  v_mfma_f32_16x16x32_bf16 v[172:175], v[228:231], v[20:23], v[172:175]
  ds_read_b64_tr_b16 v[214:215], v249 offset:5376
  ds_read_b64_tr_b16 v[216:217], v248 offset:6144
  v_mfma_f32_16x16x32_bf16 v[180:183], v[228:231], v[32:35], 0
  s_waitcnt lgkmcnt(7)
  ds_read_b64_tr_b16 v[218:219], v248 offset:6912
  v_cvt_pk_bf16_f32 v126, v188, v189
  v_mfma_f32_16x16x32_bf16 v[168:171], v[200:203], v[24:27], v[168:171]
  ds_read_b64_tr_b16 v[220:221], v249 offset:6144
  v_cvt_pk_bf16_f32 v127, v190, v191
  v_mfma_f32_16x16x32_bf16 v[176:179], v[200:203], v[36:39], v[176:179]
  s_waitcnt lgkmcnt(7)
  ds_read_b64_tr_b16 v[222:223], v249 offset:6912
  v_cvt_pk_bf16_f32 v148, v192, v193
  v_mfma_f32_16x16x32_bf16 v[172:175], v[204:207], v[24:27], v[172:175]
  ds_read_b64_tr_b16 v[224:225], v250 offset:0
  v_cvt_pk_bf16_f32 v149, v194, v195
  v_mfma_f32_16x16x32_bf16 v[180:183], v[204:207], v[36:39], v[180:183]
  s_waitcnt lgkmcnt(7)
  ds_read_b64_tr_b16 v[226:227], v250 offset:768
  v_cvt_pk_bf16_f32 v150, v196, v197
  v_mfma_f32_16x16x32_bf16 v[168:171], v[208:211], v[28:31], v[168:171]
  ds_read_b64_tr_b16 v[228:229], v251 offset:0
  v_cvt_pk_bf16_f32 v151, v198, v199
  v_mfma_f32_16x16x32_bf16 v[176:179], v[208:211], v[40:43], v[176:179]
  s_waitcnt lgkmcnt(7)
  ds_read_b64_tr_b16 v[230:231], v251 offset:768
  v_mfma_f32_16x16x32_bf16 v[172:175], v[212:215], v[28:31], v[172:175]
  ds_read_b64_tr_b16 v[200:201], v250 offset:1536
  v_mfma_f32_16x16x32_bf16 v[180:183], v[212:215], v[40:43], v[180:183]
  s_waitcnt lgkmcnt(7)
  ds_read_b64_tr_b16 v[202:203], v250 offset:2304
  v_mfma_f32_16x16x32_bf16 v[176:179], v[216:219], v[44:47], v[176:179]
  s_waitcnt lgkmcnt(6)
  ds_read_b64_tr_b16 v[204:205], v251 offset:1536
  ds_read_b64_tr_b16 v[206:207], v251 offset:2304
  v_mfma_f32_16x16x32_bf16 v[180:183], v[220:223], v[44:47], v[180:183]
  ds_read_b64_tr_b16 v[208:209], v250 offset:3072
  v_mfma_f32_16x16x32_bf16 v[60:63], v[36:39], v[80:83], v[60:63]
  s_waitcnt lgkmcnt(7)
  ds_read_b64_tr_b16 v[210:211], v250 offset:3840
  v_mfma_f32_16x16x32_bf16 v[184:187], v[224:227], v[16:19], 0
  s_waitcnt lgkmcnt(6)
  ds_read_b64_tr_b16 v[212:213], v251 offset:3072
  v_mfma_f32_16x16x32_bf16 v[188:191], v[228:231], v[16:19], 0
  ds_read_b64_tr_b16 v[214:215], v251 offset:3840
  v_mfma_f32_16x16x32_bf16 v[56:59], v[24:27], v[80:83], v[56:59]
  s_waitcnt lgkmcnt(6)
  ds_read_b64_tr_b16 v[216:217], v250 offset:4608
  v_mfma_f32_16x16x32_bf16 v[184:187], v[200:203], v[20:23], v[184:187]
  ds_read_b64_tr_b16 v[218:219], v250 offset:5376
  v_cvt_pk_bf16_f32 v128, v168, v169
  v_mfma_f32_16x16x32_bf16 v[192:195], v[200:203], v[32:35], 0
  s_waitcnt lgkmcnt(6)
  ds_read_b64_tr_b16 v[220:221], v251 offset:4608
  v_cvt_pk_bf16_f32 v129, v170, v171
  v_mfma_f32_16x16x32_bf16 v[188:191], v[204:207], v[20:23], v[188:191]
  ds_read_b64_tr_b16 v[222:223], v251 offset:5376
  v_cvt_pk_bf16_f32 v130, v172, v173
  v_mfma_f32_16x16x32_bf16 v[196:199], v[204:207], v[32:35], 0
  s_waitcnt lgkmcnt(6)
  ds_read_b64_tr_b16 v[224:225], v250 offset:6144
  ds_read_b64_tr_b16 v[226:227], v250 offset:6912
  v_mfma_f32_16x16x32_bf16 v[184:187], v[208:211], v[24:27], v[184:187]
  ds_read_b64_tr_b16 v[228:229], v251 offset:6144
  v_cvt_pk_bf16_f32 v131, v174, v175
  v_mfma_f32_16x16x32_bf16 v[192:195], v[208:211], v[36:39], v[192:195]
  s_waitcnt lgkmcnt(7)
  ds_read_b64_tr_b16 v[230:231], v251 offset:6912
  v_cvt_pk_bf16_f32 v152, v176, v177
  v_mfma_f32_16x16x32_bf16 v[188:191], v[212:215], v[24:27], v[188:191]
  ds_read_b64_tr_b16 v[200:201], v244 offset:256
  v_cvt_pk_bf16_f32 v153, v178, v179
  v_mfma_f32_16x16x32_bf16 v[196:199], v[212:215], v[36:39], v[196:199]
  s_waitcnt lgkmcnt(7)
  ds_read_b64_tr_b16 v[202:203], v244 offset:1024
  v_cvt_pk_bf16_f32 v154, v180, v181
  v_mfma_f32_16x16x32_bf16 v[184:187], v[216:219], v[28:31], v[184:187]
  ds_read_b64_tr_b16 v[204:205], v245 offset:256
  v_cvt_pk_bf16_f32 v155, v182, v183
  v_mfma_f32_16x16x32_bf16 v[192:195], v[216:219], v[40:43], v[192:195]
  s_waitcnt lgkmcnt(7)
  ds_read_b64_tr_b16 v[206:207], v245 offset:1024
  v_mfma_f32_16x16x32_bf16 v[188:191], v[220:223], v[28:31], v[188:191]
  ds_read_b64_tr_b16 v[208:209], v244 offset:1792
  v_mfma_f32_16x16x32_bf16 v[196:199], v[220:223], v[40:43], v[196:199]
  s_waitcnt lgkmcnt(7)
  ds_read_b64_tr_b16 v[210:211], v244 offset:2560
  v_mfma_f32_16x16x32_bf16 v[192:195], v[224:227], v[44:47], v[192:195]
  s_waitcnt lgkmcnt(6)
  ds_read_b64_tr_b16 v[212:213], v245 offset:1792
  v_mfma_f32_16x16x32_bf16 v[196:199], v[228:231], v[44:47], v[196:199]
  ds_read_b64_tr_b16 v[214:215], v245 offset:2560
  ds_read_b64_tr_b16 v[216:217], v244 offset:3328
  v_mfma_f32_16x16x32_bf16 v[60:63], v[40:43], v[80:83], v[60:63]
  ds_read_b64_tr_b16 v[218:219], v244 offset:4096
  s_cmp_lt_u32 s40, 5
  s_cbranch_scc1 M_l3
  s_waitcnt vmcnt(0)
  s_barrier
M_l3:
  s_waitcnt lgkmcnt(8)
  v_mfma_f32_16x16x32_bf16 v[168:171], v[200:203], v[16:19], 0
  s_waitcnt lgkmcnt(6)
  ds_read_b64_tr_b16 v[220:221], v245 offset:3328
  v_mfma_f32_16x16x32_bf16 v[172:175], v[204:207], v[16:19], 0
  ds_read_b64_tr_b16 v[222:223], v245 offset:4096
  v_mfma_f32_16x16x32_bf16 v[56:59], v[28:31], v[80:83], v[56:59]
  s_waitcnt lgkmcnt(6)
  ds_read_b64_tr_b16 v[224:225], v244 offset:4864
  v_mfma_f32_16x16x32_bf16 v[168:171], v[208:211], v[20:23], v[168:171]
  ds_read_b64_tr_b16 v[226:227], v244 offset:5632
  v_cvt_pk_bf16_f32 v132, v184, v185
  v_mfma_f32_16x16x32_bf16 v[176:179], v[208:211], v[32:35], 0
  s_waitcnt lgkmcnt(6)
  ds_read_b64_tr_b16 v[228:229], v245 offset:4864
  v_cvt_pk_bf16_f32 v133, v186, v187
  v_mfma_f32_16x16x32_bf16 v[172:175], v[212:215], v[20:23], v[172:175]
  ds_read_b64_tr_b16 v[230:231], v245 offset:5632
  v_cvt_pk_bf16_f32 v134, v188, v189
  v_mfma_f32_16x16x32_bf16 v[180:183], v[212:215], v[32:35], 0
  s_waitcnt lgkmcnt(6)
  ds_read_b64_tr_b16 v[200:201], v244 offset:6400
  v_cvt_pk_bf16_f32 v135, v190, v191
  v_mfma_f32_16x16x32_bf16 v[168:171], v[216:219], v[24:27], v[168:171]
  ds_read_b64_tr_b16 v[202:203], v244 offset:7168
  v_cvt_pk_bf16_f32 v156, v192, v193
  v_mfma_f32_16x16x32_bf16 v[176:179], v[216:219], v[36:39], v[176:179]
  s_waitcnt lgkmcnt(6)
  ds_read_b64_tr_b16 v[204:205], v245 offset:6400
  ds_read_b64_tr_b16 v[206:207], v245 offset:7168
  v_mfma_f32_16x16x32_bf16 v[172:175], v[220:223], v[24:27], v[172:175]
  ds_read_b64_tr_b16 v[208:209], v246 offset:256
  v_cvt_pk_bf16_f32 v157, v194, v195
  v_mfma_f32_16x16x32_bf16 v[180:183], v[220:223], v[36:39], v[180:183]
  s_waitcnt lgkmcnt(7)
  ds_read_b64_tr_b16 v[210:211], v246 offset:1024
  v_cvt_pk_bf16_f32 v158, v196, v197
  v_mfma_f32_16x16x32_bf16 v[168:171], v[224:227], v[28:31], v[168:171]
  ds_read_b64_tr_b16 v[212:213], v247 offset:256
  v_cvt_pk_bf16_f32 v159, v198, v199
  v_mfma_f32_16x16x32_bf16 v[176:179], v[224:227], v[40:43], v[176:179]
  s_waitcnt lgkmcnt(7)
  ds_read_b64_tr_b16 v[214:215], v247 offset:1024
  v_mfma_f32_16x16x32_bf16 v[172:175], v[228:231], v[28:31], v[172:175]
  ds_read_b64_tr_b16 v[216:217], v246 offset:1792
  v_mfma_f32_16x16x32_bf16 v[180:183], v[228:231], v[40:43], v[180:183]
  s_waitcnt lgkmcnt(7)
  ds_read_b64_tr_b16 v[218:219], v246 offset:2560
  v_mfma_f32_16x16x32_bf16 v[176:179], v[200:203], v[44:47], v[176:179]
  s_waitcnt lgkmcnt(6)
  ds_read_b64_tr_b16 v[220:221], v247 offset:1792
  v_mfma_f32_16x16x32_bf16 v[180:183], v[204:207], v[44:47], v[180:183]
  ds_read_b64_tr_b16 v[222:223], v247 offset:2560
  v_mfma_f32_16x16x32_bf16 v[60:63], v[44:47], v[80:83], v[60:63]
  s_waitcnt lgkmcnt(6)
  ds_read_b64_tr_b16 v[224:225], v246 offset:3328
  v_mfma_f32_16x16x32_bf16 v[184:187], v[208:211], v[16:19], 0
  s_waitcnt lgkmcnt(5)
  ds_read_b64_tr_b16 v[226:227], v246 offset:4096
  ds_read_b64_tr_b16 v[228:229], v247 offset:3328
  v_mfma_f32_16x16x32_bf16 v[188:191], v[212:215], v[16:19], 0
  s_waitcnt lgkmcnt(5)
  ds_read_b64_tr_b16 v[230:231], v247 offset:4096
  v_mfma_f32_16x16x32_bf16 v[184:187], v[216:219], v[20:23], v[184:187]
  ds_read_b64_tr_b16 v[200:201], v246 offset:4864
  v_mfma_f32_16x16x32_bf16 v[192:195], v[216:219], v[32:35], 0
  s_waitcnt lgkmcnt(5)
  ds_read_b64_tr_b16 v[202:203], v246 offset:5632
  v_cvt_pk_bf16_f32 v136, v168, v169
  v_mfma_f32_16x16x32_bf16 v[188:191], v[220:223], v[20:23], v[188:191]
  ds_read_b64_tr_b16 v[204:205], v247 offset:4864
  v_cvt_pk_bf16_f32 v137, v170, v171
  v_mfma_f32_16x16x32_bf16 v[196:199], v[220:223], v[32:35], 0
  s_waitcnt lgkmcnt(5)
  ds_read_b64_tr_b16 v[206:207], v247 offset:5632
  v_cvt_pk_bf16_f32 v138, v172, v173
  v_mfma_f32_16x16x32_bf16 v[184:187], v[224:227], v[24:27], v[184:187]
  ds_read_b64_tr_b16 v[208:209], v246 offset:6400
  v_cvt_pk_bf16_f32 v139, v174, v175
  v_mfma_f32_16x16x32_bf16 v[192:195], v[224:227], v[36:39], v[192:195]
  s_waitcnt lgkmcnt(5)
  ds_read_b64_tr_b16 v[210:211], v246 offset:7168
  v_cvt_pk_bf16_f32 v160, v176, v177
  v_mfma_f32_16x16x32_bf16 v[188:191], v[228:231], v[24:27], v[188:191]
  ds_read_b64_tr_b16 v[212:213], v247 offset:6400
  v_cvt_pk_bf16_f32 v161, v178, v179
  v_mfma_f32_16x16x32_bf16 v[196:199], v[228:231], v[36:39], v[196:199]
  s_waitcnt lgkmcnt(5)
  ds_read_b64_tr_b16 v[214:215], v247 offset:7168
  v_cvt_pk_bf16_f32 v162, v180, v181
  v_mfma_f32_16x16x32_bf16 v[184:187], v[200:203], v[28:31], v[184:187]
  v_cvt_pk_bf16_f32 v163, v182, v183
  v_mfma_f32_16x16x32_bf16 v[192:195], v[200:203], v[40:43], v[192:195]
  s_waitcnt lgkmcnt(4)
  v_mfma_f32_16x16x32_bf16 v[188:191], v[204:207], v[28:31], v[188:191]
  v_mfma_f32_16x16x32_bf16 v[196:199], v[204:207], v[40:43], v[196:199]
  s_waitcnt lgkmcnt(2)
  v_mfma_f32_16x16x32_bf16 v[192:195], v[208:211], v[44:47], v[192:195]
  s_waitcnt lgkmcnt(0)
  v_mfma_f32_16x16x32_bf16 v[196:199], v[212:215], v[44:47], v[196:199]
  s_cmp_ge_u32 s40, 5
  s_cbranch_scc1 M_e3
  s_barrier
  s_mov_b32 s55, 10240
  buffer_load_dwordx4 v[232:235], v252, s[24:27], s55 offen offset:0 sc1
  buffer_load_dwordx4 v[236:239], v252, s[24:27], s55 offen offset:1024 sc1
  s_mul_i32 s55, s40, 12288
  s_add_u32 s59, s55, 12288
  s_mov_b32 m0, s55
  s_add_u32 s55, s55, 4096
  buffer_load_dwordx4 v252, s[24:27], s59 offen offset:0 sc1 lds
  buffer_load_dwordx4 v252, s[24:27], s59 offen offset:1024 sc1 lds
  buffer_load_dwordx4 v252, s[24:27], s59 offen offset:2048 sc1 lds
  buffer_load_dwordx4 v252, s[24:27], s59 offen offset:3072 sc1 lds
  s_add_u32 s59, s59, 4096
  s_mov_b32 m0, s55
  s_add_u32 s55, s55, 4096
  buffer_load_dwordx4 v252, s[24:27], s59 offen offset:0 sc1 lds
  buffer_load_dwordx4 v252, s[24:27], s59 offen offset:1024 sc1 lds
  buffer_load_dwordx4 v252, s[24:27], s59 offen offset:2048 sc1 lds
  buffer_load_dwordx4 v252, s[24:27], s59 offen offset:3072 sc1 lds
  s_add_u32 s59, s59, 4096
  s_mov_b32 m0, s55
  s_add_u32 s55, s55, 4096
  buffer_load_dwordx4 v252, s[24:27], s59 offen offset:0 sc1 lds
  buffer_load_dwordx4 v252, s[24:27], s59 offen offset:1024 sc1 lds
  buffer_load_dwordx4 v252, s[24:27], s59 offen offset:2048 sc1 lds
  buffer_load_dwordx4 v252, s[24:27], s59 offen offset:3072 sc1 lds
  s_add_u32 s59, s59, 4096
M_e3:
  v_cvt_pk_bf16_f32 v140, v184, v185
  v_cvt_pk_bf16_f32 v141, v186, v187
  v_cvt_pk_bf16_f32 v142, v188, v189
  v_cvt_pk_bf16_f32 v143, v190, v191
  v_cvt_pk_bf16_f32 v164, v192, v193
  v_cvt_pk_bf16_f32 v165, v194, v195
  v_cvt_pk_bf16_f32 v166, v196, v197
  v_cvt_pk_bf16_f32 v167, v198, v199
  ds_read_b128 v[200:203], v253 offset:0
  ds_read_b128 v[204:207], v253 offset:1024
  ds_read_b128 v[208:211], v253 offset:2048
  ds_read_b128 v[212:215], v253 offset:3072
  ds_read_b128 v[216:219], v253 offset:4096
  ds_read_b128 v[220:223], v253 offset:5120
  s_waitcnt lgkmcnt(5)
  v_mfma_f32_16x16x32_bf16 v[168:171], v[120:123], v[200:203], 0
  ds_read_b128 v[224:227], v253 offset:6144
  v_rcp_f32 v56, v56
  v_mfma_f32_16x16x32_bf16 v[176:179], v[144:147], v[200:203], 0
  s_waitcnt lgkmcnt(5)
  v_rcp_f32 v57, v57
  v_rcp_f32 v58, v58
  v_mfma_f32_16x16x32_bf16 v[172:175], v[120:123], v[204:207], 0
  ds_read_b128 v[228:231], v253 offset:7168
  v_rcp_f32 v59, v59
  v_mfma_f32_16x16x32_bf16 v[180:183], v[144:147], v[204:207], 0
  s_waitcnt lgkmcnt(5)
  v_rcp_f32 v60, v60
  v_rcp_f32 v61, v61
  v_mfma_f32_16x16x32_bf16 v[168:171], v[124:127], v[208:211], v[168:171]
  ds_read_b128 v[200:203], v253 offset:8192
  v_rcp_f32 v62, v62
  v_mfma_f32_16x16x32_bf16 v[176:179], v[148:151], v[208:211], v[176:179]
  s_waitcnt lgkmcnt(5)
  v_rcp_f32 v63, v63
  v_mfma_f32_16x16x32_bf16 v[172:175], v[124:127], v[212:215], v[172:175]
  ds_read_b128 v[204:207], v253 offset:9216
  v_mfma_f32_16x16x32_bf16 v[180:183], v[148:151], v[212:215], v[180:183]
  s_waitcnt lgkmcnt(5)
  v_mfma_f32_16x16x32_bf16 v[168:171], v[128:131], v[216:219], v[168:171]
  v_mfma_f32_16x16x32_bf16 v[176:179], v[152:155], v[216:219], v[176:179]
  s_waitcnt lgkmcnt(4)
  v_mfma_f32_16x16x32_bf16 v[172:175], v[128:131], v[220:223], v[172:175]
  v_mfma_f32_16x16x32_bf16 v[180:183], v[152:155], v[220:223], v[180:183]
  s_waitcnt lgkmcnt(3)
  v_mfma_f32_16x16x32_bf16 v[168:171], v[132:135], v[224:227], v[168:171]
  v_mfma_f32_16x16x32_bf16 v[176:179], v[156:159], v[224:227], v[176:179]
  s_waitcnt lgkmcnt(2)
  v_mfma_f32_16x16x32_bf16 v[172:175], v[132:135], v[228:231], v[172:175]
  v_mfma_f32_16x16x32_bf16 v[180:183], v[156:159], v[228:231], v[180:183]
  s_waitcnt lgkmcnt(1)
  v_mfma_f32_16x16x32_bf16 v[168:171], v[136:139], v[200:203], v[168:171]
  v_mfma_f32_16x16x32_bf16 v[176:179], v[160:163], v[200:203], v[176:179]
  s_waitcnt lgkmcnt(0)
  v_mfma_f32_16x16x32_bf16 v[172:175], v[136:139], v[204:207], v[172:175]
  v_mfma_f32_16x16x32_bf16 v[180:183], v[160:163], v[204:207], v[180:183]
  s_waitcnt vmcnt(12)
  v_mfma_f32_16x16x32_bf16 v[168:171], v[140:143], v[232:235], v[168:171]
  v_mfma_f32_16x16x32_bf16 v[176:179], v[164:167], v[232:235], v[176:179]
  v_mfma_f32_16x16x32_bf16 v[172:175], v[140:143], v[236:239], v[172:175]
  v_mfma_f32_16x16x32_bf16 v[180:183], v[164:167], v[236:239], v[180:183]
  s_cmp_ge_u32 s40, 5
  s_cbranch_scc1 M_e4
  s_waitcnt vmcnt(0)
  s_barrier
M_e4:
  ds_read_b128 v[216:219], v252 offset:0
  ds_read_b128 v[220:223], v252 offset:1024
  ds_read_b128 v[224:227], v252 offset:2048
  ds_read_b128 v[228:231], v252 offset:3072
  ds_read_b128 v[200:203], v252 offset:4096
  ds_read_b128 v[204:207], v252 offset:5120
  s_waitcnt lgkmcnt(5)
  v_mfma_f32_16x16x32_bf16 v[184:187], v[120:123], v[216:219], 0
  ds_read_b128 v[208:211], v252 offset:6144
  v_mfma_f32_16x16x32_bf16 v[192:195], v[144:147], v[216:219], 0
  s_waitcnt lgkmcnt(5)
  v_mfma_f32_16x16x32_bf16 v[188:191], v[120:123], v[220:223], 0
  ds_read_b128 v[212:215], v252 offset:7168
  v_mul_f32 v168, v168, v56
  v_mfma_f32_16x16x32_bf16 v[196:199], v[144:147], v[220:223], 0
  s_waitcnt lgkmcnt(5)
  v_mul_f32 v172, v172, v56
  v_cvt_pk_bf16_f32 v64, v168, v172
  v_mfma_f32_16x16x32_bf16 v[184:187], v[124:127], v[224:227], v[184:187]
  ds_read_b128 v[216:219], v252 offset:8192
  v_mul_f32 v169, v169, v57
  v_mfma_f32_16x16x32_bf16 v[192:195], v[148:151], v[224:227], v[192:195]
  s_waitcnt lgkmcnt(5)
  v_mul_f32 v173, v173, v57
  v_cvt_pk_bf16_f32 v66, v169, v173
  v_mfma_f32_16x16x32_bf16 v[188:191], v[124:127], v[228:231], v[188:191]
  ds_read_b128 v[220:223], v252 offset:9216
  v_mul_f32 v170, v170, v58
  v_mfma_f32_16x16x32_bf16 v[196:199], v[148:151], v[228:231], v[196:199]
  s_waitcnt lgkmcnt(5)
  v_mul_f32 v174, v174, v58
  v_cvt_pk_bf16_f32 v68, v170, v174
  v_mfma_f32_16x16x32_bf16 v[184:187], v[128:131], v[200:203], v[184:187]
  ds_read_b128 v[224:227], v252 offset:10240
  v_mul_f32 v171, v171, v59
  v_mfma_f32_16x16x32_bf16 v[192:195], v[152:155], v[200:203], v[192:195]
  s_waitcnt lgkmcnt(5)
  v_mul_f32 v175, v175, v59
  v_cvt_pk_bf16_f32 v70, v171, v175
  v_mfma_f32_16x16x32_bf16 v[188:191], v[128:131], v[204:207], v[188:191]
  ds_read_b128 v[228:231], v252 offset:11264
  v_mul_f32 v176, v176, v60
  v_mfma_f32_16x16x32_bf16 v[196:199], v[152:155], v[204:207], v[196:199]
  s_waitcnt lgkmcnt(5)
  v_mul_f32 v180, v180, v60
  v_cvt_pk_bf16_f32 v72, v176, v180
  v_mfma_f32_16x16x32_bf16 v[184:187], v[132:135], v[208:211], v[184:187]
  ds_read_b128 v[200:203], v252 offset:12288
  v_mul_f32 v177, v177, v61
  v_mfma_f32_16x16x32_bf16 v[192:195], v[156:159], v[208:211], v[192:195]
  s_waitcnt lgkmcnt(5)
  v_mul_f32 v181, v181, v61
  v_cvt_pk_bf16_f32 v74, v177, v181
  v_mfma_f32_16x16x32_bf16 v[188:191], v[132:135], v[212:215], v[188:191]
  ds_read_b128 v[204:207], v252 offset:13312
  v_mul_f32 v178, v178, v62
  v_mfma_f32_16x16x32_bf16 v[196:199], v[156:159], v[212:215], v[196:199]
  s_waitcnt lgkmcnt(5)
  v_mul_f32 v182, v182, v62
  v_cvt_pk_bf16_f32 v76, v178, v182
  v_mfma_f32_16x16x32_bf16 v[184:187], v[136:139], v[216:219], v[184:187]
  ds_read_b128 v[208:211], v252 offset:14336
  v_mul_f32 v179, v179, v63
  v_mfma_f32_16x16x32_bf16 v[192:195], v[160:163], v[216:219], v[192:195]
  s_waitcnt lgkmcnt(5)
  v_mul_f32 v183, v183, v63
  v_cvt_pk_bf16_f32 v78, v179, v183
  v_mfma_f32_16x16x32_bf16 v[188:191], v[136:139], v[220:223], v[188:191]
  ds_read_b128 v[212:215], v252 offset:15360
  v_mfma_f32_16x16x32_bf16 v[196:199], v[160:163], v[220:223], v[196:199]
  s_waitcnt lgkmcnt(5)
  v_mfma_f32_16x16x32_bf16 v[184:187], v[140:143], v[224:227], v[184:187]
  ds_read_b128 v[216:219], v252 offset:16384
  v_mfma_f32_16x16x32_bf16 v[192:195], v[164:167], v[224:227], v[192:195]
  s_waitcnt lgkmcnt(5)
  v_mfma_f32_16x16x32_bf16 v[188:191], v[140:143], v[228:231], v[188:191]
  ds_read_b128 v[220:223], v252 offset:17408
  v_mfma_f32_16x16x32_bf16 v[196:199], v[164:167], v[228:231], v[196:199]
  s_setprio 2
  s_waitcnt lgkmcnt(5)
  v_mfma_f32_16x16x32_bf16 v[168:171], v[120:123], v[200:203], 0
  ds_read_b128 v[224:227], v252 offset:18432
  v_mfma_f32_16x16x32_bf16 v[176:179], v[144:147], v[200:203], 0
  s_waitcnt lgkmcnt(5)
  v_mfma_f32_16x16x32_bf16 v[172:175], v[120:123], v[204:207], 0
  ds_read_b128 v[228:231], v252 offset:19456
  v_mul_f32 v184, v184, v56
  v_mfma_f32_16x16x32_bf16 v[180:183], v[144:147], v[204:207], 0
  s_waitcnt lgkmcnt(5)
  v_mul_f32 v188, v188, v56
  v_cvt_pk_bf16_f32 v65, v184, v188
  v_mfma_f32_16x16x32_bf16 v[168:171], v[124:127], v[208:211], v[168:171]
  ds_read_b128 v[200:203], v252 offset:20480
  buffer_store_dwordx2 v[64:65], v4, s[20:23], 0 offen offset:0 sc1
  v_mfma_f32_16x16x32_bf16 v[176:179], v[148:151], v[208:211], v[176:179]
  s_waitcnt lgkmcnt(5)
  v_mul_f32 v185, v185, v57
  v_mul_f32 v189, v189, v57
  v_mfma_f32_16x16x32_bf16 v[172:175], v[124:127], v[212:215], v[172:175]
  ds_read_b128 v[204:207], v252 offset:21504
  v_cvt_pk_bf16_f32 v67, v185, v189
  v_mfma_f32_16x16x32_bf16 v[180:183], v[148:151], v[212:215], v[180:183]
  s_waitcnt lgkmcnt(5)
  buffer_store_dwordx2 v[66:67], v5, s[20:23], 0 offen offset:0 sc1
  v_mul_f32 v186, v186, v58
  v_mfma_f32_16x16x32_bf16 v[168:171], v[128:131], v[216:219], v[168:171]
  ds_read_b128 v[208:211], v252 offset:22528
  v_mul_f32 v190, v190, v58
  v_mfma_f32_16x16x32_bf16 v[176:179], v[152:155], v[216:219], v[176:179]
  s_waitcnt lgkmcnt(5)
  v_cvt_pk_bf16_f32 v69, v186, v190
  buffer_store_dwordx2 v[68:69], v6, s[20:23], 0 offen offset:0 sc1
  v_mfma_f32_16x16x32_bf16 v[172:175], v[128:131], v[220:223], v[172:175]
  ds_read_b128 v[212:215], v252 offset:23552
  v_mul_f32 v187, v187, v59
  v_mfma_f32_16x16x32_bf16 v[180:183], v[152:155], v[220:223], v[180:183]
  s_waitcnt lgkmcnt(5)
  v_mul_f32 v191, v191, v59
  v_cvt_pk_bf16_f32 v71, v187, v191
  v_mfma_f32_16x16x32_bf16 v[168:171], v[132:135], v[224:227], v[168:171]
  ds_read_b128 v[216:219], v252 offset:24576
  buffer_store_dwordx2 v[70:71], v7, s[20:23], 0 offen offset:0 sc1
  v_mfma_f32_16x16x32_bf16 v[176:179], v[156:159], v[224:227], v[176:179]
  s_waitcnt lgkmcnt(5)
  v_mul_f32 v192, v192, v60
  v_mul_f32 v196, v196, v60
  v_mfma_f32_16x16x32_bf16 v[172:175], v[132:135], v[228:231], v[172:175]
  ds_read_b128 v[220:223], v252 offset:25600
  v_cvt_pk_bf16_f32 v73, v192, v196
  v_mfma_f32_16x16x32_bf16 v[180:183], v[156:159], v[228:231], v[180:183]
  s_waitcnt lgkmcnt(5)
  buffer_store_dwordx2 v[72:73], v8, s[20:23], 0 offen offset:0 sc1
  v_mul_f32 v193, v193, v61
  v_mfma_f32_16x16x32_bf16 v[168:171], v[136:139], v[200:203], v[168:171]
  ds_read_b128 v[224:227], v252 offset:26624
  v_mul_f32 v197, v197, v61
  v_mfma_f32_16x16x32_bf16 v[176:179], v[160:163], v[200:203], v[176:179]
  s_waitcnt lgkmcnt(5)
  v_cvt_pk_bf16_f32 v75, v193, v197
  buffer_store_dwordx2 v[74:75], v9, s[20:23], 0 offen offset:0 sc1
  v_mfma_f32_16x16x32_bf16 v[172:175], v[136:139], v[204:207], v[172:175]
  ds_read_b128 v[228:231], v252 offset:27648
  v_mul_f32 v194, v194, v62
  v_mfma_f32_16x16x32_bf16 v[180:183], v[160:163], v[204:207], v[180:183]
  s_waitcnt lgkmcnt(5)
  v_mul_f32 v198, v198, v62
  v_cvt_pk_bf16_f32 v77, v194, v198
  v_mfma_f32_16x16x32_bf16 v[168:171], v[140:143], v[208:211], v[168:171]
  ds_read_b128 v[200:203], v252 offset:28672
  buffer_store_dwordx2 v[76:77], v10, s[20:23], 0 offen offset:0 sc1
  v_mfma_f32_16x16x32_bf16 v[176:179], v[164:167], v[208:211], v[176:179]
  s_waitcnt lgkmcnt(5)
  v_mul_f32 v195, v195, v63
  v_mul_f32 v199, v199, v63
  v_mfma_f32_16x16x32_bf16 v[172:175], v[140:143], v[212:215], v[172:175]
  ds_read_b128 v[204:207], v252 offset:29696
  v_cvt_pk_bf16_f32 v79, v195, v199
  v_mfma_f32_16x16x32_bf16 v[180:183], v[164:167], v[212:215], v[180:183]
  s_waitcnt lgkmcnt(5)
  buffer_store_dwordx2 v[78:79], v11, s[20:23], 0 offen offset:0 sc1
  v_mfma_f32_16x16x32_bf16 v[184:187], v[120:123], v[216:219], 0
  ds_read_b128 v[208:211], v252 offset:30720
  v_mfma_f32_16x16x32_bf16 v[192:195], v[144:147], v[216:219], 0
  s_waitcnt lgkmcnt(5)
  v_mfma_f32_16x16x32_bf16 v[188:191], v[120:123], v[220:223], 0
  ds_read_b128 v[212:215], v252 offset:31744
  v_mul_f32 v168, v168, v56
  v_mfma_f32_16x16x32_bf16 v[196:199], v[144:147], v[220:223], 0
  s_waitcnt lgkmcnt(5)
  v_mul_f32 v172, v172, v56
  v_cvt_pk_bf16_f32 v64, v168, v172
  v_mfma_f32_16x16x32_bf16 v[184:187], v[124:127], v[224:227], v[184:187]
  ds_read_b128 v[216:219], v252 offset:32768
  v_mul_f32 v169, v169, v57
  v_mfma_f32_16x16x32_bf16 v[192:195], v[148:151], v[224:227], v[192:195]
  s_waitcnt lgkmcnt(5)
  v_mul_f32 v173, v173, v57
  v_cvt_pk_bf16_f32 v66, v169, v173
  v_mfma_f32_16x16x32_bf16 v[188:191], v[124:127], v[228:231], v[188:191]
  ds_read_b128 v[220:223], v252 offset:33792
  v_mul_f32 v170, v170, v58
  v_mfma_f32_16x16x32_bf16 v[196:199], v[148:151], v[228:231], v[196:199]
  s_waitcnt lgkmcnt(5)
  v_mul_f32 v174, v174, v58
  v_cvt_pk_bf16_f32 v68, v170, v174
  v_mfma_f32_16x16x32_bf16 v[184:187], v[128:131], v[200:203], v[184:187]
  ds_read_b128 v[224:227], v252 offset:34816
  v_mul_f32 v171, v171, v59
  v_mfma_f32_16x16x32_bf16 v[192:195], v[152:155], v[200:203], v[192:195]
  s_waitcnt lgkmcnt(5)
  v_mul_f32 v175, v175, v59
  v_cvt_pk_bf16_f32 v70, v171, v175
  v_mfma_f32_16x16x32_bf16 v[188:191], v[128:131], v[204:207], v[188:191]
  ds_read_b128 v[228:231], v252 offset:35840
  v_mul_f32 v176, v176, v60
  v_mfma_f32_16x16x32_bf16 v[196:199], v[152:155], v[204:207], v[196:199]
  s_waitcnt lgkmcnt(5)
  v_mul_f32 v180, v180, v60
  v_cvt_pk_bf16_f32 v72, v176, v180
  v_mfma_f32_16x16x32_bf16 v[184:187], v[132:135], v[208:211], v[184:187]
  ds_read_b128 v[200:203], v252 offset:36864
  v_mul_f32 v177, v177, v61
  v_mfma_f32_16x16x32_bf16 v[192:195], v[156:159], v[208:211], v[192:195]
  s_waitcnt lgkmcnt(5)
  v_mul_f32 v181, v181, v61
  v_cvt_pk_bf16_f32 v74, v177, v181
  v_mfma_f32_16x16x32_bf16 v[188:191], v[132:135], v[212:215], v[188:191]
  ds_read_b128 v[204:207], v252 offset:37888
  v_mul_f32 v178, v178, v62
  v_mfma_f32_16x16x32_bf16 v[196:199], v[156:159], v[212:215], v[196:199]
  s_waitcnt lgkmcnt(5)
  v_mul_f32 v182, v182, v62
  v_cvt_pk_bf16_f32 v76, v178, v182
  v_mfma_f32_16x16x32_bf16 v[184:187], v[136:139], v[216:219], v[184:187]
  ds_read_b128 v[208:211], v252 offset:38912
  v_mul_f32 v179, v179, v63
  v_mfma_f32_16x16x32_bf16 v[192:195], v[160:163], v[216:219], v[192:195]
  s_waitcnt lgkmcnt(5)
  v_mul_f32 v183, v183, v63
  v_cvt_pk_bf16_f32 v78, v179, v183
  v_mfma_f32_16x16x32_bf16 v[188:191], v[136:139], v[220:223], v[188:191]
  ds_read_b128 v[212:215], v252 offset:39936
  v_mfma_f32_16x16x32_bf16 v[196:199], v[160:163], v[220:223], v[196:199]
  s_waitcnt lgkmcnt(5)
  v_mfma_f32_16x16x32_bf16 v[184:187], v[140:143], v[224:227], v[184:187]
  ds_read_b128 v[216:219], v252 offset:40960
  v_mfma_f32_16x16x32_bf16 v[192:195], v[164:167], v[224:227], v[192:195]
  s_waitcnt lgkmcnt(5)
  v_mfma_f32_16x16x32_bf16 v[188:191], v[140:143], v[228:231], v[188:191]
  ds_read_b128 v[220:223], v252 offset:41984
  v_mfma_f32_16x16x32_bf16 v[196:199], v[164:167], v[228:231], v[196:199]
  s_setprio 1
  s_waitcnt lgkmcnt(5)
  v_mfma_f32_16x16x32_bf16 v[168:171], v[120:123], v[200:203], 0
  ds_read_b128 v[224:227], v252 offset:43008
  v_mfma_f32_16x16x32_bf16 v[176:179], v[144:147], v[200:203], 0
  s_waitcnt lgkmcnt(5)
  v_mfma_f32_16x16x32_bf16 v[172:175], v[120:123], v[204:207], 0
  ds_read_b128 v[228:231], v252 offset:44032
  v_mul_f32 v184, v184, v56
  v_mfma_f32_16x16x32_bf16 v[180:183], v[144:147], v[204:207], 0
  s_waitcnt lgkmcnt(5)
  v_mul_f32 v188, v188, v56
  v_cvt_pk_bf16_f32 v65, v184, v188
  v_mfma_f32_16x16x32_bf16 v[168:171], v[124:127], v[208:211], v[168:171]
  ds_read_b128 v[200:203], v252 offset:45056
  buffer_store_dwordx2 v[64:65], v4, s[20:23], 0 offen offset:128 sc1
  v_mfma_f32_16x16x32_bf16 v[176:179], v[148:151], v[208:211], v[176:179]
  s_waitcnt lgkmcnt(5)
  v_mul_f32 v185, v185, v57
  v_mul_f32 v189, v189, v57
  v_mfma_f32_16x16x32_bf16 v[172:175], v[124:127], v[212:215], v[172:175]
  ds_read_b128 v[204:207], v252 offset:46080
  v_cvt_pk_bf16_f32 v67, v185, v189
  v_mfma_f32_16x16x32_bf16 v[180:183], v[148:151], v[212:215], v[180:183]
  s_waitcnt lgkmcnt(5)
  buffer_store_dwordx2 v[66:67], v5, s[20:23], 0 offen offset:128 sc1
  v_mul_f32 v186, v186, v58
  v_mfma_f32_16x16x32_bf16 v[168:171], v[128:131], v[216:219], v[168:171]
  ds_read_b128 v[208:211], v252 offset:47104
  v_mul_f32 v190, v190, v58
  v_mfma_f32_16x16x32_bf16 v[176:179], v[152:155], v[216:219], v[176:179]
  s_waitcnt lgkmcnt(5)
  v_cvt_pk_bf16_f32 v69, v186, v190
  buffer_store_dwordx2 v[68:69], v6, s[20:23], 0 offen offset:128 sc1
  v_mfma_f32_16x16x32_bf16 v[172:175], v[128:131], v[220:223], v[172:175]
  ds_read_b128 v[212:215], v252 offset:48128
  v_mul_f32 v187, v187, v59
  v_mfma_f32_16x16x32_bf16 v[180:183], v[152:155], v[220:223], v[180:183]
  s_waitcnt lgkmcnt(5)
  v_mul_f32 v191, v191, v59
  v_cvt_pk_bf16_f32 v71, v187, v191
  v_mfma_f32_16x16x32_bf16 v[168:171], v[132:135], v[224:227], v[168:171]
  ds_read_b128 v[216:219], v252 offset:49152
  buffer_store_dwordx2 v[70:71], v7, s[20:23], 0 offen offset:128 sc1
  v_mfma_f32_16x16x32_bf16 v[176:179], v[156:159], v[224:227], v[176:179]
  s_waitcnt lgkmcnt(5)
  v_mul_f32 v192, v192, v60
  v_mul_f32 v196, v196, v60
  v_mfma_f32_16x16x32_bf16 v[172:175], v[132:135], v[228:231], v[172:175]
  ds_read_b128 v[220:223], v252 offset:50176
  v_cvt_pk_bf16_f32 v73, v192, v196
  v_mfma_f32_16x16x32_bf16 v[180:183], v[156:159], v[228:231], v[180:183]
  s_waitcnt lgkmcnt(5)
  buffer_store_dwordx2 v[72:73], v8, s[20:23], 0 offen offset:128 sc1
  v_mul_f32 v193, v193, v61
  v_mfma_f32_16x16x32_bf16 v[168:171], v[136:139], v[200:203], v[168:171]
  ds_read_b128 v[224:227], v252 offset:51200
  v_mul_f32 v197, v197, v61
  v_mfma_f32_16x16x32_bf16 v[176:179], v[160:163], v[200:203], v[176:179]
  s_waitcnt lgkmcnt(5)
  v_cvt_pk_bf16_f32 v75, v193, v197
  buffer_store_dwordx2 v[74:75], v9, s[20:23], 0 offen offset:128 sc1
  v_mfma_f32_16x16x32_bf16 v[172:175], v[136:139], v[204:207], v[172:175]
  ds_read_b128 v[228:231], v252 offset:52224
  v_mul_f32 v194, v194, v62
  v_mfma_f32_16x16x32_bf16 v[180:183], v[160:163], v[204:207], v[180:183]
  s_waitcnt lgkmcnt(5)
  v_mul_f32 v198, v198, v62
  v_cvt_pk_bf16_f32 v77, v194, v198
  v_mfma_f32_16x16x32_bf16 v[168:171], v[140:143], v[208:211], v[168:171]
  ds_read_b128 v[200:203], v252 offset:53248
  buffer_store_dwordx2 v[76:77], v10, s[20:23], 0 offen offset:128 sc1
  v_mfma_f32_16x16x32_bf16 v[176:179], v[164:167], v[208:211], v[176:179]
  s_waitcnt lgkmcnt(5)
  v_mul_f32 v195, v195, v63
  v_mul_f32 v199, v199, v63
  v_mfma_f32_16x16x32_bf16 v[172:175], v[140:143], v[212:215], v[172:175]
  ds_read_b128 v[204:207], v252 offset:54272
  v_cvt_pk_bf16_f32 v79, v195, v199
  v_mfma_f32_16x16x32_bf16 v[180:183], v[164:167], v[212:215], v[180:183]
  buffer_store_dwordx2 v[78:79], v11, s[20:23], 0 offen offset:128 sc1
  s_setprio 0
  s_waitcnt lgkmcnt(5)
  v_mfma_f32_16x16x32_bf16 v[184:187], v[120:123], v[216:219], 0
  ds_read_b128 v[208:211], v252 offset:55296
  v_mfma_f32_16x16x32_bf16 v[192:195], v[144:147], v[216:219], 0
  s_waitcnt lgkmcnt(5)
  v_mfma_f32_16x16x32_bf16 v[188:191], v[120:123], v[220:223], 0
  ds_read_b128 v[212:215], v252 offset:56320
  v_mul_f32 v168, v168, v56
  v_mfma_f32_16x16x32_bf16 v[196:199], v[144:147], v[220:223], 0
  s_waitcnt lgkmcnt(5)
  v_mul_f32 v172, v172, v56
  v_cvt_pk_bf16_f32 v64, v168, v172
  v_mfma_f32_16x16x32_bf16 v[184:187], v[124:127], v[224:227], v[184:187]
  ds_read_b128 v[216:219], v252 offset:57344
  v_mul_f32 v169, v169, v57
  v_mfma_f32_16x16x32_bf16 v[192:195], v[148:151], v[224:227], v[192:195]
  s_waitcnt lgkmcnt(5)
  v_mul_f32 v173, v173, v57
  v_cvt_pk_bf16_f32 v66, v169, v173
  v_mfma_f32_16x16x32_bf16 v[188:191], v[124:127], v[228:231], v[188:191]
  ds_read_b128 v[220:223], v252 offset:58368
  v_mul_f32 v170, v170, v58
  v_mfma_f32_16x16x32_bf16 v[196:199], v[148:151], v[228:231], v[196:199]
  s_waitcnt lgkmcnt(5)
  v_mul_f32 v174, v174, v58
  v_cvt_pk_bf16_f32 v68, v170, v174
  v_mfma_f32_16x16x32_bf16 v[184:187], v[128:131], v[200:203], v[184:187]
  ds_read_b128 v[224:227], v252 offset:59392
  v_mul_f32 v171, v171, v59
  v_mfma_f32_16x16x32_bf16 v[192:195], v[152:155], v[200:203], v[192:195]
  s_waitcnt lgkmcnt(5)
  v_mul_f32 v175, v175, v59
  v_cvt_pk_bf16_f32 v70, v171, v175
  v_mfma_f32_16x16x32_bf16 v[188:191], v[128:131], v[204:207], v[188:191]
  ds_read_b128 v[228:231], v252 offset:60416
  v_mul_f32 v176, v176, v60
  v_mfma_f32_16x16x32_bf16 v[196:199], v[152:155], v[204:207], v[196:199]
  s_waitcnt lgkmcnt(5)
  v_mul_f32 v180, v180, v60
  v_cvt_pk_bf16_f32 v72, v176, v180
  v_mfma_f32_16x16x32_bf16 v[184:187], v[132:135], v[208:211], v[184:187]
  v_mul_f32 v177, v177, v61
  v_mul_f32 v181, v181, v61
  v_mfma_f32_16x16x32_bf16 v[192:195], v[156:159], v[208:211], v[192:195]
  s_waitcnt lgkmcnt(4)
  v_cvt_pk_bf16_f32 v74, v177, v181
  v_mul_f32 v178, v178, v62
  v_mfma_f32_16x16x32_bf16 v[188:191], v[132:135], v[212:215], v[188:191]
  v_mul_f32 v182, v182, v62
  v_cvt_pk_bf16_f32 v76, v178, v182
  v_mfma_f32_16x16x32_bf16 v[196:199], v[156:159], v[212:215], v[196:199]
  s_waitcnt lgkmcnt(3)
  v_mul_f32 v179, v179, v63
  v_mul_f32 v183, v183, v63
  v_mfma_f32_16x16x32_bf16 v[184:187], v[136:139], v[216:219], v[184:187]
  v_cvt_pk_bf16_f32 v78, v179, v183
  v_mfma_f32_16x16x32_bf16 v[192:195], v[160:163], v[216:219], v[192:195]
  s_waitcnt lgkmcnt(2)
  v_mfma_f32_16x16x32_bf16 v[188:191], v[136:139], v[220:223], v[188:191]
  v_mfma_f32_16x16x32_bf16 v[196:199], v[160:163], v[220:223], v[196:199]
  s_waitcnt lgkmcnt(1)
  v_mfma_f32_16x16x32_bf16 v[184:187], v[140:143], v[224:227], v[184:187]
  v_mfma_f32_16x16x32_bf16 v[192:195], v[164:167], v[224:227], v[192:195]
  s_waitcnt lgkmcnt(0)
  v_mfma_f32_16x16x32_bf16 v[188:191], v[140:143], v[228:231], v[188:191]
  v_mfma_f32_16x16x32_bf16 v[196:199], v[164:167], v[228:231], v[196:199]
  s_nop 3
  v_mul_f32 v184, v184, v56
  s_nop 1
  v_mul_f32 v188, v188, v56
  v_cvt_pk_bf16_f32 v65, v184, v188
  buffer_store_dwordx2 v[64:65], v4, s[20:23], 0 offen offset:256 sc1
  v_mul_f32 v185, v185, v57
  v_mul_f32 v189, v189, v57
  v_cvt_pk_bf16_f32 v67, v185, v189
  buffer_store_dwordx2 v[66:67], v5, s[20:23], 0 offen offset:256 sc1
  v_mul_f32 v186, v186, v58
  v_mul_f32 v190, v190, v58
  v_cvt_pk_bf16_f32 v69, v186, v190
  buffer_store_dwordx2 v[68:69], v6, s[20:23], 0 offen offset:256 sc1
  v_mul_f32 v187, v187, v59
  v_mul_f32 v191, v191, v59
  v_cvt_pk_bf16_f32 v71, v187, v191
  buffer_store_dwordx2 v[70:71], v7, s[20:23], 0 offen offset:256 sc1
  v_mul_f32 v192, v192, v60
  v_mul_f32 v196, v196, v60
  v_cvt_pk_bf16_f32 v73, v192, v196
  buffer_store_dwordx2 v[72:73], v8, s[20:23], 0 offen offset:256 sc1
  v_mul_f32 v193, v193, v61
  v_mul_f32 v197, v197, v61
  v_cvt_pk_bf16_f32 v75, v193, v197
  buffer_store_dwordx2 v[74:75], v9, s[20:23], 0 offen offset:256 sc1
  v_mul_f32 v194, v194, v62
  v_mul_f32 v198, v198, v62
  v_cvt_pk_bf16_f32 v77, v194, v198
  buffer_store_dwordx2 v[76:77], v10, s[20:23], 0 offen offset:256 sc1
  v_mul_f32 v195, v195, v63
  v_mul_f32 v199, v199, v63
  v_cvt_pk_bf16_f32 v79, v195, v199
  buffer_store_dwordx2 v[78:79], v11, s[20:23], 0 offen offset:256 sc1
  s_endpgm
M_helper:
  v_add_u32 v4, 0, v1
  v_xor_b32 v4, 0, v4
  v_mul_u32_u24 v5, 2731, v4
  v_lshrrev_b32 v5, 16, v5
  v_mul_u32_u24 v5, 384, v5
  v_lshl_add_u32 v4, v4, 4, v5
  v_add_u32 v16, s46, v4
  v_add_u32 v19, 6144, v16
  v_add_u32 v22, 12288, v16
  v_max_i32 v16, 0, v16
  v_add_u32 v4, 64, v1
  v_xor_b32 v4, 0, v4
  v_mul_u32_u24 v5, 2731, v4
  v_lshrrev_b32 v5, 16, v5
  v_mul_u32_u24 v5, 384, v5
  v_lshl_add_u32 v4, v4, 4, v5
  v_add_u32 v17, s46, v4
  v_add_u32 v20, 6144, v17
  v_max_i32 v17, 0, v17
  v_add_u32 v4, 128, v1
  v_xor_b32 v4, 0, v4
  v_mul_u32_u24 v5, 2731, v4
  v_lshrrev_b32 v5, 16, v5
  v_mul_u32_u24 v5, 384, v5
  v_lshl_add_u32 v4, v4, 4, v5
  v_add_u32 v18, s46, v4
  v_add_u32 v21, 6144, v18
  v_max_i32 v18, 0, v18
  v_add_u32 v4, 416, v1
  v_xor_b32 v4, 0, v4
  v_mul_u32_u24 v5, 2731, v4
  v_lshrrev_b32 v5, 16, v5
  v_mul_u32_u24 v5, 384, v5
  v_lshl_add_u32 v4, v4, 4, v5
  v_add_u32 v23, s46, v4
  s_add_i32 s56, s45, 0
  s_lshl_b32 s56, s56, 1
  s_add_i32 s56, s56, s41
  s_max_i32 s56, s56, 0
  s_min_i32 s56, s56, 223
  s_mul_i32 s56, s56, 86016
  s_mov_b32 m0, 0
  s_nop 0
  buffer_load_dwordx4 v16, s[16:19], s56 offen lds
  s_mov_b32 m0, 1024
  s_nop 0
  buffer_load_dwordx4 v17, s[16:19], s56 offen lds
  s_mov_b32 m0, 2048
  s_nop 0
  buffer_load_dwordx4 v18, s[16:19], s56 offen lds
  s_mov_b32 m0, 3072
  s_nop 0
  buffer_load_dwordx4 v19, s[16:19], s56 offen lds
  s_mov_b32 m0, 4096
  s_nop 0
  buffer_load_dwordx4 v20, s[16:19], s56 offen lds
  s_mov_b32 m0, 5120
  s_nop 0
  buffer_load_dwordx4 v21, s[16:19], s56 offen lds
  s_mov_b32 m0, 6144
  s_nop 0
  buffer_load_dwordx4 v22, s[16:19], s56 offen lds
  s_mov_b32 m0, 6656
  s_nop 0
  buffer_load_dwordx4 v23, s[16:19], s56 offen lds
  s_add_i32 s56, s45, 8
  s_lshl_b32 s56, s56, 1
  s_add_i32 s56, s56, s41
  s_max_i32 s56, s56, 0
  s_min_i32 s56, s56, 223
  s_mul_i32 s56, s56, 86016
  s_mov_b32 m0, 61440
  s_nop 0
  buffer_load_dwordx4 v16, s[16:19], s56 offen lds
  s_mov_b32 m0, 62464
  s_nop 0
  buffer_load_dwordx4 v17, s[16:19], s56 offen lds
  s_mov_b32 m0, 63488
  s_nop 0
  buffer_load_dwordx4 v18, s[16:19], s56 offen lds
  s_mov_b32 m0, 64512
  s_nop 0
  buffer_load_dwordx4 v19, s[16:19], s56 offen lds
  s_mov_b32 m0, 65536
  s_nop 0
  buffer_load_dwordx4 v20, s[16:19], s56 offen lds
  s_mov_b32 m0, 66560
  s_nop 0
  buffer_load_dwordx4 v21, s[16:19], s56 offen lds
  s_mov_b32 m0, 67584
  s_nop 0
  buffer_load_dwordx4 v22, s[16:19], s56 offen lds
  s_mov_b32 m0, 68096
  s_nop 0
  buffer_load_dwordx4 v23, s[16:19], s56 offen lds
  v_add_u32 v4, 0, v1
  v_xor_b32 v4, 8, v4
  v_mul_u32_u24 v5, 2731, v4
  v_lshrrev_b32 v5, 16, v5
  v_mul_u32_u24 v5, 384, v5
  v_lshl_add_u32 v4, v4, 4, v5
  v_add_u32 v24, s46, v4
  v_add_u32 v27, 6144, v24
  v_add_u32 v30, 12288, v24
  v_max_i32 v24, 0, v24
  v_add_u32 v4, 64, v1
  v_xor_b32 v4, 8, v4
  v_mul_u32_u24 v5, 2731, v4
  v_lshrrev_b32 v5, 16, v5
  v_mul_u32_u24 v5, 384, v5
  v_lshl_add_u32 v4, v4, 4, v5
  v_add_u32 v25, s46, v4
  v_add_u32 v28, 6144, v25
  v_max_i32 v25, 0, v25
  v_add_u32 v4, 128, v1
  v_xor_b32 v4, 8, v4
  v_mul_u32_u24 v5, 2731, v4
  v_lshrrev_b32 v5, 16, v5
  v_mul_u32_u24 v5, 384, v5
  v_lshl_add_u32 v4, v4, 4, v5
  v_add_u32 v26, s46, v4
  v_add_u32 v29, 6144, v26
  v_max_i32 v26, 0, v26
  v_add_u32 v4, 416, v1
  v_xor_b32 v4, 8, v4
  v_mul_u32_u24 v5, 2731, v4
  v_lshrrev_b32 v5, 16, v5
  v_mul_u32_u24 v5, 384, v5
  v_lshl_add_u32 v4, v4, 4, v5
  v_add_u32 v31, s46, v4
  s_add_i32 s56, s45, 1
  s_lshl_b32 s56, s56, 1
  s_add_i32 s56, s56, s41
  s_max_i32 s56, s56, 0
  s_min_i32 s56, s56, 223
  s_mul_i32 s56, s56, 86016
  s_mov_b32 m0, 7680
  s_nop 0
  buffer_load_dwordx4 v24, s[16:19], s56 offen lds
  s_mov_b32 m0, 8704
  s_nop 0
  buffer_load_dwordx4 v25, s[16:19], s56 offen lds
  s_mov_b32 m0, 9728
  s_nop 0
  buffer_load_dwordx4 v26, s[16:19], s56 offen lds
  s_mov_b32 m0, 10752
  s_nop 0
  buffer_load_dwordx4 v27, s[16:19], s56 offen lds
  s_mov_b32 m0, 11776
  s_nop 0
  buffer_load_dwordx4 v28, s[16:19], s56 offen lds
  s_mov_b32 m0, 12800
  s_nop 0
  buffer_load_dwordx4 v29, s[16:19], s56 offen lds
  s_mov_b32 m0, 13824
  s_nop 0
  buffer_load_dwordx4 v30, s[16:19], s56 offen lds
  s_mov_b32 m0, 14336
  s_nop 0
  buffer_load_dwordx4 v31, s[16:19], s56 offen lds
  v_add_u32 v4, 0, v1
  v_xor_b32 v4, 2, v4
  v_mul_u32_u24 v5, 2731, v4
  v_lshrrev_b32 v5, 16, v5
  v_mul_u32_u24 v5, 384, v5
  v_lshl_add_u32 v4, v4, 4, v5
  v_add_u32 v32, s46, v4
  v_add_u32 v35, 6144, v32
  v_add_u32 v38, 12288, v32
  v_max_i32 v32, 0, v32
  v_add_u32 v4, 64, v1
  v_xor_b32 v4, 2, v4
  v_mul_u32_u24 v5, 2731, v4
  v_lshrrev_b32 v5, 16, v5
  v_mul_u32_u24 v5, 384, v5
  v_lshl_add_u32 v4, v4, 4, v5
  v_add_u32 v33, s46, v4
  v_add_u32 v36, 6144, v33
  v_max_i32 v33, 0, v33
  v_add_u32 v4, 128, v1
  v_xor_b32 v4, 2, v4
  v_mul_u32_u24 v5, 2731, v4
  v_lshrrev_b32 v5, 16, v5
  v_mul_u32_u24 v5, 384, v5
  v_lshl_add_u32 v4, v4, 4, v5
  v_add_u32 v34, s46, v4
  v_add_u32 v37, 6144, v34
  v_max_i32 v34, 0, v34
  v_add_u32 v4, 416, v1
  v_xor_b32 v4, 2, v4
  v_mul_u32_u24 v5, 2731, v4
  v_lshrrev_b32 v5, 16, v5
  v_mul_u32_u24 v5, 384, v5
  v_lshl_add_u32 v4, v4, 4, v5
  v_add_u32 v39, s46, v4
  s_add_i32 s56, s45, 2
  s_lshl_b32 s56, s56, 1
  s_add_i32 s56, s56, s41
  s_max_i32 s56, s56, 0
  s_min_i32 s56, s56, 223
  s_mul_i32 s56, s56, 86016
  s_mov_b32 m0, 15360
  s_nop 0
  buffer_load_dwordx4 v32, s[16:19], s56 offen lds
  s_mov_b32 m0, 16384
  s_nop 0
  buffer_load_dwordx4 v33, s[16:19], s56 offen lds
  s_mov_b32 m0, 17408
  s_nop 0
  buffer_load_dwordx4 v34, s[16:19], s56 offen lds
  s_mov_b32 m0, 18432
  s_nop 0
  buffer_load_dwordx4 v35, s[16:19], s56 offen lds
  s_mov_b32 m0, 19456
  s_nop 0
  buffer_load_dwordx4 v36, s[16:19], s56 offen lds
  s_mov_b32 m0, 20480
  s_nop 0
  buffer_load_dwordx4 v37, s[16:19], s56 offen lds
  s_mov_b32 m0, 21504
  s_nop 0
  buffer_load_dwordx4 v38, s[16:19], s56 offen lds
  s_mov_b32 m0, 22016
  s_nop 0
  buffer_load_dwordx4 v39, s[16:19], s56 offen lds
  v_add_u32 v4, 0, v1
  v_xor_b32 v4, 10, v4
  v_mul_u32_u24 v5, 2731, v4
  v_lshrrev_b32 v5, 16, v5
  v_mul_u32_u24 v5, 384, v5
  v_lshl_add_u32 v4, v4, 4, v5
  v_add_u32 v40, s46, v4
  v_add_u32 v43, 6144, v40
  v_add_u32 v46, 12288, v40
  v_max_i32 v40, 0, v40
  v_add_u32 v4, 64, v1
  v_xor_b32 v4, 10, v4
  v_mul_u32_u24 v5, 2731, v4
  v_lshrrev_b32 v5, 16, v5
  v_mul_u32_u24 v5, 384, v5
  v_lshl_add_u32 v4, v4, 4, v5
  v_add_u32 v41, s46, v4
  v_add_u32 v44, 6144, v41
  v_max_i32 v41, 0, v41
  v_add_u32 v4, 128, v1
  v_xor_b32 v4, 10, v4
  v_mul_u32_u24 v5, 2731, v4
  v_lshrrev_b32 v5, 16, v5
  v_mul_u32_u24 v5, 384, v5
  v_lshl_add_u32 v4, v4, 4, v5
  v_add_u32 v42, s46, v4
  v_add_u32 v45, 6144, v42
  v_max_i32 v42, 0, v42
  v_add_u32 v4, 416, v1
  v_xor_b32 v4, 10, v4
  v_mul_u32_u24 v5, 2731, v4
  v_lshrrev_b32 v5, 16, v5
  v_mul_u32_u24 v5, 384, v5
  v_lshl_add_u32 v4, v4, 4, v5
  v_add_u32 v47, s46, v4
  s_add_i32 s56, s45, 3
  s_lshl_b32 s56, s56, 1
  s_add_i32 s56, s56, s41
  s_max_i32 s56, s56, 0
  s_min_i32 s56, s56, 223
  s_mul_i32 s56, s56, 86016
  s_mov_b32 m0, 23040
  s_nop 0
  buffer_load_dwordx4 v40, s[16:19], s56 offen lds
  s_mov_b32 m0, 24064
  s_nop 0
  buffer_load_dwordx4 v41, s[16:19], s56 offen lds
  s_mov_b32 m0, 25088
  s_nop 0
  buffer_load_dwordx4 v42, s[16:19], s56 offen lds
  s_mov_b32 m0, 26112
  s_nop 0
  buffer_load_dwordx4 v43, s[16:19], s56 offen lds
  s_mov_b32 m0, 27136
  s_nop 0
  buffer_load_dwordx4 v44, s[16:19], s56 offen lds
  s_mov_b32 m0, 28160
  s_nop 0
  buffer_load_dwordx4 v45, s[16:19], s56 offen lds
  s_mov_b32 m0, 29184
  s_nop 0
  buffer_load_dwordx4 v46, s[16:19], s56 offen lds
  s_mov_b32 m0, 29696
  s_nop 0
  buffer_load_dwordx4 v47, s[16:19], s56 offen lds
  v_add_u32 v4, 0, v1
  v_xor_b32 v4, 4, v4
  v_mul_u32_u24 v5, 2731, v4
  v_lshrrev_b32 v5, 16, v5
  v_mul_u32_u24 v5, 384, v5
  v_lshl_add_u32 v4, v4, 4, v5
  v_add_u32 v48, s46, v4
  v_add_u32 v51, 6144, v48
  v_add_u32 v54, 12288, v48
  v_max_i32 v48, 0, v48
  v_add_u32 v4, 64, v1
  v_xor_b32 v4, 4, v4
  v_mul_u32_u24 v5, 2731, v4
  v_lshrrev_b32 v5, 16, v5
  v_mul_u32_u24 v5, 384, v5
  v_lshl_add_u32 v4, v4, 4, v5
  v_add_u32 v49, s46, v4
  v_add_u32 v52, 6144, v49
  v_max_i32 v49, 0, v49
  v_add_u32 v4, 128, v1
  v_xor_b32 v4, 4, v4
  v_mul_u32_u24 v5, 2731, v4
  v_lshrrev_b32 v5, 16, v5
  v_mul_u32_u24 v5, 384, v5
  v_lshl_add_u32 v4, v4, 4, v5
  v_add_u32 v50, s46, v4
  v_add_u32 v53, 6144, v50
  v_max_i32 v50, 0, v50
  v_add_u32 v4, 416, v1
  v_xor_b32 v4, 4, v4
  v_mul_u32_u24 v5, 2731, v4
  v_lshrrev_b32 v5, 16, v5
  v_mul_u32_u24 v5, 384, v5
  v_lshl_add_u32 v4, v4, 4, v5
  v_add_u32 v55, s46, v4
  s_add_i32 s56, s45, 4
  s_lshl_b32 s56, s56, 1
  s_add_i32 s56, s56, s41
  s_max_i32 s56, s56, 0
  s_min_i32 s56, s56, 223
  s_mul_i32 s56, s56, 86016
  s_mov_b32 m0, 30720
  s_nop 0
  buffer_load_dwordx4 v48, s[16:19], s56 offen lds
  s_mov_b32 m0, 31744
  s_nop 0
  buffer_load_dwordx4 v49, s[16:19], s56 offen lds
  s_mov_b32 m0, 32768
  s_nop 0
  buffer_load_dwordx4 v50, s[16:19], s56 offen lds
  s_mov_b32 m0, 33792
  s_nop 0
  buffer_load_dwordx4 v51, s[16:19], s56 offen lds
  s_mov_b32 m0, 34816
  s_nop 0
  buffer_load_dwordx4 v52, s[16:19], s56 offen lds
  s_mov_b32 m0, 35840
  s_nop 0
  buffer_load_dwordx4 v53, s[16:19], s56 offen lds
  s_mov_b32 m0, 36864
  s_nop 0
  buffer_load_dwordx4 v54, s[16:19], s56 offen lds
  s_mov_b32 m0, 37376
  s_nop 0
  buffer_load_dwordx4 v55, s[16:19], s56 offen lds
  v_add_u32 v4, 0, v1
  v_xor_b32 v4, 12, v4
  v_mul_u32_u24 v5, 2731, v4
  v_lshrrev_b32 v5, 16, v5
  v_mul_u32_u24 v5, 384, v5
  v_lshl_add_u32 v4, v4, 4, v5
  v_add_u32 v56, s46, v4
  v_add_u32 v59, 6144, v56
  v_add_u32 v62, 12288, v56
  v_max_i32 v56, 0, v56
  v_add_u32 v4, 64, v1
  v_xor_b32 v4, 12, v4
  v_mul_u32_u24 v5, 2731, v4
  v_lshrrev_b32 v5, 16, v5
  v_mul_u32_u24 v5, 384, v5
  v_lshl_add_u32 v4, v4, 4, v5
  v_add_u32 v57, s46, v4
  v_add_u32 v60, 6144, v57
  v_max_i32 v57, 0, v57
  v_add_u32 v4, 128, v1
  v_xor_b32 v4, 12, v4
  v_mul_u32_u24 v5, 2731, v4
  v_lshrrev_b32 v5, 16, v5
  v_mul_u32_u24 v5, 384, v5
  v_lshl_add_u32 v4, v4, 4, v5
  v_add_u32 v58, s46, v4
  v_add_u32 v61, 6144, v58
  v_max_i32 v58, 0, v58
  v_add_u32 v4, 416, v1
  v_xor_b32 v4, 12, v4
  v_mul_u32_u24 v5, 2731, v4
  v_lshrrev_b32 v5, 16, v5
  v_mul_u32_u24 v5, 384, v5
  v_lshl_add_u32 v4, v4, 4, v5
  v_add_u32 v63, s46, v4
  s_add_i32 s56, s45, 5
  s_lshl_b32 s56, s56, 1
  s_add_i32 s56, s56, s41
  s_max_i32 s56, s56, 0
  s_min_i32 s56, s56, 223
  s_mul_i32 s56, s56, 86016
  s_mov_b32 m0, 38400
  s_nop 0
  buffer_load_dwordx4 v56, s[16:19], s56 offen lds
  s_mov_b32 m0, 39424
  s_nop 0
  buffer_load_dwordx4 v57, s[16:19], s56 offen lds
  s_mov_b32 m0, 40448
  s_nop 0
  buffer_load_dwordx4 v58, s[16:19], s56 offen lds
  s_mov_b32 m0, 41472
  s_nop 0
  buffer_load_dwordx4 v59, s[16:19], s56 offen lds
  s_mov_b32 m0, 42496
  s_nop 0
  buffer_load_dwordx4 v60, s[16:19], s56 offen lds
  s_mov_b32 m0, 43520
  s_nop 0
  buffer_load_dwordx4 v61, s[16:19], s56 offen lds
  s_mov_b32 m0, 44544
  s_nop 0
  buffer_load_dwordx4 v62, s[16:19], s56 offen lds
  s_mov_b32 m0, 45056
  s_nop 0
  buffer_load_dwordx4 v63, s[16:19], s56 offen lds
  v_add_u32 v4, 0, v1
  v_xor_b32 v4, 6, v4
  v_mul_u32_u24 v5, 2731, v4
  v_lshrrev_b32 v5, 16, v5
  v_mul_u32_u24 v5, 384, v5
  v_lshl_add_u32 v4, v4, 4, v5
  v_add_u32 v64, s46, v4
  v_add_u32 v67, 6144, v64
  v_add_u32 v70, 12288, v64
  v_max_i32 v64, 0, v64
  v_add_u32 v4, 64, v1
  v_xor_b32 v4, 6, v4
  v_mul_u32_u24 v5, 2731, v4
  v_lshrrev_b32 v5, 16, v5
  v_mul_u32_u24 v5, 384, v5
  v_lshl_add_u32 v4, v4, 4, v5
  v_add_u32 v65, s46, v4
  v_add_u32 v68, 6144, v65
  v_max_i32 v65, 0, v65
  v_add_u32 v4, 128, v1
  v_xor_b32 v4, 6, v4
  v_mul_u32_u24 v5, 2731, v4
  v_lshrrev_b32 v5, 16, v5
  v_mul_u32_u24 v5, 384, v5
  v_lshl_add_u32 v4, v4, 4, v5
  v_add_u32 v66, s46, v4
  v_add_u32 v69, 6144, v66
  v_max_i32 v66, 0, v66
  v_add_u32 v4, 416, v1
  v_xor_b32 v4, 6, v4
  v_mul_u32_u24 v5, 2731, v4
  v_lshrrev_b32 v5, 16, v5
  v_mul_u32_u24 v5, 384, v5
  v_lshl_add_u32 v4, v4, 4, v5
  v_add_u32 v71, s46, v4
  s_waitcnt vmcnt(40)
  s_add_i32 s56, s45, 6
  s_lshl_b32 s56, s56, 1
  s_add_i32 s56, s56, s41
  s_max_i32 s56, s56, 0
  s_min_i32 s56, s56, 223
  s_mul_i32 s56, s56, 86016
  s_mov_b32 m0, 46080
  s_nop 0
  buffer_load_dwordx4 v64, s[16:19], s56 offen lds
  s_mov_b32 m0, 47104
  s_nop 0
  buffer_load_dwordx4 v65, s[16:19], s56 offen lds
  s_mov_b32 m0, 48128
  s_nop 0
  buffer_load_dwordx4 v66, s[16:19], s56 offen lds
  s_mov_b32 m0, 49152
  s_nop 0
  buffer_load_dwordx4 v67, s[16:19], s56 offen lds
  s_mov_b32 m0, 50176
  s_nop 0
  buffer_load_dwordx4 v68, s[16:19], s56 offen lds
  s_mov_b32 m0, 51200
  s_nop 0
  buffer_load_dwordx4 v69, s[16:19], s56 offen lds
  s_mov_b32 m0, 52224
  s_nop 0
  buffer_load_dwordx4 v70, s[16:19], s56 offen lds
  s_mov_b32 m0, 52736
  s_nop 0
  buffer_load_dwordx4 v71, s[16:19], s56 offen lds
  v_add_u32 v4, 0, v1
  v_xor_b32 v4, 14, v4
  v_mul_u32_u24 v5, 2731, v4
  v_lshrrev_b32 v5, 16, v5
  v_mul_u32_u24 v5, 384, v5
  v_lshl_add_u32 v4, v4, 4, v5
  v_add_u32 v72, s46, v4
  v_add_u32 v75, 6144, v72
  v_add_u32 v78, 12288, v72
  v_max_i32 v72, 0, v72
  v_add_u32 v4, 64, v1
  v_xor_b32 v4, 14, v4
  v_mul_u32_u24 v5, 2731, v4
  v_lshrrev_b32 v5, 16, v5
  v_mul_u32_u24 v5, 384, v5
  v_lshl_add_u32 v4, v4, 4, v5
  v_add_u32 v73, s46, v4
  v_add_u32 v76, 6144, v73
  v_max_i32 v73, 0, v73
  v_add_u32 v4, 128, v1
  v_xor_b32 v4, 14, v4
  v_mul_u32_u24 v5, 2731, v4
  v_lshrrev_b32 v5, 16, v5
  v_mul_u32_u24 v5, 384, v5
  v_lshl_add_u32 v4, v4, 4, v5
  v_add_u32 v74, s46, v4
  v_add_u32 v77, 6144, v74
  v_max_i32 v74, 0, v74
  v_add_u32 v4, 416, v1
  v_xor_b32 v4, 14, v4
  v_mul_u32_u24 v5, 2731, v4
  v_lshrrev_b32 v5, 16, v5
  v_mul_u32_u24 v5, 384, v5
  v_lshl_add_u32 v4, v4, 4, v5
  v_add_u32 v79, s46, v4
  s_add_i32 s56, s45, 7
  s_lshl_b32 s56, s56, 1
  s_add_i32 s56, s56, s41
  s_max_i32 s56, s56, 0
  s_min_i32 s56, s56, 223
  s_mul_i32 s56, s56, 86016
  s_mov_b32 m0, 53760
  s_nop 0
  buffer_load_dwordx4 v72, s[16:19], s56 offen lds
  s_mov_b32 m0, 54784
  s_nop 0
  buffer_load_dwordx4 v73, s[16:19], s56 offen lds
  s_mov_b32 m0, 55808
  s_nop 0
  buffer_load_dwordx4 v74, s[16:19], s56 offen lds
  s_mov_b32 m0, 56832
  s_nop 0
  buffer_load_dwordx4 v75, s[16:19], s56 offen lds
  s_mov_b32 m0, 57856
  s_nop 0
  buffer_load_dwordx4 v76, s[16:19], s56 offen lds
  s_mov_b32 m0, 58880
  s_nop 0
  buffer_load_dwordx4 v77, s[16:19], s56 offen lds
  s_mov_b32 m0, 59904
  s_nop 0
  buffer_load_dwordx4 v78, s[16:19], s56 offen lds
  s_mov_b32 m0, 60416
  s_nop 0
  buffer_load_dwordx4 v79, s[16:19], s56 offen lds
  s_mov_b32 s32, s8
  s_and_b32 s33, s9, 0xffff
  s_mov_b32 s34, 73728
  s_mov_b32 s35, 0x00020000
  s_mov_b32 s36, s12
  s_and_b32 s37, s13, 0xffff
  s_mov_b32 s38, 256
  s_mov_b32 s39, 0x00020000
  s_cmp_ge_u32 s2, 72
  s_cbranch_scc1 H_1
  s_mul_hi_u32 s56, s2, 0x15555556
  s_mul_i32 s57, s56, 12
  s_sub_u32 s57, s2, s57
  s_and_b32 s58, s57, 1
  s_lshr_b32 s57, s57, 1
  s_lshl_b32 s56, s56, 1
  s_add_u32 s56, s56, s58
  s_lshr_b32 s58, s56, 2
  s_lshl_b32 s58, s58, 6
  s_and_b32 s56, s56, 3
  s_add_u32 s56, s56, s58
  s_lshl_b32 s56, s56, 1
  v_mul_u32_u24 v10, 3072, v2
  v_lshl_add_u32 v10, v3, 3, v10
  v_mul_u32_u24 v8, 1152, v3
  v_lshl_add_u32 v8, v2, 4, v8
  s_mul_i32 s57, s57, 36864
  s_add_u32 s58, s57, 18432
  s_waitcnt vmcnt(2)
  buffer_load_ushort v168, v10, s[32:35], s56 offen offset:0
  buffer_load_ushort v169, v10, s[32:35], s56 offen offset:384
  buffer_load_ushort v170, v10, s[32:35], s56 offen offset:768
  buffer_load_ushort v171, v10, s[32:35], s56 offen offset:1152
  buffer_load_ushort v172, v10, s[32:35], s56 offen offset:1536
  buffer_load_ushort v173, v10, s[32:35], s56 offen offset:1920
  buffer_load_ushort v174, v10, s[32:35], s56 offen offset:2304
  buffer_load_ushort v175, v10, s[32:35], s56 offen offset:2688
  s_add_u32 s56, s56, 12288
  buffer_load_ushort v176, v10, s[32:35], s56 offen offset:0
  buffer_load_ushort v177, v10, s[32:35], s56 offen offset:384
  buffer_load_ushort v178, v10, s[32:35], s56 offen offset:768
  buffer_load_ushort v179, v10, s[32:35], s56 offen offset:1152
  buffer_load_ushort v180, v10, s[32:35], s56 offen offset:1536
  buffer_load_ushort v181, v10, s[32:35], s56 offen offset:1920
  buffer_load_ushort v182, v10, s[32:35], s56 offen offset:2304
  buffer_load_ushort v183, v10, s[32:35], s56 offen offset:2688
  s_add_u32 s56, s56, 12288
  buffer_load_ushort v184, v10, s[32:35], s56 offen offset:0
  buffer_load_ushort v185, v10, s[32:35], s56 offen offset:384
  buffer_load_ushort v186, v10, s[32:35], s56 offen offset:768
  buffer_load_ushort v187, v10, s[32:35], s56 offen offset:1152
  buffer_load_ushort v188, v10, s[32:35], s56 offen offset:1536
  buffer_load_ushort v189, v10, s[32:35], s56 offen offset:1920
  buffer_load_ushort v190, v10, s[32:35], s56 offen offset:2304
  buffer_load_ushort v191, v10, s[32:35], s56 offen offset:2688
  s_add_u32 s56, s56, 12288
  buffer_load_ushort v192, v10, s[32:35], s56 offen offset:0
  buffer_load_ushort v193, v10, s[32:35], s56 offen offset:384
  buffer_load_ushort v194, v10, s[32:35], s56 offen offset:768
  buffer_load_ushort v195, v10, s[32:35], s56 offen offset:1152
  buffer_load_ushort v196, v10, s[32:35], s56 offen offset:1536
  buffer_load_ushort v197, v10, s[32:35], s56 offen offset:1920
  buffer_load_ushort v198, v10, s[32:35], s56 offen offset:2304
  buffer_load_ushort v199, v10, s[32:35], s56 offen offset:2688
  s_add_u32 s56, s56, 12288
  buffer_load_ushort v200, v10, s[32:35], s56 offen offset:0
  buffer_load_ushort v201, v10, s[32:35], s56 offen offset:384
  buffer_load_ushort v202, v10, s[32:35], s56 offen offset:768
  buffer_load_ushort v203, v10, s[32:35], s56 offen offset:1152
  buffer_load_ushort v204, v10, s[32:35], s56 offen offset:1536
  buffer_load_ushort v205, v10, s[32:35], s56 offen offset:1920
  buffer_load_ushort v206, v10, s[32:35], s56 offen offset:2304
  buffer_load_ushort v207, v10, s[32:35], s56 offen offset:2688
  s_add_u32 s56, s56, 12288
  buffer_load_ushort v208, v10, s[32:35], s56 offen offset:0
  buffer_load_ushort v209, v10, s[32:35], s56 offen offset:384
  buffer_load_ushort v210, v10, s[32:35], s56 offen offset:768
  buffer_load_ushort v211, v10, s[32:35], s56 offen offset:1152
  buffer_load_ushort v212, v10, s[32:35], s56 offen offset:1536
  buffer_load_ushort v213, v10, s[32:35], s56 offen offset:1920
  buffer_load_ushort v214, v10, s[32:35], s56 offen offset:2304
  buffer_load_ushort v215, v10, s[32:35], s56 offen offset:2688
  s_add_u32 s56, s56, 12288
  buffer_load_dwordx4 v[120:123], v8, s[28:31], s57 offen offset:768
  buffer_load_dwordx4 v[144:147], v8, s[28:31], s58 offen offset:768
  buffer_load_dwordx4 v[124:127], v8, s[28:31], s57 offen offset:832
  buffer_load_dwordx4 v[148:151], v8, s[28:31], s58 offen offset:832
  buffer_load_dwordx4 v[128:131], v8, s[28:31], s57 offen offset:896
  buffer_load_dwordx4 v[152:155], v8, s[28:31], s58 offen offset:896
  buffer_load_dwordx4 v[132:135], v8, s[28:31], s57 offen offset:960
  buffer_load_dwordx4 v[156:159], v8, s[28:31], s58 offen offset:960
  buffer_load_dwordx4 v[136:139], v8, s[28:31], s57 offen offset:1024
  buffer_load_dwordx4 v[160:163], v8, s[28:31], s58 offen offset:1024
  buffer_load_dwordx4 v[140:143], v8, s[28:31], s57 offen offset:1088
  buffer_load_dwordx4 v[164:167], v8, s[28:31], s58 offen offset:1088
H_1:
  s_barrier
  s_cmp_ge_u32 s2, 72
  s_cbranch_scc1 H_2
  s_waitcnt vmcnt(0)
  v_lshl_or_b32 v96, v169, 16, v168
  v_lshl_or_b32 v97, v171, 16, v170
  v_lshl_or_b32 v98, v173, 16, v172
  v_lshl_or_b32 v99, v175, 16, v174
  v_lshl_or_b32 v100, v177, 16, v176
  v_lshl_or_b32 v101, v179, 16, v178
  v_lshl_or_b32 v102, v181, 16, v180
  v_lshl_or_b32 v103, v183, 16, v182
  v_lshl_or_b32 v104, v185, 16, v184
  v_lshl_or_b32 v105, v187, 16, v186
  v_lshl_or_b32 v106, v189, 16, v188
  v_lshl_or_b32 v107, v191, 16, v190
  v_lshl_or_b32 v108, v193, 16, v192
  v_lshl_or_b32 v109, v195, 16, v194
  v_lshl_or_b32 v110, v197, 16, v196
  v_lshl_or_b32 v111, v199, 16, v198
  v_lshl_or_b32 v112, v201, 16, v200
  v_lshl_or_b32 v113, v203, 16, v202
  v_lshl_or_b32 v114, v205, 16, v204
  v_lshl_or_b32 v115, v207, 16, v206
  v_lshl_or_b32 v116, v209, 16, v208
  v_lshl_or_b32 v117, v211, 16, v210
  v_lshl_or_b32 v118, v213, 16, v212
  v_lshl_or_b32 v119, v215, 16, v214
  v_mfma_f32_16x16x32_bf16 v[88:91], v[120:123], v[96:99], 0
  v_mfma_f32_16x16x32_bf16 v[92:95], v[144:147], v[96:99], 0
  v_mfma_f32_16x16x32_bf16 v[88:91], v[124:127], v[100:103], v[88:91]
  v_mfma_f32_16x16x32_bf16 v[92:95], v[148:151], v[100:103], v[92:95]
  v_mfma_f32_16x16x32_bf16 v[88:91], v[128:131], v[104:107], v[88:91]
  v_mfma_f32_16x16x32_bf16 v[92:95], v[152:155], v[104:107], v[92:95]
  v_mfma_f32_16x16x32_bf16 v[88:91], v[132:135], v[108:111], v[88:91]
  v_mfma_f32_16x16x32_bf16 v[92:95], v[156:159], v[108:111], v[92:95]
  v_mfma_f32_16x16x32_bf16 v[88:91], v[136:139], v[112:115], v[88:91]
  v_mfma_f32_16x16x32_bf16 v[92:95], v[160:163], v[112:115], v[92:95]
  v_mfma_f32_16x16x32_bf16 v[88:91], v[140:143], v[116:119], v[88:91]
  v_mfma_f32_16x16x32_bf16 v[92:95], v[164:167], v[116:119], v[92:95]
  s_nop 6
  v_cvt_pk_bf16_f32 v84, v88, v89
  v_cvt_pk_bf16_f32 v85, v90, v91
  v_cvt_pk_bf16_f32 v86, v92, v93
  v_cvt_pk_bf16_f32 v87, v94, v95
  s_lshl_b32 s55, s2, 10
  buffer_store_dwordx4 v[84:87], v252, s[24:27], s55 offen sc1
  s_branch H_2b
H_2:
  s_waitcnt vmcnt(0)
H_2b:
  s_barrier
  s_add_i32 s56, s45, 16
  s_lshl_b32 s56, s56, 1
  s_add_i32 s56, s56, s41
  s_max_i32 s56, s56, 0
  s_min_i32 s56, s56, 223
  s_mul_i32 s56, s56, 86016
  s_mov_b32 m0, 122880
  s_nop 0
  buffer_load_dwordx4 v16, s[16:19], s56 offen lds
  s_mov_b32 m0, 123904
  s_nop 0
  buffer_load_dwordx4 v17, s[16:19], s56 offen lds
  s_mov_b32 m0, 124928
  s_nop 0
  buffer_load_dwordx4 v18, s[16:19], s56 offen lds
  s_mov_b32 m0, 125952
  s_nop 0
  buffer_load_dwordx4 v19, s[16:19], s56 offen lds
  s_mov_b32 m0, 126976
  s_nop 0
  buffer_load_dwordx4 v20, s[16:19], s56 offen lds
  s_mov_b32 m0, 128000
  s_nop 0
  buffer_load_dwordx4 v21, s[16:19], s56 offen lds
  s_mov_b32 m0, 129024
  s_nop 0
  buffer_load_dwordx4 v22, s[16:19], s56 offen lds
  s_mov_b32 m0, 129536
  s_nop 0
  buffer_load_dwordx4 v23, s[16:19], s56 offen lds
  s_add_i32 s56, s45, 17
  s_lshl_b32 s56, s56, 1
  s_add_i32 s56, s56, s41
  s_max_i32 s56, s56, 0
  s_min_i32 s56, s56, 223
  s_mul_i32 s56, s56, 86016
  s_mov_b32 m0, 130560
  s_nop 0
  buffer_load_dwordx4 v24, s[16:19], s56 offen lds
  s_mov_b32 m0, 131584
  s_nop 0
  buffer_load_dwordx4 v25, s[16:19], s56 offen lds
  s_mov_b32 m0, 132608
  s_nop 0
  buffer_load_dwordx4 v26, s[16:19], s56 offen lds
  s_mov_b32 m0, 133632
  s_nop 0
  buffer_load_dwordx4 v27, s[16:19], s56 offen lds
  s_mov_b32 m0, 134656
  s_nop 0
  buffer_load_dwordx4 v28, s[16:19], s56 offen lds
  s_mov_b32 m0, 135680
  s_nop 0
  buffer_load_dwordx4 v29, s[16:19], s56 offen lds
  s_mov_b32 m0, 136704
  s_nop 0
  buffer_load_dwordx4 v30, s[16:19], s56 offen lds
  s_mov_b32 m0, 137216
  s_nop 0
  buffer_load_dwordx4 v31, s[16:19], s56 offen lds
  s_add_i32 s56, s45, 18
  s_lshl_b32 s56, s56, 1
  s_add_i32 s56, s56, s41
  s_max_i32 s56, s56, 0
  s_min_i32 s56, s56, 223
  s_mul_i32 s56, s56, 86016
  s_mov_b32 m0, 138240
  s_nop 0
  buffer_load_dwordx4 v32, s[16:19], s56 offen lds
  s_mov_b32 m0, 139264
  s_nop 0
  buffer_load_dwordx4 v33, s[16:19], s56 offen lds
  s_mov_b32 m0, 140288
  s_nop 0
  buffer_load_dwordx4 v34, s[16:19], s56 offen lds
  s_mov_b32 m0, 141312
  s_nop 0
  buffer_load_dwordx4 v35, s[16:19], s56 offen lds
  s_mov_b32 m0, 142336
  s_nop 0
  buffer_load_dwordx4 v36, s[16:19], s56 offen lds
  s_mov_b32 m0, 143360
  s_nop 0
  buffer_load_dwordx4 v37, s[16:19], s56 offen lds
  s_mov_b32 m0, 144384
  s_nop 0
  buffer_load_dwordx4 v38, s[16:19], s56 offen lds
  s_mov_b32 m0, 144896
  s_nop 0
  buffer_load_dwordx4 v39, s[16:19], s56 offen lds
  s_add_i32 s56, s45, 19
  s_lshl_b32 s56, s56, 1
  s_add_i32 s56, s56, s41
  s_max_i32 s56, s56, 0
  s_min_i32 s56, s56, 223
  s_mul_i32 s56, s56, 86016
  s_mov_b32 m0, 145920
  s_nop 0
  buffer_load_dwordx4 v40, s[16:19], s56 offen lds
  s_mov_b32 m0, 146944
  s_nop 0
  buffer_load_dwordx4 v41, s[16:19], s56 offen lds
  s_mov_b32 m0, 147968
  s_nop 0
  buffer_load_dwordx4 v42, s[16:19], s56 offen lds
  s_mov_b32 m0, 148992
  s_nop 0
  buffer_load_dwordx4 v43, s[16:19], s56 offen lds
  s_mov_b32 m0, 150016
  s_nop 0
  buffer_load_dwordx4 v44, s[16:19], s56 offen lds
  s_mov_b32 m0, 151040
  s_nop 0
  buffer_load_dwordx4 v45, s[16:19], s56 offen lds
  s_mov_b32 m0, 152064
  s_nop 0
  buffer_load_dwordx4 v46, s[16:19], s56 offen lds
  s_mov_b32 m0, 152576
  s_nop 0
  buffer_load_dwordx4 v47, s[16:19], s56 offen lds
  s_cmp_ge_u32 s2, 72
  s_cbranch_scc1 H_3
  v_mov_b32 v4, 1
  v_mov_b32 v5, 0
  s_mov_b64 exec, 1
  s_waitcnt vmcnt(32)
  buffer_atomic_add v4, v5, s[36:39], 0 offen sc0 sc1
  s_waitcnt vmcnt(0)
  v_readfirstlane_b32 s56, v4
  s_nop 0
  s_cmp_lg_u32 s56, 71
  s_cbranch_scc1 H_notlast
  buffer_store_dword v4, v5, s[36:39], 0 offen offset:128 sc1
H_notlast:
  s_mov_b64 exec, -1
H_3:
  s_waitcnt vmcnt(0)
  s_barrier
  v_mov_b32 v6, 0
  s_mov_b32 s59, 0
  s_mov_b64 exec, 1
H_pollV:
  buffer_load_dword v7, v6, s[36:39], 0 offen offset:128 sc1
  s_waitcnt vmcnt(0)
  v_cmp_eq_u32 vcc, 0, v7
  s_add_u32 s59, s59, 1
  s_cmp_gt_u32 s59, 200000
  s_cbranch_scc1 H_pollV_x
  s_cmp_lg_u64 vcc, 0
  s_cbranch_scc0 H_pollV_x
  s_sleep 2
  s_branch H_pollV
H_pollV_x:
  s_mov_b64 exec, -1
  s_mov_b32 m0, 153600
  s_mov_b32 s59, 0
  buffer_load_dwordx4 v252, s[24:27], s59 offen offset:0 sc1 lds
  buffer_load_dwordx4 v252, s[24:27], s59 offen offset:1024 sc1 lds
  buffer_load_dwordx4 v252, s[24:27], s59 offen offset:2048 sc1 lds
  buffer_load_dwordx4 v252, s[24:27], s59 offen offset:3072 sc1 lds
  s_mov_b32 m0, 157696
  s_mov_b32 s59, 4096
  buffer_load_dwordx4 v252, s[24:27], s59 offen offset:0 sc1 lds
  buffer_load_dwordx4 v252, s[24:27], s59 offen offset:1024 sc1 lds
  buffer_load_dwordx4 v252, s[24:27], s59 offen offset:2048 sc1 lds
  buffer_load_dwordx4 v252, s[24:27], s59 offen offset:3072 sc1 lds
  s_mov_b32 m0, 161792
  s_mov_b32 s59, 8192
  buffer_load_dwordx4 v252, s[24:27], s59 offen offset:0 sc1 lds
  buffer_load_dwordx4 v252, s[24:27], s59 offen offset:1024 sc1 lds
  s_waitcnt vmcnt(0)
  s_barrier
  s_mov_b32 m0, 0
  s_mov_b32 s59, 12288
  buffer_load_dwordx4 v252, s[24:27], s59 offen offset:0 sc1 lds
  buffer_load_dwordx4 v252, s[24:27], s59 offen offset:1024 sc1 lds
  buffer_load_dwordx4 v252, s[24:27], s59 offen offset:2048 sc1 lds
  buffer_load_dwordx4 v252, s[24:27], s59 offen offset:3072 sc1 lds
  s_mov_b32 m0, 4096
  s_mov_b32 s59, 16384
  buffer_load_dwordx4 v252, s[24:27], s59 offen offset:0 sc1 lds
  buffer_load_dwordx4 v252, s[24:27], s59 offen offset:1024 sc1 lds
  buffer_load_dwordx4 v252, s[24:27], s59 offen offset:2048 sc1 lds
  buffer_load_dwordx4 v252, s[24:27], s59 offen offset:3072 sc1 lds
  s_mov_b32 m0, 8192
  s_mov_b32 s59, 20480
  buffer_load_dwordx4 v252, s[24:27], s59 offen offset:0 sc1 lds
  buffer_load_dwordx4 v252, s[24:27], s59 offen offset:1024 sc1 lds
  buffer_load_dwordx4 v252, s[24:27], s59 offen offset:2048 sc1 lds
  buffer_load_dwordx4 v252, s[24:27], s59 offen offset:3072 sc1 lds
  s_waitcnt vmcnt(0)
  s_barrier
M_done:
  s_endpgm
CODE_END:
.section .rodata,"a"
.p2align 6
.amdhsa_kernel standalone__neighborhood_nat__vision_kernel
  .amdhsa_next_free_vgpr 256
  .amdhsa_next_free_sgpr 102
  .amdhsa_accum_offset 256
  .amdhsa_group_segment_fixed_size 0
  .amdhsa_kernarg_size 48
  .amdhsa_user_sgpr_count 2
  .amdhsa_user_sgpr_kernarg_segment_ptr 1
  .amdhsa_system_sgpr_workgroup_id_x 1
.end_amdhsa_kernel
```

```asm
; @launch grid=(256,1,1) block=(512,1,1) lds=163840
.amdgcn_target "amdgcn-amd-amdhsa--gfx950"
.text
.globl standalone__neighborhood_nat__vision_kernel
.p2align 8
.type standalone__neighborhood_nat__vision_kernel,@function
standalone__neighborhood_nat__vision_kernel:
  s_cmp_ge_u32 s2, 256
  s_cbranch_scc1 M_done
  s_load_dwordx8 s[4:11], s[0:1], 0
  s_load_dwordx4 s[12:15], s[0:1], 32
  v_lshrrev_b32 v4, 6, v0
  v_and_b32 v1, 63, v0
  v_readfirstlane_b32 s40, v4
  v_lshrrev_b32 v2, 4, v1
  v_and_b32 v3, 15, v1
  v_lshlrev_b32 v252, 4, v1
  s_getpc_b64 s[16:17]
  s_and_b32 s16, s16, -256
  s_and_b32 s17, s17, 0xffff
  s_mov_b32 s18, CODE_END-standalone__neighborhood_nat__vision_kernel
  s_mov_b32 s19, 0x00020000
  s_lshr_b32 s55, s2, 3
  s_lshl_b32 s55, s55, 10
  s_cmp_lg_u32 s40, 3
  s_cbranch_scc1 M_nocpf
  buffer_load_dwordx4 v[136:139], v252, s[16:19], s55 offen
M_nocpf:
  v_bfe_u32 v5, v1, 2, 2
  v_lshrrev_b32 v6, 5, v1
  v_lshlrev_b32 v7, 1, v6
  v_and_b32 v8, 3, v1
  v_xor_b32 v7, v7, v8
  v_lshlrev_b32 v7, 4, v7
  s_movk_i32 s60, 1152
  v_lshl_add_u32 v4, v2, 3, v5
  v_mad_u32_u24 v200, v4, s60, v7
  v_lshl_add_u32 v4, v2, 5, v5
  v_mad_u32_u24 v201, v4, s60, v7
  v_mul_u32_u24 v6, 55296, v6
  v_sub_u32 v202, v201, v6
  v_lshrrev_b32 v4, 2, v1
  v_mad_u32_u24 v203, v4, s60, v7
  v_lshrrev_b32 v4, 3, v3
  v_lshlrev_b32 v4, 1, v4
  v_xor_b32 v4, v4, v2
  v_lshl_add_u32 v4, v3, 2, v4
  v_lshlrev_b32 v195, 4, v4
  s_and_b32 s55, s2, 7
  s_lshr_b32 s56, s2, 3
  s_lshr_b32 s41, s55, 2
  s_bfe_u32 s42, s55, 0x10001
  s_and_b32 s55, s55, 1
  s_lshl_b32 s55, s55, 2
  s_lshr_b32 s43, s56, 3
  s_add_u32 s43, s43, s55
  s_and_b32 s44, s56, 7
  s_mul_i32 s43, s43, 14
  s_mul_i32 s44, s44, 14
  s_cmp_lt_u32 s40, 4
  s_waitcnt lgkmcnt(0)
  s_mov_b32 s28, s6
  s_mov_b32 s29, s7
  s_mov_b32 s30, 221184
  s_mov_b32 s31, 0x00020000
  s_cbranch_scc1 M_mw
  s_mov_b32 s16, s4
  s_and_b32 s17, s5, 0xffff
  s_mov_b32 s18, 19267584
  s_mov_b32 s19, 0x00020000
  s_mov_b32 s24, s14
  s_and_b32 s25, s15, 0xffff
  s_mov_b32 s26, 268435456
  s_mov_b32 s27, 0x00020000
  s_mov_b32 s20, s10
  s_and_b32 s21, s11, 0xffff
  s_mov_b32 s22, 19267584
  s_mov_b32 s23, 0x00020000
  s_mov_b32 s36, s12
  s_and_b32 s37, s13, 0xffff
  s_mov_b32 s38, 256
  s_mov_b32 s39, 0x00020000
  s_mul_i32 s61, s41, 13
  s_add_i32 s61, s61, -6
  s_mul_i32 s62, s42, 13
  s_add_i32 s62, s62, -6
  s_cmp_ge_u32 s40, 4
  s_cselect_b32 s53, -4, 3
  s_add_i32 s53, s53, s40
  s_lshl_b32 s53, s53, 1
  s_mul_i32 s55, s41, 6
  s_add_i32 s45, s43, s55
  s_add_i32 s45, s45, -6
  s_cmp_eq_i32 s45, -6
  s_cselect_b32 s47, 6, 0
  s_cmp_eq_i32 s45, 98
  s_cselect_b32 s48, 7, 13
  s_cselect_b32 s49, 2, 0
  s_sub_i32 s45, s45, s49
  s_mul_i32 s55, s42, 6
  s_add_i32 s56, s44, s55
  s_add_i32 s56, s56, -6
  s_cmp_eq_i32 s56, -6
  s_cselect_b32 s50, 6, 0
  s_cmp_eq_i32 s56, 98
  s_cselect_b32 s51, 7, 13
  s_lshl_b32 s56, s56, 1
  s_add_i32 s56, s56, s42
  s_mul_i32 s46, s56, 384
  s_max_i32 s92, s53, s47
  s_min_i32 s92, s92, s48
  s_and_b32 s92, s92, -2
  s_add_u32 s52, s92, s49
  s_mov_b32 s54, 4286578688
  s_mov_b32 s63, 1037384597
  s_and_b32 s93, s40, 1
  s_lshl_b32 s93, s93, 3
  s_and_b32 s56, s40, 6
  s_or_b32 s93, s93, s56
  s_add_u32 s56, s40, 8
  s_add_i32 s100, s45, s56
  s_lshl_b32 s100, s100, 1
  s_add_i32 s100, s100, s41
  s_max_i32 s100, s100, 0
  s_min_i32 s100, s100, 223
  s_mul_i32 s100, s100, 86016
  s_mul_i32 s101, s56, 7680
  s_add_u32 s4, s43, s53
  s_mov_b32 s5, 86016
  s_movk_i32 s6, 384
  s_cmp_eq_u32 s40, 4
  s_cselect_b32 s94, s2, 999
  s_mov_b32 s0, 0x55555555
  s_mov_b32 s1, 0x55555555
  s_mov_b32 s10, 0x33333333
  s_mov_b32 s11, 0x33333333
  s_mov_b32 vcc_lo, 0
  s_mov_b32 vcc_hi, -1
  s_mov_b32 s32, s8
  s_and_b32 s33, s9, 0xffff
  s_mov_b32 s34, 73728
  s_mov_b32 s35, 0x00020000
  v_bfe_u32 v4, v1, 2, 2
  v_and_b32 v5, 3, v1
  v_lshrrev_b32 v6, 5, v1
  v_lshl_add_u32 v5, v2, 2, v5
  v_lshlrev_b32 v6, 7, v6
  v_sub_u32 v6, 256, v6
  v_lshrrev_b32 v197, 1, v4
  v_and_b32 v255, 1, v4
  v_add_u32 v197, s4, v197
  v_lshl_add_u32 v0, v255, 2, s44
  v_lshl_add_u32 v198, v197, 1, s61
  v_add_u32 v199, 112, v197
  v_lshlrev_b32 v255, 30, v255
  v_med3_i32 v197, v198, v197, v199
  v_mul_lo_u32 v197, v197, s5
  v_lshl_add_u32 v197, v5, 4, v197
  v_add_u32 v16, 0, v0
  v_lshl_add_u32 v198, v16, 1, s62
  v_add_u32 v199, 112, v16
  v_med3_i32 v16, v198, v16, v199
  v_mad_u32_u24 v16, v16, s6, v197
  v_add_u32 v20, 1, v0
  v_lshl_add_u32 v198, v20, 1, s62
  v_add_u32 v199, 112, v20
  v_med3_i32 v20, v198, v20, v199
  v_mad_u32_u24 v20, v20, s6, v197
  v_add_u32 v24, 2, v0
  v_lshl_add_u32 v198, v24, 1, s62
  v_add_u32 v199, 112, v24
  v_med3_i32 v24, v198, v24, v199
  v_mad_u32_u24 v24, v24, s6, v197
  v_add_u32 v28, 3, v0
  v_lshl_add_u32 v198, v28, 1, s62
  v_add_u32 v199, 112, v28
  v_med3_i32 v28, v198, v28, v199
  v_mad_u32_u24 v28, v28, s6, v197
  v_add_u32 v28, v28, v255
  v_add_u32 v40, 7, v0
  v_lshl_add_u32 v198, v40, 1, s62
  v_add_u32 v199, 112, v40
  v_med3_i32 v40, v198, v40, v199
  v_mad_u32_u24 v40, v40, s6, v197
  v_add_u32 v44, 8, v0
  v_lshl_add_u32 v198, v44, 1, s62
  v_add_u32 v199, 112, v44
  v_med3_i32 v44, v198, v44, v199
  v_mad_u32_u24 v44, v44, s6, v197
  v_add_u32 v48, 9, v0
  v_lshl_add_u32 v198, v48, 1, s62
  v_add_u32 v199, 112, v48
  v_med3_i32 v48, v198, v48, v199
  v_mad_u32_u24 v48, v48, s6, v197
  v_add_u32 v52, 10, v0
  v_lshl_add_u32 v198, v52, 1, s62
  v_add_u32 v199, 112, v52
  v_med3_i32 v52, v198, v52, v199
  v_mad_u32_u24 v52, v52, s6, v197
  v_add_u32 v52, v52, v255
  v_cndmask_b32 v32, v16, v40, vcc
  v_cndmask_b32 v36, v20, v44, vcc
  v_cndmask_b32 v56, v24, v48, vcc
  v_cndmask_b32 v60, v28, v52, vcc
  v_add_u32 v32, v32, v6
  v_add_u32 v36, v36, v6
  v_add_u32 v56, v56, v6
  v_add_u32 v60, v60, v6
  v_lshrrev_b32 v4, 3, v3
  v_add_u32 v4, s53, v4
  v_max_i32 v4, s47, v4
  v_min_i32 v4, s48, v4
  v_subrev_u32 v4, s92, v4
  v_and_b32 v5, 1, v2
  v_sub_u32 v6, v5, v4
  v_ashrrev_i32 v12, 31, v6
  v_and_b32 v12, s54, v12
  v_sub_u32 v6, v4, v5
  v_ashrrev_i32 v13, 31, v6
  v_and_b32 v13, s54, v13
  v_and_b32 v4, 7, v3
  v_lshrrev_b32 v5, 1, v2
  v_subrev_u32 v7, 7, v4
  v_ashrrev_i32 v7, 31, v7
  v_and_b32 v7, 0x7f, v7
  v_add_u32 v6, 0, v4
  v_max_i32 v6, s50, v6
  v_min_i32 v6, s51, v6
  v_lshlrev_b32 v6, v6, v7
  v_lshrrev_b32 v6, v5, v6
  v_not_b32 v14, v6
  v_add_u32 v6, 7, v4
  v_max_i32 v6, s50, v6
  v_min_i32 v6, s51, v6
  v_lshlrev_b32 v6, v6, v7
  v_lshrrev_b32 v6, v5, v6
  v_not_b32 v15, v6
  v_add_u32 v4, s52, v4
  v_and_b32 v5, 1, v4
  v_lshlrev_b32 v5, 3, v5
  v_and_or_b32 v5, v4, 6, v5
  v_mul_u32_u24 v4, 7680, v4
  v_lshrrev_b32 v6, 3, v3
  v_mul_u32_u24 v6, 24, v6
  v_add_u32 v6, v6, v2
  v_add_u32 v7, 0, v6
  v_xor_b32 v7, v7, v5
  v_lshl_add_u32 v240, v7, 4, v4
  v_add_u32 v7, 4, v6
  v_xor_b32 v7, v7, v5
  v_lshl_add_u32 v241, v7, 4, v4
  v_add_u32 v7, 8, v6
  v_xor_b32 v7, v7, v5
  v_lshl_add_u32 v242, v7, 4, v4
  v_add_u32 v7, 12, v6
  v_xor_b32 v7, v7, v5
  v_lshl_add_u32 v243, v7, 4, v4
  v_and_b32 v4, 1, v2
  v_lshlrev_b32 v4, 2, v4
  v_lshrrev_b32 v5, 2, v3
  v_add3_u32 v4, v4, v5, s52
  v_and_b32 v5, 1, v4
  v_lshlrev_b32 v5, 3, v5
  v_and_or_b32 v5, v4, 6, v5
  v_mul_u32_u24 v4, 7680, v4
  v_and_b32 v6, 1, v3
  v_lshl_add_u32 v4, v6, 3, v4
  v_lshrrev_b32 v6, 1, v2
  v_mul_u32_u24 v6, 24, v6
  v_bfe_u32 v7, v3, 1, 1
  v_add_u32 v6, v6, v7
  v_add_u32 v7, 0, v6
  v_xor_b32 v7, v7, v5
  v_lshl_add_u32 v244, v7, 4, v4
  v_add_u32 v7, 2, v6
  v_xor_b32 v7, v7, v5
  v_lshl_add_u32 v245, v7, 4, v4
  v_add_u32 v7, 4, v6
  v_xor_b32 v7, v7, v5
  v_lshl_add_u32 v246, v7, 4, v4
  v_add_u32 v7, 6, v6
  v_xor_b32 v7, v7, v5
  v_lshl_add_u32 v247, v7, 4, v4
  v_add_u32 v7, 8, v6
  v_xor_b32 v7, v7, v5
  v_lshl_add_u32 v248, v7, 4, v4
  v_add_u32 v7, 10, v6
  v_xor_b32 v7, v7, v5
  v_lshl_add_u32 v249, v7, 4, v4
  v_add_u32 v7, 12, v6
  v_xor_b32 v7, v7, v5
  v_lshl_add_u32 v250, v7, 4, v4
  v_add_u32 v7, 14, v6
  v_xor_b32 v7, v7, v5
  v_lshl_add_u32 v251, v7, 4, v4
  v_add_u32 v253, 153600, v252
  v_add_u32 v254, 90112, v252
  v_add_u32 v4, 0, v1
  v_xor_b32 v4, s93, v4
  v_mul_u32_u24 v5, 2731, v4
  v_lshrrev_b32 v5, 16, v5
  v_mul_u32_u24 v5, 384, v5
  v_lshl_add_u32 v4, v4, 4, v5
  v_add_u32 v232, s46, v4
  v_add_u32 v235, 6144, v232
  v_add_u32 v238, 12288, v232
  v_max_i32 v232, 0, v232
  v_add_u32 v4, 64, v1
  v_xor_b32 v4, s93, v4
  v_mul_u32_u24 v5, 2731, v4
  v_lshrrev_b32 v5, 16, v5
  v_mul_u32_u24 v5, 384, v5
  v_lshl_add_u32 v4, v4, 4, v5
  v_add_u32 v233, s46, v4
  v_add_u32 v236, 6144, v233
  v_max_i32 v233, 0, v233
  v_add_u32 v4, 128, v1
  v_xor_b32 v4, s93, v4
  v_mul_u32_u24 v5, 2731, v4
  v_lshrrev_b32 v5, 16, v5
  v_mul_u32_u24 v5, 384, v5
  v_lshl_add_u32 v4, v4, 4, v5
  v_add_u32 v234, s46, v4
  v_add_u32 v237, 6144, v234
  v_max_i32 v234, 0, v234
  v_add_u32 v4, 416, v1
  v_xor_b32 v4, s93, v4
  v_mul_u32_u24 v5, 2731, v4
  v_lshrrev_b32 v5, 16, v5
  v_mul_u32_u24 v5, 384, v5
  v_lshl_add_u32 v4, v4, 4, v5
  v_add_u32 v239, s46, v4
  v_lshrrev_b32 v197, 1, v2
  v_and_b32 v255, 1, v2
  v_add_u32 v197, s4, v197
  v_lshl_add_u32 v0, v255, 2, s44
  v_lshl_add_u32 v198, v197, 1, s61
  v_add_u32 v199, 112, v197
  v_lshlrev_b32 v255, 30, v255
  v_med3_i32 v197, v198, v197, v199
  v_mul_lo_u32 v197, v197, s5
  v_lshl_add_u32 v197, v3, 3, v197
  v_add_u32 v4, 0, v0
  v_lshl_add_u32 v198, v4, 1, s62
  v_add_u32 v199, 112, v4
  v_med3_i32 v4, v198, v4, v199
  v_mad_u32_u24 v4, v4, s6, v197
  v_add_u32 v5, 1, v0
  v_lshl_add_u32 v198, v5, 1, s62
  v_add_u32 v199, 112, v5
  v_med3_i32 v5, v198, v5, v199
  v_mad_u32_u24 v5, v5, s6, v197
  v_add_u32 v6, 2, v0
  v_lshl_add_u32 v198, v6, 1, s62
  v_add_u32 v199, 112, v6
  v_med3_i32 v6, v198, v6, v199
  v_mad_u32_u24 v6, v6, s6, v197
  v_add_u32 v7, 3, v0
  v_lshl_add_u32 v198, v7, 1, s62
  v_add_u32 v199, 112, v7
  v_med3_i32 v7, v198, v7, v199
  v_mad_u32_u24 v7, v7, s6, v197
  v_add_u32 v7, v7, v255
  v_add_u32 v8, 7, v0
  v_lshl_add_u32 v198, v8, 1, s62
  v_add_u32 v199, 112, v8
  v_med3_i32 v8, v198, v8, v199
  v_mad_u32_u24 v8, v8, s6, v197
  v_add_u32 v9, 8, v0
  v_lshl_add_u32 v198, v9, 1, s62
  v_add_u32 v199, 112, v9
  v_med3_i32 v9, v198, v9, v199
  v_mad_u32_u24 v9, v9, s6, v197
  v_add_u32 v10, 9, v0
  v_lshl_add_u32 v198, v10, 1, s62
  v_add_u32 v199, 112, v10
  v_med3_i32 v10, v198, v10, v199
  v_mad_u32_u24 v10, v10, s6, v197
  v_add_u32 v11, 10, v0
  v_lshl_add_u32 v198, v11, 1, s62
  v_add_u32 v199, 112, v11
  v_med3_i32 v11, v198, v11, v199
  v_mad_u32_u24 v11, v11, s6, v197
  v_add_u32 v11, v11, v255
  s_and_b32 s55, s40, 3
  s_mul_i32 s57, s55, 6144
  s_mul_i32 s56, s55, 4608
  s_add_u32 m0, s57, 0
  s_nop 0
  buffer_load_dwordx4 v201, s[28:31], s56 offen offset:0 lds
  s_add_u32 m0, s57, 960
  s_nop 0
  buffer_load_dwordx4 v201, s[28:31], s56 offen offset:64 lds
  s_add_u32 m0, s57, 1920
  s_nop 0
  buffer_load_dwordx4 v201, s[28:31], s56 offen offset:128 lds
  s_add_u32 m0, s57, 2880
  s_nop 0
  buffer_load_dwordx4 v201, s[28:31], s56 offen offset:192 lds
  s_add_u32 m0, s57, 3840
  s_nop 0
  buffer_load_dwordx4 v201, s[28:31], s56 offen offset:256 lds
  s_add_u32 m0, s57, 4800
  s_nop 0
  buffer_load_dwordx4 v201, s[28:31], s56 offen offset:320 lds
  s_add_u32 s56, s56, 18432
  s_add_u32 m0, s57, 24576
  s_nop 0
  buffer_load_dwordx4 v201, s[28:31], s56 offen offset:0 lds
  s_add_u32 m0, s57, 25536
  s_nop 0
  buffer_load_dwordx4 v201, s[28:31], s56 offen offset:64 lds
  s_add_u32 m0, s57, 26496
  s_nop 0
  buffer_load_dwordx4 v201, s[28:31], s56 offen offset:128 lds
  s_add_u32 m0, s57, 27456
  s_nop 0
  buffer_load_dwordx4 v201, s[28:31], s56 offen offset:192 lds
  s_add_u32 m0, s57, 28416
  s_nop 0
  buffer_load_dwordx4 v201, s[28:31], s56 offen offset:256 lds
  s_add_u32 m0, s57, 29376
  s_nop 0
  buffer_load_dwordx4 v201, s[28:31], s56 offen offset:320 lds
  s_add_u32 s56, s56, 129024
  s_add_u32 m0, s57, 49152
  s_nop 0
  buffer_load_dwordx4 v202, s[28:31], s56 offen offset:0 lds
  s_add_u32 m0, s57, 50112
  s_nop 0
  buffer_load_dwordx4 v202, s[28:31], s56 offen offset:64 lds
  s_add_u32 m0, s57, 51072
  s_nop 0
  buffer_load_dwordx4 v202, s[28:31], s56 offen offset:128 lds
  s_add_u32 m0, s57, 52032
  s_nop 0
  buffer_load_dwordx4 v202, s[28:31], s56 offen offset:192 lds
  s_add_u32 m0, s57, 52992
  s_nop 0
  buffer_load_dwordx4 v202, s[28:31], s56 offen offset:256 lds
  s_add_u32 m0, s57, 53952
  s_nop 0
  buffer_load_dwordx4 v202, s[28:31], s56 offen offset:320 lds
  s_waitcnt vmcnt(12)
  s_barrier
  buffer_load_dwordx4 v[16:19], v16, s[16:19], 0 offen
  buffer_load_dwordx4 v[20:23], v20, s[16:19], 0 offen
  buffer_load_dwordx4 v[24:27], v24, s[16:19], 0 offen
  buffer_load_dwordx4 v[28:31], v28, s[16:19], 0 offen
  buffer_load_dwordx4 v[40:43], v40, s[16:19], 0 offen
  buffer_load_dwordx4 v[44:47], v44, s[16:19], 0 offen
  s_waitcnt vmcnt(6)
  s_barrier
  s_cmp_ge_u32 s94, 144
  s_cbranch_scc1 M_v1
  s_mul_hi_u32 s55, s2, 0x15555556
  s_mul_i32 s56, s55, 12
  s_sub_u32 s56, s2, s56
  s_mul_i32 s57, s55, 18432
  s_mov_b32 m0, 72960
  s_nop 0
  buffer_load_dwordx4 v203, s[28:31], s57 offen offset:768 lds
  s_mov_b32 m0, 73920
  s_nop 0
  buffer_load_dwordx4 v203, s[28:31], s57 offen offset:832 lds
  s_mov_b32 m0, 74880
  s_nop 0
  buffer_load_dwordx4 v203, s[28:31], s57 offen offset:896 lds
  s_mov_b32 m0, 75840
  s_nop 0
  buffer_load_dwordx4 v203, s[28:31], s57 offen offset:960 lds
  s_mov_b32 m0, 76800
  s_nop 0
  buffer_load_dwordx4 v203, s[28:31], s57 offen offset:1024 lds
  s_mov_b32 m0, 77760
  s_nop 0
  buffer_load_dwordx4 v203, s[28:31], s57 offen offset:1088 lds
  v_lshrrev_b32 v112, 1, v1
  v_mul_u32_u24 v112, 384, v112
  v_and_b32 v113, 1, v1
  v_lshl_add_u32 v112, v113, 4, v112
  s_lshl_b32 s57, s56, 5
  s_mov_b32 m0, 79872
  s_nop 0
  buffer_load_dwordx4 v112, s[32:35], s57 offen lds
  s_add_u32 s57, s57, 12288
  s_mov_b32 m0, 80896
  s_nop 0
  buffer_load_dwordx4 v112, s[32:35], s57 offen lds
  s_add_u32 s57, s57, 12288
  s_mov_b32 m0, 81920
  s_nop 0
  buffer_load_dwordx4 v112, s[32:35], s57 offen lds
  s_add_u32 s57, s57, 12288
  s_mov_b32 m0, 82944
  s_nop 0
  buffer_load_dwordx4 v112, s[32:35], s57 offen lds
  s_add_u32 s57, s57, 12288
  s_mov_b32 m0, 83968
  s_nop 0
  buffer_load_dwordx4 v112, s[32:35], s57 offen lds
  s_add_u32 s57, s57, 12288
  s_mov_b32 m0, 84992
  s_nop 0
  buffer_load_dwordx4 v112, s[32:35], s57 offen lds
  s_add_u32 s57, s57, 12288
  s_lshr_b32 s57, s56, 2
  s_mul_i32 s95, s57, 24576
  s_and_b32 s56, s56, 3
  s_lshl_b32 s56, s56, 6
  s_add_u32 s95, s95, s56
  s_lshr_b32 s56, s55, 1
  s_lshl_b32 s56, s56, 11
  s_add_u32 s95, s95, s56
  s_and_b32 s55, s55, 1
  s_lshl_b32 s55, s55, 3
  s_add_u32 s95, s95, s55
M_v1:
  buffer_load_dwordx4 v[48:51], v48, s[16:19], 0 offen
  buffer_load_dwordx4 v[52:55], v52, s[16:19], 0 offen
  buffer_load_dwordx4 v[32:35], v32, s[16:19], 0 offen
  buffer_load_dwordx4 v[36:39], v36, s[16:19], 0 offen
  buffer_load_dwordx4 v[56:59], v56, s[16:19], 0 offen
  buffer_load_dwordx4 v[60:63], v60, s[16:19], 0 offen
  v_add_u32 v118, 73728, v195
  s_cmp_ge_u32 s94, 144
  s_cbranch_scc1 M_v2
  v_lshlrev_b32 v119, 3, v3
  v_lshl_add_u32 v119, v2, 8, v119
  v_add_u32 v119, 79872, v119
  s_waitcnt vmcnt(6)
  ds_read_b128 v[64:67], v118 offset:0
  ds_read_b128 v[68:71], v118 offset:1024
  ds_read_b128 v[72:75], v118 offset:2048
  ds_read_b128 v[76:79], v118 offset:3072
  ds_read_b128 v[80:83], v118 offset:4096
  ds_read_b128 v[84:87], v118 offset:5120
  s_waitcnt lgkmcnt(2)
  ds_read_b64_tr_b16 v[88:89], v119 offset:0
  ds_read_b64_tr_b16 v[90:91], v119 offset:128
  ds_read_b64_tr_b16 v[92:93], v119 offset:1024
  ds_read_b64_tr_b16 v[94:95], v119 offset:1152
  ds_read_b64_tr_b16 v[96:97], v119 offset:2048
  ds_read_b64_tr_b16 v[98:99], v119 offset:2176
  ds_read_b64_tr_b16 v[100:101], v119 offset:3072
  ds_read_b64_tr_b16 v[102:103], v119 offset:3200
  ds_read_b64_tr_b16 v[104:105], v119 offset:4096
  ds_read_b64_tr_b16 v[106:107], v119 offset:4224
  ds_read_b64_tr_b16 v[108:109], v119 offset:5120
  ds_read_b64_tr_b16 v[110:111], v119 offset:5248
  s_waitcnt lgkmcnt(0)
  v_mfma_f32_16x16x32_bf16 v[112:115], v[64:67], v[88:91], 0
  v_mfma_f32_16x16x32_bf16 v[112:115], v[68:71], v[92:95], v[112:115]
  v_mfma_f32_16x16x32_bf16 v[112:115], v[72:75], v[96:99], v[112:115]
  v_mfma_f32_16x16x32_bf16 v[112:115], v[76:79], v[100:103], v[112:115]
  v_mfma_f32_16x16x32_bf16 v[112:115], v[80:83], v[104:107], v[112:115]
  v_mfma_f32_16x16x32_bf16 v[112:115], v[84:87], v[108:111], v[112:115]
  v_bfe_u32 v118, v3, 1, 1
  v_mul_u32_u24 v118, 12288, v118
  v_and_b32 v119, 1, v3
  v_lshl_add_u32 v118, v119, 10, v118
  v_lshrrev_b32 v119, 2, v3
  v_lshl_add_u32 v118, v119, 4, v118
  v_lshl_add_u32 v118, v2, 8, v118
  s_nop 0
  v_cvt_pk_bf16_f32 v116, v112, v113
  v_cvt_pk_bf16_f32 v117, v114, v115
M_v2:
  s_mov_b64 vcc, s[0:1]
  s_waitcnt vmcnt(10)
  v_cndmask_b32_dpp v168, v20, v16, vcc quad_perm:[1,0,3,2] row_mask:0xf bank_mask:0xf
  v_cndmask_b32_dpp v169, v21, v17, vcc quad_perm:[1,0,3,2] row_mask:0xf bank_mask:0xf
  v_cndmask_b32_dpp v170, v22, v18, vcc quad_perm:[1,0,3,2] row_mask:0xf bank_mask:0xf
  v_cndmask_b32_dpp v171, v23, v19, vcc quad_perm:[1,0,3,2] row_mask:0xf bank_mask:0xf
  s_waitcnt vmcnt(8)
  v_cndmask_b32_dpp v176, v28, v24, vcc quad_perm:[1,0,3,2] row_mask:0xf bank_mask:0xf
  v_cndmask_b32_dpp v177, v29, v25, vcc quad_perm:[1,0,3,2] row_mask:0xf bank_mask:0xf
  v_cndmask_b32_dpp v178, v30, v26, vcc quad_perm:[1,0,3,2] row_mask:0xf bank_mask:0xf
  v_cndmask_b32_dpp v179, v31, v27, vcc quad_perm:[1,0,3,2] row_mask:0xf bank_mask:0xf
  s_not_b64 vcc, vcc
  v_cndmask_b32_dpp v172, v16, v20, vcc quad_perm:[1,0,3,2] row_mask:0xf bank_mask:0xf
  v_cndmask_b32_dpp v173, v17, v21, vcc quad_perm:[1,0,3,2] row_mask:0xf bank_mask:0xf
  v_cndmask_b32_dpp v174, v18, v22, vcc quad_perm:[1,0,3,2] row_mask:0xf bank_mask:0xf
  v_cndmask_b32_dpp v175, v19, v23, vcc quad_perm:[1,0,3,2] row_mask:0xf bank_mask:0xf
  v_cndmask_b32_dpp v180, v24, v28, vcc quad_perm:[1,0,3,2] row_mask:0xf bank_mask:0xf
  v_cndmask_b32_dpp v181, v25, v29, vcc quad_perm:[1,0,3,2] row_mask:0xf bank_mask:0xf
  v_cndmask_b32_dpp v182, v26, v30, vcc quad_perm:[1,0,3,2] row_mask:0xf bank_mask:0xf
  v_cndmask_b32_dpp v183, v27, v31, vcc quad_perm:[1,0,3,2] row_mask:0xf bank_mask:0xf
  s_mov_b64 vcc, s[10:11]
  v_cndmask_b32_dpp v16, v176, v168, vcc quad_perm:[2,3,0,1] row_mask:0xf bank_mask:0xf
  v_cndmask_b32_dpp v17, v177, v169, vcc quad_perm:[2,3,0,1] row_mask:0xf bank_mask:0xf
  v_cndmask_b32_dpp v18, v178, v170, vcc quad_perm:[2,3,0,1] row_mask:0xf bank_mask:0xf
  v_cndmask_b32_dpp v19, v179, v171, vcc quad_perm:[2,3,0,1] row_mask:0xf bank_mask:0xf
  v_cndmask_b32_dpp v20, v180, v172, vcc quad_perm:[2,3,0,1] row_mask:0xf bank_mask:0xf
  v_cndmask_b32_dpp v21, v181, v173, vcc quad_perm:[2,3,0,1] row_mask:0xf bank_mask:0xf
  v_cndmask_b32_dpp v22, v182, v174, vcc quad_perm:[2,3,0,1] row_mask:0xf bank_mask:0xf
  v_cndmask_b32_dpp v23, v183, v175, vcc quad_perm:[2,3,0,1] row_mask:0xf bank_mask:0xf
  s_not_b64 vcc, vcc
  v_cndmask_b32_dpp v24, v168, v176, vcc quad_perm:[2,3,0,1] row_mask:0xf bank_mask:0xf
  v_cndmask_b32_dpp v25, v169, v177, vcc quad_perm:[2,3,0,1] row_mask:0xf bank_mask:0xf
  v_cndmask_b32_dpp v26, v170, v178, vcc quad_perm:[2,3,0,1] row_mask:0xf bank_mask:0xf
  v_cndmask_b32_dpp v27, v171, v179, vcc quad_perm:[2,3,0,1] row_mask:0xf bank_mask:0xf
  v_cndmask_b32_dpp v28, v172, v180, vcc quad_perm:[2,3,0,1] row_mask:0xf bank_mask:0xf
  v_cndmask_b32_dpp v29, v173, v181, vcc quad_perm:[2,3,0,1] row_mask:0xf bank_mask:0xf
  v_cndmask_b32_dpp v30, v174, v182, vcc quad_perm:[2,3,0,1] row_mask:0xf bank_mask:0xf
  v_cndmask_b32_dpp v31, v175, v183, vcc quad_perm:[2,3,0,1] row_mask:0xf bank_mask:0xf
  s_mov_b64 vcc, s[0:1]
  s_waitcnt vmcnt(6)
  v_cndmask_b32_dpp v168, v44, v40, vcc quad_perm:[1,0,3,2] row_mask:0xf bank_mask:0xf
  v_cndmask_b32_dpp v169, v45, v41, vcc quad_perm:[1,0,3,2] row_mask:0xf bank_mask:0xf
  v_cndmask_b32_dpp v170, v46, v42, vcc quad_perm:[1,0,3,2] row_mask:0xf bank_mask:0xf
  v_cndmask_b32_dpp v171, v47, v43, vcc quad_perm:[1,0,3,2] row_mask:0xf bank_mask:0xf
  s_waitcnt vmcnt(4)
  v_cndmask_b32_dpp v176, v52, v48, vcc quad_perm:[1,0,3,2] row_mask:0xf bank_mask:0xf
  v_cndmask_b32_dpp v177, v53, v49, vcc quad_perm:[1,0,3,2] row_mask:0xf bank_mask:0xf
  v_cndmask_b32_dpp v178, v54, v50, vcc quad_perm:[1,0,3,2] row_mask:0xf bank_mask:0xf
  v_cndmask_b32_dpp v179, v55, v51, vcc quad_perm:[1,0,3,2] row_mask:0xf bank_mask:0xf
  s_not_b64 vcc, vcc
  v_cndmask_b32_dpp v172, v40, v44, vcc quad_perm:[1,0,3,2] row_mask:0xf bank_mask:0xf
  v_cndmask_b32_dpp v173, v41, v45, vcc quad_perm:[1,0,3,2] row_mask:0xf bank_mask:0xf
  v_cndmask_b32_dpp v174, v42, v46, vcc quad_perm:[1,0,3,2] row_mask:0xf bank_mask:0xf
  v_cndmask_b32_dpp v175, v43, v47, vcc quad_perm:[1,0,3,2] row_mask:0xf bank_mask:0xf
  v_cndmask_b32_dpp v180, v48, v52, vcc quad_perm:[1,0,3,2] row_mask:0xf bank_mask:0xf
  v_cndmask_b32_dpp v181, v49, v53, vcc quad_perm:[1,0,3,2] row_mask:0xf bank_mask:0xf
  v_cndmask_b32_dpp v182, v50, v54, vcc quad_perm:[1,0,3,2] row_mask:0xf bank_mask:0xf
  v_cndmask_b32_dpp v183, v51, v55, vcc quad_perm:[1,0,3,2] row_mask:0xf bank_mask:0xf
  s_mov_b64 vcc, s[10:11]
  v_cndmask_b32_dpp v40, v176, v168, vcc quad_perm:[2,3,0,1] row_mask:0xf bank_mask:0xf
  v_cndmask_b32_dpp v41, v177, v169, vcc quad_perm:[2,3,0,1] row_mask:0xf bank_mask:0xf
  v_cndmask_b32_dpp v42, v178, v170, vcc quad_perm:[2,3,0,1] row_mask:0xf bank_mask:0xf
  v_cndmask_b32_dpp v43, v179, v171, vcc quad_perm:[2,3,0,1] row_mask:0xf bank_mask:0xf
  v_cndmask_b32_dpp v44, v180, v172, vcc quad_perm:[2,3,0,1] row_mask:0xf bank_mask:0xf
  v_cndmask_b32_dpp v45, v181, v173, vcc quad_perm:[2,3,0,1] row_mask:0xf bank_mask:0xf
  v_cndmask_b32_dpp v46, v182, v174, vcc quad_perm:[2,3,0,1] row_mask:0xf bank_mask:0xf
  v_cndmask_b32_dpp v47, v183, v175, vcc quad_perm:[2,3,0,1] row_mask:0xf bank_mask:0xf
  s_not_b64 vcc, vcc
  v_cndmask_b32_dpp v48, v168, v176, vcc quad_perm:[2,3,0,1] row_mask:0xf bank_mask:0xf
  v_cndmask_b32_dpp v49, v169, v177, vcc quad_perm:[2,3,0,1] row_mask:0xf bank_mask:0xf
  v_cndmask_b32_dpp v50, v170, v178, vcc quad_perm:[2,3,0,1] row_mask:0xf bank_mask:0xf
  v_cndmask_b32_dpp v51, v171, v179, vcc quad_perm:[2,3,0,1] row_mask:0xf bank_mask:0xf
  v_cndmask_b32_dpp v52, v172, v180, vcc quad_perm:[2,3,0,1] row_mask:0xf bank_mask:0xf
  v_cndmask_b32_dpp v53, v173, v181, vcc quad_perm:[2,3,0,1] row_mask:0xf bank_mask:0xf
  v_cndmask_b32_dpp v54, v174, v182, vcc quad_perm:[2,3,0,1] row_mask:0xf bank_mask:0xf
  v_cndmask_b32_dpp v55, v175, v183, vcc quad_perm:[2,3,0,1] row_mask:0xf bank_mask:0xf
  s_mov_b64 vcc, s[0:1]
  s_waitcnt vmcnt(2)
  v_cndmask_b32_dpp v168, v36, v32, vcc quad_perm:[1,0,3,2] row_mask:0xf bank_mask:0xf
  v_cndmask_b32_dpp v169, v37, v33, vcc quad_perm:[1,0,3,2] row_mask:0xf bank_mask:0xf
  v_cndmask_b32_dpp v170, v38, v34, vcc quad_perm:[1,0,3,2] row_mask:0xf bank_mask:0xf
  v_cndmask_b32_dpp v171, v39, v35, vcc quad_perm:[1,0,3,2] row_mask:0xf bank_mask:0xf
  s_waitcnt vmcnt(0)
  v_cndmask_b32_dpp v176, v60, v56, vcc quad_perm:[1,0,3,2] row_mask:0xf bank_mask:0xf
  v_cndmask_b32_dpp v177, v61, v57, vcc quad_perm:[1,0,3,2] row_mask:0xf bank_mask:0xf
  v_cndmask_b32_dpp v178, v62, v58, vcc quad_perm:[1,0,3,2] row_mask:0xf bank_mask:0xf
  v_cndmask_b32_dpp v179, v63, v59, vcc quad_perm:[1,0,3,2] row_mask:0xf bank_mask:0xf
  s_not_b64 vcc, vcc
  v_cndmask_b32_dpp v172, v32, v36, vcc quad_perm:[1,0,3,2] row_mask:0xf bank_mask:0xf
  v_cndmask_b32_dpp v173, v33, v37, vcc quad_perm:[1,0,3,2] row_mask:0xf bank_mask:0xf
  v_cndmask_b32_dpp v174, v34, v38, vcc quad_perm:[1,0,3,2] row_mask:0xf bank_mask:0xf
  v_cndmask_b32_dpp v175, v35, v39, vcc quad_perm:[1,0,3,2] row_mask:0xf bank_mask:0xf
  v_cndmask_b32_dpp v180, v56, v60, vcc quad_perm:[1,0,3,2] row_mask:0xf bank_mask:0xf
  v_cndmask_b32_dpp v181, v57, v61, vcc quad_perm:[1,0,3,2] row_mask:0xf bank_mask:0xf
  v_cndmask_b32_dpp v182, v58, v62, vcc quad_perm:[1,0,3,2] row_mask:0xf bank_mask:0xf
  v_cndmask_b32_dpp v183, v59, v63, vcc quad_perm:[1,0,3,2] row_mask:0xf bank_mask:0xf
  s_mov_b64 vcc, s[10:11]
  v_cndmask_b32_dpp v32, v176, v168, vcc quad_perm:[2,3,0,1] row_mask:0xf bank_mask:0xf
  v_cndmask_b32_dpp v33, v177, v169, vcc quad_perm:[2,3,0,1] row_mask:0xf bank_mask:0xf
  v_cndmask_b32_dpp v34, v178, v170, vcc quad_perm:[2,3,0,1] row_mask:0xf bank_mask:0xf
  v_cndmask_b32_dpp v35, v179, v171, vcc quad_perm:[2,3,0,1] row_mask:0xf bank_mask:0xf
  v_cndmask_b32_dpp v36, v180, v172, vcc quad_perm:[2,3,0,1] row_mask:0xf bank_mask:0xf
  v_cndmask_b32_dpp v37, v181, v173, vcc quad_perm:[2,3,0,1] row_mask:0xf bank_mask:0xf
  v_cndmask_b32_dpp v38, v182, v174, vcc quad_perm:[2,3,0,1] row_mask:0xf bank_mask:0xf
  v_cndmask_b32_dpp v39, v183, v175, vcc quad_perm:[2,3,0,1] row_mask:0xf bank_mask:0xf
  s_not_b64 vcc, vcc
  v_cndmask_b32_dpp v56, v168, v176, vcc quad_perm:[2,3,0,1] row_mask:0xf bank_mask:0xf
  v_cndmask_b32_dpp v57, v169, v177, vcc quad_perm:[2,3,0,1] row_mask:0xf bank_mask:0xf
  v_cndmask_b32_dpp v58, v170, v178, vcc quad_perm:[2,3,0,1] row_mask:0xf bank_mask:0xf
  v_cndmask_b32_dpp v59, v171, v179, vcc quad_perm:[2,3,0,1] row_mask:0xf bank_mask:0xf
  v_cndmask_b32_dpp v60, v172, v180, vcc quad_perm:[2,3,0,1] row_mask:0xf bank_mask:0xf
  v_cndmask_b32_dpp v61, v173, v181, vcc quad_perm:[2,3,0,1] row_mask:0xf bank_mask:0xf
  v_cndmask_b32_dpp v62, v174, v182, vcc quad_perm:[2,3,0,1] row_mask:0xf bank_mask:0xf
  v_cndmask_b32_dpp v63, v175, v183, vcc quad_perm:[2,3,0,1] row_mask:0xf bank_mask:0xf
  v_permlane32_swap_b32 v32, v56
  v_permlane32_swap_b32 v33, v57
  v_permlane32_swap_b32 v34, v58
  v_permlane32_swap_b32 v35, v59
  v_permlane32_swap_b32 v36, v60
  v_permlane32_swap_b32 v37, v61
  v_permlane32_swap_b32 v38, v62
  v_permlane32_swap_b32 v39, v63
  s_cmp_ge_u32 s94, 144
  s_cbranch_scc1 M_v3
  buffer_store_dwordx2 v[116:117], v118, s[24:27], s95 offen sc1
M_v3:
  s_barrier
  s_setprio 1
  s_branch M_pa
M_mw:
  s_lshr_b32 s55, s2, 3
  s_cmp_lg_u32 s40, 1
  s_cbranch_scc1 M_nowarm1
  s_mul_i32 s55, s55, 6912
  s_add_u32 s56, s55, 4096
  buffer_load_dwordx4 v[136:139], v252, s[28:31], s55 offen offset:0
  buffer_load_dwordx4 v[140:143], v252, s[28:31], s55 offen offset:1024
  buffer_load_dwordx4 v[144:147], v252, s[28:31], s55 offen offset:2048
  buffer_load_dwordx4 v[148:151], v252, s[28:31], s55 offen offset:3072
  buffer_load_dwordx4 v[152:155], v252, s[28:31], s56 offen offset:0
  buffer_load_dwordx4 v[156:159], v252, s[28:31], s56 offen offset:1024
  buffer_load_dwordx4 v[160:163], v252, s[28:31], s56 offen offset:2048
M_nowarm1:
  s_cmp_lg_u32 s40, 2
  s_cbranch_scc1 M_nowarm2
  s_mov_b32 s32, s8
  s_and_b32 s33, s9, 0xffff
  s_mov_b32 s34, 73728
  s_mov_b32 s35, 0x00020000
  s_mul_i32 s55, s55, 2304
  s_waitcnt vmcnt(6)
  buffer_load_dwordx4 v[136:139], v252, s[32:35], s55 offen offset:0
  s_waitcnt vmcnt(6)
  buffer_load_dwordx4 v[140:143], v252, s[32:35], s55 offen offset:1024
  s_waitcnt vmcnt(6)
  buffer_load_dwordx4 v[144:147], v252, s[32:35], s55 offen offset:2048
M_nowarm2:
  s_mul_i32 s57, s40, 18432
  s_mul_i32 s55, s40, 3
  s_add_u32 s56, s55, 0
  s_lshr_b32 s58, s56, 1
  s_and_b32 s56, s56, 1
  s_mul_i32 s59, s58, 12
  s_add_u32 s59, s59, s56
  s_lshl_b32 s59, s59, 10
  s_add_u32 s59, s59, 90112
  v_add_u32 v192, s59, v252
  s_mul_i32 s58, s58, 36864
  s_mul_i32 s56, s56, 4608
  s_add_u32 s56, s56, s58
  s_add_u32 m0, s57, 89728
  s_nop 0
  buffer_load_dwordx4 v200, s[28:31], s56 offen offset:384 lds
  s_add_u32 m0, s57, 90688
  s_nop 0
  buffer_load_dwordx4 v200, s[28:31], s56 offen offset:448 lds
  s_add_u32 m0, s57, 91648
  s_nop 0
  buffer_load_dwordx4 v200, s[28:31], s56 offen offset:512 lds
  s_add_u32 m0, s57, 92608
  s_nop 0
  buffer_load_dwordx4 v200, s[28:31], s56 offen offset:576 lds
  s_add_u32 m0, s57, 93568
  s_nop 0
  buffer_load_dwordx4 v200, s[28:31], s56 offen offset:640 lds
  s_add_u32 m0, s57, 94528
  s_nop 0
  buffer_load_dwordx4 v200, s[28:31], s56 offen offset:704 lds
  s_add_u32 s56, s55, 1
  s_lshr_b32 s58, s56, 1
  s_and_b32 s56, s56, 1
  s_mul_i32 s59, s58, 12
  s_add_u32 s59, s59, s56
  s_lshl_b32 s59, s59, 10
  s_add_u32 s59, s59, 90112
  v_add_u32 v193, s59, v252
  s_mul_i32 s58, s58, 36864
  s_mul_i32 s56, s56, 4608
  s_add_u32 s56, s56, s58
  s_add_u32 m0, s57, 95872
  s_nop 0
  buffer_load_dwordx4 v200, s[28:31], s56 offen offset:384 lds
  s_add_u32 m0, s57, 96832
  s_nop 0
  buffer_load_dwordx4 v200, s[28:31], s56 offen offset:448 lds
  s_add_u32 m0, s57, 97792
  s_nop 0
  buffer_load_dwordx4 v200, s[28:31], s56 offen offset:512 lds
  s_add_u32 m0, s57, 98752
  s_nop 0
  buffer_load_dwordx4 v200, s[28:31], s56 offen offset:576 lds
  s_add_u32 m0, s57, 99712
  s_nop 0
  buffer_load_dwordx4 v200, s[28:31], s56 offen offset:640 lds
  s_add_u32 m0, s57, 100672
  s_nop 0
  buffer_load_dwordx4 v200, s[28:31], s56 offen offset:704 lds
  s_add_u32 s56, s55, 2
  s_lshr_b32 s58, s56, 1
  s_and_b32 s56, s56, 1
  s_mul_i32 s59, s58, 12
  s_add_u32 s59, s59, s56
  s_lshl_b32 s59, s59, 10
  s_add_u32 s59, s59, 90112
  v_add_u32 v194, s59, v252
  s_mul_i32 s58, s58, 36864
  s_mul_i32 s56, s56, 4608
  s_add_u32 s56, s56, s58
  s_add_u32 m0, s57, 102016
  s_nop 0
  buffer_load_dwordx4 v200, s[28:31], s56 offen offset:384 lds
  s_add_u32 m0, s57, 102976
  s_nop 0
  buffer_load_dwordx4 v200, s[28:31], s56 offen offset:448 lds
  s_add_u32 m0, s57, 103936
  s_nop 0
  buffer_load_dwordx4 v200, s[28:31], s56 offen offset:512 lds
  s_add_u32 m0, s57, 104896
  s_nop 0
  buffer_load_dwordx4 v200, s[28:31], s56 offen offset:576 lds
  s_add_u32 m0, s57, 105856
  s_nop 0
  buffer_load_dwordx4 v200, s[28:31], s56 offen offset:640 lds
  s_add_u32 m0, s57, 106816
  s_nop 0
  buffer_load_dwordx4 v200, s[28:31], s56 offen offset:704 lds
  s_add_u32 s57, s57, 90112
  v_add_u32 v184, s57, v195
  v_add_u32 v196, 36864, v195
  s_mov_b32 s16, s4
  s_and_b32 s17, s5, 0xffff
  s_mov_b32 s18, 19267584
  s_mov_b32 s19, 0x00020000
  s_mov_b32 s24, s14
  s_and_b32 s25, s15, 0xffff
  s_mov_b32 s26, 268435456
  s_mov_b32 s27, 0x00020000
  s_mov_b32 s20, s10
  s_and_b32 s21, s11, 0xffff
  s_mov_b32 s22, 19267584
  s_mov_b32 s23, 0x00020000
  s_mov_b32 s36, s12
  s_and_b32 s37, s13, 0xffff
  s_mov_b32 s38, 256
  s_mov_b32 s39, 0x00020000
  s_mul_i32 s61, s41, 13
  s_add_i32 s61, s61, -6
  s_mul_i32 s62, s42, 13
  s_add_i32 s62, s62, -6
  s_cmp_ge_u32 s40, 4
  s_cselect_b32 s53, -4, 3
  s_add_i32 s53, s53, s40
  s_lshl_b32 s53, s53, 1
  s_mul_i32 s55, s41, 6
  s_add_i32 s45, s43, s55
  s_add_i32 s45, s45, -6
  s_cmp_eq_i32 s45, -6
  s_cselect_b32 s47, 6, 0
  s_cmp_eq_i32 s45, 98
  s_cselect_b32 s48, 7, 13
  s_cselect_b32 s49, 2, 0
  s_sub_i32 s45, s45, s49
  s_mul_i32 s55, s42, 6
  s_add_i32 s56, s44, s55
  s_add_i32 s56, s56, -6
  s_cmp_eq_i32 s56, -6
  s_cselect_b32 s50, 6, 0
  s_cmp_eq_i32 s56, 98
  s_cselect_b32 s51, 7, 13
  s_lshl_b32 s56, s56, 1
  s_add_i32 s56, s56, s42
  s_mul_i32 s46, s56, 384
  s_max_i32 s92, s53, s47
  s_min_i32 s92, s92, s48
  s_and_b32 s92, s92, -2
  s_add_u32 s52, s92, s49
  s_mov_b32 s54, 4286578688
  s_mov_b32 s63, 1037384597
  s_and_b32 s93, s40, 1
  s_lshl_b32 s93, s93, 3
  s_and_b32 s56, s40, 6
  s_or_b32 s93, s93, s56
  s_add_u32 s56, s40, 8
  s_add_i32 s100, s45, s56
  s_lshl_b32 s100, s100, 1
  s_add_i32 s100, s100, s41
  s_max_i32 s100, s100, 0
  s_min_i32 s100, s100, 223
  s_mul_i32 s100, s100, 86016
  s_mul_i32 s101, s56, 7680
  s_add_u32 s4, s43, s53
  s_mov_b32 s5, 86016
  s_movk_i32 s6, 384
  s_cmp_eq_u32 s40, 4
  s_cselect_b32 s94, s2, 999
  s_mov_b32 s0, 0x55555555
  s_mov_b32 s1, 0x55555555
  s_mov_b32 s10, 0x33333333
  s_mov_b32 s11, 0x33333333
  s_mov_b32 vcc_lo, 0
  s_mov_b32 vcc_hi, -1
  v_bfe_u32 v4, v1, 2, 2
  v_and_b32 v5, 3, v1
  v_lshrrev_b32 v6, 5, v1
  v_lshl_add_u32 v5, v2, 2, v5
  v_lshlrev_b32 v6, 7, v6
  v_sub_u32 v6, 256, v6
  v_lshrrev_b32 v197, 1, v4
  v_and_b32 v255, 1, v4
  v_add_u32 v197, s4, v197
  v_lshl_add_u32 v0, v255, 2, s44
  v_lshl_add_u32 v198, v197, 1, s61
  v_add_u32 v199, 112, v197
  v_lshlrev_b32 v255, 30, v255
  v_med3_i32 v197, v198, v197, v199
  v_mul_lo_u32 v197, v197, s5
  v_lshl_add_u32 v197, v5, 4, v197
  v_add_u32 v16, 0, v0
  v_lshl_add_u32 v198, v16, 1, s62
  v_add_u32 v199, 112, v16
  v_med3_i32 v16, v198, v16, v199
  v_mad_u32_u24 v16, v16, s6, v197
  v_add_u32 v20, 1, v0
  v_lshl_add_u32 v198, v20, 1, s62
  v_add_u32 v199, 112, v20
  v_med3_i32 v20, v198, v20, v199
  v_mad_u32_u24 v20, v20, s6, v197
  v_add_u32 v24, 2, v0
  v_lshl_add_u32 v198, v24, 1, s62
  v_add_u32 v199, 112, v24
  v_med3_i32 v24, v198, v24, v199
  v_mad_u32_u24 v24, v24, s6, v197
  v_add_u32 v28, 3, v0
  v_lshl_add_u32 v198, v28, 1, s62
  v_add_u32 v199, 112, v28
  v_med3_i32 v28, v198, v28, v199
  v_mad_u32_u24 v28, v28, s6, v197
  v_add_u32 v28, v28, v255
  v_add_u32 v40, 7, v0
  v_lshl_add_u32 v198, v40, 1, s62
  v_add_u32 v199, 112, v40
  v_med3_i32 v40, v198, v40, v199
  v_mad_u32_u24 v40, v40, s6, v197
  v_add_u32 v44, 8, v0
  v_lshl_add_u32 v198, v44, 1, s62
  v_add_u32 v199, 112, v44
  v_med3_i32 v44, v198, v44, v199
  v_mad_u32_u24 v44, v44, s6, v197
  v_add_u32 v48, 9, v0
  v_lshl_add_u32 v198, v48, 1, s62
  v_add_u32 v199, 112, v48
  v_med3_i32 v48, v198, v48, v199
  v_mad_u32_u24 v48, v48, s6, v197
  v_add_u32 v52, 10, v0
  v_lshl_add_u32 v198, v52, 1, s62
  v_add_u32 v199, 112, v52
  v_med3_i32 v52, v198, v52, v199
  v_mad_u32_u24 v52, v52, s6, v197
  v_add_u32 v52, v52, v255
  v_cndmask_b32 v32, v16, v40, vcc
  v_cndmask_b32 v36, v20, v44, vcc
  v_cndmask_b32 v56, v24, v48, vcc
  v_cndmask_b32 v60, v28, v52, vcc
  v_add_u32 v32, v32, v6
  v_add_u32 v36, v36, v6
  v_add_u32 v56, v56, v6
  v_add_u32 v60, v60, v6
  s_waitcnt vmcnt(12)
  ds_read_b128 v[64:67], v184 offset:0
  ds_read_b128 v[68:71], v184 offset:1024
  ds_read_b128 v[72:75], v184 offset:2048
  ds_read_b128 v[76:79], v184 offset:3072
  ds_read_b128 v[80:83], v184 offset:4096
  ds_read_b128 v[84:87], v184 offset:5120
  s_waitcnt vmcnt(6)
  ds_read_b128 v[88:91], v184 offset:6144
  ds_read_b128 v[92:95], v184 offset:7168
  ds_read_b128 v[96:99], v184 offset:8192
  ds_read_b128 v[100:103], v184 offset:9216
  ds_read_b128 v[104:107], v184 offset:10240
  ds_read_b128 v[108:111], v184 offset:11264
  s_waitcnt vmcnt(0)
  ds_read_b128 v[112:115], v184 offset:12288
  ds_read_b128 v[116:119], v184 offset:13312
  s_waitcnt lgkmcnt(8)
  ds_read_b128 v[120:123], v184 offset:14336
  ds_read_b128 v[124:127], v184 offset:15360
  ds_read_b128 v[128:131], v184 offset:16384
  ds_read_b128 v[132:135], v184 offset:17408
  v_lshrrev_b32 v4, 3, v3
  v_add_u32 v4, s53, v4
  v_max_i32 v4, s47, v4
  v_min_i32 v4, s48, v4
  v_subrev_u32 v4, s92, v4
  v_and_b32 v5, 1, v2
  v_sub_u32 v6, v5, v4
  v_ashrrev_i32 v12, 31, v6
  v_and_b32 v12, s54, v12
  v_sub_u32 v6, v4, v5
  v_ashrrev_i32 v13, 31, v6
  v_and_b32 v13, s54, v13
  v_and_b32 v4, 7, v3
  v_lshrrev_b32 v5, 1, v2
  v_subrev_u32 v7, 7, v4
  v_ashrrev_i32 v7, 31, v7
  v_and_b32 v7, 0x7f, v7
  v_add_u32 v6, 0, v4
  v_max_i32 v6, s50, v6
  v_min_i32 v6, s51, v6
  v_lshlrev_b32 v6, v6, v7
  v_lshrrev_b32 v6, v5, v6
  v_not_b32 v14, v6
  v_add_u32 v6, 7, v4
  v_max_i32 v6, s50, v6
  v_min_i32 v6, s51, v6
  v_lshlrev_b32 v6, v6, v7
  v_lshrrev_b32 v6, v5, v6
  v_not_b32 v15, v6
  v_add_u32 v4, s52, v4
  v_and_b32 v5, 1, v4
  v_lshlrev_b32 v5, 3, v5
  v_and_or_b32 v5, v4, 6, v5
  v_mul_u32_u24 v4, 7680, v4
  v_lshrrev_b32 v6, 3, v3
  v_mul_u32_u24 v6, 24, v6
  v_add_u32 v6, v6, v2
  v_add_u32 v7, 0, v6
  v_xor_b32 v7, v7, v5
  v_lshl_add_u32 v240, v7, 4, v4
  v_add_u32 v7, 4, v6
  v_xor_b32 v7, v7, v5
  v_lshl_add_u32 v241, v7, 4, v4
  v_add_u32 v7, 8, v6
  v_xor_b32 v7, v7, v5
  v_lshl_add_u32 v242, v7, 4, v4
  v_add_u32 v7, 12, v6
  v_xor_b32 v7, v7, v5
  v_lshl_add_u32 v243, v7, 4, v4
  v_and_b32 v4, 1, v2
  v_lshlrev_b32 v4, 2, v4
  v_lshrrev_b32 v5, 2, v3
  v_add3_u32 v4, v4, v5, s52
  v_and_b32 v5, 1, v4
  v_lshlrev_b32 v5, 3, v5
  v_and_or_b32 v5, v4, 6, v5
  v_mul_u32_u24 v4, 7680, v4
  v_and_b32 v6, 1, v3
  v_lshl_add_u32 v4, v6, 3, v4
  v_lshrrev_b32 v6, 1, v2
  s_waitcnt lgkmcnt(0)
  s_barrier
  ds_read_b128 v[200:203], v195 offset:0
  ds_read_b128 v[204:207], v195 offset:6144
  ds_read_b128 v[208:211], v195 offset:1024
  ds_read_b128 v[212:215], v195 offset:7168
  ds_read_b128 v[216:219], v195 offset:2048
  ds_read_b128 v[220:223], v195 offset:8192
  s_cmp_eq_u32 s40, 0
  s_setprio 3
  s_waitcnt lgkmcnt(5)
  v_mfma_f32_16x16x32_bf16 v[136:139], v[200:203], v[64:67], 0
  ds_read_b128 v[224:227], v195 offset:3072
  v_mul_u32_u24 v6, 24, v6
  v_mfma_f32_16x16x32_bf16 v[144:147], v[200:203], v[88:91], 0
  v_bfe_u32 v7, v3, 1, 1
  v_add_u32 v6, v6, v7
  v_mfma_f32_16x16x32_bf16 v[152:155], v[200:203], v[112:115], 0
  s_waitcnt lgkmcnt(5)
  v_add_u32 v7, 0, v6
  v_xor_b32 v7, v7, v5
  v_mfma_f32_16x16x32_bf16 v[140:143], v[204:207], v[64:67], 0
  ds_read_b128 v[228:231], v195 offset:9216
  v_lshl_add_u32 v244, v7, 4, v4
  v_mfma_f32_16x16x32_bf16 v[148:151], v[204:207], v[88:91], 0
  v_add_u32 v7, 2, v6
  v_xor_b32 v7, v7, v5
  v_mfma_f32_16x16x32_bf16 v[156:159], v[204:207], v[112:115], 0
  s_waitcnt lgkmcnt(5)
  v_lshl_add_u32 v245, v7, 4, v4
  v_add_u32 v7, 4, v6
  v_mfma_f32_16x16x32_bf16 v[136:139], v[208:211], v[68:71], v[136:139]
  ds_read_b128 v[200:203], v195 offset:4096
  v_xor_b32 v7, v7, v5
  v_mfma_f32_16x16x32_bf16 v[144:147], v[208:211], v[92:95], v[144:147]
  v_lshl_add_u32 v246, v7, 4, v4
  v_add_u32 v7, 6, v6
  v_mfma_f32_16x16x32_bf16 v[152:155], v[208:211], v[116:119], v[152:155]
  s_waitcnt lgkmcnt(5)
  v_xor_b32 v7, v7, v5
  v_lshl_add_u32 v247, v7, 4, v4
  v_mfma_f32_16x16x32_bf16 v[140:143], v[212:215], v[68:71], v[140:143]
  ds_read_b128 v[204:207], v195 offset:10240
  v_add_u32 v7, 8, v6
  v_mfma_f32_16x16x32_bf16 v[148:151], v[212:215], v[92:95], v[148:151]
  v_xor_b32 v7, v7, v5
  v_lshl_add_u32 v248, v7, 4, v4
  v_mfma_f32_16x16x32_bf16 v[156:159], v[212:215], v[116:119], v[156:159]
  s_waitcnt lgkmcnt(5)
  v_add_u32 v7, 10, v6
  v_xor_b32 v7, v7, v5
  v_mfma_f32_16x16x32_bf16 v[136:139], v[216:219], v[72:75], v[136:139]
  ds_read_b128 v[208:211], v195 offset:5120
  v_lshl_add_u32 v249, v7, 4, v4
  v_mfma_f32_16x16x32_bf16 v[144:147], v[216:219], v[96:99], v[144:147]
  v_add_u32 v7, 12, v6
  v_xor_b32 v7, v7, v5
  v_mfma_f32_16x16x32_bf16 v[152:155], v[216:219], v[120:123], v[152:155]
  s_waitcnt lgkmcnt(5)
  v_lshl_add_u32 v250, v7, 4, v4
  v_add_u32 v7, 14, v6
  v_mfma_f32_16x16x32_bf16 v[140:143], v[220:223], v[72:75], v[140:143]
  ds_read_b128 v[212:215], v195 offset:11264
  v_xor_b32 v7, v7, v5
  v_mfma_f32_16x16x32_bf16 v[148:151], v[220:223], v[96:99], v[148:151]
  v_lshl_add_u32 v251, v7, 4, v4
  v_add_u32 v253, 153600, v252
  v_mfma_f32_16x16x32_bf16 v[156:159], v[220:223], v[120:123], v[156:159]
  s_waitcnt lgkmcnt(5)
  v_add_u32 v254, 90112, v252
  v_add_u32 v4, 0, v1
  v_mfma_f32_16x16x32_bf16 v[136:139], v[224:227], v[76:79], v[136:139]
  ds_read_b128 v[216:219], v195 offset:12288
  v_xor_b32 v4, s93, v4
  v_mfma_f32_16x16x32_bf16 v[144:147], v[224:227], v[100:103], v[144:147]
  v_mul_u32_u24 v5, 2731, v4
  v_lshrrev_b32 v5, 16, v5
  v_mfma_f32_16x16x32_bf16 v[152:155], v[224:227], v[124:127], v[152:155]
  s_waitcnt lgkmcnt(5)
  v_mul_u32_u24 v5, 384, v5
  v_lshl_add_u32 v4, v4, 4, v5
  v_mfma_f32_16x16x32_bf16 v[140:143], v[228:231], v[76:79], v[140:143]
  ds_read_b128 v[220:223], v195 offset:18432
  v_add_u32 v232, s46, v4
  v_mfma_f32_16x16x32_bf16 v[148:151], v[228:231], v[100:103], v[148:151]
  v_add_u32 v235, 6144, v232
  v_add_u32 v238, 12288, v232
  v_mfma_f32_16x16x32_bf16 v[156:159], v[228:231], v[124:127], v[156:159]
  s_waitcnt lgkmcnt(5)
  v_max_i32 v232, 0, v232
  v_add_u32 v4, 64, v1
  v_mfma_f32_16x16x32_bf16 v[136:139], v[200:203], v[80:83], v[136:139]
  ds_read_b128 v[224:227], v195 offset:13312
  v_xor_b32 v4, s93, v4
  v_mfma_f32_16x16x32_bf16 v[144:147], v[200:203], v[104:107], v[144:147]
  v_mul_u32_u24 v5, 2731, v4
  v_lshrrev_b32 v5, 16, v5
  v_mfma_f32_16x16x32_bf16 v[152:155], v[200:203], v[128:131], v[152:155]
  s_waitcnt lgkmcnt(5)
  v_mul_u32_u24 v5, 384, v5
  v_lshl_add_u32 v4, v4, 4, v5
  v_mfma_f32_16x16x32_bf16 v[140:143], v[204:207], v[80:83], v[140:143]
  ds_read_b128 v[228:231], v195 offset:19456
  v_add_u32 v233, s46, v4
  v_mfma_f32_16x16x32_bf16 v[148:151], v[204:207], v[104:107], v[148:151]
  v_add_u32 v236, 6144, v233
  v_max_i32 v233, 0, v233
  v_mfma_f32_16x16x32_bf16 v[156:159], v[204:207], v[128:131], v[156:159]
  s_waitcnt lgkmcnt(5)
  v_add_u32 v4, 128, v1
  v_xor_b32 v4, s93, v4
  v_mfma_f32_16x16x32_bf16 v[136:139], v[208:211], v[84:87], v[136:139]
  ds_read_b128 v[200:203], v195 offset:14336
  v_mul_u32_u24 v5, 2731, v4
  v_mfma_f32_16x16x32_bf16 v[144:147], v[208:211], v[108:111], v[144:147]
  v_lshrrev_b32 v5, 16, v5
  v_mul_u32_u24 v5, 384, v5
  v_mfma_f32_16x16x32_bf16 v[152:155], v[208:211], v[132:135], v[152:155]
  s_waitcnt lgkmcnt(5)
  v_lshl_add_u32 v4, v4, 4, v5
  v_add_u32 v234, s46, v4
  v_mfma_f32_16x16x32_bf16 v[140:143], v[212:215], v[84:87], v[140:143]
  ds_read_b128 v[204:207], v195 offset:20480
  v_add_u32 v237, 6144, v234
  v_mfma_f32_16x16x32_bf16 v[148:151], v[212:215], v[108:111], v[148:151]
  v_max_i32 v234, 0, v234
  v_add_u32 v4, 416, v1
  v_mfma_f32_16x16x32_bf16 v[156:159], v[212:215], v[132:135], v[156:159]
  s_waitcnt lgkmcnt(5)
  v_xor_b32 v4, s93, v4
  v_mul_u32_u24 v5, 2731, v4
  v_mfma_f32_16x16x32_bf16 v[160:163], v[216:219], v[64:67], 0
  ds_read_b128 v[208:211], v195 offset:15360
  v_lshrrev_b32 v5, 16, v5
  v_mfma_f32_16x16x32_bf16 v[168:171], v[216:219], v[88:91], 0
  v_mul_u32_u24 v5, 384, v5
  v_lshl_add_u32 v4, v4, 4, v5
  v_mfma_f32_16x16x32_bf16 v[176:179], v[216:219], v[112:115], 0
  s_waitcnt lgkmcnt(5)
  v_add_u32 v239, s46, v4
  v_lshrrev_b32 v197, 1, v2
  v_mfma_f32_16x16x32_bf16 v[164:167], v[220:223], v[64:67], 0
  ds_read_b128 v[212:215], v195 offset:21504
  v_cvt_pk_bf16_f32 v184, v136, v137
  v_mfma_f32_16x16x32_bf16 v[172:175], v[220:223], v[88:91], 0
  v_cvt_pk_bf16_f32 v185, v138, v139
  v_cvt_pk_bf16_f32 v186, v140, v141
  v_mfma_f32_16x16x32_bf16 v[180:183], v[220:223], v[112:115], 0
  s_waitcnt lgkmcnt(5)
  v_cvt_pk_bf16_f32 v187, v142, v143
  v_and_b32 v255, 1, v2
  v_mfma_f32_16x16x32_bf16 v[160:163], v[224:227], v[68:71], v[160:163]
  ds_read_b128 v[216:219], v195 offset:16384
  v_add_u32 v197, s4, v197
  v_mfma_f32_16x16x32_bf16 v[168:171], v[224:227], v[92:95], v[168:171]
  ds_write_b128 v192, v[184:187] offset:0
  v_mfma_f32_16x16x32_bf16 v[176:179], v[224:227], v[116:119], v[176:179]
  s_waitcnt lgkmcnt(6)
  v_lshl_add_u32 v0, v255, 2, s44
  v_lshl_add_u32 v198, v197, 1, s61
  v_mfma_f32_16x16x32_bf16 v[164:167], v[228:231], v[68:71], v[164:167]
  ds_read_b128 v[220:223], v195 offset:22528
  v_cvt_pk_bf16_f32 v188, v144, v145
  v_mfma_f32_16x16x32_bf16 v[172:175], v[228:231], v[92:95], v[172:175]
  v_cvt_pk_bf16_f32 v189, v146, v147
  v_cvt_pk_bf16_f32 v190, v148, v149
  v_mfma_f32_16x16x32_bf16 v[180:183], v[228:231], v[116:119], v[180:183]
  s_waitcnt lgkmcnt(6)
  v_cvt_pk_bf16_f32 v191, v150, v151
  v_add_u32 v199, 112, v197
  v_mfma_f32_16x16x32_bf16 v[160:163], v[200:203], v[72:75], v[160:163]
  ds_read_b128 v[224:227], v195 offset:17408
  v_lshlrev_b32 v255, 30, v255
  v_mfma_f32_16x16x32_bf16 v[168:171], v[200:203], v[96:99], v[168:171]
  ds_write_b128 v193, v[188:191] offset:0
  v_mfma_f32_16x16x32_bf16 v[176:179], v[200:203], v[120:123], v[176:179]
  v_med3_i32 v197, v198, v197, v199
  v_mul_lo_u32 v197, v197, s5
  s_barrier
  s_waitcnt lgkmcnt(7)
  v_mfma_f32_16x16x32_bf16 v[164:167], v[204:207], v[72:75], v[164:167]
  ds_read_b128 v[228:231], v195 offset:23552
  v_cvt_pk_bf16_f32 v184, v152, v153
  v_mfma_f32_16x16x32_bf16 v[172:175], v[204:207], v[96:99], v[172:175]
  v_cvt_pk_bf16_f32 v185, v154, v155
  v_cvt_pk_bf16_f32 v186, v156, v157
  v_mfma_f32_16x16x32_bf16 v[180:183], v[204:207], v[120:123], v[180:183]
  s_waitcnt lgkmcnt(7)
  v_cvt_pk_bf16_f32 v187, v158, v159
  v_lshl_add_u32 v197, v3, 3, v197
  v_mfma_f32_16x16x32_bf16 v[160:163], v[208:211], v[76:79], v[160:163]
  ds_read_b128 v[200:203], v195 offset:24576
  v_add_u32 v4, 0, v0
  v_mfma_f32_16x16x32_bf16 v[168:171], v[208:211], v[100:103], v[168:171]
  ds_write_b128 v194, v[184:187] offset:0
  v_mfma_f32_16x16x32_bf16 v[176:179], v[208:211], v[124:127], v[176:179]
  s_waitcnt lgkmcnt(8)
  v_lshl_add_u32 v198, v4, 1, s62
  v_add_u32 v199, 112, v4
  v_mfma_f32_16x16x32_bf16 v[164:167], v[212:215], v[76:79], v[164:167]
  ds_read_b128 v[204:207], v195 offset:30720
  v_med3_i32 v4, v198, v4, v199
  v_mfma_f32_16x16x32_bf16 v[172:175], v[212:215], v[100:103], v[172:175]
  v_mad_u32_u24 v4, v4, s6, v197
  v_add_u32 v5, 1, v0
  v_mfma_f32_16x16x32_bf16 v[180:183], v[212:215], v[124:127], v[180:183]
  s_waitcnt lgkmcnt(8)
  v_lshl_add_u32 v198, v5, 1, s62
  v_add_u32 v199, 112, v5
  v_mfma_f32_16x16x32_bf16 v[160:163], v[216:219], v[80:83], v[160:163]
  ds_read_b128 v[208:211], v195 offset:25600
  v_med3_i32 v5, v198, v5, v199
  v_mfma_f32_16x16x32_bf16 v[168:171], v[216:219], v[104:107], v[168:171]
  v_mad_u32_u24 v5, v5, s6, v197
  v_add_u32 v6, 2, v0
  v_mfma_f32_16x16x32_bf16 v[176:179], v[216:219], v[128:131], v[176:179]
  s_waitcnt lgkmcnt(7)
  v_lshl_add_u32 v198, v6, 1, s62
  v_add_u32 v199, 112, v6
  v_mfma_f32_16x16x32_bf16 v[164:167], v[220:223], v[80:83], v[164:167]
  ds_read_b128 v[212:215], v195 offset:31744
  v_med3_i32 v6, v198, v6, v199
  v_mfma_f32_16x16x32_bf16 v[172:175], v[220:223], v[104:107], v[172:175]
  v_mad_u32_u24 v6, v6, s6, v197
  v_add_u32 v7, 3, v0
  v_mfma_f32_16x16x32_bf16 v[180:183], v[220:223], v[128:131], v[180:183]
  s_waitcnt lgkmcnt(7)
  v_lshl_add_u32 v198, v7, 1, s62
  v_add_u32 v199, 112, v7
  v_mfma_f32_16x16x32_bf16 v[160:163], v[224:227], v[84:87], v[160:163]
  ds_read_b128 v[216:219], v195 offset:26624
  v_med3_i32 v7, v198, v7, v199
  v_mfma_f32_16x16x32_bf16 v[168:171], v[224:227], v[108:111], v[168:171]
  v_mad_u32_u24 v7, v7, s6, v197
  v_add_u32 v7, v7, v255
  v_mfma_f32_16x16x32_bf16 v[176:179], v[224:227], v[132:135], v[176:179]
  s_waitcnt lgkmcnt(6)
  v_add_u32 v8, 7, v0
  v_lshl_add_u32 v198, v8, 1, s62
  v_mfma_f32_16x16x32_bf16 v[164:167], v[228:231], v[84:87], v[164:167]
  ds_read_b128 v[220:223], v195 offset:32768
  v_add_u32 v199, 112, v8
  v_mfma_f32_16x16x32_bf16 v[172:175], v[228:231], v[108:111], v[172:175]
  s_cbranch_scc1 M_sx0
  buffer_load_dwordx4 v[16:19], v16, s[16:19], 0 offen
M_sx0:
  v_mfma_f32_16x16x32_bf16 v[180:183], v[228:231], v[132:135], v[180:183]
  s_waitcnt lgkmcnt(6)
  v_med3_i32 v8, v198, v8, v199
  v_mad_u32_u24 v8, v8, s6, v197
  v_mfma_f32_16x16x32_bf16 v[136:139], v[200:203], v[64:67], 0
  ds_read_b128 v[224:227], v195 offset:27648
  v_add_u32 v9, 8, v0
  v_mfma_f32_16x16x32_bf16 v[144:147], v[200:203], v[88:91], 0
  v_lshl_add_u32 v198, v9, 1, s62
  v_add_u32 v199, 112, v9
  v_mfma_f32_16x16x32_bf16 v[152:155], v[200:203], v[112:115], 0
  s_waitcnt lgkmcnt(5)
  v_med3_i32 v9, v198, v9, v199
  v_mad_u32_u24 v9, v9, s6, v197
  v_mfma_f32_16x16x32_bf16 v[140:143], v[204:207], v[64:67], 0
  ds_read_b128 v[228:231], v195 offset:33792
  v_cvt_pk_bf16_f32 v184, v160, v161
  v_mfma_f32_16x16x32_bf16 v[148:151], v[204:207], v[88:91], 0
  v_cvt_pk_bf16_f32 v185, v162, v163
  v_cvt_pk_bf16_f32 v186, v164, v165
  v_mfma_f32_16x16x32_bf16 v[156:159], v[204:207], v[112:115], 0
  s_waitcnt lgkmcnt(5)
  v_cvt_pk_bf16_f32 v187, v166, v167
  v_add_u32 v10, 9, v0
  v_mfma_f32_16x16x32_bf16 v[136:139], v[208:211], v[68:71], v[136:139]
  ds_read_b128 v[200:203], v195 offset:28672
  v_lshl_add_u32 v198, v10, 1, s62
  v_mfma_f32_16x16x32_bf16 v[144:147], v[208:211], v[92:95], v[144:147]
  ds_write_b128 v192, v[184:187] offset:2048
  v_mfma_f32_16x16x32_bf16 v[152:155], v[208:211], v[116:119], v[152:155]
  s_waitcnt lgkmcnt(6)
  v_add_u32 v199, 112, v10
  v_med3_i32 v10, v198, v10, v199
  v_mfma_f32_16x16x32_bf16 v[140:143], v[212:215], v[68:71], v[140:143]
  ds_read_b128 v[204:207], v195 offset:34816
  v_cvt_pk_bf16_f32 v188, v168, v169
  v_mfma_f32_16x16x32_bf16 v[148:151], v[212:215], v[92:95], v[148:151]
  s_cbranch_scc1 M_sx1
  buffer_load_dwordx4 v[20:23], v20, s[16:19], 0 offen
M_sx1:
  v_mfma_f32_16x16x32_bf16 v[156:159], v[212:215], v[116:119], v[156:159]
  s_waitcnt lgkmcnt(6)
  v_cvt_pk_bf16_f32 v189, v170, v171
  v_cvt_pk_bf16_f32 v190, v172, v173
  v_mfma_f32_16x16x32_bf16 v[136:139], v[216:219], v[72:75], v[136:139]
  ds_read_b128 v[208:211], v195 offset:29696
  v_cvt_pk_bf16_f32 v191, v174, v175
  v_mfma_f32_16x16x32_bf16 v[144:147], v[216:219], v[96:99], v[144:147]
  ds_write_b128 v193, v[188:191] offset:2048
  v_mfma_f32_16x16x32_bf16 v[152:155], v[216:219], v[120:123], v[152:155]
  s_waitcnt lgkmcnt(7)
  v_mad_u32_u24 v10, v10, s6, v197
  v_add_u32 v11, 10, v0
  v_mfma_f32_16x16x32_bf16 v[140:143], v[220:223], v[72:75], v[140:143]
  ds_read_b128 v[212:215], v195 offset:35840
  v_cvt_pk_bf16_f32 v184, v176, v177
  v_mfma_f32_16x16x32_bf16 v[148:151], v[220:223], v[96:99], v[148:151]
  v_cvt_pk_bf16_f32 v185, v178, v179
  v_cvt_pk_bf16_f32 v186, v180, v181
  v_mfma_f32_16x16x32_bf16 v[156:159], v[220:223], v[120:123], v[156:159]
  s_waitcnt lgkmcnt(7)
  v_cvt_pk_bf16_f32 v187, v182, v183
  v_lshl_add_u32 v198, v11, 1, s62
  v_mfma_f32_16x16x32_bf16 v[136:139], v[224:227], v[76:79], v[136:139]
  ds_read_b128 v[216:219], v196 offset:0
  v_add_u32 v199, 112, v11
  v_mfma_f32_16x16x32_bf16 v[144:147], v[224:227], v[100:103], v[144:147]
  ds_write_b128 v194, v[184:187] offset:2048
  v_mfma_f32_16x16x32_bf16 v[152:155], v[224:227], v[124:127], v[152:155]
  s_waitcnt lgkmcnt(8)
  v_med3_i32 v11, v198, v11, v199
  v_mad_u32_u24 v11, v11, s6, v197
  v_mfma_f32_16x16x32_bf16 v[140:143], v[228:231], v[76:79], v[140:143]
  ds_read_b128 v[220:223], v196 offset:6144
  v_add_u32 v11, v11, v255
  v_mfma_f32_16x16x32_bf16 v[148:151], v[228:231], v[100:103], v[148:151]
  s_cbranch_scc1 M_sx2
  buffer_load_dwordx4 v[24:27], v24, s[16:19], 0 offen
M_sx2:
  v_mfma_f32_16x16x32_bf16 v[156:159], v[228:231], v[124:127], v[156:159]
  s_waitcnt lgkmcnt(8)
  v_mfma_f32_16x16x32_bf16 v[136:139], v[200:203], v[80:83], v[136:139]
  ds_read_b128 v[224:227], v196 offset:1024
  v_mfma_f32_16x16x32_bf16 v[144:147], v[200:203], v[104:107], v[144:147]
  v_mfma_f32_16x16x32_bf16 v[152:155], v[200:203], v[128:131], v[152:155]
  s_waitcnt lgkmcnt(7)
  v_mfma_f32_16x16x32_bf16 v[140:143], v[204:207], v[80:83], v[140:143]
  ds_read_b128 v[228:231], v196 offset:7168
  v_mfma_f32_16x16x32_bf16 v[148:151], v[204:207], v[104:107], v[148:151]
  s_cbranch_scc1 M_sx3
  buffer_load_dwordx4 v[28:31], v28, s[16:19], 0 offen
M_sx3:
  v_mfma_f32_16x16x32_bf16 v[156:159], v[204:207], v[128:131], v[156:159]
  s_waitcnt lgkmcnt(7)
  v_mfma_f32_16x16x32_bf16 v[136:139], v[208:211], v[84:87], v[136:139]
  ds_read_b128 v[200:203], v196 offset:2048
  v_mfma_f32_16x16x32_bf16 v[144:147], v[208:211], v[108:111], v[144:147]
  v_mfma_f32_16x16x32_bf16 v[152:155], v[208:211], v[132:135], v[152:155]
  s_waitcnt lgkmcnt(6)
  v_mfma_f32_16x16x32_bf16 v[140:143], v[212:215], v[84:87], v[140:143]
  ds_read_b128 v[204:207], v196 offset:8192
  v_mfma_f32_16x16x32_bf16 v[148:151], v[212:215], v[108:111], v[148:151]
  v_mfma_f32_16x16x32_bf16 v[156:159], v[212:215], v[132:135], v[156:159]
  s_waitcnt lgkmcnt(6)
  v_mfma_f32_16x16x32_bf16 v[160:163], v[216:219], v[64:67], 0
  ds_read_b128 v[208:211], v196 offset:3072
  v_mfma_f32_16x16x32_bf16 v[168:171], v[216:219], v[88:91], 0
  v_mfma_f32_16x16x32_bf16 v[176:179], v[216:219], v[112:115], 0
  s_waitcnt lgkmcnt(5)
  v_mfma_f32_16x16x32_bf16 v[164:167], v[220:223], v[64:67], 0
  ds_read_b128 v[212:215], v196 offset:9216
  v_cvt_pk_bf16_f32 v184, v136, v137
  v_mfma_f32_16x16x32_bf16 v[172:175], v[220:223], v[88:91], 0
  s_cbranch_scc1 M_sx4
  buffer_load_dwordx4 v[40:43], v40, s[16:19], 0 offen
M_sx4:
  v_mfma_f32_16x16x32_bf16 v[180:183], v[220:223], v[112:115], 0
  s_waitcnt lgkmcnt(5)
  v_cvt_pk_bf16_f32 v185, v138, v139
  v_cvt_pk_bf16_f32 v186, v140, v141
  v_mfma_f32_16x16x32_bf16 v[160:163], v[224:227], v[68:71], v[160:163]
  ds_read_b128 v[216:219], v196 offset:4096
  v_cvt_pk_bf16_f32 v187, v142, v143
  v_mfma_f32_16x16x32_bf16 v[168:171], v[224:227], v[92:95], v[168:171]
  ds_write_b128 v192, v[184:187] offset:4096
  v_mfma_f32_16x16x32_bf16 v[176:179], v[224:227], v[116:119], v[176:179]
  s_waitcnt lgkmcnt(6)
  v_mfma_f32_16x16x32_bf16 v[164:167], v[228:231], v[68:71], v[164:167]
  ds_read_b128 v[220:223], v196 offset:10240
  v_cvt_pk_bf16_f32 v188, v144, v145
  v_mfma_f32_16x16x32_bf16 v[172:175], v[228:231], v[92:95], v[172:175]
  v_cvt_pk_bf16_f32 v189, v146, v147
  v_cvt_pk_bf16_f32 v190, v148, v149
  v_mfma_f32_16x16x32_bf16 v[180:183], v[228:231], v[116:119], v[180:183]
  s_waitcnt lgkmcnt(6)
  v_cvt_pk_bf16_f32 v191, v150, v151
  v_mfma_f32_16x16x32_bf16 v[160:163], v[200:203], v[72:75], v[160:163]
  ds_read_b128 v[224:227], v196 offset:5120
  v_mfma_f32_16x16x32_bf16 v[168:171], v[200:203], v[96:99], v[168:171]
  ds_write_b128 v193, v[188:191] offset:4096
  v_mfma_f32_16x16x32_bf16 v[176:179], v[200:203], v[120:123], v[176:179]
  s_waitcnt lgkmcnt(7)
  v_mfma_f32_16x16x32_bf16 v[164:167], v[204:207], v[72:75], v[164:167]
  ds_read_b128 v[228:231], v196 offset:11264
  v_cvt_pk_bf16_f32 v184, v152, v153
  v_mfma_f32_16x16x32_bf16 v[172:175], v[204:207], v[96:99], v[172:175]
  s_cbranch_scc1 M_sx5
  buffer_load_dwordx4 v[44:47], v44, s[16:19], 0 offen
M_sx5:
  v_mfma_f32_16x16x32_bf16 v[180:183], v[204:207], v[120:123], v[180:183]
  s_waitcnt lgkmcnt(7)
  v_cvt_pk_bf16_f32 v185, v154, v155
  v_cvt_pk_bf16_f32 v186, v156, v157
  v_mfma_f32_16x16x32_bf16 v[160:163], v[208:211], v[76:79], v[160:163]
  ds_read_b128 v[200:203], v196 offset:12288
  v_cvt_pk_bf16_f32 v187, v158, v159
  v_mfma_f32_16x16x32_bf16 v[168:171], v[208:211], v[100:103], v[168:171]
  ds_write_b128 v194, v[184:187] offset:4096
  v_mfma_f32_16x16x32_bf16 v[176:179], v[208:211], v[124:127], v[176:179]
  s_waitcnt lgkmcnt(8)
  v_mfma_f32_16x16x32_bf16 v[164:167], v[212:215], v[76:79], v[164:167]
  ds_read_b128 v[204:207], v196 offset:18432
  v_mfma_f32_16x16x32_bf16 v[172:175], v[212:215], v[100:103], v[172:175]
  s_cbranch_scc1 M_sx6
  buffer_load_dwordx4 v[48:51], v48, s[16:19], 0 offen
M_sx6:
  v_mfma_f32_16x16x32_bf16 v[180:183], v[212:215], v[124:127], v[180:183]
  s_waitcnt lgkmcnt(8)
  v_mfma_f32_16x16x32_bf16 v[160:163], v[216:219], v[80:83], v[160:163]
  ds_read_b128 v[208:211], v196 offset:13312
  v_mfma_f32_16x16x32_bf16 v[168:171], v[216:219], v[104:107], v[168:171]
  v_mfma_f32_16x16x32_bf16 v[176:179], v[216:219], v[128:131], v[176:179]
  s_waitcnt lgkmcnt(7)
  v_mfma_f32_16x16x32_bf16 v[164:167], v[220:223], v[80:83], v[164:167]
  ds_read_b128 v[212:215], v196 offset:19456
  v_mfma_f32_16x16x32_bf16 v[172:175], v[220:223], v[104:107], v[172:175]
  v_mfma_f32_16x16x32_bf16 v[180:183], v[220:223], v[128:131], v[180:183]
  s_waitcnt lgkmcnt(7)
  v_mfma_f32_16x16x32_bf16 v[160:163], v[224:227], v[84:87], v[160:163]
  ds_read_b128 v[216:219], v196 offset:14336
  v_mfma_f32_16x16x32_bf16 v[168:171], v[224:227], v[108:111], v[168:171]
  v_mfma_f32_16x16x32_bf16 v[176:179], v[224:227], v[132:135], v[176:179]
  s_waitcnt lgkmcnt(6)
  v_mfma_f32_16x16x32_bf16 v[164:167], v[228:231], v[84:87], v[164:167]
  ds_read_b128 v[220:223], v196 offset:20480
  v_mfma_f32_16x16x32_bf16 v[172:175], v[228:231], v[108:111], v[172:175]
  s_cbranch_scc1 M_sx7
  buffer_load_dwordx4 v[52:55], v52, s[16:19], 0 offen
M_sx7:
  v_mfma_f32_16x16x32_bf16 v[180:183], v[228:231], v[132:135], v[180:183]
  s_waitcnt lgkmcnt(6)
  v_mfma_f32_16x16x32_bf16 v[136:139], v[200:203], v[64:67], 0
  ds_read_b128 v[224:227], v196 offset:15360
  v_mfma_f32_16x16x32_bf16 v[144:147], v[200:203], v[88:91], 0
  v_mfma_f32_16x16x32_bf16 v[152:155], v[200:203], v[112:115], 0
  s_waitcnt lgkmcnt(5)
  v_mfma_f32_16x16x32_bf16 v[140:143], v[204:207], v[64:67], 0
  ds_read_b128 v[228:231], v196 offset:21504
  v_cvt_pk_bf16_f32 v184, v160, v161
  v_mfma_f32_16x16x32_bf16 v[148:151], v[204:207], v[88:91], 0
  v_cvt_pk_bf16_f32 v185, v162, v163
  v_cvt_pk_bf16_f32 v186, v164, v165
  v_mfma_f32_16x16x32_bf16 v[156:159], v[204:207], v[112:115], 0
  s_waitcnt lgkmcnt(5)
  v_cvt_pk_bf16_f32 v187, v166, v167
  v_mfma_f32_16x16x32_bf16 v[136:139], v[208:211], v[68:71], v[136:139]
  ds_read_b128 v[200:203], v196 offset:16384
  v_mfma_f32_16x16x32_bf16 v[144:147], v[208:211], v[92:95], v[144:147]
  ds_write_b128 v192, v[184:187] offset:6144
  v_mfma_f32_16x16x32_bf16 v[152:155], v[208:211], v[116:119], v[152:155]
  s_waitcnt lgkmcnt(6)
  v_mfma_f32_16x16x32_bf16 v[140:143], v[212:215], v[68:71], v[140:143]
  ds_read_b128 v[204:207], v196 offset:22528
  v_cvt_pk_bf16_f32 v188, v168, v169
  v_mfma_f32_16x16x32_bf16 v[148:151], v[212:215], v[92:95], v[148:151]
  s_cbranch_scc1 M_sx8
  buffer_load_dwordx4 v[32:35], v32, s[16:19], 0 offen
M_sx8:
  v_mfma_f32_16x16x32_bf16 v[156:159], v[212:215], v[116:119], v[156:159]
  s_waitcnt lgkmcnt(6)
  v_cvt_pk_bf16_f32 v189, v170, v171
  v_cvt_pk_bf16_f32 v190, v172, v173
  v_mfma_f32_16x16x32_bf16 v[136:139], v[216:219], v[72:75], v[136:139]
  ds_read_b128 v[208:211], v196 offset:17408
  v_cvt_pk_bf16_f32 v191, v174, v175
  v_mfma_f32_16x16x32_bf16 v[144:147], v[216:219], v[96:99], v[144:147]
  ds_write_b128 v193, v[188:191] offset:6144
  v_mfma_f32_16x16x32_bf16 v[152:155], v[216:219], v[120:123], v[152:155]
  s_waitcnt lgkmcnt(7)
  v_mfma_f32_16x16x32_bf16 v[140:143], v[220:223], v[72:75], v[140:143]
  ds_read_b128 v[212:215], v196 offset:23552
  v_cvt_pk_bf16_f32 v184, v176, v177
  v_mfma_f32_16x16x32_bf16 v[148:151], v[220:223], v[96:99], v[148:151]
  s_cbranch_scc1 M_sx9
  buffer_load_dwordx4 v[36:39], v36, s[16:19], 0 offen
M_sx9:
  v_mfma_f32_16x16x32_bf16 v[156:159], v[220:223], v[120:123], v[156:159]
  s_waitcnt lgkmcnt(7)
  v_cvt_pk_bf16_f32 v185, v178, v179
  v_cvt_pk_bf16_f32 v186, v180, v181
  v_mfma_f32_16x16x32_bf16 v[136:139], v[224:227], v[76:79], v[136:139]
  ds_read_b128 v[216:219], v196 offset:24576
  v_cvt_pk_bf16_f32 v187, v182, v183
  v_mfma_f32_16x16x32_bf16 v[144:147], v[224:227], v[100:103], v[144:147]
  ds_write_b128 v194, v[184:187] offset:6144
  v_mfma_f32_16x16x32_bf16 v[152:155], v[224:227], v[124:127], v[152:155]
  s_waitcnt lgkmcnt(8)
  v_mfma_f32_16x16x32_bf16 v[140:143], v[228:231], v[76:79], v[140:143]
  ds_read_b128 v[220:223], v196 offset:30720
  v_mfma_f32_16x16x32_bf16 v[148:151], v[228:231], v[100:103], v[148:151]
  v_mfma_f32_16x16x32_bf16 v[156:159], v[228:231], v[124:127], v[156:159]
  s_waitcnt lgkmcnt(8)
  v_mfma_f32_16x16x32_bf16 v[136:139], v[200:203], v[80:83], v[136:139]
  ds_read_b128 v[224:227], v196 offset:25600
  v_mfma_f32_16x16x32_bf16 v[144:147], v[200:203], v[104:107], v[144:147]
  v_mfma_f32_16x16x32_bf16 v[152:155], v[200:203], v[128:131], v[152:155]
  s_waitcnt lgkmcnt(7)
  v_mfma_f32_16x16x32_bf16 v[140:143], v[204:207], v[80:83], v[140:143]
  ds_read_b128 v[228:231], v196 offset:31744
  v_mfma_f32_16x16x32_bf16 v[148:151], v[204:207], v[104:107], v[148:151]
  s_cbranch_scc1 M_sx10
  buffer_load_dwordx4 v[56:59], v56, s[16:19], 0 offen
M_sx10:
  v_mfma_f32_16x16x32_bf16 v[156:159], v[204:207], v[128:131], v[156:159]
  s_waitcnt lgkmcnt(7)
  v_mfma_f32_16x16x32_bf16 v[136:139], v[208:211], v[84:87], v[136:139]
  ds_read_b128 v[200:203], v196 offset:26624
  v_mfma_f32_16x16x32_bf16 v[144:147], v[208:211], v[108:111], v[144:147]
  v_mfma_f32_16x16x32_bf16 v[152:155], v[208:211], v[132:135], v[152:155]
  s_waitcnt lgkmcnt(6)
  v_mfma_f32_16x16x32_bf16 v[140:143], v[212:215], v[84:87], v[140:143]
  ds_read_b128 v[204:207], v196 offset:32768
  v_mfma_f32_16x16x32_bf16 v[148:151], v[212:215], v[108:111], v[148:151]
  v_mfma_f32_16x16x32_bf16 v[156:159], v[212:215], v[132:135], v[156:159]
  s_waitcnt lgkmcnt(6)
  v_mfma_f32_16x16x32_bf16 v[160:163], v[216:219], v[64:67], 0
  ds_read_b128 v[208:211], v196 offset:27648
  v_mfma_f32_16x16x32_bf16 v[168:171], v[216:219], v[88:91], 0
  s_cbranch_scc1 M_sx11
  buffer_load_dwordx4 v[60:63], v60, s[16:19], 0 offen
M_sx11:
  v_mfma_f32_16x16x32_bf16 v[176:179], v[216:219], v[112:115], 0
  s_waitcnt lgkmcnt(5)
  v_mfma_f32_16x16x32_bf16 v[164:167], v[220:223], v[64:67], 0
  ds_read_b128 v[212:215], v196 offset:33792
  v_cvt_pk_bf16_f32 v184, v136, v137
  v_mfma_f32_16x16x32_bf16 v[172:175], v[220:223], v[88:91], 0
  v_cvt_pk_bf16_f32 v185, v138, v139
  v_cvt_pk_bf16_f32 v186, v140, v141
  v_mfma_f32_16x16x32_bf16 v[180:183], v[220:223], v[112:115], 0
  s_waitcnt lgkmcnt(5)
  v_cvt_pk_bf16_f32 v187, v142, v143
  v_mfma_f32_16x16x32_bf16 v[160:163], v[224:227], v[68:71], v[160:163]
  ds_read_b128 v[216:219], v196 offset:28672
  v_mfma_f32_16x16x32_bf16 v[168:171], v[224:227], v[92:95], v[168:171]
  ds_write_b128 v192, v[184:187] offset:8192
  v_mfma_f32_16x16x32_bf16 v[176:179], v[224:227], v[116:119], v[176:179]
  s_waitcnt lgkmcnt(6)
  v_mfma_f32_16x16x32_bf16 v[164:167], v[228:231], v[68:71], v[164:167]
  ds_read_b128 v[220:223], v196 offset:34816
  v_cvt_pk_bf16_f32 v188, v144, v145
  v_mfma_f32_16x16x32_bf16 v[172:175], v[228:231], v[92:95], v[172:175]
  v_cvt_pk_bf16_f32 v189, v146, v147
  v_cvt_pk_bf16_f32 v190, v148, v149
  v_mfma_f32_16x16x32_bf16 v[180:183], v[228:231], v[116:119], v[180:183]
  s_waitcnt lgkmcnt(6)
  v_cvt_pk_bf16_f32 v191, v150, v151
  v_mfma_f32_16x16x32_bf16 v[160:163], v[200:203], v[72:75], v[160:163]
  ds_read_b128 v[224:227], v196 offset:29696
  v_mfma_f32_16x16x32_bf16 v[168:171], v[200:203], v[96:99], v[168:171]
  ds_write_b128 v193, v[188:191] offset:8192
  v_mfma_f32_16x16x32_bf16 v[176:179], v[200:203], v[120:123], v[176:179]
  s_waitcnt lgkmcnt(7)
  v_mfma_f32_16x16x32_bf16 v[164:167], v[204:207], v[72:75], v[164:167]
  ds_read_b128 v[228:231], v196 offset:35840
  v_cvt_pk_bf16_f32 v184, v152, v153
  v_mfma_f32_16x16x32_bf16 v[172:175], v[204:207], v[96:99], v[172:175]
  v_cvt_pk_bf16_f32 v185, v154, v155
  v_cvt_pk_bf16_f32 v186, v156, v157
  v_mfma_f32_16x16x32_bf16 v[180:183], v[204:207], v[120:123], v[180:183]
  s_waitcnt lgkmcnt(7)
  v_cvt_pk_bf16_f32 v187, v158, v159
  v_mfma_f32_16x16x32_bf16 v[160:163], v[208:211], v[76:79], v[160:163]
  v_mfma_f32_16x16x32_bf16 v[168:171], v[208:211], v[100:103], v[168:171]
  ds_write_b128 v194, v[184:187] offset:8192
  v_mfma_f32_16x16x32_bf16 v[176:179], v[208:211], v[124:127], v[176:179]
  s_waitcnt lgkmcnt(7)
  v_mfma_f32_16x16x32_bf16 v[164:167], v[212:215], v[76:79], v[164:167]
  v_mfma_f32_16x16x32_bf16 v[172:175], v[212:215], v[100:103], v[172:175]
  v_mfma_f32_16x16x32_bf16 v[180:183], v[212:215], v[124:127], v[180:183]
  s_waitcnt lgkmcnt(6)
  v_mfma_f32_16x16x32_bf16 v[160:163], v[216:219], v[80:83], v[160:163]
  v_mfma_f32_16x16x32_bf16 v[168:171], v[216:219], v[104:107], v[168:171]
  v_mfma_f32_16x16x32_bf16 v[176:179], v[216:219], v[128:131], v[176:179]
  s_waitcnt lgkmcnt(4)
  v_mfma_f32_16x16x32_bf16 v[164:167], v[220:223], v[80:83], v[164:167]
  v_mfma_f32_16x16x32_bf16 v[172:175], v[220:223], v[104:107], v[172:175]
  v_mfma_f32_16x16x32_bf16 v[180:183], v[220:223], v[128:131], v[180:183]
  s_waitcnt lgkmcnt(3)
  v_mfma_f32_16x16x32_bf16 v[160:163], v[224:227], v[84:87], v[160:163]
  v_mfma_f32_16x16x32_bf16 v[168:171], v[224:227], v[108:111], v[168:171]
  v_mfma_f32_16x16x32_bf16 v[176:179], v[224:227], v[132:135], v[176:179]
  s_waitcnt lgkmcnt(1)
  v_mfma_f32_16x16x32_bf16 v[164:167], v[228:231], v[84:87], v[164:167]
  v_mfma_f32_16x16x32_bf16 v[172:175], v[228:231], v[108:111], v[172:175]
  v_mfma_f32_16x16x32_bf16 v[180:183], v[228:231], v[132:135], v[180:183]
  s_nop 1
  v_cvt_pk_bf16_f32 v184, v160, v161
  v_cvt_pk_bf16_f32 v185, v162, v163
  s_nop 1
  v_cvt_pk_bf16_f32 v186, v164, v165
  v_cvt_pk_bf16_f32 v187, v166, v167
  ds_write_b128 v192, v[184:187] offset:10240
  v_cvt_pk_bf16_f32 v188, v168, v169
  v_cvt_pk_bf16_f32 v189, v170, v171
  v_cvt_pk_bf16_f32 v190, v172, v173
  v_cvt_pk_bf16_f32 v191, v174, v175
  ds_write_b128 v193, v[188:191] offset:10240
  v_cvt_pk_bf16_f32 v184, v176, v177
  v_cvt_pk_bf16_f32 v185, v178, v179
  v_cvt_pk_bf16_f32 v186, v180, v181
  v_cvt_pk_bf16_f32 v187, v182, v183
  ds_write_b128 v194, v[184:187] offset:10240
  s_waitcnt lgkmcnt(0)
  s_barrier
  s_cbranch_scc1 M_helper
  s_setprio 0
  s_mov_b64 vcc, s[0:1]
  s_waitcnt vmcnt(10)
  v_cndmask_b32_dpp v168, v20, v16, vcc quad_perm:[1,0,3,2] row_mask:0xf bank_mask:0xf
  v_cndmask_b32_dpp v169, v21, v17, vcc quad_perm:[1,0,3,2] row_mask:0xf bank_mask:0xf
  v_cndmask_b32_dpp v170, v22, v18, vcc quad_perm:[1,0,3,2] row_mask:0xf bank_mask:0xf
  v_cndmask_b32_dpp v171, v23, v19, vcc quad_perm:[1,0,3,2] row_mask:0xf bank_mask:0xf
  s_waitcnt vmcnt(8)
  v_cndmask_b32_dpp v176, v28, v24, vcc quad_perm:[1,0,3,2] row_mask:0xf bank_mask:0xf
  v_cndmask_b32_dpp v177, v29, v25, vcc quad_perm:[1,0,3,2] row_mask:0xf bank_mask:0xf
  v_cndmask_b32_dpp v178, v30, v26, vcc quad_perm:[1,0,3,2] row_mask:0xf bank_mask:0xf
  v_cndmask_b32_dpp v179, v31, v27, vcc quad_perm:[1,0,3,2] row_mask:0xf bank_mask:0xf
  s_not_b64 vcc, vcc
  v_cndmask_b32_dpp v172, v16, v20, vcc quad_perm:[1,0,3,2] row_mask:0xf bank_mask:0xf
  v_cndmask_b32_dpp v173, v17, v21, vcc quad_perm:[1,0,3,2] row_mask:0xf bank_mask:0xf
  v_cndmask_b32_dpp v174, v18, v22, vcc quad_perm:[1,0,3,2] row_mask:0xf bank_mask:0xf
  v_cndmask_b32_dpp v175, v19, v23, vcc quad_perm:[1,0,3,2] row_mask:0xf bank_mask:0xf
  v_cndmask_b32_dpp v180, v24, v28, vcc quad_perm:[1,0,3,2] row_mask:0xf bank_mask:0xf
  v_cndmask_b32_dpp v181, v25, v29, vcc quad_perm:[1,0,3,2] row_mask:0xf bank_mask:0xf
  v_cndmask_b32_dpp v182, v26, v30, vcc quad_perm:[1,0,3,2] row_mask:0xf bank_mask:0xf
  v_cndmask_b32_dpp v183, v27, v31, vcc quad_perm:[1,0,3,2] row_mask:0xf bank_mask:0xf
  s_mov_b64 vcc, s[10:11]
  v_cndmask_b32_dpp v16, v176, v168, vcc quad_perm:[2,3,0,1] row_mask:0xf bank_mask:0xf
  v_cndmask_b32_dpp v17, v177, v169, vcc quad_perm:[2,3,0,1] row_mask:0xf bank_mask:0xf
  v_cndmask_b32_dpp v18, v178, v170, vcc quad_perm:[2,3,0,1] row_mask:0xf bank_mask:0xf
  v_cndmask_b32_dpp v19, v179, v171, vcc quad_perm:[2,3,0,1] row_mask:0xf bank_mask:0xf
  v_cndmask_b32_dpp v20, v180, v172, vcc quad_perm:[2,3,0,1] row_mask:0xf bank_mask:0xf
  v_cndmask_b32_dpp v21, v181, v173, vcc quad_perm:[2,3,0,1] row_mask:0xf bank_mask:0xf
  v_cndmask_b32_dpp v22, v182, v174, vcc quad_perm:[2,3,0,1] row_mask:0xf bank_mask:0xf
  v_cndmask_b32_dpp v23, v183, v175, vcc quad_perm:[2,3,0,1] row_mask:0xf bank_mask:0xf
  s_not_b64 vcc, vcc
  v_cndmask_b32_dpp v24, v168, v176, vcc quad_perm:[2,3,0,1] row_mask:0xf bank_mask:0xf
  v_cndmask_b32_dpp v25, v169, v177, vcc quad_perm:[2,3,0,1] row_mask:0xf bank_mask:0xf
  v_cndmask_b32_dpp v26, v170, v178, vcc quad_perm:[2,3,0,1] row_mask:0xf bank_mask:0xf
  v_cndmask_b32_dpp v27, v171, v179, vcc quad_perm:[2,3,0,1] row_mask:0xf bank_mask:0xf
  v_cndmask_b32_dpp v28, v172, v180, vcc quad_perm:[2,3,0,1] row_mask:0xf bank_mask:0xf
  v_cndmask_b32_dpp v29, v173, v181, vcc quad_perm:[2,3,0,1] row_mask:0xf bank_mask:0xf
  v_cndmask_b32_dpp v30, v174, v182, vcc quad_perm:[2,3,0,1] row_mask:0xf bank_mask:0xf
  v_cndmask_b32_dpp v31, v175, v183, vcc quad_perm:[2,3,0,1] row_mask:0xf bank_mask:0xf
  s_mov_b64 vcc, s[0:1]
  s_waitcnt vmcnt(6)
  v_cndmask_b32_dpp v168, v44, v40, vcc quad_perm:[1,0,3,2] row_mask:0xf bank_mask:0xf
  v_cndmask_b32_dpp v169, v45, v41, vcc quad_perm:[1,0,3,2] row_mask:0xf bank_mask:0xf
  v_cndmask_b32_dpp v170, v46, v42, vcc quad_perm:[1,0,3,2] row_mask:0xf bank_mask:0xf
  v_cndmask_b32_dpp v171, v47, v43, vcc quad_perm:[1,0,3,2] row_mask:0xf bank_mask:0xf
  s_waitcnt vmcnt(4)
  v_cndmask_b32_dpp v176, v52, v48, vcc quad_perm:[1,0,3,2] row_mask:0xf bank_mask:0xf
  v_cndmask_b32_dpp v177, v53, v49, vcc quad_perm:[1,0,3,2] row_mask:0xf bank_mask:0xf
  v_cndmask_b32_dpp v178, v54, v50, vcc quad_perm:[1,0,3,2] row_mask:0xf bank_mask:0xf
  v_cndmask_b32_dpp v179, v55, v51, vcc quad_perm:[1,0,3,2] row_mask:0xf bank_mask:0xf
  s_not_b64 vcc, vcc
  v_cndmask_b32_dpp v172, v40, v44, vcc quad_perm:[1,0,3,2] row_mask:0xf bank_mask:0xf
  v_cndmask_b32_dpp v173, v41, v45, vcc quad_perm:[1,0,3,2] row_mask:0xf bank_mask:0xf
  v_cndmask_b32_dpp v174, v42, v46, vcc quad_perm:[1,0,3,2] row_mask:0xf bank_mask:0xf
  v_cndmask_b32_dpp v175, v43, v47, vcc quad_perm:[1,0,3,2] row_mask:0xf bank_mask:0xf
  v_cndmask_b32_dpp v180, v48, v52, vcc quad_perm:[1,0,3,2] row_mask:0xf bank_mask:0xf
  v_cndmask_b32_dpp v181, v49, v53, vcc quad_perm:[1,0,3,2] row_mask:0xf bank_mask:0xf
  v_cndmask_b32_dpp v182, v50, v54, vcc quad_perm:[1,0,3,2] row_mask:0xf bank_mask:0xf
  v_cndmask_b32_dpp v183, v51, v55, vcc quad_perm:[1,0,3,2] row_mask:0xf bank_mask:0xf
  s_mov_b64 vcc, s[10:11]
  v_cndmask_b32_dpp v40, v176, v168, vcc quad_perm:[2,3,0,1] row_mask:0xf bank_mask:0xf
  v_cndmask_b32_dpp v41, v177, v169, vcc quad_perm:[2,3,0,1] row_mask:0xf bank_mask:0xf
  v_cndmask_b32_dpp v42, v178, v170, vcc quad_perm:[2,3,0,1] row_mask:0xf bank_mask:0xf
  v_cndmask_b32_dpp v43, v179, v171, vcc quad_perm:[2,3,0,1] row_mask:0xf bank_mask:0xf
  v_cndmask_b32_dpp v44, v180, v172, vcc quad_perm:[2,3,0,1] row_mask:0xf bank_mask:0xf
  v_cndmask_b32_dpp v45, v181, v173, vcc quad_perm:[2,3,0,1] row_mask:0xf bank_mask:0xf
  v_cndmask_b32_dpp v46, v182, v174, vcc quad_perm:[2,3,0,1] row_mask:0xf bank_mask:0xf
  v_cndmask_b32_dpp v47, v183, v175, vcc quad_perm:[2,3,0,1] row_mask:0xf bank_mask:0xf
  s_not_b64 vcc, vcc
  v_cndmask_b32_dpp v48, v168, v176, vcc quad_perm:[2,3,0,1] row_mask:0xf bank_mask:0xf
  v_cndmask_b32_dpp v49, v169, v177, vcc quad_perm:[2,3,0,1] row_mask:0xf bank_mask:0xf
  v_cndmask_b32_dpp v50, v170, v178, vcc quad_perm:[2,3,0,1] row_mask:0xf bank_mask:0xf
  v_cndmask_b32_dpp v51, v171, v179, vcc quad_perm:[2,3,0,1] row_mask:0xf bank_mask:0xf
  v_cndmask_b32_dpp v52, v172, v180, vcc quad_perm:[2,3,0,1] row_mask:0xf bank_mask:0xf
  v_cndmask_b32_dpp v53, v173, v181, vcc quad_perm:[2,3,0,1] row_mask:0xf bank_mask:0xf
  v_cndmask_b32_dpp v54, v174, v182, vcc quad_perm:[2,3,0,1] row_mask:0xf bank_mask:0xf
  v_cndmask_b32_dpp v55, v175, v183, vcc quad_perm:[2,3,0,1] row_mask:0xf bank_mask:0xf
  s_mov_b64 vcc, s[0:1]
  s_waitcnt vmcnt(2)
  v_cndmask_b32_dpp v168, v36, v32, vcc quad_perm:[1,0,3,2] row_mask:0xf bank_mask:0xf
  v_cndmask_b32_dpp v169, v37, v33, vcc quad_perm:[1,0,3,2] row_mask:0xf bank_mask:0xf
  v_cndmask_b32_dpp v170, v38, v34, vcc quad_perm:[1,0,3,2] row_mask:0xf bank_mask:0xf
  v_cndmask_b32_dpp v171, v39, v35, vcc quad_perm:[1,0,3,2] row_mask:0xf bank_mask:0xf
  s_waitcnt vmcnt(0)
  v_cndmask_b32_dpp v176, v60, v56, vcc quad_perm:[1,0,3,2] row_mask:0xf bank_mask:0xf
  v_cndmask_b32_dpp v177, v61, v57, vcc quad_perm:[1,0,3,2] row_mask:0xf bank_mask:0xf
  v_cndmask_b32_dpp v178, v62, v58, vcc quad_perm:[1,0,3,2] row_mask:0xf bank_mask:0xf
  v_cndmask_b32_dpp v179, v63, v59, vcc quad_perm:[1,0,3,2] row_mask:0xf bank_mask:0xf
  s_not_b64 vcc, vcc
  v_cndmask_b32_dpp v172, v32, v36, vcc quad_perm:[1,0,3,2] row_mask:0xf bank_mask:0xf
  v_cndmask_b32_dpp v173, v33, v37, vcc quad_perm:[1,0,3,2] row_mask:0xf bank_mask:0xf
  v_cndmask_b32_dpp v174, v34, v38, vcc quad_perm:[1,0,3,2] row_mask:0xf bank_mask:0xf
  v_cndmask_b32_dpp v175, v35, v39, vcc quad_perm:[1,0,3,2] row_mask:0xf bank_mask:0xf
  v_cndmask_b32_dpp v180, v56, v60, vcc quad_perm:[1,0,3,2] row_mask:0xf bank_mask:0xf
  v_cndmask_b32_dpp v181, v57, v61, vcc quad_perm:[1,0,3,2] row_mask:0xf bank_mask:0xf
  v_cndmask_b32_dpp v182, v58, v62, vcc quad_perm:[1,0,3,2] row_mask:0xf bank_mask:0xf
  v_cndmask_b32_dpp v183, v59, v63, vcc quad_perm:[1,0,3,2] row_mask:0xf bank_mask:0xf
  s_mov_b64 vcc, s[10:11]
  v_cndmask_b32_dpp v32, v176, v168, vcc quad_perm:[2,3,0,1] row_mask:0xf bank_mask:0xf
  v_cndmask_b32_dpp v33, v177, v169, vcc quad_perm:[2,3,0,1] row_mask:0xf bank_mask:0xf
  v_cndmask_b32_dpp v34, v178, v170, vcc quad_perm:[2,3,0,1] row_mask:0xf bank_mask:0xf
  v_cndmask_b32_dpp v35, v179, v171, vcc quad_perm:[2,3,0,1] row_mask:0xf bank_mask:0xf
  v_cndmask_b32_dpp v36, v180, v172, vcc quad_perm:[2,3,0,1] row_mask:0xf bank_mask:0xf
  v_cndmask_b32_dpp v37, v181, v173, vcc quad_perm:[2,3,0,1] row_mask:0xf bank_mask:0xf
  v_cndmask_b32_dpp v38, v182, v174, vcc quad_perm:[2,3,0,1] row_mask:0xf bank_mask:0xf
  v_cndmask_b32_dpp v39, v183, v175, vcc quad_perm:[2,3,0,1] row_mask:0xf bank_mask:0xf
  s_not_b64 vcc, vcc
  v_cndmask_b32_dpp v56, v168, v176, vcc quad_perm:[2,3,0,1] row_mask:0xf bank_mask:0xf
  v_cndmask_b32_dpp v57, v169, v177, vcc quad_perm:[2,3,0,1] row_mask:0xf bank_mask:0xf
  v_cndmask_b32_dpp v58, v170, v178, vcc quad_perm:[2,3,0,1] row_mask:0xf bank_mask:0xf
  v_cndmask_b32_dpp v59, v171, v179, vcc quad_perm:[2,3,0,1] row_mask:0xf bank_mask:0xf
  v_cndmask_b32_dpp v60, v172, v180, vcc quad_perm:[2,3,0,1] row_mask:0xf bank_mask:0xf
  v_cndmask_b32_dpp v61, v173, v181, vcc quad_perm:[2,3,0,1] row_mask:0xf bank_mask:0xf
  v_cndmask_b32_dpp v62, v174, v182, vcc quad_perm:[2,3,0,1] row_mask:0xf bank_mask:0xf
  v_cndmask_b32_dpp v63, v175, v183, vcc quad_perm:[2,3,0,1] row_mask:0xf bank_mask:0xf
  v_permlane32_swap_b32 v32, v56
  v_permlane32_swap_b32 v33, v57
  v_permlane32_swap_b32 v34, v58
  v_permlane32_swap_b32 v35, v59
  v_permlane32_swap_b32 v36, v60
  v_permlane32_swap_b32 v37, v61
  v_permlane32_swap_b32 v38, v62
  v_permlane32_swap_b32 v39, v63
M_pa:
  ds_read_b128 v[200:203], v254 offset:0
  ds_read_b128 v[204:207], v254 offset:1024
  ds_read_b128 v[208:211], v254 offset:2048
  ds_read_b128 v[212:215], v254 offset:3072
  ds_read_b128 v[216:219], v254 offset:4096
  ds_read_b128 v[220:223], v254 offset:5120
  s_waitcnt lgkmcnt(5)
  v_mfma_f32_16x16x32_bf16 v[168:171], v[200:203], v[16:19], 0
  ds_read_b128 v[224:227], v254 offset:6144
  v_mfma_f32_16x16x32_bf16 v[176:179], v[200:203], v[40:43], 0
  s_waitcnt lgkmcnt(5)
  v_mfma_f32_16x16x32_bf16 v[172:175], v[204:207], v[16:19], 0
  ds_read_b128 v[228:231], v254 offset:7168
  v_mfma_f32_16x16x32_bf16 v[180:183], v[204:207], v[40:43], 0
  s_waitcnt lgkmcnt(5)
  v_mfma_f32_16x16x32_bf16 v[168:171], v[208:211], v[20:23], v[168:171]
  ds_read_b128 v[200:203], v254 offset:8192
  v_mfma_f32_16x16x32_bf16 v[176:179], v[208:211], v[44:47], v[176:179]
  s_waitcnt lgkmcnt(5)
  v_mfma_f32_16x16x32_bf16 v[172:175], v[212:215], v[20:23], v[172:175]
  ds_read_b128 v[204:207], v254 offset:9216
  v_mfma_f32_16x16x32_bf16 v[180:183], v[212:215], v[44:47], v[180:183]
  s_waitcnt lgkmcnt(5)
  v_mfma_f32_16x16x32_bf16 v[168:171], v[216:219], v[24:27], v[168:171]
  ds_read_b128 v[208:211], v254 offset:10240
  v_mfma_f32_16x16x32_bf16 v[176:179], v[216:219], v[48:51], v[176:179]
  s_waitcnt lgkmcnt(5)
  v_mfma_f32_16x16x32_bf16 v[172:175], v[220:223], v[24:27], v[172:175]
  ds_read_b128 v[212:215], v254 offset:11264
  v_mfma_f32_16x16x32_bf16 v[180:183], v[220:223], v[48:51], v[180:183]
  s_waitcnt lgkmcnt(5)
  v_mfma_f32_16x16x32_bf16 v[168:171], v[224:227], v[28:31], v[168:171]
  ds_read_b128 v[216:219], v254 offset:12288
  v_mfma_f32_16x16x32_bf16 v[176:179], v[224:227], v[52:55], v[176:179]
  s_waitcnt lgkmcnt(5)
  v_mfma_f32_16x16x32_bf16 v[172:175], v[228:231], v[28:31], v[172:175]
  ds_read_b128 v[220:223], v254 offset:13312
  v_mfma_f32_16x16x32_bf16 v[180:183], v[228:231], v[52:55], v[180:183]
  s_waitcnt lgkmcnt(5)
  v_mfma_f32_16x16x32_bf16 v[168:171], v[200:203], v[32:35], v[168:171]
  ds_read_b128 v[224:227], v254 offset:14336
  v_mfma_f32_16x16x32_bf16 v[176:179], v[200:203], v[56:59], v[176:179]
  s_waitcnt lgkmcnt(5)
  v_mfma_f32_16x16x32_bf16 v[172:175], v[204:207], v[32:35], v[172:175]
  ds_read_b128 v[228:231], v254 offset:15360
  v_mfma_f32_16x16x32_bf16 v[180:183], v[204:207], v[56:59], v[180:183]
  s_waitcnt lgkmcnt(5)
  v_mfma_f32_16x16x32_bf16 v[168:171], v[208:211], v[36:39], v[168:171]
  ds_read_b128 v[200:203], v254 offset:16384
  v_mfma_f32_16x16x32_bf16 v[176:179], v[208:211], v[60:63], v[176:179]
  s_waitcnt lgkmcnt(5)
  v_mfma_f32_16x16x32_bf16 v[172:175], v[212:215], v[36:39], v[172:175]
  ds_read_b128 v[204:207], v254 offset:17408
  v_mfma_f32_16x16x32_bf16 v[180:183], v[212:215], v[60:63], v[180:183]
  s_cmp_ge_u32 s94, 144
  s_cbranch_scc1 M_v4
  v_mov_b32 v255, 1
  v_mov_b32 v0, 0
  s_mov_b64 exec, 1
  s_waitcnt vmcnt(0)
  buffer_atomic_add v255, v0, s[36:39], 0 offen sc0 sc1
  s_mov_b64 exec, -1
M_v4:
  s_waitcnt lgkmcnt(5)
  v_mfma_f32_16x16x32_bf16 v[184:187], v[216:219], v[16:19], 0
  ds_read_b128 v[208:211], v254 offset:18432
  v_mfma_f32_16x16x32_bf16 v[192:195], v[216:219], v[40:43], 0
  s_waitcnt lgkmcnt(5)
  v_mfma_f32_16x16x32_bf16 v[188:191], v[220:223], v[16:19], 0
  ds_read_b128 v[212:215], v254 offset:19456
  v_cvt_pk_bf16_f32 v120, v168, v169
  v_mfma_f32_16x16x32_bf16 v[196:199], v[220:223], v[40:43], 0
  s_waitcnt lgkmcnt(5)
  v_cvt_pk_bf16_f32 v121, v170, v171
  v_cvt_pk_bf16_f32 v122, v172, v173
  v_mfma_f32_16x16x32_bf16 v[184:187], v[224:227], v[20:23], v[184:187]
  ds_read_b128 v[216:219], v254 offset:20480
  v_cvt_pk_bf16_f32 v123, v174, v175
  v_mfma_f32_16x16x32_bf16 v[192:195], v[224:227], v[44:47], v[192:195]
  s_waitcnt lgkmcnt(5)
  v_cvt_pk_bf16_f32 v144, v176, v177
  v_cvt_pk_bf16_f32 v145, v178, v179
  v_mfma_f32_16x16x32_bf16 v[188:191], v[228:231], v[20:23], v[188:191]
  ds_read_b128 v[220:223], v254 offset:21504
  v_cvt_pk_bf16_f32 v146, v180, v181
  v_mfma_f32_16x16x32_bf16 v[196:199], v[228:231], v[44:47], v[196:199]
  s_waitcnt lgkmcnt(5)
  v_cvt_pk_bf16_f32 v147, v182, v183
  v_mfma_f32_16x16x32_bf16 v[184:187], v[200:203], v[24:27], v[184:187]
  ds_read_b128 v[224:227], v254 offset:22528
  v_mfma_f32_16x16x32_bf16 v[192:195], v[200:203], v[48:51], v[192:195]
  s_waitcnt lgkmcnt(5)
  v_mfma_f32_16x16x32_bf16 v[188:191], v[204:207], v[24:27], v[188:191]
  ds_read_b128 v[228:231], v254 offset:23552
  v_mfma_f32_16x16x32_bf16 v[196:199], v[204:207], v[48:51], v[196:199]
  s_waitcnt lgkmcnt(5)
  v_mfma_f32_16x16x32_bf16 v[184:187], v[208:211], v[28:31], v[184:187]
  ds_read_b128 v[200:203], v254 offset:24576
  v_mfma_f32_16x16x32_bf16 v[192:195], v[208:211], v[52:55], v[192:195]
  s_waitcnt lgkmcnt(5)
  v_mfma_f32_16x16x32_bf16 v[188:191], v[212:215], v[28:31], v[188:191]
  ds_read_b128 v[204:207], v254 offset:25600
  v_mfma_f32_16x16x32_bf16 v[196:199], v[212:215], v[52:55], v[196:199]
  s_waitcnt lgkmcnt(5)
  v_mfma_f32_16x16x32_bf16 v[184:187], v[216:219], v[32:35], v[184:187]
  ds_read_b128 v[208:211], v254 offset:26624
  v_mfma_f32_16x16x32_bf16 v[192:195], v[216:219], v[56:59], v[192:195]
  s_waitcnt lgkmcnt(5)
  v_mfma_f32_16x16x32_bf16 v[188:191], v[220:223], v[32:35], v[188:191]
  ds_read_b128 v[212:215], v254 offset:27648
  v_mfma_f32_16x16x32_bf16 v[196:199], v[220:223], v[56:59], v[196:199]
  s_waitcnt lgkmcnt(5)
  v_mfma_f32_16x16x32_bf16 v[184:187], v[224:227], v[36:39], v[184:187]
  ds_read_b128 v[216:219], v254 offset:28672
  v_mfma_f32_16x16x32_bf16 v[192:195], v[224:227], v[60:63], v[192:195]
  s_waitcnt lgkmcnt(5)
  v_bfe_i32 v66, v14, 0, 1
  v_bfe_i32 v94, v15, 6, 1
  v_mfma_f32_16x16x32_bf16 v[188:191], v[228:231], v[36:39], v[188:191]
  ds_read_b128 v[220:223], v254 offset:29696
  v_and_b32 v65, s54, v66
  v_mfma_f32_16x16x32_bf16 v[196:199], v[228:231], v[60:63], v[196:199]
  s_waitcnt lgkmcnt(5)
  v_and_b32 v93, s54, v94
  v_and_b32 v66, s54, v66
  v_mfma_f32_16x16x32_bf16 v[168:171], v[200:203], v[16:19], 0
  ds_read_b128 v[224:227], v254 offset:30720
  v_and_b32 v94, s54, v94
  v_mfma_f32_16x16x32_bf16 v[176:179], v[200:203], v[40:43], 0
  s_waitcnt lgkmcnt(5)
  v_or_b32 v64, v65, v12
  v_or_b32 v92, v93, v12
  v_mfma_f32_16x16x32_bf16 v[172:175], v[204:207], v[16:19], 0
  ds_read_b128 v[228:231], v254 offset:31744
  v_cvt_pk_bf16_f32 v124, v184, v185
  v_mfma_f32_16x16x32_bf16 v[180:183], v[204:207], v[40:43], 0
  s_waitcnt lgkmcnt(5)
  v_cvt_pk_bf16_f32 v125, v186, v187
  v_cvt_pk_bf16_f32 v126, v188, v189
  v_mfma_f32_16x16x32_bf16 v[168:171], v[208:211], v[20:23], v[168:171]
  ds_read_b128 v[200:203], v254 offset:32768
  v_cvt_pk_bf16_f32 v127, v190, v191
  v_mfma_f32_16x16x32_bf16 v[176:179], v[208:211], v[44:47], v[176:179]
  s_waitcnt lgkmcnt(5)
  v_cvt_pk_bf16_f32 v148, v192, v193
  v_cvt_pk_bf16_f32 v149, v194, v195
  v_mfma_f32_16x16x32_bf16 v[172:175], v[212:215], v[20:23], v[172:175]
  ds_read_b128 v[204:207], v254 offset:33792
  v_cvt_pk_bf16_f32 v150, v196, v197
  v_mfma_f32_16x16x32_bf16 v[180:183], v[212:215], v[44:47], v[180:183]
  s_waitcnt lgkmcnt(5)
  v_cvt_pk_bf16_f32 v151, v198, v199
  v_or_b32 v67, v65, v13
  v_mfma_f32_16x16x32_bf16 v[168:171], v[216:219], v[24:27], v[168:171]
  ds_read_b128 v[208:211], v254 offset:34816
  v_or_b32 v95, v93, v13
  v_mfma_f32_16x16x32_bf16 v[176:179], v[216:219], v[48:51], v[176:179]
  s_waitcnt lgkmcnt(5)
  v_bfe_i32 v70, v14, 2, 1
  v_bfe_i32 v98, v15, 8, 1
  v_mfma_f32_16x16x32_bf16 v[172:175], v[220:223], v[24:27], v[172:175]
  ds_read_b128 v[212:215], v254 offset:35840
  v_and_b32 v69, s54, v70
  v_mfma_f32_16x16x32_bf16 v[180:183], v[220:223], v[48:51], v[180:183]
  s_waitcnt lgkmcnt(5)
  v_and_b32 v97, s54, v98
  v_and_b32 v70, s54, v70
  v_mfma_f32_16x16x32_bf16 v[168:171], v[224:227], v[28:31], v[168:171]
  ds_read_b128 v[216:219], v254 offset:36864
  v_and_b32 v98, s54, v98
  v_mfma_f32_16x16x32_bf16 v[176:179], v[224:227], v[52:55], v[176:179]
  s_waitcnt lgkmcnt(5)
  v_or_b32 v68, v69, v12
  v_or_b32 v96, v97, v12
  v_mfma_f32_16x16x32_bf16 v[172:175], v[228:231], v[28:31], v[172:175]
  ds_read_b128 v[220:223], v254 offset:37888
  v_or_b32 v71, v69, v13
  v_mfma_f32_16x16x32_bf16 v[180:183], v[228:231], v[52:55], v[180:183]
  s_waitcnt lgkmcnt(5)
  v_or_b32 v99, v97, v13
  v_bfe_i32 v74, v14, 4, 1
  v_mfma_f32_16x16x32_bf16 v[168:171], v[200:203], v[32:35], v[168:171]
  ds_read_b128 v[224:227], v254 offset:38912
  v_bfe_i32 v102, v15, 10, 1
  v_mfma_f32_16x16x32_bf16 v[176:179], v[200:203], v[56:59], v[176:179]
  s_waitcnt lgkmcnt(5)
  v_and_b32 v73, s54, v74
  v_and_b32 v101, s54, v102
  v_mfma_f32_16x16x32_bf16 v[172:175], v[204:207], v[32:35], v[172:175]
  ds_read_b128 v[228:231], v254 offset:39936
  v_and_b32 v74, s54, v74
  v_mfma_f32_16x16x32_bf16 v[180:183], v[204:207], v[56:59], v[180:183]
  s_waitcnt lgkmcnt(5)
  v_and_b32 v102, s54, v102
  v_or_b32 v72, v73, v12
  v_mfma_f32_16x16x32_bf16 v[168:171], v[208:211], v[36:39], v[168:171]
  ds_read_b128 v[200:203], v254 offset:40960
  v_or_b32 v100, v101, v12
  v_mfma_f32_16x16x32_bf16 v[176:179], v[208:211], v[60:63], v[176:179]
  s_waitcnt lgkmcnt(5)
  v_or_b32 v75, v73, v13
  v_or_b32 v103, v101, v13
  v_mfma_f32_16x16x32_bf16 v[172:175], v[212:215], v[36:39], v[172:175]
  ds_read_b128 v[204:207], v254 offset:41984
  v_bfe_i32 v78, v14, 6, 1
  v_mfma_f32_16x16x32_bf16 v[180:183], v[212:215], v[60:63], v[180:183]
  v_bfe_i32 v106, v15, 12, 1
  v_and_b32 v77, s54, v78
  s_cmp_ge_u32 s94, 144
  s_cbranch_scc1 M_v5
  s_waitcnt vmcnt(0)
  v_readfirstlane_b32 s56, v255
  s_nop 1
  s_cmp_lg_u32 s56, 143
  s_cbranch_scc1 M_v5
  s_mov_b64 exec, 1
  buffer_store_dword v255, v0, s[36:39], 0 offen offset:128 sc1
  s_mov_b64 exec, -1
M_v5:
  s_barrier
  s_waitcnt lgkmcnt(5)
  v_mfma_f32_16x16x32_bf16 v[184:187], v[216:219], v[16:19], 0
  ds_read_b128 v[208:211], v254 offset:43008
  s_add_u32 m0, s101, 0
  s_nop 0
  buffer_load_dwordx4 v232, s[16:19], s100 offen lds
  v_mfma_f32_16x16x32_bf16 v[192:195], v[216:219], v[40:43], 0
  s_waitcnt lgkmcnt(5)
  s_add_u32 m0, s101, 1024
  s_nop 0
  buffer_load_dwordx4 v233, s[16:19], s100 offen lds
  s_add_u32 m0, s101, 2048
  s_nop 0
  buffer_load_dwordx4 v234, s[16:19], s100 offen lds
  v_mfma_f32_16x16x32_bf16 v[188:191], v[220:223], v[16:19], 0
  ds_read_b128 v[212:215], v254 offset:44032
  v_cvt_pk_bf16_f32 v128, v168, v169
  v_mfma_f32_16x16x32_bf16 v[196:199], v[220:223], v[40:43], 0
  s_waitcnt lgkmcnt(5)
  v_cvt_pk_bf16_f32 v129, v170, v171
  v_cvt_pk_bf16_f32 v130, v172, v173
  v_mfma_f32_16x16x32_bf16 v[184:187], v[224:227], v[20:23], v[184:187]
  ds_read_b128 v[216:219], v254 offset:45056
  v_cvt_pk_bf16_f32 v131, v174, v175
  v_mfma_f32_16x16x32_bf16 v[192:195], v[224:227], v[44:47], v[192:195]
  s_waitcnt lgkmcnt(5)
  v_cvt_pk_bf16_f32 v152, v176, v177
  v_cvt_pk_bf16_f32 v153, v178, v179
  v_mfma_f32_16x16x32_bf16 v[188:191], v[228:231], v[20:23], v[188:191]
  ds_read_b128 v[220:223], v254 offset:46080
  v_cvt_pk_bf16_f32 v154, v180, v181
  v_mfma_f32_16x16x32_bf16 v[196:199], v[228:231], v[44:47], v[196:199]
  s_waitcnt lgkmcnt(5)
  v_cvt_pk_bf16_f32 v155, v182, v183
  s_add_u32 m0, s101, 3072
  s_nop 0
  buffer_load_dwordx4 v235, s[16:19], s100 offen lds
  v_mfma_f32_16x16x32_bf16 v[184:187], v[200:203], v[24:27], v[184:187]
  ds_read_b128 v[224:227], v254 offset:47104
  s_add_u32 m0, s101, 4096
  s_nop 0
  buffer_load_dwordx4 v236, s[16:19], s100 offen lds
  v_mfma_f32_16x16x32_bf16 v[192:195], v[200:203], v[48:51], v[192:195]
  s_waitcnt lgkmcnt(5)
  s_add_u32 m0, s101, 5120
  s_nop 0
  buffer_load_dwordx4 v237, s[16:19], s100 offen lds
  s_add_u32 m0, s101, 6144
  s_nop 0
  buffer_load_dwordx4 v238, s[16:19], s100 offen lds
  v_mfma_f32_16x16x32_bf16 v[188:191], v[204:207], v[24:27], v[188:191]
  ds_read_b128 v[228:231], v254 offset:48128
  s_add_u32 m0, s101, 6656
  s_nop 0
  buffer_load_dwordx4 v239, s[16:19], s100 offen lds
  v_mfma_f32_16x16x32_bf16 v[196:199], v[204:207], v[48:51], v[196:199]
  s_waitcnt lgkmcnt(5)
  v_and_b32 v105, s54, v106
  v_and_b32 v78, s54, v78
  v_mfma_f32_16x16x32_bf16 v[184:187], v[208:211], v[28:31], v[184:187]
  ds_read_b128 v[200:203], v254 offset:49152
  v_and_b32 v106, s54, v106
  v_mfma_f32_16x16x32_bf16 v[192:195], v[208:211], v[52:55], v[192:195]
  s_waitcnt lgkmcnt(5)
  v_or_b32 v76, v77, v12
  v_or_b32 v104, v105, v12
  v_mfma_f32_16x16x32_bf16 v[188:191], v[212:215], v[28:31], v[188:191]
  ds_read_b128 v[204:207], v254 offset:50176
  v_or_b32 v79, v77, v13
  v_mfma_f32_16x16x32_bf16 v[196:199], v[212:215], v[52:55], v[196:199]
  s_waitcnt lgkmcnt(5)
  v_or_b32 v107, v105, v13
  v_bfe_i32 v82, v14, 8, 1
  v_mfma_f32_16x16x32_bf16 v[184:187], v[216:219], v[32:35], v[184:187]
  ds_read_b128 v[208:211], v254 offset:51200
  v_bfe_i32 v110, v15, 14, 1
  v_mfma_f32_16x16x32_bf16 v[192:195], v[216:219], v[56:59], v[192:195]
  s_waitcnt lgkmcnt(5)
  v_and_b32 v81, s54, v82
  v_and_b32 v109, s54, v110
  v_mfma_f32_16x16x32_bf16 v[188:191], v[220:223], v[32:35], v[188:191]
  ds_read_b128 v[212:215], v254 offset:52224
  v_and_b32 v82, s54, v82
  v_mfma_f32_16x16x32_bf16 v[196:199], v[220:223], v[56:59], v[196:199]
  s_waitcnt lgkmcnt(5)
  v_and_b32 v110, s54, v110
  v_or_b32 v80, v81, v12
  v_mfma_f32_16x16x32_bf16 v[184:187], v[224:227], v[36:39], v[184:187]
  ds_read_b128 v[216:219], v254 offset:53248
  v_or_b32 v108, v109, v12
  v_mfma_f32_16x16x32_bf16 v[192:195], v[224:227], v[60:63], v[192:195]
  s_waitcnt lgkmcnt(5)
  v_or_b32 v83, v81, v13
  v_or_b32 v111, v109, v13
  v_mfma_f32_16x16x32_bf16 v[188:191], v[228:231], v[36:39], v[188:191]
  ds_read_b128 v[220:223], v254 offset:54272
  v_bfe_i32 v86, v14, 10, 1
  v_mfma_f32_16x16x32_bf16 v[196:199], v[228:231], v[60:63], v[196:199]
  s_waitcnt lgkmcnt(5)
  v_bfe_i32 v114, v15, 16, 1
  v_and_b32 v85, s54, v86
  v_mfma_f32_16x16x32_bf16 v[168:171], v[200:203], v[16:19], 0
  ds_read_b128 v[224:227], v254 offset:55296
  v_and_b32 v113, s54, v114
  v_mfma_f32_16x16x32_bf16 v[176:179], v[200:203], v[40:43], 0
  s_waitcnt lgkmcnt(5)
  ds_read_b128 v[232:235], v254 offset:61440
  v_and_b32 v86, s54, v86
  v_mfma_f32_16x16x32_bf16 v[172:175], v[204:207], v[16:19], 0
  ds_read_b128 v[228:231], v254 offset:56320
  v_cvt_pk_bf16_f32 v132, v184, v185
  v_mfma_f32_16x16x32_bf16 v[180:183], v[204:207], v[40:43], 0
  s_waitcnt lgkmcnt(6)
  ds_read_b128 v[236:239], v254 offset:62464
  v_cvt_pk_bf16_f32 v133, v186, v187
  v_mfma_f32_16x16x32_bf16 v[168:171], v[208:211], v[20:23], v[168:171]
  ds_read_b128 v[200:203], v254 offset:57344
  v_cvt_pk_bf16_f32 v134, v188, v189
  v_mfma_f32_16x16x32_bf16 v[176:179], v[208:211], v[44:47], v[176:179]
  s_waitcnt lgkmcnt(7)
  v_cvt_pk_bf16_f32 v135, v190, v191
  v_cvt_pk_bf16_f32 v156, v192, v193
  v_mfma_f32_16x16x32_bf16 v[172:175], v[212:215], v[20:23], v[172:175]
  ds_read_b128 v[204:207], v254 offset:58368
  v_cvt_pk_bf16_f32 v157, v194, v195
  v_mfma_f32_16x16x32_bf16 v[180:183], v[212:215], v[44:47], v[180:183]
  s_waitcnt lgkmcnt(7)
  v_cvt_pk_bf16_f32 v158, v196, v197
  v_cvt_pk_bf16_f32 v159, v198, v199
  v_mfma_f32_16x16x32_bf16 v[168:171], v[216:219], v[24:27], v[168:171]
  ds_read_b128 v[208:211], v254 offset:59392
  v_and_b32 v114, s54, v114
  v_mfma_f32_16x16x32_bf16 v[176:179], v[216:219], v[48:51], v[176:179]
  s_waitcnt lgkmcnt(7)
  v_or_b32 v84, v85, v12
  v_or_b32 v112, v113, v12
  v_mfma_f32_16x16x32_bf16 v[172:175], v[220:223], v[24:27], v[172:175]
  ds_read_b128 v[212:215], v254 offset:60416
  v_or_b32 v87, v85, v13
  v_mfma_f32_16x16x32_bf16 v[180:183], v[220:223], v[48:51], v[180:183]
  s_waitcnt lgkmcnt(7)
  v_or_b32 v115, v113, v13
  v_bfe_i32 v90, v14, 12, 1
  v_mfma_f32_16x16x32_bf16 v[168:171], v[224:227], v[28:31], v[168:171]
  v_bfe_i32 v118, v15, 18, 1
  v_and_b32 v89, s54, v90
  v_mfma_f32_16x16x32_bf16 v[176:179], v[224:227], v[52:55], v[176:179]
  s_waitcnt lgkmcnt(5)
  v_and_b32 v117, s54, v118
  v_and_b32 v90, s54, v90
  v_mfma_f32_16x16x32_bf16 v[172:175], v[228:231], v[28:31], v[172:175]
  v_and_b32 v118, s54, v118
  v_or_b32 v88, v89, v12
  v_mfma_f32_16x16x32_bf16 v[180:183], v[228:231], v[52:55], v[180:183]
  s_waitcnt lgkmcnt(3)
  v_or_b32 v116, v117, v12
  v_or_b32 v91, v89, v13
  v_mfma_f32_16x16x32_bf16 v[168:171], v[200:203], v[32:35], v[168:171]
  ds_read_b128 v[224:227], v253 offset:0
  v_or_b32 v119, v117, v13
  v_mfma_f32_16x16x32_bf16 v[176:179], v[200:203], v[56:59], v[176:179]
  s_waitcnt lgkmcnt(3)
  v_mfma_f32_16x16x32_bf16 v[172:175], v[204:207], v[32:35], v[172:175]
  ds_read_b128 v[228:231], v253 offset:1024
  v_mfma_f32_16x16x32_bf16 v[180:183], v[204:207], v[56:59], v[180:183]
  s_waitcnt lgkmcnt(3)
  v_mfma_f32_16x16x32_bf16 v[168:171], v[208:211], v[36:39], v[168:171]
  ds_read_b128 v[200:203], v253 offset:2048
  v_mfma_f32_16x16x32_bf16 v[176:179], v[208:211], v[60:63], v[176:179]
  s_waitcnt lgkmcnt(3)
  v_mfma_f32_16x16x32_bf16 v[172:175], v[212:215], v[36:39], v[172:175]
  ds_read_b128 v[204:207], v253 offset:3072
  v_mfma_f32_16x16x32_bf16 v[180:183], v[212:215], v[60:63], v[180:183]
  s_waitcnt vmcnt(0)
  s_barrier
  s_setprio 2
  s_cmp_lt_u32 s40, 4
  s_cbranch_scc1 M_pr1
  s_setprio 3
M_pr1:
  v_mfma_f32_16x16x32_bf16 v[184:187], v[232:235], v[16:19], 0
  ds_read_b128 v[208:211], v253 offset:4096
  v_mfma_f32_16x16x32_bf16 v[192:195], v[232:235], v[40:43], 0
  v_mfma_f32_16x16x32_bf16 v[188:191], v[236:239], v[16:19], 0
  ds_read_b128 v[212:215], v253 offset:5120
  v_cvt_pk_bf16_f32 v136, v168, v169
  v_mfma_f32_16x16x32_bf16 v[196:199], v[236:239], v[40:43], 0
  s_waitcnt lgkmcnt(5)
  v_cvt_pk_bf16_f32 v137, v170, v171
  v_cvt_pk_bf16_f32 v138, v172, v173
  v_mfma_f32_16x16x32_bf16 v[184:187], v[224:227], v[20:23], v[184:187]
  ds_read_b128 v[216:219], v253 offset:6144
  v_cvt_pk_bf16_f32 v139, v174, v175
  v_mfma_f32_16x16x32_bf16 v[192:195], v[224:227], v[44:47], v[192:195]
  s_waitcnt lgkmcnt(5)
  v_cvt_pk_bf16_f32 v160, v176, v177
  v_cvt_pk_bf16_f32 v161, v178, v179
  v_mfma_f32_16x16x32_bf16 v[188:191], v[228:231], v[20:23], v[188:191]
  ds_read_b128 v[220:223], v253 offset:7168
  v_cvt_pk_bf16_f32 v162, v180, v181
  v_mfma_f32_16x16x32_bf16 v[196:199], v[228:231], v[44:47], v[196:199]
  s_waitcnt lgkmcnt(5)
  v_cvt_pk_bf16_f32 v163, v182, v183
  v_mfma_f32_16x16x32_bf16 v[184:187], v[200:203], v[24:27], v[184:187]
  ds_read_b128 v[224:227], v253 offset:8192
  v_mfma_f32_16x16x32_bf16 v[192:195], v[200:203], v[48:51], v[192:195]
  s_waitcnt lgkmcnt(5)
  v_mfma_f32_16x16x32_bf16 v[188:191], v[204:207], v[24:27], v[188:191]
  ds_read_b128 v[228:231], v253 offset:9216
  v_mfma_f32_16x16x32_bf16 v[196:199], v[204:207], v[48:51], v[196:199]
  s_waitcnt lgkmcnt(5)
  v_mfma_f32_16x16x32_bf16 v[184:187], v[208:211], v[28:31], v[184:187]
  v_mfma_f32_16x16x32_bf16 v[192:195], v[208:211], v[52:55], v[192:195]
  s_waitcnt lgkmcnt(4)
  v_mfma_f32_16x16x32_bf16 v[188:191], v[212:215], v[28:31], v[188:191]
  v_mfma_f32_16x16x32_bf16 v[196:199], v[212:215], v[52:55], v[196:199]
  s_waitcnt lgkmcnt(3)
  v_mfma_f32_16x16x32_bf16 v[184:187], v[216:219], v[32:35], v[184:187]
  v_mfma_f32_16x16x32_bf16 v[192:195], v[216:219], v[56:59], v[192:195]
  s_waitcnt lgkmcnt(2)
  v_mfma_f32_16x16x32_bf16 v[188:191], v[220:223], v[32:35], v[188:191]
  v_mfma_f32_16x16x32_bf16 v[196:199], v[220:223], v[56:59], v[196:199]
  s_waitcnt lgkmcnt(1)
  v_mfma_f32_16x16x32_bf16 v[184:187], v[224:227], v[36:39], v[184:187]
  v_mfma_f32_16x16x32_bf16 v[192:195], v[224:227], v[60:63], v[192:195]
  s_waitcnt lgkmcnt(0)
  v_mfma_f32_16x16x32_bf16 v[188:191], v[228:231], v[36:39], v[188:191]
  v_mfma_f32_16x16x32_bf16 v[196:199], v[228:231], v[60:63], v[196:199]
  s_cmp_ge_u32 s40, 4
  s_cbranch_scc1 M_l1
  s_barrier
M_l1:
  ds_read_b128 v[200:203], v240 offset:0
  ds_read_b128 v[204:207], v240 offset:2304
  ds_read_b128 v[208:211], v241 offset:0
  ds_read_b128 v[212:215], v241 offset:2304
  ds_read_b128 v[216:219], v242 offset:0
  ds_read_b128 v[220:223], v242 offset:2304
  ds_read_b128 v[224:227], v243 offset:0
  v_cvt_pk_bf16_f32 v140, v184, v185
  v_cvt_pk_bf16_f32 v141, v186, v187
  v_cvt_pk_bf16_f32 v142, v188, v189
  v_cvt_pk_bf16_f32 v143, v190, v191
  v_cvt_pk_bf16_f32 v164, v192, v193
  v_cvt_pk_bf16_f32 v165, v194, v195
  v_cvt_pk_bf16_f32 v166, v196, v197
  v_cvt_pk_bf16_f32 v167, v198, v199
  s_waitcnt lgkmcnt(6)
  v_mfma_f32_16x16x32_bf16 v[64:67], v[200:203], v[120:123], v[64:67]
  s_waitcnt lgkmcnt(5)
  ds_read_b128 v[228:231], v243 offset:2304
  v_mfma_f32_16x16x32_bf16 v[76:79], v[204:207], v[120:123], v[76:79]
  v_mfma_f32_16x16x32_bf16 v[92:95], v[204:207], v[144:147], v[92:95]
  s_waitcnt lgkmcnt(5)
  ds_read_b128 v[200:203], v240 offset:256
  v_mfma_f32_16x16x32_bf16 v[64:67], v[208:211], v[124:127], v[64:67]
  s_waitcnt lgkmcnt(5)
  ds_read_b128 v[204:207], v240 offset:2560
  v_mfma_f32_16x16x32_bf16 v[76:79], v[212:215], v[124:127], v[76:79]
  v_mfma_f32_16x16x32_bf16 v[92:95], v[212:215], v[148:151], v[92:95]
  s_waitcnt lgkmcnt(5)
  ds_read_b128 v[208:211], v241 offset:256
  v_mfma_f32_16x16x32_bf16 v[64:67], v[216:219], v[128:131], v[64:67]
  s_waitcnt lgkmcnt(5)
  ds_read_b128 v[212:215], v241 offset:2560
  v_mfma_f32_16x16x32_bf16 v[76:79], v[220:223], v[128:131], v[76:79]
  v_mfma_f32_16x16x32_bf16 v[92:95], v[220:223], v[152:155], v[92:95]
  s_waitcnt lgkmcnt(5)
  ds_read_b128 v[216:219], v240 offset:768
  v_mfma_f32_16x16x32_bf16 v[64:67], v[224:227], v[132:135], v[64:67]
  s_waitcnt lgkmcnt(5)
  ds_read_b128 v[220:223], v240 offset:3072
  v_mfma_f32_16x16x32_bf16 v[76:79], v[228:231], v[132:135], v[76:79]
  v_mfma_f32_16x16x32_bf16 v[92:95], v[228:231], v[156:159], v[92:95]
  s_waitcnt lgkmcnt(5)
  ds_read_b128 v[224:227], v241 offset:768
  v_mfma_f32_16x16x32_bf16 v[64:67], v[200:203], v[136:139], v[64:67]
  s_waitcnt lgkmcnt(5)
  ds_read_b128 v[228:231], v241 offset:3072
  v_mfma_f32_16x16x32_bf16 v[76:79], v[204:207], v[136:139], v[76:79]
  v_mfma_f32_16x16x32_bf16 v[92:95], v[204:207], v[160:163], v[92:95]
  s_waitcnt lgkmcnt(5)
  ds_read_b128 v[200:203], v242 offset:768
  v_mfma_f32_16x16x32_bf16 v[64:67], v[208:211], v[140:143], v[64:67]
  s_waitcnt lgkmcnt(5)
  ds_read_b128 v[204:207], v242 offset:3072
  v_mfma_f32_16x16x32_bf16 v[76:79], v[212:215], v[140:143], v[76:79]
  v_mfma_f32_16x16x32_bf16 v[92:95], v[212:215], v[164:167], v[92:95]
  s_waitcnt lgkmcnt(5)
  ds_read_b128 v[208:211], v243 offset:768
  v_mfma_f32_16x16x32_bf16 v[68:71], v[216:219], v[120:123], v[68:71]
  s_waitcnt lgkmcnt(5)
  ds_read_b128 v[212:215], v243 offset:3072
  v_mfma_f32_16x16x32_bf16 v[80:83], v[220:223], v[120:123], v[80:83]
  v_mfma_f32_16x16x32_bf16 v[96:99], v[220:223], v[144:147], v[96:99]
  s_waitcnt lgkmcnt(5)
  ds_read_b128 v[216:219], v240 offset:1024
  v_mfma_f32_16x16x32_bf16 v[68:71], v[224:227], v[124:127], v[68:71]
  s_waitcnt lgkmcnt(5)
  ds_read_b128 v[220:223], v240 offset:3328
  v_mfma_f32_16x16x32_bf16 v[80:83], v[228:231], v[124:127], v[80:83]
  v_mfma_f32_16x16x32_bf16 v[96:99], v[228:231], v[148:151], v[96:99]
  s_waitcnt lgkmcnt(5)
  ds_read_b128 v[224:227], v241 offset:1024
  v_mfma_f32_16x16x32_bf16 v[68:71], v[200:203], v[128:131], v[68:71]
  s_waitcnt lgkmcnt(5)
  ds_read_b128 v[228:231], v241 offset:3328
  v_mfma_f32_16x16x32_bf16 v[80:83], v[204:207], v[128:131], v[80:83]
  v_mfma_f32_16x16x32_bf16 v[96:99], v[204:207], v[152:155], v[96:99]
  s_waitcnt lgkmcnt(5)
  ds_read_b128 v[200:203], v240 offset:1536
  v_mfma_f32_16x16x32_bf16 v[68:71], v[208:211], v[132:135], v[68:71]
  s_waitcnt lgkmcnt(5)
  ds_read_b128 v[204:207], v240 offset:3840
  v_mfma_f32_16x16x32_bf16 v[80:83], v[212:215], v[132:135], v[80:83]
  v_mfma_f32_16x16x32_bf16 v[96:99], v[212:215], v[156:159], v[96:99]
  s_waitcnt lgkmcnt(5)
  ds_read_b128 v[208:211], v241 offset:1536
  v_mfma_f32_16x16x32_bf16 v[68:71], v[216:219], v[136:139], v[68:71]
  s_waitcnt lgkmcnt(5)
  ds_read_b128 v[212:215], v241 offset:3840
  v_mfma_f32_16x16x32_bf16 v[80:83], v[220:223], v[136:139], v[80:83]
  v_mfma_f32_16x16x32_bf16 v[96:99], v[220:223], v[160:163], v[96:99]
  s_waitcnt lgkmcnt(5)
  ds_read_b128 v[216:219], v242 offset:1536
  v_mfma_f32_16x16x32_bf16 v[68:71], v[224:227], v[140:143], v[68:71]
  s_waitcnt lgkmcnt(5)
  ds_read_b128 v[220:223], v242 offset:3840
  v_mfma_f32_16x16x32_bf16 v[80:83], v[228:231], v[140:143], v[80:83]
  v_mfma_f32_16x16x32_bf16 v[96:99], v[228:231], v[164:167], v[96:99]
  s_waitcnt lgkmcnt(5)
  ds_read_b128 v[224:227], v243 offset:1536
  v_mfma_f32_16x16x32_bf16 v[72:75], v[200:203], v[120:123], v[72:75]
  s_waitcnt lgkmcnt(5)
  ds_read_b128 v[228:231], v243 offset:3840
  v_mfma_f32_16x16x32_bf16 v[84:87], v[204:207], v[120:123], v[84:87]
  v_mfma_f32_16x16x32_bf16 v[100:103], v[204:207], v[144:147], v[100:103]
  s_waitcnt lgkmcnt(5)
  ds_read_b128 v[200:203], v240 offset:1792
  v_mfma_f32_16x16x32_bf16 v[72:75], v[208:211], v[124:127], v[72:75]
  s_waitcnt lgkmcnt(5)
  ds_read_b128 v[204:207], v240 offset:4096
  v_mfma_f32_16x16x32_bf16 v[84:87], v[212:215], v[124:127], v[84:87]
  v_mfma_f32_16x16x32_bf16 v[100:103], v[212:215], v[148:151], v[100:103]
  s_waitcnt lgkmcnt(5)
  ds_read_b128 v[208:211], v241 offset:1792
  v_mfma_f32_16x16x32_bf16 v[72:75], v[216:219], v[128:131], v[72:75]
  s_waitcnt lgkmcnt(5)
  ds_read_b128 v[212:215], v241 offset:4096
  v_mfma_f32_16x16x32_bf16 v[84:87], v[220:223], v[128:131], v[84:87]
  v_mfma_f32_16x16x32_bf16 v[100:103], v[220:223], v[152:155], v[100:103]
  s_waitcnt lgkmcnt(5)
  ds_read_b128 v[216:219], v240 offset:5376
  v_mfma_f32_16x16x32_bf16 v[72:75], v[224:227], v[132:135], v[72:75]
  s_waitcnt lgkmcnt(5)
  ds_read_b128 v[220:223], v240 offset:4608
  v_mfma_f32_16x16x32_bf16 v[84:87], v[228:231], v[132:135], v[84:87]
  v_mfma_f32_16x16x32_bf16 v[100:103], v[228:231], v[156:159], v[100:103]
  s_waitcnt lgkmcnt(5)
  ds_read_b128 v[224:227], v241 offset:5376
  v_mfma_f32_16x16x32_bf16 v[72:75], v[200:203], v[136:139], v[72:75]
  s_waitcnt lgkmcnt(5)
  ds_read_b128 v[228:231], v241 offset:4608
  v_mfma_f32_16x16x32_bf16 v[84:87], v[204:207], v[136:139], v[84:87]
  v_mfma_f32_16x16x32_bf16 v[100:103], v[204:207], v[160:163], v[100:103]
  s_waitcnt lgkmcnt(5)
  ds_read_b128 v[200:203], v242 offset:5376
  v_mfma_f32_16x16x32_bf16 v[72:75], v[208:211], v[140:143], v[72:75]
  s_waitcnt lgkmcnt(5)
  ds_read_b128 v[204:207], v242 offset:4608
  v_mfma_f32_16x16x32_bf16 v[84:87], v[212:215], v[140:143], v[84:87]
  v_mfma_f32_16x16x32_bf16 v[100:103], v[212:215], v[164:167], v[100:103]
  s_waitcnt lgkmcnt(5)
  ds_read_b128 v[208:211], v243 offset:5376
  v_mfma_f32_16x16x32_bf16 v[108:111], v[216:219], v[144:147], v[108:111]
  s_waitcnt lgkmcnt(5)
  ds_read_b128 v[212:215], v243 offset:4608
  v_mfma_f32_16x16x32_bf16 v[88:91], v[220:223], v[120:123], v[88:91]
  v_mfma_f32_16x16x32_bf16 v[104:107], v[220:223], v[144:147], v[104:107]
  s_waitcnt lgkmcnt(5)
  ds_read_b128 v[216:219], v240 offset:5632
  v_mfma_f32_16x16x32_bf16 v[108:111], v[224:227], v[148:151], v[108:111]
  s_waitcnt lgkmcnt(5)
  ds_read_b128 v[220:223], v240 offset:4864
  v_mfma_f32_16x16x32_bf16 v[88:91], v[228:231], v[124:127], v[88:91]
  v_mfma_f32_16x16x32_bf16 v[104:107], v[228:231], v[148:151], v[104:107]
  s_waitcnt lgkmcnt(5)
  ds_read_b128 v[224:227], v241 offset:5632
  v_mfma_f32_16x16x32_bf16 v[108:111], v[200:203], v[152:155], v[108:111]
  s_waitcnt lgkmcnt(5)
  ds_read_b128 v[228:231], v241 offset:4864
  v_mfma_f32_16x16x32_bf16 v[88:91], v[204:207], v[128:131], v[88:91]
  v_mfma_f32_16x16x32_bf16 v[104:107], v[204:207], v[152:155], v[104:107]
  s_waitcnt lgkmcnt(5)
  ds_read_b128 v[200:203], v240 offset:6144
  v_mfma_f32_16x16x32_bf16 v[108:111], v[208:211], v[156:159], v[108:111]
  s_waitcnt lgkmcnt(5)
  ds_read_b128 v[204:207], v240 offset:6912
  v_mfma_f32_16x16x32_bf16 v[88:91], v[212:215], v[132:135], v[88:91]
  v_mfma_f32_16x16x32_bf16 v[104:107], v[212:215], v[156:159], v[104:107]
  s_waitcnt lgkmcnt(5)
  ds_read_b128 v[208:211], v241 offset:6144
  v_mfma_f32_16x16x32_bf16 v[108:111], v[216:219], v[160:163], v[108:111]
  s_waitcnt lgkmcnt(5)
  ds_read_b128 v[212:215], v241 offset:6912
  v_mfma_f32_16x16x32_bf16 v[88:91], v[220:223], v[136:139], v[88:91]
  v_mfma_f32_16x16x32_bf16 v[104:107], v[220:223], v[160:163], v[104:107]
  s_waitcnt lgkmcnt(5)
  ds_read_b128 v[216:219], v242 offset:6144
  v_mfma_f32_16x16x32_bf16 v[108:111], v[224:227], v[164:167], v[108:111]
  s_waitcnt lgkmcnt(5)
  ds_read_b128 v[220:223], v242 offset:6912
  v_mfma_f32_16x16x32_bf16 v[88:91], v[228:231], v[140:143], v[88:91]
  v_mfma_f32_16x16x32_bf16 v[104:107], v[228:231], v[164:167], v[104:107]
  s_waitcnt lgkmcnt(5)
  ds_read_b128 v[224:227], v243 offset:6144
  v_mfma_f32_16x16x32_bf16 v[112:115], v[200:203], v[144:147], v[112:115]
  s_waitcnt lgkmcnt(5)
  ds_read_b128 v[228:231], v243 offset:6912
  v_mfma_f32_16x16x32_bf16 v[116:119], v[204:207], v[144:147], v[116:119]
  s_waitcnt lgkmcnt(5)
  ds_read_b128 v[200:203], v240 offset:6400
  v_mfma_f32_16x16x32_bf16 v[112:115], v[208:211], v[148:151], v[112:115]
  s_waitcnt lgkmcnt(5)
  ds_read_b128 v[204:207], v240 offset:7168
  v_mfma_f32_16x16x32_bf16 v[116:119], v[212:215], v[148:151], v[116:119]
  s_waitcnt lgkmcnt(5)
  ds_read_b128 v[208:211], v241 offset:6400
  v_mfma_f32_16x16x32_bf16 v[112:115], v[216:219], v[152:155], v[112:115]
  s_waitcnt lgkmcnt(5)
  ds_read_b128 v[212:215], v241 offset:7168
  v_mfma_f32_16x16x32_bf16 v[116:119], v[220:223], v[152:155], v[116:119]
  s_waitcnt lgkmcnt(5)
  v_mfma_f32_16x16x32_bf16 v[112:115], v[224:227], v[156:159], v[112:115]
  s_waitcnt lgkmcnt(4)
  v_mfma_f32_16x16x32_bf16 v[116:119], v[228:231], v[156:159], v[116:119]
  s_waitcnt lgkmcnt(3)
  v_mfma_f32_16x16x32_bf16 v[112:115], v[200:203], v[160:163], v[112:115]
  s_waitcnt lgkmcnt(2)
  v_mfma_f32_16x16x32_bf16 v[116:119], v[204:207], v[160:163], v[116:119]
  s_waitcnt lgkmcnt(1)
  v_mfma_f32_16x16x32_bf16 v[112:115], v[208:211], v[164:167], v[112:115]
  s_waitcnt lgkmcnt(0)
  v_mfma_f32_16x16x32_bf16 v[116:119], v[212:215], v[164:167], v[116:119]
  s_setprio 0
  s_cmp_lt_u32 s40, 4
  s_cbranch_scc1 M_pr2
  s_setprio 1
M_pr2:
  v_mov_b32 v30, 0
  v_mov_b32 v31, 0
  v_mov_b32 v32, 0
  v_mov_b32 v33, 0
  v_max3_f32 v12, v64, v65, v66
  v_max3_f32 v14, v67, v68, v69
  v_max3_f32 v13, v92, v93, v94
  v_max3_f32 v15, v95, v96, v97
  v_max3_f32 v12, v12, v70, v71
  v_max3_f32 v14, v14, v72, v73
  v_max3_f32 v13, v13, v98, v99
  v_max3_f32 v15, v15, v100, v101
  v_max3_f32 v12, v12, v74, v75
  v_max3_f32 v14, v14, v76, v77
  v_max3_f32 v13, v13, v102, v103
  v_max3_f32 v15, v15, v104, v105
  v_max3_f32 v12, v12, v78, v79
  v_max3_f32 v14, v14, v80, v81
  v_max3_f32 v13, v13, v106, v107
  v_max3_f32 v15, v15, v108, v109
  v_max3_f32 v12, v12, v82, v83
  v_max3_f32 v14, v14, v84, v85
  v_max3_f32 v13, v13, v110, v111
  v_max3_f32 v15, v15, v112, v113
  v_max3_f32 v12, v12, v86, v87
  v_max3_f32 v14, v14, v88, v89
  v_max3_f32 v13, v13, v114, v115
  v_max3_f32 v15, v15, v116, v117
  v_max3_f32 v12, v12, v90, v91
  v_max3_f32 v13, v13, v118, v119
  s_mov_b32 s56, 0xff7fffff
  v_max3_f32 v12, v12, v14, s56
  v_max3_f32 v13, v13, v15, s56
  v_mov_b32 v14, v12
  v_mov_b32 v15, v13
  s_nop 0
  v_permlane32_swap_b32 v12, v14
  v_permlane32_swap_b32 v13, v15
  v_max_f32 v12, v12, v14
  v_max_f32 v13, v13, v15
  v_mov_b32 v14, v12
  v_mov_b32 v15, v13
  s_nop 0
  v_permlane16_swap_b32 v12, v14
  v_permlane16_swap_b32 v13, v15
  v_max_f32 v12, v12, v14
  v_max_f32 v13, v13, v15
  v_mul_f32 v12, s63, v12
  v_mul_f32 v13, s63, v13
  s_cmp_lt_u32 s40, 4
  s_cbranch_scc1 M_e2
  s_barrier
M_e2:
  v_fma_f32 v64, v64, s63, -v12
  v_fma_f32 v65, v65, s63, -v12
  v_fma_f32 v66, v66, s63, -v12
  v_fma_f32 v67, v67, s63, -v12
  v_exp_f32 v64, v64
  v_exp_f32 v65, v65
  v_exp_f32 v66, v66
  v_exp_f32 v67, v67
  v_fma_f32 v92, v92, s63, -v13
  v_fma_f32 v93, v93, s63, -v13
  v_fma_f32 v94, v94, s63, -v13
  v_fma_f32 v95, v95, s63, -v13
  v_exp_f32 v92, v92
  v_exp_f32 v93, v93
  v_exp_f32 v94, v94
  v_exp_f32 v95, v95
  v_cvt_pk_bf16_f32 v16, v64, v65
  v_cvt_pk_bf16_f32 v17, v66, v67
  v_cvt_pk_bf16_f32 v34, v92, v93
  v_cvt_pk_bf16_f32 v35, v94, v95
  s_mov_b32 s55, 10240
  buffer_load_dwordx4 v[64:67], v252, s[24:27], s55 offen offset:0 sc1
  buffer_load_dwordx4 v[92:95], v252, s[24:27], s55 offen offset:1024 sc1
  v_fma_f32 v68, v68, s63, -v12
  v_fma_f32 v69, v69, s63, -v12
  v_fma_f32 v70, v70, s63, -v12
  v_fma_f32 v71, v71, s63, -v12
  v_exp_f32 v68, v68
  v_exp_f32 v69, v69
  v_exp_f32 v70, v70
  v_exp_f32 v71, v71
  v_fma_f32 v96, v96, s63, -v13
  v_fma_f32 v97, v97, s63, -v13
  v_fma_f32 v98, v98, s63, -v13
  v_fma_f32 v99, v99, s63, -v13
  v_exp_f32 v96, v96
  v_exp_f32 v97, v97
  v_exp_f32 v98, v98
  v_exp_f32 v99, v99
  v_cvt_pk_bf16_f32 v18, v68, v69
  v_cvt_pk_bf16_f32 v19, v70, v71
  v_cvt_pk_bf16_f32 v36, v96, v97
  v_cvt_pk_bf16_f32 v37, v98, v99
  buffer_load_dwordx4 v[68:71], v252, s[24:27], s55 offen offset:2048 sc1
  buffer_load_dwordx4 v[96:99], v252, s[24:27], s55 offen offset:3072 sc1
  v_fma_f32 v72, v72, s63, -v12
  v_fma_f32 v73, v73, s63, -v12
  v_fma_f32 v74, v74, s63, -v12
  v_fma_f32 v75, v75, s63, -v12
  v_exp_f32 v72, v72
  v_exp_f32 v73, v73
  v_exp_f32 v74, v74
  v_exp_f32 v75, v75
  v_fma_f32 v100, v100, s63, -v13
  v_fma_f32 v101, v101, s63, -v13
  v_fma_f32 v102, v102, s63, -v13
  v_fma_f32 v103, v103, s63, -v13
  v_exp_f32 v100, v100
  v_exp_f32 v101, v101
  v_exp_f32 v102, v102
  v_exp_f32 v103, v103
  v_cvt_pk_bf16_f32 v20, v72, v73
  v_cvt_pk_bf16_f32 v21, v74, v75
  v_cvt_pk_bf16_f32 v38, v100, v101
  v_cvt_pk_bf16_f32 v39, v102, v103
  s_mov_b32 s55, 14336
  buffer_load_dwordx4 v[72:75], v252, s[24:27], s55 offen offset:0 sc1
  buffer_load_dwordx4 v[100:103], v252, s[24:27], s55 offen offset:1024 sc1
  v_fma_f32 v76, v76, s63, -v12
  v_fma_f32 v77, v77, s63, -v12
  v_fma_f32 v78, v78, s63, -v12
  v_fma_f32 v79, v79, s63, -v12
  v_exp_f32 v76, v76
  v_exp_f32 v77, v77
  v_exp_f32 v78, v78
  v_exp_f32 v79, v79
  v_fma_f32 v104, v104, s63, -v13
  v_fma_f32 v105, v105, s63, -v13
  v_fma_f32 v106, v106, s63, -v13
  v_fma_f32 v107, v107, s63, -v13
  v_exp_f32 v104, v104
  v_exp_f32 v105, v105
  v_exp_f32 v106, v106
  v_exp_f32 v107, v107
  v_cvt_pk_bf16_f32 v22, v76, v77
  v_cvt_pk_bf16_f32 v23, v78, v79
  v_cvt_pk_bf16_f32 v40, v104, v105
  v_cvt_pk_bf16_f32 v41, v106, v107
  buffer_load_dwordx4 v[76:79], v252, s[24:27], s55 offen offset:2048 sc1
  buffer_load_dwordx4 v[104:107], v252, s[24:27], s55 offen offset:3072 sc1
  v_fma_f32 v80, v80, s63, -v12
  v_fma_f32 v81, v81, s63, -v12
  v_fma_f32 v82, v82, s63, -v12
  v_fma_f32 v83, v83, s63, -v12
  v_exp_f32 v80, v80
  v_exp_f32 v81, v81
  v_exp_f32 v82, v82
  v_exp_f32 v83, v83
  v_fma_f32 v108, v108, s63, -v13
  v_fma_f32 v109, v109, s63, -v13
  v_fma_f32 v110, v110, s63, -v13
  v_fma_f32 v111, v111, s63, -v13
  v_exp_f32 v108, v108
  v_exp_f32 v109, v109
  v_exp_f32 v110, v110
  v_exp_f32 v111, v111
  v_cvt_pk_bf16_f32 v24, v80, v81
  v_cvt_pk_bf16_f32 v25, v82, v83
  v_cvt_pk_bf16_f32 v42, v108, v109
  v_cvt_pk_bf16_f32 v43, v110, v111
  s_mov_b32 s55, 18432
  buffer_load_dwordx4 v[80:83], v252, s[24:27], s55 offen offset:0 sc1
  buffer_load_dwordx4 v[108:111], v252, s[24:27], s55 offen offset:1024 sc1
  v_fma_f32 v84, v84, s63, -v12
  v_fma_f32 v85, v85, s63, -v12
  v_fma_f32 v86, v86, s63, -v12
  v_fma_f32 v87, v87, s63, -v12
  v_exp_f32 v84, v84
  v_exp_f32 v85, v85
  v_exp_f32 v86, v86
  v_exp_f32 v87, v87
  v_fma_f32 v112, v112, s63, -v13
  v_fma_f32 v113, v113, s63, -v13
  v_fma_f32 v114, v114, s63, -v13
  v_fma_f32 v115, v115, s63, -v13
  v_exp_f32 v112, v112
  v_exp_f32 v113, v113
  v_exp_f32 v114, v114
  v_exp_f32 v115, v115
  v_cvt_pk_bf16_f32 v26, v84, v85
  v_cvt_pk_bf16_f32 v27, v86, v87
  v_cvt_pk_bf16_f32 v44, v112, v113
  v_cvt_pk_bf16_f32 v45, v114, v115
  buffer_load_dwordx4 v[84:87], v252, s[24:27], s55 offen offset:2048 sc1
  buffer_load_dwordx4 v[112:115], v252, s[24:27], s55 offen offset:3072 sc1
  ds_read_b64_tr_b16 v[200:201], v244 offset:0
  ds_read_b64_tr_b16 v[202:203], v244 offset:768
  ds_read_b64_tr_b16 v[204:205], v245 offset:0
  ds_read_b64_tr_b16 v[206:207], v245 offset:768
  ds_read_b64_tr_b16 v[208:209], v244 offset:1536
  ds_read_b64_tr_b16 v[210:211], v244 offset:2304
  ds_read_b64_tr_b16 v[212:213], v245 offset:1536
  ds_read_b64_tr_b16 v[214:215], v245 offset:2304
  ds_read_b64_tr_b16 v[216:217], v244 offset:3072
  ds_read_b64_tr_b16 v[218:219], v244 offset:3840
  ds_read_b64_tr_b16 v[220:221], v245 offset:3072
  ds_read_b64_tr_b16 v[222:223], v245 offset:3840
  s_cmp_ge_u32 s40, 4
  s_cbranch_scc1 M_l2
  s_barrier
M_l2:
  v_fma_f32 v88, v88, s63, -v12
  v_fma_f32 v89, v89, s63, -v12
  v_fma_f32 v90, v90, s63, -v12
  v_fma_f32 v91, v91, s63, -v12
  v_exp_f32 v88, v88
  v_exp_f32 v89, v89
  v_exp_f32 v90, v90
  v_exp_f32 v91, v91
  v_fma_f32 v116, v116, s63, -v13
  v_fma_f32 v117, v117, s63, -v13
  v_fma_f32 v118, v118, s63, -v13
  v_fma_f32 v119, v119, s63, -v13
  v_exp_f32 v116, v116
  v_exp_f32 v117, v117
  v_exp_f32 v118, v118
  v_exp_f32 v119, v119
  v_cvt_pk_bf16_f32 v28, v88, v89
  v_cvt_pk_bf16_f32 v29, v90, v91
  v_cvt_pk_bf16_f32 v46, v116, v117
  v_cvt_pk_bf16_f32 v47, v118, v119
  s_mov_b32 s55, 22528
  buffer_load_dwordx4 v[88:91], v252, s[24:27], s55 offen offset:0 sc1
  buffer_load_dwordx4 v[116:119], v252, s[24:27], s55 offen offset:1024 sc1
  v_mov_b32 v48, 0x3f803f80
  v_mov_b32 v49, 0x3f803f80
  v_mov_b32 v50, 0x3f803f80
  v_mov_b32 v51, 0x3f803f80
  s_setprio 2
  s_cmp_lt_u32 s40, 4
  s_cbranch_scc1 M_pr3
  s_setprio 3
M_pr3:
  s_waitcnt lgkmcnt(10)
  v_mfma_f32_16x16x32_bf16 v[168:171], v[200:203], v[16:19], 0
  s_waitcnt lgkmcnt(8)
  ds_read_b64_tr_b16 v[224:225], v244 offset:4608
  ds_read_b64_tr_b16 v[226:227], v244 offset:5376
  v_mfma_f32_16x16x32_bf16 v[172:175], v[204:207], v[16:19], 0
  s_waitcnt lgkmcnt(8)
  ds_read_b64_tr_b16 v[228:229], v245 offset:4608
  v_mfma_f32_16x16x32_bf16 v[168:171], v[208:211], v[20:23], v[168:171]
  ds_read_b64_tr_b16 v[230:231], v245 offset:5376
  v_mfma_f32_16x16x32_bf16 v[176:179], v[208:211], v[32:35], 0
  s_waitcnt lgkmcnt(8)
  ds_read_b64_tr_b16 v[200:201], v244 offset:6144
  v_mfma_f32_16x16x32_bf16 v[172:175], v[212:215], v[20:23], v[172:175]
  ds_read_b64_tr_b16 v[202:203], v244 offset:6912
  v_mfma_f32_16x16x32_bf16 v[180:183], v[212:215], v[32:35], 0
  s_waitcnt lgkmcnt(8)
  ds_read_b64_tr_b16 v[204:205], v245 offset:6144
  v_mfma_f32_16x16x32_bf16 v[168:171], v[216:219], v[24:27], v[168:171]
  ds_read_b64_tr_b16 v[206:207], v245 offset:6912
  v_mfma_f32_16x16x32_bf16 v[176:179], v[216:219], v[36:39], v[176:179]
  s_waitcnt lgkmcnt(8)
  ds_read_b64_tr_b16 v[208:209], v246 offset:0
  v_mfma_f32_16x16x32_bf16 v[172:175], v[220:223], v[24:27], v[172:175]
  ds_read_b64_tr_b16 v[210:211], v246 offset:768
  v_mfma_f32_16x16x32_bf16 v[180:183], v[220:223], v[36:39], v[180:183]
  s_waitcnt lgkmcnt(8)
  ds_read_b64_tr_b16 v[212:213], v247 offset:0
  ds_read_b64_tr_b16 v[214:215], v247 offset:768
  v_mfma_f32_16x16x32_bf16 v[168:171], v[224:227], v[28:31], v[168:171]
  ds_read_b64_tr_b16 v[216:217], v246 offset:1536
  v_mfma_f32_16x16x32_bf16 v[176:179], v[224:227], v[40:43], v[176:179]
  s_waitcnt lgkmcnt(9)
  ds_read_b64_tr_b16 v[218:219], v246 offset:2304
  v_mfma_f32_16x16x32_bf16 v[172:175], v[228:231], v[28:31], v[172:175]
  ds_read_b64_tr_b16 v[220:221], v247 offset:1536
  v_mfma_f32_16x16x32_bf16 v[180:183], v[228:231], v[40:43], v[180:183]
  s_waitcnt lgkmcnt(9)
  ds_read_b64_tr_b16 v[222:223], v247 offset:2304
  v_mfma_f32_16x16x32_bf16 v[176:179], v[200:203], v[44:47], v[176:179]
  s_waitcnt lgkmcnt(8)
  ds_read_b64_tr_b16 v[224:225], v246 offset:3072
  v_mfma_f32_16x16x32_bf16 v[180:183], v[204:207], v[44:47], v[180:183]
  ds_read_b64_tr_b16 v[226:227], v246 offset:3840
  s_cmp_ge_u32 s40, 4
  s_cbranch_scc1 M_l3
  s_barrier
M_l3:
  s_waitcnt lgkmcnt(8)
  v_mfma_f32_16x16x32_bf16 v[184:187], v[208:211], v[16:19], 0
  s_waitcnt lgkmcnt(6)
  ds_read_b64_tr_b16 v[228:229], v247 offset:3072
  v_mfma_f32_16x16x32_bf16 v[188:191], v[212:215], v[16:19], 0
  ds_read_b64_tr_b16 v[230:231], v247 offset:3840
  v_mfma_f32_16x16x32_bf16 v[56:59], v[16:19], v[48:51], 0
  s_waitcnt lgkmcnt(6)
  ds_read_b64_tr_b16 v[200:201], v246 offset:4608
  v_mfma_f32_16x16x32_bf16 v[184:187], v[216:219], v[20:23], v[184:187]
  ds_read_b64_tr_b16 v[202:203], v246 offset:5376
  ds_read_b64_tr_b16 v[204:205], v247 offset:4608
  v_mfma_f32_16x16x32_bf16 v[192:195], v[216:219], v[32:35], 0
  s_waitcnt lgkmcnt(7)
  ds_read_b64_tr_b16 v[206:207], v247 offset:5376
  v_cvt_pk_bf16_f32 v120, v168, v169
  v_mfma_f32_16x16x32_bf16 v[188:191], v[220:223], v[20:23], v[188:191]
  ds_read_b64_tr_b16 v[208:209], v246 offset:6144
  v_cvt_pk_bf16_f32 v121, v170, v171
  v_mfma_f32_16x16x32_bf16 v[196:199], v[220:223], v[32:35], 0
  s_waitcnt lgkmcnt(7)
  ds_read_b64_tr_b16 v[210:211], v246 offset:6912
  v_cvt_pk_bf16_f32 v122, v172, v173
  v_mfma_f32_16x16x32_bf16 v[184:187], v[224:227], v[24:27], v[184:187]
  ds_read_b64_tr_b16 v[212:213], v247 offset:6144
  v_cvt_pk_bf16_f32 v123, v174, v175
  v_mfma_f32_16x16x32_bf16 v[192:195], v[224:227], v[36:39], v[192:195]
  s_waitcnt lgkmcnt(7)
  ds_read_b64_tr_b16 v[214:215], v247 offset:6912
  v_cvt_pk_bf16_f32 v144, v176, v177
  v_mfma_f32_16x16x32_bf16 v[188:191], v[228:231], v[24:27], v[188:191]
  ds_read_b64_tr_b16 v[216:217], v248 offset:0
  v_cvt_pk_bf16_f32 v145, v178, v179
  v_mfma_f32_16x16x32_bf16 v[196:199], v[228:231], v[36:39], v[196:199]
  s_waitcnt lgkmcnt(7)
  ds_read_b64_tr_b16 v[218:219], v248 offset:768
  v_cvt_pk_bf16_f32 v146, v180, v181
  v_mfma_f32_16x16x32_bf16 v[184:187], v[200:203], v[28:31], v[184:187]
  ds_read_b64_tr_b16 v[220:221], v249 offset:0
  v_cvt_pk_bf16_f32 v147, v182, v183
  v_mfma_f32_16x16x32_bf16 v[192:195], v[200:203], v[40:43], v[192:195]
  s_waitcnt lgkmcnt(7)
  ds_read_b64_tr_b16 v[222:223], v249 offset:768
  v_mfma_f32_16x16x32_bf16 v[188:191], v[204:207], v[28:31], v[188:191]
  ds_read_b64_tr_b16 v[224:225], v248 offset:1536
  ds_read_b64_tr_b16 v[226:227], v248 offset:2304
  v_mfma_f32_16x16x32_bf16 v[196:199], v[204:207], v[40:43], v[196:199]
  s_waitcnt lgkmcnt(8)
  ds_read_b64_tr_b16 v[228:229], v249 offset:1536
  v_mfma_f32_16x16x32_bf16 v[192:195], v[208:211], v[44:47], v[192:195]
  s_waitcnt lgkmcnt(7)
  ds_read_b64_tr_b16 v[230:231], v249 offset:2304
  v_mfma_f32_16x16x32_bf16 v[196:199], v[212:215], v[44:47], v[196:199]
  ds_read_b64_tr_b16 v[200:201], v248 offset:3072
  v_mfma_f32_16x16x32_bf16 v[60:63], v[32:35], v[48:51], 0
  s_waitcnt lgkmcnt(7)
  ds_read_b64_tr_b16 v[202:203], v248 offset:3840
  v_mfma_f32_16x16x32_bf16 v[168:171], v[216:219], v[16:19], 0
  s_waitcnt lgkmcnt(6)
  ds_read_b64_tr_b16 v[204:205], v249 offset:3072
  v_mfma_f32_16x16x32_bf16 v[172:175], v[220:223], v[16:19], 0
  ds_read_b64_tr_b16 v[206:207], v249 offset:3840
  v_mfma_f32_16x16x32_bf16 v[56:59], v[20:23], v[48:51], v[56:59]
  s_waitcnt lgkmcnt(6)
  ds_read_b64_tr_b16 v[208:209], v248 offset:4608
  v_mfma_f32_16x16x32_bf16 v[168:171], v[224:227], v[20:23], v[168:171]
  ds_read_b64_tr_b16 v[210:211], v248 offset:5376
  v_cvt_pk_bf16_f32 v124, v184, v185
  v_mfma_f32_16x16x32_bf16 v[176:179], v[224:227], v[32:35], 0
  s_waitcnt lgkmcnt(6)
  ds_read_b64_tr_b16 v[212:213], v249 offset:4608
  v_cvt_pk_bf16_f32 v125, v186, v187
  v_mfma_f32_16x16x32_bf16 v[172:175], v[228:231], v[20:23], v[172:175]
  ds_read_b64_tr_b16 v[214:215], v249 offset:5376
  ds_read_b64_tr_b16 v[216:217], v248 offset:6144
  v_mfma_f32_16x16x32_bf16 v[180:183], v[228:231], v[32:35], 0
  s_waitcnt lgkmcnt(7)
  ds_read_b64_tr_b16 v[218:219], v248 offset:6912
  v_cvt_pk_bf16_f32 v126, v188, v189
  v_mfma_f32_16x16x32_bf16 v[168:171], v[200:203], v[24:27], v[168:171]
  ds_read_b64_tr_b16 v[220:221], v249 offset:6144
  v_cvt_pk_bf16_f32 v127, v190, v191
  v_mfma_f32_16x16x32_bf16 v[176:179], v[200:203], v[36:39], v[176:179]
  s_waitcnt lgkmcnt(7)
  ds_read_b64_tr_b16 v[222:223], v249 offset:6912
  v_cvt_pk_bf16_f32 v148, v192, v193
  v_mfma_f32_16x16x32_bf16 v[172:175], v[204:207], v[24:27], v[172:175]
  ds_read_b64_tr_b16 v[224:225], v250 offset:0
  v_cvt_pk_bf16_f32 v149, v194, v195
  v_mfma_f32_16x16x32_bf16 v[180:183], v[204:207], v[36:39], v[180:183]
  s_waitcnt lgkmcnt(7)
  ds_read_b64_tr_b16 v[226:227], v250 offset:768
  v_cvt_pk_bf16_f32 v150, v196, v197
  v_mfma_f32_16x16x32_bf16 v[168:171], v[208:211], v[28:31], v[168:171]
  ds_read_b64_tr_b16 v[228:229], v251 offset:0
  v_cvt_pk_bf16_f32 v151, v198, v199
  v_mfma_f32_16x16x32_bf16 v[176:179], v[208:211], v[40:43], v[176:179]
  s_waitcnt lgkmcnt(7)
  ds_read_b64_tr_b16 v[230:231], v251 offset:768
  v_mfma_f32_16x16x32_bf16 v[172:175], v[212:215], v[28:31], v[172:175]
  ds_read_b64_tr_b16 v[200:201], v250 offset:1536
  v_mfma_f32_16x16x32_bf16 v[180:183], v[212:215], v[40:43], v[180:183]
  s_waitcnt lgkmcnt(7)
  ds_read_b64_tr_b16 v[202:203], v250 offset:2304
  v_mfma_f32_16x16x32_bf16 v[176:179], v[216:219], v[44:47], v[176:179]
  s_waitcnt lgkmcnt(6)
  ds_read_b64_tr_b16 v[204:205], v251 offset:1536
  ds_read_b64_tr_b16 v[206:207], v251 offset:2304
  v_mfma_f32_16x16x32_bf16 v[180:183], v[220:223], v[44:47], v[180:183]
  ds_read_b64_tr_b16 v[208:209], v250 offset:3072
  v_mfma_f32_16x16x32_bf16 v[60:63], v[36:39], v[48:51], v[60:63]
  s_waitcnt lgkmcnt(7)
  ds_read_b64_tr_b16 v[210:211], v250 offset:3840
  v_mfma_f32_16x16x32_bf16 v[184:187], v[224:227], v[16:19], 0
  s_waitcnt lgkmcnt(6)
  ds_read_b64_tr_b16 v[212:213], v251 offset:3072
  v_mfma_f32_16x16x32_bf16 v[188:191], v[228:231], v[16:19], 0
  ds_read_b64_tr_b16 v[214:215], v251 offset:3840
  v_mfma_f32_16x16x32_bf16 v[56:59], v[24:27], v[48:51], v[56:59]
  s_waitcnt lgkmcnt(6)
  ds_read_b64_tr_b16 v[216:217], v250 offset:4608
  v_mfma_f32_16x16x32_bf16 v[184:187], v[200:203], v[20:23], v[184:187]
  ds_read_b64_tr_b16 v[218:219], v250 offset:5376
  v_cvt_pk_bf16_f32 v128, v168, v169
  v_mfma_f32_16x16x32_bf16 v[192:195], v[200:203], v[32:35], 0
  s_waitcnt lgkmcnt(6)
  ds_read_b64_tr_b16 v[220:221], v251 offset:4608
  v_cvt_pk_bf16_f32 v129, v170, v171
  v_mfma_f32_16x16x32_bf16 v[188:191], v[204:207], v[20:23], v[188:191]
  ds_read_b64_tr_b16 v[222:223], v251 offset:5376
  v_cvt_pk_bf16_f32 v130, v172, v173
  v_mfma_f32_16x16x32_bf16 v[196:199], v[204:207], v[32:35], 0
  s_waitcnt lgkmcnt(6)
  ds_read_b64_tr_b16 v[224:225], v250 offset:6144
  ds_read_b64_tr_b16 v[226:227], v250 offset:6912
  v_mfma_f32_16x16x32_bf16 v[184:187], v[208:211], v[24:27], v[184:187]
  ds_read_b64_tr_b16 v[228:229], v251 offset:6144
  v_cvt_pk_bf16_f32 v131, v174, v175
  v_mfma_f32_16x16x32_bf16 v[192:195], v[208:211], v[36:39], v[192:195]
  s_waitcnt lgkmcnt(7)
  ds_read_b64_tr_b16 v[230:231], v251 offset:6912
  v_cvt_pk_bf16_f32 v152, v176, v177
  v_mfma_f32_16x16x32_bf16 v[188:191], v[212:215], v[24:27], v[188:191]
  ds_read_b64_tr_b16 v[200:201], v244 offset:256
  v_cvt_pk_bf16_f32 v153, v178, v179
  v_mfma_f32_16x16x32_bf16 v[196:199], v[212:215], v[36:39], v[196:199]
  s_waitcnt lgkmcnt(7)
  ds_read_b64_tr_b16 v[202:203], v244 offset:1024
  v_cvt_pk_bf16_f32 v154, v180, v181
  v_mfma_f32_16x16x32_bf16 v[184:187], v[216:219], v[28:31], v[184:187]
  ds_read_b64_tr_b16 v[204:205], v245 offset:256
  v_cvt_pk_bf16_f32 v155, v182, v183
  v_mfma_f32_16x16x32_bf16 v[192:195], v[216:219], v[40:43], v[192:195]
  s_waitcnt lgkmcnt(7)
  ds_read_b64_tr_b16 v[206:207], v245 offset:1024
  v_mfma_f32_16x16x32_bf16 v[188:191], v[220:223], v[28:31], v[188:191]
  ds_read_b64_tr_b16 v[208:209], v244 offset:1792
  v_mfma_f32_16x16x32_bf16 v[196:199], v[220:223], v[40:43], v[196:199]
  s_waitcnt lgkmcnt(7)
  ds_read_b64_tr_b16 v[210:211], v244 offset:2560
  v_mfma_f32_16x16x32_bf16 v[192:195], v[224:227], v[44:47], v[192:195]
  s_waitcnt lgkmcnt(6)
  ds_read_b64_tr_b16 v[212:213], v245 offset:1792
  v_mfma_f32_16x16x32_bf16 v[196:199], v[228:231], v[44:47], v[196:199]
  ds_read_b64_tr_b16 v[214:215], v245 offset:2560
  ds_read_b64_tr_b16 v[216:217], v244 offset:3328
  v_mfma_f32_16x16x32_bf16 v[60:63], v[40:43], v[48:51], v[60:63]
  s_waitcnt lgkmcnt(7)
  ds_read_b64_tr_b16 v[218:219], v244 offset:4096
  v_mfma_f32_16x16x32_bf16 v[168:171], v[200:203], v[16:19], 0
  s_waitcnt lgkmcnt(6)
  ds_read_b64_tr_b16 v[220:221], v245 offset:3328
  v_mfma_f32_16x16x32_bf16 v[172:175], v[204:207], v[16:19], 0
  ds_read_b64_tr_b16 v[222:223], v245 offset:4096
  v_mfma_f32_16x16x32_bf16 v[56:59], v[28:31], v[48:51], v[56:59]
  s_waitcnt lgkmcnt(6)
  ds_read_b64_tr_b16 v[224:225], v244 offset:4864
  v_mfma_f32_16x16x32_bf16 v[168:171], v[208:211], v[20:23], v[168:171]
  ds_read_b64_tr_b16 v[226:227], v244 offset:5632
  v_cvt_pk_bf16_f32 v132, v184, v185
  v_mfma_f32_16x16x32_bf16 v[176:179], v[208:211], v[32:35], 0
  s_waitcnt lgkmcnt(6)
  ds_read_b64_tr_b16 v[228:229], v245 offset:4864
  v_cvt_pk_bf16_f32 v133, v186, v187
  v_mfma_f32_16x16x32_bf16 v[172:175], v[212:215], v[20:23], v[172:175]
  ds_read_b64_tr_b16 v[230:231], v245 offset:5632
  v_cvt_pk_bf16_f32 v134, v188, v189
  v_mfma_f32_16x16x32_bf16 v[180:183], v[212:215], v[32:35], 0
  s_waitcnt lgkmcnt(6)
  ds_read_b64_tr_b16 v[200:201], v244 offset:6400
  v_cvt_pk_bf16_f32 v135, v190, v191
  v_mfma_f32_16x16x32_bf16 v[168:171], v[216:219], v[24:27], v[168:171]
  ds_read_b64_tr_b16 v[202:203], v244 offset:7168
  v_cvt_pk_bf16_f32 v156, v192, v193
  v_mfma_f32_16x16x32_bf16 v[176:179], v[216:219], v[36:39], v[176:179]
  s_waitcnt lgkmcnt(6)
  ds_read_b64_tr_b16 v[204:205], v245 offset:6400
  ds_read_b64_tr_b16 v[206:207], v245 offset:7168
  v_mfma_f32_16x16x32_bf16 v[172:175], v[220:223], v[24:27], v[172:175]
  ds_read_b64_tr_b16 v[208:209], v246 offset:256
  v_cvt_pk_bf16_f32 v157, v194, v195
  v_mfma_f32_16x16x32_bf16 v[180:183], v[220:223], v[36:39], v[180:183]
  s_waitcnt lgkmcnt(7)
  ds_read_b64_tr_b16 v[210:211], v246 offset:1024
  v_cvt_pk_bf16_f32 v158, v196, v197
  v_mfma_f32_16x16x32_bf16 v[168:171], v[224:227], v[28:31], v[168:171]
  ds_read_b64_tr_b16 v[212:213], v247 offset:256
  v_cvt_pk_bf16_f32 v159, v198, v199
  v_mfma_f32_16x16x32_bf16 v[176:179], v[224:227], v[40:43], v[176:179]
  s_waitcnt lgkmcnt(7)
  ds_read_b64_tr_b16 v[214:215], v247 offset:1024
  v_mfma_f32_16x16x32_bf16 v[172:175], v[228:231], v[28:31], v[172:175]
  ds_read_b64_tr_b16 v[216:217], v246 offset:1792
  v_mfma_f32_16x16x32_bf16 v[180:183], v[228:231], v[40:43], v[180:183]
  s_waitcnt lgkmcnt(7)
  ds_read_b64_tr_b16 v[218:219], v246 offset:2560
  v_mfma_f32_16x16x32_bf16 v[176:179], v[200:203], v[44:47], v[176:179]
  s_waitcnt lgkmcnt(6)
  ds_read_b64_tr_b16 v[220:221], v247 offset:1792
  v_mfma_f32_16x16x32_bf16 v[180:183], v[204:207], v[44:47], v[180:183]
  ds_read_b64_tr_b16 v[222:223], v247 offset:2560
  v_mfma_f32_16x16x32_bf16 v[60:63], v[44:47], v[48:51], v[60:63]
  s_waitcnt lgkmcnt(6)
  ds_read_b64_tr_b16 v[224:225], v246 offset:3328
  v_mfma_f32_16x16x32_bf16 v[184:187], v[208:211], v[16:19], 0
  s_waitcnt lgkmcnt(5)
  ds_read_b64_tr_b16 v[226:227], v246 offset:4096
  ds_read_b64_tr_b16 v[228:229], v247 offset:3328
  v_mfma_f32_16x16x32_bf16 v[188:191], v[212:215], v[16:19], 0
  s_waitcnt lgkmcnt(5)
  ds_read_b64_tr_b16 v[230:231], v247 offset:4096
  v_mfma_f32_16x16x32_bf16 v[184:187], v[216:219], v[20:23], v[184:187]
  ds_read_b64_tr_b16 v[200:201], v246 offset:4864
  v_mfma_f32_16x16x32_bf16 v[192:195], v[216:219], v[32:35], 0
  s_waitcnt lgkmcnt(5)
  ds_read_b64_tr_b16 v[202:203], v246 offset:5632
  v_cvt_pk_bf16_f32 v136, v168, v169
  v_mfma_f32_16x16x32_bf16 v[188:191], v[220:223], v[20:23], v[188:191]
  ds_read_b64_tr_b16 v[204:205], v247 offset:4864
  v_cvt_pk_bf16_f32 v137, v170, v171
  v_mfma_f32_16x16x32_bf16 v[196:199], v[220:223], v[32:35], 0
  s_waitcnt lgkmcnt(5)
  ds_read_b64_tr_b16 v[206:207], v247 offset:5632
  v_cvt_pk_bf16_f32 v138, v172, v173
  v_mfma_f32_16x16x32_bf16 v[184:187], v[224:227], v[24:27], v[184:187]
  ds_read_b64_tr_b16 v[208:209], v246 offset:6400
  v_cvt_pk_bf16_f32 v139, v174, v175
  v_mfma_f32_16x16x32_bf16 v[192:195], v[224:227], v[36:39], v[192:195]
  s_waitcnt lgkmcnt(5)
  ds_read_b64_tr_b16 v[210:211], v246 offset:7168
  v_cvt_pk_bf16_f32 v160, v176, v177
  v_mfma_f32_16x16x32_bf16 v[188:191], v[228:231], v[24:27], v[188:191]
  ds_read_b64_tr_b16 v[212:213], v247 offset:6400
  v_cvt_pk_bf16_f32 v161, v178, v179
  v_mfma_f32_16x16x32_bf16 v[196:199], v[228:231], v[36:39], v[196:199]
  s_waitcnt lgkmcnt(5)
  ds_read_b64_tr_b16 v[214:215], v247 offset:7168
  v_cvt_pk_bf16_f32 v162, v180, v181
  v_mfma_f32_16x16x32_bf16 v[184:187], v[200:203], v[28:31], v[184:187]
  v_cvt_pk_bf16_f32 v163, v182, v183
  v_mfma_f32_16x16x32_bf16 v[192:195], v[200:203], v[40:43], v[192:195]
  s_waitcnt lgkmcnt(4)
  v_mfma_f32_16x16x32_bf16 v[188:191], v[204:207], v[28:31], v[188:191]
  v_mfma_f32_16x16x32_bf16 v[196:199], v[204:207], v[40:43], v[196:199]
  s_waitcnt lgkmcnt(2)
  v_mfma_f32_16x16x32_bf16 v[192:195], v[208:211], v[44:47], v[192:195]
  s_waitcnt lgkmcnt(0)
  v_mfma_f32_16x16x32_bf16 v[196:199], v[212:215], v[44:47], v[196:199]
  s_waitcnt vmcnt(0)
  s_cmp_lt_u32 s40, 4
  s_cbranch_scc1 M_e3
  s_barrier
  s_mul_i32 s55, s40, 9216
  s_sub_u32 s55, s55, 24576
  s_add_u32 s59, s55, 24576
  s_mov_b32 m0, s55
  s_add_u32 s55, s55, 3072
  buffer_load_dwordx4 v252, s[24:27], s59 offen offset:0 sc1 lds
  buffer_load_dwordx4 v252, s[24:27], s59 offen offset:1024 sc1 lds
  buffer_load_dwordx4 v252, s[24:27], s59 offen offset:2048 sc1 lds
  s_add_u32 s59, s59, 3072
  s_mov_b32 m0, s55
  s_add_u32 s55, s55, 3072
  buffer_load_dwordx4 v252, s[24:27], s59 offen offset:0 sc1 lds
  buffer_load_dwordx4 v252, s[24:27], s59 offen offset:1024 sc1 lds
  buffer_load_dwordx4 v252, s[24:27], s59 offen offset:2048 sc1 lds
  s_add_u32 s59, s59, 3072
  s_mov_b32 m0, s55
  s_add_u32 s55, s55, 3072
  buffer_load_dwordx4 v252, s[24:27], s59 offen offset:0 sc1 lds
  buffer_load_dwordx4 v252, s[24:27], s59 offen offset:1024 sc1 lds
  buffer_load_dwordx4 v252, s[24:27], s59 offen offset:2048 sc1 lds
  s_add_u32 s59, s59, 3072
M_e3:
  v_cvt_pk_bf16_f32 v140, v184, v185
  v_cvt_pk_bf16_f32 v141, v186, v187
  v_cvt_pk_bf16_f32 v142, v188, v189
  v_cvt_pk_bf16_f32 v143, v190, v191
  v_cvt_pk_bf16_f32 v164, v192, v193
  v_cvt_pk_bf16_f32 v165, v194, v195
  v_cvt_pk_bf16_f32 v166, v196, v197
  v_cvt_pk_bf16_f32 v167, v198, v199
  ds_read_b128 v[200:203], v253 offset:0
  ds_read_b128 v[204:207], v253 offset:1024
  ds_read_b128 v[208:211], v253 offset:2048
  ds_read_b128 v[212:215], v253 offset:3072
  s_waitcnt lgkmcnt(3)
  v_mfma_f32_16x16x32_bf16 v[168:171], v[120:123], v[200:203], 0
  ds_read_b128 v[216:219], v253 offset:4096
  v_rcp_f32 v56, v56
  v_mfma_f32_16x16x32_bf16 v[176:179], v[144:147], v[200:203], 0
  s_waitcnt lgkmcnt(3)
  v_rcp_f32 v57, v57
  v_rcp_f32 v58, v58
  v_mfma_f32_16x16x32_bf16 v[172:175], v[120:123], v[204:207], 0
  ds_read_b128 v[220:223], v253 offset:5120
  v_rcp_f32 v59, v59
  v_mfma_f32_16x16x32_bf16 v[180:183], v[144:147], v[204:207], 0
  s_waitcnt lgkmcnt(3)
  v_rcp_f32 v60, v60
  v_rcp_f32 v61, v61
  v_mfma_f32_16x16x32_bf16 v[168:171], v[124:127], v[208:211], v[168:171]
  ds_read_b128 v[224:227], v253 offset:6144
  v_rcp_f32 v62, v62
  v_mfma_f32_16x16x32_bf16 v[176:179], v[148:151], v[208:211], v[176:179]
  s_waitcnt lgkmcnt(3)
  v_rcp_f32 v63, v63
  v_mfma_f32_16x16x32_bf16 v[172:175], v[124:127], v[212:215], v[172:175]
  ds_read_b128 v[228:231], v253 offset:7168
  v_mfma_f32_16x16x32_bf16 v[180:183], v[148:151], v[212:215], v[180:183]
  s_waitcnt lgkmcnt(3)
  v_mfma_f32_16x16x32_bf16 v[168:171], v[128:131], v[216:219], v[168:171]
  ds_read_b128 v[200:203], v253 offset:8192
  v_mfma_f32_16x16x32_bf16 v[176:179], v[152:155], v[216:219], v[176:179]
  s_waitcnt lgkmcnt(3)
  v_mfma_f32_16x16x32_bf16 v[172:175], v[128:131], v[220:223], v[172:175]
  ds_read_b128 v[204:207], v253 offset:9216
  v_mfma_f32_16x16x32_bf16 v[180:183], v[152:155], v[220:223], v[180:183]
  s_waitcnt lgkmcnt(3)
  v_mfma_f32_16x16x32_bf16 v[168:171], v[132:135], v[224:227], v[168:171]
  v_mfma_f32_16x16x32_bf16 v[176:179], v[156:159], v[224:227], v[176:179]
  s_waitcnt lgkmcnt(2)
  v_mfma_f32_16x16x32_bf16 v[172:175], v[132:135], v[228:231], v[172:175]
  v_mfma_f32_16x16x32_bf16 v[180:183], v[156:159], v[228:231], v[180:183]
  s_waitcnt lgkmcnt(1)
  v_mfma_f32_16x16x32_bf16 v[168:171], v[136:139], v[200:203], v[168:171]
  v_mfma_f32_16x16x32_bf16 v[176:179], v[160:163], v[200:203], v[176:179]
  s_waitcnt lgkmcnt(0)
  v_mfma_f32_16x16x32_bf16 v[172:175], v[136:139], v[204:207], v[172:175]
  v_mfma_f32_16x16x32_bf16 v[180:183], v[160:163], v[204:207], v[180:183]
  v_mfma_f32_16x16x32_bf16 v[168:171], v[140:143], v[64:67], v[168:171]
  v_mfma_f32_16x16x32_bf16 v[176:179], v[164:167], v[64:67], v[176:179]
  v_mfma_f32_16x16x32_bf16 v[172:175], v[140:143], v[92:95], v[172:175]
  v_mfma_f32_16x16x32_bf16 v[180:183], v[164:167], v[92:95], v[180:183]
  v_mfma_f32_16x16x32_bf16 v[184:187], v[120:123], v[68:71], 0
  v_mfma_f32_16x16x32_bf16 v[192:195], v[144:147], v[68:71], 0
  v_mfma_f32_16x16x32_bf16 v[188:191], v[120:123], v[96:99], 0
  s_nop 1
  v_mul_f32 v168, v168, v56
  s_nop 0
  v_mul_f32 v172, v172, v56
  v_mfma_f32_16x16x32_bf16 v[196:199], v[144:147], v[96:99], 0
  v_cvt_pk_bf16_f32 v16, v168, v172
  v_mul_f32 v169, v169, v57
  v_mfma_f32_16x16x32_bf16 v[184:187], v[124:127], v[72:75], v[184:187]
  v_mul_f32 v173, v173, v57
  v_cvt_pk_bf16_f32 v18, v169, v173
  v_mfma_f32_16x16x32_bf16 v[192:195], v[148:151], v[72:75], v[192:195]
  v_mul_f32 v170, v170, v58
  v_mul_f32 v174, v174, v58
  v_mfma_f32_16x16x32_bf16 v[188:191], v[124:127], v[100:103], v[188:191]
  v_cvt_pk_bf16_f32 v20, v170, v174
  v_mul_f32 v171, v171, v59
  v_mfma_f32_16x16x32_bf16 v[196:199], v[148:151], v[100:103], v[196:199]
  v_mul_f32 v175, v175, v59
  v_cvt_pk_bf16_f32 v22, v171, v175
  v_mfma_f32_16x16x32_bf16 v[184:187], v[128:131], v[76:79], v[184:187]
  v_mul_f32 v176, v176, v60
  v_mul_f32 v180, v180, v60
  v_mfma_f32_16x16x32_bf16 v[192:195], v[152:155], v[76:79], v[192:195]
  v_cvt_pk_bf16_f32 v24, v176, v180
  v_mul_f32 v177, v177, v61
  v_mfma_f32_16x16x32_bf16 v[188:191], v[128:131], v[104:107], v[188:191]
  v_mul_f32 v181, v181, v61
  v_cvt_pk_bf16_f32 v26, v177, v181
  v_mfma_f32_16x16x32_bf16 v[196:199], v[152:155], v[104:107], v[196:199]
  v_mul_f32 v178, v178, v62
  v_mul_f32 v182, v182, v62
  v_mfma_f32_16x16x32_bf16 v[184:187], v[132:135], v[80:83], v[184:187]
  v_cvt_pk_bf16_f32 v28, v178, v182
  v_mul_f32 v179, v179, v63
  v_mfma_f32_16x16x32_bf16 v[192:195], v[156:159], v[80:83], v[192:195]
  v_mul_f32 v183, v183, v63
  v_cvt_pk_bf16_f32 v30, v179, v183
  v_mfma_f32_16x16x32_bf16 v[188:191], v[132:135], v[108:111], v[188:191]
  v_mfma_f32_16x16x32_bf16 v[196:199], v[156:159], v[108:111], v[196:199]
  s_cmp_lt_u32 s40, 4
  s_cbranch_scc1 M_e4
  s_waitcnt vmcnt(0)
  s_barrier
M_e4:
  v_mfma_f32_16x16x32_bf16 v[184:187], v[136:139], v[84:87], v[184:187]
  ds_read_b128 v[200:203], v252 offset:0
  v_mfma_f32_16x16x32_bf16 v[192:195], v[160:163], v[84:87], v[192:195]
  v_mfma_f32_16x16x32_bf16 v[188:191], v[136:139], v[112:115], v[188:191]
  ds_read_b128 v[204:207], v252 offset:1024
  v_mfma_f32_16x16x32_bf16 v[196:199], v[160:163], v[112:115], v[196:199]
  v_mfma_f32_16x16x32_bf16 v[184:187], v[140:143], v[88:91], v[184:187]
  ds_read_b128 v[208:211], v252 offset:2048
  v_mfma_f32_16x16x32_bf16 v[192:195], v[164:167], v[88:91], v[192:195]
  v_mfma_f32_16x16x32_bf16 v[188:191], v[140:143], v[116:119], v[188:191]
  ds_read_b128 v[212:215], v252 offset:3072
  v_mfma_f32_16x16x32_bf16 v[196:199], v[164:167], v[116:119], v[196:199]
  s_waitcnt lgkmcnt(3)
  v_mfma_f32_16x16x32_bf16 v[168:171], v[120:123], v[200:203], 0
  ds_read_b128 v[216:219], v252 offset:4096
  v_mfma_f32_16x16x32_bf16 v[176:179], v[144:147], v[200:203], 0
  s_waitcnt lgkmcnt(3)
  v_mfma_f32_16x16x32_bf16 v[172:175], v[120:123], v[204:207], 0
  ds_read_b128 v[220:223], v252 offset:5120
  v_mul_f32 v184, v184, v56
  v_mfma_f32_16x16x32_bf16 v[180:183], v[144:147], v[204:207], 0
  s_waitcnt lgkmcnt(3)
  v_mul_f32 v188, v188, v56
  v_cvt_pk_bf16_f32 v17, v184, v188
  v_mfma_f32_16x16x32_bf16 v[168:171], v[124:127], v[208:211], v[168:171]
  ds_read_b128 v[224:227], v252 offset:6144
  buffer_store_dwordx2 v[16:17], v4, s[20:23], 0 offen offset:0 sc1
  v_mfma_f32_16x16x32_bf16 v[176:179], v[148:151], v[208:211], v[176:179]
  s_waitcnt lgkmcnt(3)
  v_mul_f32 v185, v185, v57
  v_mul_f32 v189, v189, v57
  v_mfma_f32_16x16x32_bf16 v[172:175], v[124:127], v[212:215], v[172:175]
  ds_read_b128 v[228:231], v252 offset:7168
  v_cvt_pk_bf16_f32 v19, v185, v189
  v_mfma_f32_16x16x32_bf16 v[180:183], v[148:151], v[212:215], v[180:183]
  s_waitcnt lgkmcnt(3)
  buffer_store_dwordx2 v[18:19], v5, s[20:23], 0 offen offset:0 sc1
  v_mul_f32 v186, v186, v58
  v_mfma_f32_16x16x32_bf16 v[168:171], v[128:131], v[216:219], v[168:171]
  ds_read_b128 v[200:203], v252 offset:8192
  v_mul_f32 v190, v190, v58
  v_mfma_f32_16x16x32_bf16 v[176:179], v[152:155], v[216:219], v[176:179]
  s_waitcnt lgkmcnt(3)
  v_cvt_pk_bf16_f32 v21, v186, v190
  buffer_store_dwordx2 v[20:21], v6, s[20:23], 0 offen offset:0 sc1
  v_mfma_f32_16x16x32_bf16 v[172:175], v[128:131], v[220:223], v[172:175]
  ds_read_b128 v[204:207], v252 offset:9216
  v_mul_f32 v187, v187, v59
  v_mfma_f32_16x16x32_bf16 v[180:183], v[152:155], v[220:223], v[180:183]
  s_waitcnt lgkmcnt(3)
  v_mul_f32 v191, v191, v59
  v_cvt_pk_bf16_f32 v23, v187, v191
  v_mfma_f32_16x16x32_bf16 v[168:171], v[132:135], v[224:227], v[168:171]
  ds_read_b128 v[208:211], v252 offset:10240
  buffer_store_dwordx2 v[22:23], v7, s[20:23], 0 offen offset:0 sc1
  v_mfma_f32_16x16x32_bf16 v[176:179], v[156:159], v[224:227], v[176:179]
  s_waitcnt lgkmcnt(3)
  v_mul_f32 v192, v192, v60
  v_mul_f32 v196, v196, v60
  v_mfma_f32_16x16x32_bf16 v[172:175], v[132:135], v[228:231], v[172:175]
  ds_read_b128 v[212:215], v252 offset:11264
  v_cvt_pk_bf16_f32 v25, v192, v196
  v_mfma_f32_16x16x32_bf16 v[180:183], v[156:159], v[228:231], v[180:183]
  s_waitcnt lgkmcnt(3)
  buffer_store_dwordx2 v[24:25], v8, s[20:23], 0 offen offset:0 sc1
  v_mul_f32 v193, v193, v61
  v_mfma_f32_16x16x32_bf16 v[168:171], v[136:139], v[200:203], v[168:171]
  ds_read_b128 v[216:219], v252 offset:12288
  v_mul_f32 v197, v197, v61
  v_mfma_f32_16x16x32_bf16 v[176:179], v[160:163], v[200:203], v[176:179]
  s_waitcnt lgkmcnt(3)
  v_cvt_pk_bf16_f32 v27, v193, v197
  buffer_store_dwordx2 v[26:27], v9, s[20:23], 0 offen offset:0 sc1
  v_mfma_f32_16x16x32_bf16 v[172:175], v[136:139], v[204:207], v[172:175]
  ds_read_b128 v[220:223], v252 offset:13312
  v_mul_f32 v194, v194, v62
  v_mfma_f32_16x16x32_bf16 v[180:183], v[160:163], v[204:207], v[180:183]
  s_waitcnt lgkmcnt(3)
  v_mul_f32 v198, v198, v62
  v_cvt_pk_bf16_f32 v29, v194, v198
  v_mfma_f32_16x16x32_bf16 v[168:171], v[140:143], v[208:211], v[168:171]
  ds_read_b128 v[224:227], v252 offset:14336
  buffer_store_dwordx2 v[28:29], v10, s[20:23], 0 offen offset:0 sc1
  v_mfma_f32_16x16x32_bf16 v[176:179], v[164:167], v[208:211], v[176:179]
  s_waitcnt lgkmcnt(3)
  v_mul_f32 v195, v195, v63
  v_mul_f32 v199, v199, v63
  v_mfma_f32_16x16x32_bf16 v[172:175], v[140:143], v[212:215], v[172:175]
  ds_read_b128 v[228:231], v252 offset:15360
  v_cvt_pk_bf16_f32 v31, v195, v199
  v_mfma_f32_16x16x32_bf16 v[180:183], v[164:167], v[212:215], v[180:183]
  s_waitcnt lgkmcnt(3)
  buffer_store_dwordx2 v[30:31], v11, s[20:23], 0 offen offset:0 sc1
  v_mfma_f32_16x16x32_bf16 v[184:187], v[120:123], v[216:219], 0
  ds_read_b128 v[200:203], v252 offset:16384
  v_mfma_f32_16x16x32_bf16 v[192:195], v[144:147], v[216:219], 0
  s_waitcnt lgkmcnt(3)
  v_mfma_f32_16x16x32_bf16 v[188:191], v[120:123], v[220:223], 0
  ds_read_b128 v[204:207], v252 offset:17408
  v_mul_f32 v168, v168, v56
  v_mfma_f32_16x16x32_bf16 v[196:199], v[144:147], v[220:223], 0
  s_waitcnt lgkmcnt(3)
  v_mul_f32 v172, v172, v56
  v_cvt_pk_bf16_f32 v16, v168, v172
  v_mfma_f32_16x16x32_bf16 v[184:187], v[124:127], v[224:227], v[184:187]
  ds_read_b128 v[208:211], v252 offset:18432
  v_mul_f32 v169, v169, v57
  v_mfma_f32_16x16x32_bf16 v[192:195], v[148:151], v[224:227], v[192:195]
  s_waitcnt lgkmcnt(3)
  v_mul_f32 v173, v173, v57
  v_cvt_pk_bf16_f32 v18, v169, v173
  v_mfma_f32_16x16x32_bf16 v[188:191], v[124:127], v[228:231], v[188:191]
  ds_read_b128 v[212:215], v252 offset:19456
  v_mul_f32 v170, v170, v58
  v_mfma_f32_16x16x32_bf16 v[196:199], v[148:151], v[228:231], v[196:199]
  s_waitcnt lgkmcnt(3)
  v_mul_f32 v174, v174, v58
  v_cvt_pk_bf16_f32 v20, v170, v174
  v_mfma_f32_16x16x32_bf16 v[184:187], v[128:131], v[200:203], v[184:187]
  ds_read_b128 v[216:219], v252 offset:20480
  v_mul_f32 v171, v171, v59
  v_mfma_f32_16x16x32_bf16 v[192:195], v[152:155], v[200:203], v[192:195]
  s_waitcnt lgkmcnt(3)
  v_mul_f32 v175, v175, v59
  v_cvt_pk_bf16_f32 v22, v171, v175
  v_mfma_f32_16x16x32_bf16 v[188:191], v[128:131], v[204:207], v[188:191]
  ds_read_b128 v[220:223], v252 offset:21504
  v_mul_f32 v176, v176, v60
  v_mfma_f32_16x16x32_bf16 v[196:199], v[152:155], v[204:207], v[196:199]
  s_waitcnt lgkmcnt(3)
  v_mul_f32 v180, v180, v60
  v_cvt_pk_bf16_f32 v24, v176, v180
  v_mfma_f32_16x16x32_bf16 v[184:187], v[132:135], v[208:211], v[184:187]
  ds_read_b128 v[224:227], v252 offset:22528
  v_mul_f32 v177, v177, v61
  v_mfma_f32_16x16x32_bf16 v[192:195], v[156:159], v[208:211], v[192:195]
  s_waitcnt lgkmcnt(3)
  v_mul_f32 v181, v181, v61
  v_cvt_pk_bf16_f32 v26, v177, v181
  v_mfma_f32_16x16x32_bf16 v[188:191], v[132:135], v[212:215], v[188:191]
  ds_read_b128 v[228:231], v252 offset:23552
  v_mul_f32 v178, v178, v62
  v_mfma_f32_16x16x32_bf16 v[196:199], v[156:159], v[212:215], v[196:199]
  s_waitcnt lgkmcnt(3)
  v_mul_f32 v182, v182, v62
  v_cvt_pk_bf16_f32 v28, v178, v182
  v_mfma_f32_16x16x32_bf16 v[184:187], v[136:139], v[216:219], v[184:187]
  ds_read_b128 v[200:203], v252 offset:24576
  v_mul_f32 v179, v179, v63
  v_mfma_f32_16x16x32_bf16 v[192:195], v[160:163], v[216:219], v[192:195]
  s_waitcnt lgkmcnt(3)
  v_mul_f32 v183, v183, v63
  v_cvt_pk_bf16_f32 v30, v179, v183
  v_mfma_f32_16x16x32_bf16 v[188:191], v[136:139], v[220:223], v[188:191]
  ds_read_b128 v[204:207], v252 offset:25600
  v_mfma_f32_16x16x32_bf16 v[196:199], v[160:163], v[220:223], v[196:199]
  s_waitcnt lgkmcnt(3)
  v_mfma_f32_16x16x32_bf16 v[184:187], v[140:143], v[224:227], v[184:187]
  ds_read_b128 v[208:211], v252 offset:26624
  v_mfma_f32_16x16x32_bf16 v[192:195], v[164:167], v[224:227], v[192:195]
  s_waitcnt lgkmcnt(3)
  v_mfma_f32_16x16x32_bf16 v[188:191], v[140:143], v[228:231], v[188:191]
  ds_read_b128 v[212:215], v252 offset:27648
  v_mfma_f32_16x16x32_bf16 v[196:199], v[164:167], v[228:231], v[196:199]
  s_waitcnt lgkmcnt(3)
  v_mfma_f32_16x16x32_bf16 v[168:171], v[120:123], v[200:203], 0
  ds_read_b128 v[216:219], v252 offset:28672
  v_mfma_f32_16x16x32_bf16 v[176:179], v[144:147], v[200:203], 0
  s_waitcnt lgkmcnt(3)
  v_mfma_f32_16x16x32_bf16 v[172:175], v[120:123], v[204:207], 0
  ds_read_b128 v[220:223], v252 offset:29696
  v_mul_f32 v184, v184, v56
  v_mfma_f32_16x16x32_bf16 v[180:183], v[144:147], v[204:207], 0
  s_waitcnt lgkmcnt(3)
  v_mul_f32 v188, v188, v56
  v_cvt_pk_bf16_f32 v17, v184, v188
  v_mfma_f32_16x16x32_bf16 v[168:171], v[124:127], v[208:211], v[168:171]
  ds_read_b128 v[224:227], v252 offset:30720
  buffer_store_dwordx2 v[16:17], v4, s[20:23], 0 offen offset:128 sc1
  v_mfma_f32_16x16x32_bf16 v[176:179], v[148:151], v[208:211], v[176:179]
  s_waitcnt lgkmcnt(3)
  v_mul_f32 v185, v185, v57
  v_mul_f32 v189, v189, v57
  v_mfma_f32_16x16x32_bf16 v[172:175], v[124:127], v[212:215], v[172:175]
  ds_read_b128 v[228:231], v252 offset:31744
  v_cvt_pk_bf16_f32 v19, v185, v189
  v_mfma_f32_16x16x32_bf16 v[180:183], v[148:151], v[212:215], v[180:183]
  s_waitcnt lgkmcnt(3)
  buffer_store_dwordx2 v[18:19], v5, s[20:23], 0 offen offset:128 sc1
  v_mul_f32 v186, v186, v58
  v_mfma_f32_16x16x32_bf16 v[168:171], v[128:131], v[216:219], v[168:171]
  ds_read_b128 v[200:203], v252 offset:32768
  v_mul_f32 v190, v190, v58
  v_mfma_f32_16x16x32_bf16 v[176:179], v[152:155], v[216:219], v[176:179]
  s_waitcnt lgkmcnt(3)
  v_cvt_pk_bf16_f32 v21, v186, v190
  buffer_store_dwordx2 v[20:21], v6, s[20:23], 0 offen offset:128 sc1
  v_mfma_f32_16x16x32_bf16 v[172:175], v[128:131], v[220:223], v[172:175]
  ds_read_b128 v[204:207], v252 offset:33792
  v_mul_f32 v187, v187, v59
  v_mfma_f32_16x16x32_bf16 v[180:183], v[152:155], v[220:223], v[180:183]
  s_waitcnt lgkmcnt(3)
  v_mul_f32 v191, v191, v59
  v_cvt_pk_bf16_f32 v23, v187, v191
  v_mfma_f32_16x16x32_bf16 v[168:171], v[132:135], v[224:227], v[168:171]
  ds_read_b128 v[208:211], v252 offset:34816
  buffer_store_dwordx2 v[22:23], v7, s[20:23], 0 offen offset:128 sc1
  v_mfma_f32_16x16x32_bf16 v[176:179], v[156:159], v[224:227], v[176:179]
  s_waitcnt lgkmcnt(3)
  v_mul_f32 v192, v192, v60
  v_mul_f32 v196, v196, v60
  v_mfma_f32_16x16x32_bf16 v[172:175], v[132:135], v[228:231], v[172:175]
  ds_read_b128 v[212:215], v252 offset:35840
  v_cvt_pk_bf16_f32 v25, v192, v196
  v_mfma_f32_16x16x32_bf16 v[180:183], v[156:159], v[228:231], v[180:183]
  s_waitcnt lgkmcnt(3)
  buffer_store_dwordx2 v[24:25], v8, s[20:23], 0 offen offset:128 sc1
  v_mul_f32 v193, v193, v61
  v_mfma_f32_16x16x32_bf16 v[168:171], v[136:139], v[200:203], v[168:171]
  ds_read_b128 v[216:219], v252 offset:36864
  v_mul_f32 v197, v197, v61
  v_mfma_f32_16x16x32_bf16 v[176:179], v[160:163], v[200:203], v[176:179]
  s_waitcnt lgkmcnt(3)
  v_cvt_pk_bf16_f32 v27, v193, v197
  buffer_store_dwordx2 v[26:27], v9, s[20:23], 0 offen offset:128 sc1
  v_mfma_f32_16x16x32_bf16 v[172:175], v[136:139], v[204:207], v[172:175]
  ds_read_b128 v[220:223], v252 offset:37888
  v_mul_f32 v194, v194, v62
  v_mfma_f32_16x16x32_bf16 v[180:183], v[160:163], v[204:207], v[180:183]
  s_waitcnt lgkmcnt(3)
  v_mul_f32 v198, v198, v62
  v_cvt_pk_bf16_f32 v29, v194, v198
  v_mfma_f32_16x16x32_bf16 v[168:171], v[140:143], v[208:211], v[168:171]
  ds_read_b128 v[224:227], v252 offset:38912
  buffer_store_dwordx2 v[28:29], v10, s[20:23], 0 offen offset:128 sc1
  v_mfma_f32_16x16x32_bf16 v[176:179], v[164:167], v[208:211], v[176:179]
  s_waitcnt lgkmcnt(3)
  v_mul_f32 v195, v195, v63
  v_mul_f32 v199, v199, v63
  v_mfma_f32_16x16x32_bf16 v[172:175], v[140:143], v[212:215], v[172:175]
  ds_read_b128 v[228:231], v252 offset:39936
  v_cvt_pk_bf16_f32 v31, v195, v199
  v_mfma_f32_16x16x32_bf16 v[180:183], v[164:167], v[212:215], v[180:183]
  s_waitcnt lgkmcnt(3)
  buffer_store_dwordx2 v[30:31], v11, s[20:23], 0 offen offset:128 sc1
  v_mfma_f32_16x16x32_bf16 v[184:187], v[120:123], v[216:219], 0
  ds_read_b128 v[200:203], v252 offset:40960
  v_mfma_f32_16x16x32_bf16 v[192:195], v[144:147], v[216:219], 0
  s_waitcnt lgkmcnt(3)
  v_mfma_f32_16x16x32_bf16 v[188:191], v[120:123], v[220:223], 0
  ds_read_b128 v[204:207], v252 offset:41984
  v_mul_f32 v168, v168, v56
  v_mfma_f32_16x16x32_bf16 v[196:199], v[144:147], v[220:223], 0
  s_waitcnt lgkmcnt(3)
  v_mul_f32 v172, v172, v56
  v_cvt_pk_bf16_f32 v16, v168, v172
  v_mfma_f32_16x16x32_bf16 v[184:187], v[124:127], v[224:227], v[184:187]
  ds_read_b128 v[208:211], v252 offset:43008
  v_mul_f32 v169, v169, v57
  v_mfma_f32_16x16x32_bf16 v[192:195], v[148:151], v[224:227], v[192:195]
  s_waitcnt lgkmcnt(3)
  v_mul_f32 v173, v173, v57
  v_cvt_pk_bf16_f32 v18, v169, v173
  v_mfma_f32_16x16x32_bf16 v[188:191], v[124:127], v[228:231], v[188:191]
  ds_read_b128 v[212:215], v252 offset:44032
  v_mul_f32 v170, v170, v58
  v_mfma_f32_16x16x32_bf16 v[196:199], v[148:151], v[228:231], v[196:199]
  s_waitcnt lgkmcnt(3)
  v_mul_f32 v174, v174, v58
  v_cvt_pk_bf16_f32 v20, v170, v174
  v_mfma_f32_16x16x32_bf16 v[184:187], v[128:131], v[200:203], v[184:187]
  ds_read_b128 v[216:219], v252 offset:45056
  v_mul_f32 v171, v171, v59
  v_mfma_f32_16x16x32_bf16 v[192:195], v[152:155], v[200:203], v[192:195]
  s_waitcnt lgkmcnt(3)
  v_mul_f32 v175, v175, v59
  v_cvt_pk_bf16_f32 v22, v171, v175
  v_mfma_f32_16x16x32_bf16 v[188:191], v[128:131], v[204:207], v[188:191]
  ds_read_b128 v[220:223], v252 offset:46080
  v_mul_f32 v176, v176, v60
  v_mfma_f32_16x16x32_bf16 v[196:199], v[152:155], v[204:207], v[196:199]
  s_waitcnt lgkmcnt(3)
  v_mul_f32 v180, v180, v60
  v_cvt_pk_bf16_f32 v24, v176, v180
  v_mfma_f32_16x16x32_bf16 v[184:187], v[132:135], v[208:211], v[184:187]
  ds_read_b128 v[224:227], v252 offset:47104
  v_mul_f32 v177, v177, v61
  v_mfma_f32_16x16x32_bf16 v[192:195], v[156:159], v[208:211], v[192:195]
  s_waitcnt lgkmcnt(3)
  v_mul_f32 v181, v181, v61
  v_cvt_pk_bf16_f32 v26, v177, v181
  v_mfma_f32_16x16x32_bf16 v[188:191], v[132:135], v[212:215], v[188:191]
  ds_read_b128 v[228:231], v252 offset:48128
  v_mul_f32 v178, v178, v62
  v_mfma_f32_16x16x32_bf16 v[196:199], v[156:159], v[212:215], v[196:199]
  s_waitcnt lgkmcnt(3)
  v_mul_f32 v182, v182, v62
  v_cvt_pk_bf16_f32 v28, v178, v182
  v_mfma_f32_16x16x32_bf16 v[184:187], v[136:139], v[216:219], v[184:187]
  v_mul_f32 v179, v179, v63
  v_mul_f32 v183, v183, v63
  v_mfma_f32_16x16x32_bf16 v[192:195], v[160:163], v[216:219], v[192:195]
  s_waitcnt lgkmcnt(2)
  v_cvt_pk_bf16_f32 v30, v179, v183
  v_mfma_f32_16x16x32_bf16 v[188:191], v[136:139], v[220:223], v[188:191]
  v_mfma_f32_16x16x32_bf16 v[196:199], v[160:163], v[220:223], v[196:199]
  s_waitcnt lgkmcnt(1)
  v_mfma_f32_16x16x32_bf16 v[184:187], v[140:143], v[224:227], v[184:187]
  v_mfma_f32_16x16x32_bf16 v[192:195], v[164:167], v[224:227], v[192:195]
  s_waitcnt lgkmcnt(0)
  v_mfma_f32_16x16x32_bf16 v[188:191], v[140:143], v[228:231], v[188:191]
  v_mfma_f32_16x16x32_bf16 v[196:199], v[164:167], v[228:231], v[196:199]
  s_nop 3
  v_mul_f32 v184, v184, v56
  s_nop 1
  v_mul_f32 v188, v188, v56
  v_cvt_pk_bf16_f32 v17, v184, v188
  buffer_store_dwordx2 v[16:17], v4, s[20:23], 0 offen offset:256 sc1
  v_mul_f32 v185, v185, v57
  v_mul_f32 v189, v189, v57
  v_cvt_pk_bf16_f32 v19, v185, v189
  buffer_store_dwordx2 v[18:19], v5, s[20:23], 0 offen offset:256 sc1
  v_mul_f32 v186, v186, v58
  v_mul_f32 v190, v190, v58
  v_cvt_pk_bf16_f32 v21, v186, v190
  buffer_store_dwordx2 v[20:21], v6, s[20:23], 0 offen offset:256 sc1
  v_mul_f32 v187, v187, v59
  v_mul_f32 v191, v191, v59
  v_cvt_pk_bf16_f32 v23, v187, v191
  buffer_store_dwordx2 v[22:23], v7, s[20:23], 0 offen offset:256 sc1
  v_mul_f32 v192, v192, v60
  v_mul_f32 v196, v196, v60
  v_cvt_pk_bf16_f32 v25, v192, v196
  buffer_store_dwordx2 v[24:25], v8, s[20:23], 0 offen offset:256 sc1
  v_mul_f32 v193, v193, v61
  v_mul_f32 v197, v197, v61
  v_cvt_pk_bf16_f32 v27, v193, v197
  buffer_store_dwordx2 v[26:27], v9, s[20:23], 0 offen offset:256 sc1
  v_mul_f32 v194, v194, v62
  v_mul_f32 v198, v198, v62
  v_cvt_pk_bf16_f32 v29, v194, v198
  buffer_store_dwordx2 v[28:29], v10, s[20:23], 0 offen offset:256 sc1
  v_mul_f32 v195, v195, v63
  v_mul_f32 v199, v199, v63
  v_cvt_pk_bf16_f32 v31, v195, v199
  buffer_store_dwordx2 v[30:31], v11, s[20:23], 0 offen offset:256 sc1
  s_endpgm
M_helper:
  s_add_i32 s56, s45, 0
  s_lshl_b32 s56, s56, 1
  s_add_i32 s56, s56, s41
  s_max_i32 s56, s56, 0
  s_min_i32 s56, s56, 223
  s_mul_i32 s56, s56, 86016
  s_mov_b32 m0, 0
  s_nop 0
  buffer_load_dwordx4 v232, s[16:19], s56 offen lds
  s_mov_b32 m0, 1024
  s_nop 0
  buffer_load_dwordx4 v233, s[16:19], s56 offen lds
  s_mov_b32 m0, 2048
  s_nop 0
  buffer_load_dwordx4 v234, s[16:19], s56 offen lds
  s_mov_b32 m0, 3072
  s_nop 0
  buffer_load_dwordx4 v235, s[16:19], s56 offen lds
  s_mov_b32 m0, 4096
  s_nop 0
  buffer_load_dwordx4 v236, s[16:19], s56 offen lds
  s_mov_b32 m0, 5120
  s_nop 0
  buffer_load_dwordx4 v237, s[16:19], s56 offen lds
  s_mov_b32 m0, 6144
  s_nop 0
  buffer_load_dwordx4 v238, s[16:19], s56 offen lds
  s_mov_b32 m0, 6656
  s_nop 0
  buffer_load_dwordx4 v239, s[16:19], s56 offen lds
  s_add_i32 s56, s45, 2
  s_lshl_b32 s56, s56, 1
  s_add_i32 s56, s56, s41
  s_max_i32 s56, s56, 0
  s_min_i32 s56, s56, 223
  s_mul_i32 s56, s56, 86016
  v_xor_b32 v64, 32, v232
  s_mov_b32 m0, 15360
  s_nop 0
  buffer_load_dwordx4 v64, s[16:19], s56 offen lds
  v_xor_b32 v65, 32, v233
  s_mov_b32 m0, 16384
  s_nop 0
  buffer_load_dwordx4 v65, s[16:19], s56 offen lds
  v_xor_b32 v66, 32, v234
  s_mov_b32 m0, 17408
  s_nop 0
  buffer_load_dwordx4 v66, s[16:19], s56 offen lds
  v_xor_b32 v67, 32, v235
  s_mov_b32 m0, 18432
  s_nop 0
  buffer_load_dwordx4 v67, s[16:19], s56 offen lds
  v_xor_b32 v68, 32, v236
  s_mov_b32 m0, 19456
  s_nop 0
  buffer_load_dwordx4 v68, s[16:19], s56 offen lds
  v_xor_b32 v69, 32, v237
  s_mov_b32 m0, 20480
  s_nop 0
  buffer_load_dwordx4 v69, s[16:19], s56 offen lds
  v_xor_b32 v70, 32, v238
  s_mov_b32 m0, 21504
  s_nop 0
  buffer_load_dwordx4 v70, s[16:19], s56 offen lds
  v_xor_b32 v71, 32, v239
  s_mov_b32 m0, 22016
  s_nop 0
  buffer_load_dwordx4 v71, s[16:19], s56 offen lds
  s_add_i32 s56, s45, 4
  s_lshl_b32 s56, s56, 1
  s_add_i32 s56, s56, s41
  s_max_i32 s56, s56, 0
  s_min_i32 s56, s56, 223
  s_mul_i32 s56, s56, 86016
  v_xor_b32 v64, 64, v232
  s_mov_b32 m0, 30720
  s_nop 0
  buffer_load_dwordx4 v64, s[16:19], s56 offen lds
  v_xor_b32 v65, 64, v233
  s_mov_b32 m0, 31744
  s_nop 0
  buffer_load_dwordx4 v65, s[16:19], s56 offen lds
  v_xor_b32 v66, 64, v234
  s_mov_b32 m0, 32768
  s_nop 0
  buffer_load_dwordx4 v66, s[16:19], s56 offen lds
  v_xor_b32 v67, 64, v235
  s_mov_b32 m0, 33792
  s_nop 0
  buffer_load_dwordx4 v67, s[16:19], s56 offen lds
  v_xor_b32 v68, 64, v236
  s_mov_b32 m0, 34816
  s_nop 0
  buffer_load_dwordx4 v68, s[16:19], s56 offen lds
  v_xor_b32 v69, 64, v237
  s_mov_b32 m0, 35840
  s_nop 0
  buffer_load_dwordx4 v69, s[16:19], s56 offen lds
  v_xor_b32 v70, 64, v238
  s_mov_b32 m0, 36864
  s_nop 0
  buffer_load_dwordx4 v70, s[16:19], s56 offen lds
  v_xor_b32 v71, 64, v239
  s_mov_b32 m0, 37376
  s_nop 0
  buffer_load_dwordx4 v71, s[16:19], s56 offen lds
  s_add_i32 s56, s45, 6
  s_lshl_b32 s56, s56, 1
  s_add_i32 s56, s56, s41
  s_max_i32 s56, s56, 0
  s_min_i32 s56, s56, 223
  s_mul_i32 s56, s56, 86016
  v_xor_b32 v64, 96, v232
  s_mov_b32 m0, 46080
  s_nop 0
  buffer_load_dwordx4 v64, s[16:19], s56 offen lds
  v_xor_b32 v65, 96, v233
  s_mov_b32 m0, 47104
  s_nop 0
  buffer_load_dwordx4 v65, s[16:19], s56 offen lds
  v_xor_b32 v66, 96, v234
  s_mov_b32 m0, 48128
  s_nop 0
  buffer_load_dwordx4 v66, s[16:19], s56 offen lds
  v_xor_b32 v67, 96, v235
  s_mov_b32 m0, 49152
  s_nop 0
  buffer_load_dwordx4 v67, s[16:19], s56 offen lds
  v_xor_b32 v68, 96, v236
  s_mov_b32 m0, 50176
  s_nop 0
  buffer_load_dwordx4 v68, s[16:19], s56 offen lds
  v_xor_b32 v69, 96, v237
  s_mov_b32 m0, 51200
  s_nop 0
  buffer_load_dwordx4 v69, s[16:19], s56 offen lds
  v_xor_b32 v70, 96, v238
  s_mov_b32 m0, 52224
  s_nop 0
  buffer_load_dwordx4 v70, s[16:19], s56 offen lds
  v_xor_b32 v71, 96, v239
  s_mov_b32 m0, 52736
  s_nop 0
  buffer_load_dwordx4 v71, s[16:19], s56 offen lds
  s_add_i32 s56, s45, 8
  s_lshl_b32 s56, s56, 1
  s_add_i32 s56, s56, s41
  s_max_i32 s56, s56, 0
  s_min_i32 s56, s56, 223
  s_mul_i32 s56, s56, 86016
  s_mov_b32 m0, 61440
  s_nop 0
  buffer_load_dwordx4 v232, s[16:19], s56 offen lds
  s_mov_b32 m0, 62464
  s_nop 0
  buffer_load_dwordx4 v233, s[16:19], s56 offen lds
  s_mov_b32 m0, 63488
  s_nop 0
  buffer_load_dwordx4 v234, s[16:19], s56 offen lds
  s_mov_b32 m0, 64512
  s_nop 0
  buffer_load_dwordx4 v235, s[16:19], s56 offen lds
  s_mov_b32 m0, 65536
  s_nop 0
  buffer_load_dwordx4 v236, s[16:19], s56 offen lds
  s_mov_b32 m0, 66560
  s_nop 0
  buffer_load_dwordx4 v237, s[16:19], s56 offen lds
  s_mov_b32 m0, 67584
  s_nop 0
  buffer_load_dwordx4 v238, s[16:19], s56 offen lds
  s_mov_b32 m0, 68096
  s_nop 0
  buffer_load_dwordx4 v239, s[16:19], s56 offen lds
  v_add_u32 v4, 0, v1
  v_xor_b32 v4, 8, v4
  v_mul_u32_u24 v5, 2731, v4
  v_lshrrev_b32 v5, 16, v5
  v_mul_u32_u24 v5, 384, v5
  v_lshl_add_u32 v4, v4, 4, v5
  v_add_u32 v244, s46, v4
  v_add_u32 v247, 6144, v244
  v_add_u32 v250, 12288, v244
  v_max_i32 v244, 0, v244
  v_add_u32 v4, 64, v1
  v_xor_b32 v4, 8, v4
  v_mul_u32_u24 v5, 2731, v4
  v_lshrrev_b32 v5, 16, v5
  v_mul_u32_u24 v5, 384, v5
  v_lshl_add_u32 v4, v4, 4, v5
  v_add_u32 v245, s46, v4
  v_add_u32 v248, 6144, v245
  v_max_i32 v245, 0, v245
  v_add_u32 v4, 128, v1
  v_xor_b32 v4, 8, v4
  v_mul_u32_u24 v5, 2731, v4
  v_lshrrev_b32 v5, 16, v5
  v_mul_u32_u24 v5, 384, v5
  v_lshl_add_u32 v4, v4, 4, v5
  v_add_u32 v246, s46, v4
  v_add_u32 v249, 6144, v246
  v_max_i32 v246, 0, v246
  v_add_u32 v4, 416, v1
  v_xor_b32 v4, 8, v4
  v_mul_u32_u24 v5, 2731, v4
  v_lshrrev_b32 v5, 16, v5
  v_mul_u32_u24 v5, 384, v5
  v_lshl_add_u32 v4, v4, 4, v5
  v_add_u32 v251, s46, v4
  s_add_i32 s56, s45, 1
  s_lshl_b32 s56, s56, 1
  s_add_i32 s56, s56, s41
  s_max_i32 s56, s56, 0
  s_min_i32 s56, s56, 223
  s_mul_i32 s56, s56, 86016
  s_mov_b32 m0, 7680
  s_nop 0
  buffer_load_dwordx4 v244, s[16:19], s56 offen lds
  s_mov_b32 m0, 8704
  s_nop 0
  buffer_load_dwordx4 v245, s[16:19], s56 offen lds
  s_mov_b32 m0, 9728
  s_nop 0
  buffer_load_dwordx4 v246, s[16:19], s56 offen lds
  s_mov_b32 m0, 10752
  s_nop 0
  buffer_load_dwordx4 v247, s[16:19], s56 offen lds
  s_mov_b32 m0, 11776
  s_nop 0
  buffer_load_dwordx4 v248, s[16:19], s56 offen lds
  s_mov_b32 m0, 12800
  s_nop 0
  buffer_load_dwordx4 v249, s[16:19], s56 offen lds
  s_mov_b32 m0, 13824
  s_nop 0
  buffer_load_dwordx4 v250, s[16:19], s56 offen lds
  s_mov_b32 m0, 14336
  s_nop 0
  buffer_load_dwordx4 v251, s[16:19], s56 offen lds
  s_add_i32 s56, s45, 3
  s_lshl_b32 s56, s56, 1
  s_add_i32 s56, s56, s41
  s_max_i32 s56, s56, 0
  s_min_i32 s56, s56, 223
  s_mul_i32 s56, s56, 86016
  v_xor_b32 v64, 32, v244
  s_mov_b32 m0, 23040
  s_nop 0
  buffer_load_dwordx4 v64, s[16:19], s56 offen lds
  v_xor_b32 v65, 32, v245
  s_mov_b32 m0, 24064
  s_nop 0
  buffer_load_dwordx4 v65, s[16:19], s56 offen lds
  v_xor_b32 v66, 32, v246
  s_mov_b32 m0, 25088
  s_nop 0
  buffer_load_dwordx4 v66, s[16:19], s56 offen lds
  v_xor_b32 v67, 32, v247
  s_mov_b32 m0, 26112
  s_nop 0
  buffer_load_dwordx4 v67, s[16:19], s56 offen lds
  v_xor_b32 v68, 32, v248
  s_mov_b32 m0, 27136
  s_nop 0
  buffer_load_dwordx4 v68, s[16:19], s56 offen lds
  v_xor_b32 v69, 32, v249
  s_mov_b32 m0, 28160
  s_nop 0
  buffer_load_dwordx4 v69, s[16:19], s56 offen lds
  v_xor_b32 v70, 32, v250
  s_mov_b32 m0, 29184
  s_nop 0
  buffer_load_dwordx4 v70, s[16:19], s56 offen lds
  v_xor_b32 v71, 32, v251
  s_mov_b32 m0, 29696
  s_nop 0
  buffer_load_dwordx4 v71, s[16:19], s56 offen lds
  s_waitcnt vmcnt(40)
  s_add_i32 s56, s45, 5
  s_lshl_b32 s56, s56, 1
  s_add_i32 s56, s56, s41
  s_max_i32 s56, s56, 0
  s_min_i32 s56, s56, 223
  s_mul_i32 s56, s56, 86016
  v_xor_b32 v64, 64, v244
  s_mov_b32 m0, 38400
  s_nop 0
  buffer_load_dwordx4 v64, s[16:19], s56 offen lds
  v_xor_b32 v65, 64, v245
  s_mov_b32 m0, 39424
  s_nop 0
  buffer_load_dwordx4 v65, s[16:19], s56 offen lds
  v_xor_b32 v66, 64, v246
  s_mov_b32 m0, 40448
  s_nop 0
  buffer_load_dwordx4 v66, s[16:19], s56 offen lds
  v_xor_b32 v67, 64, v247
  s_mov_b32 m0, 41472
  s_nop 0
  buffer_load_dwordx4 v67, s[16:19], s56 offen lds
  v_xor_b32 v68, 64, v248
  s_mov_b32 m0, 42496
  s_nop 0
  buffer_load_dwordx4 v68, s[16:19], s56 offen lds
  v_xor_b32 v69, 64, v249
  s_mov_b32 m0, 43520
  s_nop 0
  buffer_load_dwordx4 v69, s[16:19], s56 offen lds
  v_xor_b32 v70, 64, v250
  s_mov_b32 m0, 44544
  s_nop 0
  buffer_load_dwordx4 v70, s[16:19], s56 offen lds
  v_xor_b32 v71, 64, v251
  s_mov_b32 m0, 45056
  s_nop 0
  buffer_load_dwordx4 v71, s[16:19], s56 offen lds
  s_add_i32 s56, s45, 7
  s_lshl_b32 s56, s56, 1
  s_add_i32 s56, s56, s41
  s_max_i32 s56, s56, 0
  s_min_i32 s56, s56, 223
  s_mul_i32 s56, s56, 86016
  v_xor_b32 v64, 96, v244
  s_mov_b32 m0, 53760
  s_nop 0
  buffer_load_dwordx4 v64, s[16:19], s56 offen lds
  v_xor_b32 v65, 96, v245
  s_mov_b32 m0, 54784
  s_nop 0
  buffer_load_dwordx4 v65, s[16:19], s56 offen lds
  v_xor_b32 v66, 96, v246
  s_mov_b32 m0, 55808
  s_nop 0
  buffer_load_dwordx4 v66, s[16:19], s56 offen lds
  v_xor_b32 v67, 96, v247
  s_mov_b32 m0, 56832
  s_nop 0
  buffer_load_dwordx4 v67, s[16:19], s56 offen lds
  v_xor_b32 v68, 96, v248
  s_mov_b32 m0, 57856
  s_nop 0
  buffer_load_dwordx4 v68, s[16:19], s56 offen lds
  v_xor_b32 v69, 96, v249
  s_mov_b32 m0, 58880
  s_nop 0
  buffer_load_dwordx4 v69, s[16:19], s56 offen lds
  v_xor_b32 v70, 96, v250
  s_mov_b32 m0, 59904
  s_nop 0
  buffer_load_dwordx4 v70, s[16:19], s56 offen lds
  v_xor_b32 v71, 96, v251
  s_mov_b32 m0, 60416
  s_nop 0
  buffer_load_dwordx4 v71, s[16:19], s56 offen lds
  s_waitcnt vmcnt(40)
  s_barrier
  s_waitcnt vmcnt(0)
  s_barrier
  s_add_i32 s56, s45, 16
  s_lshl_b32 s56, s56, 1
  s_add_i32 s56, s56, s41
  s_max_i32 s56, s56, 0
  s_min_i32 s56, s56, 223
  s_mul_i32 s56, s56, 86016
  s_mov_b32 m0, 122880
  s_nop 0
  buffer_load_dwordx4 v232, s[16:19], s56 offen lds
  s_mov_b32 m0, 123904
  s_nop 0
  buffer_load_dwordx4 v233, s[16:19], s56 offen lds
  s_mov_b32 m0, 124928
  s_nop 0
  buffer_load_dwordx4 v234, s[16:19], s56 offen lds
  s_mov_b32 m0, 125952
  s_nop 0
  buffer_load_dwordx4 v235, s[16:19], s56 offen lds
  s_mov_b32 m0, 126976
  s_nop 0
  buffer_load_dwordx4 v236, s[16:19], s56 offen lds
  s_mov_b32 m0, 128000
  s_nop 0
  buffer_load_dwordx4 v237, s[16:19], s56 offen lds
  s_mov_b32 m0, 129024
  s_nop 0
  buffer_load_dwordx4 v238, s[16:19], s56 offen lds
  s_mov_b32 m0, 129536
  s_nop 0
  buffer_load_dwordx4 v239, s[16:19], s56 offen lds
  s_add_i32 s56, s45, 17
  s_lshl_b32 s56, s56, 1
  s_add_i32 s56, s56, s41
  s_max_i32 s56, s56, 0
  s_min_i32 s56, s56, 223
  s_mul_i32 s56, s56, 86016
  s_mov_b32 m0, 130560
  s_nop 0
  buffer_load_dwordx4 v244, s[16:19], s56 offen lds
  s_mov_b32 m0, 131584
  s_nop 0
  buffer_load_dwordx4 v245, s[16:19], s56 offen lds
  s_mov_b32 m0, 132608
  s_nop 0
  buffer_load_dwordx4 v246, s[16:19], s56 offen lds
  s_mov_b32 m0, 133632
  s_nop 0
  buffer_load_dwordx4 v247, s[16:19], s56 offen lds
  s_mov_b32 m0, 134656
  s_nop 0
  buffer_load_dwordx4 v248, s[16:19], s56 offen lds
  s_mov_b32 m0, 135680
  s_nop 0
  buffer_load_dwordx4 v249, s[16:19], s56 offen lds
  s_mov_b32 m0, 136704
  s_nop 0
  buffer_load_dwordx4 v250, s[16:19], s56 offen lds
  s_mov_b32 m0, 137216
  s_nop 0
  buffer_load_dwordx4 v251, s[16:19], s56 offen lds
  s_add_i32 s56, s45, 18
  s_lshl_b32 s56, s56, 1
  s_add_i32 s56, s56, s41
  s_max_i32 s56, s56, 0
  s_min_i32 s56, s56, 223
  s_mul_i32 s56, s56, 86016
  v_xor_b32 v64, 32, v232
  s_mov_b32 m0, 138240
  s_nop 0
  buffer_load_dwordx4 v64, s[16:19], s56 offen lds
  v_xor_b32 v65, 32, v233
  s_mov_b32 m0, 139264
  s_nop 0
  buffer_load_dwordx4 v65, s[16:19], s56 offen lds
  v_xor_b32 v66, 32, v234
  s_mov_b32 m0, 140288
  s_nop 0
  buffer_load_dwordx4 v66, s[16:19], s56 offen lds
  v_xor_b32 v67, 32, v235
  s_mov_b32 m0, 141312
  s_nop 0
  buffer_load_dwordx4 v67, s[16:19], s56 offen lds
  v_xor_b32 v68, 32, v236
  s_mov_b32 m0, 142336
  s_nop 0
  buffer_load_dwordx4 v68, s[16:19], s56 offen lds
  v_xor_b32 v69, 32, v237
  s_mov_b32 m0, 143360
  s_nop 0
  buffer_load_dwordx4 v69, s[16:19], s56 offen lds
  v_xor_b32 v70, 32, v238
  s_mov_b32 m0, 144384
  s_nop 0
  buffer_load_dwordx4 v70, s[16:19], s56 offen lds
  v_xor_b32 v71, 32, v239
  s_mov_b32 m0, 144896
  s_nop 0
  buffer_load_dwordx4 v71, s[16:19], s56 offen lds
  s_add_i32 s56, s45, 19
  s_lshl_b32 s56, s56, 1
  s_add_i32 s56, s56, s41
  s_max_i32 s56, s56, 0
  s_min_i32 s56, s56, 223
  s_mul_i32 s56, s56, 86016
  v_xor_b32 v64, 32, v244
  s_mov_b32 m0, 145920
  s_nop 0
  buffer_load_dwordx4 v64, s[16:19], s56 offen lds
  v_xor_b32 v65, 32, v245
  s_mov_b32 m0, 146944
  s_nop 0
  buffer_load_dwordx4 v65, s[16:19], s56 offen lds
  v_xor_b32 v66, 32, v246
  s_mov_b32 m0, 147968
  s_nop 0
  buffer_load_dwordx4 v66, s[16:19], s56 offen lds
  v_xor_b32 v67, 32, v247
  s_mov_b32 m0, 148992
  s_nop 0
  buffer_load_dwordx4 v67, s[16:19], s56 offen lds
  v_xor_b32 v68, 32, v248
  s_mov_b32 m0, 150016
  s_nop 0
  buffer_load_dwordx4 v68, s[16:19], s56 offen lds
  v_xor_b32 v69, 32, v249
  s_mov_b32 m0, 151040
  s_nop 0
  buffer_load_dwordx4 v69, s[16:19], s56 offen lds
  v_xor_b32 v70, 32, v250
  s_mov_b32 m0, 152064
  s_nop 0
  buffer_load_dwordx4 v70, s[16:19], s56 offen lds
  v_xor_b32 v71, 32, v251
  s_mov_b32 m0, 152576
  s_nop 0
  buffer_load_dwordx4 v71, s[16:19], s56 offen lds
  s_waitcnt vmcnt(0)
  v_mov_b32 v6, 0
  s_mov_b32 s59, 0
  s_mov_b64 exec, 1
H_pollV:
  buffer_load_dword v7, v6, s[36:39], 0 offen offset:128 sc1
  s_waitcnt vmcnt(0)
  v_cmp_eq_u32 vcc, 0, v7
  s_add_u32 s59, s59, 1
  s_cmp_gt_u32 s59, 200000
  s_cbranch_scc1 H_pollV_x
  s_cmp_lg_u64 vcc, 0
  s_cbranch_scc0 H_pollV_x
  s_sleep 2
  s_branch H_pollV
H_pollV_x:
  s_mov_b64 exec, -1
  s_barrier
  s_mov_b32 m0, 153600
  s_mov_b32 s59, 0
  buffer_load_dwordx4 v252, s[24:27], s59 offen offset:0 sc1 lds
  buffer_load_dwordx4 v252, s[24:27], s59 offen offset:1024 sc1 lds
  buffer_load_dwordx4 v252, s[24:27], s59 offen offset:2048 sc1 lds
  buffer_load_dwordx4 v252, s[24:27], s59 offen offset:3072 sc1 lds
  s_mov_b32 m0, 157696
  s_mov_b32 s59, 4096
  buffer_load_dwordx4 v252, s[24:27], s59 offen offset:0 sc1 lds
  buffer_load_dwordx4 v252, s[24:27], s59 offen offset:1024 sc1 lds
  buffer_load_dwordx4 v252, s[24:27], s59 offen offset:2048 sc1 lds
  buffer_load_dwordx4 v252, s[24:27], s59 offen offset:3072 sc1 lds
  s_mov_b32 m0, 161792
  s_mov_b32 s59, 8192
  buffer_load_dwordx4 v252, s[24:27], s59 offen offset:0 sc1 lds
  buffer_load_dwordx4 v252, s[24:27], s59 offen offset:1024 sc1 lds
  s_waitcnt vmcnt(0)
  s_barrier
  s_mov_b32 m0, 0
  s_mov_b32 s59, 24576
  buffer_load_dwordx4 v252, s[24:27], s59 offen offset:0 sc1 lds
  buffer_load_dwordx4 v252, s[24:27], s59 offen offset:1024 sc1 lds
  buffer_load_dwordx4 v252, s[24:27], s59 offen offset:2048 sc1 lds
  buffer_load_dwordx4 v252, s[24:27], s59 offen offset:3072 sc1 lds
  s_mov_b32 m0, 4096
  s_mov_b32 s59, 28672
  buffer_load_dwordx4 v252, s[24:27], s59 offen offset:0 sc1 lds
  buffer_load_dwordx4 v252, s[24:27], s59 offen offset:1024 sc1 lds
  buffer_load_dwordx4 v252, s[24:27], s59 offen offset:2048 sc1 lds
  buffer_load_dwordx4 v252, s[24:27], s59 offen offset:3072 sc1 lds
  s_mov_b32 m0, 8192
  s_mov_b32 s59, 32768
  buffer_load_dwordx4 v252, s[24:27], s59 offen offset:0 sc1 lds
  buffer_load_dwordx4 v252, s[24:27], s59 offen offset:1024 sc1 lds
  buffer_load_dwordx4 v252, s[24:27], s59 offen offset:2048 sc1 lds
  buffer_load_dwordx4 v252, s[24:27], s59 offen offset:3072 sc1 lds
  s_waitcnt vmcnt(0)
  s_barrier
M_done:
  s_endpgm
CODE_END:
.section .rodata,"a"
.p2align 6
.amdhsa_kernel standalone__neighborhood_nat__vision_kernel
  .amdhsa_next_free_vgpr 256
  .amdhsa_next_free_sgpr 102
  .amdhsa_accum_offset 256
  .amdhsa_group_segment_fixed_size 0
  .amdhsa_kernarg_size 48
  .amdhsa_user_sgpr_count 2
  .amdhsa_user_sgpr_kernarg_segment_ptr 1
  .amdhsa_system_sgpr_workgroup_id_x 1
.end_amdhsa_kernel
```

```asm
; @launch grid=(256,1,1) block=(512,1,1) lds=163840
.amdgcn_target "amdgcn-amd-amdhsa--gfx950"
.text
.globl standalone__neighborhood_nat__vision_kernel
.p2align 8
.type standalone__neighborhood_nat__vision_kernel,@function
standalone__neighborhood_nat__vision_kernel:
  s_cmp_ge_u32 s2, 256
  s_cbranch_scc1 M_done
  s_load_dwordx8 s[4:11], s[0:1], 0
  s_load_dwordx4 s[12:15], s[0:1], 32
  v_lshrrev_b32 v4, 6, v0
  v_and_b32 v1, 63, v0
  v_readfirstlane_b32 s40, v4
  v_lshrrev_b32 v2, 4, v1
  v_and_b32 v3, 15, v1
  v_lshlrev_b32 v252, 4, v1
  s_getpc_b64 s[16:17]
  s_and_b32 s16, s16, -256
  s_and_b32 s17, s17, 0xffff
  s_mov_b32 s18, CODE_END-standalone__neighborhood_nat__vision_kernel
  s_mov_b32 s19, 0x00020000
  s_lshr_b32 s55, s2, 3
  s_lshl_b32 s55, s55, 10
  s_cmp_lg_u32 s40, 3
  s_cbranch_scc1 M_nocpf
  buffer_load_dwordx4 v[136:139], v252, s[16:19], s55 offen
M_nocpf:
  v_bfe_u32 v5, v1, 2, 2
  v_lshrrev_b32 v6, 5, v1
  v_lshlrev_b32 v7, 1, v6
  v_and_b32 v8, 3, v1
  v_xor_b32 v7, v7, v8
  v_lshlrev_b32 v7, 4, v7
  s_movk_i32 s60, 1152
  v_lshl_add_u32 v4, v2, 3, v5
  v_mad_u32_u24 v200, v4, s60, v7
  v_lshl_add_u32 v4, v2, 5, v5
  v_mad_u32_u24 v201, v4, s60, v7
  v_mul_u32_u24 v6, 55296, v6
  v_sub_u32 v202, v201, v6
  v_lshrrev_b32 v4, 2, v1
  v_mad_u32_u24 v203, v4, s60, v7
  v_lshrrev_b32 v4, 3, v3
  v_lshlrev_b32 v4, 1, v4
  v_xor_b32 v4, v4, v2
  v_lshl_add_u32 v4, v3, 2, v4
  v_lshlrev_b32 v195, 4, v4
  s_and_b32 s55, s2, 7
  s_lshr_b32 s56, s2, 3
  s_lshr_b32 s41, s55, 2
  s_bfe_u32 s42, s55, 0x10001
  s_and_b32 s55, s55, 1
  s_lshl_b32 s55, s55, 2
  s_lshr_b32 s43, s56, 3
  s_add_u32 s43, s43, s55
  s_and_b32 s44, s56, 7
  s_mul_i32 s43, s43, 14
  s_mul_i32 s44, s44, 14
  s_cmp_lt_u32 s40, 4
  s_waitcnt lgkmcnt(0)
  s_mov_b32 s28, s6
  s_mov_b32 s29, s7
  s_mov_b32 s30, 221184
  s_mov_b32 s31, 0x00020000
  s_cbranch_scc1 M_mw
  s_mov_b32 s16, s4
  s_and_b32 s17, s5, 0xffff
  s_mov_b32 s18, 19267584
  s_mov_b32 s19, 0x00020000
  s_mov_b32 s24, s14
  s_and_b32 s25, s15, 0xffff
  s_mov_b32 s26, 268435456
  s_mov_b32 s27, 0x00020000
  s_mov_b32 s20, s10
  s_and_b32 s21, s11, 0xffff
  s_mov_b32 s22, 19267584
  s_mov_b32 s23, 0x00020000
  s_mov_b32 s36, s12
  s_and_b32 s37, s13, 0xffff
  s_mov_b32 s38, 256
  s_mov_b32 s39, 0x00020000
  s_mul_i32 s61, s41, 13
  s_add_i32 s61, s61, -6
  s_mul_i32 s62, s42, 13
  s_add_i32 s62, s62, -6
  s_cmp_ge_u32 s40, 4
  s_cselect_b32 s53, -4, 3
  s_add_i32 s53, s53, s40
  s_lshl_b32 s53, s53, 1
  s_mul_i32 s55, s41, 6
  s_add_i32 s45, s43, s55
  s_add_i32 s45, s45, -6
  s_cmp_eq_i32 s45, -6
  s_cselect_b32 s47, 6, 0
  s_cmp_eq_i32 s45, 98
  s_cselect_b32 s48, 7, 13
  s_cselect_b32 s49, 2, 0
  s_sub_i32 s45, s45, s49
  s_mul_i32 s55, s42, 6
  s_add_i32 s56, s44, s55
  s_add_i32 s56, s56, -6
  s_cmp_eq_i32 s56, -6
  s_cselect_b32 s50, 6, 0
  s_cmp_eq_i32 s56, 98
  s_cselect_b32 s51, 7, 13
  s_lshl_b32 s56, s56, 1
  s_add_i32 s56, s56, s42
  s_mul_i32 s46, s56, 384
  s_max_i32 s92, s53, s47
  s_min_i32 s92, s92, s48
  s_and_b32 s92, s92, -2
  s_add_u32 s52, s92, s49
  s_mov_b32 s54, 4286578688
  s_mov_b32 s63, 1037384597
  s_and_b32 s93, s40, 1
  s_lshl_b32 s93, s93, 3
  s_and_b32 s56, s40, 6
  s_or_b32 s93, s93, s56
  s_add_u32 s56, s40, 8
  s_add_i32 s100, s45, s56
  s_lshl_b32 s100, s100, 1
  s_add_i32 s100, s100, s41
  s_max_i32 s100, s100, 0
  s_min_i32 s100, s100, 223
  s_mul_i32 s100, s100, 86016
  s_mul_i32 s101, s56, 7680
  s_add_u32 s4, s43, s53
  s_mov_b32 s5, 86016
  s_movk_i32 s6, 384
  s_cmp_eq_u32 s40, 4
  s_cselect_b32 s94, s2, 999
  s_mov_b32 s0, 0x55555555
  s_mov_b32 s1, 0x55555555
  s_mov_b32 s10, 0x33333333
  s_mov_b32 s11, 0x33333333
  s_mov_b32 vcc_lo, 0
  s_mov_b32 vcc_hi, -1
  s_mov_b32 s32, s8
  s_and_b32 s33, s9, 0xffff
  s_mov_b32 s34, 73728
  s_mov_b32 s35, 0x00020000
  v_bfe_u32 v4, v1, 2, 2
  v_and_b32 v5, 3, v1
  v_lshrrev_b32 v6, 5, v1
  v_lshl_add_u32 v5, v2, 2, v5
  v_lshlrev_b32 v6, 7, v6
  v_sub_u32 v6, 256, v6
  v_lshrrev_b32 v197, 1, v4
  v_and_b32 v255, 1, v4
  v_add_u32 v197, s4, v197
  v_lshl_add_u32 v0, v255, 2, s44
  v_lshl_add_u32 v198, v197, 1, s61
  v_add_u32 v199, 112, v197
  v_lshlrev_b32 v255, 30, v255
  v_med3_i32 v197, v198, v197, v199
  v_mul_lo_u32 v197, v197, s5
  v_lshl_add_u32 v197, v5, 4, v197
  v_add_u32 v16, 0, v0
  v_lshl_add_u32 v198, v16, 1, s62
  v_add_u32 v199, 112, v16
  v_med3_i32 v16, v198, v16, v199
  v_mad_u32_u24 v16, v16, s6, v197
  v_add_u32 v20, 1, v0
  v_lshl_add_u32 v198, v20, 1, s62
  v_add_u32 v199, 112, v20
  v_med3_i32 v20, v198, v20, v199
  v_mad_u32_u24 v20, v20, s6, v197
  v_add_u32 v24, 2, v0
  v_lshl_add_u32 v198, v24, 1, s62
  v_add_u32 v199, 112, v24
  v_med3_i32 v24, v198, v24, v199
  v_mad_u32_u24 v24, v24, s6, v197
  v_add_u32 v28, 3, v0
  v_lshl_add_u32 v198, v28, 1, s62
  v_add_u32 v199, 112, v28
  v_med3_i32 v28, v198, v28, v199
  v_mad_u32_u24 v28, v28, s6, v197
  v_add_u32 v28, v28, v255
  v_add_u32 v40, 7, v0
  v_lshl_add_u32 v198, v40, 1, s62
  v_add_u32 v199, 112, v40
  v_med3_i32 v40, v198, v40, v199
  v_mad_u32_u24 v40, v40, s6, v197
  v_add_u32 v44, 8, v0
  v_lshl_add_u32 v198, v44, 1, s62
  v_add_u32 v199, 112, v44
  v_med3_i32 v44, v198, v44, v199
  v_mad_u32_u24 v44, v44, s6, v197
  v_add_u32 v48, 9, v0
  v_lshl_add_u32 v198, v48, 1, s62
  v_add_u32 v199, 112, v48
  v_med3_i32 v48, v198, v48, v199
  v_mad_u32_u24 v48, v48, s6, v197
  v_add_u32 v52, 10, v0
  v_lshl_add_u32 v198, v52, 1, s62
  v_add_u32 v199, 112, v52
  v_med3_i32 v52, v198, v52, v199
  v_mad_u32_u24 v52, v52, s6, v197
  v_add_u32 v52, v52, v255
  v_cndmask_b32 v32, v16, v40, vcc
  v_cndmask_b32 v36, v20, v44, vcc
  v_cndmask_b32 v56, v24, v48, vcc
  v_cndmask_b32 v60, v28, v52, vcc
  v_add_u32 v32, v32, v6
  v_add_u32 v36, v36, v6
  v_add_u32 v56, v56, v6
  v_add_u32 v60, v60, v6
  v_lshrrev_b32 v4, 3, v3
  v_add_u32 v4, s53, v4
  v_max_i32 v4, s47, v4
  v_min_i32 v4, s48, v4
  v_subrev_u32 v4, s92, v4
  v_and_b32 v5, 1, v2
  v_sub_u32 v6, v5, v4
  v_ashrrev_i32 v12, 31, v6
  v_and_b32 v12, s54, v12
  v_sub_u32 v6, v4, v5
  v_ashrrev_i32 v13, 31, v6
  v_and_b32 v13, s54, v13
  v_and_b32 v4, 7, v3
  v_lshrrev_b32 v5, 1, v2
  v_subrev_u32 v7, 7, v4
  v_ashrrev_i32 v7, 31, v7
  v_and_b32 v7, 0x7f, v7
  v_add_u32 v6, 0, v4
  v_max_i32 v6, s50, v6
  v_min_i32 v6, s51, v6
  v_lshlrev_b32 v6, v6, v7
  v_lshrrev_b32 v6, v5, v6
  v_not_b32 v14, v6
  v_add_u32 v6, 7, v4
  v_max_i32 v6, s50, v6
  v_min_i32 v6, s51, v6
  v_lshlrev_b32 v6, v6, v7
  v_lshrrev_b32 v6, v5, v6
  v_not_b32 v15, v6
  v_add_u32 v4, s52, v4
  v_and_b32 v5, 1, v4
  v_lshlrev_b32 v5, 3, v5
  v_and_or_b32 v5, v4, 6, v5
  v_mul_u32_u24 v4, 7680, v4
  v_lshrrev_b32 v6, 3, v3
  v_mul_u32_u24 v6, 24, v6
  v_add_u32 v6, v6, v2
  v_add_u32 v7, 0, v6
  v_xor_b32 v7, v7, v5
  v_lshl_add_u32 v240, v7, 4, v4
  v_add_u32 v7, 4, v6
  v_xor_b32 v7, v7, v5
  v_lshl_add_u32 v241, v7, 4, v4
  v_add_u32 v7, 8, v6
  v_xor_b32 v7, v7, v5
  v_lshl_add_u32 v242, v7, 4, v4
  v_add_u32 v7, 12, v6
  v_xor_b32 v7, v7, v5
  v_lshl_add_u32 v243, v7, 4, v4
  v_and_b32 v4, 1, v2
  v_lshlrev_b32 v4, 2, v4
  v_lshrrev_b32 v5, 2, v3
  v_add3_u32 v4, v4, v5, s52
  v_and_b32 v5, 1, v4
  v_lshlrev_b32 v5, 3, v5
  v_and_or_b32 v5, v4, 6, v5
  v_mul_u32_u24 v4, 7680, v4
  v_and_b32 v6, 1, v3
  v_lshl_add_u32 v4, v6, 3, v4
  v_lshrrev_b32 v6, 1, v2
  v_mul_u32_u24 v6, 24, v6
  v_bfe_u32 v7, v3, 1, 1
  v_add_u32 v6, v6, v7
  v_add_u32 v7, 0, v6
  v_xor_b32 v7, v7, v5
  v_lshl_add_u32 v244, v7, 4, v4
  v_add_u32 v7, 2, v6
  v_xor_b32 v7, v7, v5
  v_lshl_add_u32 v245, v7, 4, v4
  v_add_u32 v7, 4, v6
  v_xor_b32 v7, v7, v5
  v_lshl_add_u32 v246, v7, 4, v4
  v_add_u32 v7, 6, v6
  v_xor_b32 v7, v7, v5
  v_lshl_add_u32 v247, v7, 4, v4
  v_add_u32 v7, 8, v6
  v_xor_b32 v7, v7, v5
  v_lshl_add_u32 v248, v7, 4, v4
  v_add_u32 v7, 10, v6
  v_xor_b32 v7, v7, v5
  v_lshl_add_u32 v249, v7, 4, v4
  v_add_u32 v7, 12, v6
  v_xor_b32 v7, v7, v5
  v_lshl_add_u32 v250, v7, 4, v4
  v_add_u32 v7, 14, v6
  v_xor_b32 v7, v7, v5
  v_lshl_add_u32 v251, v7, 4, v4
  v_add_u32 v253, 153600, v252
  v_add_u32 v254, 90112, v252
  v_add_u32 v4, 0, v1
  v_xor_b32 v4, s93, v4
  v_mul_u32_u24 v5, 2731, v4
  v_lshrrev_b32 v5, 16, v5
  v_mul_u32_u24 v5, 384, v5
  v_lshl_add_u32 v4, v4, 4, v5
  v_add_u32 v232, s46, v4
  v_add_u32 v235, 6144, v232
  v_add_u32 v238, 12288, v232
  v_max_i32 v232, 0, v232
  v_add_u32 v4, 64, v1
  v_xor_b32 v4, s93, v4
  v_mul_u32_u24 v5, 2731, v4
  v_lshrrev_b32 v5, 16, v5
  v_mul_u32_u24 v5, 384, v5
  v_lshl_add_u32 v4, v4, 4, v5
  v_add_u32 v233, s46, v4
  v_add_u32 v236, 6144, v233
  v_max_i32 v233, 0, v233
  v_add_u32 v4, 128, v1
  v_xor_b32 v4, s93, v4
  v_mul_u32_u24 v5, 2731, v4
  v_lshrrev_b32 v5, 16, v5
  v_mul_u32_u24 v5, 384, v5
  v_lshl_add_u32 v4, v4, 4, v5
  v_add_u32 v234, s46, v4
  v_add_u32 v237, 6144, v234
  v_max_i32 v234, 0, v234
  v_add_u32 v4, 416, v1
  v_xor_b32 v4, s93, v4
  v_mul_u32_u24 v5, 2731, v4
  v_lshrrev_b32 v5, 16, v5
  v_mul_u32_u24 v5, 384, v5
  v_lshl_add_u32 v4, v4, 4, v5
  v_add_u32 v239, s46, v4
  v_lshrrev_b32 v197, 1, v2
  v_and_b32 v255, 1, v2
  v_add_u32 v197, s4, v197
  v_lshl_add_u32 v0, v255, 2, s44
  v_lshl_add_u32 v198, v197, 1, s61
  v_add_u32 v199, 112, v197
  v_lshlrev_b32 v255, 30, v255
  v_med3_i32 v197, v198, v197, v199
  v_mul_lo_u32 v197, v197, s5
  v_lshl_add_u32 v197, v3, 3, v197
  v_add_u32 v4, 0, v0
  v_lshl_add_u32 v198, v4, 1, s62
  v_add_u32 v199, 112, v4
  v_med3_i32 v4, v198, v4, v199
  v_mad_u32_u24 v4, v4, s6, v197
  v_add_u32 v5, 1, v0
  v_lshl_add_u32 v198, v5, 1, s62
  v_add_u32 v199, 112, v5
  v_med3_i32 v5, v198, v5, v199
  v_mad_u32_u24 v5, v5, s6, v197
  v_add_u32 v6, 2, v0
  v_lshl_add_u32 v198, v6, 1, s62
  v_add_u32 v199, 112, v6
  v_med3_i32 v6, v198, v6, v199
  v_mad_u32_u24 v6, v6, s6, v197
  v_add_u32 v7, 3, v0
  v_lshl_add_u32 v198, v7, 1, s62
  v_add_u32 v199, 112, v7
  v_med3_i32 v7, v198, v7, v199
  v_mad_u32_u24 v7, v7, s6, v197
  v_add_u32 v7, v7, v255
  v_add_u32 v8, 7, v0
  v_lshl_add_u32 v198, v8, 1, s62
  v_add_u32 v199, 112, v8
  v_med3_i32 v8, v198, v8, v199
  v_mad_u32_u24 v8, v8, s6, v197
  v_add_u32 v9, 8, v0
  v_lshl_add_u32 v198, v9, 1, s62
  v_add_u32 v199, 112, v9
  v_med3_i32 v9, v198, v9, v199
  v_mad_u32_u24 v9, v9, s6, v197
  v_add_u32 v10, 9, v0
  v_lshl_add_u32 v198, v10, 1, s62
  v_add_u32 v199, 112, v10
  v_med3_i32 v10, v198, v10, v199
  v_mad_u32_u24 v10, v10, s6, v197
  v_add_u32 v11, 10, v0
  v_lshl_add_u32 v198, v11, 1, s62
  v_add_u32 v199, 112, v11
  v_med3_i32 v11, v198, v11, v199
  v_mad_u32_u24 v11, v11, s6, v197
  v_add_u32 v11, v11, v255
  s_and_b32 s55, s40, 3
  s_mul_i32 s57, s55, 6144
  s_mul_i32 s56, s55, 4608
  s_add_u32 m0, s57, 0
  s_nop 0
  buffer_load_dwordx4 v201, s[28:31], s56 offen offset:0 lds
  s_add_u32 m0, s57, 960
  s_nop 0
  buffer_load_dwordx4 v201, s[28:31], s56 offen offset:64 lds
  s_add_u32 m0, s57, 1920
  s_nop 0
  buffer_load_dwordx4 v201, s[28:31], s56 offen offset:128 lds
  s_add_u32 m0, s57, 2880
  s_nop 0
  buffer_load_dwordx4 v201, s[28:31], s56 offen offset:192 lds
  s_add_u32 m0, s57, 3840
  s_nop 0
  buffer_load_dwordx4 v201, s[28:31], s56 offen offset:256 lds
  s_add_u32 m0, s57, 4800
  s_nop 0
  buffer_load_dwordx4 v201, s[28:31], s56 offen offset:320 lds
  s_add_u32 s56, s56, 18432
  s_add_u32 m0, s57, 24576
  s_nop 0
  buffer_load_dwordx4 v201, s[28:31], s56 offen offset:0 lds
  s_add_u32 m0, s57, 25536
  s_nop 0
  buffer_load_dwordx4 v201, s[28:31], s56 offen offset:64 lds
  s_add_u32 m0, s57, 26496
  s_nop 0
  buffer_load_dwordx4 v201, s[28:31], s56 offen offset:128 lds
  s_add_u32 m0, s57, 27456
  s_nop 0
  buffer_load_dwordx4 v201, s[28:31], s56 offen offset:192 lds
  s_add_u32 m0, s57, 28416
  s_nop 0
  buffer_load_dwordx4 v201, s[28:31], s56 offen offset:256 lds
  s_add_u32 m0, s57, 29376
  s_nop 0
  buffer_load_dwordx4 v201, s[28:31], s56 offen offset:320 lds
  s_add_u32 s56, s56, 129024
  s_waitcnt vmcnt(6)
  s_barrier
  s_add_u32 m0, s57, 49152
  s_nop 0
  buffer_load_dwordx4 v202, s[28:31], s56 offen offset:0 lds
  s_add_u32 m0, s57, 50112
  s_nop 0
  buffer_load_dwordx4 v202, s[28:31], s56 offen offset:64 lds
  s_add_u32 m0, s57, 51072
  s_nop 0
  buffer_load_dwordx4 v202, s[28:31], s56 offen offset:128 lds
  s_add_u32 m0, s57, 52032
  s_nop 0
  buffer_load_dwordx4 v202, s[28:31], s56 offen offset:192 lds
  s_add_u32 m0, s57, 52992
  s_nop 0
  buffer_load_dwordx4 v202, s[28:31], s56 offen offset:256 lds
  s_add_u32 m0, s57, 53952
  s_nop 0
  buffer_load_dwordx4 v202, s[28:31], s56 offen offset:320 lds
  s_waitcnt vmcnt(4)
  buffer_load_dwordx4 v[16:19], v16, s[16:19], 0 offen
  buffer_load_dwordx4 v[20:23], v20, s[16:19], 0 offen
  buffer_load_dwordx4 v[24:27], v24, s[16:19], 0 offen
  buffer_load_dwordx4 v[28:31], v28, s[16:19], 0 offen
  buffer_load_dwordx4 v[40:43], v40, s[16:19], 0 offen
  buffer_load_dwordx4 v[44:47], v44, s[16:19], 0 offen
  s_waitcnt vmcnt(6)
  s_barrier
  buffer_load_dwordx4 v[48:51], v48, s[16:19], 0 offen
  buffer_load_dwordx4 v[52:55], v52, s[16:19], 0 offen
  buffer_load_dwordx4 v[32:35], v32, s[16:19], 0 offen
  buffer_load_dwordx4 v[36:39], v36, s[16:19], 0 offen
  buffer_load_dwordx4 v[56:59], v56, s[16:19], 0 offen
  buffer_load_dwordx4 v[60:63], v60, s[16:19], 0 offen
  s_mov_b64 vcc, s[0:1]
  s_waitcnt vmcnt(10)
  v_cndmask_b32_dpp v168, v20, v16, vcc quad_perm:[1,0,3,2] row_mask:0xf bank_mask:0xf
  v_cndmask_b32_dpp v169, v21, v17, vcc quad_perm:[1,0,3,2] row_mask:0xf bank_mask:0xf
  v_cndmask_b32_dpp v170, v22, v18, vcc quad_perm:[1,0,3,2] row_mask:0xf bank_mask:0xf
  v_cndmask_b32_dpp v171, v23, v19, vcc quad_perm:[1,0,3,2] row_mask:0xf bank_mask:0xf
  s_waitcnt vmcnt(8)
  v_cndmask_b32_dpp v176, v28, v24, vcc quad_perm:[1,0,3,2] row_mask:0xf bank_mask:0xf
  v_cndmask_b32_dpp v177, v29, v25, vcc quad_perm:[1,0,3,2] row_mask:0xf bank_mask:0xf
  v_cndmask_b32_dpp v178, v30, v26, vcc quad_perm:[1,0,3,2] row_mask:0xf bank_mask:0xf
  v_cndmask_b32_dpp v179, v31, v27, vcc quad_perm:[1,0,3,2] row_mask:0xf bank_mask:0xf
  s_not_b64 vcc, vcc
  v_cndmask_b32_dpp v172, v16, v20, vcc quad_perm:[1,0,3,2] row_mask:0xf bank_mask:0xf
  v_cndmask_b32_dpp v173, v17, v21, vcc quad_perm:[1,0,3,2] row_mask:0xf bank_mask:0xf
  v_cndmask_b32_dpp v174, v18, v22, vcc quad_perm:[1,0,3,2] row_mask:0xf bank_mask:0xf
  v_cndmask_b32_dpp v175, v19, v23, vcc quad_perm:[1,0,3,2] row_mask:0xf bank_mask:0xf
  v_cndmask_b32_dpp v180, v24, v28, vcc quad_perm:[1,0,3,2] row_mask:0xf bank_mask:0xf
  v_cndmask_b32_dpp v181, v25, v29, vcc quad_perm:[1,0,3,2] row_mask:0xf bank_mask:0xf
  v_cndmask_b32_dpp v182, v26, v30, vcc quad_perm:[1,0,3,2] row_mask:0xf bank_mask:0xf
  v_cndmask_b32_dpp v183, v27, v31, vcc quad_perm:[1,0,3,2] row_mask:0xf bank_mask:0xf
  s_mov_b64 vcc, s[10:11]
  v_cndmask_b32_dpp v16, v176, v168, vcc quad_perm:[2,3,0,1] row_mask:0xf bank_mask:0xf
  v_cndmask_b32_dpp v17, v177, v169, vcc quad_perm:[2,3,0,1] row_mask:0xf bank_mask:0xf
  v_cndmask_b32_dpp v18, v178, v170, vcc quad_perm:[2,3,0,1] row_mask:0xf bank_mask:0xf
  v_cndmask_b32_dpp v19, v179, v171, vcc quad_perm:[2,3,0,1] row_mask:0xf bank_mask:0xf
  v_cndmask_b32_dpp v20, v180, v172, vcc quad_perm:[2,3,0,1] row_mask:0xf bank_mask:0xf
  v_cndmask_b32_dpp v21, v181, v173, vcc quad_perm:[2,3,0,1] row_mask:0xf bank_mask:0xf
  v_cndmask_b32_dpp v22, v182, v174, vcc quad_perm:[2,3,0,1] row_mask:0xf bank_mask:0xf
  v_cndmask_b32_dpp v23, v183, v175, vcc quad_perm:[2,3,0,1] row_mask:0xf bank_mask:0xf
  s_not_b64 vcc, vcc
  v_cndmask_b32_dpp v24, v168, v176, vcc quad_perm:[2,3,0,1] row_mask:0xf bank_mask:0xf
  v_cndmask_b32_dpp v25, v169, v177, vcc quad_perm:[2,3,0,1] row_mask:0xf bank_mask:0xf
  v_cndmask_b32_dpp v26, v170, v178, vcc quad_perm:[2,3,0,1] row_mask:0xf bank_mask:0xf
  v_cndmask_b32_dpp v27, v171, v179, vcc quad_perm:[2,3,0,1] row_mask:0xf bank_mask:0xf
  v_cndmask_b32_dpp v28, v172, v180, vcc quad_perm:[2,3,0,1] row_mask:0xf bank_mask:0xf
  v_cndmask_b32_dpp v29, v173, v181, vcc quad_perm:[2,3,0,1] row_mask:0xf bank_mask:0xf
  v_cndmask_b32_dpp v30, v174, v182, vcc quad_perm:[2,3,0,1] row_mask:0xf bank_mask:0xf
  v_cndmask_b32_dpp v31, v175, v183, vcc quad_perm:[2,3,0,1] row_mask:0xf bank_mask:0xf
  s_mov_b64 vcc, s[0:1]
  s_waitcnt vmcnt(6)
  v_cndmask_b32_dpp v168, v44, v40, vcc quad_perm:[1,0,3,2] row_mask:0xf bank_mask:0xf
  v_cndmask_b32_dpp v169, v45, v41, vcc quad_perm:[1,0,3,2] row_mask:0xf bank_mask:0xf
  v_cndmask_b32_dpp v170, v46, v42, vcc quad_perm:[1,0,3,2] row_mask:0xf bank_mask:0xf
  v_cndmask_b32_dpp v171, v47, v43, vcc quad_perm:[1,0,3,2] row_mask:0xf bank_mask:0xf
  s_waitcnt vmcnt(4)
  v_cndmask_b32_dpp v176, v52, v48, vcc quad_perm:[1,0,3,2] row_mask:0xf bank_mask:0xf
  v_cndmask_b32_dpp v177, v53, v49, vcc quad_perm:[1,0,3,2] row_mask:0xf bank_mask:0xf
  v_cndmask_b32_dpp v178, v54, v50, vcc quad_perm:[1,0,3,2] row_mask:0xf bank_mask:0xf
  v_cndmask_b32_dpp v179, v55, v51, vcc quad_perm:[1,0,3,2] row_mask:0xf bank_mask:0xf
  s_not_b64 vcc, vcc
  v_cndmask_b32_dpp v172, v40, v44, vcc quad_perm:[1,0,3,2] row_mask:0xf bank_mask:0xf
  v_cndmask_b32_dpp v173, v41, v45, vcc quad_perm:[1,0,3,2] row_mask:0xf bank_mask:0xf
  v_cndmask_b32_dpp v174, v42, v46, vcc quad_perm:[1,0,3,2] row_mask:0xf bank_mask:0xf
  v_cndmask_b32_dpp v175, v43, v47, vcc quad_perm:[1,0,3,2] row_mask:0xf bank_mask:0xf
  v_cndmask_b32_dpp v180, v48, v52, vcc quad_perm:[1,0,3,2] row_mask:0xf bank_mask:0xf
  v_cndmask_b32_dpp v181, v49, v53, vcc quad_perm:[1,0,3,2] row_mask:0xf bank_mask:0xf
  v_cndmask_b32_dpp v182, v50, v54, vcc quad_perm:[1,0,3,2] row_mask:0xf bank_mask:0xf
  v_cndmask_b32_dpp v183, v51, v55, vcc quad_perm:[1,0,3,2] row_mask:0xf bank_mask:0xf
  s_mov_b64 vcc, s[10:11]
  v_cndmask_b32_dpp v40, v176, v168, vcc quad_perm:[2,3,0,1] row_mask:0xf bank_mask:0xf
  v_cndmask_b32_dpp v41, v177, v169, vcc quad_perm:[2,3,0,1] row_mask:0xf bank_mask:0xf
  v_cndmask_b32_dpp v42, v178, v170, vcc quad_perm:[2,3,0,1] row_mask:0xf bank_mask:0xf
  v_cndmask_b32_dpp v43, v179, v171, vcc quad_perm:[2,3,0,1] row_mask:0xf bank_mask:0xf
  v_cndmask_b32_dpp v44, v180, v172, vcc quad_perm:[2,3,0,1] row_mask:0xf bank_mask:0xf
  v_cndmask_b32_dpp v45, v181, v173, vcc quad_perm:[2,3,0,1] row_mask:0xf bank_mask:0xf
  v_cndmask_b32_dpp v46, v182, v174, vcc quad_perm:[2,3,0,1] row_mask:0xf bank_mask:0xf
  v_cndmask_b32_dpp v47, v183, v175, vcc quad_perm:[2,3,0,1] row_mask:0xf bank_mask:0xf
  s_not_b64 vcc, vcc
  v_cndmask_b32_dpp v48, v168, v176, vcc quad_perm:[2,3,0,1] row_mask:0xf bank_mask:0xf
  v_cndmask_b32_dpp v49, v169, v177, vcc quad_perm:[2,3,0,1] row_mask:0xf bank_mask:0xf
  v_cndmask_b32_dpp v50, v170, v178, vcc quad_perm:[2,3,0,1] row_mask:0xf bank_mask:0xf
  v_cndmask_b32_dpp v51, v171, v179, vcc quad_perm:[2,3,0,1] row_mask:0xf bank_mask:0xf
  v_cndmask_b32_dpp v52, v172, v180, vcc quad_perm:[2,3,0,1] row_mask:0xf bank_mask:0xf
  v_cndmask_b32_dpp v53, v173, v181, vcc quad_perm:[2,3,0,1] row_mask:0xf bank_mask:0xf
  v_cndmask_b32_dpp v54, v174, v182, vcc quad_perm:[2,3,0,1] row_mask:0xf bank_mask:0xf
  v_cndmask_b32_dpp v55, v175, v183, vcc quad_perm:[2,3,0,1] row_mask:0xf bank_mask:0xf
  s_mov_b64 vcc, s[0:1]
  s_waitcnt vmcnt(2)
  v_cndmask_b32_dpp v168, v36, v32, vcc quad_perm:[1,0,3,2] row_mask:0xf bank_mask:0xf
  v_cndmask_b32_dpp v169, v37, v33, vcc quad_perm:[1,0,3,2] row_mask:0xf bank_mask:0xf
  v_cndmask_b32_dpp v170, v38, v34, vcc quad_perm:[1,0,3,2] row_mask:0xf bank_mask:0xf
  v_cndmask_b32_dpp v171, v39, v35, vcc quad_perm:[1,0,3,2] row_mask:0xf bank_mask:0xf
  s_waitcnt vmcnt(0)
  v_cndmask_b32_dpp v176, v60, v56, vcc quad_perm:[1,0,3,2] row_mask:0xf bank_mask:0xf
  v_cndmask_b32_dpp v177, v61, v57, vcc quad_perm:[1,0,3,2] row_mask:0xf bank_mask:0xf
  v_cndmask_b32_dpp v178, v62, v58, vcc quad_perm:[1,0,3,2] row_mask:0xf bank_mask:0xf
  v_cndmask_b32_dpp v179, v63, v59, vcc quad_perm:[1,0,3,2] row_mask:0xf bank_mask:0xf
  s_not_b64 vcc, vcc
  v_cndmask_b32_dpp v172, v32, v36, vcc quad_perm:[1,0,3,2] row_mask:0xf bank_mask:0xf
  v_cndmask_b32_dpp v173, v33, v37, vcc quad_perm:[1,0,3,2] row_mask:0xf bank_mask:0xf
  v_cndmask_b32_dpp v174, v34, v38, vcc quad_perm:[1,0,3,2] row_mask:0xf bank_mask:0xf
  v_cndmask_b32_dpp v175, v35, v39, vcc quad_perm:[1,0,3,2] row_mask:0xf bank_mask:0xf
  v_cndmask_b32_dpp v180, v56, v60, vcc quad_perm:[1,0,3,2] row_mask:0xf bank_mask:0xf
  v_cndmask_b32_dpp v181, v57, v61, vcc quad_perm:[1,0,3,2] row_mask:0xf bank_mask:0xf
  v_cndmask_b32_dpp v182, v58, v62, vcc quad_perm:[1,0,3,2] row_mask:0xf bank_mask:0xf
  v_cndmask_b32_dpp v183, v59, v63, vcc quad_perm:[1,0,3,2] row_mask:0xf bank_mask:0xf
  s_mov_b64 vcc, s[10:11]
  v_cndmask_b32_dpp v32, v176, v168, vcc quad_perm:[2,3,0,1] row_mask:0xf bank_mask:0xf
  v_cndmask_b32_dpp v33, v177, v169, vcc quad_perm:[2,3,0,1] row_mask:0xf bank_mask:0xf
  v_cndmask_b32_dpp v34, v178, v170, vcc quad_perm:[2,3,0,1] row_mask:0xf bank_mask:0xf
  v_cndmask_b32_dpp v35, v179, v171, vcc quad_perm:[2,3,0,1] row_mask:0xf bank_mask:0xf
  v_cndmask_b32_dpp v36, v180, v172, vcc quad_perm:[2,3,0,1] row_mask:0xf bank_mask:0xf
  v_cndmask_b32_dpp v37, v181, v173, vcc quad_perm:[2,3,0,1] row_mask:0xf bank_mask:0xf
  v_cndmask_b32_dpp v38, v182, v174, vcc quad_perm:[2,3,0,1] row_mask:0xf bank_mask:0xf
  v_cndmask_b32_dpp v39, v183, v175, vcc quad_perm:[2,3,0,1] row_mask:0xf bank_mask:0xf
  s_not_b64 vcc, vcc
  v_cndmask_b32_dpp v56, v168, v176, vcc quad_perm:[2,3,0,1] row_mask:0xf bank_mask:0xf
  v_cndmask_b32_dpp v57, v169, v177, vcc quad_perm:[2,3,0,1] row_mask:0xf bank_mask:0xf
  v_cndmask_b32_dpp v58, v170, v178, vcc quad_perm:[2,3,0,1] row_mask:0xf bank_mask:0xf
  v_cndmask_b32_dpp v59, v171, v179, vcc quad_perm:[2,3,0,1] row_mask:0xf bank_mask:0xf
  v_cndmask_b32_dpp v60, v172, v180, vcc quad_perm:[2,3,0,1] row_mask:0xf bank_mask:0xf
  v_cndmask_b32_dpp v61, v173, v181, vcc quad_perm:[2,3,0,1] row_mask:0xf bank_mask:0xf
  v_cndmask_b32_dpp v62, v174, v182, vcc quad_perm:[2,3,0,1] row_mask:0xf bank_mask:0xf
  v_cndmask_b32_dpp v63, v175, v183, vcc quad_perm:[2,3,0,1] row_mask:0xf bank_mask:0xf
  v_permlane32_swap_b32 v32, v56
  v_permlane32_swap_b32 v33, v57
  v_permlane32_swap_b32 v34, v58
  v_permlane32_swap_b32 v35, v59
  v_permlane32_swap_b32 v36, v60
  v_permlane32_swap_b32 v37, v61
  v_permlane32_swap_b32 v38, v62
  v_permlane32_swap_b32 v39, v63
  s_cmp_ge_u32 s94, 144
  s_cbranch_scc1 M_v1
  s_mul_hi_u32 s55, s2, 0x15555556
  s_mul_i32 s56, s55, 12
  s_sub_u32 s56, s2, s56
  s_mul_i32 s57, s55, 18432
  s_mov_b32 m0, 72960
  s_nop 0
  buffer_load_dwordx4 v203, s[28:31], s57 offen offset:768 lds
  s_mov_b32 m0, 73920
  s_nop 0
  buffer_load_dwordx4 v203, s[28:31], s57 offen offset:832 lds
  s_mov_b32 m0, 74880
  s_nop 0
  buffer_load_dwordx4 v203, s[28:31], s57 offen offset:896 lds
  s_mov_b32 m0, 75840
  s_nop 0
  buffer_load_dwordx4 v203, s[28:31], s57 offen offset:960 lds
  s_mov_b32 m0, 76800
  s_nop 0
  buffer_load_dwordx4 v203, s[28:31], s57 offen offset:1024 lds
  s_mov_b32 m0, 77760
  s_nop 0
  buffer_load_dwordx4 v203, s[28:31], s57 offen offset:1088 lds
  v_lshrrev_b32 v112, 1, v1
  v_mul_u32_u24 v112, 384, v112
  v_and_b32 v113, 1, v1
  v_lshl_add_u32 v112, v113, 4, v112
  s_lshl_b32 s57, s56, 5
  s_mov_b32 m0, 79872
  s_nop 0
  buffer_load_dwordx4 v112, s[32:35], s57 offen lds
  s_add_u32 s57, s57, 12288
  s_mov_b32 m0, 80896
  s_nop 0
  buffer_load_dwordx4 v112, s[32:35], s57 offen lds
  s_add_u32 s57, s57, 12288
  s_mov_b32 m0, 81920
  s_nop 0
  buffer_load_dwordx4 v112, s[32:35], s57 offen lds
  s_add_u32 s57, s57, 12288
  s_mov_b32 m0, 82944
  s_nop 0
  buffer_load_dwordx4 v112, s[32:35], s57 offen lds
  s_add_u32 s57, s57, 12288
  s_mov_b32 m0, 83968
  s_nop 0
  buffer_load_dwordx4 v112, s[32:35], s57 offen lds
  s_add_u32 s57, s57, 12288
  s_mov_b32 m0, 84992
  s_nop 0
  buffer_load_dwordx4 v112, s[32:35], s57 offen lds
  s_add_u32 s57, s57, 12288
  s_lshr_b32 s57, s56, 2
  s_mul_i32 s95, s57, 24576
  s_and_b32 s56, s56, 3
  s_lshl_b32 s56, s56, 6
  s_add_u32 s95, s95, s56
  s_lshr_b32 s56, s55, 1
  s_lshl_b32 s56, s56, 11
  s_add_u32 s95, s95, s56
  s_and_b32 s55, s55, 1
  s_lshl_b32 s55, s55, 3
  s_add_u32 s95, s95, s55
  v_add_u32 v118, 73728, v195
M_v1:
  s_barrier
  s_setprio 1
  s_branch M_pa
M_mw:
  s_lshr_b32 s55, s2, 3
  s_cmp_lg_u32 s40, 1
  s_cbranch_scc1 M_nowarm1
  s_mul_i32 s55, s55, 6912
  s_add_u32 s56, s55, 4096
  buffer_load_dwordx4 v[136:139], v252, s[28:31], s55 offen offset:0
  buffer_load_dwordx4 v[140:143], v252, s[28:31], s55 offen offset:1024
  buffer_load_dwordx4 v[144:147], v252, s[28:31], s55 offen offset:2048
  buffer_load_dwordx4 v[148:151], v252, s[28:31], s55 offen offset:3072
  buffer_load_dwordx4 v[152:155], v252, s[28:31], s56 offen offset:0
  buffer_load_dwordx4 v[156:159], v252, s[28:31], s56 offen offset:1024
  buffer_load_dwordx4 v[160:163], v252, s[28:31], s56 offen offset:2048
M_nowarm1:
  s_cmp_lg_u32 s40, 2
  s_cbranch_scc1 M_nowarm2
  s_mov_b32 s32, s8
  s_and_b32 s33, s9, 0xffff
  s_mov_b32 s34, 73728
  s_mov_b32 s35, 0x00020000
  s_mul_i32 s55, s55, 2304
  s_waitcnt vmcnt(6)
  buffer_load_dwordx4 v[136:139], v252, s[32:35], s55 offen offset:0
  s_waitcnt vmcnt(6)
  buffer_load_dwordx4 v[140:143], v252, s[32:35], s55 offen offset:1024
  s_waitcnt vmcnt(6)
  buffer_load_dwordx4 v[144:147], v252, s[32:35], s55 offen offset:2048
M_nowarm2:
  s_mul_i32 s57, s40, 18432
  s_mul_i32 s55, s40, 3
  s_add_u32 s56, s55, 0
  s_lshr_b32 s58, s56, 1
  s_and_b32 s56, s56, 1
  s_mul_i32 s59, s58, 12
  s_add_u32 s59, s59, s56
  s_lshl_b32 s59, s59, 10
  s_add_u32 s59, s59, 90112
  v_add_u32 v192, s59, v252
  s_mul_i32 s58, s58, 36864
  s_mul_i32 s56, s56, 4608
  s_add_u32 s56, s56, s58
  s_add_u32 m0, s57, 89728
  s_nop 0
  buffer_load_dwordx4 v200, s[28:31], s56 offen offset:384 lds
  s_add_u32 m0, s57, 90688
  s_nop 0
  buffer_load_dwordx4 v200, s[28:31], s56 offen offset:448 lds
  s_add_u32 m0, s57, 91648
  s_nop 0
  buffer_load_dwordx4 v200, s[28:31], s56 offen offset:512 lds
  s_add_u32 m0, s57, 92608
  s_nop 0
  buffer_load_dwordx4 v200, s[28:31], s56 offen offset:576 lds
  s_add_u32 m0, s57, 93568
  s_nop 0
  buffer_load_dwordx4 v200, s[28:31], s56 offen offset:640 lds
  s_add_u32 m0, s57, 94528
  s_nop 0
  buffer_load_dwordx4 v200, s[28:31], s56 offen offset:704 lds
  s_add_u32 s56, s55, 1
  s_lshr_b32 s58, s56, 1
  s_and_b32 s56, s56, 1
  s_mul_i32 s59, s58, 12
  s_add_u32 s59, s59, s56
  s_lshl_b32 s59, s59, 10
  s_add_u32 s59, s59, 90112
  v_add_u32 v193, s59, v252
  s_mul_i32 s58, s58, 36864
  s_mul_i32 s56, s56, 4608
  s_add_u32 s56, s56, s58
  s_add_u32 m0, s57, 95872
  s_nop 0
  buffer_load_dwordx4 v200, s[28:31], s56 offen offset:384 lds
  s_add_u32 m0, s57, 96832
  s_nop 0
  buffer_load_dwordx4 v200, s[28:31], s56 offen offset:448 lds
  s_add_u32 m0, s57, 97792
  s_nop 0
  buffer_load_dwordx4 v200, s[28:31], s56 offen offset:512 lds
  s_add_u32 m0, s57, 98752
  s_nop 0
  buffer_load_dwordx4 v200, s[28:31], s56 offen offset:576 lds
  s_add_u32 m0, s57, 99712
  s_nop 0
  buffer_load_dwordx4 v200, s[28:31], s56 offen offset:640 lds
  s_add_u32 m0, s57, 100672
  s_nop 0
  buffer_load_dwordx4 v200, s[28:31], s56 offen offset:704 lds
  s_add_u32 s56, s55, 2
  s_lshr_b32 s58, s56, 1
  s_and_b32 s56, s56, 1
  s_mul_i32 s59, s58, 12
  s_add_u32 s59, s59, s56
  s_lshl_b32 s59, s59, 10
  s_add_u32 s59, s59, 90112
  v_add_u32 v194, s59, v252
  s_mul_i32 s58, s58, 36864
  s_mul_i32 s56, s56, 4608
  s_add_u32 s56, s56, s58
  s_add_u32 m0, s57, 102016
  s_nop 0
  buffer_load_dwordx4 v200, s[28:31], s56 offen offset:384 lds
  s_add_u32 m0, s57, 102976
  s_nop 0
  buffer_load_dwordx4 v200, s[28:31], s56 offen offset:448 lds
  s_add_u32 m0, s57, 103936
  s_nop 0
  buffer_load_dwordx4 v200, s[28:31], s56 offen offset:512 lds
  s_add_u32 m0, s57, 104896
  s_nop 0
  buffer_load_dwordx4 v200, s[28:31], s56 offen offset:576 lds
  s_add_u32 m0, s57, 105856
  s_nop 0
  buffer_load_dwordx4 v200, s[28:31], s56 offen offset:640 lds
  s_add_u32 m0, s57, 106816
  s_nop 0
  buffer_load_dwordx4 v200, s[28:31], s56 offen offset:704 lds
  s_add_u32 s57, s57, 90112
  v_add_u32 v184, s57, v195
  v_add_u32 v196, 36864, v195
  s_mov_b32 s16, s4
  s_and_b32 s17, s5, 0xffff
  s_mov_b32 s18, 19267584
  s_mov_b32 s19, 0x00020000
  s_mov_b32 s24, s14
  s_and_b32 s25, s15, 0xffff
  s_mov_b32 s26, 268435456
  s_mov_b32 s27, 0x00020000
  s_mov_b32 s20, s10
  s_and_b32 s21, s11, 0xffff
  s_mov_b32 s22, 19267584
  s_mov_b32 s23, 0x00020000
  s_mov_b32 s36, s12
  s_and_b32 s37, s13, 0xffff
  s_mov_b32 s38, 256
  s_mov_b32 s39, 0x00020000
  s_mul_i32 s61, s41, 13
  s_add_i32 s61, s61, -6
  s_mul_i32 s62, s42, 13
  s_add_i32 s62, s62, -6
  s_cmp_ge_u32 s40, 4
  s_cselect_b32 s53, -4, 3
  s_add_i32 s53, s53, s40
  s_lshl_b32 s53, s53, 1
  s_mul_i32 s55, s41, 6
  s_add_i32 s45, s43, s55
  s_add_i32 s45, s45, -6
  s_cmp_eq_i32 s45, -6
  s_cselect_b32 s47, 6, 0
  s_cmp_eq_i32 s45, 98
  s_cselect_b32 s48, 7, 13
  s_cselect_b32 s49, 2, 0
  s_sub_i32 s45, s45, s49
  s_mul_i32 s55, s42, 6
  s_add_i32 s56, s44, s55
  s_add_i32 s56, s56, -6
  s_cmp_eq_i32 s56, -6
  s_cselect_b32 s50, 6, 0
  s_cmp_eq_i32 s56, 98
  s_cselect_b32 s51, 7, 13
  s_lshl_b32 s56, s56, 1
  s_add_i32 s56, s56, s42
  s_mul_i32 s46, s56, 384
  s_max_i32 s92, s53, s47
  s_min_i32 s92, s92, s48
  s_and_b32 s92, s92, -2
  s_add_u32 s52, s92, s49
  s_mov_b32 s54, 4286578688
  s_mov_b32 s63, 1037384597
  s_and_b32 s93, s40, 1
  s_lshl_b32 s93, s93, 3
  s_and_b32 s56, s40, 6
  s_or_b32 s93, s93, s56
  s_add_u32 s56, s40, 8
  s_add_i32 s100, s45, s56
  s_lshl_b32 s100, s100, 1
  s_add_i32 s100, s100, s41
  s_max_i32 s100, s100, 0
  s_min_i32 s100, s100, 223
  s_mul_i32 s100, s100, 86016
  s_mul_i32 s101, s56, 7680
  s_add_u32 s4, s43, s53
  s_mov_b32 s5, 86016
  s_movk_i32 s6, 384
  s_cmp_eq_u32 s40, 4
  s_cselect_b32 s94, s2, 999
  s_mov_b32 s0, 0x55555555
  s_mov_b32 s1, 0x55555555
  s_mov_b32 s10, 0x33333333
  s_mov_b32 s11, 0x33333333
  s_mov_b32 vcc_lo, 0
  s_mov_b32 vcc_hi, -1
  v_bfe_u32 v4, v1, 2, 2
  v_and_b32 v5, 3, v1
  v_lshrrev_b32 v6, 5, v1
  v_lshl_add_u32 v5, v2, 2, v5
  v_lshlrev_b32 v6, 7, v6
  v_sub_u32 v6, 256, v6
  v_lshrrev_b32 v197, 1, v4
  v_and_b32 v255, 1, v4
  v_add_u32 v197, s4, v197
  v_lshl_add_u32 v0, v255, 2, s44
  v_lshl_add_u32 v198, v197, 1, s61
  v_add_u32 v199, 112, v197
  v_lshlrev_b32 v255, 30, v255
  v_med3_i32 v197, v198, v197, v199
  v_mul_lo_u32 v197, v197, s5
  v_lshl_add_u32 v197, v5, 4, v197
  v_add_u32 v16, 0, v0
  v_lshl_add_u32 v198, v16, 1, s62
  v_add_u32 v199, 112, v16
  v_med3_i32 v16, v198, v16, v199
  v_mad_u32_u24 v16, v16, s6, v197
  v_add_u32 v20, 1, v0
  v_lshl_add_u32 v198, v20, 1, s62
  v_add_u32 v199, 112, v20
  v_med3_i32 v20, v198, v20, v199
  v_mad_u32_u24 v20, v20, s6, v197
  v_add_u32 v24, 2, v0
  v_lshl_add_u32 v198, v24, 1, s62
  v_add_u32 v199, 112, v24
  v_med3_i32 v24, v198, v24, v199
  v_mad_u32_u24 v24, v24, s6, v197
  v_add_u32 v28, 3, v0
  v_lshl_add_u32 v198, v28, 1, s62
  v_add_u32 v199, 112, v28
  v_med3_i32 v28, v198, v28, v199
  v_mad_u32_u24 v28, v28, s6, v197
  v_add_u32 v28, v28, v255
  v_add_u32 v40, 7, v0
  v_lshl_add_u32 v198, v40, 1, s62
  v_add_u32 v199, 112, v40
  v_med3_i32 v40, v198, v40, v199
  v_mad_u32_u24 v40, v40, s6, v197
  v_add_u32 v44, 8, v0
  v_lshl_add_u32 v198, v44, 1, s62
  v_add_u32 v199, 112, v44
  v_med3_i32 v44, v198, v44, v199
  v_mad_u32_u24 v44, v44, s6, v197
  v_add_u32 v48, 9, v0
  v_lshl_add_u32 v198, v48, 1, s62
  v_add_u32 v199, 112, v48
  v_med3_i32 v48, v198, v48, v199
  v_mad_u32_u24 v48, v48, s6, v197
  v_add_u32 v52, 10, v0
  v_lshl_add_u32 v198, v52, 1, s62
  v_add_u32 v199, 112, v52
  v_med3_i32 v52, v198, v52, v199
  v_mad_u32_u24 v52, v52, s6, v197
  v_add_u32 v52, v52, v255
  v_cndmask_b32 v32, v16, v40, vcc
  v_cndmask_b32 v36, v20, v44, vcc
  v_cndmask_b32 v56, v24, v48, vcc
  v_cndmask_b32 v60, v28, v52, vcc
  v_add_u32 v32, v32, v6
  v_add_u32 v36, v36, v6
  v_add_u32 v56, v56, v6
  v_add_u32 v60, v60, v6
  s_waitcnt vmcnt(12)
  ds_read_b128 v[64:67], v184 offset:0
  ds_read_b128 v[68:71], v184 offset:1024
  ds_read_b128 v[72:75], v184 offset:2048
  ds_read_b128 v[76:79], v184 offset:3072
  ds_read_b128 v[80:83], v184 offset:4096
  ds_read_b128 v[84:87], v184 offset:5120
  s_waitcnt vmcnt(6)
  ds_read_b128 v[88:91], v184 offset:6144
  ds_read_b128 v[92:95], v184 offset:7168
  ds_read_b128 v[96:99], v184 offset:8192
  ds_read_b128 v[100:103], v184 offset:9216
  ds_read_b128 v[104:107], v184 offset:10240
  ds_read_b128 v[108:111], v184 offset:11264
  s_waitcnt vmcnt(0)
  ds_read_b128 v[112:115], v184 offset:12288
  ds_read_b128 v[116:119], v184 offset:13312
  s_waitcnt lgkmcnt(8)
  ds_read_b128 v[120:123], v184 offset:14336
  ds_read_b128 v[124:127], v184 offset:15360
  ds_read_b128 v[128:131], v184 offset:16384
  ds_read_b128 v[132:135], v184 offset:17408
  v_lshrrev_b32 v4, 3, v3
  v_add_u32 v4, s53, v4
  v_max_i32 v4, s47, v4
  v_min_i32 v4, s48, v4
  v_subrev_u32 v4, s92, v4
  v_and_b32 v5, 1, v2
  v_sub_u32 v6, v5, v4
  v_ashrrev_i32 v12, 31, v6
  v_and_b32 v12, s54, v12
  v_sub_u32 v6, v4, v5
  v_ashrrev_i32 v13, 31, v6
  v_and_b32 v13, s54, v13
  v_and_b32 v4, 7, v3
  v_lshrrev_b32 v5, 1, v2
  v_subrev_u32 v7, 7, v4
  v_ashrrev_i32 v7, 31, v7
  v_and_b32 v7, 0x7f, v7
  v_add_u32 v6, 0, v4
  v_max_i32 v6, s50, v6
  v_min_i32 v6, s51, v6
  v_lshlrev_b32 v6, v6, v7
  v_lshrrev_b32 v6, v5, v6
  v_not_b32 v14, v6
  v_add_u32 v6, 7, v4
  v_max_i32 v6, s50, v6
  v_min_i32 v6, s51, v6
  v_lshlrev_b32 v6, v6, v7
  v_lshrrev_b32 v6, v5, v6
  v_not_b32 v15, v6
  v_add_u32 v4, s52, v4
  s_waitcnt lgkmcnt(0)
  s_barrier
  ds_read_b128 v[200:203], v195 offset:0
  ds_read_b128 v[204:207], v195 offset:6144
  ds_read_b128 v[208:211], v195 offset:1024
  ds_read_b128 v[212:215], v195 offset:7168
  ds_read_b128 v[216:219], v195 offset:2048
  ds_read_b128 v[220:223], v195 offset:8192
  s_cmp_eq_u32 s40, 0
  s_setprio 3
  s_waitcnt lgkmcnt(5)
  v_mfma_f32_16x16x32_bf16 v[136:139], v[200:203], v[64:67], 0
  ds_read_b128 v[224:227], v195 offset:3072
  v_and_b32 v5, 1, v4
  v_mfma_f32_16x16x32_bf16 v[144:147], v[200:203], v[88:91], 0
  v_lshlrev_b32 v5, 3, v5
  v_and_or_b32 v5, v4, 6, v5
  v_mfma_f32_16x16x32_bf16 v[152:155], v[200:203], v[112:115], 0
  s_waitcnt lgkmcnt(5)
  v_mul_u32_u24 v4, 7680, v4
  v_lshrrev_b32 v6, 3, v3
  v_mfma_f32_16x16x32_bf16 v[140:143], v[204:207], v[64:67], 0
  ds_read_b128 v[228:231], v195 offset:9216
  v_mul_u32_u24 v6, 24, v6
  v_mfma_f32_16x16x32_bf16 v[148:151], v[204:207], v[88:91], 0
  v_add_u32 v6, v6, v2
  v_add_u32 v7, 0, v6
  v_mfma_f32_16x16x32_bf16 v[156:159], v[204:207], v[112:115], 0
  s_waitcnt lgkmcnt(5)
  v_xor_b32 v7, v7, v5
  v_lshl_add_u32 v240, v7, 4, v4
  v_mfma_f32_16x16x32_bf16 v[136:139], v[208:211], v[68:71], v[136:139]
  ds_read_b128 v[200:203], v195 offset:4096
  v_add_u32 v7, 4, v6
  v_mfma_f32_16x16x32_bf16 v[144:147], v[208:211], v[92:95], v[144:147]
  v_xor_b32 v7, v7, v5
  v_lshl_add_u32 v241, v7, 4, v4
  v_mfma_f32_16x16x32_bf16 v[152:155], v[208:211], v[116:119], v[152:155]
  s_waitcnt lgkmcnt(5)
  v_add_u32 v7, 8, v6
  v_xor_b32 v7, v7, v5
  v_mfma_f32_16x16x32_bf16 v[140:143], v[212:215], v[68:71], v[140:143]
  ds_read_b128 v[204:207], v195 offset:10240
  v_lshl_add_u32 v242, v7, 4, v4
  v_mfma_f32_16x16x32_bf16 v[148:151], v[212:215], v[92:95], v[148:151]
  v_add_u32 v7, 12, v6
  v_xor_b32 v7, v7, v5
  v_mfma_f32_16x16x32_bf16 v[156:159], v[212:215], v[116:119], v[156:159]
  s_waitcnt lgkmcnt(5)
  v_lshl_add_u32 v243, v7, 4, v4
  v_and_b32 v4, 1, v2
  v_mfma_f32_16x16x32_bf16 v[136:139], v[216:219], v[72:75], v[136:139]
  ds_read_b128 v[208:211], v195 offset:5120
  v_lshlrev_b32 v4, 2, v4
  v_mfma_f32_16x16x32_bf16 v[144:147], v[216:219], v[96:99], v[144:147]
  v_lshrrev_b32 v5, 2, v3
  v_add3_u32 v4, v4, v5, s52
  v_mfma_f32_16x16x32_bf16 v[152:155], v[216:219], v[120:123], v[152:155]
  s_waitcnt lgkmcnt(5)
  v_and_b32 v5, 1, v4
  v_lshlrev_b32 v5, 3, v5
  v_mfma_f32_16x16x32_bf16 v[140:143], v[220:223], v[72:75], v[140:143]
  ds_read_b128 v[212:215], v195 offset:11264
  v_and_or_b32 v5, v4, 6, v5
  v_mfma_f32_16x16x32_bf16 v[148:151], v[220:223], v[96:99], v[148:151]
  v_mul_u32_u24 v4, 7680, v4
  v_and_b32 v6, 1, v3
  v_mfma_f32_16x16x32_bf16 v[156:159], v[220:223], v[120:123], v[156:159]
  s_waitcnt lgkmcnt(5)
  v_lshl_add_u32 v4, v6, 3, v4
  v_lshrrev_b32 v6, 1, v2
  v_mfma_f32_16x16x32_bf16 v[136:139], v[224:227], v[76:79], v[136:139]
  ds_read_b128 v[216:219], v195 offset:12288
  v_mul_u32_u24 v6, 24, v6
  v_mfma_f32_16x16x32_bf16 v[144:147], v[224:227], v[100:103], v[144:147]
  v_bfe_u32 v7, v3, 1, 1
  v_add_u32 v6, v6, v7
  v_mfma_f32_16x16x32_bf16 v[152:155], v[224:227], v[124:127], v[152:155]
  s_waitcnt lgkmcnt(5)
  v_add_u32 v7, 0, v6
  v_xor_b32 v7, v7, v5
  v_mfma_f32_16x16x32_bf16 v[140:143], v[228:231], v[76:79], v[140:143]
  ds_read_b128 v[220:223], v195 offset:18432
  v_lshl_add_u32 v244, v7, 4, v4
  v_mfma_f32_16x16x32_bf16 v[148:151], v[228:231], v[100:103], v[148:151]
  v_add_u32 v7, 2, v6
  v_xor_b32 v7, v7, v5
  v_mfma_f32_16x16x32_bf16 v[156:159], v[228:231], v[124:127], v[156:159]
  s_waitcnt lgkmcnt(5)
  v_lshl_add_u32 v245, v7, 4, v4
  v_add_u32 v7, 4, v6
  v_mfma_f32_16x16x32_bf16 v[136:139], v[200:203], v[80:83], v[136:139]
  ds_read_b128 v[224:227], v195 offset:13312
  v_xor_b32 v7, v7, v5
  v_mfma_f32_16x16x32_bf16 v[144:147], v[200:203], v[104:107], v[144:147]
  v_lshl_add_u32 v246, v7, 4, v4
  v_add_u32 v7, 6, v6
  v_mfma_f32_16x16x32_bf16 v[152:155], v[200:203], v[128:131], v[152:155]
  s_waitcnt lgkmcnt(5)
  v_xor_b32 v7, v7, v5
  v_lshl_add_u32 v247, v7, 4, v4
  v_mfma_f32_16x16x32_bf16 v[140:143], v[204:207], v[80:83], v[140:143]
  ds_read_b128 v[228:231], v195 offset:19456
  v_add_u32 v7, 8, v6
  v_mfma_f32_16x16x32_bf16 v[148:151], v[204:207], v[104:107], v[148:151]
  v_xor_b32 v7, v7, v5
  v_lshl_add_u32 v248, v7, 4, v4
  v_mfma_f32_16x16x32_bf16 v[156:159], v[204:207], v[128:131], v[156:159]
  s_waitcnt lgkmcnt(5)
  v_add_u32 v7, 10, v6
  v_xor_b32 v7, v7, v5
  v_mfma_f32_16x16x32_bf16 v[136:139], v[208:211], v[84:87], v[136:139]
  ds_read_b128 v[200:203], v195 offset:14336
  v_lshl_add_u32 v249, v7, 4, v4
  v_mfma_f32_16x16x32_bf16 v[144:147], v[208:211], v[108:111], v[144:147]
  v_add_u32 v7, 12, v6
  v_xor_b32 v7, v7, v5
  v_mfma_f32_16x16x32_bf16 v[152:155], v[208:211], v[132:135], v[152:155]
  s_waitcnt lgkmcnt(5)
  v_lshl_add_u32 v250, v7, 4, v4
  v_add_u32 v7, 14, v6
  v_mfma_f32_16x16x32_bf16 v[140:143], v[212:215], v[84:87], v[140:143]
  ds_read_b128 v[204:207], v195 offset:20480
  v_xor_b32 v7, v7, v5
  v_mfma_f32_16x16x32_bf16 v[148:151], v[212:215], v[108:111], v[148:151]
  v_lshl_add_u32 v251, v7, 4, v4
  v_add_u32 v253, 153600, v252
  v_mfma_f32_16x16x32_bf16 v[156:159], v[212:215], v[132:135], v[156:159]
  s_waitcnt lgkmcnt(5)
  v_add_u32 v254, 90112, v252
  v_add_u32 v4, 0, v1
  v_mfma_f32_16x16x32_bf16 v[160:163], v[216:219], v[64:67], 0
  ds_read_b128 v[208:211], v195 offset:15360
  v_xor_b32 v4, s93, v4
  v_mfma_f32_16x16x32_bf16 v[168:171], v[216:219], v[88:91], 0
  v_mul_u32_u24 v5, 2731, v4
  v_lshrrev_b32 v5, 16, v5
  v_mfma_f32_16x16x32_bf16 v[176:179], v[216:219], v[112:115], 0
  s_waitcnt lgkmcnt(5)
  v_mul_u32_u24 v5, 384, v5
  v_lshl_add_u32 v4, v4, 4, v5
  v_mfma_f32_16x16x32_bf16 v[164:167], v[220:223], v[64:67], 0
  ds_read_b128 v[212:215], v195 offset:21504
  v_cvt_pk_bf16_f32 v184, v136, v137
  v_mfma_f32_16x16x32_bf16 v[172:175], v[220:223], v[88:91], 0
  v_cvt_pk_bf16_f32 v185, v138, v139
  v_cvt_pk_bf16_f32 v186, v140, v141
  v_mfma_f32_16x16x32_bf16 v[180:183], v[220:223], v[112:115], 0
  s_waitcnt lgkmcnt(5)
  v_cvt_pk_bf16_f32 v187, v142, v143
  v_add_u32 v232, s46, v4
  v_mfma_f32_16x16x32_bf16 v[160:163], v[224:227], v[68:71], v[160:163]
  ds_read_b128 v[216:219], v195 offset:16384
  v_add_u32 v235, 6144, v232
  v_mfma_f32_16x16x32_bf16 v[168:171], v[224:227], v[92:95], v[168:171]
  ds_write_b128 v192, v[184:187] offset:0
  v_mfma_f32_16x16x32_bf16 v[176:179], v[224:227], v[116:119], v[176:179]
  s_waitcnt lgkmcnt(6)
  v_add_u32 v238, 12288, v232
  v_max_i32 v232, 0, v232
  v_mfma_f32_16x16x32_bf16 v[164:167], v[228:231], v[68:71], v[164:167]
  ds_read_b128 v[220:223], v195 offset:22528
  v_cvt_pk_bf16_f32 v188, v144, v145
  v_mfma_f32_16x16x32_bf16 v[172:175], v[228:231], v[92:95], v[172:175]
  v_cvt_pk_bf16_f32 v189, v146, v147
  v_cvt_pk_bf16_f32 v190, v148, v149
  v_mfma_f32_16x16x32_bf16 v[180:183], v[228:231], v[116:119], v[180:183]
  s_waitcnt lgkmcnt(6)
  v_cvt_pk_bf16_f32 v191, v150, v151
  v_add_u32 v4, 64, v1
  v_mfma_f32_16x16x32_bf16 v[160:163], v[200:203], v[72:75], v[160:163]
  ds_read_b128 v[224:227], v195 offset:17408
  v_xor_b32 v4, s93, v4
  v_mfma_f32_16x16x32_bf16 v[168:171], v[200:203], v[96:99], v[168:171]
  ds_write_b128 v193, v[188:191] offset:0
  v_mfma_f32_16x16x32_bf16 v[176:179], v[200:203], v[120:123], v[176:179]
  v_mul_u32_u24 v5, 2731, v4
  v_lshrrev_b32 v5, 16, v5
  s_barrier
  s_waitcnt lgkmcnt(7)
  v_mfma_f32_16x16x32_bf16 v[164:167], v[204:207], v[72:75], v[164:167]
  ds_read_b128 v[228:231], v195 offset:23552
  v_cvt_pk_bf16_f32 v184, v152, v153
  v_mfma_f32_16x16x32_bf16 v[172:175], v[204:207], v[96:99], v[172:175]
  v_cvt_pk_bf16_f32 v185, v154, v155
  v_cvt_pk_bf16_f32 v186, v156, v157
  v_mfma_f32_16x16x32_bf16 v[180:183], v[204:207], v[120:123], v[180:183]
  s_waitcnt lgkmcnt(7)
  v_cvt_pk_bf16_f32 v187, v158, v159
  v_mul_u32_u24 v5, 384, v5
  v_mfma_f32_16x16x32_bf16 v[160:163], v[208:211], v[76:79], v[160:163]
  ds_read_b128 v[200:203], v195 offset:24576
  v_lshl_add_u32 v4, v4, 4, v5
  v_mfma_f32_16x16x32_bf16 v[168:171], v[208:211], v[100:103], v[168:171]
  ds_write_b128 v194, v[184:187] offset:0
  v_mfma_f32_16x16x32_bf16 v[176:179], v[208:211], v[124:127], v[176:179]
  s_waitcnt lgkmcnt(8)
  v_add_u32 v233, s46, v4
  v_add_u32 v236, 6144, v233
  v_mfma_f32_16x16x32_bf16 v[164:167], v[212:215], v[76:79], v[164:167]
  ds_read_b128 v[204:207], v195 offset:30720
  v_max_i32 v233, 0, v233
  v_mfma_f32_16x16x32_bf16 v[172:175], v[212:215], v[100:103], v[172:175]
  v_add_u32 v4, 128, v1
  v_xor_b32 v4, s93, v4
  v_mfma_f32_16x16x32_bf16 v[180:183], v[212:215], v[124:127], v[180:183]
  s_waitcnt lgkmcnt(8)
  v_mul_u32_u24 v5, 2731, v4
  v_lshrrev_b32 v5, 16, v5
  v_mfma_f32_16x16x32_bf16 v[160:163], v[216:219], v[80:83], v[160:163]
  ds_read_b128 v[208:211], v195 offset:25600
  v_mul_u32_u24 v5, 384, v5
  v_mfma_f32_16x16x32_bf16 v[168:171], v[216:219], v[104:107], v[168:171]
  v_lshl_add_u32 v4, v4, 4, v5
  v_add_u32 v234, s46, v4
  v_mfma_f32_16x16x32_bf16 v[176:179], v[216:219], v[128:131], v[176:179]
  s_waitcnt lgkmcnt(7)
  v_add_u32 v237, 6144, v234
  v_max_i32 v234, 0, v234
  v_mfma_f32_16x16x32_bf16 v[164:167], v[220:223], v[80:83], v[164:167]
  ds_read_b128 v[212:215], v195 offset:31744
  v_add_u32 v4, 416, v1
  v_mfma_f32_16x16x32_bf16 v[172:175], v[220:223], v[104:107], v[172:175]
  v_xor_b32 v4, s93, v4
  v_mul_u32_u24 v5, 2731, v4
  v_mfma_f32_16x16x32_bf16 v[180:183], v[220:223], v[128:131], v[180:183]
  s_waitcnt lgkmcnt(7)
  v_lshrrev_b32 v5, 16, v5
  v_mul_u32_u24 v5, 384, v5
  v_mfma_f32_16x16x32_bf16 v[160:163], v[224:227], v[84:87], v[160:163]
  ds_read_b128 v[216:219], v195 offset:26624
  v_lshl_add_u32 v4, v4, 4, v5
  v_mfma_f32_16x16x32_bf16 v[168:171], v[224:227], v[108:111], v[168:171]
  v_add_u32 v239, s46, v4
  v_lshrrev_b32 v197, 1, v2
  v_mfma_f32_16x16x32_bf16 v[176:179], v[224:227], v[132:135], v[176:179]
  s_waitcnt lgkmcnt(6)
  v_and_b32 v255, 1, v2
  v_add_u32 v197, s4, v197
  v_mfma_f32_16x16x32_bf16 v[164:167], v[228:231], v[84:87], v[164:167]
  ds_read_b128 v[220:223], v195 offset:32768
  v_lshl_add_u32 v0, v255, 2, s44
  v_mfma_f32_16x16x32_bf16 v[172:175], v[228:231], v[108:111], v[172:175]
  s_cbranch_scc1 M_sx0
  buffer_load_dwordx4 v[16:19], v16, s[16:19], 0 offen
M_sx0:
  v_mfma_f32_16x16x32_bf16 v[180:183], v[228:231], v[132:135], v[180:183]
  s_waitcnt lgkmcnt(6)
  v_lshl_add_u32 v198, v197, 1, s61
  v_add_u32 v199, 112, v197
  v_mfma_f32_16x16x32_bf16 v[136:139], v[200:203], v[64:67], 0
  ds_read_b128 v[224:227], v195 offset:27648
  v_lshlrev_b32 v255, 30, v255
  v_mfma_f32_16x16x32_bf16 v[144:147], v[200:203], v[88:91], 0
  v_med3_i32 v197, v198, v197, v199
  v_mul_lo_u32 v197, v197, s5
  v_mfma_f32_16x16x32_bf16 v[152:155], v[200:203], v[112:115], 0
  s_waitcnt lgkmcnt(5)
  v_lshl_add_u32 v197, v3, 3, v197
  v_add_u32 v4, 0, v0
  v_mfma_f32_16x16x32_bf16 v[140:143], v[204:207], v[64:67], 0
  ds_read_b128 v[228:231], v195 offset:33792
  v_cvt_pk_bf16_f32 v184, v160, v161
  v_mfma_f32_16x16x32_bf16 v[148:151], v[204:207], v[88:91], 0
  v_cvt_pk_bf16_f32 v185, v162, v163
  v_cvt_pk_bf16_f32 v186, v164, v165
  v_mfma_f32_16x16x32_bf16 v[156:159], v[204:207], v[112:115], 0
  s_waitcnt lgkmcnt(5)
  v_cvt_pk_bf16_f32 v187, v166, v167
  v_lshl_add_u32 v198, v4, 1, s62
  v_mfma_f32_16x16x32_bf16 v[136:139], v[208:211], v[68:71], v[136:139]
  ds_read_b128 v[200:203], v195 offset:28672
  v_add_u32 v199, 112, v4
  v_mfma_f32_16x16x32_bf16 v[144:147], v[208:211], v[92:95], v[144:147]
  ds_write_b128 v192, v[184:187] offset:2048
  v_mfma_f32_16x16x32_bf16 v[152:155], v[208:211], v[116:119], v[152:155]
  s_waitcnt lgkmcnt(6)
  v_med3_i32 v4, v198, v4, v199
  v_mad_u32_u24 v4, v4, s6, v197
  v_mfma_f32_16x16x32_bf16 v[140:143], v[212:215], v[68:71], v[140:143]
  ds_read_b128 v[204:207], v195 offset:34816
  v_cvt_pk_bf16_f32 v188, v168, v169
  v_mfma_f32_16x16x32_bf16 v[148:151], v[212:215], v[92:95], v[148:151]
  s_cbranch_scc1 M_sx1
  buffer_load_dwordx4 v[20:23], v20, s[16:19], 0 offen
M_sx1:
  v_mfma_f32_16x16x32_bf16 v[156:159], v[212:215], v[116:119], v[156:159]
  s_waitcnt lgkmcnt(6)
  v_cvt_pk_bf16_f32 v189, v170, v171
  v_cvt_pk_bf16_f32 v190, v172, v173
  v_mfma_f32_16x16x32_bf16 v[136:139], v[216:219], v[72:75], v[136:139]
  ds_read_b128 v[208:211], v195 offset:29696
  v_cvt_pk_bf16_f32 v191, v174, v175
  v_mfma_f32_16x16x32_bf16 v[144:147], v[216:219], v[96:99], v[144:147]
  ds_write_b128 v193, v[188:191] offset:2048
  v_mfma_f32_16x16x32_bf16 v[152:155], v[216:219], v[120:123], v[152:155]
  s_waitcnt lgkmcnt(7)
  v_add_u32 v5, 1, v0
  v_lshl_add_u32 v198, v5, 1, s62
  v_mfma_f32_16x16x32_bf16 v[140:143], v[220:223], v[72:75], v[140:143]
  ds_read_b128 v[212:215], v195 offset:35840
  v_cvt_pk_bf16_f32 v184, v176, v177
  v_mfma_f32_16x16x32_bf16 v[148:151], v[220:223], v[96:99], v[148:151]
  v_cvt_pk_bf16_f32 v185, v178, v179
  v_cvt_pk_bf16_f32 v186, v180, v181
  v_mfma_f32_16x16x32_bf16 v[156:159], v[220:223], v[120:123], v[156:159]
  s_waitcnt lgkmcnt(7)
  v_cvt_pk_bf16_f32 v187, v182, v183
  v_add_u32 v199, 112, v5
  v_mfma_f32_16x16x32_bf16 v[136:139], v[224:227], v[76:79], v[136:139]
  ds_read_b128 v[216:219], v196 offset:0
  v_med3_i32 v5, v198, v5, v199
  v_mfma_f32_16x16x32_bf16 v[144:147], v[224:227], v[100:103], v[144:147]
  ds_write_b128 v194, v[184:187] offset:2048
  v_mfma_f32_16x16x32_bf16 v[152:155], v[224:227], v[124:127], v[152:155]
  s_waitcnt lgkmcnt(8)
  v_mad_u32_u24 v5, v5, s6, v197
  v_add_u32 v6, 2, v0
  v_mfma_f32_16x16x32_bf16 v[140:143], v[228:231], v[76:79], v[140:143]
  ds_read_b128 v[220:223], v196 offset:6144
  v_lshl_add_u32 v198, v6, 1, s62
  v_mfma_f32_16x16x32_bf16 v[148:151], v[228:231], v[100:103], v[148:151]
  s_cbranch_scc1 M_sx2
  buffer_load_dwordx4 v[24:27], v24, s[16:19], 0 offen
M_sx2:
  v_mfma_f32_16x16x32_bf16 v[156:159], v[228:231], v[124:127], v[156:159]
  s_waitcnt lgkmcnt(8)
  v_add_u32 v199, 112, v6
  v_med3_i32 v6, v198, v6, v199
  v_mfma_f32_16x16x32_bf16 v[136:139], v[200:203], v[80:83], v[136:139]
  ds_read_b128 v[224:227], v196 offset:1024
  v_mad_u32_u24 v6, v6, s6, v197
  v_mfma_f32_16x16x32_bf16 v[144:147], v[200:203], v[104:107], v[144:147]
  v_add_u32 v7, 3, v0
  v_lshl_add_u32 v198, v7, 1, s62
  v_mfma_f32_16x16x32_bf16 v[152:155], v[200:203], v[128:131], v[152:155]
  s_waitcnt lgkmcnt(7)
  v_add_u32 v199, 112, v7
  v_med3_i32 v7, v198, v7, v199
  v_mfma_f32_16x16x32_bf16 v[140:143], v[204:207], v[80:83], v[140:143]
  ds_read_b128 v[228:231], v196 offset:7168
  v_mad_u32_u24 v7, v7, s6, v197
  v_mfma_f32_16x16x32_bf16 v[148:151], v[204:207], v[104:107], v[148:151]
  s_cbranch_scc1 M_sx3
  buffer_load_dwordx4 v[28:31], v28, s[16:19], 0 offen
M_sx3:
  v_mfma_f32_16x16x32_bf16 v[156:159], v[204:207], v[128:131], v[156:159]
  s_waitcnt lgkmcnt(7)
  v_add_u32 v7, v7, v255
  v_add_u32 v8, 7, v0
  v_mfma_f32_16x16x32_bf16 v[136:139], v[208:211], v[84:87], v[136:139]
  ds_read_b128 v[200:203], v196 offset:2048
  v_lshl_add_u32 v198, v8, 1, s62
  v_mfma_f32_16x16x32_bf16 v[144:147], v[208:211], v[108:111], v[144:147]
  v_add_u32 v199, 112, v8
  v_med3_i32 v8, v198, v8, v199
  v_mfma_f32_16x16x32_bf16 v[152:155], v[208:211], v[132:135], v[152:155]
  s_waitcnt lgkmcnt(6)
  v_mad_u32_u24 v8, v8, s6, v197
  v_add_u32 v9, 8, v0
  v_mfma_f32_16x16x32_bf16 v[140:143], v[212:215], v[84:87], v[140:143]
  ds_read_b128 v[204:207], v196 offset:8192
  v_lshl_add_u32 v198, v9, 1, s62
  v_mfma_f32_16x16x32_bf16 v[148:151], v[212:215], v[108:111], v[148:151]
  v_add_u32 v199, 112, v9
  v_med3_i32 v9, v198, v9, v199
  v_mfma_f32_16x16x32_bf16 v[156:159], v[212:215], v[132:135], v[156:159]
  s_waitcnt lgkmcnt(6)
  v_mad_u32_u24 v9, v9, s6, v197
  v_add_u32 v10, 9, v0
  v_mfma_f32_16x16x32_bf16 v[160:163], v[216:219], v[64:67], 0
  ds_read_b128 v[208:211], v196 offset:3072
  v_lshl_add_u32 v198, v10, 1, s62
  v_mfma_f32_16x16x32_bf16 v[168:171], v[216:219], v[88:91], 0
  v_add_u32 v199, 112, v10
  v_med3_i32 v10, v198, v10, v199
  v_mfma_f32_16x16x32_bf16 v[176:179], v[216:219], v[112:115], 0
  s_waitcnt lgkmcnt(5)
  v_mad_u32_u24 v10, v10, s6, v197
  v_add_u32 v11, 10, v0
  v_mfma_f32_16x16x32_bf16 v[164:167], v[220:223], v[64:67], 0
  ds_read_b128 v[212:215], v196 offset:9216
  v_cvt_pk_bf16_f32 v184, v136, v137
  v_mfma_f32_16x16x32_bf16 v[172:175], v[220:223], v[88:91], 0
  s_cbranch_scc1 M_sx4
  buffer_load_dwordx4 v[40:43], v40, s[16:19], 0 offen
M_sx4:
  v_mfma_f32_16x16x32_bf16 v[180:183], v[220:223], v[112:115], 0
  s_waitcnt lgkmcnt(5)
  v_cvt_pk_bf16_f32 v185, v138, v139
  v_cvt_pk_bf16_f32 v186, v140, v141
  v_mfma_f32_16x16x32_bf16 v[160:163], v[224:227], v[68:71], v[160:163]
  ds_read_b128 v[216:219], v196 offset:4096
  v_cvt_pk_bf16_f32 v187, v142, v143
  v_mfma_f32_16x16x32_bf16 v[168:171], v[224:227], v[92:95], v[168:171]
  ds_write_b128 v192, v[184:187] offset:4096
  v_mfma_f32_16x16x32_bf16 v[176:179], v[224:227], v[116:119], v[176:179]
  s_waitcnt lgkmcnt(6)
  v_lshl_add_u32 v198, v11, 1, s62
  v_add_u32 v199, 112, v11
  v_mfma_f32_16x16x32_bf16 v[164:167], v[228:231], v[68:71], v[164:167]
  ds_read_b128 v[220:223], v196 offset:10240
  v_cvt_pk_bf16_f32 v188, v144, v145
  v_mfma_f32_16x16x32_bf16 v[172:175], v[228:231], v[92:95], v[172:175]
  v_cvt_pk_bf16_f32 v189, v146, v147
  v_cvt_pk_bf16_f32 v190, v148, v149
  v_mfma_f32_16x16x32_bf16 v[180:183], v[228:231], v[116:119], v[180:183]
  s_waitcnt lgkmcnt(6)
  v_cvt_pk_bf16_f32 v191, v150, v151
  v_med3_i32 v11, v198, v11, v199
  v_mfma_f32_16x16x32_bf16 v[160:163], v[200:203], v[72:75], v[160:163]
  ds_read_b128 v[224:227], v196 offset:5120
  v_mad_u32_u24 v11, v11, s6, v197
  v_mfma_f32_16x16x32_bf16 v[168:171], v[200:203], v[96:99], v[168:171]
  ds_write_b128 v193, v[188:191] offset:4096
  v_mfma_f32_16x16x32_bf16 v[176:179], v[200:203], v[120:123], v[176:179]
  s_waitcnt lgkmcnt(7)
  v_add_u32 v11, v11, v255
  v_mfma_f32_16x16x32_bf16 v[164:167], v[204:207], v[72:75], v[164:167]
  ds_read_b128 v[228:231], v196 offset:11264
  v_cvt_pk_bf16_f32 v184, v152, v153
  v_mfma_f32_16x16x32_bf16 v[172:175], v[204:207], v[96:99], v[172:175]
  s_cbranch_scc1 M_sx5
  buffer_load_dwordx4 v[44:47], v44, s[16:19], 0 offen
M_sx5:
  v_mfma_f32_16x16x32_bf16 v[180:183], v[204:207], v[120:123], v[180:183]
  s_waitcnt lgkmcnt(7)
  v_cvt_pk_bf16_f32 v185, v154, v155
  v_cvt_pk_bf16_f32 v186, v156, v157
  v_mfma_f32_16x16x32_bf16 v[160:163], v[208:211], v[76:79], v[160:163]
  ds_read_b128 v[200:203], v196 offset:12288
  v_cvt_pk_bf16_f32 v187, v158, v159
  v_mfma_f32_16x16x32_bf16 v[168:171], v[208:211], v[100:103], v[168:171]
  ds_write_b128 v194, v[184:187] offset:4096
  v_mfma_f32_16x16x32_bf16 v[176:179], v[208:211], v[124:127], v[176:179]
  s_waitcnt lgkmcnt(8)
  v_mfma_f32_16x16x32_bf16 v[164:167], v[212:215], v[76:79], v[164:167]
  ds_read_b128 v[204:207], v196 offset:18432
  v_mfma_f32_16x16x32_bf16 v[172:175], v[212:215], v[100:103], v[172:175]
  s_cbranch_scc1 M_sx6
  buffer_load_dwordx4 v[48:51], v48, s[16:19], 0 offen
M_sx6:
  v_mfma_f32_16x16x32_bf16 v[180:183], v[212:215], v[124:127], v[180:183]
  s_waitcnt lgkmcnt(8)
  v_mfma_f32_16x16x32_bf16 v[160:163], v[216:219], v[80:83], v[160:163]
  ds_read_b128 v[208:211], v196 offset:13312
  v_mfma_f32_16x16x32_bf16 v[168:171], v[216:219], v[104:107], v[168:171]
  v_mfma_f32_16x16x32_bf16 v[176:179], v[216:219], v[128:131], v[176:179]
  s_waitcnt lgkmcnt(7)
  v_mfma_f32_16x16x32_bf16 v[164:167], v[220:223], v[80:83], v[164:167]
  ds_read_b128 v[212:215], v196 offset:19456
  v_mfma_f32_16x16x32_bf16 v[172:175], v[220:223], v[104:107], v[172:175]
  v_mfma_f32_16x16x32_bf16 v[180:183], v[220:223], v[128:131], v[180:183]
  s_waitcnt lgkmcnt(7)
  v_mfma_f32_16x16x32_bf16 v[160:163], v[224:227], v[84:87], v[160:163]
  ds_read_b128 v[216:219], v196 offset:14336
  v_mfma_f32_16x16x32_bf16 v[168:171], v[224:227], v[108:111], v[168:171]
  v_mfma_f32_16x16x32_bf16 v[176:179], v[224:227], v[132:135], v[176:179]
  s_waitcnt lgkmcnt(6)
  v_mfma_f32_16x16x32_bf16 v[164:167], v[228:231], v[84:87], v[164:167]
  ds_read_b128 v[220:223], v196 offset:20480
  v_mfma_f32_16x16x32_bf16 v[172:175], v[228:231], v[108:111], v[172:175]
  s_cbranch_scc1 M_sx7
  buffer_load_dwordx4 v[52:55], v52, s[16:19], 0 offen
M_sx7:
  v_mfma_f32_16x16x32_bf16 v[180:183], v[228:231], v[132:135], v[180:183]
  s_waitcnt lgkmcnt(6)
  v_mfma_f32_16x16x32_bf16 v[136:139], v[200:203], v[64:67], 0
  ds_read_b128 v[224:227], v196 offset:15360
  v_mfma_f32_16x16x32_bf16 v[144:147], v[200:203], v[88:91], 0
  v_mfma_f32_16x16x32_bf16 v[152:155], v[200:203], v[112:115], 0
  s_waitcnt lgkmcnt(5)
  v_mfma_f32_16x16x32_bf16 v[140:143], v[204:207], v[64:67], 0
  ds_read_b128 v[228:231], v196 offset:21504
  v_cvt_pk_bf16_f32 v184, v160, v161
  v_mfma_f32_16x16x32_bf16 v[148:151], v[204:207], v[88:91], 0
  v_cvt_pk_bf16_f32 v185, v162, v163
  v_cvt_pk_bf16_f32 v186, v164, v165
  v_mfma_f32_16x16x32_bf16 v[156:159], v[204:207], v[112:115], 0
  s_waitcnt lgkmcnt(5)
  v_cvt_pk_bf16_f32 v187, v166, v167
  v_mfma_f32_16x16x32_bf16 v[136:139], v[208:211], v[68:71], v[136:139]
  ds_read_b128 v[200:203], v196 offset:16384
  v_mfma_f32_16x16x32_bf16 v[144:147], v[208:211], v[92:95], v[144:147]
  ds_write_b128 v192, v[184:187] offset:6144
  v_mfma_f32_16x16x32_bf16 v[152:155], v[208:211], v[116:119], v[152:155]
  s_waitcnt lgkmcnt(6)
  v_mfma_f32_16x16x32_bf16 v[140:143], v[212:215], v[68:71], v[140:143]
  ds_read_b128 v[204:207], v196 offset:22528
  v_cvt_pk_bf16_f32 v188, v168, v169
  v_mfma_f32_16x16x32_bf16 v[148:151], v[212:215], v[92:95], v[148:151]
  s_cbranch_scc1 M_sx8
  buffer_load_dwordx4 v[32:35], v32, s[16:19], 0 offen
M_sx8:
  v_mfma_f32_16x16x32_bf16 v[156:159], v[212:215], v[116:119], v[156:159]
  s_waitcnt lgkmcnt(6)
  v_cvt_pk_bf16_f32 v189, v170, v171
  v_cvt_pk_bf16_f32 v190, v172, v173
  v_mfma_f32_16x16x32_bf16 v[136:139], v[216:219], v[72:75], v[136:139]
  ds_read_b128 v[208:211], v196 offset:17408
  v_cvt_pk_bf16_f32 v191, v174, v175
  v_mfma_f32_16x16x32_bf16 v[144:147], v[216:219], v[96:99], v[144:147]
  ds_write_b128 v193, v[188:191] offset:6144
  v_mfma_f32_16x16x32_bf16 v[152:155], v[216:219], v[120:123], v[152:155]
  s_waitcnt lgkmcnt(7)
  v_mfma_f32_16x16x32_bf16 v[140:143], v[220:223], v[72:75], v[140:143]
  ds_read_b128 v[212:215], v196 offset:23552
  v_cvt_pk_bf16_f32 v184, v176, v177
  v_mfma_f32_16x16x32_bf16 v[148:151], v[220:223], v[96:99], v[148:151]
  s_cbranch_scc1 M_sx9
  buffer_load_dwordx4 v[36:39], v36, s[16:19], 0 offen
M_sx9:
  v_mfma_f32_16x16x32_bf16 v[156:159], v[220:223], v[120:123], v[156:159]
  s_waitcnt lgkmcnt(7)
  v_cvt_pk_bf16_f32 v185, v178, v179
  v_cvt_pk_bf16_f32 v186, v180, v181
  v_mfma_f32_16x16x32_bf16 v[136:139], v[224:227], v[76:79], v[136:139]
  ds_read_b128 v[216:219], v196 offset:24576
  v_cvt_pk_bf16_f32 v187, v182, v183
  v_mfma_f32_16x16x32_bf16 v[144:147], v[224:227], v[100:103], v[144:147]
  ds_write_b128 v194, v[184:187] offset:6144
  v_mfma_f32_16x16x32_bf16 v[152:155], v[224:227], v[124:127], v[152:155]
  s_waitcnt lgkmcnt(8)
  v_mfma_f32_16x16x32_bf16 v[140:143], v[228:231], v[76:79], v[140:143]
  ds_read_b128 v[220:223], v196 offset:30720
  v_mfma_f32_16x16x32_bf16 v[148:151], v[228:231], v[100:103], v[148:151]
  v_mfma_f32_16x16x32_bf16 v[156:159], v[228:231], v[124:127], v[156:159]
  s_waitcnt lgkmcnt(8)
  v_mfma_f32_16x16x32_bf16 v[136:139], v[200:203], v[80:83], v[136:139]
  ds_read_b128 v[224:227], v196 offset:25600
  v_mfma_f32_16x16x32_bf16 v[144:147], v[200:203], v[104:107], v[144:147]
  v_mfma_f32_16x16x32_bf16 v[152:155], v[200:203], v[128:131], v[152:155]
  s_waitcnt lgkmcnt(7)
  v_mfma_f32_16x16x32_bf16 v[140:143], v[204:207], v[80:83], v[140:143]
  ds_read_b128 v[228:231], v196 offset:31744
  v_mfma_f32_16x16x32_bf16 v[148:151], v[204:207], v[104:107], v[148:151]
  s_cbranch_scc1 M_sx10
  buffer_load_dwordx4 v[56:59], v56, s[16:19], 0 offen
M_sx10:
  v_mfma_f32_16x16x32_bf16 v[156:159], v[204:207], v[128:131], v[156:159]
  s_waitcnt lgkmcnt(7)
  v_mfma_f32_16x16x32_bf16 v[136:139], v[208:211], v[84:87], v[136:139]
  ds_read_b128 v[200:203], v196 offset:26624
  v_mfma_f32_16x16x32_bf16 v[144:147], v[208:211], v[108:111], v[144:147]
  v_mfma_f32_16x16x32_bf16 v[152:155], v[208:211], v[132:135], v[152:155]
  s_waitcnt lgkmcnt(6)
  v_mfma_f32_16x16x32_bf16 v[140:143], v[212:215], v[84:87], v[140:143]
  ds_read_b128 v[204:207], v196 offset:32768
  v_mfma_f32_16x16x32_bf16 v[148:151], v[212:215], v[108:111], v[148:151]
  v_mfma_f32_16x16x32_bf16 v[156:159], v[212:215], v[132:135], v[156:159]
  s_waitcnt lgkmcnt(6)
  v_mfma_f32_16x16x32_bf16 v[160:163], v[216:219], v[64:67], 0
  ds_read_b128 v[208:211], v196 offset:27648
  v_mfma_f32_16x16x32_bf16 v[168:171], v[216:219], v[88:91], 0
  s_cbranch_scc1 M_sx11
  buffer_load_dwordx4 v[60:63], v60, s[16:19], 0 offen
M_sx11:
  v_mfma_f32_16x16x32_bf16 v[176:179], v[216:219], v[112:115], 0
  s_waitcnt lgkmcnt(5)
  v_mfma_f32_16x16x32_bf16 v[164:167], v[220:223], v[64:67], 0
  ds_read_b128 v[212:215], v196 offset:33792
  v_cvt_pk_bf16_f32 v184, v136, v137
  v_mfma_f32_16x16x32_bf16 v[172:175], v[220:223], v[88:91], 0
  v_cvt_pk_bf16_f32 v185, v138, v139
  v_cvt_pk_bf16_f32 v186, v140, v141
  v_mfma_f32_16x16x32_bf16 v[180:183], v[220:223], v[112:115], 0
  s_waitcnt lgkmcnt(5)
  v_cvt_pk_bf16_f32 v187, v142, v143
  v_mfma_f32_16x16x32_bf16 v[160:163], v[224:227], v[68:71], v[160:163]
  ds_read_b128 v[216:219], v196 offset:28672
  v_mfma_f32_16x16x32_bf16 v[168:171], v[224:227], v[92:95], v[168:171]
  ds_write_b128 v192, v[184:187] offset:8192
  v_mfma_f32_16x16x32_bf16 v[176:179], v[224:227], v[116:119], v[176:179]
  s_waitcnt lgkmcnt(6)
  v_mfma_f32_16x16x32_bf16 v[164:167], v[228:231], v[68:71], v[164:167]
  ds_read_b128 v[220:223], v196 offset:34816
  v_cvt_pk_bf16_f32 v188, v144, v145
  v_mfma_f32_16x16x32_bf16 v[172:175], v[228:231], v[92:95], v[172:175]
  v_cvt_pk_bf16_f32 v189, v146, v147
  v_cvt_pk_bf16_f32 v190, v148, v149
  v_mfma_f32_16x16x32_bf16 v[180:183], v[228:231], v[116:119], v[180:183]
  s_waitcnt lgkmcnt(6)
  v_cvt_pk_bf16_f32 v191, v150, v151
  v_mfma_f32_16x16x32_bf16 v[160:163], v[200:203], v[72:75], v[160:163]
  ds_read_b128 v[224:227], v196 offset:29696
  v_mfma_f32_16x16x32_bf16 v[168:171], v[200:203], v[96:99], v[168:171]
  ds_write_b128 v193, v[188:191] offset:8192
  v_mfma_f32_16x16x32_bf16 v[176:179], v[200:203], v[120:123], v[176:179]
  s_waitcnt lgkmcnt(7)
  v_mfma_f32_16x16x32_bf16 v[164:167], v[204:207], v[72:75], v[164:167]
  ds_read_b128 v[228:231], v196 offset:35840
  v_cvt_pk_bf16_f32 v184, v152, v153
  v_mfma_f32_16x16x32_bf16 v[172:175], v[204:207], v[96:99], v[172:175]
  v_cvt_pk_bf16_f32 v185, v154, v155
  v_cvt_pk_bf16_f32 v186, v156, v157
  v_mfma_f32_16x16x32_bf16 v[180:183], v[204:207], v[120:123], v[180:183]
  s_waitcnt lgkmcnt(7)
  v_cvt_pk_bf16_f32 v187, v158, v159
  v_mfma_f32_16x16x32_bf16 v[160:163], v[208:211], v[76:79], v[160:163]
  v_mfma_f32_16x16x32_bf16 v[168:171], v[208:211], v[100:103], v[168:171]
  ds_write_b128 v194, v[184:187] offset:8192
  v_mfma_f32_16x16x32_bf16 v[176:179], v[208:211], v[124:127], v[176:179]
  s_waitcnt lgkmcnt(7)
  v_mfma_f32_16x16x32_bf16 v[164:167], v[212:215], v[76:79], v[164:167]
  v_mfma_f32_16x16x32_bf16 v[172:175], v[212:215], v[100:103], v[172:175]
  v_mfma_f32_16x16x32_bf16 v[180:183], v[212:215], v[124:127], v[180:183]
  s_waitcnt lgkmcnt(6)
  v_mfma_f32_16x16x32_bf16 v[160:163], v[216:219], v[80:83], v[160:163]
  v_mfma_f32_16x16x32_bf16 v[168:171], v[216:219], v[104:107], v[168:171]
  v_mfma_f32_16x16x32_bf16 v[176:179], v[216:219], v[128:131], v[176:179]
  s_waitcnt lgkmcnt(4)
  v_mfma_f32_16x16x32_bf16 v[164:167], v[220:223], v[80:83], v[164:167]
  v_mfma_f32_16x16x32_bf16 v[172:175], v[220:223], v[104:107], v[172:175]
  v_mfma_f32_16x16x32_bf16 v[180:183], v[220:223], v[128:131], v[180:183]
  s_waitcnt lgkmcnt(3)
  v_mfma_f32_16x16x32_bf16 v[160:163], v[224:227], v[84:87], v[160:163]
  v_mfma_f32_16x16x32_bf16 v[168:171], v[224:227], v[108:111], v[168:171]
  v_mfma_f32_16x16x32_bf16 v[176:179], v[224:227], v[132:135], v[176:179]
  s_waitcnt lgkmcnt(1)
  v_mfma_f32_16x16x32_bf16 v[164:167], v[228:231], v[84:87], v[164:167]
  v_mfma_f32_16x16x32_bf16 v[172:175], v[228:231], v[108:111], v[172:175]
  v_mfma_f32_16x16x32_bf16 v[180:183], v[228:231], v[132:135], v[180:183]
  s_nop 1
  v_cvt_pk_bf16_f32 v184, v160, v161
  v_cvt_pk_bf16_f32 v185, v162, v163
  s_nop 1
  v_cvt_pk_bf16_f32 v186, v164, v165
  v_cvt_pk_bf16_f32 v187, v166, v167
  ds_write_b128 v192, v[184:187] offset:10240
  v_cvt_pk_bf16_f32 v188, v168, v169
  v_cvt_pk_bf16_f32 v189, v170, v171
  v_cvt_pk_bf16_f32 v190, v172, v173
  v_cvt_pk_bf16_f32 v191, v174, v175
  ds_write_b128 v193, v[188:191] offset:10240
  v_cvt_pk_bf16_f32 v184, v176, v177
  v_cvt_pk_bf16_f32 v185, v178, v179
  v_cvt_pk_bf16_f32 v186, v180, v181
  v_cvt_pk_bf16_f32 v187, v182, v183
  ds_write_b128 v194, v[184:187] offset:10240
  s_waitcnt lgkmcnt(0)
  s_barrier
  s_cbranch_scc1 M_helper
  s_setprio 0
  s_mov_b64 vcc, s[0:1]
  s_waitcnt vmcnt(10)
  v_cndmask_b32_dpp v168, v20, v16, vcc quad_perm:[1,0,3,2] row_mask:0xf bank_mask:0xf
  v_cndmask_b32_dpp v169, v21, v17, vcc quad_perm:[1,0,3,2] row_mask:0xf bank_mask:0xf
  v_cndmask_b32_dpp v170, v22, v18, vcc quad_perm:[1,0,3,2] row_mask:0xf bank_mask:0xf
  v_cndmask_b32_dpp v171, v23, v19, vcc quad_perm:[1,0,3,2] row_mask:0xf bank_mask:0xf
  s_waitcnt vmcnt(8)
  v_cndmask_b32_dpp v176, v28, v24, vcc quad_perm:[1,0,3,2] row_mask:0xf bank_mask:0xf
  v_cndmask_b32_dpp v177, v29, v25, vcc quad_perm:[1,0,3,2] row_mask:0xf bank_mask:0xf
  v_cndmask_b32_dpp v178, v30, v26, vcc quad_perm:[1,0,3,2] row_mask:0xf bank_mask:0xf
  v_cndmask_b32_dpp v179, v31, v27, vcc quad_perm:[1,0,3,2] row_mask:0xf bank_mask:0xf
  s_not_b64 vcc, vcc
  v_cndmask_b32_dpp v172, v16, v20, vcc quad_perm:[1,0,3,2] row_mask:0xf bank_mask:0xf
  v_cndmask_b32_dpp v173, v17, v21, vcc quad_perm:[1,0,3,2] row_mask:0xf bank_mask:0xf
  v_cndmask_b32_dpp v174, v18, v22, vcc quad_perm:[1,0,3,2] row_mask:0xf bank_mask:0xf
  v_cndmask_b32_dpp v175, v19, v23, vcc quad_perm:[1,0,3,2] row_mask:0xf bank_mask:0xf
  v_cndmask_b32_dpp v180, v24, v28, vcc quad_perm:[1,0,3,2] row_mask:0xf bank_mask:0xf
  v_cndmask_b32_dpp v181, v25, v29, vcc quad_perm:[1,0,3,2] row_mask:0xf bank_mask:0xf
  v_cndmask_b32_dpp v182, v26, v30, vcc quad_perm:[1,0,3,2] row_mask:0xf bank_mask:0xf
  v_cndmask_b32_dpp v183, v27, v31, vcc quad_perm:[1,0,3,2] row_mask:0xf bank_mask:0xf
  s_mov_b64 vcc, s[10:11]
  v_cndmask_b32_dpp v16, v176, v168, vcc quad_perm:[2,3,0,1] row_mask:0xf bank_mask:0xf
  v_cndmask_b32_dpp v17, v177, v169, vcc quad_perm:[2,3,0,1] row_mask:0xf bank_mask:0xf
  v_cndmask_b32_dpp v18, v178, v170, vcc quad_perm:[2,3,0,1] row_mask:0xf bank_mask:0xf
  v_cndmask_b32_dpp v19, v179, v171, vcc quad_perm:[2,3,0,1] row_mask:0xf bank_mask:0xf
  v_cndmask_b32_dpp v20, v180, v172, vcc quad_perm:[2,3,0,1] row_mask:0xf bank_mask:0xf
  v_cndmask_b32_dpp v21, v181, v173, vcc quad_perm:[2,3,0,1] row_mask:0xf bank_mask:0xf
  v_cndmask_b32_dpp v22, v182, v174, vcc quad_perm:[2,3,0,1] row_mask:0xf bank_mask:0xf
  v_cndmask_b32_dpp v23, v183, v175, vcc quad_perm:[2,3,0,1] row_mask:0xf bank_mask:0xf
  s_not_b64 vcc, vcc
  v_cndmask_b32_dpp v24, v168, v176, vcc quad_perm:[2,3,0,1] row_mask:0xf bank_mask:0xf
  v_cndmask_b32_dpp v25, v169, v177, vcc quad_perm:[2,3,0,1] row_mask:0xf bank_mask:0xf
  v_cndmask_b32_dpp v26, v170, v178, vcc quad_perm:[2,3,0,1] row_mask:0xf bank_mask:0xf
  v_cndmask_b32_dpp v27, v171, v179, vcc quad_perm:[2,3,0,1] row_mask:0xf bank_mask:0xf
  v_cndmask_b32_dpp v28, v172, v180, vcc quad_perm:[2,3,0,1] row_mask:0xf bank_mask:0xf
  v_cndmask_b32_dpp v29, v173, v181, vcc quad_perm:[2,3,0,1] row_mask:0xf bank_mask:0xf
  v_cndmask_b32_dpp v30, v174, v182, vcc quad_perm:[2,3,0,1] row_mask:0xf bank_mask:0xf
  v_cndmask_b32_dpp v31, v175, v183, vcc quad_perm:[2,3,0,1] row_mask:0xf bank_mask:0xf
  s_mov_b64 vcc, s[0:1]
  s_waitcnt vmcnt(6)
  v_cndmask_b32_dpp v168, v44, v40, vcc quad_perm:[1,0,3,2] row_mask:0xf bank_mask:0xf
  v_cndmask_b32_dpp v169, v45, v41, vcc quad_perm:[1,0,3,2] row_mask:0xf bank_mask:0xf
  v_cndmask_b32_dpp v170, v46, v42, vcc quad_perm:[1,0,3,2] row_mask:0xf bank_mask:0xf
  v_cndmask_b32_dpp v171, v47, v43, vcc quad_perm:[1,0,3,2] row_mask:0xf bank_mask:0xf
  s_waitcnt vmcnt(4)
  v_cndmask_b32_dpp v176, v52, v48, vcc quad_perm:[1,0,3,2] row_mask:0xf bank_mask:0xf
  v_cndmask_b32_dpp v177, v53, v49, vcc quad_perm:[1,0,3,2] row_mask:0xf bank_mask:0xf
  v_cndmask_b32_dpp v178, v54, v50, vcc quad_perm:[1,0,3,2] row_mask:0xf bank_mask:0xf
  v_cndmask_b32_dpp v179, v55, v51, vcc quad_perm:[1,0,3,2] row_mask:0xf bank_mask:0xf
  s_not_b64 vcc, vcc
  v_cndmask_b32_dpp v172, v40, v44, vcc quad_perm:[1,0,3,2] row_mask:0xf bank_mask:0xf
  v_cndmask_b32_dpp v173, v41, v45, vcc quad_perm:[1,0,3,2] row_mask:0xf bank_mask:0xf
  v_cndmask_b32_dpp v174, v42, v46, vcc quad_perm:[1,0,3,2] row_mask:0xf bank_mask:0xf
  v_cndmask_b32_dpp v175, v43, v47, vcc quad_perm:[1,0,3,2] row_mask:0xf bank_mask:0xf
  v_cndmask_b32_dpp v180, v48, v52, vcc quad_perm:[1,0,3,2] row_mask:0xf bank_mask:0xf
  v_cndmask_b32_dpp v181, v49, v53, vcc quad_perm:[1,0,3,2] row_mask:0xf bank_mask:0xf
  v_cndmask_b32_dpp v182, v50, v54, vcc quad_perm:[1,0,3,2] row_mask:0xf bank_mask:0xf
  v_cndmask_b32_dpp v183, v51, v55, vcc quad_perm:[1,0,3,2] row_mask:0xf bank_mask:0xf
  s_mov_b64 vcc, s[10:11]
  v_cndmask_b32_dpp v40, v176, v168, vcc quad_perm:[2,3,0,1] row_mask:0xf bank_mask:0xf
  v_cndmask_b32_dpp v41, v177, v169, vcc quad_perm:[2,3,0,1] row_mask:0xf bank_mask:0xf
  v_cndmask_b32_dpp v42, v178, v170, vcc quad_perm:[2,3,0,1] row_mask:0xf bank_mask:0xf
  v_cndmask_b32_dpp v43, v179, v171, vcc quad_perm:[2,3,0,1] row_mask:0xf bank_mask:0xf
  v_cndmask_b32_dpp v44, v180, v172, vcc quad_perm:[2,3,0,1] row_mask:0xf bank_mask:0xf
  v_cndmask_b32_dpp v45, v181, v173, vcc quad_perm:[2,3,0,1] row_mask:0xf bank_mask:0xf
  v_cndmask_b32_dpp v46, v182, v174, vcc quad_perm:[2,3,0,1] row_mask:0xf bank_mask:0xf
  v_cndmask_b32_dpp v47, v183, v175, vcc quad_perm:[2,3,0,1] row_mask:0xf bank_mask:0xf
  s_not_b64 vcc, vcc
  v_cndmask_b32_dpp v48, v168, v176, vcc quad_perm:[2,3,0,1] row_mask:0xf bank_mask:0xf
  v_cndmask_b32_dpp v49, v169, v177, vcc quad_perm:[2,3,0,1] row_mask:0xf bank_mask:0xf
  v_cndmask_b32_dpp v50, v170, v178, vcc quad_perm:[2,3,0,1] row_mask:0xf bank_mask:0xf
  v_cndmask_b32_dpp v51, v171, v179, vcc quad_perm:[2,3,0,1] row_mask:0xf bank_mask:0xf
  v_cndmask_b32_dpp v52, v172, v180, vcc quad_perm:[2,3,0,1] row_mask:0xf bank_mask:0xf
  v_cndmask_b32_dpp v53, v173, v181, vcc quad_perm:[2,3,0,1] row_mask:0xf bank_mask:0xf
  v_cndmask_b32_dpp v54, v174, v182, vcc quad_perm:[2,3,0,1] row_mask:0xf bank_mask:0xf
  v_cndmask_b32_dpp v55, v175, v183, vcc quad_perm:[2,3,0,1] row_mask:0xf bank_mask:0xf
  s_mov_b64 vcc, s[0:1]
  s_waitcnt vmcnt(2)
  v_cndmask_b32_dpp v168, v36, v32, vcc quad_perm:[1,0,3,2] row_mask:0xf bank_mask:0xf
  v_cndmask_b32_dpp v169, v37, v33, vcc quad_perm:[1,0,3,2] row_mask:0xf bank_mask:0xf
  v_cndmask_b32_dpp v170, v38, v34, vcc quad_perm:[1,0,3,2] row_mask:0xf bank_mask:0xf
  v_cndmask_b32_dpp v171, v39, v35, vcc quad_perm:[1,0,3,2] row_mask:0xf bank_mask:0xf
  s_waitcnt vmcnt(0)
  v_cndmask_b32_dpp v176, v60, v56, vcc quad_perm:[1,0,3,2] row_mask:0xf bank_mask:0xf
  v_cndmask_b32_dpp v177, v61, v57, vcc quad_perm:[1,0,3,2] row_mask:0xf bank_mask:0xf
  v_cndmask_b32_dpp v178, v62, v58, vcc quad_perm:[1,0,3,2] row_mask:0xf bank_mask:0xf
  v_cndmask_b32_dpp v179, v63, v59, vcc quad_perm:[1,0,3,2] row_mask:0xf bank_mask:0xf
  s_not_b64 vcc, vcc
  v_cndmask_b32_dpp v172, v32, v36, vcc quad_perm:[1,0,3,2] row_mask:0xf bank_mask:0xf
  v_cndmask_b32_dpp v173, v33, v37, vcc quad_perm:[1,0,3,2] row_mask:0xf bank_mask:0xf
  v_cndmask_b32_dpp v174, v34, v38, vcc quad_perm:[1,0,3,2] row_mask:0xf bank_mask:0xf
  v_cndmask_b32_dpp v175, v35, v39, vcc quad_perm:[1,0,3,2] row_mask:0xf bank_mask:0xf
  v_cndmask_b32_dpp v180, v56, v60, vcc quad_perm:[1,0,3,2] row_mask:0xf bank_mask:0xf
  v_cndmask_b32_dpp v181, v57, v61, vcc quad_perm:[1,0,3,2] row_mask:0xf bank_mask:0xf
  v_cndmask_b32_dpp v182, v58, v62, vcc quad_perm:[1,0,3,2] row_mask:0xf bank_mask:0xf
  v_cndmask_b32_dpp v183, v59, v63, vcc quad_perm:[1,0,3,2] row_mask:0xf bank_mask:0xf
  s_mov_b64 vcc, s[10:11]
  v_cndmask_b32_dpp v32, v176, v168, vcc quad_perm:[2,3,0,1] row_mask:0xf bank_mask:0xf
  v_cndmask_b32_dpp v33, v177, v169, vcc quad_perm:[2,3,0,1] row_mask:0xf bank_mask:0xf
  v_cndmask_b32_dpp v34, v178, v170, vcc quad_perm:[2,3,0,1] row_mask:0xf bank_mask:0xf
  v_cndmask_b32_dpp v35, v179, v171, vcc quad_perm:[2,3,0,1] row_mask:0xf bank_mask:0xf
  v_cndmask_b32_dpp v36, v180, v172, vcc quad_perm:[2,3,0,1] row_mask:0xf bank_mask:0xf
  v_cndmask_b32_dpp v37, v181, v173, vcc quad_perm:[2,3,0,1] row_mask:0xf bank_mask:0xf
  v_cndmask_b32_dpp v38, v182, v174, vcc quad_perm:[2,3,0,1] row_mask:0xf bank_mask:0xf
  v_cndmask_b32_dpp v39, v183, v175, vcc quad_perm:[2,3,0,1] row_mask:0xf bank_mask:0xf
  s_not_b64 vcc, vcc
  v_cndmask_b32_dpp v56, v168, v176, vcc quad_perm:[2,3,0,1] row_mask:0xf bank_mask:0xf
  v_cndmask_b32_dpp v57, v169, v177, vcc quad_perm:[2,3,0,1] row_mask:0xf bank_mask:0xf
  v_cndmask_b32_dpp v58, v170, v178, vcc quad_perm:[2,3,0,1] row_mask:0xf bank_mask:0xf
  v_cndmask_b32_dpp v59, v171, v179, vcc quad_perm:[2,3,0,1] row_mask:0xf bank_mask:0xf
  v_cndmask_b32_dpp v60, v172, v180, vcc quad_perm:[2,3,0,1] row_mask:0xf bank_mask:0xf
  v_cndmask_b32_dpp v61, v173, v181, vcc quad_perm:[2,3,0,1] row_mask:0xf bank_mask:0xf
  v_cndmask_b32_dpp v62, v174, v182, vcc quad_perm:[2,3,0,1] row_mask:0xf bank_mask:0xf
  v_cndmask_b32_dpp v63, v175, v183, vcc quad_perm:[2,3,0,1] row_mask:0xf bank_mask:0xf
  v_permlane32_swap_b32 v32, v56
  v_permlane32_swap_b32 v33, v57
  v_permlane32_swap_b32 v34, v58
  v_permlane32_swap_b32 v35, v59
  v_permlane32_swap_b32 v36, v60
  v_permlane32_swap_b32 v37, v61
  v_permlane32_swap_b32 v38, v62
  v_permlane32_swap_b32 v39, v63
M_pa:
  ds_read_b128 v[200:203], v254 offset:0
  ds_read_b128 v[204:207], v254 offset:1024
  ds_read_b128 v[208:211], v254 offset:2048
  ds_read_b128 v[212:215], v254 offset:3072
  ds_read_b128 v[216:219], v254 offset:4096
  ds_read_b128 v[220:223], v254 offset:5120
  s_waitcnt lgkmcnt(5)
  v_mfma_f32_16x16x32_bf16 v[168:171], v[200:203], v[16:19], 0
  ds_read_b128 v[224:227], v254 offset:6144
  v_mfma_f32_16x16x32_bf16 v[176:179], v[200:203], v[40:43], 0
  s_waitcnt lgkmcnt(5)
  v_mfma_f32_16x16x32_bf16 v[172:175], v[204:207], v[16:19], 0
  ds_read_b128 v[228:231], v254 offset:7168
  v_mfma_f32_16x16x32_bf16 v[180:183], v[204:207], v[40:43], 0
  s_waitcnt lgkmcnt(5)
  v_mfma_f32_16x16x32_bf16 v[168:171], v[208:211], v[20:23], v[168:171]
  ds_read_b128 v[200:203], v254 offset:8192
  v_mfma_f32_16x16x32_bf16 v[176:179], v[208:211], v[44:47], v[176:179]
  s_waitcnt lgkmcnt(5)
  v_mfma_f32_16x16x32_bf16 v[172:175], v[212:215], v[20:23], v[172:175]
  ds_read_b128 v[204:207], v254 offset:9216
  v_mfma_f32_16x16x32_bf16 v[180:183], v[212:215], v[44:47], v[180:183]
  s_waitcnt lgkmcnt(5)
  v_mfma_f32_16x16x32_bf16 v[168:171], v[216:219], v[24:27], v[168:171]
  ds_read_b128 v[208:211], v254 offset:10240
  v_mfma_f32_16x16x32_bf16 v[176:179], v[216:219], v[48:51], v[176:179]
  s_waitcnt lgkmcnt(5)
  v_mfma_f32_16x16x32_bf16 v[172:175], v[220:223], v[24:27], v[172:175]
  ds_read_b128 v[212:215], v254 offset:11264
  v_mfma_f32_16x16x32_bf16 v[180:183], v[220:223], v[48:51], v[180:183]
  s_waitcnt lgkmcnt(5)
  v_mfma_f32_16x16x32_bf16 v[168:171], v[224:227], v[28:31], v[168:171]
  ds_read_b128 v[216:219], v254 offset:12288
  v_mfma_f32_16x16x32_bf16 v[176:179], v[224:227], v[52:55], v[176:179]
  s_waitcnt lgkmcnt(5)
  v_mfma_f32_16x16x32_bf16 v[172:175], v[228:231], v[28:31], v[172:175]
  ds_read_b128 v[220:223], v254 offset:13312
  v_mfma_f32_16x16x32_bf16 v[180:183], v[228:231], v[52:55], v[180:183]
  s_waitcnt lgkmcnt(5)
  v_mfma_f32_16x16x32_bf16 v[168:171], v[200:203], v[32:35], v[168:171]
  ds_read_b128 v[224:227], v254 offset:14336
  v_mfma_f32_16x16x32_bf16 v[176:179], v[200:203], v[56:59], v[176:179]
  s_waitcnt lgkmcnt(5)
  v_mfma_f32_16x16x32_bf16 v[172:175], v[204:207], v[32:35], v[172:175]
  ds_read_b128 v[228:231], v254 offset:15360
  v_mfma_f32_16x16x32_bf16 v[180:183], v[204:207], v[56:59], v[180:183]
  s_waitcnt lgkmcnt(5)
  v_mfma_f32_16x16x32_bf16 v[168:171], v[208:211], v[36:39], v[168:171]
  ds_read_b128 v[200:203], v254 offset:16384
  v_mfma_f32_16x16x32_bf16 v[176:179], v[208:211], v[60:63], v[176:179]
  s_waitcnt lgkmcnt(5)
  v_mfma_f32_16x16x32_bf16 v[172:175], v[212:215], v[36:39], v[172:175]
  ds_read_b128 v[204:207], v254 offset:17408
  v_mfma_f32_16x16x32_bf16 v[180:183], v[212:215], v[60:63], v[180:183]
  s_cmp_ge_u32 s94, 144
  s_cbranch_scc1 M_v2
  v_lshlrev_b32 v119, 3, v3
  v_lshl_add_u32 v119, v2, 8, v119
  v_add_u32 v119, 79872, v119
  s_waitcnt vmcnt(0)
  ds_read_b128 v[64:67], v118 offset:0
  ds_read_b128 v[68:71], v118 offset:1024
  ds_read_b128 v[72:75], v118 offset:2048
  ds_read_b128 v[76:79], v118 offset:3072
  ds_read_b128 v[80:83], v118 offset:4096
  ds_read_b128 v[84:87], v118 offset:5120
  s_waitcnt lgkmcnt(2)
  ds_read_b64_tr_b16 v[88:89], v119 offset:0
  ds_read_b64_tr_b16 v[90:91], v119 offset:128
  ds_read_b64_tr_b16 v[92:93], v119 offset:1024
  ds_read_b64_tr_b16 v[94:95], v119 offset:1152
  ds_read_b64_tr_b16 v[96:97], v119 offset:2048
  ds_read_b64_tr_b16 v[98:99], v119 offset:2176
  ds_read_b64_tr_b16 v[100:101], v119 offset:3072
  ds_read_b64_tr_b16 v[102:103], v119 offset:3200
  ds_read_b64_tr_b16 v[104:105], v119 offset:4096
  ds_read_b64_tr_b16 v[106:107], v119 offset:4224
  ds_read_b64_tr_b16 v[108:109], v119 offset:5120
  ds_read_b64_tr_b16 v[110:111], v119 offset:5248
  s_waitcnt lgkmcnt(0)
  v_mfma_f32_16x16x32_bf16 v[112:115], v[64:67], v[88:91], 0
  v_mfma_f32_16x16x32_bf16 v[112:115], v[68:71], v[92:95], v[112:115]
  v_mfma_f32_16x16x32_bf16 v[112:115], v[72:75], v[96:99], v[112:115]
  v_mfma_f32_16x16x32_bf16 v[112:115], v[76:79], v[100:103], v[112:115]
  v_mfma_f32_16x16x32_bf16 v[112:115], v[80:83], v[104:107], v[112:115]
  v_mfma_f32_16x16x32_bf16 v[112:115], v[84:87], v[108:111], v[112:115]
  v_bfe_u32 v118, v3, 1, 1
  v_mul_u32_u24 v118, 12288, v118
  v_and_b32 v119, 1, v3
  v_lshl_add_u32 v118, v119, 10, v118
  v_lshrrev_b32 v119, 2, v3
  v_lshl_add_u32 v118, v119, 4, v118
  v_lshl_add_u32 v118, v2, 8, v118
  s_nop 0
  v_cvt_pk_bf16_f32 v116, v112, v113
  v_cvt_pk_bf16_f32 v117, v114, v115
  buffer_store_dwordx2 v[116:117], v118, s[24:27], s95 offen sc1
M_v2:
  s_waitcnt lgkmcnt(5)
  v_mfma_f32_16x16x32_bf16 v[184:187], v[216:219], v[16:19], 0
  ds_read_b128 v[208:211], v254 offset:18432
  v_mfma_f32_16x16x32_bf16 v[192:195], v[216:219], v[40:43], 0
  s_waitcnt lgkmcnt(5)
  v_mfma_f32_16x16x32_bf16 v[188:191], v[220:223], v[16:19], 0
  ds_read_b128 v[212:215], v254 offset:19456
  v_cvt_pk_bf16_f32 v120, v168, v169
  v_mfma_f32_16x16x32_bf16 v[196:199], v[220:223], v[40:43], 0
  s_waitcnt lgkmcnt(5)
  v_cvt_pk_bf16_f32 v121, v170, v171
  v_cvt_pk_bf16_f32 v122, v172, v173
  v_mfma_f32_16x16x32_bf16 v[184:187], v[224:227], v[20:23], v[184:187]
  ds_read_b128 v[216:219], v254 offset:20480
  v_cvt_pk_bf16_f32 v123, v174, v175
  v_mfma_f32_16x16x32_bf16 v[192:195], v[224:227], v[44:47], v[192:195]
  s_waitcnt lgkmcnt(5)
  v_cvt_pk_bf16_f32 v144, v176, v177
  v_cvt_pk_bf16_f32 v145, v178, v179
  v_mfma_f32_16x16x32_bf16 v[188:191], v[228:231], v[20:23], v[188:191]
  ds_read_b128 v[220:223], v254 offset:21504
  v_cvt_pk_bf16_f32 v146, v180, v181
  v_mfma_f32_16x16x32_bf16 v[196:199], v[228:231], v[44:47], v[196:199]
  s_waitcnt lgkmcnt(5)
  v_cvt_pk_bf16_f32 v147, v182, v183
  v_mfma_f32_16x16x32_bf16 v[184:187], v[200:203], v[24:27], v[184:187]
  ds_read_b128 v[224:227], v254 offset:22528
  v_mfma_f32_16x16x32_bf16 v[192:195], v[200:203], v[48:51], v[192:195]
  s_waitcnt lgkmcnt(5)
  v_mfma_f32_16x16x32_bf16 v[188:191], v[204:207], v[24:27], v[188:191]
  ds_read_b128 v[228:231], v254 offset:23552
  v_mfma_f32_16x16x32_bf16 v[196:199], v[204:207], v[48:51], v[196:199]
  s_waitcnt lgkmcnt(5)
  v_mfma_f32_16x16x32_bf16 v[184:187], v[208:211], v[28:31], v[184:187]
  ds_read_b128 v[200:203], v254 offset:24576
  v_mfma_f32_16x16x32_bf16 v[192:195], v[208:211], v[52:55], v[192:195]
  s_waitcnt lgkmcnt(5)
  v_mfma_f32_16x16x32_bf16 v[188:191], v[212:215], v[28:31], v[188:191]
  ds_read_b128 v[204:207], v254 offset:25600
  v_mfma_f32_16x16x32_bf16 v[196:199], v[212:215], v[52:55], v[196:199]
  s_waitcnt lgkmcnt(5)
  v_mfma_f32_16x16x32_bf16 v[184:187], v[216:219], v[32:35], v[184:187]
  ds_read_b128 v[208:211], v254 offset:26624
  v_mfma_f32_16x16x32_bf16 v[192:195], v[216:219], v[56:59], v[192:195]
  s_waitcnt lgkmcnt(5)
  v_mfma_f32_16x16x32_bf16 v[188:191], v[220:223], v[32:35], v[188:191]
  ds_read_b128 v[212:215], v254 offset:27648
  v_mfma_f32_16x16x32_bf16 v[196:199], v[220:223], v[56:59], v[196:199]
  s_waitcnt lgkmcnt(5)
  v_mfma_f32_16x16x32_bf16 v[184:187], v[224:227], v[36:39], v[184:187]
  ds_read_b128 v[216:219], v254 offset:28672
  v_mfma_f32_16x16x32_bf16 v[192:195], v[224:227], v[60:63], v[192:195]
  s_waitcnt lgkmcnt(5)
  v_bfe_i32 v66, v14, 0, 1
  v_bfe_i32 v94, v15, 6, 1
  v_mfma_f32_16x16x32_bf16 v[188:191], v[228:231], v[36:39], v[188:191]
  ds_read_b128 v[220:223], v254 offset:29696
  v_and_b32 v65, s54, v66
  v_mfma_f32_16x16x32_bf16 v[196:199], v[228:231], v[60:63], v[196:199]
  v_and_b32 v93, s54, v94
  v_and_b32 v66, s54, v66
  s_cmp_ge_u32 s94, 144
  s_cbranch_scc1 M_v4
  v_mov_b32 v255, 1
  v_mov_b32 v0, 0
  s_mov_b64 exec, 1
  s_waitcnt vmcnt(0)
  buffer_atomic_add v255, v0, s[36:39], 0 offen sc0 sc1
  s_mov_b64 exec, -1
M_v4:
  s_waitcnt lgkmcnt(5)
  v_mfma_f32_16x16x32_bf16 v[168:171], v[200:203], v[16:19], 0
  ds_read_b128 v[224:227], v254 offset:30720
  v_and_b32 v94, s54, v94
  v_mfma_f32_16x16x32_bf16 v[176:179], v[200:203], v[40:43], 0
  s_waitcnt lgkmcnt(5)
  v_or_b32 v64, v65, v12
  v_or_b32 v92, v93, v12
  v_mfma_f32_16x16x32_bf16 v[172:175], v[204:207], v[16:19], 0
  ds_read_b128 v[228:231], v254 offset:31744
  v_cvt_pk_bf16_f32 v124, v184, v185
  v_mfma_f32_16x16x32_bf16 v[180:183], v[204:207], v[40:43], 0
  s_waitcnt lgkmcnt(5)
  v_cvt_pk_bf16_f32 v125, v186, v187
  v_cvt_pk_bf16_f32 v126, v188, v189
  v_mfma_f32_16x16x32_bf16 v[168:171], v[208:211], v[20:23], v[168:171]
  ds_read_b128 v[200:203], v254 offset:32768
  v_cvt_pk_bf16_f32 v127, v190, v191
  v_mfma_f32_16x16x32_bf16 v[176:179], v[208:211], v[44:47], v[176:179]
  s_waitcnt lgkmcnt(5)
  v_cvt_pk_bf16_f32 v148, v192, v193
  v_cvt_pk_bf16_f32 v149, v194, v195
  v_mfma_f32_16x16x32_bf16 v[172:175], v[212:215], v[20:23], v[172:175]
  ds_read_b128 v[204:207], v254 offset:33792
  v_cvt_pk_bf16_f32 v150, v196, v197
  v_mfma_f32_16x16x32_bf16 v[180:183], v[212:215], v[44:47], v[180:183]
  s_waitcnt lgkmcnt(5)
  v_cvt_pk_bf16_f32 v151, v198, v199
  v_or_b32 v67, v65, v13
  v_mfma_f32_16x16x32_bf16 v[168:171], v[216:219], v[24:27], v[168:171]
  ds_read_b128 v[208:211], v254 offset:34816
  v_or_b32 v95, v93, v13
  v_mfma_f32_16x16x32_bf16 v[176:179], v[216:219], v[48:51], v[176:179]
  s_waitcnt lgkmcnt(5)
  v_bfe_i32 v70, v14, 2, 1
  v_bfe_i32 v98, v15, 8, 1
  v_mfma_f32_16x16x32_bf16 v[172:175], v[220:223], v[24:27], v[172:175]
  ds_read_b128 v[212:215], v254 offset:35840
  v_and_b32 v69, s54, v70
  v_mfma_f32_16x16x32_bf16 v[180:183], v[220:223], v[48:51], v[180:183]
  s_waitcnt lgkmcnt(5)
  v_and_b32 v97, s54, v98
  v_and_b32 v70, s54, v70
  v_mfma_f32_16x16x32_bf16 v[168:171], v[224:227], v[28:31], v[168:171]
  ds_read_b128 v[216:219], v254 offset:36864
  v_and_b32 v98, s54, v98
  v_mfma_f32_16x16x32_bf16 v[176:179], v[224:227], v[52:55], v[176:179]
  s_waitcnt lgkmcnt(5)
  v_or_b32 v68, v69, v12
  v_or_b32 v96, v97, v12
  v_mfma_f32_16x16x32_bf16 v[172:175], v[228:231], v[28:31], v[172:175]
  ds_read_b128 v[220:223], v254 offset:37888
  v_or_b32 v71, v69, v13
  v_mfma_f32_16x16x32_bf16 v[180:183], v[228:231], v[52:55], v[180:183]
  s_waitcnt lgkmcnt(5)
  v_or_b32 v99, v97, v13
  v_bfe_i32 v74, v14, 4, 1
  v_mfma_f32_16x16x32_bf16 v[168:171], v[200:203], v[32:35], v[168:171]
  ds_read_b128 v[224:227], v254 offset:38912
  v_bfe_i32 v102, v15, 10, 1
  v_mfma_f32_16x16x32_bf16 v[176:179], v[200:203], v[56:59], v[176:179]
  s_waitcnt lgkmcnt(5)
  v_and_b32 v73, s54, v74
  v_and_b32 v101, s54, v102
  v_mfma_f32_16x16x32_bf16 v[172:175], v[204:207], v[32:35], v[172:175]
  ds_read_b128 v[228:231], v254 offset:39936
  v_and_b32 v74, s54, v74
  v_mfma_f32_16x16x32_bf16 v[180:183], v[204:207], v[56:59], v[180:183]
  s_waitcnt lgkmcnt(5)
  v_and_b32 v102, s54, v102
  v_or_b32 v72, v73, v12
  v_mfma_f32_16x16x32_bf16 v[168:171], v[208:211], v[36:39], v[168:171]
  ds_read_b128 v[200:203], v254 offset:40960
  v_or_b32 v100, v101, v12
  v_mfma_f32_16x16x32_bf16 v[176:179], v[208:211], v[60:63], v[176:179]
  s_waitcnt lgkmcnt(5)
  v_or_b32 v75, v73, v13
  v_or_b32 v103, v101, v13
  v_mfma_f32_16x16x32_bf16 v[172:175], v[212:215], v[36:39], v[172:175]
  ds_read_b128 v[204:207], v254 offset:41984
  v_bfe_i32 v78, v14, 6, 1
  v_mfma_f32_16x16x32_bf16 v[180:183], v[212:215], v[60:63], v[180:183]
  v_bfe_i32 v106, v15, 12, 1
  v_and_b32 v77, s54, v78
  s_cmp_ge_u32 s94, 144
  s_cbranch_scc1 M_v5
  s_waitcnt vmcnt(0)
  v_readfirstlane_b32 s56, v255
  s_nop 1
  s_cmp_lg_u32 s56, 143
  s_cbranch_scc1 M_v5
  s_mov_b64 exec, 1
  buffer_store_dword v255, v0, s[36:39], 0 offen offset:128 sc1
  s_mov_b64 exec, -1
M_v5:
  s_barrier
  s_waitcnt lgkmcnt(5)
  v_mfma_f32_16x16x32_bf16 v[184:187], v[216:219], v[16:19], 0
  ds_read_b128 v[208:211], v254 offset:43008
  s_add_u32 m0, s101, 0
  s_nop 0
  buffer_load_dwordx4 v232, s[16:19], s100 offen lds
  v_mfma_f32_16x16x32_bf16 v[192:195], v[216:219], v[40:43], 0
  s_waitcnt lgkmcnt(5)
  s_add_u32 m0, s101, 1024
  s_nop 0
  buffer_load_dwordx4 v233, s[16:19], s100 offen lds
  s_add_u32 m0, s101, 2048
  s_nop 0
  buffer_load_dwordx4 v234, s[16:19], s100 offen lds
  v_mfma_f32_16x16x32_bf16 v[188:191], v[220:223], v[16:19], 0
  ds_read_b128 v[212:215], v254 offset:44032
  v_cvt_pk_bf16_f32 v128, v168, v169
  v_mfma_f32_16x16x32_bf16 v[196:199], v[220:223], v[40:43], 0
  s_waitcnt lgkmcnt(5)
  v_cvt_pk_bf16_f32 v129, v170, v171
  v_cvt_pk_bf16_f32 v130, v172, v173
  v_mfma_f32_16x16x32_bf16 v[184:187], v[224:227], v[20:23], v[184:187]
  ds_read_b128 v[216:219], v254 offset:45056
  v_cvt_pk_bf16_f32 v131, v174, v175
  v_mfma_f32_16x16x32_bf16 v[192:195], v[224:227], v[44:47], v[192:195]
  s_waitcnt lgkmcnt(5)
  v_cvt_pk_bf16_f32 v152, v176, v177
  v_cvt_pk_bf16_f32 v153, v178, v179
  v_mfma_f32_16x16x32_bf16 v[188:191], v[228:231], v[20:23], v[188:191]
  ds_read_b128 v[220:223], v254 offset:46080
  v_cvt_pk_bf16_f32 v154, v180, v181
  v_mfma_f32_16x16x32_bf16 v[196:199], v[228:231], v[44:47], v[196:199]
  s_waitcnt lgkmcnt(5)
  v_cvt_pk_bf16_f32 v155, v182, v183
  s_add_u32 m0, s101, 3072
  s_nop 0
  buffer_load_dwordx4 v235, s[16:19], s100 offen lds
  v_mfma_f32_16x16x32_bf16 v[184:187], v[200:203], v[24:27], v[184:187]
  ds_read_b128 v[224:227], v254 offset:47104
  s_add_u32 m0, s101, 4096
  s_nop 0
  buffer_load_dwordx4 v236, s[16:19], s100 offen lds
  v_mfma_f32_16x16x32_bf16 v[192:195], v[200:203], v[48:51], v[192:195]
  s_waitcnt lgkmcnt(5)
  s_add_u32 m0, s101, 5120
  s_nop 0
  buffer_load_dwordx4 v237, s[16:19], s100 offen lds
  s_add_u32 m0, s101, 6144
  s_nop 0
  buffer_load_dwordx4 v238, s[16:19], s100 offen lds
  v_mfma_f32_16x16x32_bf16 v[188:191], v[204:207], v[24:27], v[188:191]
  ds_read_b128 v[228:231], v254 offset:48128
  s_add_u32 m0, s101, 6656
  s_nop 0
  buffer_load_dwordx4 v239, s[16:19], s100 offen lds
  v_mfma_f32_16x16x32_bf16 v[196:199], v[204:207], v[48:51], v[196:199]
  s_waitcnt lgkmcnt(5)
  v_and_b32 v105, s54, v106
  v_and_b32 v78, s54, v78
  v_mfma_f32_16x16x32_bf16 v[184:187], v[208:211], v[28:31], v[184:187]
  ds_read_b128 v[200:203], v254 offset:49152
  v_and_b32 v106, s54, v106
  v_mfma_f32_16x16x32_bf16 v[192:195], v[208:211], v[52:55], v[192:195]
  s_waitcnt lgkmcnt(5)
  v_or_b32 v76, v77, v12
  v_or_b32 v104, v105, v12
  v_mfma_f32_16x16x32_bf16 v[188:191], v[212:215], v[28:31], v[188:191]
  ds_read_b128 v[204:207], v254 offset:50176
  v_or_b32 v79, v77, v13
  v_mfma_f32_16x16x32_bf16 v[196:199], v[212:215], v[52:55], v[196:199]
  s_waitcnt lgkmcnt(5)
  v_or_b32 v107, v105, v13
  v_bfe_i32 v82, v14, 8, 1
  v_mfma_f32_16x16x32_bf16 v[184:187], v[216:219], v[32:35], v[184:187]
  ds_read_b128 v[208:211], v254 offset:51200
  v_bfe_i32 v110, v15, 14, 1
  v_mfma_f32_16x16x32_bf16 v[192:195], v[216:219], v[56:59], v[192:195]
  s_waitcnt lgkmcnt(5)
  v_and_b32 v81, s54, v82
  v_and_b32 v109, s54, v110
  v_mfma_f32_16x16x32_bf16 v[188:191], v[220:223], v[32:35], v[188:191]
  ds_read_b128 v[212:215], v254 offset:52224
  v_and_b32 v82, s54, v82
  v_mfma_f32_16x16x32_bf16 v[196:199], v[220:223], v[56:59], v[196:199]
  s_waitcnt lgkmcnt(5)
  v_and_b32 v110, s54, v110
  v_or_b32 v80, v81, v12
  v_mfma_f32_16x16x32_bf16 v[184:187], v[224:227], v[36:39], v[184:187]
  ds_read_b128 v[216:219], v254 offset:53248
  v_or_b32 v108, v109, v12
  v_mfma_f32_16x16x32_bf16 v[192:195], v[224:227], v[60:63], v[192:195]
  s_waitcnt lgkmcnt(5)
  v_or_b32 v83, v81, v13
  v_or_b32 v111, v109, v13
  v_mfma_f32_16x16x32_bf16 v[188:191], v[228:231], v[36:39], v[188:191]
  ds_read_b128 v[220:223], v254 offset:54272
  v_bfe_i32 v86, v14, 10, 1
  v_mfma_f32_16x16x32_bf16 v[196:199], v[228:231], v[60:63], v[196:199]
  s_waitcnt lgkmcnt(5)
  v_bfe_i32 v114, v15, 16, 1
  v_and_b32 v85, s54, v86
  v_mfma_f32_16x16x32_bf16 v[168:171], v[200:203], v[16:19], 0
  ds_read_b128 v[224:227], v254 offset:55296
  v_and_b32 v113, s54, v114
  v_mfma_f32_16x16x32_bf16 v[176:179], v[200:203], v[40:43], 0
  s_waitcnt lgkmcnt(5)
  ds_read_b128 v[232:235], v254 offset:61440
  v_and_b32 v86, s54, v86
  v_mfma_f32_16x16x32_bf16 v[172:175], v[204:207], v[16:19], 0
  ds_read_b128 v[228:231], v254 offset:56320
  v_cvt_pk_bf16_f32 v132, v184, v185
  v_mfma_f32_16x16x32_bf16 v[180:183], v[204:207], v[40:43], 0
  s_waitcnt lgkmcnt(6)
  ds_read_b128 v[236:239], v254 offset:62464
  v_cvt_pk_bf16_f32 v133, v186, v187
  v_mfma_f32_16x16x32_bf16 v[168:171], v[208:211], v[20:23], v[168:171]
  ds_read_b128 v[200:203], v254 offset:57344
  v_cvt_pk_bf16_f32 v134, v188, v189
  v_mfma_f32_16x16x32_bf16 v[176:179], v[208:211], v[44:47], v[176:179]
  s_waitcnt lgkmcnt(7)
  v_cvt_pk_bf16_f32 v135, v190, v191
  v_cvt_pk_bf16_f32 v156, v192, v193
  v_mfma_f32_16x16x32_bf16 v[172:175], v[212:215], v[20:23], v[172:175]
  ds_read_b128 v[204:207], v254 offset:58368
  v_cvt_pk_bf16_f32 v157, v194, v195
  v_mfma_f32_16x16x32_bf16 v[180:183], v[212:215], v[44:47], v[180:183]
  s_waitcnt lgkmcnt(7)
  v_cvt_pk_bf16_f32 v158, v196, v197
  v_cvt_pk_bf16_f32 v159, v198, v199
  v_mfma_f32_16x16x32_bf16 v[168:171], v[216:219], v[24:27], v[168:171]
  ds_read_b128 v[208:211], v254 offset:59392
  v_and_b32 v114, s54, v114
  v_mfma_f32_16x16x32_bf16 v[176:179], v[216:219], v[48:51], v[176:179]
  s_waitcnt lgkmcnt(7)
  v_or_b32 v84, v85, v12
  v_or_b32 v112, v113, v12
  v_mfma_f32_16x16x32_bf16 v[172:175], v[220:223], v[24:27], v[172:175]
  ds_read_b128 v[212:215], v254 offset:60416
  v_or_b32 v87, v85, v13
  v_mfma_f32_16x16x32_bf16 v[180:183], v[220:223], v[48:51], v[180:183]
  s_waitcnt lgkmcnt(7)
  v_or_b32 v115, v113, v13
  v_bfe_i32 v90, v14, 12, 1
  v_mfma_f32_16x16x32_bf16 v[168:171], v[224:227], v[28:31], v[168:171]
  v_bfe_i32 v118, v15, 18, 1
  v_and_b32 v89, s54, v90
  v_mfma_f32_16x16x32_bf16 v[176:179], v[224:227], v[52:55], v[176:179]
  s_waitcnt lgkmcnt(5)
  v_and_b32 v117, s54, v118
  v_and_b32 v90, s54, v90
  v_mfma_f32_16x16x32_bf16 v[172:175], v[228:231], v[28:31], v[172:175]
  v_and_b32 v118, s54, v118
  v_or_b32 v88, v89, v12
  v_mfma_f32_16x16x32_bf16 v[180:183], v[228:231], v[52:55], v[180:183]
  s_waitcnt lgkmcnt(3)
  v_or_b32 v116, v117, v12
  v_or_b32 v91, v89, v13
  v_mfma_f32_16x16x32_bf16 v[168:171], v[200:203], v[32:35], v[168:171]
  ds_read_b128 v[224:227], v253 offset:0
  v_or_b32 v119, v117, v13
  v_mfma_f32_16x16x32_bf16 v[176:179], v[200:203], v[56:59], v[176:179]
  s_waitcnt lgkmcnt(3)
  v_mfma_f32_16x16x32_bf16 v[172:175], v[204:207], v[32:35], v[172:175]
  ds_read_b128 v[228:231], v253 offset:1024
  v_mfma_f32_16x16x32_bf16 v[180:183], v[204:207], v[56:59], v[180:183]
  s_waitcnt lgkmcnt(3)
  v_mfma_f32_16x16x32_bf16 v[168:171], v[208:211], v[36:39], v[168:171]
  ds_read_b128 v[200:203], v253 offset:2048
  v_mfma_f32_16x16x32_bf16 v[176:179], v[208:211], v[60:63], v[176:179]
  s_waitcnt lgkmcnt(3)
  v_mfma_f32_16x16x32_bf16 v[172:175], v[212:215], v[36:39], v[172:175]
  ds_read_b128 v[204:207], v253 offset:3072
  v_mfma_f32_16x16x32_bf16 v[180:183], v[212:215], v[60:63], v[180:183]
  s_waitcnt vmcnt(0)
  s_barrier
  s_setprio 2
  s_cmp_lt_u32 s40, 4
  s_cbranch_scc1 M_pr1
  s_setprio 3
M_pr1:
  v_mfma_f32_16x16x32_bf16 v[184:187], v[232:235], v[16:19], 0
  ds_read_b128 v[208:211], v253 offset:4096
  v_mfma_f32_16x16x32_bf16 v[192:195], v[232:235], v[40:43], 0
  v_mfma_f32_16x16x32_bf16 v[188:191], v[236:239], v[16:19], 0
  ds_read_b128 v[212:215], v253 offset:5120
  v_cvt_pk_bf16_f32 v136, v168, v169
  v_mfma_f32_16x16x32_bf16 v[196:199], v[236:239], v[40:43], 0
  s_waitcnt lgkmcnt(5)
  v_cvt_pk_bf16_f32 v137, v170, v171
  v_cvt_pk_bf16_f32 v138, v172, v173
  v_mfma_f32_16x16x32_bf16 v[184:187], v[224:227], v[20:23], v[184:187]
  ds_read_b128 v[216:219], v253 offset:6144
  v_cvt_pk_bf16_f32 v139, v174, v175
  v_mfma_f32_16x16x32_bf16 v[192:195], v[224:227], v[44:47], v[192:195]
  s_waitcnt lgkmcnt(5)
  v_cvt_pk_bf16_f32 v160, v176, v177
  v_cvt_pk_bf16_f32 v161, v178, v179
  v_mfma_f32_16x16x32_bf16 v[188:191], v[228:231], v[20:23], v[188:191]
  ds_read_b128 v[220:223], v253 offset:7168
  v_cvt_pk_bf16_f32 v162, v180, v181
  v_mfma_f32_16x16x32_bf16 v[196:199], v[228:231], v[44:47], v[196:199]
  s_waitcnt lgkmcnt(5)
  v_cvt_pk_bf16_f32 v163, v182, v183
  v_mfma_f32_16x16x32_bf16 v[184:187], v[200:203], v[24:27], v[184:187]
  ds_read_b128 v[224:227], v253 offset:8192
  v_mfma_f32_16x16x32_bf16 v[192:195], v[200:203], v[48:51], v[192:195]
  s_waitcnt lgkmcnt(5)
  v_mfma_f32_16x16x32_bf16 v[188:191], v[204:207], v[24:27], v[188:191]
  ds_read_b128 v[228:231], v253 offset:9216
  v_mfma_f32_16x16x32_bf16 v[196:199], v[204:207], v[48:51], v[196:199]
  s_waitcnt lgkmcnt(5)
  v_mfma_f32_16x16x32_bf16 v[184:187], v[208:211], v[28:31], v[184:187]
  v_mfma_f32_16x16x32_bf16 v[192:195], v[208:211], v[52:55], v[192:195]
  s_waitcnt lgkmcnt(4)
  v_mfma_f32_16x16x32_bf16 v[188:191], v[212:215], v[28:31], v[188:191]
  v_mfma_f32_16x16x32_bf16 v[196:199], v[212:215], v[52:55], v[196:199]
  s_waitcnt lgkmcnt(3)
  v_mfma_f32_16x16x32_bf16 v[184:187], v[216:219], v[32:35], v[184:187]
  v_mfma_f32_16x16x32_bf16 v[192:195], v[216:219], v[56:59], v[192:195]
  s_waitcnt lgkmcnt(2)
  v_mfma_f32_16x16x32_bf16 v[188:191], v[220:223], v[32:35], v[188:191]
  v_mfma_f32_16x16x32_bf16 v[196:199], v[220:223], v[56:59], v[196:199]
  s_waitcnt lgkmcnt(1)
  v_mfma_f32_16x16x32_bf16 v[184:187], v[224:227], v[36:39], v[184:187]
  v_mfma_f32_16x16x32_bf16 v[192:195], v[224:227], v[60:63], v[192:195]
  s_waitcnt lgkmcnt(0)
  v_mfma_f32_16x16x32_bf16 v[188:191], v[228:231], v[36:39], v[188:191]
  v_mfma_f32_16x16x32_bf16 v[196:199], v[228:231], v[60:63], v[196:199]
  s_cmp_ge_u32 s40, 4
  s_cbranch_scc1 M_l1
  s_barrier
M_l1:
  ds_read_b128 v[200:203], v240 offset:0
  ds_read_b128 v[204:207], v240 offset:2304
  ds_read_b128 v[208:211], v241 offset:0
  ds_read_b128 v[212:215], v241 offset:2304
  ds_read_b128 v[216:219], v242 offset:0
  ds_read_b128 v[220:223], v242 offset:2304
  ds_read_b128 v[224:227], v243 offset:0
  v_cvt_pk_bf16_f32 v140, v184, v185
  v_cvt_pk_bf16_f32 v141, v186, v187
  v_cvt_pk_bf16_f32 v142, v188, v189
  v_cvt_pk_bf16_f32 v143, v190, v191
  v_cvt_pk_bf16_f32 v164, v192, v193
  v_cvt_pk_bf16_f32 v165, v194, v195
  v_cvt_pk_bf16_f32 v166, v196, v197
  v_cvt_pk_bf16_f32 v167, v198, v199
  s_mov_b32 s56, 0xff7fffff
  s_waitcnt lgkmcnt(6)
  v_mfma_f32_16x16x32_bf16 v[64:67], v[200:203], v[120:123], v[64:67]
  s_waitcnt lgkmcnt(5)
  ds_read_b128 v[228:231], v243 offset:2304
  v_mov_b32 v30, 0
  v_mfma_f32_16x16x32_bf16 v[76:79], v[204:207], v[120:123], v[76:79]
  v_mov_b32 v31, 0
  v_mov_b32 v32, 0
  v_mfma_f32_16x16x32_bf16 v[92:95], v[204:207], v[144:147], v[92:95]
  s_waitcnt lgkmcnt(5)
  ds_read_b128 v[200:203], v240 offset:256
  v_mov_b32 v33, 0
  v_mfma_f32_16x16x32_bf16 v[64:67], v[208:211], v[124:127], v[64:67]
  s_waitcnt lgkmcnt(5)
  ds_read_b128 v[204:207], v240 offset:2560
  v_mov_b32 v48, 0x3f803f80
  v_mfma_f32_16x16x32_bf16 v[76:79], v[212:215], v[124:127], v[76:79]
  v_mov_b32 v49, 0x3f803f80
  v_mov_b32 v50, 0x3f803f80
  v_mfma_f32_16x16x32_bf16 v[92:95], v[212:215], v[148:151], v[92:95]
  s_waitcnt lgkmcnt(5)
  ds_read_b128 v[208:211], v241 offset:256
  v_mov_b32 v51, 0x3f803f80
  v_mfma_f32_16x16x32_bf16 v[64:67], v[216:219], v[128:131], v[64:67]
  s_waitcnt lgkmcnt(5)
  ds_read_b128 v[212:215], v241 offset:2560
  v_mfma_f32_16x16x32_bf16 v[76:79], v[220:223], v[128:131], v[76:79]
  v_mfma_f32_16x16x32_bf16 v[92:95], v[220:223], v[152:155], v[92:95]
  s_waitcnt lgkmcnt(5)
  ds_read_b128 v[216:219], v240 offset:768
  v_mfma_f32_16x16x32_bf16 v[64:67], v[224:227], v[132:135], v[64:67]
  s_waitcnt lgkmcnt(5)
  ds_read_b128 v[220:223], v240 offset:3072
  v_mfma_f32_16x16x32_bf16 v[76:79], v[228:231], v[132:135], v[76:79]
  v_mfma_f32_16x16x32_bf16 v[92:95], v[228:231], v[156:159], v[92:95]
  s_waitcnt lgkmcnt(5)
  ds_read_b128 v[224:227], v241 offset:768
  v_mfma_f32_16x16x32_bf16 v[64:67], v[200:203], v[136:139], v[64:67]
  s_waitcnt lgkmcnt(5)
  ds_read_b128 v[228:231], v241 offset:3072
  v_mfma_f32_16x16x32_bf16 v[76:79], v[204:207], v[136:139], v[76:79]
  v_mfma_f32_16x16x32_bf16 v[92:95], v[204:207], v[160:163], v[92:95]
  s_waitcnt lgkmcnt(5)
  ds_read_b128 v[200:203], v242 offset:768
  v_mfma_f32_16x16x32_bf16 v[64:67], v[208:211], v[140:143], v[64:67]
  s_waitcnt lgkmcnt(5)
  ds_read_b128 v[204:207], v242 offset:3072
  v_mfma_f32_16x16x32_bf16 v[76:79], v[212:215], v[140:143], v[76:79]
  v_mfma_f32_16x16x32_bf16 v[92:95], v[212:215], v[164:167], v[92:95]
  s_waitcnt lgkmcnt(5)
  ds_read_b128 v[208:211], v243 offset:768
  v_mfma_f32_16x16x32_bf16 v[68:71], v[216:219], v[120:123], v[68:71]
  s_waitcnt lgkmcnt(5)
  ds_read_b128 v[212:215], v243 offset:3072
  v_mfma_f32_16x16x32_bf16 v[80:83], v[220:223], v[120:123], v[80:83]
  v_max3_f32 v12, v64, v65, s56
  v_max3_f32 v12, v66, v67, v12
  v_mfma_f32_16x16x32_bf16 v[96:99], v[220:223], v[144:147], v[96:99]
  s_waitcnt lgkmcnt(5)
  ds_read_b128 v[216:219], v240 offset:1024
  v_max3_f32 v12, v76, v77, v12
  v_mfma_f32_16x16x32_bf16 v[68:71], v[224:227], v[124:127], v[68:71]
  s_waitcnt lgkmcnt(5)
  ds_read_b128 v[220:223], v240 offset:3328
  v_max3_f32 v12, v78, v79, v12
  v_mfma_f32_16x16x32_bf16 v[80:83], v[228:231], v[124:127], v[80:83]
  v_max3_f32 v13, v92, v93, s56
  v_max3_f32 v13, v94, v95, v13
  v_mfma_f32_16x16x32_bf16 v[96:99], v[228:231], v[148:151], v[96:99]
  s_waitcnt lgkmcnt(5)
  ds_read_b128 v[224:227], v241 offset:1024
  v_mfma_f32_16x16x32_bf16 v[68:71], v[200:203], v[128:131], v[68:71]
  s_waitcnt lgkmcnt(5)
  ds_read_b128 v[228:231], v241 offset:3328
  v_mfma_f32_16x16x32_bf16 v[80:83], v[204:207], v[128:131], v[80:83]
  v_mfma_f32_16x16x32_bf16 v[96:99], v[204:207], v[152:155], v[96:99]
  s_waitcnt lgkmcnt(5)
  ds_read_b128 v[200:203], v240 offset:1536
  v_mfma_f32_16x16x32_bf16 v[68:71], v[208:211], v[132:135], v[68:71]
  s_waitcnt lgkmcnt(5)
  ds_read_b128 v[204:207], v240 offset:3840
  v_mfma_f32_16x16x32_bf16 v[80:83], v[212:215], v[132:135], v[80:83]
  v_mfma_f32_16x16x32_bf16 v[96:99], v[212:215], v[156:159], v[96:99]
  s_waitcnt lgkmcnt(5)
  ds_read_b128 v[208:211], v241 offset:1536
  v_mfma_f32_16x16x32_bf16 v[68:71], v[216:219], v[136:139], v[68:71]
  s_waitcnt lgkmcnt(5)
  ds_read_b128 v[212:215], v241 offset:3840
  v_mfma_f32_16x16x32_bf16 v[80:83], v[220:223], v[136:139], v[80:83]
  v_mfma_f32_16x16x32_bf16 v[96:99], v[220:223], v[160:163], v[96:99]
  s_waitcnt lgkmcnt(5)
  ds_read_b128 v[216:219], v242 offset:1536
  v_mfma_f32_16x16x32_bf16 v[68:71], v[224:227], v[140:143], v[68:71]
  s_waitcnt lgkmcnt(5)
  ds_read_b128 v[220:223], v242 offset:3840
  v_mfma_f32_16x16x32_bf16 v[80:83], v[228:231], v[140:143], v[80:83]
  v_mfma_f32_16x16x32_bf16 v[96:99], v[228:231], v[164:167], v[96:99]
  s_waitcnt lgkmcnt(5)
  ds_read_b128 v[224:227], v243 offset:1536
  v_mfma_f32_16x16x32_bf16 v[72:75], v[200:203], v[120:123], v[72:75]
  s_waitcnt lgkmcnt(5)
  ds_read_b128 v[228:231], v243 offset:3840
  v_mfma_f32_16x16x32_bf16 v[84:87], v[204:207], v[120:123], v[84:87]
  v_max3_f32 v12, v68, v69, v12
  v_max3_f32 v12, v70, v71, v12
  v_mfma_f32_16x16x32_bf16 v[100:103], v[204:207], v[144:147], v[100:103]
  s_waitcnt lgkmcnt(5)
  ds_read_b128 v[200:203], v240 offset:1792
  v_max3_f32 v12, v80, v81, v12
  v_mfma_f32_16x16x32_bf16 v[72:75], v[208:211], v[124:127], v[72:75]
  s_waitcnt lgkmcnt(5)
  ds_read_b128 v[204:207], v240 offset:4096
  v_max3_f32 v12, v82, v83, v12
  v_mfma_f32_16x16x32_bf16 v[84:87], v[212:215], v[124:127], v[84:87]
  v_max3_f32 v13, v96, v97, v13
  v_max3_f32 v13, v98, v99, v13
  v_mfma_f32_16x16x32_bf16 v[100:103], v[212:215], v[148:151], v[100:103]
  s_waitcnt lgkmcnt(5)
  ds_read_b128 v[208:211], v241 offset:1792
  v_mfma_f32_16x16x32_bf16 v[72:75], v[216:219], v[128:131], v[72:75]
  s_waitcnt lgkmcnt(5)
  ds_read_b128 v[212:215], v241 offset:4096
  v_mfma_f32_16x16x32_bf16 v[84:87], v[220:223], v[128:131], v[84:87]
  v_mfma_f32_16x16x32_bf16 v[100:103], v[220:223], v[152:155], v[100:103]
  s_waitcnt lgkmcnt(5)
  ds_read_b128 v[216:219], v240 offset:5376
  v_mfma_f32_16x16x32_bf16 v[72:75], v[224:227], v[132:135], v[72:75]
  s_waitcnt lgkmcnt(5)
  ds_read_b128 v[220:223], v240 offset:4608
  v_mfma_f32_16x16x32_bf16 v[84:87], v[228:231], v[132:135], v[84:87]
  v_mfma_f32_16x16x32_bf16 v[100:103], v[228:231], v[156:159], v[100:103]
  s_waitcnt lgkmcnt(5)
  ds_read_b128 v[224:227], v241 offset:5376
  v_mfma_f32_16x16x32_bf16 v[72:75], v[200:203], v[136:139], v[72:75]
  s_waitcnt lgkmcnt(5)
  ds_read_b128 v[228:231], v241 offset:4608
  v_mfma_f32_16x16x32_bf16 v[84:87], v[204:207], v[136:139], v[84:87]
  v_mfma_f32_16x16x32_bf16 v[100:103], v[204:207], v[160:163], v[100:103]
  s_waitcnt lgkmcnt(5)
  ds_read_b128 v[200:203], v242 offset:5376
  v_mfma_f32_16x16x32_bf16 v[72:75], v[208:211], v[140:143], v[72:75]
  s_waitcnt lgkmcnt(5)
  ds_read_b128 v[204:207], v242 offset:4608
  v_mfma_f32_16x16x32_bf16 v[84:87], v[212:215], v[140:143], v[84:87]
  v_mfma_f32_16x16x32_bf16 v[100:103], v[212:215], v[164:167], v[100:103]
  s_waitcnt lgkmcnt(5)
  ds_read_b128 v[208:211], v243 offset:5376
  v_mfma_f32_16x16x32_bf16 v[108:111], v[216:219], v[144:147], v[108:111]
  s_waitcnt lgkmcnt(5)
  ds_read_b128 v[212:215], v243 offset:4608
  v_mfma_f32_16x16x32_bf16 v[88:91], v[220:223], v[120:123], v[88:91]
  v_max3_f32 v12, v72, v73, v12
  v_max3_f32 v12, v74, v75, v12
  v_mfma_f32_16x16x32_bf16 v[104:107], v[220:223], v[144:147], v[104:107]
  s_waitcnt lgkmcnt(5)
  ds_read_b128 v[216:219], v240 offset:5632
  v_max3_f32 v12, v84, v85, v12
  v_mfma_f32_16x16x32_bf16 v[108:111], v[224:227], v[148:151], v[108:111]
  s_waitcnt lgkmcnt(5)
  ds_read_b128 v[220:223], v240 offset:4864
  v_max3_f32 v12, v86, v87, v12
  v_mfma_f32_16x16x32_bf16 v[88:91], v[228:231], v[124:127], v[88:91]
  v_max3_f32 v13, v100, v101, v13
  v_max3_f32 v13, v102, v103, v13
  v_mfma_f32_16x16x32_bf16 v[104:107], v[228:231], v[148:151], v[104:107]
  s_waitcnt lgkmcnt(5)
  ds_read_b128 v[224:227], v241 offset:5632
  v_mfma_f32_16x16x32_bf16 v[108:111], v[200:203], v[152:155], v[108:111]
  s_waitcnt lgkmcnt(5)
  ds_read_b128 v[228:231], v241 offset:4864
  v_mfma_f32_16x16x32_bf16 v[88:91], v[204:207], v[128:131], v[88:91]
  v_mfma_f32_16x16x32_bf16 v[104:107], v[204:207], v[152:155], v[104:107]
  s_waitcnt lgkmcnt(5)
  ds_read_b128 v[200:203], v240 offset:6144
  v_mfma_f32_16x16x32_bf16 v[108:111], v[208:211], v[156:159], v[108:111]
  s_waitcnt lgkmcnt(5)
  ds_read_b128 v[204:207], v240 offset:6912
  v_mfma_f32_16x16x32_bf16 v[88:91], v[212:215], v[132:135], v[88:91]
  v_mfma_f32_16x16x32_bf16 v[104:107], v[212:215], v[156:159], v[104:107]
  s_waitcnt lgkmcnt(5)
  ds_read_b128 v[208:211], v241 offset:6144
  v_mfma_f32_16x16x32_bf16 v[108:111], v[216:219], v[160:163], v[108:111]
  s_waitcnt lgkmcnt(5)
  ds_read_b128 v[212:215], v241 offset:6912
  v_mfma_f32_16x16x32_bf16 v[88:91], v[220:223], v[136:139], v[88:91]
  v_mfma_f32_16x16x32_bf16 v[104:107], v[220:223], v[160:163], v[104:107]
  s_waitcnt lgkmcnt(5)
  ds_read_b128 v[216:219], v242 offset:6144
  v_mfma_f32_16x16x32_bf16 v[108:111], v[224:227], v[164:167], v[108:111]
  s_waitcnt lgkmcnt(5)
  ds_read_b128 v[220:223], v242 offset:6912
  v_mfma_f32_16x16x32_bf16 v[88:91], v[228:231], v[140:143], v[88:91]
  v_mfma_f32_16x16x32_bf16 v[104:107], v[228:231], v[164:167], v[104:107]
  s_waitcnt lgkmcnt(5)
  ds_read_b128 v[224:227], v243 offset:6144
  v_mfma_f32_16x16x32_bf16 v[112:115], v[200:203], v[144:147], v[112:115]
  s_waitcnt lgkmcnt(5)
  ds_read_b128 v[228:231], v243 offset:6912
  v_mfma_f32_16x16x32_bf16 v[116:119], v[204:207], v[144:147], v[116:119]
  s_waitcnt lgkmcnt(5)
  ds_read_b128 v[200:203], v240 offset:6400
  v_max3_f32 v13, v108, v109, v13
  v_mfma_f32_16x16x32_bf16 v[112:115], v[208:211], v[148:151], v[112:115]
  s_waitcnt lgkmcnt(5)
  ds_read_b128 v[204:207], v240 offset:7168
  v_max3_f32 v13, v110, v111, v13
  v_mfma_f32_16x16x32_bf16 v[116:119], v[212:215], v[148:151], v[116:119]
  s_waitcnt lgkmcnt(5)
  ds_read_b128 v[208:211], v241 offset:6400
  v_max3_f32 v12, v88, v89, v12
  v_mfma_f32_16x16x32_bf16 v[112:115], v[216:219], v[152:155], v[112:115]
  s_waitcnt lgkmcnt(5)
  ds_read_b128 v[212:215], v241 offset:7168
  v_max3_f32 v12, v90, v91, v12
  v_mfma_f32_16x16x32_bf16 v[116:119], v[220:223], v[152:155], v[116:119]
  s_waitcnt lgkmcnt(5)
  v_max3_f32 v13, v104, v105, v13
  v_max3_f32 v13, v106, v107, v13
  v_mfma_f32_16x16x32_bf16 v[112:115], v[224:227], v[156:159], v[112:115]
  s_waitcnt lgkmcnt(4)
  v_mov_b32 v14, v12
  s_nop 1
  v_permlane32_swap_b32 v12, v14
  v_mfma_f32_16x16x32_bf16 v[116:119], v[228:231], v[156:159], v[116:119]
  s_waitcnt lgkmcnt(3)
  v_max_f32 v12, v12, v14
  v_mfma_f32_16x16x32_bf16 v[112:115], v[200:203], v[160:163], v[112:115]
  s_waitcnt lgkmcnt(2)
  v_mfma_f32_16x16x32_bf16 v[116:119], v[204:207], v[160:163], v[116:119]
  s_waitcnt lgkmcnt(1)
  v_mov_b32 v14, v12
  v_mfma_f32_16x16x32_bf16 v[112:115], v[208:211], v[164:167], v[112:115]
  s_waitcnt lgkmcnt(0)
  v_mfma_f32_16x16x32_bf16 v[116:119], v[212:215], v[164:167], v[116:119]
  v_permlane16_swap_b32 v12, v14
  s_setprio 0
  s_cmp_lt_u32 s40, 4
  s_cbranch_scc1 M_pr2
  s_setprio 1
M_pr2:
  v_max_f32 v12, v12, v14
  v_mul_f32 v12, s63, v12
  v_max3_f32 v13, v112, v113, v13
  v_max3_f32 v13, v114, v115, v13
  v_max3_f32 v13, v116, v117, v13
  v_max3_f32 v13, v118, v119, v13
  v_mov_b32 v15, v13
  s_nop 1
  v_permlane32_swap_b32 v13, v15
  v_max_f32 v13, v13, v15
  v_mov_b32 v15, v13
  s_nop 1
  v_permlane16_swap_b32 v13, v15
  v_max_f32 v13, v13, v15
  v_mul_f32 v13, s63, v13
  v_fma_f32 v64, v64, s63, -v12
  v_fma_f32 v65, v65, s63, -v12
  v_fma_f32 v66, v66, s63, -v12
  v_fma_f32 v67, v67, s63, -v12
  v_exp_f32 v64, v64
  v_exp_f32 v65, v65
  v_exp_f32 v66, v66
  v_exp_f32 v67, v67
  v_fma_f32 v92, v92, s63, -v13
  v_fma_f32 v93, v93, s63, -v13
  v_fma_f32 v94, v94, s63, -v13
  v_fma_f32 v95, v95, s63, -v13
  v_exp_f32 v92, v92
  v_exp_f32 v93, v93
  v_exp_f32 v94, v94
  v_exp_f32 v95, v95
  v_cvt_pk_bf16_f32 v16, v64, v65
  v_cvt_pk_bf16_f32 v17, v66, v67
  v_cvt_pk_bf16_f32 v34, v92, v93
  v_cvt_pk_bf16_f32 v35, v94, v95
  v_fma_f32 v68, v68, s63, -v12
  v_fma_f32 v69, v69, s63, -v12
  v_fma_f32 v70, v70, s63, -v12
  v_fma_f32 v71, v71, s63, -v12
  v_exp_f32 v68, v68
  v_exp_f32 v69, v69
  v_exp_f32 v70, v70
  v_exp_f32 v71, v71
  v_fma_f32 v96, v96, s63, -v13
  v_fma_f32 v97, v97, s63, -v13
  v_fma_f32 v98, v98, s63, -v13
  v_fma_f32 v99, v99, s63, -v13
  v_exp_f32 v96, v96
  v_exp_f32 v97, v97
  v_exp_f32 v98, v98
  v_exp_f32 v99, v99
  v_cvt_pk_bf16_f32 v18, v68, v69
  v_cvt_pk_bf16_f32 v19, v70, v71
  v_cvt_pk_bf16_f32 v36, v96, v97
  v_cvt_pk_bf16_f32 v37, v98, v99
  s_cmp_lt_u32 s40, 4
  s_cbranch_scc1 M_e2
  s_barrier
M_e2:
  s_mov_b32 s55, 10240
  buffer_load_dwordx4 v[64:67], v252, s[24:27], s55 offen offset:0 sc1
  buffer_load_dwordx4 v[92:95], v252, s[24:27], s55 offen offset:1024 sc1
  buffer_load_dwordx4 v[68:71], v252, s[24:27], s55 offen offset:2048 sc1
  buffer_load_dwordx4 v[96:99], v252, s[24:27], s55 offen offset:3072 sc1
  v_fma_f32 v72, v72, s63, -v12
  v_fma_f32 v73, v73, s63, -v12
  v_fma_f32 v74, v74, s63, -v12
  v_fma_f32 v75, v75, s63, -v12
  v_exp_f32 v72, v72
  v_exp_f32 v73, v73
  v_exp_f32 v74, v74
  v_exp_f32 v75, v75
  v_fma_f32 v100, v100, s63, -v13
  v_fma_f32 v101, v101, s63, -v13
  v_fma_f32 v102, v102, s63, -v13
  v_fma_f32 v103, v103, s63, -v13
  v_exp_f32 v100, v100
  v_exp_f32 v101, v101
  v_exp_f32 v102, v102
  v_exp_f32 v103, v103
  v_cvt_pk_bf16_f32 v20, v72, v73
  v_cvt_pk_bf16_f32 v21, v74, v75
  v_cvt_pk_bf16_f32 v38, v100, v101
  v_cvt_pk_bf16_f32 v39, v102, v103
  s_mov_b32 s55, 14336
  buffer_load_dwordx4 v[72:75], v252, s[24:27], s55 offen offset:0 sc1
  buffer_load_dwordx4 v[100:103], v252, s[24:27], s55 offen offset:1024 sc1
  v_fma_f32 v76, v76, s63, -v12
  v_fma_f32 v77, v77, s63, -v12
  v_fma_f32 v78, v78, s63, -v12
  v_fma_f32 v79, v79, s63, -v12
  v_exp_f32 v76, v76
  v_exp_f32 v77, v77
  v_exp_f32 v78, v78
  v_exp_f32 v79, v79
  v_fma_f32 v104, v104, s63, -v13
  v_fma_f32 v105, v105, s63, -v13
  v_fma_f32 v106, v106, s63, -v13
  v_fma_f32 v107, v107, s63, -v13
  v_exp_f32 v104, v104
  v_exp_f32 v105, v105
  v_exp_f32 v106, v106
  v_exp_f32 v107, v107
  v_cvt_pk_bf16_f32 v22, v76, v77
  v_cvt_pk_bf16_f32 v23, v78, v79
  v_cvt_pk_bf16_f32 v40, v104, v105
  v_cvt_pk_bf16_f32 v41, v106, v107
  buffer_load_dwordx4 v[76:79], v252, s[24:27], s55 offen offset:2048 sc1
  buffer_load_dwordx4 v[104:107], v252, s[24:27], s55 offen offset:3072 sc1
  v_fma_f32 v80, v80, s63, -v12
  v_fma_f32 v81, v81, s63, -v12
  v_fma_f32 v82, v82, s63, -v12
  v_fma_f32 v83, v83, s63, -v12
  v_exp_f32 v80, v80
  v_exp_f32 v81, v81
  v_exp_f32 v82, v82
  v_exp_f32 v83, v83
  v_fma_f32 v108, v108, s63, -v13
  v_fma_f32 v109, v109, s63, -v13
  v_fma_f32 v110, v110, s63, -v13
  v_fma_f32 v111, v111, s63, -v13
  v_exp_f32 v108, v108
  v_exp_f32 v109, v109
  v_exp_f32 v110, v110
  v_exp_f32 v111, v111
  v_cvt_pk_bf16_f32 v24, v80, v81
  v_cvt_pk_bf16_f32 v25, v82, v83
  v_cvt_pk_bf16_f32 v42, v108, v109
  v_cvt_pk_bf16_f32 v43, v110, v111
  s_mov_b32 s55, 18432
  buffer_load_dwordx4 v[80:83], v252, s[24:27], s55 offen offset:0 sc1
  buffer_load_dwordx4 v[108:111], v252, s[24:27], s55 offen offset:1024 sc1
  v_fma_f32 v84, v84, s63, -v12
  v_fma_f32 v85, v85, s63, -v12
  v_fma_f32 v86, v86, s63, -v12
  v_fma_f32 v87, v87, s63, -v12
  v_exp_f32 v84, v84
  v_exp_f32 v85, v85
  v_exp_f32 v86, v86
  v_exp_f32 v87, v87
  v_fma_f32 v112, v112, s63, -v13
  v_fma_f32 v113, v113, s63, -v13
  v_fma_f32 v114, v114, s63, -v13
  v_fma_f32 v115, v115, s63, -v13
  v_exp_f32 v112, v112
  v_exp_f32 v113, v113
  v_exp_f32 v114, v114
  v_exp_f32 v115, v115
  v_cvt_pk_bf16_f32 v26, v84, v85
  v_cvt_pk_bf16_f32 v27, v86, v87
  v_cvt_pk_bf16_f32 v44, v112, v113
  v_cvt_pk_bf16_f32 v45, v114, v115
  buffer_load_dwordx4 v[84:87], v252, s[24:27], s55 offen offset:2048 sc1
  buffer_load_dwordx4 v[112:115], v252, s[24:27], s55 offen offset:3072 sc1
  ds_read_b64_tr_b16 v[200:201], v244 offset:0
  ds_read_b64_tr_b16 v[202:203], v244 offset:768
  ds_read_b64_tr_b16 v[204:205], v245 offset:0
  ds_read_b64_tr_b16 v[206:207], v245 offset:768
  ds_read_b64_tr_b16 v[208:209], v244 offset:1536
  ds_read_b64_tr_b16 v[210:211], v244 offset:2304
  ds_read_b64_tr_b16 v[212:213], v245 offset:1536
  ds_read_b64_tr_b16 v[214:215], v245 offset:2304
  ds_read_b64_tr_b16 v[216:217], v244 offset:3072
  ds_read_b64_tr_b16 v[218:219], v244 offset:3840
  ds_read_b64_tr_b16 v[220:221], v245 offset:3072
  ds_read_b64_tr_b16 v[222:223], v245 offset:3840
  v_fma_f32 v88, v88, s63, -v12
  v_fma_f32 v89, v89, s63, -v12
  v_fma_f32 v90, v90, s63, -v12
  v_fma_f32 v91, v91, s63, -v12
  v_exp_f32 v88, v88
  v_exp_f32 v89, v89
  v_exp_f32 v90, v90
  v_exp_f32 v91, v91
  v_fma_f32 v116, v116, s63, -v13
  v_fma_f32 v117, v117, s63, -v13
  v_fma_f32 v118, v118, s63, -v13
  v_fma_f32 v119, v119, s63, -v13
  v_exp_f32 v116, v116
  v_exp_f32 v117, v117
  v_exp_f32 v118, v118
  v_exp_f32 v119, v119
  v_cvt_pk_bf16_f32 v28, v88, v89
  v_cvt_pk_bf16_f32 v29, v90, v91
  v_cvt_pk_bf16_f32 v46, v116, v117
  v_cvt_pk_bf16_f32 v47, v118, v119
  s_mov_b32 s55, 22528
  buffer_load_dwordx4 v[88:91], v252, s[24:27], s55 offen offset:0 sc1
  buffer_load_dwordx4 v[116:119], v252, s[24:27], s55 offen offset:1024 sc1
  s_cmp_ge_u32 s40, 4
  s_cbranch_scc1 M_l2
  s_barrier
M_l2:
  s_setprio 2
  s_cmp_lt_u32 s40, 4
  s_cbranch_scc1 M_pr3
  s_setprio 3
M_pr3:
  s_waitcnt lgkmcnt(10)
  v_mfma_f32_16x16x32_bf16 v[168:171], v[200:203], v[16:19], 0
  s_waitcnt lgkmcnt(8)
  ds_read_b64_tr_b16 v[224:225], v244 offset:4608
  ds_read_b64_tr_b16 v[226:227], v244 offset:5376
  v_mfma_f32_16x16x32_bf16 v[172:175], v[204:207], v[16:19], 0
  s_waitcnt lgkmcnt(8)
  ds_read_b64_tr_b16 v[228:229], v245 offset:4608
  v_mfma_f32_16x16x32_bf16 v[168:171], v[208:211], v[20:23], v[168:171]
  ds_read_b64_tr_b16 v[230:231], v245 offset:5376
  v_mfma_f32_16x16x32_bf16 v[176:179], v[208:211], v[32:35], 0
  s_waitcnt lgkmcnt(8)
  ds_read_b64_tr_b16 v[200:201], v244 offset:6144
  v_mfma_f32_16x16x32_bf16 v[172:175], v[212:215], v[20:23], v[172:175]
  ds_read_b64_tr_b16 v[202:203], v244 offset:6912
  v_mfma_f32_16x16x32_bf16 v[180:183], v[212:215], v[32:35], 0
  s_waitcnt lgkmcnt(8)
  ds_read_b64_tr_b16 v[204:205], v245 offset:6144
  v_mfma_f32_16x16x32_bf16 v[168:171], v[216:219], v[24:27], v[168:171]
  ds_read_b64_tr_b16 v[206:207], v245 offset:6912
  v_mfma_f32_16x16x32_bf16 v[176:179], v[216:219], v[36:39], v[176:179]
  s_waitcnt lgkmcnt(8)
  ds_read_b64_tr_b16 v[208:209], v246 offset:0
  v_mfma_f32_16x16x32_bf16 v[172:175], v[220:223], v[24:27], v[172:175]
  ds_read_b64_tr_b16 v[210:211], v246 offset:768
  v_mfma_f32_16x16x32_bf16 v[180:183], v[220:223], v[36:39], v[180:183]
  s_waitcnt lgkmcnt(8)
  ds_read_b64_tr_b16 v[212:213], v247 offset:0
  ds_read_b64_tr_b16 v[214:215], v247 offset:768
  v_mfma_f32_16x16x32_bf16 v[168:171], v[224:227], v[28:31], v[168:171]
  ds_read_b64_tr_b16 v[216:217], v246 offset:1536
  v_mfma_f32_16x16x32_bf16 v[176:179], v[224:227], v[40:43], v[176:179]
  s_waitcnt lgkmcnt(9)
  ds_read_b64_tr_b16 v[218:219], v246 offset:2304
  v_mfma_f32_16x16x32_bf16 v[172:175], v[228:231], v[28:31], v[172:175]
  ds_read_b64_tr_b16 v[220:221], v247 offset:1536
  v_mfma_f32_16x16x32_bf16 v[180:183], v[228:231], v[40:43], v[180:183]
  s_waitcnt lgkmcnt(9)
  ds_read_b64_tr_b16 v[222:223], v247 offset:2304
  v_mfma_f32_16x16x32_bf16 v[176:179], v[200:203], v[44:47], v[176:179]
  s_waitcnt lgkmcnt(8)
  ds_read_b64_tr_b16 v[224:225], v246 offset:3072
  v_mfma_f32_16x16x32_bf16 v[180:183], v[204:207], v[44:47], v[180:183]
  s_waitcnt lgkmcnt(7)
  ds_read_b64_tr_b16 v[226:227], v246 offset:3840
  v_mfma_f32_16x16x32_bf16 v[184:187], v[208:211], v[16:19], 0
  s_waitcnt lgkmcnt(6)
  ds_read_b64_tr_b16 v[228:229], v247 offset:3072
  v_mfma_f32_16x16x32_bf16 v[188:191], v[212:215], v[16:19], 0
  ds_read_b64_tr_b16 v[230:231], v247 offset:3840
  v_mfma_f32_16x16x32_bf16 v[56:59], v[16:19], v[48:51], 0
  s_waitcnt lgkmcnt(6)
  ds_read_b64_tr_b16 v[200:201], v246 offset:4608
  v_mfma_f32_16x16x32_bf16 v[184:187], v[216:219], v[20:23], v[184:187]
  ds_read_b64_tr_b16 v[202:203], v246 offset:5376
  ds_read_b64_tr_b16 v[204:205], v247 offset:4608
  v_mfma_f32_16x16x32_bf16 v[192:195], v[216:219], v[32:35], 0
  s_waitcnt lgkmcnt(7)
  ds_read_b64_tr_b16 v[206:207], v247 offset:5376
  v_cvt_pk_bf16_f32 v120, v168, v169
  v_mfma_f32_16x16x32_bf16 v[188:191], v[220:223], v[20:23], v[188:191]
  ds_read_b64_tr_b16 v[208:209], v246 offset:6144
  v_cvt_pk_bf16_f32 v121, v170, v171
  v_mfma_f32_16x16x32_bf16 v[196:199], v[220:223], v[32:35], 0
  s_waitcnt lgkmcnt(7)
  ds_read_b64_tr_b16 v[210:211], v246 offset:6912
  v_cvt_pk_bf16_f32 v122, v172, v173
  v_mfma_f32_16x16x32_bf16 v[184:187], v[224:227], v[24:27], v[184:187]
  ds_read_b64_tr_b16 v[212:213], v247 offset:6144
  v_cvt_pk_bf16_f32 v123, v174, v175
  v_mfma_f32_16x16x32_bf16 v[192:195], v[224:227], v[36:39], v[192:195]
  s_waitcnt lgkmcnt(7)
  ds_read_b64_tr_b16 v[214:215], v247 offset:6912
  v_cvt_pk_bf16_f32 v144, v176, v177
  v_mfma_f32_16x16x32_bf16 v[188:191], v[228:231], v[24:27], v[188:191]
  ds_read_b64_tr_b16 v[216:217], v248 offset:0
  v_cvt_pk_bf16_f32 v145, v178, v179
  v_mfma_f32_16x16x32_bf16 v[196:199], v[228:231], v[36:39], v[196:199]
  s_waitcnt lgkmcnt(7)
  ds_read_b64_tr_b16 v[218:219], v248 offset:768
  v_cvt_pk_bf16_f32 v146, v180, v181
  v_mfma_f32_16x16x32_bf16 v[184:187], v[200:203], v[28:31], v[184:187]
  ds_read_b64_tr_b16 v[220:221], v249 offset:0
  v_cvt_pk_bf16_f32 v147, v182, v183
  v_mfma_f32_16x16x32_bf16 v[192:195], v[200:203], v[40:43], v[192:195]
  s_waitcnt lgkmcnt(7)
  ds_read_b64_tr_b16 v[222:223], v249 offset:768
  v_mfma_f32_16x16x32_bf16 v[188:191], v[204:207], v[28:31], v[188:191]
  ds_read_b64_tr_b16 v[224:225], v248 offset:1536
  ds_read_b64_tr_b16 v[226:227], v248 offset:2304
  v_mfma_f32_16x16x32_bf16 v[196:199], v[204:207], v[40:43], v[196:199]
  s_waitcnt lgkmcnt(8)
  ds_read_b64_tr_b16 v[228:229], v249 offset:1536
  v_mfma_f32_16x16x32_bf16 v[192:195], v[208:211], v[44:47], v[192:195]
  s_waitcnt lgkmcnt(7)
  ds_read_b64_tr_b16 v[230:231], v249 offset:2304
  v_mfma_f32_16x16x32_bf16 v[196:199], v[212:215], v[44:47], v[196:199]
  ds_read_b64_tr_b16 v[200:201], v248 offset:3072
  v_mfma_f32_16x16x32_bf16 v[60:63], v[32:35], v[48:51], 0
  ds_read_b64_tr_b16 v[202:203], v248 offset:3840
  s_cmp_ge_u32 s40, 4
  s_cbranch_scc1 M_l3
  s_barrier
M_l3:
  s_waitcnt lgkmcnt(8)
  v_mfma_f32_16x16x32_bf16 v[168:171], v[216:219], v[16:19], 0
  s_waitcnt lgkmcnt(6)
  ds_read_b64_tr_b16 v[204:205], v249 offset:3072
  v_mfma_f32_16x16x32_bf16 v[172:175], v[220:223], v[16:19], 0
  ds_read_b64_tr_b16 v[206:207], v249 offset:3840
  v_mfma_f32_16x16x32_bf16 v[56:59], v[20:23], v[48:51], v[56:59]
  s_waitcnt lgkmcnt(6)
  ds_read_b64_tr_b16 v[208:209], v248 offset:4608
  v_mfma_f32_16x16x32_bf16 v[168:171], v[224:227], v[20:23], v[168:171]
  ds_read_b64_tr_b16 v[210:211], v248 offset:5376
  v_cvt_pk_bf16_f32 v124, v184, v185
  v_mfma_f32_16x16x32_bf16 v[176:179], v[224:227], v[32:35], 0
  s_waitcnt lgkmcnt(6)
  ds_read_b64_tr_b16 v[212:213], v249 offset:4608
  v_cvt_pk_bf16_f32 v125, v186, v187
  v_mfma_f32_16x16x32_bf16 v[172:175], v[228:231], v[20:23], v[172:175]
  ds_read_b64_tr_b16 v[214:215], v249 offset:5376
  ds_read_b64_tr_b16 v[216:217], v248 offset:6144
  v_mfma_f32_16x16x32_bf16 v[180:183], v[228:231], v[32:35], 0
  s_waitcnt lgkmcnt(7)
  ds_read_b64_tr_b16 v[218:219], v248 offset:6912
  v_cvt_pk_bf16_f32 v126, v188, v189
  v_mfma_f32_16x16x32_bf16 v[168:171], v[200:203], v[24:27], v[168:171]
  ds_read_b64_tr_b16 v[220:221], v249 offset:6144
  v_cvt_pk_bf16_f32 v127, v190, v191
  v_mfma_f32_16x16x32_bf16 v[176:179], v[200:203], v[36:39], v[176:179]
  s_waitcnt lgkmcnt(7)
  ds_read_b64_tr_b16 v[222:223], v249 offset:6912
  v_cvt_pk_bf16_f32 v148, v192, v193
  v_mfma_f32_16x16x32_bf16 v[172:175], v[204:207], v[24:27], v[172:175]
  ds_read_b64_tr_b16 v[224:225], v250 offset:0
  v_cvt_pk_bf16_f32 v149, v194, v195
  v_mfma_f32_16x16x32_bf16 v[180:183], v[204:207], v[36:39], v[180:183]
  s_waitcnt lgkmcnt(7)
  ds_read_b64_tr_b16 v[226:227], v250 offset:768
  v_cvt_pk_bf16_f32 v150, v196, v197
  v_mfma_f32_16x16x32_bf16 v[168:171], v[208:211], v[28:31], v[168:171]
  ds_read_b64_tr_b16 v[228:229], v251 offset:0
  v_cvt_pk_bf16_f32 v151, v198, v199
  v_mfma_f32_16x16x32_bf16 v[176:179], v[208:211], v[40:43], v[176:179]
  s_waitcnt lgkmcnt(7)
  ds_read_b64_tr_b16 v[230:231], v251 offset:768
  v_mfma_f32_16x16x32_bf16 v[172:175], v[212:215], v[28:31], v[172:175]
  ds_read_b64_tr_b16 v[200:201], v250 offset:1536
  v_mfma_f32_16x16x32_bf16 v[180:183], v[212:215], v[40:43], v[180:183]
  s_waitcnt lgkmcnt(7)
  ds_read_b64_tr_b16 v[202:203], v250 offset:2304
  v_mfma_f32_16x16x32_bf16 v[176:179], v[216:219], v[44:47], v[176:179]
  s_waitcnt lgkmcnt(6)
  ds_read_b64_tr_b16 v[204:205], v251 offset:1536
  ds_read_b64_tr_b16 v[206:207], v251 offset:2304
  v_mfma_f32_16x16x32_bf16 v[180:183], v[220:223], v[44:47], v[180:183]
  ds_read_b64_tr_b16 v[208:209], v250 offset:3072
  v_mfma_f32_16x16x32_bf16 v[60:63], v[36:39], v[48:51], v[60:63]
  s_waitcnt lgkmcnt(7)
  ds_read_b64_tr_b16 v[210:211], v250 offset:3840
  v_mfma_f32_16x16x32_bf16 v[184:187], v[224:227], v[16:19], 0
  s_waitcnt lgkmcnt(6)
  ds_read_b64_tr_b16 v[212:213], v251 offset:3072
  v_mfma_f32_16x16x32_bf16 v[188:191], v[228:231], v[16:19], 0
  ds_read_b64_tr_b16 v[214:215], v251 offset:3840
  v_mfma_f32_16x16x32_bf16 v[56:59], v[24:27], v[48:51], v[56:59]
  s_waitcnt lgkmcnt(6)
  ds_read_b64_tr_b16 v[216:217], v250 offset:4608
  v_mfma_f32_16x16x32_bf16 v[184:187], v[200:203], v[20:23], v[184:187]
  ds_read_b64_tr_b16 v[218:219], v250 offset:5376
  v_cvt_pk_bf16_f32 v128, v168, v169
  v_mfma_f32_16x16x32_bf16 v[192:195], v[200:203], v[32:35], 0
  s_waitcnt lgkmcnt(6)
  ds_read_b64_tr_b16 v[220:221], v251 offset:4608
  v_cvt_pk_bf16_f32 v129, v170, v171
  v_mfma_f32_16x16x32_bf16 v[188:191], v[204:207], v[20:23], v[188:191]
  ds_read_b64_tr_b16 v[222:223], v251 offset:5376
  v_cvt_pk_bf16_f32 v130, v172, v173
  v_mfma_f32_16x16x32_bf16 v[196:199], v[204:207], v[32:35], 0
  s_waitcnt lgkmcnt(6)
  ds_read_b64_tr_b16 v[224:225], v250 offset:6144
  ds_read_b64_tr_b16 v[226:227], v250 offset:6912
  v_mfma_f32_16x16x32_bf16 v[184:187], v[208:211], v[24:27], v[184:187]
  ds_read_b64_tr_b16 v[228:229], v251 offset:6144
  v_cvt_pk_bf16_f32 v131, v174, v175
  v_mfma_f32_16x16x32_bf16 v[192:195], v[208:211], v[36:39], v[192:195]
  s_waitcnt lgkmcnt(7)
  ds_read_b64_tr_b16 v[230:231], v251 offset:6912
  v_cvt_pk_bf16_f32 v152, v176, v177
  v_mfma_f32_16x16x32_bf16 v[188:191], v[212:215], v[24:27], v[188:191]
  ds_read_b64_tr_b16 v[200:201], v244 offset:256
  v_cvt_pk_bf16_f32 v153, v178, v179
  v_mfma_f32_16x16x32_bf16 v[196:199], v[212:215], v[36:39], v[196:199]
  s_waitcnt lgkmcnt(7)
  ds_read_b64_tr_b16 v[202:203], v244 offset:1024
  v_cvt_pk_bf16_f32 v154, v180, v181
  v_mfma_f32_16x16x32_bf16 v[184:187], v[216:219], v[28:31], v[184:187]
  ds_read_b64_tr_b16 v[204:205], v245 offset:256
  v_cvt_pk_bf16_f32 v155, v182, v183
  v_mfma_f32_16x16x32_bf16 v[192:195], v[216:219], v[40:43], v[192:195]
  s_waitcnt lgkmcnt(7)
  ds_read_b64_tr_b16 v[206:207], v245 offset:1024
  v_mfma_f32_16x16x32_bf16 v[188:191], v[220:223], v[28:31], v[188:191]
  ds_read_b64_tr_b16 v[208:209], v244 offset:1792
  v_mfma_f32_16x16x32_bf16 v[196:199], v[220:223], v[40:43], v[196:199]
  s_waitcnt lgkmcnt(7)
  ds_read_b64_tr_b16 v[210:211], v244 offset:2560
  v_mfma_f32_16x16x32_bf16 v[192:195], v[224:227], v[44:47], v[192:195]
  s_waitcnt lgkmcnt(6)
  ds_read_b64_tr_b16 v[212:213], v245 offset:1792
  v_mfma_f32_16x16x32_bf16 v[196:199], v[228:231], v[44:47], v[196:199]
  ds_read_b64_tr_b16 v[214:215], v245 offset:2560
  ds_read_b64_tr_b16 v[216:217], v244 offset:3328
  v_mfma_f32_16x16x32_bf16 v[60:63], v[40:43], v[48:51], v[60:63]
  s_waitcnt lgkmcnt(7)
  ds_read_b64_tr_b16 v[218:219], v244 offset:4096
  v_mfma_f32_16x16x32_bf16 v[168:171], v[200:203], v[16:19], 0
  s_waitcnt lgkmcnt(6)
  ds_read_b64_tr_b16 v[220:221], v245 offset:3328
  v_mfma_f32_16x16x32_bf16 v[172:175], v[204:207], v[16:19], 0
  ds_read_b64_tr_b16 v[222:223], v245 offset:4096
  v_mfma_f32_16x16x32_bf16 v[56:59], v[28:31], v[48:51], v[56:59]
  s_waitcnt lgkmcnt(6)
  ds_read_b64_tr_b16 v[224:225], v244 offset:4864
  v_mfma_f32_16x16x32_bf16 v[168:171], v[208:211], v[20:23], v[168:171]
  ds_read_b64_tr_b16 v[226:227], v244 offset:5632
  v_cvt_pk_bf16_f32 v132, v184, v185
  v_mfma_f32_16x16x32_bf16 v[176:179], v[208:211], v[32:35], 0
  s_waitcnt lgkmcnt(6)
  ds_read_b64_tr_b16 v[228:229], v245 offset:4864
  v_cvt_pk_bf16_f32 v133, v186, v187
  v_mfma_f32_16x16x32_bf16 v[172:175], v[212:215], v[20:23], v[172:175]
  ds_read_b64_tr_b16 v[230:231], v245 offset:5632
  v_cvt_pk_bf16_f32 v134, v188, v189
  v_mfma_f32_16x16x32_bf16 v[180:183], v[212:215], v[32:35], 0
  s_waitcnt lgkmcnt(6)
  ds_read_b64_tr_b16 v[200:201], v244 offset:6400
  v_cvt_pk_bf16_f32 v135, v190, v191
  v_mfma_f32_16x16x32_bf16 v[168:171], v[216:219], v[24:27], v[168:171]
  ds_read_b64_tr_b16 v[202:203], v244 offset:7168
  v_cvt_pk_bf16_f32 v156, v192, v193
  v_mfma_f32_16x16x32_bf16 v[176:179], v[216:219], v[36:39], v[176:179]
  s_waitcnt lgkmcnt(6)
  ds_read_b64_tr_b16 v[204:205], v245 offset:6400
  ds_read_b64_tr_b16 v[206:207], v245 offset:7168
  v_mfma_f32_16x16x32_bf16 v[172:175], v[220:223], v[24:27], v[172:175]
  ds_read_b64_tr_b16 v[208:209], v246 offset:256
  v_cvt_pk_bf16_f32 v157, v194, v195
  v_mfma_f32_16x16x32_bf16 v[180:183], v[220:223], v[36:39], v[180:183]
  s_waitcnt lgkmcnt(7)
  ds_read_b64_tr_b16 v[210:211], v246 offset:1024
  v_cvt_pk_bf16_f32 v158, v196, v197
  v_mfma_f32_16x16x32_bf16 v[168:171], v[224:227], v[28:31], v[168:171]
  ds_read_b64_tr_b16 v[212:213], v247 offset:256
  v_cvt_pk_bf16_f32 v159, v198, v199
  v_mfma_f32_16x16x32_bf16 v[176:179], v[224:227], v[40:43], v[176:179]
  s_waitcnt lgkmcnt(7)
  ds_read_b64_tr_b16 v[214:215], v247 offset:1024
  v_mfma_f32_16x16x32_bf16 v[172:175], v[228:231], v[28:31], v[172:175]
  ds_read_b64_tr_b16 v[216:217], v246 offset:1792
  v_mfma_f32_16x16x32_bf16 v[180:183], v[228:231], v[40:43], v[180:183]
  s_waitcnt lgkmcnt(7)
  ds_read_b64_tr_b16 v[218:219], v246 offset:2560
  v_mfma_f32_16x16x32_bf16 v[176:179], v[200:203], v[44:47], v[176:179]
  s_waitcnt lgkmcnt(6)
  ds_read_b64_tr_b16 v[220:221], v247 offset:1792
  v_mfma_f32_16x16x32_bf16 v[180:183], v[204:207], v[44:47], v[180:183]
  ds_read_b64_tr_b16 v[222:223], v247 offset:2560
  v_mfma_f32_16x16x32_bf16 v[60:63], v[44:47], v[48:51], v[60:63]
  s_waitcnt lgkmcnt(6)
  ds_read_b64_tr_b16 v[224:225], v246 offset:3328
  v_mfma_f32_16x16x32_bf16 v[184:187], v[208:211], v[16:19], 0
  s_waitcnt lgkmcnt(5)
  ds_read_b64_tr_b16 v[226:227], v246 offset:4096
  ds_read_b64_tr_b16 v[228:229], v247 offset:3328
  v_mfma_f32_16x16x32_bf16 v[188:191], v[212:215], v[16:19], 0
  s_waitcnt lgkmcnt(5)
  ds_read_b64_tr_b16 v[230:231], v247 offset:4096
  v_mfma_f32_16x16x32_bf16 v[184:187], v[216:219], v[20:23], v[184:187]
  ds_read_b64_tr_b16 v[200:201], v246 offset:4864
  v_mfma_f32_16x16x32_bf16 v[192:195], v[216:219], v[32:35], 0
  s_waitcnt lgkmcnt(5)
  ds_read_b64_tr_b16 v[202:203], v246 offset:5632
  v_cvt_pk_bf16_f32 v136, v168, v169
  v_mfma_f32_16x16x32_bf16 v[188:191], v[220:223], v[20:23], v[188:191]
  ds_read_b64_tr_b16 v[204:205], v247 offset:4864
  v_cvt_pk_bf16_f32 v137, v170, v171
  v_mfma_f32_16x16x32_bf16 v[196:199], v[220:223], v[32:35], 0
  s_waitcnt lgkmcnt(5)
  ds_read_b64_tr_b16 v[206:207], v247 offset:5632
  v_cvt_pk_bf16_f32 v138, v172, v173
  v_mfma_f32_16x16x32_bf16 v[184:187], v[224:227], v[24:27], v[184:187]
  ds_read_b64_tr_b16 v[208:209], v246 offset:6400
  v_cvt_pk_bf16_f32 v139, v174, v175
  v_mfma_f32_16x16x32_bf16 v[192:195], v[224:227], v[36:39], v[192:195]
  s_waitcnt lgkmcnt(5)
  ds_read_b64_tr_b16 v[210:211], v246 offset:7168
  v_cvt_pk_bf16_f32 v160, v176, v177
  v_mfma_f32_16x16x32_bf16 v[188:191], v[228:231], v[24:27], v[188:191]
  ds_read_b64_tr_b16 v[212:213], v247 offset:6400
  v_cvt_pk_bf16_f32 v161, v178, v179
  v_mfma_f32_16x16x32_bf16 v[196:199], v[228:231], v[36:39], v[196:199]
  s_waitcnt lgkmcnt(5)
  ds_read_b64_tr_b16 v[214:215], v247 offset:7168
  v_cvt_pk_bf16_f32 v162, v180, v181
  v_mfma_f32_16x16x32_bf16 v[184:187], v[200:203], v[28:31], v[184:187]
  v_cvt_pk_bf16_f32 v163, v182, v183
  v_mfma_f32_16x16x32_bf16 v[192:195], v[200:203], v[40:43], v[192:195]
  s_waitcnt lgkmcnt(4)
  v_mfma_f32_16x16x32_bf16 v[188:191], v[204:207], v[28:31], v[188:191]
  v_mfma_f32_16x16x32_bf16 v[196:199], v[204:207], v[40:43], v[196:199]
  s_waitcnt lgkmcnt(2)
  v_mfma_f32_16x16x32_bf16 v[192:195], v[208:211], v[44:47], v[192:195]
  s_waitcnt lgkmcnt(0)
  v_mfma_f32_16x16x32_bf16 v[196:199], v[212:215], v[44:47], v[196:199]
  s_waitcnt vmcnt(0)
  s_cmp_lt_u32 s40, 4
  s_cbranch_scc1 M_e3
  s_barrier
  s_mul_i32 s55, s40, 9216
  s_sub_u32 s55, s55, 24576
  s_add_u32 s59, s55, 24576
  s_mov_b32 m0, s55
  s_add_u32 s55, s55, 3072
  buffer_load_dwordx4 v252, s[24:27], s59 offen offset:0 sc1 lds
  buffer_load_dwordx4 v252, s[24:27], s59 offen offset:1024 sc1 lds
  buffer_load_dwordx4 v252, s[24:27], s59 offen offset:2048 sc1 lds
  s_add_u32 s59, s59, 3072
  s_mov_b32 m0, s55
  s_add_u32 s55, s55, 3072
  buffer_load_dwordx4 v252, s[24:27], s59 offen offset:0 sc1 lds
  buffer_load_dwordx4 v252, s[24:27], s59 offen offset:1024 sc1 lds
  buffer_load_dwordx4 v252, s[24:27], s59 offen offset:2048 sc1 lds
  s_add_u32 s59, s59, 3072
  s_mov_b32 m0, s55
  s_add_u32 s55, s55, 3072
  buffer_load_dwordx4 v252, s[24:27], s59 offen offset:0 sc1 lds
  buffer_load_dwordx4 v252, s[24:27], s59 offen offset:1024 sc1 lds
  buffer_load_dwordx4 v252, s[24:27], s59 offen offset:2048 sc1 lds
  s_add_u32 s59, s59, 3072
M_e3:
  v_cvt_pk_bf16_f32 v140, v184, v185
  v_cvt_pk_bf16_f32 v141, v186, v187
  v_cvt_pk_bf16_f32 v142, v188, v189
  v_cvt_pk_bf16_f32 v143, v190, v191
  v_cvt_pk_bf16_f32 v164, v192, v193
  v_cvt_pk_bf16_f32 v165, v194, v195
  v_cvt_pk_bf16_f32 v166, v196, v197
  v_cvt_pk_bf16_f32 v167, v198, v199
  ds_read_b128 v[200:203], v253 offset:0
  ds_read_b128 v[204:207], v253 offset:1024
  ds_read_b128 v[208:211], v253 offset:2048
  ds_read_b128 v[212:215], v253 offset:3072
  s_waitcnt lgkmcnt(3)
  v_mfma_f32_16x16x32_bf16 v[168:171], v[120:123], v[200:203], 0
  ds_read_b128 v[216:219], v253 offset:4096
  v_rcp_f32 v56, v56
  v_mfma_f32_16x16x32_bf16 v[176:179], v[144:147], v[200:203], 0
  s_waitcnt lgkmcnt(3)
  v_rcp_f32 v57, v57
  v_rcp_f32 v58, v58
  v_mfma_f32_16x16x32_bf16 v[172:175], v[120:123], v[204:207], 0
  ds_read_b128 v[220:223], v253 offset:5120
  v_rcp_f32 v59, v59
  v_mfma_f32_16x16x32_bf16 v[180:183], v[144:147], v[204:207], 0
  s_waitcnt lgkmcnt(3)
  v_rcp_f32 v60, v60
  v_rcp_f32 v61, v61
  v_mfma_f32_16x16x32_bf16 v[168:171], v[124:127], v[208:211], v[168:171]
  ds_read_b128 v[224:227], v253 offset:6144
  v_rcp_f32 v62, v62
  v_mfma_f32_16x16x32_bf16 v[176:179], v[148:151], v[208:211], v[176:179]
  s_waitcnt lgkmcnt(3)
  v_rcp_f32 v63, v63
  v_mfma_f32_16x16x32_bf16 v[172:175], v[124:127], v[212:215], v[172:175]
  ds_read_b128 v[228:231], v253 offset:7168
  v_mfma_f32_16x16x32_bf16 v[180:183], v[148:151], v[212:215], v[180:183]
  s_waitcnt lgkmcnt(3)
  v_mfma_f32_16x16x32_bf16 v[168:171], v[128:131], v[216:219], v[168:171]
  ds_read_b128 v[200:203], v253 offset:8192
  v_mfma_f32_16x16x32_bf16 v[176:179], v[152:155], v[216:219], v[176:179]
  s_waitcnt lgkmcnt(3)
  v_mfma_f32_16x16x32_bf16 v[172:175], v[128:131], v[220:223], v[172:175]
  ds_read_b128 v[204:207], v253 offset:9216
  v_mfma_f32_16x16x32_bf16 v[180:183], v[152:155], v[220:223], v[180:183]
  s_waitcnt lgkmcnt(3)
  v_mfma_f32_16x16x32_bf16 v[168:171], v[132:135], v[224:227], v[168:171]
  v_mfma_f32_16x16x32_bf16 v[176:179], v[156:159], v[224:227], v[176:179]
  s_waitcnt lgkmcnt(2)
  v_mfma_f32_16x16x32_bf16 v[172:175], v[132:135], v[228:231], v[172:175]
  v_mfma_f32_16x16x32_bf16 v[180:183], v[156:159], v[228:231], v[180:183]
  s_waitcnt lgkmcnt(1)
  v_mfma_f32_16x16x32_bf16 v[168:171], v[136:139], v[200:203], v[168:171]
  v_mfma_f32_16x16x32_bf16 v[176:179], v[160:163], v[200:203], v[176:179]
  s_waitcnt lgkmcnt(0)
  v_mfma_f32_16x16x32_bf16 v[172:175], v[136:139], v[204:207], v[172:175]
  v_mfma_f32_16x16x32_bf16 v[180:183], v[160:163], v[204:207], v[180:183]
  v_mfma_f32_16x16x32_bf16 v[168:171], v[140:143], v[64:67], v[168:171]
  v_mfma_f32_16x16x32_bf16 v[176:179], v[164:167], v[64:67], v[176:179]
  v_mfma_f32_16x16x32_bf16 v[172:175], v[140:143], v[92:95], v[172:175]
  v_mfma_f32_16x16x32_bf16 v[180:183], v[164:167], v[92:95], v[180:183]
  v_mfma_f32_16x16x32_bf16 v[184:187], v[120:123], v[68:71], 0
  v_mfma_f32_16x16x32_bf16 v[192:195], v[144:147], v[68:71], 0
  v_mfma_f32_16x16x32_bf16 v[188:191], v[120:123], v[96:99], 0
  s_nop 1
  v_mul_f32 v168, v168, v56
  s_nop 0
  v_mul_f32 v172, v172, v56
  v_mfma_f32_16x16x32_bf16 v[196:199], v[144:147], v[96:99], 0
  v_cvt_pk_bf16_f32 v16, v168, v172
  v_mul_f32 v169, v169, v57
  v_mfma_f32_16x16x32_bf16 v[184:187], v[124:127], v[72:75], v[184:187]
  v_mul_f32 v173, v173, v57
  v_cvt_pk_bf16_f32 v18, v169, v173
  v_mfma_f32_16x16x32_bf16 v[192:195], v[148:151], v[72:75], v[192:195]
  v_mul_f32 v170, v170, v58
  v_mul_f32 v174, v174, v58
  v_mfma_f32_16x16x32_bf16 v[188:191], v[124:127], v[100:103], v[188:191]
  v_cvt_pk_bf16_f32 v20, v170, v174
  v_mul_f32 v171, v171, v59
  v_mfma_f32_16x16x32_bf16 v[196:199], v[148:151], v[100:103], v[196:199]
  v_mul_f32 v175, v175, v59
  v_cvt_pk_bf16_f32 v22, v171, v175
  v_mfma_f32_16x16x32_bf16 v[184:187], v[128:131], v[76:79], v[184:187]
  v_mul_f32 v176, v176, v60
  v_mul_f32 v180, v180, v60
  v_mfma_f32_16x16x32_bf16 v[192:195], v[152:155], v[76:79], v[192:195]
  v_cvt_pk_bf16_f32 v24, v176, v180
  v_mul_f32 v177, v177, v61
  v_mfma_f32_16x16x32_bf16 v[188:191], v[128:131], v[104:107], v[188:191]
  v_mul_f32 v181, v181, v61
  v_cvt_pk_bf16_f32 v26, v177, v181
  v_mfma_f32_16x16x32_bf16 v[196:199], v[152:155], v[104:107], v[196:199]
  v_mul_f32 v178, v178, v62
  v_mul_f32 v182, v182, v62
  v_mfma_f32_16x16x32_bf16 v[184:187], v[132:135], v[80:83], v[184:187]
  v_cvt_pk_bf16_f32 v28, v178, v182
  v_mul_f32 v179, v179, v63
  v_mfma_f32_16x16x32_bf16 v[192:195], v[156:159], v[80:83], v[192:195]
  v_mul_f32 v183, v183, v63
  v_cvt_pk_bf16_f32 v30, v179, v183
  v_mfma_f32_16x16x32_bf16 v[188:191], v[132:135], v[108:111], v[188:191]
  v_mfma_f32_16x16x32_bf16 v[196:199], v[156:159], v[108:111], v[196:199]
  s_cmp_lt_u32 s40, 4
  s_cbranch_scc1 M_e4
  s_waitcnt vmcnt(0)
  s_barrier
M_e4:
  v_mfma_f32_16x16x32_bf16 v[184:187], v[136:139], v[84:87], v[184:187]
  ds_read_b128 v[200:203], v252 offset:0
  v_mfma_f32_16x16x32_bf16 v[192:195], v[160:163], v[84:87], v[192:195]
  v_mfma_f32_16x16x32_bf16 v[188:191], v[136:139], v[112:115], v[188:191]
  ds_read_b128 v[204:207], v252 offset:1024
  v_mfma_f32_16x16x32_bf16 v[196:199], v[160:163], v[112:115], v[196:199]
  v_mfma_f32_16x16x32_bf16 v[184:187], v[140:143], v[88:91], v[184:187]
  ds_read_b128 v[208:211], v252 offset:2048
  v_mfma_f32_16x16x32_bf16 v[192:195], v[164:167], v[88:91], v[192:195]
  v_mfma_f32_16x16x32_bf16 v[188:191], v[140:143], v[116:119], v[188:191]
  ds_read_b128 v[212:215], v252 offset:3072
  v_mfma_f32_16x16x32_bf16 v[196:199], v[164:167], v[116:119], v[196:199]
  s_waitcnt lgkmcnt(3)
  v_mfma_f32_16x16x32_bf16 v[168:171], v[120:123], v[200:203], 0
  ds_read_b128 v[216:219], v252 offset:4096
  v_mfma_f32_16x16x32_bf16 v[176:179], v[144:147], v[200:203], 0
  s_waitcnt lgkmcnt(3)
  v_mfma_f32_16x16x32_bf16 v[172:175], v[120:123], v[204:207], 0
  ds_read_b128 v[220:223], v252 offset:5120
  v_mul_f32 v184, v184, v56
  v_mfma_f32_16x16x32_bf16 v[180:183], v[144:147], v[204:207], 0
  s_waitcnt lgkmcnt(3)
  v_mul_f32 v188, v188, v56
  v_cvt_pk_bf16_f32 v17, v184, v188
  v_mfma_f32_16x16x32_bf16 v[168:171], v[124:127], v[208:211], v[168:171]
  ds_read_b128 v[224:227], v252 offset:6144
  buffer_store_dwordx2 v[16:17], v4, s[20:23], 0 offen offset:0 sc1
  v_mfma_f32_16x16x32_bf16 v[176:179], v[148:151], v[208:211], v[176:179]
  s_waitcnt lgkmcnt(3)
  v_mul_f32 v185, v185, v57
  v_mul_f32 v189, v189, v57
  v_mfma_f32_16x16x32_bf16 v[172:175], v[124:127], v[212:215], v[172:175]
  ds_read_b128 v[228:231], v252 offset:7168
  v_cvt_pk_bf16_f32 v19, v185, v189
  v_mfma_f32_16x16x32_bf16 v[180:183], v[148:151], v[212:215], v[180:183]
  s_waitcnt lgkmcnt(3)
  buffer_store_dwordx2 v[18:19], v5, s[20:23], 0 offen offset:0 sc1
  v_mul_f32 v186, v186, v58
  v_mfma_f32_16x16x32_bf16 v[168:171], v[128:131], v[216:219], v[168:171]
  ds_read_b128 v[200:203], v252 offset:8192
  v_mul_f32 v190, v190, v58
  v_mfma_f32_16x16x32_bf16 v[176:179], v[152:155], v[216:219], v[176:179]
  s_waitcnt lgkmcnt(3)
  v_cvt_pk_bf16_f32 v21, v186, v190
  buffer_store_dwordx2 v[20:21], v6, s[20:23], 0 offen offset:0 sc1
  v_mfma_f32_16x16x32_bf16 v[172:175], v[128:131], v[220:223], v[172:175]
  ds_read_b128 v[204:207], v252 offset:9216
  v_mul_f32 v187, v187, v59
  v_mfma_f32_16x16x32_bf16 v[180:183], v[152:155], v[220:223], v[180:183]
  s_waitcnt lgkmcnt(3)
  v_mul_f32 v191, v191, v59
  v_cvt_pk_bf16_f32 v23, v187, v191
  v_mfma_f32_16x16x32_bf16 v[168:171], v[132:135], v[224:227], v[168:171]
  ds_read_b128 v[208:211], v252 offset:10240
  buffer_store_dwordx2 v[22:23], v7, s[20:23], 0 offen offset:0 sc1
  v_mfma_f32_16x16x32_bf16 v[176:179], v[156:159], v[224:227], v[176:179]
  s_waitcnt lgkmcnt(3)
  v_mul_f32 v192, v192, v60
  v_mul_f32 v196, v196, v60
  v_mfma_f32_16x16x32_bf16 v[172:175], v[132:135], v[228:231], v[172:175]
  ds_read_b128 v[212:215], v252 offset:11264
  v_cvt_pk_bf16_f32 v25, v192, v196
  v_mfma_f32_16x16x32_bf16 v[180:183], v[156:159], v[228:231], v[180:183]
  s_waitcnt lgkmcnt(3)
  buffer_store_dwordx2 v[24:25], v8, s[20:23], 0 offen offset:0 sc1
  v_mul_f32 v193, v193, v61
  v_mfma_f32_16x16x32_bf16 v[168:171], v[136:139], v[200:203], v[168:171]
  ds_read_b128 v[216:219], v252 offset:12288
  v_mul_f32 v197, v197, v61
  v_mfma_f32_16x16x32_bf16 v[176:179], v[160:163], v[200:203], v[176:179]
  s_waitcnt lgkmcnt(3)
  v_cvt_pk_bf16_f32 v27, v193, v197
  buffer_store_dwordx2 v[26:27], v9, s[20:23], 0 offen offset:0 sc1
  v_mfma_f32_16x16x32_bf16 v[172:175], v[136:139], v[204:207], v[172:175]
  ds_read_b128 v[220:223], v252 offset:13312
  v_mul_f32 v194, v194, v62
  v_mfma_f32_16x16x32_bf16 v[180:183], v[160:163], v[204:207], v[180:183]
  s_waitcnt lgkmcnt(3)
  v_mul_f32 v198, v198, v62
  v_cvt_pk_bf16_f32 v29, v194, v198
  v_mfma_f32_16x16x32_bf16 v[168:171], v[140:143], v[208:211], v[168:171]
  ds_read_b128 v[224:227], v252 offset:14336
  buffer_store_dwordx2 v[28:29], v10, s[20:23], 0 offen offset:0 sc1
  v_mfma_f32_16x16x32_bf16 v[176:179], v[164:167], v[208:211], v[176:179]
  s_waitcnt lgkmcnt(3)
  v_mul_f32 v195, v195, v63
  v_mul_f32 v199, v199, v63
  v_mfma_f32_16x16x32_bf16 v[172:175], v[140:143], v[212:215], v[172:175]
  ds_read_b128 v[228:231], v252 offset:15360
  v_cvt_pk_bf16_f32 v31, v195, v199
  v_mfma_f32_16x16x32_bf16 v[180:183], v[164:167], v[212:215], v[180:183]
  s_waitcnt lgkmcnt(3)
  buffer_store_dwordx2 v[30:31], v11, s[20:23], 0 offen offset:0 sc1
  v_mfma_f32_16x16x32_bf16 v[184:187], v[120:123], v[216:219], 0
  ds_read_b128 v[200:203], v252 offset:16384
  v_mfma_f32_16x16x32_bf16 v[192:195], v[144:147], v[216:219], 0
  s_waitcnt lgkmcnt(3)
  v_mfma_f32_16x16x32_bf16 v[188:191], v[120:123], v[220:223], 0
  ds_read_b128 v[204:207], v252 offset:17408
  v_mul_f32 v168, v168, v56
  v_mfma_f32_16x16x32_bf16 v[196:199], v[144:147], v[220:223], 0
  s_waitcnt lgkmcnt(3)
  v_mul_f32 v172, v172, v56
  v_cvt_pk_bf16_f32 v16, v168, v172
  v_mfma_f32_16x16x32_bf16 v[184:187], v[124:127], v[224:227], v[184:187]
  ds_read_b128 v[208:211], v252 offset:18432
  v_mul_f32 v169, v169, v57
  v_mfma_f32_16x16x32_bf16 v[192:195], v[148:151], v[224:227], v[192:195]
  s_waitcnt lgkmcnt(3)
  v_mul_f32 v173, v173, v57
  v_cvt_pk_bf16_f32 v18, v169, v173
  v_mfma_f32_16x16x32_bf16 v[188:191], v[124:127], v[228:231], v[188:191]
  ds_read_b128 v[212:215], v252 offset:19456
  v_mul_f32 v170, v170, v58
  v_mfma_f32_16x16x32_bf16 v[196:199], v[148:151], v[228:231], v[196:199]
  s_waitcnt lgkmcnt(3)
  v_mul_f32 v174, v174, v58
  v_cvt_pk_bf16_f32 v20, v170, v174
  v_mfma_f32_16x16x32_bf16 v[184:187], v[128:131], v[200:203], v[184:187]
  ds_read_b128 v[216:219], v252 offset:20480
  v_mul_f32 v171, v171, v59
  v_mfma_f32_16x16x32_bf16 v[192:195], v[152:155], v[200:203], v[192:195]
  s_waitcnt lgkmcnt(3)
  v_mul_f32 v175, v175, v59
  v_cvt_pk_bf16_f32 v22, v171, v175
  v_mfma_f32_16x16x32_bf16 v[188:191], v[128:131], v[204:207], v[188:191]
  ds_read_b128 v[220:223], v252 offset:21504
  v_mul_f32 v176, v176, v60
  v_mfma_f32_16x16x32_bf16 v[196:199], v[152:155], v[204:207], v[196:199]
  s_waitcnt lgkmcnt(3)
  v_mul_f32 v180, v180, v60
  v_cvt_pk_bf16_f32 v24, v176, v180
  v_mfma_f32_16x16x32_bf16 v[184:187], v[132:135], v[208:211], v[184:187]
  ds_read_b128 v[224:227], v252 offset:22528
  v_mul_f32 v177, v177, v61
  v_mfma_f32_16x16x32_bf16 v[192:195], v[156:159], v[208:211], v[192:195]
  s_waitcnt lgkmcnt(3)
  v_mul_f32 v181, v181, v61
  v_cvt_pk_bf16_f32 v26, v177, v181
  v_mfma_f32_16x16x32_bf16 v[188:191], v[132:135], v[212:215], v[188:191]
  ds_read_b128 v[228:231], v252 offset:23552
  v_mul_f32 v178, v178, v62
  v_mfma_f32_16x16x32_bf16 v[196:199], v[156:159], v[212:215], v[196:199]
  s_waitcnt lgkmcnt(3)
  v_mul_f32 v182, v182, v62
  v_cvt_pk_bf16_f32 v28, v178, v182
  v_mfma_f32_16x16x32_bf16 v[184:187], v[136:139], v[216:219], v[184:187]
  ds_read_b128 v[200:203], v252 offset:24576
  v_mul_f32 v179, v179, v63
  v_mfma_f32_16x16x32_bf16 v[192:195], v[160:163], v[216:219], v[192:195]
  s_waitcnt lgkmcnt(3)
  v_mul_f32 v183, v183, v63
  v_cvt_pk_bf16_f32 v30, v179, v183
  v_mfma_f32_16x16x32_bf16 v[188:191], v[136:139], v[220:223], v[188:191]
  ds_read_b128 v[204:207], v252 offset:25600
  v_mfma_f32_16x16x32_bf16 v[196:199], v[160:163], v[220:223], v[196:199]
  s_waitcnt lgkmcnt(3)
  v_mfma_f32_16x16x32_bf16 v[184:187], v[140:143], v[224:227], v[184:187]
  ds_read_b128 v[208:211], v252 offset:26624
  v_mfma_f32_16x16x32_bf16 v[192:195], v[164:167], v[224:227], v[192:195]
  s_waitcnt lgkmcnt(3)
  v_mfma_f32_16x16x32_bf16 v[188:191], v[140:143], v[228:231], v[188:191]
  ds_read_b128 v[212:215], v252 offset:27648
  v_mfma_f32_16x16x32_bf16 v[196:199], v[164:167], v[228:231], v[196:199]
  s_waitcnt lgkmcnt(3)
  v_mfma_f32_16x16x32_bf16 v[168:171], v[120:123], v[200:203], 0
  ds_read_b128 v[216:219], v252 offset:28672
  v_mfma_f32_16x16x32_bf16 v[176:179], v[144:147], v[200:203], 0
  s_waitcnt lgkmcnt(3)
  v_mfma_f32_16x16x32_bf16 v[172:175], v[120:123], v[204:207], 0
  ds_read_b128 v[220:223], v252 offset:29696
  v_mul_f32 v184, v184, v56
  v_mfma_f32_16x16x32_bf16 v[180:183], v[144:147], v[204:207], 0
  s_waitcnt lgkmcnt(3)
  v_mul_f32 v188, v188, v56
  v_cvt_pk_bf16_f32 v17, v184, v188
  v_mfma_f32_16x16x32_bf16 v[168:171], v[124:127], v[208:211], v[168:171]
  ds_read_b128 v[224:227], v252 offset:30720
  buffer_store_dwordx2 v[16:17], v4, s[20:23], 0 offen offset:128 sc1
  v_mfma_f32_16x16x32_bf16 v[176:179], v[148:151], v[208:211], v[176:179]
  s_waitcnt lgkmcnt(3)
  v_mul_f32 v185, v185, v57
  v_mul_f32 v189, v189, v57
  v_mfma_f32_16x16x32_bf16 v[172:175], v[124:127], v[212:215], v[172:175]
  ds_read_b128 v[228:231], v252 offset:31744
  v_cvt_pk_bf16_f32 v19, v185, v189
  v_mfma_f32_16x16x32_bf16 v[180:183], v[148:151], v[212:215], v[180:183]
  s_waitcnt lgkmcnt(3)
  buffer_store_dwordx2 v[18:19], v5, s[20:23], 0 offen offset:128 sc1
  v_mul_f32 v186, v186, v58
  v_mfma_f32_16x16x32_bf16 v[168:171], v[128:131], v[216:219], v[168:171]
  ds_read_b128 v[200:203], v252 offset:32768
  v_mul_f32 v190, v190, v58
  v_mfma_f32_16x16x32_bf16 v[176:179], v[152:155], v[216:219], v[176:179]
  s_waitcnt lgkmcnt(3)
  v_cvt_pk_bf16_f32 v21, v186, v190
  buffer_store_dwordx2 v[20:21], v6, s[20:23], 0 offen offset:128 sc1
  v_mfma_f32_16x16x32_bf16 v[172:175], v[128:131], v[220:223], v[172:175]
  ds_read_b128 v[204:207], v252 offset:33792
  v_mul_f32 v187, v187, v59
  v_mfma_f32_16x16x32_bf16 v[180:183], v[152:155], v[220:223], v[180:183]
  s_waitcnt lgkmcnt(3)
  v_mul_f32 v191, v191, v59
  v_cvt_pk_bf16_f32 v23, v187, v191
  v_mfma_f32_16x16x32_bf16 v[168:171], v[132:135], v[224:227], v[168:171]
  ds_read_b128 v[208:211], v252 offset:34816
  buffer_store_dwordx2 v[22:23], v7, s[20:23], 0 offen offset:128 sc1
  v_mfma_f32_16x16x32_bf16 v[176:179], v[156:159], v[224:227], v[176:179]
  s_waitcnt lgkmcnt(3)
  v_mul_f32 v192, v192, v60
  v_mul_f32 v196, v196, v60
  v_mfma_f32_16x16x32_bf16 v[172:175], v[132:135], v[228:231], v[172:175]
  ds_read_b128 v[212:215], v252 offset:35840
  v_cvt_pk_bf16_f32 v25, v192, v196
  v_mfma_f32_16x16x32_bf16 v[180:183], v[156:159], v[228:231], v[180:183]
  s_waitcnt lgkmcnt(3)
  buffer_store_dwordx2 v[24:25], v8, s[20:23], 0 offen offset:128 sc1
  v_mul_f32 v193, v193, v61
  v_mfma_f32_16x16x32_bf16 v[168:171], v[136:139], v[200:203], v[168:171]
  ds_read_b128 v[216:219], v252 offset:36864
  v_mul_f32 v197, v197, v61
  v_mfma_f32_16x16x32_bf16 v[176:179], v[160:163], v[200:203], v[176:179]
  s_waitcnt lgkmcnt(3)
  v_cvt_pk_bf16_f32 v27, v193, v197
  buffer_store_dwordx2 v[26:27], v9, s[20:23], 0 offen offset:128 sc1
  v_mfma_f32_16x16x32_bf16 v[172:175], v[136:139], v[204:207], v[172:175]
  ds_read_b128 v[220:223], v252 offset:37888
  v_mul_f32 v194, v194, v62
  v_mfma_f32_16x16x32_bf16 v[180:183], v[160:163], v[204:207], v[180:183]
  s_waitcnt lgkmcnt(3)
  v_mul_f32 v198, v198, v62
  v_cvt_pk_bf16_f32 v29, v194, v198
  v_mfma_f32_16x16x32_bf16 v[168:171], v[140:143], v[208:211], v[168:171]
  ds_read_b128 v[224:227], v252 offset:38912
  buffer_store_dwordx2 v[28:29], v10, s[20:23], 0 offen offset:128 sc1
  v_mfma_f32_16x16x32_bf16 v[176:179], v[164:167], v[208:211], v[176:179]
  s_waitcnt lgkmcnt(3)
  v_mul_f32 v195, v195, v63
  v_mul_f32 v199, v199, v63
  v_mfma_f32_16x16x32_bf16 v[172:175], v[140:143], v[212:215], v[172:175]
  ds_read_b128 v[228:231], v252 offset:39936
  v_cvt_pk_bf16_f32 v31, v195, v199
  v_mfma_f32_16x16x32_bf16 v[180:183], v[164:167], v[212:215], v[180:183]
  s_waitcnt lgkmcnt(3)
  buffer_store_dwordx2 v[30:31], v11, s[20:23], 0 offen offset:128 sc1
  v_mfma_f32_16x16x32_bf16 v[184:187], v[120:123], v[216:219], 0
  ds_read_b128 v[200:203], v252 offset:40960
  v_mfma_f32_16x16x32_bf16 v[192:195], v[144:147], v[216:219], 0
  s_waitcnt lgkmcnt(3)
  v_mfma_f32_16x16x32_bf16 v[188:191], v[120:123], v[220:223], 0
  ds_read_b128 v[204:207], v252 offset:41984
  v_mul_f32 v168, v168, v56
  v_mfma_f32_16x16x32_bf16 v[196:199], v[144:147], v[220:223], 0
  s_waitcnt lgkmcnt(3)
  v_mul_f32 v172, v172, v56
  v_cvt_pk_bf16_f32 v16, v168, v172
  v_mfma_f32_16x16x32_bf16 v[184:187], v[124:127], v[224:227], v[184:187]
  ds_read_b128 v[208:211], v252 offset:43008
  v_mul_f32 v169, v169, v57
  v_mfma_f32_16x16x32_bf16 v[192:195], v[148:151], v[224:227], v[192:195]
  s_waitcnt lgkmcnt(3)
  v_mul_f32 v173, v173, v57
  v_cvt_pk_bf16_f32 v18, v169, v173
  v_mfma_f32_16x16x32_bf16 v[188:191], v[124:127], v[228:231], v[188:191]
  ds_read_b128 v[212:215], v252 offset:44032
  v_mul_f32 v170, v170, v58
  v_mfma_f32_16x16x32_bf16 v[196:199], v[148:151], v[228:231], v[196:199]
  s_waitcnt lgkmcnt(3)
  v_mul_f32 v174, v174, v58
  v_cvt_pk_bf16_f32 v20, v170, v174
  v_mfma_f32_16x16x32_bf16 v[184:187], v[128:131], v[200:203], v[184:187]
  ds_read_b128 v[216:219], v252 offset:45056
  v_mul_f32 v171, v171, v59
  v_mfma_f32_16x16x32_bf16 v[192:195], v[152:155], v[200:203], v[192:195]
  s_waitcnt lgkmcnt(3)
  v_mul_f32 v175, v175, v59
  v_cvt_pk_bf16_f32 v22, v171, v175
  v_mfma_f32_16x16x32_bf16 v[188:191], v[128:131], v[204:207], v[188:191]
  ds_read_b128 v[220:223], v252 offset:46080
  v_mul_f32 v176, v176, v60
  v_mfma_f32_16x16x32_bf16 v[196:199], v[152:155], v[204:207], v[196:199]
  s_waitcnt lgkmcnt(3)
  v_mul_f32 v180, v180, v60
  v_cvt_pk_bf16_f32 v24, v176, v180
  v_mfma_f32_16x16x32_bf16 v[184:187], v[132:135], v[208:211], v[184:187]
  ds_read_b128 v[224:227], v252 offset:47104
  v_mul_f32 v177, v177, v61
  v_mfma_f32_16x16x32_bf16 v[192:195], v[156:159], v[208:211], v[192:195]
  s_waitcnt lgkmcnt(3)
  v_mul_f32 v181, v181, v61
  v_cvt_pk_bf16_f32 v26, v177, v181
  v_mfma_f32_16x16x32_bf16 v[188:191], v[132:135], v[212:215], v[188:191]
  ds_read_b128 v[228:231], v252 offset:48128
  v_mul_f32 v178, v178, v62
  v_mfma_f32_16x16x32_bf16 v[196:199], v[156:159], v[212:215], v[196:199]
  s_waitcnt lgkmcnt(3)
  v_mul_f32 v182, v182, v62
  v_cvt_pk_bf16_f32 v28, v178, v182
  v_mfma_f32_16x16x32_bf16 v[184:187], v[136:139], v[216:219], v[184:187]
  v_mul_f32 v179, v179, v63
  v_mul_f32 v183, v183, v63
  v_mfma_f32_16x16x32_bf16 v[192:195], v[160:163], v[216:219], v[192:195]
  s_waitcnt lgkmcnt(2)
  v_cvt_pk_bf16_f32 v30, v179, v183
  v_mfma_f32_16x16x32_bf16 v[188:191], v[136:139], v[220:223], v[188:191]
  v_mfma_f32_16x16x32_bf16 v[196:199], v[160:163], v[220:223], v[196:199]
  s_waitcnt lgkmcnt(1)
  v_mfma_f32_16x16x32_bf16 v[184:187], v[140:143], v[224:227], v[184:187]
  v_mfma_f32_16x16x32_bf16 v[192:195], v[164:167], v[224:227], v[192:195]
  s_waitcnt lgkmcnt(0)
  v_mfma_f32_16x16x32_bf16 v[188:191], v[140:143], v[228:231], v[188:191]
  v_mfma_f32_16x16x32_bf16 v[196:199], v[164:167], v[228:231], v[196:199]
  s_nop 3
  v_mul_f32 v184, v184, v56
  s_nop 1
  v_mul_f32 v188, v188, v56
  v_cvt_pk_bf16_f32 v17, v184, v188
  buffer_store_dwordx2 v[16:17], v4, s[20:23], 0 offen offset:256 sc1
  v_mul_f32 v185, v185, v57
  v_mul_f32 v189, v189, v57
  v_cvt_pk_bf16_f32 v19, v185, v189
  buffer_store_dwordx2 v[18:19], v5, s[20:23], 0 offen offset:256 sc1
  v_mul_f32 v186, v186, v58
  v_mul_f32 v190, v190, v58
  v_cvt_pk_bf16_f32 v21, v186, v190
  buffer_store_dwordx2 v[20:21], v6, s[20:23], 0 offen offset:256 sc1
  v_mul_f32 v187, v187, v59
  v_mul_f32 v191, v191, v59
  v_cvt_pk_bf16_f32 v23, v187, v191
  buffer_store_dwordx2 v[22:23], v7, s[20:23], 0 offen offset:256 sc1
  v_mul_f32 v192, v192, v60
  v_mul_f32 v196, v196, v60
  v_cvt_pk_bf16_f32 v25, v192, v196
  buffer_store_dwordx2 v[24:25], v8, s[20:23], 0 offen offset:256 sc1
  v_mul_f32 v193, v193, v61
  v_mul_f32 v197, v197, v61
  v_cvt_pk_bf16_f32 v27, v193, v197
  buffer_store_dwordx2 v[26:27], v9, s[20:23], 0 offen offset:256 sc1
  v_mul_f32 v194, v194, v62
  v_mul_f32 v198, v198, v62
  v_cvt_pk_bf16_f32 v29, v194, v198
  buffer_store_dwordx2 v[28:29], v10, s[20:23], 0 offen offset:256 sc1
  v_mul_f32 v195, v195, v63
  v_mul_f32 v199, v199, v63
  v_cvt_pk_bf16_f32 v31, v195, v199
  buffer_store_dwordx2 v[30:31], v11, s[20:23], 0 offen offset:256 sc1
  s_endpgm
M_helper:
  s_add_i32 s56, s45, 0
  s_lshl_b32 s56, s56, 1
  s_add_i32 s56, s56, s41
  s_max_i32 s56, s56, 0
  s_min_i32 s56, s56, 223
  s_mul_i32 s56, s56, 86016
  s_mov_b32 m0, 0
  s_nop 0
  buffer_load_dwordx4 v232, s[16:19], s56 offen lds
  s_mov_b32 m0, 1024
  s_nop 0
  buffer_load_dwordx4 v233, s[16:19], s56 offen lds
  s_mov_b32 m0, 2048
  s_nop 0
  buffer_load_dwordx4 v234, s[16:19], s56 offen lds
  s_mov_b32 m0, 3072
  s_nop 0
  buffer_load_dwordx4 v235, s[16:19], s56 offen lds
  s_mov_b32 m0, 4096
  s_nop 0
  buffer_load_dwordx4 v236, s[16:19], s56 offen lds
  s_mov_b32 m0, 5120
  s_nop 0
  buffer_load_dwordx4 v237, s[16:19], s56 offen lds
  s_mov_b32 m0, 6144
  s_nop 0
  buffer_load_dwordx4 v238, s[16:19], s56 offen lds
  s_mov_b32 m0, 6656
  s_nop 0
  buffer_load_dwordx4 v239, s[16:19], s56 offen lds
  s_add_i32 s56, s45, 2
  s_lshl_b32 s56, s56, 1
  s_add_i32 s56, s56, s41
  s_max_i32 s56, s56, 0
  s_min_i32 s56, s56, 223
  s_mul_i32 s56, s56, 86016
  v_xor_b32 v64, 32, v232
  s_mov_b32 m0, 15360
  s_nop 0
  buffer_load_dwordx4 v64, s[16:19], s56 offen lds
  v_xor_b32 v65, 32, v233
  s_mov_b32 m0, 16384
  s_nop 0
  buffer_load_dwordx4 v65, s[16:19], s56 offen lds
  v_xor_b32 v66, 32, v234
  s_mov_b32 m0, 17408
  s_nop 0
  buffer_load_dwordx4 v66, s[16:19], s56 offen lds
  v_xor_b32 v67, 32, v235
  s_mov_b32 m0, 18432
  s_nop 0
  buffer_load_dwordx4 v67, s[16:19], s56 offen lds
  v_xor_b32 v68, 32, v236
  s_mov_b32 m0, 19456
  s_nop 0
  buffer_load_dwordx4 v68, s[16:19], s56 offen lds
  v_xor_b32 v69, 32, v237
  s_mov_b32 m0, 20480
  s_nop 0
  buffer_load_dwordx4 v69, s[16:19], s56 offen lds
  v_xor_b32 v70, 32, v238
  s_mov_b32 m0, 21504
  s_nop 0
  buffer_load_dwordx4 v70, s[16:19], s56 offen lds
  v_xor_b32 v71, 32, v239
  s_mov_b32 m0, 22016
  s_nop 0
  buffer_load_dwordx4 v71, s[16:19], s56 offen lds
  s_add_i32 s56, s45, 4
  s_lshl_b32 s56, s56, 1
  s_add_i32 s56, s56, s41
  s_max_i32 s56, s56, 0
  s_min_i32 s56, s56, 223
  s_mul_i32 s56, s56, 86016
  v_xor_b32 v64, 64, v232
  s_mov_b32 m0, 30720
  s_nop 0
  buffer_load_dwordx4 v64, s[16:19], s56 offen lds
  v_xor_b32 v65, 64, v233
  s_mov_b32 m0, 31744
  s_nop 0
  buffer_load_dwordx4 v65, s[16:19], s56 offen lds
  v_xor_b32 v66, 64, v234
  s_mov_b32 m0, 32768
  s_nop 0
  buffer_load_dwordx4 v66, s[16:19], s56 offen lds
  v_xor_b32 v67, 64, v235
  s_mov_b32 m0, 33792
  s_nop 0
  buffer_load_dwordx4 v67, s[16:19], s56 offen lds
  v_xor_b32 v68, 64, v236
  s_mov_b32 m0, 34816
  s_nop 0
  buffer_load_dwordx4 v68, s[16:19], s56 offen lds
  v_xor_b32 v69, 64, v237
  s_mov_b32 m0, 35840
  s_nop 0
  buffer_load_dwordx4 v69, s[16:19], s56 offen lds
  v_xor_b32 v70, 64, v238
  s_mov_b32 m0, 36864
  s_nop 0
  buffer_load_dwordx4 v70, s[16:19], s56 offen lds
  v_xor_b32 v71, 64, v239
  s_mov_b32 m0, 37376
  s_nop 0
  buffer_load_dwordx4 v71, s[16:19], s56 offen lds
  s_add_i32 s56, s45, 6
  s_lshl_b32 s56, s56, 1
  s_add_i32 s56, s56, s41
  s_max_i32 s56, s56, 0
  s_min_i32 s56, s56, 223
  s_mul_i32 s56, s56, 86016
  v_xor_b32 v64, 96, v232
  s_mov_b32 m0, 46080
  s_nop 0
  buffer_load_dwordx4 v64, s[16:19], s56 offen lds
  v_xor_b32 v65, 96, v233
  s_mov_b32 m0, 47104
  s_nop 0
  buffer_load_dwordx4 v65, s[16:19], s56 offen lds
  v_xor_b32 v66, 96, v234
  s_mov_b32 m0, 48128
  s_nop 0
  buffer_load_dwordx4 v66, s[16:19], s56 offen lds
  v_xor_b32 v67, 96, v235
  s_mov_b32 m0, 49152
  s_nop 0
  buffer_load_dwordx4 v67, s[16:19], s56 offen lds
  v_xor_b32 v68, 96, v236
  s_mov_b32 m0, 50176
  s_nop 0
  buffer_load_dwordx4 v68, s[16:19], s56 offen lds
  v_xor_b32 v69, 96, v237
  s_mov_b32 m0, 51200
  s_nop 0
  buffer_load_dwordx4 v69, s[16:19], s56 offen lds
  v_xor_b32 v70, 96, v238
  s_mov_b32 m0, 52224
  s_nop 0
  buffer_load_dwordx4 v70, s[16:19], s56 offen lds
  v_xor_b32 v71, 96, v239
  s_mov_b32 m0, 52736
  s_nop 0
  buffer_load_dwordx4 v71, s[16:19], s56 offen lds
  s_add_i32 s56, s45, 8
  s_lshl_b32 s56, s56, 1
  s_add_i32 s56, s56, s41
  s_max_i32 s56, s56, 0
  s_min_i32 s56, s56, 223
  s_mul_i32 s56, s56, 86016
  s_mov_b32 m0, 61440
  s_nop 0
  buffer_load_dwordx4 v232, s[16:19], s56 offen lds
  s_mov_b32 m0, 62464
  s_nop 0
  buffer_load_dwordx4 v233, s[16:19], s56 offen lds
  s_mov_b32 m0, 63488
  s_nop 0
  buffer_load_dwordx4 v234, s[16:19], s56 offen lds
  s_mov_b32 m0, 64512
  s_nop 0
  buffer_load_dwordx4 v235, s[16:19], s56 offen lds
  s_mov_b32 m0, 65536
  s_nop 0
  buffer_load_dwordx4 v236, s[16:19], s56 offen lds
  s_mov_b32 m0, 66560
  s_nop 0
  buffer_load_dwordx4 v237, s[16:19], s56 offen lds
  s_mov_b32 m0, 67584
  s_nop 0
  buffer_load_dwordx4 v238, s[16:19], s56 offen lds
  s_mov_b32 m0, 68096
  s_nop 0
  buffer_load_dwordx4 v239, s[16:19], s56 offen lds
  v_add_u32 v4, 0, v1
  v_xor_b32 v4, 8, v4
  v_mul_u32_u24 v5, 2731, v4
  v_lshrrev_b32 v5, 16, v5
  v_mul_u32_u24 v5, 384, v5
  v_lshl_add_u32 v4, v4, 4, v5
  v_add_u32 v244, s46, v4
  v_add_u32 v247, 6144, v244
  v_add_u32 v250, 12288, v244
  v_max_i32 v244, 0, v244
  v_add_u32 v4, 64, v1
  v_xor_b32 v4, 8, v4
  v_mul_u32_u24 v5, 2731, v4
  v_lshrrev_b32 v5, 16, v5
  v_mul_u32_u24 v5, 384, v5
  v_lshl_add_u32 v4, v4, 4, v5
  v_add_u32 v245, s46, v4
  v_add_u32 v248, 6144, v245
  v_max_i32 v245, 0, v245
  v_add_u32 v4, 128, v1
  v_xor_b32 v4, 8, v4
  v_mul_u32_u24 v5, 2731, v4
  v_lshrrev_b32 v5, 16, v5
  v_mul_u32_u24 v5, 384, v5
  v_lshl_add_u32 v4, v4, 4, v5
  v_add_u32 v246, s46, v4
  v_add_u32 v249, 6144, v246
  v_max_i32 v246, 0, v246
  v_add_u32 v4, 416, v1
  v_xor_b32 v4, 8, v4
  v_mul_u32_u24 v5, 2731, v4
  v_lshrrev_b32 v5, 16, v5
  v_mul_u32_u24 v5, 384, v5
  v_lshl_add_u32 v4, v4, 4, v5
  v_add_u32 v251, s46, v4
  s_add_i32 s56, s45, 1
  s_lshl_b32 s56, s56, 1
  s_add_i32 s56, s56, s41
  s_max_i32 s56, s56, 0
  s_min_i32 s56, s56, 223
  s_mul_i32 s56, s56, 86016
  s_mov_b32 m0, 7680
  s_nop 0
  buffer_load_dwordx4 v244, s[16:19], s56 offen lds
  s_mov_b32 m0, 8704
  s_nop 0
  buffer_load_dwordx4 v245, s[16:19], s56 offen lds
  s_mov_b32 m0, 9728
  s_nop 0
  buffer_load_dwordx4 v246, s[16:19], s56 offen lds
  s_mov_b32 m0, 10752
  s_nop 0
  buffer_load_dwordx4 v247, s[16:19], s56 offen lds
  s_mov_b32 m0, 11776
  s_nop 0
  buffer_load_dwordx4 v248, s[16:19], s56 offen lds
  s_mov_b32 m0, 12800
  s_nop 0
  buffer_load_dwordx4 v249, s[16:19], s56 offen lds
  s_mov_b32 m0, 13824
  s_nop 0
  buffer_load_dwordx4 v250, s[16:19], s56 offen lds
  s_mov_b32 m0, 14336
  s_nop 0
  buffer_load_dwordx4 v251, s[16:19], s56 offen lds
  s_add_i32 s56, s45, 3
  s_lshl_b32 s56, s56, 1
  s_add_i32 s56, s56, s41
  s_max_i32 s56, s56, 0
  s_min_i32 s56, s56, 223
  s_mul_i32 s56, s56, 86016
  v_xor_b32 v64, 32, v244
  s_mov_b32 m0, 23040
  s_nop 0
  buffer_load_dwordx4 v64, s[16:19], s56 offen lds
  v_xor_b32 v65, 32, v245
  s_mov_b32 m0, 24064
  s_nop 0
  buffer_load_dwordx4 v65, s[16:19], s56 offen lds
  v_xor_b32 v66, 32, v246
  s_mov_b32 m0, 25088
  s_nop 0
  buffer_load_dwordx4 v66, s[16:19], s56 offen lds
  v_xor_b32 v67, 32, v247
  s_mov_b32 m0, 26112
  s_nop 0
  buffer_load_dwordx4 v67, s[16:19], s56 offen lds
  v_xor_b32 v68, 32, v248
  s_mov_b32 m0, 27136
  s_nop 0
  buffer_load_dwordx4 v68, s[16:19], s56 offen lds
  v_xor_b32 v69, 32, v249
  s_mov_b32 m0, 28160
  s_nop 0
  buffer_load_dwordx4 v69, s[16:19], s56 offen lds
  v_xor_b32 v70, 32, v250
  s_mov_b32 m0, 29184
  s_nop 0
  buffer_load_dwordx4 v70, s[16:19], s56 offen lds
  v_xor_b32 v71, 32, v251
  s_mov_b32 m0, 29696
  s_nop 0
  buffer_load_dwordx4 v71, s[16:19], s56 offen lds
  s_waitcnt vmcnt(40)
  s_add_i32 s56, s45, 5
  s_lshl_b32 s56, s56, 1
  s_add_i32 s56, s56, s41
  s_max_i32 s56, s56, 0
  s_min_i32 s56, s56, 223
  s_mul_i32 s56, s56, 86016
  v_xor_b32 v64, 64, v244
  s_mov_b32 m0, 38400
  s_nop 0
  buffer_load_dwordx4 v64, s[16:19], s56 offen lds
  v_xor_b32 v65, 64, v245
  s_mov_b32 m0, 39424
  s_nop 0
  buffer_load_dwordx4 v65, s[16:19], s56 offen lds
  v_xor_b32 v66, 64, v246
  s_mov_b32 m0, 40448
  s_nop 0
  buffer_load_dwordx4 v66, s[16:19], s56 offen lds
  v_xor_b32 v67, 64, v247
  s_mov_b32 m0, 41472
  s_nop 0
  buffer_load_dwordx4 v67, s[16:19], s56 offen lds
  v_xor_b32 v68, 64, v248
  s_mov_b32 m0, 42496
  s_nop 0
  buffer_load_dwordx4 v68, s[16:19], s56 offen lds
  v_xor_b32 v69, 64, v249
  s_mov_b32 m0, 43520
  s_nop 0
  buffer_load_dwordx4 v69, s[16:19], s56 offen lds
  v_xor_b32 v70, 64, v250
  s_mov_b32 m0, 44544
  s_nop 0
  buffer_load_dwordx4 v70, s[16:19], s56 offen lds
  v_xor_b32 v71, 64, v251
  s_mov_b32 m0, 45056
  s_nop 0
  buffer_load_dwordx4 v71, s[16:19], s56 offen lds
  s_add_i32 s56, s45, 7
  s_lshl_b32 s56, s56, 1
  s_add_i32 s56, s56, s41
  s_max_i32 s56, s56, 0
  s_min_i32 s56, s56, 223
  s_mul_i32 s56, s56, 86016
  v_xor_b32 v64, 96, v244
  s_mov_b32 m0, 53760
  s_nop 0
  buffer_load_dwordx4 v64, s[16:19], s56 offen lds
  v_xor_b32 v65, 96, v245
  s_mov_b32 m0, 54784
  s_nop 0
  buffer_load_dwordx4 v65, s[16:19], s56 offen lds
  v_xor_b32 v66, 96, v246
  s_mov_b32 m0, 55808
  s_nop 0
  buffer_load_dwordx4 v66, s[16:19], s56 offen lds
  v_xor_b32 v67, 96, v247
  s_mov_b32 m0, 56832
  s_nop 0
  buffer_load_dwordx4 v67, s[16:19], s56 offen lds
  v_xor_b32 v68, 96, v248
  s_mov_b32 m0, 57856
  s_nop 0
  buffer_load_dwordx4 v68, s[16:19], s56 offen lds
  v_xor_b32 v69, 96, v249
  s_mov_b32 m0, 58880
  s_nop 0
  buffer_load_dwordx4 v69, s[16:19], s56 offen lds
  v_xor_b32 v70, 96, v250
  s_mov_b32 m0, 59904
  s_nop 0
  buffer_load_dwordx4 v70, s[16:19], s56 offen lds
  v_xor_b32 v71, 96, v251
  s_mov_b32 m0, 60416
  s_nop 0
  buffer_load_dwordx4 v71, s[16:19], s56 offen lds
  s_waitcnt vmcnt(40)
  s_barrier
  s_waitcnt vmcnt(0)
  s_barrier
  s_add_i32 s56, s45, 16
  s_lshl_b32 s56, s56, 1
  s_add_i32 s56, s56, s41
  s_max_i32 s56, s56, 0
  s_min_i32 s56, s56, 223
  s_mul_i32 s56, s56, 86016
  s_mov_b32 m0, 122880
  s_nop 0
  buffer_load_dwordx4 v232, s[16:19], s56 offen lds
  s_mov_b32 m0, 123904
  s_nop 0
  buffer_load_dwordx4 v233, s[16:19], s56 offen lds
  s_mov_b32 m0, 124928
  s_nop 0
  buffer_load_dwordx4 v234, s[16:19], s56 offen lds
  s_mov_b32 m0, 125952
  s_nop 0
  buffer_load_dwordx4 v235, s[16:19], s56 offen lds
  s_mov_b32 m0, 126976
  s_nop 0
  buffer_load_dwordx4 v236, s[16:19], s56 offen lds
  s_mov_b32 m0, 128000
  s_nop 0
  buffer_load_dwordx4 v237, s[16:19], s56 offen lds
  s_mov_b32 m0, 129024
  s_nop 0
  buffer_load_dwordx4 v238, s[16:19], s56 offen lds
  s_mov_b32 m0, 129536
  s_nop 0
  buffer_load_dwordx4 v239, s[16:19], s56 offen lds
  s_add_i32 s56, s45, 17
  s_lshl_b32 s56, s56, 1
  s_add_i32 s56, s56, s41
  s_max_i32 s56, s56, 0
  s_min_i32 s56, s56, 223
  s_mul_i32 s56, s56, 86016
  s_mov_b32 m0, 130560
  s_nop 0
  buffer_load_dwordx4 v244, s[16:19], s56 offen lds
  s_mov_b32 m0, 131584
  s_nop 0
  buffer_load_dwordx4 v245, s[16:19], s56 offen lds
  s_mov_b32 m0, 132608
  s_nop 0
  buffer_load_dwordx4 v246, s[16:19], s56 offen lds
  s_mov_b32 m0, 133632
  s_nop 0
  buffer_load_dwordx4 v247, s[16:19], s56 offen lds
  s_mov_b32 m0, 134656
  s_nop 0
  buffer_load_dwordx4 v248, s[16:19], s56 offen lds
  s_mov_b32 m0, 135680
  s_nop 0
  buffer_load_dwordx4 v249, s[16:19], s56 offen lds
  s_mov_b32 m0, 136704
  s_nop 0
  buffer_load_dwordx4 v250, s[16:19], s56 offen lds
  s_mov_b32 m0, 137216
  s_nop 0
  buffer_load_dwordx4 v251, s[16:19], s56 offen lds
  s_add_i32 s56, s45, 18
  s_lshl_b32 s56, s56, 1
  s_add_i32 s56, s56, s41
  s_max_i32 s56, s56, 0
  s_min_i32 s56, s56, 223
  s_mul_i32 s56, s56, 86016
  v_xor_b32 v64, 32, v232
  s_mov_b32 m0, 138240
  s_nop 0
  buffer_load_dwordx4 v64, s[16:19], s56 offen lds
  v_xor_b32 v65, 32, v233
  s_mov_b32 m0, 139264
  s_nop 0
  buffer_load_dwordx4 v65, s[16:19], s56 offen lds
  v_xor_b32 v66, 32, v234
  s_mov_b32 m0, 140288
  s_nop 0
  buffer_load_dwordx4 v66, s[16:19], s56 offen lds
  v_xor_b32 v67, 32, v235
  s_mov_b32 m0, 141312
  s_nop 0
  buffer_load_dwordx4 v67, s[16:19], s56 offen lds
  v_xor_b32 v68, 32, v236
  s_mov_b32 m0, 142336
  s_nop 0
  buffer_load_dwordx4 v68, s[16:19], s56 offen lds
  v_xor_b32 v69, 32, v237
  s_mov_b32 m0, 143360
  s_nop 0
  buffer_load_dwordx4 v69, s[16:19], s56 offen lds
  v_xor_b32 v70, 32, v238
  s_mov_b32 m0, 144384
  s_nop 0
  buffer_load_dwordx4 v70, s[16:19], s56 offen lds
  v_xor_b32 v71, 32, v239
  s_mov_b32 m0, 144896
  s_nop 0
  buffer_load_dwordx4 v71, s[16:19], s56 offen lds
  s_add_i32 s56, s45, 19
  s_lshl_b32 s56, s56, 1
  s_add_i32 s56, s56, s41
  s_max_i32 s56, s56, 0
  s_min_i32 s56, s56, 223
  s_mul_i32 s56, s56, 86016
  v_xor_b32 v64, 32, v244
  s_mov_b32 m0, 145920
  s_nop 0
  buffer_load_dwordx4 v64, s[16:19], s56 offen lds
  v_xor_b32 v65, 32, v245
  s_mov_b32 m0, 146944
  s_nop 0
  buffer_load_dwordx4 v65, s[16:19], s56 offen lds
  v_xor_b32 v66, 32, v246
  s_mov_b32 m0, 147968
  s_nop 0
  buffer_load_dwordx4 v66, s[16:19], s56 offen lds
  v_xor_b32 v67, 32, v247
  s_mov_b32 m0, 148992
  s_nop 0
  buffer_load_dwordx4 v67, s[16:19], s56 offen lds
  v_xor_b32 v68, 32, v248
  s_mov_b32 m0, 150016
  s_nop 0
  buffer_load_dwordx4 v68, s[16:19], s56 offen lds
  v_xor_b32 v69, 32, v249
  s_mov_b32 m0, 151040
  s_nop 0
  buffer_load_dwordx4 v69, s[16:19], s56 offen lds
  v_xor_b32 v70, 32, v250
  s_mov_b32 m0, 152064
  s_nop 0
  buffer_load_dwordx4 v70, s[16:19], s56 offen lds
  v_xor_b32 v71, 32, v251
  s_mov_b32 m0, 152576
  s_nop 0
  buffer_load_dwordx4 v71, s[16:19], s56 offen lds
  s_waitcnt vmcnt(0)
  v_mov_b32 v6, 0
  s_mov_b32 s59, 0
  s_mov_b64 exec, 1
H_pollV:
  buffer_load_dword v7, v6, s[36:39], 0 offen offset:128 sc1
  s_waitcnt vmcnt(0)
  v_cmp_eq_u32 vcc, 0, v7
  s_add_u32 s59, s59, 1
  s_cmp_gt_u32 s59, 200000
  s_cbranch_scc1 H_pollV_x
  s_cmp_lg_u64 vcc, 0
  s_cbranch_scc0 H_pollV_x
  s_sleep 2
  s_branch H_pollV
H_pollV_x:
  s_mov_b64 exec, -1
  s_lshr_b32 s55, s2, 3
  s_mul_i32 s55, s55, 2304
  buffer_load_dwordx4 v[80:83], v252, s[24:27], s55 offen offset:0 sc1
  buffer_load_dwordx4 v[84:87], v252, s[24:27], s55 offen offset:1024 sc1
  buffer_load_dwordx4 v[88:91], v252, s[24:27], s55 offen offset:2048 sc1
  s_barrier
  s_mov_b32 m0, 153600
  s_mov_b32 s59, 0
  buffer_load_dwordx4 v252, s[24:27], s59 offen offset:0 sc1 lds
  buffer_load_dwordx4 v252, s[24:27], s59 offen offset:1024 sc1 lds
  buffer_load_dwordx4 v252, s[24:27], s59 offen offset:2048 sc1 lds
  buffer_load_dwordx4 v252, s[24:27], s59 offen offset:3072 sc1 lds
  s_mov_b32 m0, 157696
  s_mov_b32 s59, 4096
  buffer_load_dwordx4 v252, s[24:27], s59 offen offset:0 sc1 lds
  buffer_load_dwordx4 v252, s[24:27], s59 offen offset:1024 sc1 lds
  buffer_load_dwordx4 v252, s[24:27], s59 offen offset:2048 sc1 lds
  buffer_load_dwordx4 v252, s[24:27], s59 offen offset:3072 sc1 lds
  s_mov_b32 m0, 161792
  s_mov_b32 s59, 8192
  buffer_load_dwordx4 v252, s[24:27], s59 offen offset:0 sc1 lds
  buffer_load_dwordx4 v252, s[24:27], s59 offen offset:1024 sc1 lds
  s_waitcnt vmcnt(0)
  s_barrier
  s_mov_b32 m0, 0
  s_mov_b32 s59, 24576
  buffer_load_dwordx4 v252, s[24:27], s59 offen offset:0 sc1 lds
  buffer_load_dwordx4 v252, s[24:27], s59 offen offset:1024 sc1 lds
  buffer_load_dwordx4 v252, s[24:27], s59 offen offset:2048 sc1 lds
  buffer_load_dwordx4 v252, s[24:27], s59 offen offset:3072 sc1 lds
  s_mov_b32 m0, 4096
  s_mov_b32 s59, 28672
  buffer_load_dwordx4 v252, s[24:27], s59 offen offset:0 sc1 lds
  buffer_load_dwordx4 v252, s[24:27], s59 offen offset:1024 sc1 lds
  buffer_load_dwordx4 v252, s[24:27], s59 offen offset:2048 sc1 lds
  buffer_load_dwordx4 v252, s[24:27], s59 offen offset:3072 sc1 lds
  s_mov_b32 m0, 8192
  s_mov_b32 s59, 32768
  buffer_load_dwordx4 v252, s[24:27], s59 offen offset:0 sc1 lds
  buffer_load_dwordx4 v252, s[24:27], s59 offen offset:1024 sc1 lds
  buffer_load_dwordx4 v252, s[24:27], s59 offen offset:2048 sc1 lds
  buffer_load_dwordx4 v252, s[24:27], s59 offen offset:3072 sc1 lds
  s_waitcnt vmcnt(0)
  s_barrier
M_done:
  s_endpgm
CODE_END:
.section .rodata,"a"
.p2align 6
.amdhsa_kernel standalone__neighborhood_nat__vision_kernel
  .amdhsa_next_free_vgpr 256
  .amdhsa_next_free_sgpr 102
  .amdhsa_accum_offset 256
  .amdhsa_group_segment_fixed_size 0
  .amdhsa_kernarg_size 48
  .amdhsa_user_sgpr_count 2
  .amdhsa_user_sgpr_kernarg_segment_ptr 1
  .amdhsa_system_sgpr_workgroup_id_x 1
.end_amdhsa_kernel
```

```asm
; @launch grid=(256,1,1) block=(512,1,1) lds=163840
.amdgcn_target "amdgcn-amd-amdhsa--gfx950"
.text
.globl standalone__neighborhood_nat__vision_kernel
.p2align 8
.type standalone__neighborhood_nat__vision_kernel,@function
standalone__neighborhood_nat__vision_kernel:
  s_cmp_ge_u32 s2, 256
  s_cbranch_scc1 M_done
  s_load_dwordx8 s[4:11], s[0:1], 0
  s_load_dwordx4 s[12:15], s[0:1], 32
  v_lshrrev_b32 v4, 6, v0
  v_and_b32 v1, 63, v0
  v_readfirstlane_b32 s40, v4
  v_lshrrev_b32 v2, 4, v1
  v_and_b32 v3, 15, v1
  v_lshlrev_b32 v252, 4, v1
  s_getpc_b64 s[16:17]
  s_and_b32 s16, s16, -256
  s_and_b32 s17, s17, 0xffff
  s_mov_b32 s18, CODE_END-standalone__neighborhood_nat__vision_kernel
  s_mov_b32 s19, 0x00020000
  s_lshr_b32 s55, s2, 3
  s_lshl_b32 s55, s55, 10
  s_cmp_lg_u32 s40, 3
  s_cbranch_scc1 M_nocpf
  buffer_load_dwordx4 v[136:139], v252, s[16:19], s55 offen
M_nocpf:
  s_cmp_lg_u32 s40, 0
  s_cbranch_scc1 M_comp
  v_bfe_u32 v5, v1, 2, 2
  v_lshrrev_b32 v6, 5, v1
  v_lshlrev_b32 v7, 1, v6
  v_and_b32 v8, 3, v1
  v_xor_b32 v7, v7, v8
  v_lshlrev_b32 v7, 4, v7
  s_movk_i32 s60, 1152
  v_lshl_add_u32 v4, v2, 3, v5
  v_mad_u32_u24 v200, v4, s60, v7
  v_lshrrev_b32 v4, 2, v1
  v_mad_u32_u24 v203, v4, s60, v7
  v_lshrrev_b32 v4, 3, v3
  v_lshlrev_b32 v4, 1, v4
  v_xor_b32 v4, v4, v2
  v_lshl_add_u32 v4, v3, 2, v4
  v_lshlrev_b32 v195, 4, v4
  v_add_u32 v195, 90112, v195
  s_waitcnt lgkmcnt(0)
  s_mov_b32 s28, s6
  s_and_b32 s29, s7, 0xffff
  s_mov_b32 s30, 221184
  s_mov_b32 s31, 0x00020000
  s_cmp_ge_u32 s2, 36
  s_cbranch_scc1 H_nom
  s_mul_hi_u32 s55, s2, 0x2aaaaaab
  s_mul_i32 s56, s55, 6
  s_sub_u32 s56, s2, s56
  s_mul_i32 s55, s55, 36864
  s_mul_i32 s56, s56, 36864
  s_mov_b32 m0, 90112
  s_nop 0
  buffer_load_dwordx4 v200, s[28:31], s56 offen offset:0 lds
  s_mov_b32 m0, 102016
  s_nop 0
  buffer_load_dwordx4 v200, s[28:31], s55 offen offset:384 lds
  s_mov_b32 m0, 91072
  s_nop 0
  buffer_load_dwordx4 v200, s[28:31], s56 offen offset:64 lds
  s_mov_b32 m0, 102976
  s_nop 0
  buffer_load_dwordx4 v200, s[28:31], s55 offen offset:448 lds
  s_mov_b32 m0, 92032
  s_nop 0
  buffer_load_dwordx4 v200, s[28:31], s56 offen offset:128 lds
  s_mov_b32 m0, 103936
  s_nop 0
  buffer_load_dwordx4 v200, s[28:31], s55 offen offset:512 lds
  s_mov_b32 m0, 92992
  s_nop 0
  buffer_load_dwordx4 v200, s[28:31], s56 offen offset:192 lds
  s_mov_b32 m0, 104896
  s_nop 0
  buffer_load_dwordx4 v200, s[28:31], s55 offen offset:576 lds
  s_mov_b32 m0, 93952
  s_nop 0
  buffer_load_dwordx4 v200, s[28:31], s56 offen offset:256 lds
  s_mov_b32 m0, 105856
  s_nop 0
  buffer_load_dwordx4 v200, s[28:31], s55 offen offset:640 lds
  s_mov_b32 m0, 94912
  s_nop 0
  buffer_load_dwordx4 v200, s[28:31], s56 offen offset:320 lds
  s_mov_b32 m0, 106816
  s_nop 0
  buffer_load_dwordx4 v200, s[28:31], s55 offen offset:704 lds
  s_add_u32 s55, s55, 4608
  s_add_u32 s56, s56, 4608
  s_mov_b32 m0, 96256
  s_nop 0
  buffer_load_dwordx4 v200, s[28:31], s56 offen offset:0 lds
  s_mov_b32 m0, 108160
  s_nop 0
  buffer_load_dwordx4 v200, s[28:31], s55 offen offset:384 lds
  s_mov_b32 m0, 97216
  s_nop 0
  buffer_load_dwordx4 v200, s[28:31], s56 offen offset:64 lds
  s_mov_b32 m0, 109120
  s_nop 0
  buffer_load_dwordx4 v200, s[28:31], s55 offen offset:448 lds
  s_mov_b32 m0, 98176
  s_nop 0
  buffer_load_dwordx4 v200, s[28:31], s56 offen offset:128 lds
  s_mov_b32 m0, 110080
  s_nop 0
  buffer_load_dwordx4 v200, s[28:31], s55 offen offset:512 lds
  s_mov_b32 m0, 99136
  s_nop 0
  buffer_load_dwordx4 v200, s[28:31], s56 offen offset:192 lds
  s_mov_b32 m0, 111040
  s_nop 0
  buffer_load_dwordx4 v200, s[28:31], s55 offen offset:576 lds
  s_mov_b32 m0, 100096
  s_nop 0
  buffer_load_dwordx4 v200, s[28:31], s56 offen offset:256 lds
  s_mov_b32 m0, 112000
  s_nop 0
  buffer_load_dwordx4 v200, s[28:31], s55 offen offset:640 lds
  s_mov_b32 m0, 101056
  s_nop 0
  buffer_load_dwordx4 v200, s[28:31], s56 offen offset:320 lds
  s_mov_b32 m0, 112960
  s_nop 0
  buffer_load_dwordx4 v200, s[28:31], s55 offen offset:704 lds
  s_barrier
  s_mov_b32 s16, s4
  s_and_b32 s17, s5, 0xffff
  s_mov_b32 s18, 19267584
  s_mov_b32 s19, 0x00020000
  s_mov_b32 s24, s14
  s_and_b32 s25, s15, 0xffff
  s_mov_b32 s26, 268435456
  s_mov_b32 s27, 0x00020000
  s_mov_b32 s20, s10
  s_and_b32 s21, s11, 0xffff
  s_mov_b32 s22, 19267584
  s_mov_b32 s23, 0x00020000
  s_mov_b32 s36, s12
  s_and_b32 s37, s13, 0xffff
  s_mov_b32 s38, 256
  s_mov_b32 s39, 0x00020000
  s_lshl_b32 s55, s2, 11
  s_add_u32 s55, s55, 131072
  s_waitcnt vmcnt(0)
  ds_read_b128 v[64:67], v195 offset:0
  ds_read_b128 v[88:91], v195 offset:6144
  ds_read_b128 v[112:115], v195 offset:12288
  ds_read_b128 v[136:139], v195 offset:18432
  ds_read_b128 v[68:71], v195 offset:1024
  ds_read_b128 v[92:95], v195 offset:7168
  ds_read_b128 v[116:119], v195 offset:13312
  ds_read_b128 v[140:143], v195 offset:19456
  ds_read_b128 v[72:75], v195 offset:2048
  ds_read_b128 v[96:99], v195 offset:8192
  ds_read_b128 v[120:123], v195 offset:14336
  ds_read_b128 v[144:147], v195 offset:20480
  s_waitcnt lgkmcnt(9)
  v_mfma_f32_16x16x32_bf16 v[160:163], v[64:67], v[112:115], 0
  v_mfma_f32_16x16x32_bf16 v[164:167], v[88:91], v[112:115], 0
  s_waitcnt lgkmcnt(8)
  v_mfma_f32_16x16x32_bf16 v[168:171], v[64:67], v[136:139], 0
  v_mfma_f32_16x16x32_bf16 v[172:175], v[88:91], v[136:139], 0
  ds_read_b128 v[76:79], v195 offset:3072
  ds_read_b128 v[100:103], v195 offset:9216
  ds_read_b128 v[124:127], v195 offset:15360
  ds_read_b128 v[148:151], v195 offset:21504
  s_waitcnt lgkmcnt(9)
  v_mfma_f32_16x16x32_bf16 v[160:163], v[68:71], v[116:119], v[160:163]
  v_mfma_f32_16x16x32_bf16 v[164:167], v[92:95], v[116:119], v[164:167]
  s_waitcnt lgkmcnt(8)
  v_mfma_f32_16x16x32_bf16 v[168:171], v[68:71], v[140:143], v[168:171]
  v_mfma_f32_16x16x32_bf16 v[172:175], v[92:95], v[140:143], v[172:175]
  ds_read_b128 v[80:83], v195 offset:4096
  ds_read_b128 v[104:107], v195 offset:10240
  ds_read_b128 v[128:131], v195 offset:16384
  ds_read_b128 v[152:155], v195 offset:22528
  s_waitcnt lgkmcnt(9)
  v_mfma_f32_16x16x32_bf16 v[160:163], v[72:75], v[120:123], v[160:163]
  v_mfma_f32_16x16x32_bf16 v[164:167], v[96:99], v[120:123], v[164:167]
  s_waitcnt lgkmcnt(8)
  v_mfma_f32_16x16x32_bf16 v[168:171], v[72:75], v[144:147], v[168:171]
  v_mfma_f32_16x16x32_bf16 v[172:175], v[96:99], v[144:147], v[172:175]
  ds_read_b128 v[84:87], v195 offset:5120
  ds_read_b128 v[108:111], v195 offset:11264
  ds_read_b128 v[132:135], v195 offset:17408
  ds_read_b128 v[156:159], v195 offset:23552
  s_waitcnt lgkmcnt(9)
  v_mfma_f32_16x16x32_bf16 v[160:163], v[76:79], v[124:127], v[160:163]
  v_mfma_f32_16x16x32_bf16 v[164:167], v[100:103], v[124:127], v[164:167]
  s_waitcnt lgkmcnt(8)
  v_mfma_f32_16x16x32_bf16 v[168:171], v[76:79], v[148:151], v[168:171]
  v_mfma_f32_16x16x32_bf16 v[172:175], v[100:103], v[148:151], v[172:175]
  s_waitcnt lgkmcnt(5)
  v_mfma_f32_16x16x32_bf16 v[160:163], v[80:83], v[128:131], v[160:163]
  v_mfma_f32_16x16x32_bf16 v[164:167], v[104:107], v[128:131], v[164:167]
  s_waitcnt lgkmcnt(4)
  v_mfma_f32_16x16x32_bf16 v[168:171], v[80:83], v[152:155], v[168:171]
  v_mfma_f32_16x16x32_bf16 v[172:175], v[104:107], v[152:155], v[172:175]
  s_waitcnt lgkmcnt(1)
  v_mfma_f32_16x16x32_bf16 v[160:163], v[84:87], v[132:135], v[160:163]
  v_mfma_f32_16x16x32_bf16 v[164:167], v[108:111], v[132:135], v[164:167]
  s_waitcnt lgkmcnt(0)
  v_mfma_f32_16x16x32_bf16 v[168:171], v[84:87], v[156:159], v[168:171]
  v_mfma_f32_16x16x32_bf16 v[172:175], v[108:111], v[156:159], v[172:175]
  s_nop 3
  v_cvt_pk_bf16_f32 v176, v160, v161
  v_cvt_pk_bf16_f32 v177, v162, v163
  v_cvt_pk_bf16_f32 v178, v164, v165
  v_cvt_pk_bf16_f32 v179, v166, v167
  buffer_store_dwordx4 v[176:179], v252, s[24:27], s55 offen offset:0 sc1
  v_cvt_pk_bf16_f32 v180, v168, v169
  v_cvt_pk_bf16_f32 v181, v170, v171
  v_cvt_pk_bf16_f32 v182, v172, v173
  v_cvt_pk_bf16_f32 v183, v174, v175
  buffer_store_dwordx4 v[180:183], v252, s[24:27], s55 offen offset:1024 sc1
  v_mov_b32 v192, 1
  v_mov_b32 v193, 0
  s_mov_b64 exec, 1
  s_waitcnt vmcnt(0)
  buffer_atomic_add v192, v193, s[36:39], 0 offen offset:0 sc0 sc1
  s_mov_b64 exec, -1
  s_barrier
  s_waitcnt vmcnt(0)
  v_readfirstlane_b32 s56, v192
  s_nop 0
  s_cmp_lg_u32 s56, 35
  s_cbranch_scc1 H_p1
  s_mov_b64 exec, 1
  buffer_store_dword v192, v193, s[36:39], 0 offen offset:128 sc1
  s_mov_b64 exec, -1
H_p1:
  s_barrier
  s_branch H_join
H_nom:
  s_mov_b32 s32, s8
  s_and_b32 s33, s9, 0xffff
  s_mov_b32 s34, 73728
  s_mov_b32 s35, 0x00020000
  s_cmp_lt_u32 s2, 112
  s_cbranch_scc1 H_nov1
  s_sub_u32 s58, s2, 112
  s_mul_hi_u32 s55, s58, 0x15555556
  s_mul_i32 s56, s55, 12
  s_sub_u32 s56, s58, s56
  s_mul_i32 s57, s55, 18432
  s_mov_b32 m0, 91392
  s_nop 0
  buffer_load_dwordx4 v203, s[28:31], s57 offen offset:768 lds
  s_mov_b32 m0, 92352
  s_nop 0
  buffer_load_dwordx4 v203, s[28:31], s57 offen offset:832 lds
  s_mov_b32 m0, 93312
  s_nop 0
  buffer_load_dwordx4 v203, s[28:31], s57 offen offset:896 lds
  s_mov_b32 m0, 94272
  s_nop 0
  buffer_load_dwordx4 v203, s[28:31], s57 offen offset:960 lds
  s_mov_b32 m0, 95232
  s_nop 0
  buffer_load_dwordx4 v203, s[28:31], s57 offen offset:1024 lds
  s_mov_b32 m0, 96192
  s_nop 0
  buffer_load_dwordx4 v203, s[28:31], s57 offen offset:1088 lds
  v_lshrrev_b32 v112, 1, v1
  v_mul_u32_u24 v112, 384, v112
  v_and_b32 v113, 1, v1
  v_lshl_add_u32 v112, v113, 4, v112
  s_lshl_b32 s57, s56, 5
  s_mov_b32 m0, 98304
  s_nop 0
  buffer_load_dwordx4 v112, s[32:35], s57 offen lds
  s_add_u32 s57, s57, 12288
  s_mov_b32 m0, 99328
  s_nop 0
  buffer_load_dwordx4 v112, s[32:35], s57 offen lds
  s_add_u32 s57, s57, 12288
  s_mov_b32 m0, 100352
  s_nop 0
  buffer_load_dwordx4 v112, s[32:35], s57 offen lds
  s_add_u32 s57, s57, 12288
  s_mov_b32 m0, 101376
  s_nop 0
  buffer_load_dwordx4 v112, s[32:35], s57 offen lds
  s_add_u32 s57, s57, 12288
  s_mov_b32 m0, 102400
  s_nop 0
  buffer_load_dwordx4 v112, s[32:35], s57 offen lds
  s_add_u32 s57, s57, 12288
  s_mov_b32 m0, 103424
  s_nop 0
  buffer_load_dwordx4 v112, s[32:35], s57 offen lds
  s_add_u32 s57, s57, 12288
  s_lshr_b32 s57, s56, 2
  s_mul_i32 s95, s57, 24576
  s_and_b32 s56, s56, 3
  s_lshl_b32 s56, s56, 6
  s_add_u32 s95, s95, s56
  s_lshr_b32 s56, s55, 1
  s_lshl_b32 s56, s56, 11
  s_add_u32 s95, s95, s56
  s_and_b32 s55, s55, 1
  s_lshl_b32 s55, s55, 3
  s_add_u32 s95, s95, s55
H_nov1:
  s_barrier
  s_mov_b32 s16, s4
  s_and_b32 s17, s5, 0xffff
  s_mov_b32 s18, 19267584
  s_mov_b32 s19, 0x00020000
  s_mov_b32 s24, s14
  s_and_b32 s25, s15, 0xffff
  s_mov_b32 s26, 268435456
  s_mov_b32 s27, 0x00020000
  s_mov_b32 s20, s10
  s_and_b32 s21, s11, 0xffff
  s_mov_b32 s22, 19267584
  s_mov_b32 s23, 0x00020000
  s_mov_b32 s36, s12
  s_and_b32 s37, s13, 0xffff
  s_mov_b32 s38, 256
  s_mov_b32 s39, 0x00020000
  s_cmp_lt_u32 s2, 112
  s_cbranch_scc1 H_join
  v_lshlrev_b32 v119, 3, v3
  v_lshl_add_u32 v119, v2, 8, v119
  v_add_u32 v119, 90112, v119
  s_waitcnt vmcnt(0)
  ds_read_b128 v[64:67], v195 offset:2048
  ds_read_b128 v[68:71], v195 offset:3072
  ds_read_b128 v[72:75], v195 offset:4096
  ds_read_b128 v[76:79], v195 offset:5120
  ds_read_b128 v[80:83], v195 offset:6144
  ds_read_b128 v[84:87], v195 offset:7168
  s_waitcnt lgkmcnt(2)
  ds_read_b64_tr_b16 v[88:89], v119 offset:8192
  ds_read_b64_tr_b16 v[90:91], v119 offset:8320
  ds_read_b64_tr_b16 v[92:93], v119 offset:9216
  ds_read_b64_tr_b16 v[94:95], v119 offset:9344
  ds_read_b64_tr_b16 v[96:97], v119 offset:10240
  ds_read_b64_tr_b16 v[98:99], v119 offset:10368
  ds_read_b64_tr_b16 v[100:101], v119 offset:11264
  ds_read_b64_tr_b16 v[102:103], v119 offset:11392
  ds_read_b64_tr_b16 v[104:105], v119 offset:12288
  ds_read_b64_tr_b16 v[106:107], v119 offset:12416
  ds_read_b64_tr_b16 v[108:109], v119 offset:13312
  ds_read_b64_tr_b16 v[110:111], v119 offset:13440
  s_waitcnt lgkmcnt(0)
  v_mfma_f32_16x16x32_bf16 v[112:115], v[64:67], v[88:91], 0
  v_mfma_f32_16x16x32_bf16 v[112:115], v[68:71], v[92:95], v[112:115]
  v_mfma_f32_16x16x32_bf16 v[112:115], v[72:75], v[96:99], v[112:115]
  v_mfma_f32_16x16x32_bf16 v[112:115], v[76:79], v[100:103], v[112:115]
  v_mfma_f32_16x16x32_bf16 v[112:115], v[80:83], v[104:107], v[112:115]
  v_mfma_f32_16x16x32_bf16 v[112:115], v[84:87], v[108:111], v[112:115]
  v_bfe_u32 v118, v3, 1, 1
  v_mul_u32_u24 v118, 12288, v118
  v_and_b32 v119, 1, v3
  v_lshl_add_u32 v118, v119, 10, v118
  v_lshrrev_b32 v119, 2, v3
  v_lshl_add_u32 v118, v119, 4, v118
  v_lshl_add_u32 v118, v2, 8, v118
  s_nop 0
  v_cvt_pk_bf16_f32 v116, v112, v113
  v_cvt_pk_bf16_f32 v117, v114, v115
  buffer_store_dwordx2 v[116:117], v118, s[24:27], s95 offen sc1
  s_branch H_join
M_comp:
  s_and_b32 s55, s2, 7
  s_lshr_b32 s56, s2, 3
  s_lshr_b32 s41, s55, 2
  s_bfe_u32 s42, s55, 0x10001
  s_and_b32 s55, s55, 1
  s_lshl_b32 s55, s55, 2
  s_lshr_b32 s43, s56, 3
  s_add_u32 s43, s43, s55
  s_and_b32 s44, s56, 7
  s_mul_i32 s43, s43, 14
  s_mul_i32 s44, s44, 14
  s_mul_i32 s61, s41, 13
  s_add_i32 s61, s61, -6
  s_mul_i32 s62, s42, 13
  s_add_i32 s62, s62, -6
  s_cmp_ge_u32 s40, 4
  s_cselect_b32 s53, -4, 3
  s_add_i32 s53, s53, s40
  s_lshl_b32 s53, s53, 1
  s_add_u32 s88, s43, s53
  s_mov_b32 s89, 86016
  s_movk_i32 s90, 384
  v_lshrrev_b32 v4, 3, v1
  v_and_b32 v5, 7, v1
  v_and_b32 v6, 6, v4
  v_xor_b32 v5, v5, v6
  v_add_u32 v6, 1, v4
  v_lshrrev_b32 v6, 3, v6
  v_lshlrev_b32 v6, 26, v6
  v_or_b32 v5, v5, v6
  v_add_u32 v4, s44, v4
  v_lshl_add_u32 v6, v4, 1, s62
  v_add_u32 v7, 112, v4
  v_med3_i32 v6, v6, v4, v7
  v_mul_u32_u24 v6, 384, v6
  v_lshl_add_u32 v168, v5, 4, v6
  v_add_u32 v4, 7, v4
  v_lshl_add_u32 v6, v4, 1, s62
  v_add_u32 v7, 112, v4
  v_med3_i32 v6, v6, v4, v7
  v_mul_u32_u24 v6, 384, v6
  v_lshl_add_u32 v169, v5, 4, v6
  s_add_u32 s55, s88, 0
  s_lshl_b32 s56, s55, 1
  s_add_i32 s56, s56, s61
  s_max_i32 s56, s56, s55
  s_add_i32 s55, s55, 112
  s_min_i32 s56, s56, s55
  s_mul_i32 s84, s56, 86016
  s_add_u32 s55, s88, 1
  s_lshl_b32 s56, s55, 1
  s_add_i32 s56, s56, s61
  s_max_i32 s56, s56, s55
  s_add_i32 s55, s55, 112
  s_min_i32 s56, s56, s55
  s_mul_i32 s85, s56, 86016
  s_mul_i32 s86, s40, 12288
  s_waitcnt lgkmcnt(0)
  s_mov_b32 s16, s4
  s_and_b32 s17, s5, 0xffff
  s_mov_b32 s18, 19267584
  s_mov_b32 s19, 0x00020000
  s_barrier
  s_add_u32 m0, s86, -11776
  s_nop 0
  buffer_load_dwordx4 v168, s[16:19], s84 offen offset:0 lds
  s_add_u32 m0, s86, -8704
  s_nop 0
  buffer_load_dwordx4 v168, s[16:19], s85 offen offset:0 lds
  s_add_u32 m0, s86, -5632
  s_nop 0
  buffer_load_dwordx4 v169, s[16:19], s84 offen offset:0 lds
  s_add_u32 m0, s86, -2560
  s_nop 0
  buffer_load_dwordx4 v169, s[16:19], s85 offen offset:0 lds
  s_cmp_lt_u32 s2, 36
  s_cbranch_scc1 M_x1
  s_add_u32 m0, s86, -10880
  s_nop 0
  buffer_load_dwordx4 v168, s[16:19], s84 offen offset:128 lds
  s_add_u32 m0, s86, -7808
  s_nop 0
  buffer_load_dwordx4 v168, s[16:19], s85 offen offset:128 lds
  s_add_u32 m0, s86, -4736
  s_nop 0
  buffer_load_dwordx4 v169, s[16:19], s84 offen offset:128 lds
  s_add_u32 m0, s86, -1664
  s_nop 0
  buffer_load_dwordx4 v169, s[16:19], s85 offen offset:128 lds
  s_add_u32 m0, s86, -9984
  s_nop 0
  buffer_load_dwordx4 v168, s[16:19], s84 offen offset:256 lds
  s_add_u32 m0, s86, -6912
  s_nop 0
  buffer_load_dwordx4 v168, s[16:19], s85 offen offset:256 lds
  s_add_u32 m0, s86, -3840
  s_nop 0
  buffer_load_dwordx4 v169, s[16:19], s84 offen offset:256 lds
  s_add_u32 m0, s86, -768
  s_nop 0
  buffer_load_dwordx4 v169, s[16:19], s85 offen offset:256 lds
M_x1:
  s_mov_b32 s24, s14
  s_and_b32 s25, s15, 0xffff
  s_mov_b32 s26, 268435456
  s_mov_b32 s27, 0x00020000
  s_mov_b32 s20, s10
  s_and_b32 s21, s11, 0xffff
  s_mov_b32 s22, 19267584
  s_mov_b32 s23, 0x00020000
  s_mov_b32 s36, s12
  s_and_b32 s37, s13, 0xffff
  s_mov_b32 s38, 256
  s_mov_b32 s39, 0x00020000
  s_mul_i32 s55, s41, 6
  s_add_i32 s45, s43, s55
  s_add_i32 s45, s45, -6
  s_cmp_eq_i32 s45, -6
  s_cselect_b32 s47, 6, 0
  s_cmp_eq_i32 s45, 98
  s_cselect_b32 s48, 7, 13
  s_cselect_b32 s49, 2, 0
  s_sub_i32 s45, s45, s49
  s_mul_i32 s55, s42, 6
  s_add_i32 s56, s44, s55
  s_add_i32 s56, s56, -6
  s_cmp_eq_i32 s56, -6
  s_cselect_b32 s50, 6, 0
  s_cmp_eq_i32 s56, 98
  s_cselect_b32 s51, 7, 13
  s_lshl_b32 s56, s56, 1
  s_add_i32 s56, s56, s42
  s_mul_i32 s46, s56, 384
  s_max_i32 s92, s53, s47
  s_min_i32 s92, s92, s48
  s_and_b32 s92, s92, -2
  s_add_u32 s52, s92, s49
  s_mov_b32 s54, 4286578688
  s_mov_b32 s63, 1037384597
  s_and_b32 s93, s40, 1
  s_lshl_b32 s93, s93, 3
  s_and_b32 s56, s40, 6
  s_or_b32 s93, s93, s56
  s_add_u32 s56, s40, 8
  s_add_i32 s100, s45, s56
  s_lshl_b32 s100, s100, 1
  s_add_i32 s100, s100, s41
  s_max_i32 s100, s100, 0
  s_min_i32 s100, s100, 223
  s_mul_i32 s100, s100, 86016
  s_mul_i32 s101, s56, 7680
  v_lshrrev_b32 v4, 3, v3
  v_add_u32 v4, s53, v4
  v_max_i32 v4, s47, v4
  v_min_i32 v4, s48, v4
  v_subrev_u32 v4, s92, v4
  v_and_b32 v5, 1, v2
  v_sub_u32 v6, v5, v4
  v_ashrrev_i32 v12, 31, v6
  v_and_b32 v12, s54, v12
  v_sub_u32 v6, v4, v5
  v_ashrrev_i32 v13, 31, v6
  v_and_b32 v13, s54, v13
  v_and_b32 v4, 7, v3
  v_lshrrev_b32 v5, 1, v2
  v_subrev_u32 v7, 7, v4
  v_ashrrev_i32 v7, 31, v7
  v_and_b32 v7, 0x7f, v7
  v_add_u32 v6, 0, v4
  v_max_i32 v6, s50, v6
  v_min_i32 v6, s51, v6
  v_lshlrev_b32 v6, v6, v7
  v_lshrrev_b32 v6, v5, v6
  v_not_b32 v14, v6
  v_add_u32 v6, 7, v4
  v_max_i32 v6, s50, v6
  v_min_i32 v6, s51, v6
  v_lshlrev_b32 v6, v6, v7
  v_lshrrev_b32 v6, v5, v6
  v_not_b32 v15, v6
  v_add_u32 v4, s52, v4
  v_and_b32 v5, 1, v4
  v_lshlrev_b32 v5, 3, v5
  v_and_or_b32 v5, v4, 6, v5
  v_mul_u32_u24 v4, 7680, v4
  v_lshrrev_b32 v6, 3, v3
  v_mul_u32_u24 v6, 24, v6
  v_add_u32 v6, v6, v2
  v_add_u32 v7, 0, v6
  v_xor_b32 v7, v7, v5
  v_lshl_add_u32 v240, v7, 4, v4
  v_add_u32 v7, 4, v6
  v_xor_b32 v7, v7, v5
  v_lshl_add_u32 v241, v7, 4, v4
  v_add_u32 v7, 8, v6
  v_xor_b32 v7, v7, v5
  v_lshl_add_u32 v242, v7, 4, v4
  v_add_u32 v7, 12, v6
  v_xor_b32 v7, v7, v5
  v_lshl_add_u32 v243, v7, 4, v4
  v_and_b32 v4, 1, v2
  v_lshlrev_b32 v4, 2, v4
  v_lshrrev_b32 v5, 2, v3
  v_add3_u32 v4, v4, v5, s52
  v_and_b32 v5, 1, v4
  v_lshlrev_b32 v5, 3, v5
  v_and_or_b32 v5, v4, 6, v5
  v_mul_u32_u24 v4, 7680, v4
  v_and_b32 v6, 1, v3
  v_lshl_add_u32 v4, v6, 3, v4
  v_lshrrev_b32 v6, 1, v2
  v_mul_u32_u24 v6, 24, v6
  v_bfe_u32 v7, v3, 1, 1
  v_add_u32 v6, v6, v7
  v_add_u32 v7, 0, v6
  v_xor_b32 v7, v7, v5
  v_lshl_add_u32 v244, v7, 4, v4
  v_add_u32 v7, 2, v6
  v_xor_b32 v7, v7, v5
  v_lshl_add_u32 v245, v7, 4, v4
  v_add_u32 v7, 4, v6
  v_xor_b32 v7, v7, v5
  v_lshl_add_u32 v246, v7, 4, v4
  v_add_u32 v7, 6, v6
  v_xor_b32 v7, v7, v5
  v_lshl_add_u32 v247, v7, 4, v4
  v_add_u32 v7, 8, v6
  v_xor_b32 v7, v7, v5
  v_lshl_add_u32 v248, v7, 4, v4
  v_add_u32 v7, 10, v6
  v_xor_b32 v7, v7, v5
  v_lshl_add_u32 v249, v7, 4, v4
  v_add_u32 v7, 12, v6
  v_xor_b32 v7, v7, v5
  v_lshl_add_u32 v250, v7, 4, v4
  v_add_u32 v7, 14, v6
  v_xor_b32 v7, v7, v5
  v_lshl_add_u32 v251, v7, 4, v4
  v_add_u32 v253, 153600, v252
  v_add_u32 v254, 90112, v252
  v_add_u32 v4, 0, v1
  v_xor_b32 v4, s93, v4
  v_mul_u32_u24 v5, 2731, v4
  v_lshrrev_b32 v5, 16, v5
  v_mul_u32_u24 v5, 384, v5
  v_lshl_add_u32 v4, v4, 4, v5
  v_add_u32 v232, s46, v4
  v_add_u32 v235, 6144, v232
  v_add_u32 v238, 12288, v232
  v_max_i32 v232, 0, v232
  v_add_u32 v4, 64, v1
  v_xor_b32 v4, s93, v4
  v_mul_u32_u24 v5, 2731, v4
  v_lshrrev_b32 v5, 16, v5
  v_mul_u32_u24 v5, 384, v5
  v_lshl_add_u32 v4, v4, 4, v5
  v_add_u32 v233, s46, v4
  v_add_u32 v236, 6144, v233
  v_max_i32 v233, 0, v233
  v_add_u32 v4, 128, v1
  v_xor_b32 v4, s93, v4
  v_mul_u32_u24 v5, 2731, v4
  v_lshrrev_b32 v5, 16, v5
  v_mul_u32_u24 v5, 384, v5
  v_lshl_add_u32 v4, v4, 4, v5
  v_add_u32 v234, s46, v4
  v_add_u32 v237, 6144, v234
  v_max_i32 v234, 0, v234
  v_add_u32 v4, 416, v1
  v_xor_b32 v4, s93, v4
  v_mul_u32_u24 v5, 2731, v4
  v_lshrrev_b32 v5, 16, v5
  v_mul_u32_u24 v5, 384, v5
  v_lshl_add_u32 v4, v4, 4, v5
  v_add_u32 v239, s46, v4
  v_lshrrev_b32 v197, 1, v2
  v_and_b32 v255, 1, v2
  v_add_u32 v197, s88, v197
  v_lshl_add_u32 v0, v255, 2, s44
  v_lshl_add_u32 v198, v197, 1, s61
  v_add_u32 v199, 112, v197
  v_lshlrev_b32 v255, 30, v255
  v_med3_i32 v197, v198, v197, v199
  v_mul_lo_u32 v197, v197, s89
  v_lshl_add_u32 v197, v3, 3, v197
  v_add_u32 v4, 0, v0
  v_lshl_add_u32 v198, v4, 1, s62
  v_add_u32 v199, 112, v4
  v_med3_i32 v4, v198, v4, v199
  v_mad_u32_u24 v4, v4, s90, v197
  v_add_u32 v5, 1, v0
  v_lshl_add_u32 v198, v5, 1, s62
  v_add_u32 v199, 112, v5
  v_med3_i32 v5, v198, v5, v199
  v_mad_u32_u24 v5, v5, s90, v197
  v_add_u32 v6, 2, v0
  v_lshl_add_u32 v198, v6, 1, s62
  v_add_u32 v199, 112, v6
  v_med3_i32 v6, v198, v6, v199
  v_mad_u32_u24 v6, v6, s90, v197
  v_add_u32 v7, 3, v0
  v_lshl_add_u32 v198, v7, 1, s62
  v_add_u32 v199, 112, v7
  v_med3_i32 v7, v198, v7, v199
  v_mad_u32_u24 v7, v7, s90, v197
  v_add_u32 v7, v7, v255
  v_add_u32 v8, 7, v0
  v_lshl_add_u32 v198, v8, 1, s62
  v_add_u32 v199, 112, v8
  v_med3_i32 v8, v198, v8, v199
  v_mad_u32_u24 v8, v8, s90, v197
  v_add_u32 v9, 8, v0
  v_lshl_add_u32 v198, v9, 1, s62
  v_add_u32 v199, 112, v9
  v_med3_i32 v9, v198, v9, v199
  v_mad_u32_u24 v9, v9, s90, v197
  v_add_u32 v10, 9, v0
  v_lshl_add_u32 v198, v10, 1, s62
  v_add_u32 v199, 112, v10
  v_med3_i32 v10, v198, v10, v199
  v_mad_u32_u24 v10, v10, s90, v197
  v_add_u32 v11, 10, v0
  v_lshl_add_u32 v198, v11, 1, s62
  v_add_u32 v199, 112, v11
  v_med3_i32 v11, v198, v11, v199
  v_mad_u32_u24 v11, v11, s90, v197
  v_add_u32 v11, v11, v255
  v_bfe_i32 v66, v14, 0, 1
  v_bfe_i32 v94, v15, 6, 1
  v_and_b32 v65, s54, v66
  v_and_b32 v93, s54, v94
  v_and_b32 v66, s54, v66
  v_and_b32 v94, s54, v94
  v_or_b32 v64, v65, v12
  v_or_b32 v92, v93, v12
  v_or_b32 v67, v65, v13
  v_or_b32 v95, v93, v13
  v_bfe_i32 v70, v14, 2, 1
  v_bfe_i32 v98, v15, 8, 1
  v_and_b32 v69, s54, v70
  v_and_b32 v97, s54, v98
  v_and_b32 v70, s54, v70
  v_and_b32 v98, s54, v98
  v_or_b32 v68, v69, v12
  v_or_b32 v96, v97, v12
  v_or_b32 v71, v69, v13
  v_or_b32 v99, v97, v13
  v_bfe_i32 v74, v14, 4, 1
  v_bfe_i32 v102, v15, 10, 1
  v_and_b32 v73, s54, v74
  v_and_b32 v101, s54, v102
  v_and_b32 v74, s54, v74
  v_and_b32 v102, s54, v102
  v_or_b32 v72, v73, v12
  v_or_b32 v100, v101, v12
  v_or_b32 v75, v73, v13
  v_or_b32 v103, v101, v13
  v_bfe_i32 v78, v14, 6, 1
  v_bfe_i32 v106, v15, 12, 1
  v_and_b32 v77, s54, v78
  v_and_b32 v105, s54, v106
  v_and_b32 v78, s54, v78
  v_and_b32 v106, s54, v106
  v_or_b32 v76, v77, v12
  v_or_b32 v104, v105, v12
  v_or_b32 v79, v77, v13
  v_or_b32 v107, v105, v13
  v_bfe_i32 v82, v14, 8, 1
  v_bfe_i32 v110, v15, 14, 1
  v_and_b32 v81, s54, v82
  v_and_b32 v109, s54, v110
  v_and_b32 v82, s54, v82
  v_and_b32 v110, s54, v110
  v_or_b32 v80, v81, v12
  v_or_b32 v108, v109, v12
  v_or_b32 v83, v81, v13
  v_or_b32 v111, v109, v13
  v_bfe_i32 v86, v14, 10, 1
  v_bfe_i32 v114, v15, 16, 1
  v_and_b32 v85, s54, v86
  v_and_b32 v113, s54, v114
  v_and_b32 v86, s54, v86
  v_and_b32 v114, s54, v114
  v_or_b32 v84, v85, v12
  v_or_b32 v112, v113, v12
  v_or_b32 v87, v85, v13
  v_or_b32 v115, v113, v13
  v_bfe_i32 v90, v14, 12, 1
  v_bfe_i32 v118, v15, 18, 1
  v_and_b32 v89, s54, v90
  v_and_b32 v117, s54, v118
  v_and_b32 v90, s54, v90
  v_and_b32 v118, s54, v118
  v_or_b32 v88, v89, v12
  v_or_b32 v116, v117, v12
  v_or_b32 v91, v89, v13
  v_or_b32 v119, v117, v13
  s_cmp_ge_u32 s2, 36
  s_cbranch_scc1 M_x2
  s_barrier
  s_add_u32 m0, s86, -10880
  s_nop 0
  buffer_load_dwordx4 v168, s[16:19], s84 offen offset:128 lds
  s_add_u32 m0, s86, -7808
  s_nop 0
  buffer_load_dwordx4 v168, s[16:19], s85 offen offset:128 lds
  s_add_u32 m0, s86, -4736
  s_nop 0
  buffer_load_dwordx4 v169, s[16:19], s84 offen offset:128 lds
  s_add_u32 m0, s86, -1664
  s_nop 0
  buffer_load_dwordx4 v169, s[16:19], s85 offen offset:128 lds
  s_barrier
  s_add_u32 m0, s86, -9984
  s_nop 0
  buffer_load_dwordx4 v168, s[16:19], s84 offen offset:256 lds
  s_add_u32 m0, s86, -6912
  s_nop 0
  buffer_load_dwordx4 v168, s[16:19], s85 offen offset:256 lds
  s_add_u32 m0, s86, -3840
  s_nop 0
  buffer_load_dwordx4 v169, s[16:19], s84 offen offset:256 lds
  s_add_u32 m0, s86, -768
  s_nop 0
  buffer_load_dwordx4 v169, s[16:19], s85 offen offset:256 lds
M_x2:
  v_and_b32 v170, 6, v3
  v_xor_b32 v170, v170, v2
  v_and_b32 v172, 7, v3
  v_lshlrev_b32 v172, 7, v172
  v_lshrrev_b32 v173, 3, v3
  v_mul_u32_u24 v173, 3072, v173
  s_add_u32 s55, s86, -11776
  v_add3_u32 v172, v172, v173, s55
  v_xor_b32 v171, 4, v170
  v_lshl_add_u32 v170, v170, 4, v172
  v_lshl_add_u32 v171, v171, 4, v172
  s_waitcnt vmcnt(8)
  ds_read_b128 v[16:19], v170 offset:0
  ds_read_b128 v[20:23], v171 offset:0
  ds_read_b128 v[40:43], v170 offset:6144
  ds_read_b128 v[44:47], v171 offset:6144
  s_waitcnt vmcnt(4)
  ds_read_b128 v[24:27], v170 offset:1024
  ds_read_b128 v[28:31], v171 offset:1024
  ds_read_b128 v[48:51], v170 offset:7168
  ds_read_b128 v[52:55], v171 offset:7168
  s_waitcnt vmcnt(0)
  ds_read_b128 v[32:35], v170 offset:2048
  ds_read_b128 v[36:39], v171 offset:2048
  ds_read_b128 v[56:59], v170 offset:8192
  ds_read_b128 v[60:63], v171 offset:8192
  s_waitcnt lgkmcnt(0)
  s_barrier
  s_lshl_b32 s55, s40, 10
  s_add_u32 s55, s55, 131072
  s_sub_u32 m0, s55, 40960
  s_nop 0
  buffer_load_dwordx4 v252, s[24:27], s55 offen sc1 lds
  s_add_u32 s55, s55, 8192
  s_sub_u32 m0, s55, 40960
  s_nop 0
  buffer_load_dwordx4 v252, s[24:27], s55 offen sc1 lds
  s_add_u32 s55, s55, 8192
  s_sub_u32 m0, s55, 40960
  s_nop 0
  buffer_load_dwordx4 v252, s[24:27], s55 offen sc1 lds
  s_add_u32 s55, s55, 8192
  s_sub_u32 m0, s55, 40960
  s_nop 0
  buffer_load_dwordx4 v252, s[24:27], s55 offen sc1 lds
  s_add_u32 s55, s55, 8192
  s_sub_u32 m0, s55, 40960
  s_nop 0
  buffer_load_dwordx4 v252, s[24:27], s55 offen sc1 lds
  s_add_u32 s55, s55, 8192
  s_sub_u32 m0, s55, 40960
  s_nop 0
  buffer_load_dwordx4 v252, s[24:27], s55 offen sc1 lds
  s_add_u32 s55, s55, 8192
  s_sub_u32 m0, s55, 40960
  s_nop 0
  buffer_load_dwordx4 v252, s[24:27], s55 offen sc1 lds
  s_add_u32 s55, s55, 8192
  s_sub_u32 m0, s55, 40960
  s_nop 0
  buffer_load_dwordx4 v252, s[24:27], s55 offen sc1 lds
  s_add_u32 s55, s55, 8192
  s_sub_u32 m0, s55, 40960
  s_nop 0
  buffer_load_dwordx4 v252, s[24:27], s55 offen sc1 lds
  s_waitcnt vmcnt(6)
  s_barrier
  ds_read_b128 v[200:203], v254 offset:0
  ds_read_b128 v[204:207], v254 offset:1024
  ds_read_b128 v[208:211], v254 offset:2048
  ds_read_b128 v[212:215], v254 offset:3072
  ds_read_b128 v[216:219], v254 offset:4096
  ds_read_b128 v[220:223], v254 offset:5120
  s_waitcnt lgkmcnt(5)
  v_mfma_f32_16x16x32_bf16 v[168:171], v[200:203], v[16:19], 0
  ds_read_b128 v[224:227], v254 offset:6144
  v_mfma_f32_16x16x32_bf16 v[176:179], v[200:203], v[40:43], 0
  s_waitcnt lgkmcnt(5)
  v_mfma_f32_16x16x32_bf16 v[172:175], v[204:207], v[16:19], 0
  ds_read_b128 v[228:231], v254 offset:7168
  v_mfma_f32_16x16x32_bf16 v[180:183], v[204:207], v[40:43], 0
  s_waitcnt lgkmcnt(5)
  v_mfma_f32_16x16x32_bf16 v[168:171], v[208:211], v[20:23], v[168:171]
  ds_read_b128 v[200:203], v254 offset:8192
  v_mfma_f32_16x16x32_bf16 v[176:179], v[208:211], v[44:47], v[176:179]
  s_waitcnt lgkmcnt(5)
  v_mfma_f32_16x16x32_bf16 v[172:175], v[212:215], v[20:23], v[172:175]
  ds_read_b128 v[204:207], v254 offset:9216
  v_mfma_f32_16x16x32_bf16 v[180:183], v[212:215], v[44:47], v[180:183]
  s_waitcnt lgkmcnt(5)
  v_mfma_f32_16x16x32_bf16 v[168:171], v[216:219], v[24:27], v[168:171]
  ds_read_b128 v[208:211], v254 offset:10240
  v_mfma_f32_16x16x32_bf16 v[176:179], v[216:219], v[48:51], v[176:179]
  s_waitcnt lgkmcnt(5)
  v_mfma_f32_16x16x32_bf16 v[172:175], v[220:223], v[24:27], v[172:175]
  ds_read_b128 v[212:215], v254 offset:11264
  v_mfma_f32_16x16x32_bf16 v[180:183], v[220:223], v[48:51], v[180:183]
  s_waitcnt lgkmcnt(5)
  v_mfma_f32_16x16x32_bf16 v[168:171], v[224:227], v[28:31], v[168:171]
  ds_read_b128 v[216:219], v254 offset:12288
  v_mfma_f32_16x16x32_bf16 v[176:179], v[224:227], v[52:55], v[176:179]
  s_waitcnt lgkmcnt(5)
  v_mfma_f32_16x16x32_bf16 v[172:175], v[228:231], v[28:31], v[172:175]
  ds_read_b128 v[220:223], v254 offset:13312
  v_mfma_f32_16x16x32_bf16 v[180:183], v[228:231], v[52:55], v[180:183]
  s_waitcnt lgkmcnt(5)
  v_mfma_f32_16x16x32_bf16 v[168:171], v[200:203], v[32:35], v[168:171]
  ds_read_b128 v[224:227], v254 offset:14336
  v_mfma_f32_16x16x32_bf16 v[176:179], v[200:203], v[56:59], v[176:179]
  s_waitcnt lgkmcnt(5)
  v_mfma_f32_16x16x32_bf16 v[172:175], v[204:207], v[32:35], v[172:175]
  ds_read_b128 v[228:231], v254 offset:15360
  v_mfma_f32_16x16x32_bf16 v[180:183], v[204:207], v[56:59], v[180:183]
  s_waitcnt lgkmcnt(5)
  v_mfma_f32_16x16x32_bf16 v[168:171], v[208:211], v[36:39], v[168:171]
  ds_read_b128 v[200:203], v254 offset:16384
  v_mfma_f32_16x16x32_bf16 v[176:179], v[208:211], v[60:63], v[176:179]
  s_waitcnt lgkmcnt(5)
  v_mfma_f32_16x16x32_bf16 v[172:175], v[212:215], v[36:39], v[172:175]
  ds_read_b128 v[204:207], v254 offset:17408
  v_mfma_f32_16x16x32_bf16 v[180:183], v[212:215], v[60:63], v[180:183]
  s_waitcnt lgkmcnt(5)
  v_mfma_f32_16x16x32_bf16 v[184:187], v[216:219], v[16:19], 0
  ds_read_b128 v[208:211], v254 offset:18432
  v_mfma_f32_16x16x32_bf16 v[192:195], v[216:219], v[40:43], 0
  s_waitcnt lgkmcnt(5)
  v_mfma_f32_16x16x32_bf16 v[188:191], v[220:223], v[16:19], 0
  ds_read_b128 v[212:215], v254 offset:19456
  v_cvt_pk_bf16_f32 v120, v168, v169
  v_mfma_f32_16x16x32_bf16 v[196:199], v[220:223], v[40:43], 0
  s_waitcnt lgkmcnt(5)
  v_cvt_pk_bf16_f32 v121, v170, v171
  v_cvt_pk_bf16_f32 v122, v172, v173
  v_mfma_f32_16x16x32_bf16 v[184:187], v[224:227], v[20:23], v[184:187]
  ds_read_b128 v[216:219], v254 offset:20480
  v_cvt_pk_bf16_f32 v123, v174, v175
  v_mfma_f32_16x16x32_bf16 v[192:195], v[224:227], v[44:47], v[192:195]
  s_waitcnt lgkmcnt(5)
  v_cvt_pk_bf16_f32 v144, v176, v177
  v_cvt_pk_bf16_f32 v145, v178, v179
  v_mfma_f32_16x16x32_bf16 v[188:191], v[228:231], v[20:23], v[188:191]
  ds_read_b128 v[220:223], v254 offset:21504
  v_cvt_pk_bf16_f32 v146, v180, v181
  v_mfma_f32_16x16x32_bf16 v[196:199], v[228:231], v[44:47], v[196:199]
  s_waitcnt lgkmcnt(5)
  v_cvt_pk_bf16_f32 v147, v182, v183
  v_mfma_f32_16x16x32_bf16 v[184:187], v[200:203], v[24:27], v[184:187]
  ds_read_b128 v[224:227], v254 offset:22528
  v_mfma_f32_16x16x32_bf16 v[192:195], v[200:203], v[48:51], v[192:195]
  s_waitcnt lgkmcnt(5)
  v_mfma_f32_16x16x32_bf16 v[188:191], v[204:207], v[24:27], v[188:191]
  ds_read_b128 v[228:231], v254 offset:23552
  v_mfma_f32_16x16x32_bf16 v[196:199], v[204:207], v[48:51], v[196:199]
  s_waitcnt vmcnt(0)
  s_barrier
  s_waitcnt lgkmcnt(5)
  v_mfma_f32_16x16x32_bf16 v[184:187], v[208:211], v[28:31], v[184:187]
  ds_read_b128 v[200:203], v254 offset:24576
  v_mfma_f32_16x16x32_bf16 v[192:195], v[208:211], v[52:55], v[192:195]
  s_waitcnt lgkmcnt(5)
  v_mfma_f32_16x16x32_bf16 v[188:191], v[212:215], v[28:31], v[188:191]
  ds_read_b128 v[204:207], v254 offset:25600
  v_mfma_f32_16x16x32_bf16 v[196:199], v[212:215], v[52:55], v[196:199]
  s_waitcnt lgkmcnt(5)
  v_mfma_f32_16x16x32_bf16 v[184:187], v[216:219], v[32:35], v[184:187]
  ds_read_b128 v[208:211], v254 offset:26624
  v_mfma_f32_16x16x32_bf16 v[192:195], v[216:219], v[56:59], v[192:195]
  s_waitcnt lgkmcnt(5)
  v_mfma_f32_16x16x32_bf16 v[188:191], v[220:223], v[32:35], v[188:191]
  ds_read_b128 v[212:215], v254 offset:27648
  v_mfma_f32_16x16x32_bf16 v[196:199], v[220:223], v[56:59], v[196:199]
  s_waitcnt lgkmcnt(5)
  v_mfma_f32_16x16x32_bf16 v[184:187], v[224:227], v[36:39], v[184:187]
  ds_read_b128 v[216:219], v254 offset:28672
  v_mfma_f32_16x16x32_bf16 v[192:195], v[224:227], v[60:63], v[192:195]
  s_waitcnt lgkmcnt(5)
  v_mfma_f32_16x16x32_bf16 v[188:191], v[228:231], v[36:39], v[188:191]
  ds_read_b128 v[220:223], v254 offset:29696
  v_mfma_f32_16x16x32_bf16 v[196:199], v[228:231], v[60:63], v[196:199]
  s_waitcnt lgkmcnt(5)
  v_mfma_f32_16x16x32_bf16 v[168:171], v[200:203], v[16:19], 0
  ds_read_b128 v[224:227], v254 offset:30720
  v_mfma_f32_16x16x32_bf16 v[176:179], v[200:203], v[40:43], 0
  s_waitcnt lgkmcnt(5)
  v_mfma_f32_16x16x32_bf16 v[172:175], v[204:207], v[16:19], 0
  ds_read_b128 v[228:231], v254 offset:31744
  v_cvt_pk_bf16_f32 v124, v184, v185
  v_mfma_f32_16x16x32_bf16 v[180:183], v[204:207], v[40:43], 0
  s_waitcnt lgkmcnt(5)
  v_cvt_pk_bf16_f32 v125, v186, v187
  v_cvt_pk_bf16_f32 v126, v188, v189
  v_mfma_f32_16x16x32_bf16 v[168:171], v[208:211], v[20:23], v[168:171]
  ds_read_b128 v[200:203], v254 offset:32768
  v_cvt_pk_bf16_f32 v127, v190, v191
  v_mfma_f32_16x16x32_bf16 v[176:179], v[208:211], v[44:47], v[176:179]
  s_waitcnt lgkmcnt(5)
  v_cvt_pk_bf16_f32 v148, v192, v193
  v_cvt_pk_bf16_f32 v149, v194, v195
  v_mfma_f32_16x16x32_bf16 v[172:175], v[212:215], v[20:23], v[172:175]
  ds_read_b128 v[204:207], v254 offset:33792
  v_cvt_pk_bf16_f32 v150, v196, v197
  v_mfma_f32_16x16x32_bf16 v[180:183], v[212:215], v[44:47], v[180:183]
  s_waitcnt lgkmcnt(5)
  v_cvt_pk_bf16_f32 v151, v198, v199
  v_mfma_f32_16x16x32_bf16 v[168:171], v[216:219], v[24:27], v[168:171]
  ds_read_b128 v[208:211], v254 offset:34816
  v_mfma_f32_16x16x32_bf16 v[176:179], v[216:219], v[48:51], v[176:179]
  s_waitcnt lgkmcnt(5)
  v_mfma_f32_16x16x32_bf16 v[172:175], v[220:223], v[24:27], v[172:175]
  ds_read_b128 v[212:215], v254 offset:35840
  v_mfma_f32_16x16x32_bf16 v[180:183], v[220:223], v[48:51], v[180:183]
  s_waitcnt lgkmcnt(5)
  v_mfma_f32_16x16x32_bf16 v[168:171], v[224:227], v[28:31], v[168:171]
  ds_read_b128 v[216:219], v254 offset:36864
  v_mfma_f32_16x16x32_bf16 v[176:179], v[224:227], v[52:55], v[176:179]
  s_waitcnt lgkmcnt(5)
  v_mfma_f32_16x16x32_bf16 v[172:175], v[228:231], v[28:31], v[172:175]
  ds_read_b128 v[220:223], v254 offset:37888
  v_mfma_f32_16x16x32_bf16 v[180:183], v[228:231], v[52:55], v[180:183]
  s_waitcnt lgkmcnt(5)
  v_mfma_f32_16x16x32_bf16 v[168:171], v[200:203], v[32:35], v[168:171]
  ds_read_b128 v[224:227], v254 offset:38912
  v_mfma_f32_16x16x32_bf16 v[176:179], v[200:203], v[56:59], v[176:179]
  s_waitcnt lgkmcnt(5)
  v_mfma_f32_16x16x32_bf16 v[172:175], v[204:207], v[32:35], v[172:175]
  ds_read_b128 v[228:231], v254 offset:39936
  v_mfma_f32_16x16x32_bf16 v[180:183], v[204:207], v[56:59], v[180:183]
  s_waitcnt lgkmcnt(5)
  v_mfma_f32_16x16x32_bf16 v[168:171], v[208:211], v[36:39], v[168:171]
  ds_read_b128 v[200:203], v254 offset:40960
  v_mfma_f32_16x16x32_bf16 v[176:179], v[208:211], v[60:63], v[176:179]
  s_waitcnt lgkmcnt(5)
  v_mfma_f32_16x16x32_bf16 v[172:175], v[212:215], v[36:39], v[172:175]
  ds_read_b128 v[204:207], v254 offset:41984
  v_mfma_f32_16x16x32_bf16 v[180:183], v[212:215], v[60:63], v[180:183]
  s_barrier
  s_waitcnt lgkmcnt(5)
  v_mfma_f32_16x16x32_bf16 v[184:187], v[216:219], v[16:19], 0
  ds_read_b128 v[208:211], v254 offset:43008
  s_add_u32 m0, s101, 0
  s_nop 0
  buffer_load_dwordx4 v232, s[16:19], s100 offen lds
  v_mfma_f32_16x16x32_bf16 v[192:195], v[216:219], v[40:43], 0
  s_waitcnt lgkmcnt(5)
  s_add_u32 m0, s101, 1024
  s_nop 0
  buffer_load_dwordx4 v233, s[16:19], s100 offen lds
  s_add_u32 m0, s101, 2048
  s_nop 0
  buffer_load_dwordx4 v234, s[16:19], s100 offen lds
  v_mfma_f32_16x16x32_bf16 v[188:191], v[220:223], v[16:19], 0
  ds_read_b128 v[212:215], v254 offset:44032
  v_cvt_pk_bf16_f32 v128, v168, v169
  v_mfma_f32_16x16x32_bf16 v[196:199], v[220:223], v[40:43], 0
  s_waitcnt lgkmcnt(5)
  v_cvt_pk_bf16_f32 v129, v170, v171
  v_cvt_pk_bf16_f32 v130, v172, v173
  v_mfma_f32_16x16x32_bf16 v[184:187], v[224:227], v[20:23], v[184:187]
  ds_read_b128 v[216:219], v254 offset:45056
  v_cvt_pk_bf16_f32 v131, v174, v175
  v_mfma_f32_16x16x32_bf16 v[192:195], v[224:227], v[44:47], v[192:195]
  s_waitcnt lgkmcnt(5)
  v_cvt_pk_bf16_f32 v152, v176, v177
  v_cvt_pk_bf16_f32 v153, v178, v179
  v_mfma_f32_16x16x32_bf16 v[188:191], v[228:231], v[20:23], v[188:191]
  ds_read_b128 v[220:223], v254 offset:46080
  v_cvt_pk_bf16_f32 v154, v180, v181
  v_mfma_f32_16x16x32_bf16 v[196:199], v[228:231], v[44:47], v[196:199]
  s_waitcnt lgkmcnt(5)
  v_cvt_pk_bf16_f32 v155, v182, v183
  s_add_u32 m0, s101, 3072
  s_nop 0
  buffer_load_dwordx4 v235, s[16:19], s100 offen lds
  v_mfma_f32_16x16x32_bf16 v[184:187], v[200:203], v[24:27], v[184:187]
  ds_read_b128 v[224:227], v254 offset:47104
  s_add_u32 m0, s101, 4096
  s_nop 0
  buffer_load_dwordx4 v236, s[16:19], s100 offen lds
  v_mfma_f32_16x16x32_bf16 v[192:195], v[200:203], v[48:51], v[192:195]
  s_waitcnt lgkmcnt(5)
  s_add_u32 m0, s101, 5120
  s_nop 0
  buffer_load_dwordx4 v237, s[16:19], s100 offen lds
  s_add_u32 m0, s101, 6144
  s_nop 0
  buffer_load_dwordx4 v238, s[16:19], s100 offen lds
  v_mfma_f32_16x16x32_bf16 v[188:191], v[204:207], v[24:27], v[188:191]
  ds_read_b128 v[228:231], v254 offset:48128
  s_add_u32 m0, s101, 6656
  s_nop 0
  buffer_load_dwordx4 v239, s[16:19], s100 offen lds
  v_mfma_f32_16x16x32_bf16 v[196:199], v[204:207], v[48:51], v[196:199]
  s_waitcnt lgkmcnt(5)
  v_mfma_f32_16x16x32_bf16 v[184:187], v[208:211], v[28:31], v[184:187]
  ds_read_b128 v[200:203], v254 offset:49152
  v_mfma_f32_16x16x32_bf16 v[192:195], v[208:211], v[52:55], v[192:195]
  s_waitcnt lgkmcnt(5)
  v_mfma_f32_16x16x32_bf16 v[188:191], v[212:215], v[28:31], v[188:191]
  ds_read_b128 v[204:207], v254 offset:50176
  v_mfma_f32_16x16x32_bf16 v[196:199], v[212:215], v[52:55], v[196:199]
  s_waitcnt lgkmcnt(5)
  v_mfma_f32_16x16x32_bf16 v[184:187], v[216:219], v[32:35], v[184:187]
  ds_read_b128 v[208:211], v254 offset:51200
  v_mfma_f32_16x16x32_bf16 v[192:195], v[216:219], v[56:59], v[192:195]
  s_waitcnt lgkmcnt(5)
  v_mfma_f32_16x16x32_bf16 v[188:191], v[220:223], v[32:35], v[188:191]
  ds_read_b128 v[212:215], v254 offset:52224
  v_mfma_f32_16x16x32_bf16 v[196:199], v[220:223], v[56:59], v[196:199]
  s_waitcnt lgkmcnt(5)
  v_mfma_f32_16x16x32_bf16 v[184:187], v[224:227], v[36:39], v[184:187]
  ds_read_b128 v[216:219], v254 offset:53248
  v_mfma_f32_16x16x32_bf16 v[192:195], v[224:227], v[60:63], v[192:195]
  s_waitcnt lgkmcnt(5)
  v_mfma_f32_16x16x32_bf16 v[188:191], v[228:231], v[36:39], v[188:191]
  ds_read_b128 v[220:223], v254 offset:54272
  v_mfma_f32_16x16x32_bf16 v[196:199], v[228:231], v[60:63], v[196:199]
  s_waitcnt lgkmcnt(5)
  v_mfma_f32_16x16x32_bf16 v[168:171], v[200:203], v[16:19], 0
  ds_read_b128 v[224:227], v254 offset:55296
  v_mfma_f32_16x16x32_bf16 v[176:179], v[200:203], v[40:43], 0
  s_waitcnt lgkmcnt(5)
  ds_read_b128 v[232:235], v254 offset:61440
  v_mfma_f32_16x16x32_bf16 v[172:175], v[204:207], v[16:19], 0
  ds_read_b128 v[228:231], v254 offset:56320
  v_cvt_pk_bf16_f32 v132, v184, v185
  v_mfma_f32_16x16x32_bf16 v[180:183], v[204:207], v[40:43], 0
  s_waitcnt lgkmcnt(6)
  ds_read_b128 v[236:239], v254 offset:62464
  v_cvt_pk_bf16_f32 v133, v186, v187
  v_mfma_f32_16x16x32_bf16 v[168:171], v[208:211], v[20:23], v[168:171]
  ds_read_b128 v[200:203], v254 offset:57344
  v_cvt_pk_bf16_f32 v134, v188, v189
  v_mfma_f32_16x16x32_bf16 v[176:179], v[208:211], v[44:47], v[176:179]
  s_waitcnt lgkmcnt(7)
  v_cvt_pk_bf16_f32 v135, v190, v191
  v_cvt_pk_bf16_f32 v156, v192, v193
  v_mfma_f32_16x16x32_bf16 v[172:175], v[212:215], v[20:23], v[172:175]
  ds_read_b128 v[204:207], v254 offset:58368
  v_cvt_pk_bf16_f32 v157, v194, v195
  v_mfma_f32_16x16x32_bf16 v[180:183], v[212:215], v[44:47], v[180:183]
  s_waitcnt lgkmcnt(7)
  v_cvt_pk_bf16_f32 v158, v196, v197
  v_cvt_pk_bf16_f32 v159, v198, v199
  v_mfma_f32_16x16x32_bf16 v[168:171], v[216:219], v[24:27], v[168:171]
  ds_read_b128 v[208:211], v254 offset:59392
  v_mfma_f32_16x16x32_bf16 v[176:179], v[216:219], v[48:51], v[176:179]
  s_waitcnt lgkmcnt(7)
  v_mfma_f32_16x16x32_bf16 v[172:175], v[220:223], v[24:27], v[172:175]
  ds_read_b128 v[212:215], v254 offset:60416
  v_mfma_f32_16x16x32_bf16 v[180:183], v[220:223], v[48:51], v[180:183]
  s_waitcnt lgkmcnt(7)
  v_mfma_f32_16x16x32_bf16 v[168:171], v[224:227], v[28:31], v[168:171]
  v_mfma_f32_16x16x32_bf16 v[176:179], v[224:227], v[52:55], v[176:179]
  s_waitcnt lgkmcnt(5)
  v_mfma_f32_16x16x32_bf16 v[172:175], v[228:231], v[28:31], v[172:175]
  v_mfma_f32_16x16x32_bf16 v[180:183], v[228:231], v[52:55], v[180:183]
  s_waitcnt lgkmcnt(3)
  v_mfma_f32_16x16x32_bf16 v[168:171], v[200:203], v[32:35], v[168:171]
  ds_read_b128 v[224:227], v253 offset:0
  v_mfma_f32_16x16x32_bf16 v[176:179], v[200:203], v[56:59], v[176:179]
  s_waitcnt lgkmcnt(3)
  v_mfma_f32_16x16x32_bf16 v[172:175], v[204:207], v[32:35], v[172:175]
  ds_read_b128 v[228:231], v253 offset:1024
  v_mfma_f32_16x16x32_bf16 v[180:183], v[204:207], v[56:59], v[180:183]
  s_waitcnt lgkmcnt(3)
  v_mfma_f32_16x16x32_bf16 v[168:171], v[208:211], v[36:39], v[168:171]
  ds_read_b128 v[200:203], v253 offset:2048
  v_mfma_f32_16x16x32_bf16 v[176:179], v[208:211], v[60:63], v[176:179]
  s_waitcnt lgkmcnt(3)
  v_mfma_f32_16x16x32_bf16 v[172:175], v[212:215], v[36:39], v[172:175]
  ds_read_b128 v[204:207], v253 offset:3072
  v_mfma_f32_16x16x32_bf16 v[180:183], v[212:215], v[60:63], v[180:183]
  s_waitcnt vmcnt(0)
  s_barrier
  s_setprio 2
  s_cmp_lt_u32 s40, 4
  s_cbranch_scc1 M_pr1
  s_setprio 3
M_pr1:
  v_mfma_f32_16x16x32_bf16 v[184:187], v[232:235], v[16:19], 0
  ds_read_b128 v[208:211], v253 offset:4096
  v_mfma_f32_16x16x32_bf16 v[192:195], v[232:235], v[40:43], 0
  v_mfma_f32_16x16x32_bf16 v[188:191], v[236:239], v[16:19], 0
  ds_read_b128 v[212:215], v253 offset:5120
  v_cvt_pk_bf16_f32 v136, v168, v169
  v_mfma_f32_16x16x32_bf16 v[196:199], v[236:239], v[40:43], 0
  s_waitcnt lgkmcnt(5)
  v_cvt_pk_bf16_f32 v137, v170, v171
  v_cvt_pk_bf16_f32 v138, v172, v173
  v_mfma_f32_16x16x32_bf16 v[184:187], v[224:227], v[20:23], v[184:187]
  ds_read_b128 v[216:219], v253 offset:6144
  v_cvt_pk_bf16_f32 v139, v174, v175
  v_mfma_f32_16x16x32_bf16 v[192:195], v[224:227], v[44:47], v[192:195]
  s_waitcnt lgkmcnt(5)
  v_cvt_pk_bf16_f32 v160, v176, v177
  v_cvt_pk_bf16_f32 v161, v178, v179
  v_mfma_f32_16x16x32_bf16 v[188:191], v[228:231], v[20:23], v[188:191]
  ds_read_b128 v[220:223], v253 offset:7168
  v_cvt_pk_bf16_f32 v162, v180, v181
  v_mfma_f32_16x16x32_bf16 v[196:199], v[228:231], v[44:47], v[196:199]
  s_waitcnt lgkmcnt(5)
  v_cvt_pk_bf16_f32 v163, v182, v183
  v_mfma_f32_16x16x32_bf16 v[184:187], v[200:203], v[24:27], v[184:187]
  ds_read_b128 v[224:227], v253 offset:8192
  v_mfma_f32_16x16x32_bf16 v[192:195], v[200:203], v[48:51], v[192:195]
  s_waitcnt lgkmcnt(5)
  v_mfma_f32_16x16x32_bf16 v[188:191], v[204:207], v[24:27], v[188:191]
  ds_read_b128 v[228:231], v253 offset:9216
  v_mfma_f32_16x16x32_bf16 v[196:199], v[204:207], v[48:51], v[196:199]
  s_waitcnt lgkmcnt(5)
  v_mfma_f32_16x16x32_bf16 v[184:187], v[208:211], v[28:31], v[184:187]
  v_mfma_f32_16x16x32_bf16 v[192:195], v[208:211], v[52:55], v[192:195]
  s_waitcnt lgkmcnt(4)
  v_mfma_f32_16x16x32_bf16 v[188:191], v[212:215], v[28:31], v[188:191]
  v_mfma_f32_16x16x32_bf16 v[196:199], v[212:215], v[52:55], v[196:199]
  s_waitcnt lgkmcnt(3)
  v_mfma_f32_16x16x32_bf16 v[184:187], v[216:219], v[32:35], v[184:187]
  v_mfma_f32_16x16x32_bf16 v[192:195], v[216:219], v[56:59], v[192:195]
  s_waitcnt lgkmcnt(2)
  v_mfma_f32_16x16x32_bf16 v[188:191], v[220:223], v[32:35], v[188:191]
  v_mfma_f32_16x16x32_bf16 v[196:199], v[220:223], v[56:59], v[196:199]
  s_waitcnt lgkmcnt(1)
  v_mfma_f32_16x16x32_bf16 v[184:187], v[224:227], v[36:39], v[184:187]
  v_mfma_f32_16x16x32_bf16 v[192:195], v[224:227], v[60:63], v[192:195]
  s_waitcnt lgkmcnt(0)
  v_mfma_f32_16x16x32_bf16 v[188:191], v[228:231], v[36:39], v[188:191]
  v_mfma_f32_16x16x32_bf16 v[196:199], v[228:231], v[60:63], v[196:199]
  s_cmp_ge_u32 s40, 4
  s_cbranch_scc1 M_l1
  s_barrier
M_l1:
  ds_read_b128 v[200:203], v240 offset:0
  ds_read_b128 v[204:207], v240 offset:2304
  ds_read_b128 v[208:211], v241 offset:0
  ds_read_b128 v[212:215], v241 offset:2304
  ds_read_b128 v[216:219], v242 offset:0
  ds_read_b128 v[220:223], v242 offset:2304
  ds_read_b128 v[224:227], v243 offset:0
  v_cvt_pk_bf16_f32 v140, v184, v185
  v_cvt_pk_bf16_f32 v141, v186, v187
  v_cvt_pk_bf16_f32 v142, v188, v189
  v_cvt_pk_bf16_f32 v143, v190, v191
  v_cvt_pk_bf16_f32 v164, v192, v193
  v_cvt_pk_bf16_f32 v165, v194, v195
  v_cvt_pk_bf16_f32 v166, v196, v197
  v_cvt_pk_bf16_f32 v167, v198, v199
  s_mov_b32 s56, 0xff7fffff
  s_waitcnt lgkmcnt(6)
  v_mfma_f32_16x16x32_bf16 v[64:67], v[200:203], v[120:123], v[64:67]
  s_waitcnt lgkmcnt(5)
  ds_read_b128 v[228:231], v243 offset:2304
  v_mov_b32 v30, 0
  v_mfma_f32_16x16x32_bf16 v[76:79], v[204:207], v[120:123], v[76:79]
  v_mov_b32 v31, 0
  v_mov_b32 v32, 0
  v_mfma_f32_16x16x32_bf16 v[92:95], v[204:207], v[144:147], v[92:95]
  s_waitcnt lgkmcnt(5)
  ds_read_b128 v[200:203], v240 offset:256
  v_mov_b32 v33, 0
  v_mfma_f32_16x16x32_bf16 v[64:67], v[208:211], v[124:127], v[64:67]
  s_waitcnt lgkmcnt(5)
  ds_read_b128 v[204:207], v240 offset:2560
  v_mov_b32 v48, 0x3f803f80
  v_mfma_f32_16x16x32_bf16 v[76:79], v[212:215], v[124:127], v[76:79]
  v_mov_b32 v49, 0x3f803f80
  v_mov_b32 v50, 0x3f803f80
  v_mfma_f32_16x16x32_bf16 v[92:95], v[212:215], v[148:151], v[92:95]
  s_waitcnt lgkmcnt(5)
  ds_read_b128 v[208:211], v241 offset:256
  v_mov_b32 v51, 0x3f803f80
  v_mfma_f32_16x16x32_bf16 v[64:67], v[216:219], v[128:131], v[64:67]
  s_waitcnt lgkmcnt(5)
  ds_read_b128 v[212:215], v241 offset:2560
  v_mfma_f32_16x16x32_bf16 v[76:79], v[220:223], v[128:131], v[76:79]
  v_mfma_f32_16x16x32_bf16 v[92:95], v[220:223], v[152:155], v[92:95]
  s_waitcnt lgkmcnt(5)
  ds_read_b128 v[216:219], v240 offset:768
  v_mfma_f32_16x16x32_bf16 v[64:67], v[224:227], v[132:135], v[64:67]
  s_waitcnt lgkmcnt(5)
  ds_read_b128 v[220:223], v240 offset:3072
  v_mfma_f32_16x16x32_bf16 v[76:79], v[228:231], v[132:135], v[76:79]
  v_mfma_f32_16x16x32_bf16 v[92:95], v[228:231], v[156:159], v[92:95]
  s_waitcnt lgkmcnt(5)
  ds_read_b128 v[224:227], v241 offset:768
  v_mfma_f32_16x16x32_bf16 v[64:67], v[200:203], v[136:139], v[64:67]
  s_waitcnt lgkmcnt(5)
  ds_read_b128 v[228:231], v241 offset:3072
  v_mfma_f32_16x16x32_bf16 v[76:79], v[204:207], v[136:139], v[76:79]
  v_mfma_f32_16x16x32_bf16 v[92:95], v[204:207], v[160:163], v[92:95]
  s_waitcnt lgkmcnt(5)
  ds_read_b128 v[200:203], v242 offset:768
  v_mfma_f32_16x16x32_bf16 v[64:67], v[208:211], v[140:143], v[64:67]
  s_waitcnt lgkmcnt(5)
  ds_read_b128 v[204:207], v242 offset:3072
  v_mfma_f32_16x16x32_bf16 v[76:79], v[212:215], v[140:143], v[76:79]
  v_mfma_f32_16x16x32_bf16 v[92:95], v[212:215], v[164:167], v[92:95]
  s_waitcnt lgkmcnt(5)
  ds_read_b128 v[208:211], v243 offset:768
  v_mfma_f32_16x16x32_bf16 v[68:71], v[216:219], v[120:123], v[68:71]
  s_waitcnt lgkmcnt(5)
  ds_read_b128 v[212:215], v243 offset:3072
  v_mfma_f32_16x16x32_bf16 v[80:83], v[220:223], v[120:123], v[80:83]
  v_max3_f32 v12, v64, v65, s56
  v_max3_f32 v12, v66, v67, v12
  v_mfma_f32_16x16x32_bf16 v[96:99], v[220:223], v[144:147], v[96:99]
  s_waitcnt lgkmcnt(5)
  ds_read_b128 v[216:219], v240 offset:1024
  v_max3_f32 v12, v76, v77, v12
  v_mfma_f32_16x16x32_bf16 v[68:71], v[224:227], v[124:127], v[68:71]
  s_waitcnt lgkmcnt(5)
  ds_read_b128 v[220:223], v240 offset:3328
  v_max3_f32 v12, v78, v79, v12
  v_mfma_f32_16x16x32_bf16 v[80:83], v[228:231], v[124:127], v[80:83]
  v_max3_f32 v13, v92, v93, s56
  v_max3_f32 v13, v94, v95, v13
  v_mfma_f32_16x16x32_bf16 v[96:99], v[228:231], v[148:151], v[96:99]
  s_waitcnt lgkmcnt(5)
  ds_read_b128 v[224:227], v241 offset:1024
  v_mfma_f32_16x16x32_bf16 v[68:71], v[200:203], v[128:131], v[68:71]
  s_waitcnt lgkmcnt(5)
  ds_read_b128 v[228:231], v241 offset:3328
  v_mfma_f32_16x16x32_bf16 v[80:83], v[204:207], v[128:131], v[80:83]
  v_mfma_f32_16x16x32_bf16 v[96:99], v[204:207], v[152:155], v[96:99]
  s_waitcnt lgkmcnt(5)
  ds_read_b128 v[200:203], v240 offset:1536
  v_mfma_f32_16x16x32_bf16 v[68:71], v[208:211], v[132:135], v[68:71]
  s_waitcnt lgkmcnt(5)
  ds_read_b128 v[204:207], v240 offset:3840
  v_mfma_f32_16x16x32_bf16 v[80:83], v[212:215], v[132:135], v[80:83]
  v_mfma_f32_16x16x32_bf16 v[96:99], v[212:215], v[156:159], v[96:99]
  s_waitcnt lgkmcnt(5)
  ds_read_b128 v[208:211], v241 offset:1536
  v_mfma_f32_16x16x32_bf16 v[68:71], v[216:219], v[136:139], v[68:71]
  s_waitcnt lgkmcnt(5)
  ds_read_b128 v[212:215], v241 offset:3840
  v_mfma_f32_16x16x32_bf16 v[80:83], v[220:223], v[136:139], v[80:83]
  v_mfma_f32_16x16x32_bf16 v[96:99], v[220:223], v[160:163], v[96:99]
  s_waitcnt lgkmcnt(5)
  ds_read_b128 v[216:219], v242 offset:1536
  v_mfma_f32_16x16x32_bf16 v[68:71], v[224:227], v[140:143], v[68:71]
  s_waitcnt lgkmcnt(5)
  ds_read_b128 v[220:223], v242 offset:3840
  v_mfma_f32_16x16x32_bf16 v[80:83], v[228:231], v[140:143], v[80:83]
  v_mfma_f32_16x16x32_bf16 v[96:99], v[228:231], v[164:167], v[96:99]
  s_waitcnt lgkmcnt(5)
  ds_read_b128 v[224:227], v243 offset:1536
  v_mfma_f32_16x16x32_bf16 v[72:75], v[200:203], v[120:123], v[72:75]
  s_waitcnt lgkmcnt(5)
  ds_read_b128 v[228:231], v243 offset:3840
  v_mfma_f32_16x16x32_bf16 v[84:87], v[204:207], v[120:123], v[84:87]
  v_max3_f32 v12, v68, v69, v12
  v_max3_f32 v12, v70, v71, v12
  v_mfma_f32_16x16x32_bf16 v[100:103], v[204:207], v[144:147], v[100:103]
  s_waitcnt lgkmcnt(5)
  ds_read_b128 v[200:203], v240 offset:1792
  v_max3_f32 v12, v80, v81, v12
  v_mfma_f32_16x16x32_bf16 v[72:75], v[208:211], v[124:127], v[72:75]
  s_waitcnt lgkmcnt(5)
  ds_read_b128 v[204:207], v240 offset:4096
  v_max3_f32 v12, v82, v83, v12
  v_mfma_f32_16x16x32_bf16 v[84:87], v[212:215], v[124:127], v[84:87]
  v_max3_f32 v13, v96, v97, v13
  v_max3_f32 v13, v98, v99, v13
  v_mfma_f32_16x16x32_bf16 v[100:103], v[212:215], v[148:151], v[100:103]
  s_waitcnt lgkmcnt(5)
  ds_read_b128 v[208:211], v241 offset:1792
  v_mfma_f32_16x16x32_bf16 v[72:75], v[216:219], v[128:131], v[72:75]
  s_waitcnt lgkmcnt(5)
  ds_read_b128 v[212:215], v241 offset:4096
  v_mfma_f32_16x16x32_bf16 v[84:87], v[220:223], v[128:131], v[84:87]
  v_mfma_f32_16x16x32_bf16 v[100:103], v[220:223], v[152:155], v[100:103]
  s_waitcnt lgkmcnt(5)
  ds_read_b128 v[216:219], v240 offset:5376
  v_mfma_f32_16x16x32_bf16 v[72:75], v[224:227], v[132:135], v[72:75]
  s_waitcnt lgkmcnt(5)
  ds_read_b128 v[220:223], v240 offset:4608
  v_mfma_f32_16x16x32_bf16 v[84:87], v[228:231], v[132:135], v[84:87]
  v_mfma_f32_16x16x32_bf16 v[100:103], v[228:231], v[156:159], v[100:103]
  s_waitcnt lgkmcnt(5)
  ds_read_b128 v[224:227], v241 offset:5376
  v_mfma_f32_16x16x32_bf16 v[72:75], v[200:203], v[136:139], v[72:75]
  s_waitcnt lgkmcnt(5)
  ds_read_b128 v[228:231], v241 offset:4608
  v_mfma_f32_16x16x32_bf16 v[84:87], v[204:207], v[136:139], v[84:87]
  v_mfma_f32_16x16x32_bf16 v[100:103], v[204:207], v[160:163], v[100:103]
  s_waitcnt lgkmcnt(5)
  ds_read_b128 v[200:203], v242 offset:5376
  v_mfma_f32_16x16x32_bf16 v[72:75], v[208:211], v[140:143], v[72:75]
  s_waitcnt lgkmcnt(5)
  ds_read_b128 v[204:207], v242 offset:4608
  v_mfma_f32_16x16x32_bf16 v[84:87], v[212:215], v[140:143], v[84:87]
  v_mfma_f32_16x16x32_bf16 v[100:103], v[212:215], v[164:167], v[100:103]
  s_waitcnt lgkmcnt(5)
  ds_read_b128 v[208:211], v243 offset:5376
  v_mfma_f32_16x16x32_bf16 v[108:111], v[216:219], v[144:147], v[108:111]
  s_waitcnt lgkmcnt(5)
  ds_read_b128 v[212:215], v243 offset:4608
  v_mfma_f32_16x16x32_bf16 v[88:91], v[220:223], v[120:123], v[88:91]
  v_max3_f32 v12, v72, v73, v12
  v_max3_f32 v12, v74, v75, v12
  v_mfma_f32_16x16x32_bf16 v[104:107], v[220:223], v[144:147], v[104:107]
  s_waitcnt lgkmcnt(5)
  ds_read_b128 v[216:219], v240 offset:5632
  v_max3_f32 v12, v84, v85, v12
  v_mfma_f32_16x16x32_bf16 v[108:111], v[224:227], v[148:151], v[108:111]
  s_waitcnt lgkmcnt(5)
  ds_read_b128 v[220:223], v240 offset:4864
  v_max3_f32 v12, v86, v87, v12
  v_mfma_f32_16x16x32_bf16 v[88:91], v[228:231], v[124:127], v[88:91]
  v_max3_f32 v13, v100, v101, v13
  v_max3_f32 v13, v102, v103, v13
  v_mfma_f32_16x16x32_bf16 v[104:107], v[228:231], v[148:151], v[104:107]
  s_waitcnt lgkmcnt(5)
  ds_read_b128 v[224:227], v241 offset:5632
  v_mfma_f32_16x16x32_bf16 v[108:111], v[200:203], v[152:155], v[108:111]
  s_waitcnt lgkmcnt(5)
  ds_read_b128 v[228:231], v241 offset:4864
  v_mfma_f32_16x16x32_bf16 v[88:91], v[204:207], v[128:131], v[88:91]
  v_mfma_f32_16x16x32_bf16 v[104:107], v[204:207], v[152:155], v[104:107]
  s_waitcnt lgkmcnt(5)
  ds_read_b128 v[200:203], v240 offset:6144
  v_mfma_f32_16x16x32_bf16 v[108:111], v[208:211], v[156:159], v[108:111]
  s_waitcnt lgkmcnt(5)
  ds_read_b128 v[204:207], v240 offset:6912
  v_mfma_f32_16x16x32_bf16 v[88:91], v[212:215], v[132:135], v[88:91]
  v_mfma_f32_16x16x32_bf16 v[104:107], v[212:215], v[156:159], v[104:107]
  s_waitcnt lgkmcnt(5)
  ds_read_b128 v[208:211], v241 offset:6144
  v_mfma_f32_16x16x32_bf16 v[108:111], v[216:219], v[160:163], v[108:111]
  s_waitcnt lgkmcnt(5)
  ds_read_b128 v[212:215], v241 offset:6912
  v_mfma_f32_16x16x32_bf16 v[88:91], v[220:223], v[136:139], v[88:91]
  v_mfma_f32_16x16x32_bf16 v[104:107], v[220:223], v[160:163], v[104:107]
  s_waitcnt lgkmcnt(5)
  ds_read_b128 v[216:219], v242 offset:6144
  v_mfma_f32_16x16x32_bf16 v[108:111], v[224:227], v[164:167], v[108:111]
  s_waitcnt lgkmcnt(5)
  ds_read_b128 v[220:223], v242 offset:6912
  v_mfma_f32_16x16x32_bf16 v[88:91], v[228:231], v[140:143], v[88:91]
  v_mfma_f32_16x16x32_bf16 v[104:107], v[228:231], v[164:167], v[104:107]
  s_waitcnt lgkmcnt(5)
  ds_read_b128 v[224:227], v243 offset:6144
  v_mfma_f32_16x16x32_bf16 v[112:115], v[200:203], v[144:147], v[112:115]
  s_waitcnt lgkmcnt(5)
  ds_read_b128 v[228:231], v243 offset:6912
  v_mfma_f32_16x16x32_bf16 v[116:119], v[204:207], v[144:147], v[116:119]
  s_waitcnt lgkmcnt(5)
  ds_read_b128 v[200:203], v240 offset:6400
  v_max3_f32 v13, v108, v109, v13
  v_mfma_f32_16x16x32_bf16 v[112:115], v[208:211], v[148:151], v[112:115]
  s_waitcnt lgkmcnt(5)
  ds_read_b128 v[204:207], v240 offset:7168
  v_max3_f32 v13, v110, v111, v13
  v_mfma_f32_16x16x32_bf16 v[116:119], v[212:215], v[148:151], v[116:119]
  s_waitcnt lgkmcnt(5)
  ds_read_b128 v[208:211], v241 offset:6400
  v_max3_f32 v12, v88, v89, v12
  v_mfma_f32_16x16x32_bf16 v[112:115], v[216:219], v[152:155], v[112:115]
  s_waitcnt lgkmcnt(5)
  ds_read_b128 v[212:215], v241 offset:7168
  v_max3_f32 v12, v90, v91, v12
  v_mfma_f32_16x16x32_bf16 v[116:119], v[220:223], v[152:155], v[116:119]
  s_waitcnt lgkmcnt(5)
  v_max3_f32 v13, v104, v105, v13
  v_max3_f32 v13, v106, v107, v13
  v_mfma_f32_16x16x32_bf16 v[112:115], v[224:227], v[156:159], v[112:115]
  s_waitcnt lgkmcnt(4)
  v_mov_b32 v14, v12
  s_nop 1
  v_permlane32_swap_b32 v12, v14
  v_mfma_f32_16x16x32_bf16 v[116:119], v[228:231], v[156:159], v[116:119]
  s_waitcnt lgkmcnt(3)
  v_max_f32 v12, v12, v14
  v_mfma_f32_16x16x32_bf16 v[112:115], v[200:203], v[160:163], v[112:115]
  s_waitcnt lgkmcnt(2)
  v_mfma_f32_16x16x32_bf16 v[116:119], v[204:207], v[160:163], v[116:119]
  s_waitcnt lgkmcnt(1)
  v_mov_b32 v14, v12
  v_mfma_f32_16x16x32_bf16 v[112:115], v[208:211], v[164:167], v[112:115]
  s_waitcnt lgkmcnt(0)
  v_mfma_f32_16x16x32_bf16 v[116:119], v[212:215], v[164:167], v[116:119]
  v_permlane16_swap_b32 v12, v14
  s_setprio 0
  s_cmp_lt_u32 s40, 4
  s_cbranch_scc1 M_pr2
  s_setprio 1
M_pr2:
  v_max_f32 v12, v12, v14
  v_mul_f32 v12, s63, v12
  v_max3_f32 v13, v112, v113, v13
  v_max3_f32 v13, v114, v115, v13
  v_max3_f32 v13, v116, v117, v13
  v_max3_f32 v13, v118, v119, v13
  v_mov_b32 v15, v13
  s_nop 1
  v_permlane32_swap_b32 v13, v15
  v_max_f32 v13, v13, v15
  v_mov_b32 v15, v13
  s_nop 1
  v_permlane16_swap_b32 v13, v15
  v_max_f32 v13, v13, v15
  v_mul_f32 v13, s63, v13
  v_fma_f32 v64, v64, s63, -v12
  v_fma_f32 v65, v65, s63, -v12
  v_fma_f32 v66, v66, s63, -v12
  v_fma_f32 v67, v67, s63, -v12
  v_exp_f32 v64, v64
  v_exp_f32 v65, v65
  v_exp_f32 v66, v66
  v_exp_f32 v67, v67
  v_fma_f32 v92, v92, s63, -v13
  v_fma_f32 v93, v93, s63, -v13
  v_fma_f32 v94, v94, s63, -v13
  v_fma_f32 v95, v95, s63, -v13
  v_exp_f32 v92, v92
  v_exp_f32 v93, v93
  v_exp_f32 v94, v94
  v_exp_f32 v95, v95
  v_cvt_pk_bf16_f32 v16, v64, v65
  v_cvt_pk_bf16_f32 v17, v66, v67
  v_cvt_pk_bf16_f32 v34, v92, v93
  v_cvt_pk_bf16_f32 v35, v94, v95
  v_fma_f32 v68, v68, s63, -v12
  v_fma_f32 v69, v69, s63, -v12
  v_fma_f32 v70, v70, s63, -v12
  v_fma_f32 v71, v71, s63, -v12
  v_exp_f32 v68, v68
  v_exp_f32 v69, v69
  v_exp_f32 v70, v70
  v_exp_f32 v71, v71
  v_fma_f32 v96, v96, s63, -v13
  v_fma_f32 v97, v97, s63, -v13
  v_fma_f32 v98, v98, s63, -v13
  v_fma_f32 v99, v99, s63, -v13
  v_exp_f32 v96, v96
  v_exp_f32 v97, v97
  v_exp_f32 v98, v98
  v_exp_f32 v99, v99
  v_cvt_pk_bf16_f32 v18, v68, v69
  v_cvt_pk_bf16_f32 v19, v70, v71
  v_cvt_pk_bf16_f32 v36, v96, v97
  v_cvt_pk_bf16_f32 v37, v98, v99
  s_cmp_lt_u32 s40, 4
  s_cbranch_scc1 M_e2
  s_barrier
M_e2:
  s_mov_b32 s55, 10240
  buffer_load_dwordx4 v[64:67], v252, s[24:27], s55 offen offset:0 sc1
  buffer_load_dwordx4 v[92:95], v252, s[24:27], s55 offen offset:1024 sc1
  buffer_load_dwordx4 v[68:71], v252, s[24:27], s55 offen offset:2048 sc1
  buffer_load_dwordx4 v[96:99], v252, s[24:27], s55 offen offset:3072 sc1
  v_fma_f32 v72, v72, s63, -v12
  v_fma_f32 v73, v73, s63, -v12
  v_fma_f32 v74, v74, s63, -v12
  v_fma_f32 v75, v75, s63, -v12
  v_exp_f32 v72, v72
  v_exp_f32 v73, v73
  v_exp_f32 v74, v74
  v_exp_f32 v75, v75
  v_fma_f32 v100, v100, s63, -v13
  v_fma_f32 v101, v101, s63, -v13
  v_fma_f32 v102, v102, s63, -v13
  v_fma_f32 v103, v103, s63, -v13
  v_exp_f32 v100, v100
  v_exp_f32 v101, v101
  v_exp_f32 v102, v102
  v_exp_f32 v103, v103
  v_cvt_pk_bf16_f32 v20, v72, v73
  v_cvt_pk_bf16_f32 v21, v74, v75
  v_cvt_pk_bf16_f32 v38, v100, v101
  v_cvt_pk_bf16_f32 v39, v102, v103
  s_mov_b32 s55, 14336
  buffer_load_dwordx4 v[72:75], v252, s[24:27], s55 offen offset:0 sc1
  buffer_load_dwordx4 v[100:103], v252, s[24:27], s55 offen offset:1024 sc1
  v_fma_f32 v76, v76, s63, -v12
  v_fma_f32 v77, v77, s63, -v12
  v_fma_f32 v78, v78, s63, -v12
  v_fma_f32 v79, v79, s63, -v12
  v_exp_f32 v76, v76
  v_exp_f32 v77, v77
  v_exp_f32 v78, v78
  v_exp_f32 v79, v79
  v_fma_f32 v104, v104, s63, -v13
  v_fma_f32 v105, v105, s63, -v13
  v_fma_f32 v106, v106, s63, -v13
  v_fma_f32 v107, v107, s63, -v13
  v_exp_f32 v104, v104
  v_exp_f32 v105, v105
  v_exp_f32 v106, v106
  v_exp_f32 v107, v107
  v_cvt_pk_bf16_f32 v22, v76, v77
  v_cvt_pk_bf16_f32 v23, v78, v79
  v_cvt_pk_bf16_f32 v40, v104, v105
  v_cvt_pk_bf16_f32 v41, v106, v107
  buffer_load_dwordx4 v[76:79], v252, s[24:27], s55 offen offset:2048 sc1
  buffer_load_dwordx4 v[104:107], v252, s[24:27], s55 offen offset:3072 sc1
  v_fma_f32 v80, v80, s63, -v12
  v_fma_f32 v81, v81, s63, -v12
  v_fma_f32 v82, v82, s63, -v12
  v_fma_f32 v83, v83, s63, -v12
  v_exp_f32 v80, v80
  v_exp_f32 v81, v81
  v_exp_f32 v82, v82
  v_exp_f32 v83, v83
  v_fma_f32 v108, v108, s63, -v13
  v_fma_f32 v109, v109, s63, -v13
  v_fma_f32 v110, v110, s63, -v13
  v_fma_f32 v111, v111, s63, -v13
  v_exp_f32 v108, v108
  v_exp_f32 v109, v109
  v_exp_f32 v110, v110
  v_exp_f32 v111, v111
  v_cvt_pk_bf16_f32 v24, v80, v81
  v_cvt_pk_bf16_f32 v25, v82, v83
  v_cvt_pk_bf16_f32 v42, v108, v109
  v_cvt_pk_bf16_f32 v43, v110, v111
  s_mov_b32 s55, 18432
  buffer_load_dwordx4 v[80:83], v252, s[24:27], s55 offen offset:0 sc1
  buffer_load_dwordx4 v[108:111], v252, s[24:27], s55 offen offset:1024 sc1
  v_fma_f32 v84, v84, s63, -v12
  v_fma_f32 v85, v85, s63, -v12
  v_fma_f32 v86, v86, s63, -v12
  v_fma_f32 v87, v87, s63, -v12
  v_exp_f32 v84, v84
  v_exp_f32 v85, v85
  v_exp_f32 v86, v86
  v_exp_f32 v87, v87
  v_fma_f32 v112, v112, s63, -v13
  v_fma_f32 v113, v113, s63, -v13
  v_fma_f32 v114, v114, s63, -v13
  v_fma_f32 v115, v115, s63, -v13
  v_exp_f32 v112, v112
  v_exp_f32 v113, v113
  v_exp_f32 v114, v114
  v_exp_f32 v115, v115
  v_cvt_pk_bf16_f32 v26, v84, v85
  v_cvt_pk_bf16_f32 v27, v86, v87
  v_cvt_pk_bf16_f32 v44, v112, v113
  v_cvt_pk_bf16_f32 v45, v114, v115
  buffer_load_dwordx4 v[84:87], v252, s[24:27], s55 offen offset:2048 sc1
  buffer_load_dwordx4 v[112:115], v252, s[24:27], s55 offen offset:3072 sc1
  ds_read_b64_tr_b16 v[200:201], v244 offset:0
  ds_read_b64_tr_b16 v[202:203], v244 offset:768
  ds_read_b64_tr_b16 v[204:205], v245 offset:0
  ds_read_b64_tr_b16 v[206:207], v245 offset:768
  ds_read_b64_tr_b16 v[208:209], v244 offset:1536
  ds_read_b64_tr_b16 v[210:211], v244 offset:2304
  ds_read_b64_tr_b16 v[212:213], v245 offset:1536
  ds_read_b64_tr_b16 v[214:215], v245 offset:2304
  ds_read_b64_tr_b16 v[216:217], v244 offset:3072
  ds_read_b64_tr_b16 v[218:219], v244 offset:3840
  ds_read_b64_tr_b16 v[220:221], v245 offset:3072
  ds_read_b64_tr_b16 v[222:223], v245 offset:3840
  v_fma_f32 v88, v88, s63, -v12
  v_fma_f32 v89, v89, s63, -v12
  v_fma_f32 v90, v90, s63, -v12
  v_fma_f32 v91, v91, s63, -v12
  v_exp_f32 v88, v88
  v_exp_f32 v89, v89
  v_exp_f32 v90, v90
  v_exp_f32 v91, v91
  v_fma_f32 v116, v116, s63, -v13
  v_fma_f32 v117, v117, s63, -v13
  v_fma_f32 v118, v118, s63, -v13
  v_fma_f32 v119, v119, s63, -v13
  v_exp_f32 v116, v116
  v_exp_f32 v117, v117
  v_exp_f32 v118, v118
  v_exp_f32 v119, v119
  v_cvt_pk_bf16_f32 v28, v88, v89
  v_cvt_pk_bf16_f32 v29, v90, v91
  v_cvt_pk_bf16_f32 v46, v116, v117
  v_cvt_pk_bf16_f32 v47, v118, v119
  s_mov_b32 s55, 22528
  buffer_load_dwordx4 v[88:91], v252, s[24:27], s55 offen offset:0 sc1
  buffer_load_dwordx4 v[116:119], v252, s[24:27], s55 offen offset:1024 sc1
  s_cmp_ge_u32 s40, 4
  s_cbranch_scc1 M_l2
  s_barrier
M_l2:
  s_setprio 2
  s_cmp_lt_u32 s40, 4
  s_cbranch_scc1 M_pr3
  s_setprio 3
M_pr3:
  s_waitcnt lgkmcnt(10)
  v_mfma_f32_16x16x32_bf16 v[168:171], v[200:203], v[16:19], 0
  s_waitcnt lgkmcnt(8)
  ds_read_b64_tr_b16 v[224:225], v244 offset:4608
  ds_read_b64_tr_b16 v[226:227], v244 offset:5376
  v_mfma_f32_16x16x32_bf16 v[172:175], v[204:207], v[16:19], 0
  s_waitcnt lgkmcnt(8)
  ds_read_b64_tr_b16 v[228:229], v245 offset:4608
  v_mfma_f32_16x16x32_bf16 v[168:171], v[208:211], v[20:23], v[168:171]
  ds_read_b64_tr_b16 v[230:231], v245 offset:5376
  v_mfma_f32_16x16x32_bf16 v[176:179], v[208:211], v[32:35], 0
  s_waitcnt lgkmcnt(8)
  ds_read_b64_tr_b16 v[200:201], v244 offset:6144
  v_mfma_f32_16x16x32_bf16 v[172:175], v[212:215], v[20:23], v[172:175]
  ds_read_b64_tr_b16 v[202:203], v244 offset:6912
  v_mfma_f32_16x16x32_bf16 v[180:183], v[212:215], v[32:35], 0
  s_waitcnt lgkmcnt(8)
  ds_read_b64_tr_b16 v[204:205], v245 offset:6144
  v_mfma_f32_16x16x32_bf16 v[168:171], v[216:219], v[24:27], v[168:171]
  ds_read_b64_tr_b16 v[206:207], v245 offset:6912
  v_mfma_f32_16x16x32_bf16 v[176:179], v[216:219], v[36:39], v[176:179]
  s_waitcnt lgkmcnt(8)
  ds_read_b64_tr_b16 v[208:209], v246 offset:0
  v_mfma_f32_16x16x32_bf16 v[172:175], v[220:223], v[24:27], v[172:175]
  ds_read_b64_tr_b16 v[210:211], v246 offset:768
  v_mfma_f32_16x16x32_bf16 v[180:183], v[220:223], v[36:39], v[180:183]
  s_waitcnt lgkmcnt(8)
  ds_read_b64_tr_b16 v[212:213], v247 offset:0
  ds_read_b64_tr_b16 v[214:215], v247 offset:768
  v_mfma_f32_16x16x32_bf16 v[168:171], v[224:227], v[28:31], v[168:171]
  ds_read_b64_tr_b16 v[216:217], v246 offset:1536
  v_mfma_f32_16x16x32_bf16 v[176:179], v[224:227], v[40:43], v[176:179]
  s_waitcnt lgkmcnt(9)
  ds_read_b64_tr_b16 v[218:219], v246 offset:2304
  v_mfma_f32_16x16x32_bf16 v[172:175], v[228:231], v[28:31], v[172:175]
  ds_read_b64_tr_b16 v[220:221], v247 offset:1536
  v_mfma_f32_16x16x32_bf16 v[180:183], v[228:231], v[40:43], v[180:183]
  s_waitcnt lgkmcnt(9)
  ds_read_b64_tr_b16 v[222:223], v247 offset:2304
  v_mfma_f32_16x16x32_bf16 v[176:179], v[200:203], v[44:47], v[176:179]
  s_waitcnt lgkmcnt(8)
  ds_read_b64_tr_b16 v[224:225], v246 offset:3072
  v_mfma_f32_16x16x32_bf16 v[180:183], v[204:207], v[44:47], v[180:183]
  s_waitcnt lgkmcnt(7)
  ds_read_b64_tr_b16 v[226:227], v246 offset:3840
  v_mfma_f32_16x16x32_bf16 v[184:187], v[208:211], v[16:19], 0
  s_waitcnt lgkmcnt(6)
  ds_read_b64_tr_b16 v[228:229], v247 offset:3072
  v_mfma_f32_16x16x32_bf16 v[188:191], v[212:215], v[16:19], 0
  ds_read_b64_tr_b16 v[230:231], v247 offset:3840
  v_mfma_f32_16x16x32_bf16 v[56:59], v[16:19], v[48:51], 0
  s_waitcnt lgkmcnt(6)
  ds_read_b64_tr_b16 v[200:201], v246 offset:4608
  v_mfma_f32_16x16x32_bf16 v[184:187], v[216:219], v[20:23], v[184:187]
  ds_read_b64_tr_b16 v[202:203], v246 offset:5376
  ds_read_b64_tr_b16 v[204:205], v247 offset:4608
  v_mfma_f32_16x16x32_bf16 v[192:195], v[216:219], v[32:35], 0
  s_waitcnt lgkmcnt(7)
  ds_read_b64_tr_b16 v[206:207], v247 offset:5376
  v_cvt_pk_bf16_f32 v120, v168, v169
  v_mfma_f32_16x16x32_bf16 v[188:191], v[220:223], v[20:23], v[188:191]
  ds_read_b64_tr_b16 v[208:209], v246 offset:6144
  v_cvt_pk_bf16_f32 v121, v170, v171
  v_mfma_f32_16x16x32_bf16 v[196:199], v[220:223], v[32:35], 0
  s_waitcnt lgkmcnt(7)
  ds_read_b64_tr_b16 v[210:211], v246 offset:6912
  v_cvt_pk_bf16_f32 v122, v172, v173
  v_mfma_f32_16x16x32_bf16 v[184:187], v[224:227], v[24:27], v[184:187]
  ds_read_b64_tr_b16 v[212:213], v247 offset:6144
  v_cvt_pk_bf16_f32 v123, v174, v175
  v_mfma_f32_16x16x32_bf16 v[192:195], v[224:227], v[36:39], v[192:195]
  s_waitcnt lgkmcnt(7)
  ds_read_b64_tr_b16 v[214:215], v247 offset:6912
  v_cvt_pk_bf16_f32 v144, v176, v177
  v_mfma_f32_16x16x32_bf16 v[188:191], v[228:231], v[24:27], v[188:191]
  ds_read_b64_tr_b16 v[216:217], v248 offset:0
  v_cvt_pk_bf16_f32 v145, v178, v179
  v_mfma_f32_16x16x32_bf16 v[196:199], v[228:231], v[36:39], v[196:199]
  s_waitcnt lgkmcnt(7)
  ds_read_b64_tr_b16 v[218:219], v248 offset:768
  v_cvt_pk_bf16_f32 v146, v180, v181
  v_mfma_f32_16x16x32_bf16 v[184:187], v[200:203], v[28:31], v[184:187]
  ds_read_b64_tr_b16 v[220:221], v249 offset:0
  v_cvt_pk_bf16_f32 v147, v182, v183
  v_mfma_f32_16x16x32_bf16 v[192:195], v[200:203], v[40:43], v[192:195]
  s_waitcnt lgkmcnt(7)
  ds_read_b64_tr_b16 v[222:223], v249 offset:768
  v_mfma_f32_16x16x32_bf16 v[188:191], v[204:207], v[28:31], v[188:191]
  ds_read_b64_tr_b16 v[224:225], v248 offset:1536
  ds_read_b64_tr_b16 v[226:227], v248 offset:2304
  v_mfma_f32_16x16x32_bf16 v[196:199], v[204:207], v[40:43], v[196:199]
  s_waitcnt lgkmcnt(8)
  ds_read_b64_tr_b16 v[228:229], v249 offset:1536
  v_mfma_f32_16x16x32_bf16 v[192:195], v[208:211], v[44:47], v[192:195]
  s_waitcnt lgkmcnt(7)
  ds_read_b64_tr_b16 v[230:231], v249 offset:2304
  v_mfma_f32_16x16x32_bf16 v[196:199], v[212:215], v[44:47], v[196:199]
  ds_read_b64_tr_b16 v[200:201], v248 offset:3072
  v_mfma_f32_16x16x32_bf16 v[60:63], v[32:35], v[48:51], 0
  ds_read_b64_tr_b16 v[202:203], v248 offset:3840
  s_cmp_ge_u32 s40, 4
  s_cbranch_scc1 M_l3
  s_barrier
M_l3:
  s_waitcnt lgkmcnt(8)
  v_mfma_f32_16x16x32_bf16 v[168:171], v[216:219], v[16:19], 0
  s_waitcnt lgkmcnt(6)
  ds_read_b64_tr_b16 v[204:205], v249 offset:3072
  v_mfma_f32_16x16x32_bf16 v[172:175], v[220:223], v[16:19], 0
  ds_read_b64_tr_b16 v[206:207], v249 offset:3840
  v_mfma_f32_16x16x32_bf16 v[56:59], v[20:23], v[48:51], v[56:59]
  s_waitcnt lgkmcnt(6)
  ds_read_b64_tr_b16 v[208:209], v248 offset:4608
  v_mfma_f32_16x16x32_bf16 v[168:171], v[224:227], v[20:23], v[168:171]
  ds_read_b64_tr_b16 v[210:211], v248 offset:5376
  v_cvt_pk_bf16_f32 v124, v184, v185
  v_mfma_f32_16x16x32_bf16 v[176:179], v[224:227], v[32:35], 0
  s_waitcnt lgkmcnt(6)
  ds_read_b64_tr_b16 v[212:213], v249 offset:4608
  v_cvt_pk_bf16_f32 v125, v186, v187
  v_mfma_f32_16x16x32_bf16 v[172:175], v[228:231], v[20:23], v[172:175]
  ds_read_b64_tr_b16 v[214:215], v249 offset:5376
  ds_read_b64_tr_b16 v[216:217], v248 offset:6144
  v_mfma_f32_16x16x32_bf16 v[180:183], v[228:231], v[32:35], 0
  s_waitcnt lgkmcnt(7)
  ds_read_b64_tr_b16 v[218:219], v248 offset:6912
  v_cvt_pk_bf16_f32 v126, v188, v189
  v_mfma_f32_16x16x32_bf16 v[168:171], v[200:203], v[24:27], v[168:171]
  ds_read_b64_tr_b16 v[220:221], v249 offset:6144
  v_cvt_pk_bf16_f32 v127, v190, v191
  v_mfma_f32_16x16x32_bf16 v[176:179], v[200:203], v[36:39], v[176:179]
  s_waitcnt lgkmcnt(7)
  ds_read_b64_tr_b16 v[222:223], v249 offset:6912
  v_cvt_pk_bf16_f32 v148, v192, v193
  v_mfma_f32_16x16x32_bf16 v[172:175], v[204:207], v[24:27], v[172:175]
  ds_read_b64_tr_b16 v[224:225], v250 offset:0
  v_cvt_pk_bf16_f32 v149, v194, v195
  v_mfma_f32_16x16x32_bf16 v[180:183], v[204:207], v[36:39], v[180:183]
  s_waitcnt lgkmcnt(7)
  ds_read_b64_tr_b16 v[226:227], v250 offset:768
  v_cvt_pk_bf16_f32 v150, v196, v197
  v_mfma_f32_16x16x32_bf16 v[168:171], v[208:211], v[28:31], v[168:171]
  ds_read_b64_tr_b16 v[228:229], v251 offset:0
  v_cvt_pk_bf16_f32 v151, v198, v199
  v_mfma_f32_16x16x32_bf16 v[176:179], v[208:211], v[40:43], v[176:179]
  s_waitcnt lgkmcnt(7)
  ds_read_b64_tr_b16 v[230:231], v251 offset:768
  v_mfma_f32_16x16x32_bf16 v[172:175], v[212:215], v[28:31], v[172:175]
  ds_read_b64_tr_b16 v[200:201], v250 offset:1536
  v_mfma_f32_16x16x32_bf16 v[180:183], v[212:215], v[40:43], v[180:183]
  s_waitcnt lgkmcnt(7)
  ds_read_b64_tr_b16 v[202:203], v250 offset:2304
  v_mfma_f32_16x16x32_bf16 v[176:179], v[216:219], v[44:47], v[176:179]
  s_waitcnt lgkmcnt(6)
  ds_read_b64_tr_b16 v[204:205], v251 offset:1536
  ds_read_b64_tr_b16 v[206:207], v251 offset:2304
  v_mfma_f32_16x16x32_bf16 v[180:183], v[220:223], v[44:47], v[180:183]
  ds_read_b64_tr_b16 v[208:209], v250 offset:3072
  v_mfma_f32_16x16x32_bf16 v[60:63], v[36:39], v[48:51], v[60:63]
  s_waitcnt lgkmcnt(7)
  ds_read_b64_tr_b16 v[210:211], v250 offset:3840
  v_mfma_f32_16x16x32_bf16 v[184:187], v[224:227], v[16:19], 0
  s_waitcnt lgkmcnt(6)
  ds_read_b64_tr_b16 v[212:213], v251 offset:3072
  v_mfma_f32_16x16x32_bf16 v[188:191], v[228:231], v[16:19], 0
  ds_read_b64_tr_b16 v[214:215], v251 offset:3840
  v_mfma_f32_16x16x32_bf16 v[56:59], v[24:27], v[48:51], v[56:59]
  s_waitcnt lgkmcnt(6)
  ds_read_b64_tr_b16 v[216:217], v250 offset:4608
  v_mfma_f32_16x16x32_bf16 v[184:187], v[200:203], v[20:23], v[184:187]
  ds_read_b64_tr_b16 v[218:219], v250 offset:5376
  v_cvt_pk_bf16_f32 v128, v168, v169
  v_mfma_f32_16x16x32_bf16 v[192:195], v[200:203], v[32:35], 0
  s_waitcnt lgkmcnt(6)
  ds_read_b64_tr_b16 v[220:221], v251 offset:4608
  v_cvt_pk_bf16_f32 v129, v170, v171
  v_mfma_f32_16x16x32_bf16 v[188:191], v[204:207], v[20:23], v[188:191]
  ds_read_b64_tr_b16 v[222:223], v251 offset:5376
  v_cvt_pk_bf16_f32 v130, v172, v173
  v_mfma_f32_16x16x32_bf16 v[196:199], v[204:207], v[32:35], 0
  s_waitcnt lgkmcnt(6)
  ds_read_b64_tr_b16 v[224:225], v250 offset:6144
  ds_read_b64_tr_b16 v[226:227], v250 offset:6912
  v_mfma_f32_16x16x32_bf16 v[184:187], v[208:211], v[24:27], v[184:187]
  ds_read_b64_tr_b16 v[228:229], v251 offset:6144
  v_cvt_pk_bf16_f32 v131, v174, v175
  v_mfma_f32_16x16x32_bf16 v[192:195], v[208:211], v[36:39], v[192:195]
  s_waitcnt lgkmcnt(7)
  ds_read_b64_tr_b16 v[230:231], v251 offset:6912
  v_cvt_pk_bf16_f32 v152, v176, v177
  v_mfma_f32_16x16x32_bf16 v[188:191], v[212:215], v[24:27], v[188:191]
  ds_read_b64_tr_b16 v[200:201], v244 offset:256
  v_cvt_pk_bf16_f32 v153, v178, v179
  v_mfma_f32_16x16x32_bf16 v[196:199], v[212:215], v[36:39], v[196:199]
  s_waitcnt lgkmcnt(7)
  ds_read_b64_tr_b16 v[202:203], v244 offset:1024
  v_cvt_pk_bf16_f32 v154, v180, v181
  v_mfma_f32_16x16x32_bf16 v[184:187], v[216:219], v[28:31], v[184:187]
  ds_read_b64_tr_b16 v[204:205], v245 offset:256
  v_cvt_pk_bf16_f32 v155, v182, v183
  v_mfma_f32_16x16x32_bf16 v[192:195], v[216:219], v[40:43], v[192:195]
  s_waitcnt lgkmcnt(7)
  ds_read_b64_tr_b16 v[206:207], v245 offset:1024
  v_mfma_f32_16x16x32_bf16 v[188:191], v[220:223], v[28:31], v[188:191]
  ds_read_b64_tr_b16 v[208:209], v244 offset:1792
  v_mfma_f32_16x16x32_bf16 v[196:199], v[220:223], v[40:43], v[196:199]
  s_waitcnt lgkmcnt(7)
  ds_read_b64_tr_b16 v[210:211], v244 offset:2560
  v_mfma_f32_16x16x32_bf16 v[192:195], v[224:227], v[44:47], v[192:195]
  s_waitcnt lgkmcnt(6)
  ds_read_b64_tr_b16 v[212:213], v245 offset:1792
  v_mfma_f32_16x16x32_bf16 v[196:199], v[228:231], v[44:47], v[196:199]
  ds_read_b64_tr_b16 v[214:215], v245 offset:2560
  ds_read_b64_tr_b16 v[216:217], v244 offset:3328
  v_mfma_f32_16x16x32_bf16 v[60:63], v[40:43], v[48:51], v[60:63]
  s_waitcnt lgkmcnt(7)
  ds_read_b64_tr_b16 v[218:219], v244 offset:4096
  v_mfma_f32_16x16x32_bf16 v[168:171], v[200:203], v[16:19], 0
  s_waitcnt lgkmcnt(6)
  ds_read_b64_tr_b16 v[220:221], v245 offset:3328
  v_mfma_f32_16x16x32_bf16 v[172:175], v[204:207], v[16:19], 0
  ds_read_b64_tr_b16 v[222:223], v245 offset:4096
  v_mfma_f32_16x16x32_bf16 v[56:59], v[28:31], v[48:51], v[56:59]
  s_waitcnt lgkmcnt(6)
  ds_read_b64_tr_b16 v[224:225], v244 offset:4864
  v_mfma_f32_16x16x32_bf16 v[168:171], v[208:211], v[20:23], v[168:171]
  ds_read_b64_tr_b16 v[226:227], v244 offset:5632
  v_cvt_pk_bf16_f32 v132, v184, v185
  v_mfma_f32_16x16x32_bf16 v[176:179], v[208:211], v[32:35], 0
  s_waitcnt lgkmcnt(6)
  ds_read_b64_tr_b16 v[228:229], v245 offset:4864
  v_cvt_pk_bf16_f32 v133, v186, v187
  v_mfma_f32_16x16x32_bf16 v[172:175], v[212:215], v[20:23], v[172:175]
  ds_read_b64_tr_b16 v[230:231], v245 offset:5632
  v_cvt_pk_bf16_f32 v134, v188, v189
  v_mfma_f32_16x16x32_bf16 v[180:183], v[212:215], v[32:35], 0
  s_waitcnt lgkmcnt(6)
  ds_read_b64_tr_b16 v[200:201], v244 offset:6400
  v_cvt_pk_bf16_f32 v135, v190, v191
  v_mfma_f32_16x16x32_bf16 v[168:171], v[216:219], v[24:27], v[168:171]
  ds_read_b64_tr_b16 v[202:203], v244 offset:7168
  v_cvt_pk_bf16_f32 v156, v192, v193
  v_mfma_f32_16x16x32_bf16 v[176:179], v[216:219], v[36:39], v[176:179]
  s_waitcnt lgkmcnt(6)
  ds_read_b64_tr_b16 v[204:205], v245 offset:6400
  ds_read_b64_tr_b16 v[206:207], v245 offset:7168
  v_mfma_f32_16x16x32_bf16 v[172:175], v[220:223], v[24:27], v[172:175]
  ds_read_b64_tr_b16 v[208:209], v246 offset:256
  v_cvt_pk_bf16_f32 v157, v194, v195
  v_mfma_f32_16x16x32_bf16 v[180:183], v[220:223], v[36:39], v[180:183]
  s_waitcnt lgkmcnt(7)
  ds_read_b64_tr_b16 v[210:211], v246 offset:1024
  v_cvt_pk_bf16_f32 v158, v196, v197
  v_mfma_f32_16x16x32_bf16 v[168:171], v[224:227], v[28:31], v[168:171]
  ds_read_b64_tr_b16 v[212:213], v247 offset:256
  v_cvt_pk_bf16_f32 v159, v198, v199
  v_mfma_f32_16x16x32_bf16 v[176:179], v[224:227], v[40:43], v[176:179]
  s_waitcnt lgkmcnt(7)
  ds_read_b64_tr_b16 v[214:215], v247 offset:1024
  v_mfma_f32_16x16x32_bf16 v[172:175], v[228:231], v[28:31], v[172:175]
  ds_read_b64_tr_b16 v[216:217], v246 offset:1792
  v_mfma_f32_16x16x32_bf16 v[180:183], v[228:231], v[40:43], v[180:183]
  s_waitcnt lgkmcnt(7)
  ds_read_b64_tr_b16 v[218:219], v246 offset:2560
  v_mfma_f32_16x16x32_bf16 v[176:179], v[200:203], v[44:47], v[176:179]
  s_waitcnt lgkmcnt(6)
  ds_read_b64_tr_b16 v[220:221], v247 offset:1792
  v_mfma_f32_16x16x32_bf16 v[180:183], v[204:207], v[44:47], v[180:183]
  ds_read_b64_tr_b16 v[222:223], v247 offset:2560
  v_mfma_f32_16x16x32_bf16 v[60:63], v[44:47], v[48:51], v[60:63]
  s_waitcnt lgkmcnt(6)
  ds_read_b64_tr_b16 v[224:225], v246 offset:3328
  v_mfma_f32_16x16x32_bf16 v[184:187], v[208:211], v[16:19], 0
  s_waitcnt lgkmcnt(5)
  ds_read_b64_tr_b16 v[226:227], v246 offset:4096
  ds_read_b64_tr_b16 v[228:229], v247 offset:3328
  v_mfma_f32_16x16x32_bf16 v[188:191], v[212:215], v[16:19], 0
  s_waitcnt lgkmcnt(5)
  ds_read_b64_tr_b16 v[230:231], v247 offset:4096
  v_mfma_f32_16x16x32_bf16 v[184:187], v[216:219], v[20:23], v[184:187]
  ds_read_b64_tr_b16 v[200:201], v246 offset:4864
  v_mfma_f32_16x16x32_bf16 v[192:195], v[216:219], v[32:35], 0
  s_waitcnt lgkmcnt(5)
  ds_read_b64_tr_b16 v[202:203], v246 offset:5632
  v_cvt_pk_bf16_f32 v136, v168, v169
  v_mfma_f32_16x16x32_bf16 v[188:191], v[220:223], v[20:23], v[188:191]
  ds_read_b64_tr_b16 v[204:205], v247 offset:4864
  v_cvt_pk_bf16_f32 v137, v170, v171
  v_mfma_f32_16x16x32_bf16 v[196:199], v[220:223], v[32:35], 0
  s_waitcnt lgkmcnt(5)
  ds_read_b64_tr_b16 v[206:207], v247 offset:5632
  v_cvt_pk_bf16_f32 v138, v172, v173
  v_mfma_f32_16x16x32_bf16 v[184:187], v[224:227], v[24:27], v[184:187]
  ds_read_b64_tr_b16 v[208:209], v246 offset:6400
  v_cvt_pk_bf16_f32 v139, v174, v175
  v_mfma_f32_16x16x32_bf16 v[192:195], v[224:227], v[36:39], v[192:195]
  s_waitcnt lgkmcnt(5)
  ds_read_b64_tr_b16 v[210:211], v246 offset:7168
  v_cvt_pk_bf16_f32 v160, v176, v177
  v_mfma_f32_16x16x32_bf16 v[188:191], v[228:231], v[24:27], v[188:191]
  ds_read_b64_tr_b16 v[212:213], v247 offset:6400
  v_cvt_pk_bf16_f32 v161, v178, v179
  v_mfma_f32_16x16x32_bf16 v[196:199], v[228:231], v[36:39], v[196:199]
  s_waitcnt lgkmcnt(5)
  ds_read_b64_tr_b16 v[214:215], v247 offset:7168
  v_cvt_pk_bf16_f32 v162, v180, v181
  v_mfma_f32_16x16x32_bf16 v[184:187], v[200:203], v[28:31], v[184:187]
  v_cvt_pk_bf16_f32 v163, v182, v183
  v_mfma_f32_16x16x32_bf16 v[192:195], v[200:203], v[40:43], v[192:195]
  s_waitcnt lgkmcnt(4)
  v_mfma_f32_16x16x32_bf16 v[188:191], v[204:207], v[28:31], v[188:191]
  v_mfma_f32_16x16x32_bf16 v[196:199], v[204:207], v[40:43], v[196:199]
  s_waitcnt lgkmcnt(2)
  v_mfma_f32_16x16x32_bf16 v[192:195], v[208:211], v[44:47], v[192:195]
  s_waitcnt lgkmcnt(0)
  v_mfma_f32_16x16x32_bf16 v[196:199], v[212:215], v[44:47], v[196:199]
  s_waitcnt vmcnt(0)
  s_cmp_lt_u32 s40, 4
  s_cbranch_scc1 M_e3
  s_barrier
  s_mul_i32 s55, s40, 9216
  s_sub_u32 s55, s55, 24576
  s_add_u32 s59, s55, 24576
  s_mov_b32 m0, s55
  s_add_u32 s55, s55, 3072
  buffer_load_dwordx4 v252, s[24:27], s59 offen offset:0 sc1 lds
  buffer_load_dwordx4 v252, s[24:27], s59 offen offset:1024 sc1 lds
  buffer_load_dwordx4 v252, s[24:27], s59 offen offset:2048 sc1 lds
  s_add_u32 s59, s59, 3072
  s_mov_b32 m0, s55
  s_add_u32 s55, s55, 3072
  buffer_load_dwordx4 v252, s[24:27], s59 offen offset:0 sc1 lds
  buffer_load_dwordx4 v252, s[24:27], s59 offen offset:1024 sc1 lds
  buffer_load_dwordx4 v252, s[24:27], s59 offen offset:2048 sc1 lds
  s_add_u32 s59, s59, 3072
  s_mov_b32 m0, s55
  s_add_u32 s55, s55, 3072
  buffer_load_dwordx4 v252, s[24:27], s59 offen offset:0 sc1 lds
  buffer_load_dwordx4 v252, s[24:27], s59 offen offset:1024 sc1 lds
  buffer_load_dwordx4 v252, s[24:27], s59 offen offset:2048 sc1 lds
  s_add_u32 s59, s59, 3072
M_e3:
  v_cvt_pk_bf16_f32 v140, v184, v185
  v_cvt_pk_bf16_f32 v141, v186, v187
  v_cvt_pk_bf16_f32 v142, v188, v189
  v_cvt_pk_bf16_f32 v143, v190, v191
  v_cvt_pk_bf16_f32 v164, v192, v193
  v_cvt_pk_bf16_f32 v165, v194, v195
  v_cvt_pk_bf16_f32 v166, v196, v197
  v_cvt_pk_bf16_f32 v167, v198, v199
  ds_read_b128 v[200:203], v253 offset:0
  ds_read_b128 v[204:207], v253 offset:1024
  ds_read_b128 v[208:211], v253 offset:2048
  ds_read_b128 v[212:215], v253 offset:3072
  s_waitcnt lgkmcnt(3)
  v_mfma_f32_16x16x32_bf16 v[168:171], v[120:123], v[200:203], 0
  ds_read_b128 v[216:219], v253 offset:4096
  v_rcp_f32 v56, v56
  v_mfma_f32_16x16x32_bf16 v[176:179], v[144:147], v[200:203], 0
  s_waitcnt lgkmcnt(3)
  v_rcp_f32 v57, v57
  v_rcp_f32 v58, v58
  v_mfma_f32_16x16x32_bf16 v[172:175], v[120:123], v[204:207], 0
  ds_read_b128 v[220:223], v253 offset:5120
  v_rcp_f32 v59, v59
  v_mfma_f32_16x16x32_bf16 v[180:183], v[144:147], v[204:207], 0
  s_waitcnt lgkmcnt(3)
  v_rcp_f32 v60, v60
  v_rcp_f32 v61, v61
  v_mfma_f32_16x16x32_bf16 v[168:171], v[124:127], v[208:211], v[168:171]
  ds_read_b128 v[224:227], v253 offset:6144
  v_rcp_f32 v62, v62
  v_mfma_f32_16x16x32_bf16 v[176:179], v[148:151], v[208:211], v[176:179]
  s_waitcnt lgkmcnt(3)
  v_rcp_f32 v63, v63
  v_mfma_f32_16x16x32_bf16 v[172:175], v[124:127], v[212:215], v[172:175]
  ds_read_b128 v[228:231], v253 offset:7168
  v_mfma_f32_16x16x32_bf16 v[180:183], v[148:151], v[212:215], v[180:183]
  s_waitcnt lgkmcnt(3)
  v_mfma_f32_16x16x32_bf16 v[168:171], v[128:131], v[216:219], v[168:171]
  ds_read_b128 v[200:203], v253 offset:8192
  v_mfma_f32_16x16x32_bf16 v[176:179], v[152:155], v[216:219], v[176:179]
  s_waitcnt lgkmcnt(3)
  v_mfma_f32_16x16x32_bf16 v[172:175], v[128:131], v[220:223], v[172:175]
  ds_read_b128 v[204:207], v253 offset:9216
  v_mfma_f32_16x16x32_bf16 v[180:183], v[152:155], v[220:223], v[180:183]
  s_waitcnt lgkmcnt(3)
  v_mfma_f32_16x16x32_bf16 v[168:171], v[132:135], v[224:227], v[168:171]
  v_mfma_f32_16x16x32_bf16 v[176:179], v[156:159], v[224:227], v[176:179]
  s_waitcnt lgkmcnt(2)
  v_mfma_f32_16x16x32_bf16 v[172:175], v[132:135], v[228:231], v[172:175]
  v_mfma_f32_16x16x32_bf16 v[180:183], v[156:159], v[228:231], v[180:183]
  s_waitcnt lgkmcnt(1)
  v_mfma_f32_16x16x32_bf16 v[168:171], v[136:139], v[200:203], v[168:171]
  v_mfma_f32_16x16x32_bf16 v[176:179], v[160:163], v[200:203], v[176:179]
  s_waitcnt lgkmcnt(0)
  v_mfma_f32_16x16x32_bf16 v[172:175], v[136:139], v[204:207], v[172:175]
  v_mfma_f32_16x16x32_bf16 v[180:183], v[160:163], v[204:207], v[180:183]
  v_mfma_f32_16x16x32_bf16 v[168:171], v[140:143], v[64:67], v[168:171]
  v_mfma_f32_16x16x32_bf16 v[176:179], v[164:167], v[64:67], v[176:179]
  v_mfma_f32_16x16x32_bf16 v[172:175], v[140:143], v[92:95], v[172:175]
  v_mfma_f32_16x16x32_bf16 v[180:183], v[164:167], v[92:95], v[180:183]
  v_mfma_f32_16x16x32_bf16 v[184:187], v[120:123], v[68:71], 0
  v_mfma_f32_16x16x32_bf16 v[192:195], v[144:147], v[68:71], 0
  v_mfma_f32_16x16x32_bf16 v[188:191], v[120:123], v[96:99], 0
  s_nop 1
  v_mul_f32 v168, v168, v56
  s_nop 0
  v_mul_f32 v172, v172, v56
  v_mfma_f32_16x16x32_bf16 v[196:199], v[144:147], v[96:99], 0
  v_cvt_pk_bf16_f32 v16, v168, v172
  v_mul_f32 v169, v169, v57
  v_mfma_f32_16x16x32_bf16 v[184:187], v[124:127], v[72:75], v[184:187]
  v_mul_f32 v173, v173, v57
  v_cvt_pk_bf16_f32 v18, v169, v173
  v_mfma_f32_16x16x32_bf16 v[192:195], v[148:151], v[72:75], v[192:195]
  v_mul_f32 v170, v170, v58
  v_mul_f32 v174, v174, v58
  v_mfma_f32_16x16x32_bf16 v[188:191], v[124:127], v[100:103], v[188:191]
  v_cvt_pk_bf16_f32 v20, v170, v174
  v_mul_f32 v171, v171, v59
  v_mfma_f32_16x16x32_bf16 v[196:199], v[148:151], v[100:103], v[196:199]
  v_mul_f32 v175, v175, v59
  v_cvt_pk_bf16_f32 v22, v171, v175
  v_mfma_f32_16x16x32_bf16 v[184:187], v[128:131], v[76:79], v[184:187]
  v_mul_f32 v176, v176, v60
  v_mul_f32 v180, v180, v60
  v_mfma_f32_16x16x32_bf16 v[192:195], v[152:155], v[76:79], v[192:195]
  v_cvt_pk_bf16_f32 v24, v176, v180
  v_mul_f32 v177, v177, v61
  v_mfma_f32_16x16x32_bf16 v[188:191], v[128:131], v[104:107], v[188:191]
  v_mul_f32 v181, v181, v61
  v_cvt_pk_bf16_f32 v26, v177, v181
  v_mfma_f32_16x16x32_bf16 v[196:199], v[152:155], v[104:107], v[196:199]
  v_mul_f32 v178, v178, v62
  v_mul_f32 v182, v182, v62
  v_mfma_f32_16x16x32_bf16 v[184:187], v[132:135], v[80:83], v[184:187]
  v_cvt_pk_bf16_f32 v28, v178, v182
  v_mul_f32 v179, v179, v63
  v_mfma_f32_16x16x32_bf16 v[192:195], v[156:159], v[80:83], v[192:195]
  v_mul_f32 v183, v183, v63
  v_cvt_pk_bf16_f32 v30, v179, v183
  v_mfma_f32_16x16x32_bf16 v[188:191], v[132:135], v[108:111], v[188:191]
  v_mfma_f32_16x16x32_bf16 v[196:199], v[156:159], v[108:111], v[196:199]
  s_cmp_lt_u32 s40, 4
  s_cbranch_scc1 M_e4
  s_waitcnt vmcnt(0)
  s_barrier
M_e4:
  v_mfma_f32_16x16x32_bf16 v[184:187], v[136:139], v[84:87], v[184:187]
  ds_read_b128 v[200:203], v252 offset:0
  v_mfma_f32_16x16x32_bf16 v[192:195], v[160:163], v[84:87], v[192:195]
  v_mfma_f32_16x16x32_bf16 v[188:191], v[136:139], v[112:115], v[188:191]
  ds_read_b128 v[204:207], v252 offset:1024
  v_mfma_f32_16x16x32_bf16 v[196:199], v[160:163], v[112:115], v[196:199]
  v_mfma_f32_16x16x32_bf16 v[184:187], v[140:143], v[88:91], v[184:187]
  ds_read_b128 v[208:211], v252 offset:2048
  v_mfma_f32_16x16x32_bf16 v[192:195], v[164:167], v[88:91], v[192:195]
  v_mfma_f32_16x16x32_bf16 v[188:191], v[140:143], v[116:119], v[188:191]
  ds_read_b128 v[212:215], v252 offset:3072
  v_mfma_f32_16x16x32_bf16 v[196:199], v[164:167], v[116:119], v[196:199]
  s_waitcnt lgkmcnt(3)
  v_mfma_f32_16x16x32_bf16 v[168:171], v[120:123], v[200:203], 0
  ds_read_b128 v[216:219], v252 offset:4096
  v_mfma_f32_16x16x32_bf16 v[176:179], v[144:147], v[200:203], 0
  s_waitcnt lgkmcnt(3)
  v_mfma_f32_16x16x32_bf16 v[172:175], v[120:123], v[204:207], 0
  ds_read_b128 v[220:223], v252 offset:5120
  v_mul_f32 v184, v184, v56
  v_mfma_f32_16x16x32_bf16 v[180:183], v[144:147], v[204:207], 0
  s_waitcnt lgkmcnt(3)
  v_mul_f32 v188, v188, v56
  v_cvt_pk_bf16_f32 v17, v184, v188
  v_mfma_f32_16x16x32_bf16 v[168:171], v[124:127], v[208:211], v[168:171]
  ds_read_b128 v[224:227], v252 offset:6144
  buffer_store_dwordx2 v[16:17], v4, s[20:23], 0 offen offset:0 sc1
  v_mfma_f32_16x16x32_bf16 v[176:179], v[148:151], v[208:211], v[176:179]
  s_waitcnt lgkmcnt(3)
  v_mul_f32 v185, v185, v57
  v_mul_f32 v189, v189, v57
  v_mfma_f32_16x16x32_bf16 v[172:175], v[124:127], v[212:215], v[172:175]
  ds_read_b128 v[228:231], v252 offset:7168
  v_cvt_pk_bf16_f32 v19, v185, v189
  v_mfma_f32_16x16x32_bf16 v[180:183], v[148:151], v[212:215], v[180:183]
  s_waitcnt lgkmcnt(3)
  buffer_store_dwordx2 v[18:19], v5, s[20:23], 0 offen offset:0 sc1
  v_mul_f32 v186, v186, v58
  v_mfma_f32_16x16x32_bf16 v[168:171], v[128:131], v[216:219], v[168:171]
  ds_read_b128 v[200:203], v252 offset:8192
  v_mul_f32 v190, v190, v58
  v_mfma_f32_16x16x32_bf16 v[176:179], v[152:155], v[216:219], v[176:179]
  s_waitcnt lgkmcnt(3)
  v_cvt_pk_bf16_f32 v21, v186, v190
  buffer_store_dwordx2 v[20:21], v6, s[20:23], 0 offen offset:0 sc1
  v_mfma_f32_16x16x32_bf16 v[172:175], v[128:131], v[220:223], v[172:175]
  ds_read_b128 v[204:207], v252 offset:9216
  v_mul_f32 v187, v187, v59
  v_mfma_f32_16x16x32_bf16 v[180:183], v[152:155], v[220:223], v[180:183]
  s_waitcnt lgkmcnt(3)
  v_mul_f32 v191, v191, v59
  v_cvt_pk_bf16_f32 v23, v187, v191
  v_mfma_f32_16x16x32_bf16 v[168:171], v[132:135], v[224:227], v[168:171]
  ds_read_b128 v[208:211], v252 offset:10240
  buffer_store_dwordx2 v[22:23], v7, s[20:23], 0 offen offset:0 sc1
  v_mfma_f32_16x16x32_bf16 v[176:179], v[156:159], v[224:227], v[176:179]
  s_waitcnt lgkmcnt(3)
  v_mul_f32 v192, v192, v60
  v_mul_f32 v196, v196, v60
  v_mfma_f32_16x16x32_bf16 v[172:175], v[132:135], v[228:231], v[172:175]
  ds_read_b128 v[212:215], v252 offset:11264
  v_cvt_pk_bf16_f32 v25, v192, v196
  v_mfma_f32_16x16x32_bf16 v[180:183], v[156:159], v[228:231], v[180:183]
  s_waitcnt lgkmcnt(3)
  buffer_store_dwordx2 v[24:25], v8, s[20:23], 0 offen offset:0 sc1
  v_mul_f32 v193, v193, v61
  v_mfma_f32_16x16x32_bf16 v[168:171], v[136:139], v[200:203], v[168:171]
  ds_read_b128 v[216:219], v252 offset:12288
  v_mul_f32 v197, v197, v61
  v_mfma_f32_16x16x32_bf16 v[176:179], v[160:163], v[200:203], v[176:179]
  s_waitcnt lgkmcnt(3)
  v_cvt_pk_bf16_f32 v27, v193, v197
  buffer_store_dwordx2 v[26:27], v9, s[20:23], 0 offen offset:0 sc1
  v_mfma_f32_16x16x32_bf16 v[172:175], v[136:139], v[204:207], v[172:175]
  ds_read_b128 v[220:223], v252 offset:13312
  v_mul_f32 v194, v194, v62
  v_mfma_f32_16x16x32_bf16 v[180:183], v[160:163], v[204:207], v[180:183]
  s_waitcnt lgkmcnt(3)
  v_mul_f32 v198, v198, v62
  v_cvt_pk_bf16_f32 v29, v194, v198
  v_mfma_f32_16x16x32_bf16 v[168:171], v[140:143], v[208:211], v[168:171]
  ds_read_b128 v[224:227], v252 offset:14336
  buffer_store_dwordx2 v[28:29], v10, s[20:23], 0 offen offset:0 sc1
  v_mfma_f32_16x16x32_bf16 v[176:179], v[164:167], v[208:211], v[176:179]
  s_waitcnt lgkmcnt(3)
  v_mul_f32 v195, v195, v63
  v_mul_f32 v199, v199, v63
  v_mfma_f32_16x16x32_bf16 v[172:175], v[140:143], v[212:215], v[172:175]
  ds_read_b128 v[228:231], v252 offset:15360
  v_cvt_pk_bf16_f32 v31, v195, v199
  v_mfma_f32_16x16x32_bf16 v[180:183], v[164:167], v[212:215], v[180:183]
  s_waitcnt lgkmcnt(3)
  buffer_store_dwordx2 v[30:31], v11, s[20:23], 0 offen offset:0 sc1
  v_mfma_f32_16x16x32_bf16 v[184:187], v[120:123], v[216:219], 0
  ds_read_b128 v[200:203], v252 offset:16384
  v_mfma_f32_16x16x32_bf16 v[192:195], v[144:147], v[216:219], 0
  s_waitcnt lgkmcnt(3)
  v_mfma_f32_16x16x32_bf16 v[188:191], v[120:123], v[220:223], 0
  ds_read_b128 v[204:207], v252 offset:17408
  v_mul_f32 v168, v168, v56
  v_mfma_f32_16x16x32_bf16 v[196:199], v[144:147], v[220:223], 0
  s_waitcnt lgkmcnt(3)
  v_mul_f32 v172, v172, v56
  v_cvt_pk_bf16_f32 v16, v168, v172
  v_mfma_f32_16x16x32_bf16 v[184:187], v[124:127], v[224:227], v[184:187]
  ds_read_b128 v[208:211], v252 offset:18432
  v_mul_f32 v169, v169, v57
  v_mfma_f32_16x16x32_bf16 v[192:195], v[148:151], v[224:227], v[192:195]
  s_waitcnt lgkmcnt(3)
  v_mul_f32 v173, v173, v57
  v_cvt_pk_bf16_f32 v18, v169, v173
  v_mfma_f32_16x16x32_bf16 v[188:191], v[124:127], v[228:231], v[188:191]
  ds_read_b128 v[212:215], v252 offset:19456
  v_mul_f32 v170, v170, v58
  v_mfma_f32_16x16x32_bf16 v[196:199], v[148:151], v[228:231], v[196:199]
  s_waitcnt lgkmcnt(3)
  v_mul_f32 v174, v174, v58
  v_cvt_pk_bf16_f32 v20, v170, v174
  v_mfma_f32_16x16x32_bf16 v[184:187], v[128:131], v[200:203], v[184:187]
  ds_read_b128 v[216:219], v252 offset:20480
  v_mul_f32 v171, v171, v59
  v_mfma_f32_16x16x32_bf16 v[192:195], v[152:155], v[200:203], v[192:195]
  s_waitcnt lgkmcnt(3)
  v_mul_f32 v175, v175, v59
  v_cvt_pk_bf16_f32 v22, v171, v175
  v_mfma_f32_16x16x32_bf16 v[188:191], v[128:131], v[204:207], v[188:191]
  ds_read_b128 v[220:223], v252 offset:21504
  v_mul_f32 v176, v176, v60
  v_mfma_f32_16x16x32_bf16 v[196:199], v[152:155], v[204:207], v[196:199]
  s_waitcnt lgkmcnt(3)
  v_mul_f32 v180, v180, v60
  v_cvt_pk_bf16_f32 v24, v176, v180
  v_mfma_f32_16x16x32_bf16 v[184:187], v[132:135], v[208:211], v[184:187]
  ds_read_b128 v[224:227], v252 offset:22528
  v_mul_f32 v177, v177, v61
  v_mfma_f32_16x16x32_bf16 v[192:195], v[156:159], v[208:211], v[192:195]
  s_waitcnt lgkmcnt(3)
  v_mul_f32 v181, v181, v61
  v_cvt_pk_bf16_f32 v26, v177, v181
  v_mfma_f32_16x16x32_bf16 v[188:191], v[132:135], v[212:215], v[188:191]
  ds_read_b128 v[228:231], v252 offset:23552
  v_mul_f32 v178, v178, v62
  v_mfma_f32_16x16x32_bf16 v[196:199], v[156:159], v[212:215], v[196:199]
  s_waitcnt lgkmcnt(3)
  v_mul_f32 v182, v182, v62
  v_cvt_pk_bf16_f32 v28, v178, v182
  v_mfma_f32_16x16x32_bf16 v[184:187], v[136:139], v[216:219], v[184:187]
  ds_read_b128 v[200:203], v252 offset:24576
  v_mul_f32 v179, v179, v63
  v_mfma_f32_16x16x32_bf16 v[192:195], v[160:163], v[216:219], v[192:195]
  s_waitcnt lgkmcnt(3)
  v_mul_f32 v183, v183, v63
  v_cvt_pk_bf16_f32 v30, v179, v183
  v_mfma_f32_16x16x32_bf16 v[188:191], v[136:139], v[220:223], v[188:191]
  ds_read_b128 v[204:207], v252 offset:25600
  v_mfma_f32_16x16x32_bf16 v[196:199], v[160:163], v[220:223], v[196:199]
  s_waitcnt lgkmcnt(3)
  v_mfma_f32_16x16x32_bf16 v[184:187], v[140:143], v[224:227], v[184:187]
  ds_read_b128 v[208:211], v252 offset:26624
  v_mfma_f32_16x16x32_bf16 v[192:195], v[164:167], v[224:227], v[192:195]
  s_waitcnt lgkmcnt(3)
  v_mfma_f32_16x16x32_bf16 v[188:191], v[140:143], v[228:231], v[188:191]
  ds_read_b128 v[212:215], v252 offset:27648
  v_mfma_f32_16x16x32_bf16 v[196:199], v[164:167], v[228:231], v[196:199]
  s_waitcnt lgkmcnt(3)
  v_mfma_f32_16x16x32_bf16 v[168:171], v[120:123], v[200:203], 0
  ds_read_b128 v[216:219], v252 offset:28672
  v_mfma_f32_16x16x32_bf16 v[176:179], v[144:147], v[200:203], 0
  s_waitcnt lgkmcnt(3)
  v_mfma_f32_16x16x32_bf16 v[172:175], v[120:123], v[204:207], 0
  ds_read_b128 v[220:223], v252 offset:29696
  v_mul_f32 v184, v184, v56
  v_mfma_f32_16x16x32_bf16 v[180:183], v[144:147], v[204:207], 0
  s_waitcnt lgkmcnt(3)
  v_mul_f32 v188, v188, v56
  v_cvt_pk_bf16_f32 v17, v184, v188
  v_mfma_f32_16x16x32_bf16 v[168:171], v[124:127], v[208:211], v[168:171]
  ds_read_b128 v[224:227], v252 offset:30720
  buffer_store_dwordx2 v[16:17], v4, s[20:23], 0 offen offset:128 sc1
  v_mfma_f32_16x16x32_bf16 v[176:179], v[148:151], v[208:211], v[176:179]
  s_waitcnt lgkmcnt(3)
  v_mul_f32 v185, v185, v57
  v_mul_f32 v189, v189, v57
  v_mfma_f32_16x16x32_bf16 v[172:175], v[124:127], v[212:215], v[172:175]
  ds_read_b128 v[228:231], v252 offset:31744
  v_cvt_pk_bf16_f32 v19, v185, v189
  v_mfma_f32_16x16x32_bf16 v[180:183], v[148:151], v[212:215], v[180:183]
  s_waitcnt lgkmcnt(3)
  buffer_store_dwordx2 v[18:19], v5, s[20:23], 0 offen offset:128 sc1
  v_mul_f32 v186, v186, v58
  v_mfma_f32_16x16x32_bf16 v[168:171], v[128:131], v[216:219], v[168:171]
  ds_read_b128 v[200:203], v252 offset:32768
  v_mul_f32 v190, v190, v58
  v_mfma_f32_16x16x32_bf16 v[176:179], v[152:155], v[216:219], v[176:179]
  s_waitcnt lgkmcnt(3)
  v_cvt_pk_bf16_f32 v21, v186, v190
  buffer_store_dwordx2 v[20:21], v6, s[20:23], 0 offen offset:128 sc1
  v_mfma_f32_16x16x32_bf16 v[172:175], v[128:131], v[220:223], v[172:175]
  ds_read_b128 v[204:207], v252 offset:33792
  v_mul_f32 v187, v187, v59
  v_mfma_f32_16x16x32_bf16 v[180:183], v[152:155], v[220:223], v[180:183]
  s_waitcnt lgkmcnt(3)
  v_mul_f32 v191, v191, v59
  v_cvt_pk_bf16_f32 v23, v187, v191
  v_mfma_f32_16x16x32_bf16 v[168:171], v[132:135], v[224:227], v[168:171]
  ds_read_b128 v[208:211], v252 offset:34816
  buffer_store_dwordx2 v[22:23], v7, s[20:23], 0 offen offset:128 sc1
  v_mfma_f32_16x16x32_bf16 v[176:179], v[156:159], v[224:227], v[176:179]
  s_waitcnt lgkmcnt(3)
  v_mul_f32 v192, v192, v60
  v_mul_f32 v196, v196, v60
  v_mfma_f32_16x16x32_bf16 v[172:175], v[132:135], v[228:231], v[172:175]
  ds_read_b128 v[212:215], v252 offset:35840
  v_cvt_pk_bf16_f32 v25, v192, v196
  v_mfma_f32_16x16x32_bf16 v[180:183], v[156:159], v[228:231], v[180:183]
  s_waitcnt lgkmcnt(3)
  buffer_store_dwordx2 v[24:25], v8, s[20:23], 0 offen offset:128 sc1
  v_mul_f32 v193, v193, v61
  v_mfma_f32_16x16x32_bf16 v[168:171], v[136:139], v[200:203], v[168:171]
  ds_read_b128 v[216:219], v252 offset:36864
  v_mul_f32 v197, v197, v61
  v_mfma_f32_16x16x32_bf16 v[176:179], v[160:163], v[200:203], v[176:179]
  s_waitcnt lgkmcnt(3)
  v_cvt_pk_bf16_f32 v27, v193, v197
  buffer_store_dwordx2 v[26:27], v9, s[20:23], 0 offen offset:128 sc1
  v_mfma_f32_16x16x32_bf16 v[172:175], v[136:139], v[204:207], v[172:175]
  ds_read_b128 v[220:223], v252 offset:37888
  v_mul_f32 v194, v194, v62
  v_mfma_f32_16x16x32_bf16 v[180:183], v[160:163], v[204:207], v[180:183]
  s_waitcnt lgkmcnt(3)
  v_mul_f32 v198, v198, v62
  v_cvt_pk_bf16_f32 v29, v194, v198
  v_mfma_f32_16x16x32_bf16 v[168:171], v[140:143], v[208:211], v[168:171]
  ds_read_b128 v[224:227], v252 offset:38912
  buffer_store_dwordx2 v[28:29], v10, s[20:23], 0 offen offset:128 sc1
  v_mfma_f32_16x16x32_bf16 v[176:179], v[164:167], v[208:211], v[176:179]
  s_waitcnt lgkmcnt(3)
  v_mul_f32 v195, v195, v63
  v_mul_f32 v199, v199, v63
  v_mfma_f32_16x16x32_bf16 v[172:175], v[140:143], v[212:215], v[172:175]
  ds_read_b128 v[228:231], v252 offset:39936
  v_cvt_pk_bf16_f32 v31, v195, v199
  v_mfma_f32_16x16x32_bf16 v[180:183], v[164:167], v[212:215], v[180:183]
  s_waitcnt lgkmcnt(3)
  buffer_store_dwordx2 v[30:31], v11, s[20:23], 0 offen offset:128 sc1
  v_mfma_f32_16x16x32_bf16 v[184:187], v[120:123], v[216:219], 0
  ds_read_b128 v[200:203], v252 offset:40960
  v_mfma_f32_16x16x32_bf16 v[192:195], v[144:147], v[216:219], 0
  s_waitcnt lgkmcnt(3)
  v_mfma_f32_16x16x32_bf16 v[188:191], v[120:123], v[220:223], 0
  ds_read_b128 v[204:207], v252 offset:41984
  v_mul_f32 v168, v168, v56
  v_mfma_f32_16x16x32_bf16 v[196:199], v[144:147], v[220:223], 0
  s_waitcnt lgkmcnt(3)
  v_mul_f32 v172, v172, v56
  v_cvt_pk_bf16_f32 v16, v168, v172
  v_mfma_f32_16x16x32_bf16 v[184:187], v[124:127], v[224:227], v[184:187]
  ds_read_b128 v[208:211], v252 offset:43008
  v_mul_f32 v169, v169, v57
  v_mfma_f32_16x16x32_bf16 v[192:195], v[148:151], v[224:227], v[192:195]
  s_waitcnt lgkmcnt(3)
  v_mul_f32 v173, v173, v57
  v_cvt_pk_bf16_f32 v18, v169, v173
  v_mfma_f32_16x16x32_bf16 v[188:191], v[124:127], v[228:231], v[188:191]
  ds_read_b128 v[212:215], v252 offset:44032
  v_mul_f32 v170, v170, v58
  v_mfma_f32_16x16x32_bf16 v[196:199], v[148:151], v[228:231], v[196:199]
  s_waitcnt lgkmcnt(3)
  v_mul_f32 v174, v174, v58
  v_cvt_pk_bf16_f32 v20, v170, v174
  v_mfma_f32_16x16x32_bf16 v[184:187], v[128:131], v[200:203], v[184:187]
  ds_read_b128 v[216:219], v252 offset:45056
  v_mul_f32 v171, v171, v59
  v_mfma_f32_16x16x32_bf16 v[192:195], v[152:155], v[200:203], v[192:195]
  s_waitcnt lgkmcnt(3)
  v_mul_f32 v175, v175, v59
  v_cvt_pk_bf16_f32 v22, v171, v175
  v_mfma_f32_16x16x32_bf16 v[188:191], v[128:131], v[204:207], v[188:191]
  ds_read_b128 v[220:223], v252 offset:46080
  v_mul_f32 v176, v176, v60
  v_mfma_f32_16x16x32_bf16 v[196:199], v[152:155], v[204:207], v[196:199]
  s_waitcnt lgkmcnt(3)
  v_mul_f32 v180, v180, v60
  v_cvt_pk_bf16_f32 v24, v176, v180
  v_mfma_f32_16x16x32_bf16 v[184:187], v[132:135], v[208:211], v[184:187]
  ds_read_b128 v[224:227], v252 offset:47104
  v_mul_f32 v177, v177, v61
  v_mfma_f32_16x16x32_bf16 v[192:195], v[156:159], v[208:211], v[192:195]
  s_waitcnt lgkmcnt(3)
  v_mul_f32 v181, v181, v61
  v_cvt_pk_bf16_f32 v26, v177, v181
  v_mfma_f32_16x16x32_bf16 v[188:191], v[132:135], v[212:215], v[188:191]
  ds_read_b128 v[228:231], v252 offset:48128
  v_mul_f32 v178, v178, v62
  v_mfma_f32_16x16x32_bf16 v[196:199], v[156:159], v[212:215], v[196:199]
  s_waitcnt lgkmcnt(3)
  v_mul_f32 v182, v182, v62
  v_cvt_pk_bf16_f32 v28, v178, v182
  v_mfma_f32_16x16x32_bf16 v[184:187], v[136:139], v[216:219], v[184:187]
  v_mul_f32 v179, v179, v63
  v_mul_f32 v183, v183, v63
  v_mfma_f32_16x16x32_bf16 v[192:195], v[160:163], v[216:219], v[192:195]
  s_waitcnt lgkmcnt(2)
  v_cvt_pk_bf16_f32 v30, v179, v183
  v_mfma_f32_16x16x32_bf16 v[188:191], v[136:139], v[220:223], v[188:191]
  v_mfma_f32_16x16x32_bf16 v[196:199], v[160:163], v[220:223], v[196:199]
  s_waitcnt lgkmcnt(1)
  v_mfma_f32_16x16x32_bf16 v[184:187], v[140:143], v[224:227], v[184:187]
  v_mfma_f32_16x16x32_bf16 v[192:195], v[164:167], v[224:227], v[192:195]
  s_waitcnt lgkmcnt(0)
  v_mfma_f32_16x16x32_bf16 v[188:191], v[140:143], v[228:231], v[188:191]
  v_mfma_f32_16x16x32_bf16 v[196:199], v[164:167], v[228:231], v[196:199]
  s_nop 3
  v_mul_f32 v184, v184, v56
  s_nop 1
  v_mul_f32 v188, v188, v56
  v_cvt_pk_bf16_f32 v17, v184, v188
  buffer_store_dwordx2 v[16:17], v4, s[20:23], 0 offen offset:256 sc1
  v_mul_f32 v185, v185, v57
  v_mul_f32 v189, v189, v57
  v_cvt_pk_bf16_f32 v19, v185, v189
  buffer_store_dwordx2 v[18:19], v5, s[20:23], 0 offen offset:256 sc1
  v_mul_f32 v186, v186, v58
  v_mul_f32 v190, v190, v58
  v_cvt_pk_bf16_f32 v21, v186, v190
  buffer_store_dwordx2 v[20:21], v6, s[20:23], 0 offen offset:256 sc1
  v_mul_f32 v187, v187, v59
  v_mul_f32 v191, v191, v59
  v_cvt_pk_bf16_f32 v23, v187, v191
  buffer_store_dwordx2 v[22:23], v7, s[20:23], 0 offen offset:256 sc1
  v_mul_f32 v192, v192, v60
  v_mul_f32 v196, v196, v60
  v_cvt_pk_bf16_f32 v25, v192, v196
  buffer_store_dwordx2 v[24:25], v8, s[20:23], 0 offen offset:256 sc1
  v_mul_f32 v193, v193, v61
  v_mul_f32 v197, v197, v61
  v_cvt_pk_bf16_f32 v27, v193, v197
  buffer_store_dwordx2 v[26:27], v9, s[20:23], 0 offen offset:256 sc1
  v_mul_f32 v194, v194, v62
  v_mul_f32 v198, v198, v62
  v_cvt_pk_bf16_f32 v29, v194, v198
  buffer_store_dwordx2 v[28:29], v10, s[20:23], 0 offen offset:256 sc1
  v_mul_f32 v195, v195, v63
  v_mul_f32 v199, v199, v63
  v_cvt_pk_bf16_f32 v31, v195, v199
  buffer_store_dwordx2 v[30:31], v11, s[20:23], 0 offen offset:256 sc1
  s_endpgm
M_helper:
H_join:
  s_and_b32 s55, s2, 7
  s_lshr_b32 s56, s2, 3
  s_lshr_b32 s41, s55, 2
  s_bfe_u32 s42, s55, 0x10001
  s_and_b32 s55, s55, 1
  s_lshl_b32 s55, s55, 2
  s_lshr_b32 s43, s56, 3
  s_add_u32 s43, s43, s55
  s_and_b32 s44, s56, 7
  s_mul_i32 s43, s43, 14
  s_mul_i32 s44, s44, 14
  s_mul_i32 s61, s41, 13
  s_add_i32 s61, s61, -6
  s_mul_i32 s62, s42, 13
  s_add_i32 s62, s62, -6
  s_cmp_ge_u32 s40, 4
  s_cselect_b32 s53, -4, 3
  s_add_i32 s53, s53, s40
  s_lshl_b32 s53, s53, 1
  s_add_u32 s88, s43, s53
  s_mov_b32 s89, 86016
  s_movk_i32 s90, 384
  s_mul_i32 s55, s41, 6
  s_add_i32 s45, s43, s55
  s_add_i32 s45, s45, -6
  s_cmp_eq_i32 s45, -6
  s_cselect_b32 s47, 6, 0
  s_cmp_eq_i32 s45, 98
  s_cselect_b32 s48, 7, 13
  s_cselect_b32 s49, 2, 0
  s_sub_i32 s45, s45, s49
  s_mul_i32 s55, s42, 6
  s_add_i32 s56, s44, s55
  s_add_i32 s56, s56, -6
  s_cmp_eq_i32 s56, -6
  s_cselect_b32 s50, 6, 0
  s_cmp_eq_i32 s56, 98
  s_cselect_b32 s51, 7, 13
  s_lshl_b32 s56, s56, 1
  s_add_i32 s56, s56, s42
  s_mul_i32 s46, s56, 384
  s_max_i32 s92, s53, s47
  s_min_i32 s92, s92, s48
  s_and_b32 s92, s92, -2
  s_add_u32 s52, s92, s49
  s_mov_b32 s54, 4286578688
  s_mov_b32 s63, 1037384597
  s_and_b32 s93, s40, 1
  s_lshl_b32 s93, s93, 3
  s_and_b32 s56, s40, 6
  s_or_b32 s93, s93, s56
  s_add_u32 s56, s40, 8
  s_add_i32 s100, s45, s56
  s_lshl_b32 s100, s100, 1
  s_add_i32 s100, s100, s41
  s_max_i32 s100, s100, 0
  s_min_i32 s100, s100, 223
  s_mul_i32 s100, s100, 86016
  s_mul_i32 s101, s56, 7680
  v_add_u32 v4, 0, v1
  v_xor_b32 v4, 0, v4
  v_mul_u32_u24 v5, 2731, v4
  v_lshrrev_b32 v5, 16, v5
  v_mul_u32_u24 v5, 384, v5
  v_lshl_add_u32 v4, v4, 4, v5
  v_add_u32 v232, s46, v4
  v_add_u32 v235, 6144, v232
  v_add_u32 v238, 12288, v232
  v_max_i32 v232, 0, v232
  v_add_u32 v4, 64, v1
  v_xor_b32 v4, 0, v4
  v_mul_u32_u24 v5, 2731, v4
  v_lshrrev_b32 v5, 16, v5
  v_mul_u32_u24 v5, 384, v5
  v_lshl_add_u32 v4, v4, 4, v5
  v_add_u32 v233, s46, v4
  v_add_u32 v236, 6144, v233
  v_max_i32 v233, 0, v233
  v_add_u32 v4, 128, v1
  v_xor_b32 v4, 0, v4
  v_mul_u32_u24 v5, 2731, v4
  v_lshrrev_b32 v5, 16, v5
  v_mul_u32_u24 v5, 384, v5
  v_lshl_add_u32 v4, v4, 4, v5
  v_add_u32 v234, s46, v4
  v_add_u32 v237, 6144, v234
  v_max_i32 v234, 0, v234
  v_add_u32 v4, 416, v1
  v_xor_b32 v4, 0, v4
  v_mul_u32_u24 v5, 2731, v4
  v_lshrrev_b32 v5, 16, v5
  v_mul_u32_u24 v5, 384, v5
  v_lshl_add_u32 v4, v4, 4, v5
  v_add_u32 v239, s46, v4
  v_add_u32 v4, 0, v1
  v_xor_b32 v4, 8, v4
  v_mul_u32_u24 v5, 2731, v4
  v_lshrrev_b32 v5, 16, v5
  v_mul_u32_u24 v5, 384, v5
  v_lshl_add_u32 v4, v4, 4, v5
  v_add_u32 v244, s46, v4
  v_add_u32 v247, 6144, v244
  v_add_u32 v250, 12288, v244
  v_max_i32 v244, 0, v244
  v_add_u32 v4, 64, v1
  v_xor_b32 v4, 8, v4
  v_mul_u32_u24 v5, 2731, v4
  v_lshrrev_b32 v5, 16, v5
  v_mul_u32_u24 v5, 384, v5
  v_lshl_add_u32 v4, v4, 4, v5
  v_add_u32 v245, s46, v4
  v_add_u32 v248, 6144, v245
  v_max_i32 v245, 0, v245
  v_add_u32 v4, 128, v1
  v_xor_b32 v4, 8, v4
  v_mul_u32_u24 v5, 2731, v4
  v_lshrrev_b32 v5, 16, v5
  v_mul_u32_u24 v5, 384, v5
  v_lshl_add_u32 v4, v4, 4, v5
  v_add_u32 v246, s46, v4
  v_add_u32 v249, 6144, v246
  v_max_i32 v246, 0, v246
  v_add_u32 v4, 416, v1
  v_xor_b32 v4, 8, v4
  v_mul_u32_u24 v5, 2731, v4
  v_lshrrev_b32 v5, 16, v5
  v_mul_u32_u24 v5, 384, v5
  v_lshl_add_u32 v4, v4, 4, v5
  v_add_u32 v251, s46, v4
  v_mov_b32 v6, 0
  s_mov_b32 s59, 0
  s_mov_b64 exec, 1
H_pollM:
  buffer_load_dword v7, v6, s[36:39], 0 offen offset:128 sc1
  s_waitcnt vmcnt(0)
  v_cmp_eq_u32 vcc, 0, v7
  s_add_u32 s59, s59, 1
  s_cmp_gt_u32 s59, 200000
  s_cbranch_scc1 H_pollM_x
  s_cmp_lg_u64 vcc, 0
  s_cbranch_scc0 H_pollM_x
  s_sleep 2
  s_branch H_pollM
H_pollM_x:
  s_mov_b64 exec, -1
  s_lshr_b32 s55, s2, 3
  s_mul_i32 s55, s55, 2304
  s_add_u32 s55, s55, 131072
  buffer_load_dwordx4 v[80:83], v252, s[24:27], s55 offen offset:0 sc1
  buffer_load_dwordx4 v[84:87], v252, s[24:27], s55 offen offset:1024 sc1
  buffer_load_dwordx4 v[88:91], v252, s[24:27], s55 offen offset:2048 sc1
  s_barrier
  s_lshl_b32 s55, s40, 10
  s_add_u32 s55, s55, 131072
  s_sub_u32 m0, s55, 40960
  s_nop 0
  buffer_load_dwordx4 v252, s[24:27], s55 offen sc1 lds
  s_add_u32 s55, s55, 8192
  s_sub_u32 m0, s55, 40960
  s_nop 0
  buffer_load_dwordx4 v252, s[24:27], s55 offen sc1 lds
  s_add_u32 s55, s55, 8192
  s_sub_u32 m0, s55, 40960
  s_nop 0
  buffer_load_dwordx4 v252, s[24:27], s55 offen sc1 lds
  s_add_u32 s55, s55, 8192
  s_sub_u32 m0, s55, 40960
  s_nop 0
  buffer_load_dwordx4 v252, s[24:27], s55 offen sc1 lds
  s_add_u32 s55, s55, 8192
  s_sub_u32 m0, s55, 40960
  s_nop 0
  buffer_load_dwordx4 v252, s[24:27], s55 offen sc1 lds
  s_add_u32 s55, s55, 8192
  s_sub_u32 m0, s55, 40960
  s_nop 0
  buffer_load_dwordx4 v252, s[24:27], s55 offen sc1 lds
  s_add_u32 s55, s55, 8192
  s_sub_u32 m0, s55, 40960
  s_nop 0
  buffer_load_dwordx4 v252, s[24:27], s55 offen sc1 lds
  s_add_u32 s55, s55, 8192
  s_sub_u32 m0, s55, 40960
  s_nop 0
  buffer_load_dwordx4 v252, s[24:27], s55 offen sc1 lds
  s_add_u32 s55, s55, 8192
  s_sub_u32 m0, s55, 40960
  s_nop 0
  buffer_load_dwordx4 v252, s[24:27], s55 offen sc1 lds
  s_waitcnt vmcnt(6)
  s_barrier
  v_mov_b32 v192, 1
  v_mov_b32 v193, 0
  s_waitcnt vmcnt(0)
  s_cmp_lt_u32 s2, 112
  s_cbranch_scc1 H_nov2
  v_mov_b32 v192, 1
  v_mov_b32 v193, 0
  s_mov_b64 exec, 1
  s_waitcnt vmcnt(0)
  buffer_atomic_add v192, v193, s[36:39], 0 offen offset:4 sc0 sc1
  s_mov_b64 exec, -1
H_nov2:
  s_add_i32 s56, s45, 0
  s_lshl_b32 s56, s56, 1
  s_add_i32 s56, s56, s41
  s_max_i32 s56, s56, 0
  s_min_i32 s56, s56, 223
  s_mul_i32 s56, s56, 86016
  s_mov_b32 m0, 0
  s_nop 0
  buffer_load_dwordx4 v232, s[16:19], s56 offen lds
  s_mov_b32 m0, 1024
  s_nop 0
  buffer_load_dwordx4 v233, s[16:19], s56 offen lds
  s_mov_b32 m0, 2048
  s_nop 0
  buffer_load_dwordx4 v234, s[16:19], s56 offen lds
  s_mov_b32 m0, 3072
  s_nop 0
  buffer_load_dwordx4 v235, s[16:19], s56 offen lds
  s_mov_b32 m0, 4096
  s_nop 0
  buffer_load_dwordx4 v236, s[16:19], s56 offen lds
  s_mov_b32 m0, 5120
  s_nop 0
  buffer_load_dwordx4 v237, s[16:19], s56 offen lds
  s_mov_b32 m0, 6144
  s_nop 0
  buffer_load_dwordx4 v238, s[16:19], s56 offen lds
  s_mov_b32 m0, 6656
  s_nop 0
  buffer_load_dwordx4 v239, s[16:19], s56 offen lds
  s_add_i32 s56, s45, 1
  s_lshl_b32 s56, s56, 1
  s_add_i32 s56, s56, s41
  s_max_i32 s56, s56, 0
  s_min_i32 s56, s56, 223
  s_mul_i32 s56, s56, 86016
  s_mov_b32 m0, 7680
  s_nop 0
  buffer_load_dwordx4 v244, s[16:19], s56 offen lds
  s_mov_b32 m0, 8704
  s_nop 0
  buffer_load_dwordx4 v245, s[16:19], s56 offen lds
  s_mov_b32 m0, 9728
  s_nop 0
  buffer_load_dwordx4 v246, s[16:19], s56 offen lds
  s_mov_b32 m0, 10752
  s_nop 0
  buffer_load_dwordx4 v247, s[16:19], s56 offen lds
  s_mov_b32 m0, 11776
  s_nop 0
  buffer_load_dwordx4 v248, s[16:19], s56 offen lds
  s_mov_b32 m0, 12800
  s_nop 0
  buffer_load_dwordx4 v249, s[16:19], s56 offen lds
  s_mov_b32 m0, 13824
  s_nop 0
  buffer_load_dwordx4 v250, s[16:19], s56 offen lds
  s_mov_b32 m0, 14336
  s_nop 0
  buffer_load_dwordx4 v251, s[16:19], s56 offen lds
  s_add_i32 s56, s45, 2
  s_lshl_b32 s56, s56, 1
  s_add_i32 s56, s56, s41
  s_max_i32 s56, s56, 0
  s_min_i32 s56, s56, 223
  s_mul_i32 s56, s56, 86016
  v_xor_b32 v64, 32, v232
  s_mov_b32 m0, 15360
  s_nop 0
  buffer_load_dwordx4 v64, s[16:19], s56 offen lds
  v_xor_b32 v65, 32, v233
  s_mov_b32 m0, 16384
  s_nop 0
  buffer_load_dwordx4 v65, s[16:19], s56 offen lds
  v_xor_b32 v66, 32, v234
  s_mov_b32 m0, 17408
  s_nop 0
  buffer_load_dwordx4 v66, s[16:19], s56 offen lds
  v_xor_b32 v67, 32, v235
  s_mov_b32 m0, 18432
  s_nop 0
  buffer_load_dwordx4 v67, s[16:19], s56 offen lds
  v_xor_b32 v68, 32, v236
  s_mov_b32 m0, 19456
  s_nop 0
  buffer_load_dwordx4 v68, s[16:19], s56 offen lds
  v_xor_b32 v69, 32, v237
  s_mov_b32 m0, 20480
  s_nop 0
  buffer_load_dwordx4 v69, s[16:19], s56 offen lds
  v_xor_b32 v70, 32, v238
  s_mov_b32 m0, 21504
  s_nop 0
  buffer_load_dwordx4 v70, s[16:19], s56 offen lds
  v_xor_b32 v71, 32, v239
  s_mov_b32 m0, 22016
  s_nop 0
  buffer_load_dwordx4 v71, s[16:19], s56 offen lds
  s_add_i32 s56, s45, 3
  s_lshl_b32 s56, s56, 1
  s_add_i32 s56, s56, s41
  s_max_i32 s56, s56, 0
  s_min_i32 s56, s56, 223
  s_mul_i32 s56, s56, 86016
  v_xor_b32 v64, 32, v244
  s_mov_b32 m0, 23040
  s_nop 0
  buffer_load_dwordx4 v64, s[16:19], s56 offen lds
  v_xor_b32 v65, 32, v245
  s_mov_b32 m0, 24064
  s_nop 0
  buffer_load_dwordx4 v65, s[16:19], s56 offen lds
  v_xor_b32 v66, 32, v246
  s_mov_b32 m0, 25088
  s_nop 0
  buffer_load_dwordx4 v66, s[16:19], s56 offen lds
  v_xor_b32 v67, 32, v247
  s_mov_b32 m0, 26112
  s_nop 0
  buffer_load_dwordx4 v67, s[16:19], s56 offen lds
  v_xor_b32 v68, 32, v248
  s_mov_b32 m0, 27136
  s_nop 0
  buffer_load_dwordx4 v68, s[16:19], s56 offen lds
  v_xor_b32 v69, 32, v249
  s_mov_b32 m0, 28160
  s_nop 0
  buffer_load_dwordx4 v69, s[16:19], s56 offen lds
  v_xor_b32 v70, 32, v250
  s_mov_b32 m0, 29184
  s_nop 0
  buffer_load_dwordx4 v70, s[16:19], s56 offen lds
  v_xor_b32 v71, 32, v251
  s_mov_b32 m0, 29696
  s_nop 0
  buffer_load_dwordx4 v71, s[16:19], s56 offen lds
  s_barrier
  s_add_i32 s56, s45, 4
  s_lshl_b32 s56, s56, 1
  s_add_i32 s56, s56, s41
  s_max_i32 s56, s56, 0
  s_min_i32 s56, s56, 223
  s_mul_i32 s56, s56, 86016
  v_xor_b32 v64, 64, v232
  s_mov_b32 m0, 30720
  s_nop 0
  buffer_load_dwordx4 v64, s[16:19], s56 offen lds
  v_xor_b32 v65, 64, v233
  s_mov_b32 m0, 31744
  s_nop 0
  buffer_load_dwordx4 v65, s[16:19], s56 offen lds
  v_xor_b32 v66, 64, v234
  s_mov_b32 m0, 32768
  s_nop 0
  buffer_load_dwordx4 v66, s[16:19], s56 offen lds
  v_xor_b32 v67, 64, v235
  s_mov_b32 m0, 33792
  s_nop 0
  buffer_load_dwordx4 v67, s[16:19], s56 offen lds
  v_xor_b32 v68, 64, v236
  s_mov_b32 m0, 34816
  s_nop 0
  buffer_load_dwordx4 v68, s[16:19], s56 offen lds
  v_xor_b32 v69, 64, v237
  s_mov_b32 m0, 35840
  s_nop 0
  buffer_load_dwordx4 v69, s[16:19], s56 offen lds
  v_xor_b32 v70, 64, v238
  s_mov_b32 m0, 36864
  s_nop 0
  buffer_load_dwordx4 v70, s[16:19], s56 offen lds
  v_xor_b32 v71, 64, v239
  s_mov_b32 m0, 37376
  s_nop 0
  buffer_load_dwordx4 v71, s[16:19], s56 offen lds
  s_add_i32 s56, s45, 5
  s_lshl_b32 s56, s56, 1
  s_add_i32 s56, s56, s41
  s_max_i32 s56, s56, 0
  s_min_i32 s56, s56, 223
  s_mul_i32 s56, s56, 86016
  v_xor_b32 v64, 64, v244
  s_mov_b32 m0, 38400
  s_nop 0
  buffer_load_dwordx4 v64, s[16:19], s56 offen lds
  v_xor_b32 v65, 64, v245
  s_mov_b32 m0, 39424
  s_nop 0
  buffer_load_dwordx4 v65, s[16:19], s56 offen lds
  v_xor_b32 v66, 64, v246
  s_mov_b32 m0, 40448
  s_nop 0
  buffer_load_dwordx4 v66, s[16:19], s56 offen lds
  v_xor_b32 v67, 64, v247
  s_mov_b32 m0, 41472
  s_nop 0
  buffer_load_dwordx4 v67, s[16:19], s56 offen lds
  v_xor_b32 v68, 64, v248
  s_mov_b32 m0, 42496
  s_nop 0
  buffer_load_dwordx4 v68, s[16:19], s56 offen lds
  v_xor_b32 v69, 64, v249
  s_mov_b32 m0, 43520
  s_nop 0
  buffer_load_dwordx4 v69, s[16:19], s56 offen lds
  v_xor_b32 v70, 64, v250
  s_mov_b32 m0, 44544
  s_nop 0
  buffer_load_dwordx4 v70, s[16:19], s56 offen lds
  v_xor_b32 v71, 64, v251
  s_mov_b32 m0, 45056
  s_nop 0
  buffer_load_dwordx4 v71, s[16:19], s56 offen lds
  s_add_i32 s56, s45, 6
  s_lshl_b32 s56, s56, 1
  s_add_i32 s56, s56, s41
  s_max_i32 s56, s56, 0
  s_min_i32 s56, s56, 223
  s_mul_i32 s56, s56, 86016
  v_xor_b32 v64, 96, v232
  s_mov_b32 m0, 46080
  s_nop 0
  buffer_load_dwordx4 v64, s[16:19], s56 offen lds
  v_xor_b32 v65, 96, v233
  s_mov_b32 m0, 47104
  s_nop 0
  buffer_load_dwordx4 v65, s[16:19], s56 offen lds
  v_xor_b32 v66, 96, v234
  s_mov_b32 m0, 48128
  s_nop 0
  buffer_load_dwordx4 v66, s[16:19], s56 offen lds
  v_xor_b32 v67, 96, v235
  s_mov_b32 m0, 49152
  s_nop 0
  buffer_load_dwordx4 v67, s[16:19], s56 offen lds
  v_xor_b32 v68, 96, v236
  s_mov_b32 m0, 50176
  s_nop 0
  buffer_load_dwordx4 v68, s[16:19], s56 offen lds
  v_xor_b32 v69, 96, v237
  s_mov_b32 m0, 51200
  s_nop 0
  buffer_load_dwordx4 v69, s[16:19], s56 offen lds
  v_xor_b32 v70, 96, v238
  s_mov_b32 m0, 52224
  s_nop 0
  buffer_load_dwordx4 v70, s[16:19], s56 offen lds
  v_xor_b32 v71, 96, v239
  s_mov_b32 m0, 52736
  s_nop 0
  buffer_load_dwordx4 v71, s[16:19], s56 offen lds
  s_waitcnt vmcnt(40)
  s_add_i32 s56, s45, 7
  s_lshl_b32 s56, s56, 1
  s_add_i32 s56, s56, s41
  s_max_i32 s56, s56, 0
  s_min_i32 s56, s56, 223
  s_mul_i32 s56, s56, 86016
  v_xor_b32 v64, 96, v244
  s_mov_b32 m0, 53760
  s_nop 0
  buffer_load_dwordx4 v64, s[16:19], s56 offen lds
  v_xor_b32 v65, 96, v245
  s_mov_b32 m0, 54784
  s_nop 0
  buffer_load_dwordx4 v65, s[16:19], s56 offen lds
  v_xor_b32 v66, 96, v246
  s_mov_b32 m0, 55808
  s_nop 0
  buffer_load_dwordx4 v66, s[16:19], s56 offen lds
  v_xor_b32 v67, 96, v247
  s_mov_b32 m0, 56832
  s_nop 0
  buffer_load_dwordx4 v67, s[16:19], s56 offen lds
  v_xor_b32 v68, 96, v248
  s_mov_b32 m0, 57856
  s_nop 0
  buffer_load_dwordx4 v68, s[16:19], s56 offen lds
  v_xor_b32 v69, 96, v249
  s_mov_b32 m0, 58880
  s_nop 0
  buffer_load_dwordx4 v69, s[16:19], s56 offen lds
  v_xor_b32 v70, 96, v250
  s_mov_b32 m0, 59904
  s_nop 0
  buffer_load_dwordx4 v70, s[16:19], s56 offen lds
  v_xor_b32 v71, 96, v251
  s_mov_b32 m0, 60416
  s_nop 0
  buffer_load_dwordx4 v71, s[16:19], s56 offen lds
  s_add_i32 s56, s45, 8
  s_lshl_b32 s56, s56, 1
  s_add_i32 s56, s56, s41
  s_max_i32 s56, s56, 0
  s_min_i32 s56, s56, 223
  s_mul_i32 s56, s56, 86016
  s_mov_b32 m0, 61440
  s_nop 0
  buffer_load_dwordx4 v232, s[16:19], s56 offen lds
  s_mov_b32 m0, 62464
  s_nop 0
  buffer_load_dwordx4 v233, s[16:19], s56 offen lds
  s_mov_b32 m0, 63488
  s_nop 0
  buffer_load_dwordx4 v234, s[16:19], s56 offen lds
  s_mov_b32 m0, 64512
  s_nop 0
  buffer_load_dwordx4 v235, s[16:19], s56 offen lds
  s_mov_b32 m0, 65536
  s_nop 0
  buffer_load_dwordx4 v236, s[16:19], s56 offen lds
  s_mov_b32 m0, 66560
  s_nop 0
  buffer_load_dwordx4 v237, s[16:19], s56 offen lds
  s_mov_b32 m0, 67584
  s_nop 0
  buffer_load_dwordx4 v238, s[16:19], s56 offen lds
  s_mov_b32 m0, 68096
  s_nop 0
  buffer_load_dwordx4 v239, s[16:19], s56 offen lds
  s_waitcnt vmcnt(40)
  v_readfirstlane_b32 s56, v192
  s_nop 0
  s_cmp_lg_u32 s56, 143
  s_cbranch_scc1 H_p2
  s_mov_b64 exec, 1
  buffer_store_dword v192, v193, s[36:39], 0 offen offset:132 sc1
  s_mov_b64 exec, -1
H_p2:
  s_barrier
  s_waitcnt vmcnt(0)
  s_barrier
  s_add_i32 s56, s45, 16
  s_lshl_b32 s56, s56, 1
  s_add_i32 s56, s56, s41
  s_max_i32 s56, s56, 0
  s_min_i32 s56, s56, 223
  s_mul_i32 s56, s56, 86016
  s_mov_b32 m0, 122880
  s_nop 0
  buffer_load_dwordx4 v232, s[16:19], s56 offen lds
  s_mov_b32 m0, 123904
  s_nop 0
  buffer_load_dwordx4 v233, s[16:19], s56 offen lds
  s_mov_b32 m0, 124928
  s_nop 0
  buffer_load_dwordx4 v234, s[16:19], s56 offen lds
  s_mov_b32 m0, 125952
  s_nop 0
  buffer_load_dwordx4 v235, s[16:19], s56 offen lds
  s_mov_b32 m0, 126976
  s_nop 0
  buffer_load_dwordx4 v236, s[16:19], s56 offen lds
  s_mov_b32 m0, 128000
  s_nop 0
  buffer_load_dwordx4 v237, s[16:19], s56 offen lds
  s_mov_b32 m0, 129024
  s_nop 0
  buffer_load_dwordx4 v238, s[16:19], s56 offen lds
  s_mov_b32 m0, 129536
  s_nop 0
  buffer_load_dwordx4 v239, s[16:19], s56 offen lds
  s_add_i32 s56, s45, 17
  s_lshl_b32 s56, s56, 1
  s_add_i32 s56, s56, s41
  s_max_i32 s56, s56, 0
  s_min_i32 s56, s56, 223
  s_mul_i32 s56, s56, 86016
  s_mov_b32 m0, 130560
  s_nop 0
  buffer_load_dwordx4 v244, s[16:19], s56 offen lds
  s_mov_b32 m0, 131584
  s_nop 0
  buffer_load_dwordx4 v245, s[16:19], s56 offen lds
  s_mov_b32 m0, 132608
  s_nop 0
  buffer_load_dwordx4 v246, s[16:19], s56 offen lds
  s_mov_b32 m0, 133632
  s_nop 0
  buffer_load_dwordx4 v247, s[16:19], s56 offen lds
  s_mov_b32 m0, 134656
  s_nop 0
  buffer_load_dwordx4 v248, s[16:19], s56 offen lds
  s_mov_b32 m0, 135680
  s_nop 0
  buffer_load_dwordx4 v249, s[16:19], s56 offen lds
  s_mov_b32 m0, 136704
  s_nop 0
  buffer_load_dwordx4 v250, s[16:19], s56 offen lds
  s_mov_b32 m0, 137216
  s_nop 0
  buffer_load_dwordx4 v251, s[16:19], s56 offen lds
  s_add_i32 s56, s45, 18
  s_lshl_b32 s56, s56, 1
  s_add_i32 s56, s56, s41
  s_max_i32 s56, s56, 0
  s_min_i32 s56, s56, 223
  s_mul_i32 s56, s56, 86016
  v_xor_b32 v64, 32, v232
  s_mov_b32 m0, 138240
  s_nop 0
  buffer_load_dwordx4 v64, s[16:19], s56 offen lds
  v_xor_b32 v65, 32, v233
  s_mov_b32 m0, 139264
  s_nop 0
  buffer_load_dwordx4 v65, s[16:19], s56 offen lds
  v_xor_b32 v66, 32, v234
  s_mov_b32 m0, 140288
  s_nop 0
  buffer_load_dwordx4 v66, s[16:19], s56 offen lds
  v_xor_b32 v67, 32, v235
  s_mov_b32 m0, 141312
  s_nop 0
  buffer_load_dwordx4 v67, s[16:19], s56 offen lds
  v_xor_b32 v68, 32, v236
  s_mov_b32 m0, 142336
  s_nop 0
  buffer_load_dwordx4 v68, s[16:19], s56 offen lds
  v_xor_b32 v69, 32, v237
  s_mov_b32 m0, 143360
  s_nop 0
  buffer_load_dwordx4 v69, s[16:19], s56 offen lds
  v_xor_b32 v70, 32, v238
  s_mov_b32 m0, 144384
  s_nop 0
  buffer_load_dwordx4 v70, s[16:19], s56 offen lds
  v_xor_b32 v71, 32, v239
  s_mov_b32 m0, 144896
  s_nop 0
  buffer_load_dwordx4 v71, s[16:19], s56 offen lds
  s_add_i32 s56, s45, 19
  s_lshl_b32 s56, s56, 1
  s_add_i32 s56, s56, s41
  s_max_i32 s56, s56, 0
  s_min_i32 s56, s56, 223
  s_mul_i32 s56, s56, 86016
  v_xor_b32 v64, 32, v244
  s_mov_b32 m0, 145920
  s_nop 0
  buffer_load_dwordx4 v64, s[16:19], s56 offen lds
  v_xor_b32 v65, 32, v245
  s_mov_b32 m0, 146944
  s_nop 0
  buffer_load_dwordx4 v65, s[16:19], s56 offen lds
  v_xor_b32 v66, 32, v246
  s_mov_b32 m0, 147968
  s_nop 0
  buffer_load_dwordx4 v66, s[16:19], s56 offen lds
  v_xor_b32 v67, 32, v247
  s_mov_b32 m0, 148992
  s_nop 0
  buffer_load_dwordx4 v67, s[16:19], s56 offen lds
  v_xor_b32 v68, 32, v248
  s_mov_b32 m0, 150016
  s_nop 0
  buffer_load_dwordx4 v68, s[16:19], s56 offen lds
  v_xor_b32 v69, 32, v249
  s_mov_b32 m0, 151040
  s_nop 0
  buffer_load_dwordx4 v69, s[16:19], s56 offen lds
  v_xor_b32 v70, 32, v250
  s_mov_b32 m0, 152064
  s_nop 0
  buffer_load_dwordx4 v70, s[16:19], s56 offen lds
  v_xor_b32 v71, 32, v251
  s_mov_b32 m0, 152576
  s_nop 0
  buffer_load_dwordx4 v71, s[16:19], s56 offen lds
  s_waitcnt vmcnt(0)
  v_mov_b32 v6, 0
  s_mov_b32 s59, 0
  s_mov_b64 exec, 1
H_pollV:
  buffer_load_dword v7, v6, s[36:39], 0 offen offset:132 sc1
  s_waitcnt vmcnt(0)
  v_cmp_eq_u32 vcc, 0, v7
  s_add_u32 s59, s59, 1
  s_cmp_gt_u32 s59, 200000
  s_cbranch_scc1 H_pollV_x
  s_cmp_lg_u64 vcc, 0
  s_cbranch_scc0 H_pollV_x
  s_sleep 2
  s_branch H_pollV
H_pollV_x:
  s_mov_b64 exec, -1
  s_lshr_b32 s55, s2, 3
  s_mul_i32 s55, s55, 2304
  buffer_load_dwordx4 v[80:83], v252, s[24:27], s55 offen offset:0 sc1
  buffer_load_dwordx4 v[84:87], v252, s[24:27], s55 offen offset:1024 sc1
  buffer_load_dwordx4 v[88:91], v252, s[24:27], s55 offen offset:2048 sc1
  s_barrier
  s_mov_b32 m0, 153600
  s_mov_b32 s59, 0
  buffer_load_dwordx4 v252, s[24:27], s59 offen offset:0 sc1 lds
  buffer_load_dwordx4 v252, s[24:27], s59 offen offset:1024 sc1 lds
  buffer_load_dwordx4 v252, s[24:27], s59 offen offset:2048 sc1 lds
  buffer_load_dwordx4 v252, s[24:27], s59 offen offset:3072 sc1 lds
  s_mov_b32 m0, 157696
  s_mov_b32 s59, 4096
  buffer_load_dwordx4 v252, s[24:27], s59 offen offset:0 sc1 lds
  buffer_load_dwordx4 v252, s[24:27], s59 offen offset:1024 sc1 lds
  buffer_load_dwordx4 v252, s[24:27], s59 offen offset:2048 sc1 lds
  buffer_load_dwordx4 v252, s[24:27], s59 offen offset:3072 sc1 lds
  s_mov_b32 m0, 161792
  s_mov_b32 s59, 8192
  buffer_load_dwordx4 v252, s[24:27], s59 offen offset:0 sc1 lds
  buffer_load_dwordx4 v252, s[24:27], s59 offen offset:1024 sc1 lds
  s_waitcnt vmcnt(0)
  s_barrier
  s_mov_b32 m0, 0
  s_mov_b32 s59, 24576
  buffer_load_dwordx4 v252, s[24:27], s59 offen offset:0 sc1 lds
  buffer_load_dwordx4 v252, s[24:27], s59 offen offset:1024 sc1 lds
  buffer_load_dwordx4 v252, s[24:27], s59 offen offset:2048 sc1 lds
  buffer_load_dwordx4 v252, s[24:27], s59 offen offset:3072 sc1 lds
  s_mov_b32 m0, 4096
  s_mov_b32 s59, 28672
  buffer_load_dwordx4 v252, s[24:27], s59 offen offset:0 sc1 lds
  buffer_load_dwordx4 v252, s[24:27], s59 offen offset:1024 sc1 lds
  buffer_load_dwordx4 v252, s[24:27], s59 offen offset:2048 sc1 lds
  buffer_load_dwordx4 v252, s[24:27], s59 offen offset:3072 sc1 lds
  s_mov_b32 m0, 8192
  s_mov_b32 s59, 32768
  buffer_load_dwordx4 v252, s[24:27], s59 offen offset:0 sc1 lds
  buffer_load_dwordx4 v252, s[24:27], s59 offen offset:1024 sc1 lds
  buffer_load_dwordx4 v252, s[24:27], s59 offen offset:2048 sc1 lds
  buffer_load_dwordx4 v252, s[24:27], s59 offen offset:3072 sc1 lds
  s_waitcnt vmcnt(0)
  s_barrier
M_done:
  s_endpgm
CODE_END:
.section .rodata,"a"
.p2align 6
.amdhsa_kernel standalone__neighborhood_nat__vision_kernel
  .amdhsa_next_free_vgpr 256
  .amdhsa_next_free_sgpr 102
  .amdhsa_accum_offset 256
  .amdhsa_group_segment_fixed_size 0
  .amdhsa_kernarg_size 48
  .amdhsa_user_sgpr_count 2
  .amdhsa_user_sgpr_kernarg_segment_ptr 1
  .amdhsa_system_sgpr_workgroup_id_x 1
.end_amdhsa_kernel
```

```asm
; @launch grid=(256,1,1) block=(512,1,1) lds=163840
.amdgcn_target "amdgcn-amd-amdhsa--gfx950"
.text
.globl standalone__neighborhood_nat__vision_kernel
.p2align 8
.type standalone__neighborhood_nat__vision_kernel,@function
standalone__neighborhood_nat__vision_kernel:
  s_cmp_ge_u32 s2, 256
  s_cbranch_scc1 M_done
  s_load_dwordx8 s[4:11], s[0:1], 0
  s_load_dwordx4 s[12:15], s[0:1], 32
  v_lshrrev_b32 v4, 6, v0
  v_and_b32 v1, 63, v0
  v_readfirstlane_b32 s40, v4
  v_lshrrev_b32 v2, 4, v1
  v_and_b32 v3, 15, v1
  v_lshlrev_b32 v252, 4, v1
  s_getpc_b64 s[16:17]
  s_and_b32 s16, s16, -256
  s_and_b32 s17, s17, 0xffff
  s_mov_b32 s18, CODE_END-standalone__neighborhood_nat__vision_kernel
  s_mov_b32 s19, 0x00020000
  s_lshr_b32 s55, s2, 3
  s_lshl_b32 s55, s55, 10
  s_cmp_lg_u32 s40, 3
  s_cbranch_scc1 M_nocpf
  buffer_load_dwordx4 v[136:139], v252, s[16:19], s55 offen
M_nocpf:
  s_cmp_lg_u32 s40, 0
  s_cbranch_scc1 M_comp
  v_bfe_u32 v5, v1, 2, 2
  v_lshrrev_b32 v6, 5, v1
  v_lshlrev_b32 v7, 1, v6
  v_and_b32 v8, 3, v1
  v_xor_b32 v7, v7, v8
  v_lshlrev_b32 v7, 4, v7
  s_movk_i32 s60, 1152
  v_lshl_add_u32 v4, v2, 3, v5
  v_mad_u32_u24 v200, v4, s60, v7
  v_lshrrev_b32 v4, 2, v1
  v_mad_u32_u24 v203, v4, s60, v7
  v_lshrrev_b32 v4, 3, v3
  v_lshlrev_b32 v4, 1, v4
  v_xor_b32 v4, v4, v2
  v_lshl_add_u32 v4, v3, 2, v4
  v_lshlrev_b32 v195, 4, v4
  v_add_u32 v195, 90112, v195
  s_waitcnt lgkmcnt(0)
  s_mov_b32 s28, s6
  s_and_b32 s29, s7, 0xffff
  s_mov_b32 s30, 221184
  s_mov_b32 s31, 0x00020000
  s_cmp_ge_u32 s2, 36
  s_cbranch_scc1 H_nom
  s_mul_hi_u32 s55, s2, 0x2aaaaaab
  s_mul_i32 s56, s55, 6
  s_sub_u32 s56, s2, s56
  s_mul_i32 s55, s55, 36864
  s_mul_i32 s56, s56, 36864
  s_mov_b32 m0, 90112
  s_nop 0
  buffer_load_dwordx4 v200, s[28:31], s56 offen offset:0 lds
  s_mov_b32 m0, 102016
  s_nop 0
  buffer_load_dwordx4 v200, s[28:31], s55 offen offset:384 lds
  s_mov_b32 m0, 91072
  s_nop 0
  buffer_load_dwordx4 v200, s[28:31], s56 offen offset:64 lds
  s_mov_b32 m0, 102976
  s_nop 0
  buffer_load_dwordx4 v200, s[28:31], s55 offen offset:448 lds
  s_mov_b32 m0, 92032
  s_nop 0
  buffer_load_dwordx4 v200, s[28:31], s56 offen offset:128 lds
  s_mov_b32 m0, 103936
  s_nop 0
  buffer_load_dwordx4 v200, s[28:31], s55 offen offset:512 lds
  s_mov_b32 m0, 92992
  s_nop 0
  buffer_load_dwordx4 v200, s[28:31], s56 offen offset:192 lds
  s_mov_b32 m0, 104896
  s_nop 0
  buffer_load_dwordx4 v200, s[28:31], s55 offen offset:576 lds
  s_mov_b32 m0, 93952
  s_nop 0
  buffer_load_dwordx4 v200, s[28:31], s56 offen offset:256 lds
  s_mov_b32 m0, 105856
  s_nop 0
  buffer_load_dwordx4 v200, s[28:31], s55 offen offset:640 lds
  s_mov_b32 m0, 94912
  s_nop 0
  buffer_load_dwordx4 v200, s[28:31], s56 offen offset:320 lds
  s_mov_b32 m0, 106816
  s_nop 0
  buffer_load_dwordx4 v200, s[28:31], s55 offen offset:704 lds
  s_add_u32 s55, s55, 4608
  s_add_u32 s56, s56, 4608
  s_mov_b32 m0, 96256
  s_nop 0
  buffer_load_dwordx4 v200, s[28:31], s56 offen offset:0 lds
  s_mov_b32 m0, 108160
  s_nop 0
  buffer_load_dwordx4 v200, s[28:31], s55 offen offset:384 lds
  s_mov_b32 m0, 97216
  s_nop 0
  buffer_load_dwordx4 v200, s[28:31], s56 offen offset:64 lds
  s_mov_b32 m0, 109120
  s_nop 0
  buffer_load_dwordx4 v200, s[28:31], s55 offen offset:448 lds
  s_mov_b32 m0, 98176
  s_nop 0
  buffer_load_dwordx4 v200, s[28:31], s56 offen offset:128 lds
  s_mov_b32 m0, 110080
  s_nop 0
  buffer_load_dwordx4 v200, s[28:31], s55 offen offset:512 lds
  s_mov_b32 m0, 99136
  s_nop 0
  buffer_load_dwordx4 v200, s[28:31], s56 offen offset:192 lds
  s_mov_b32 m0, 111040
  s_nop 0
  buffer_load_dwordx4 v200, s[28:31], s55 offen offset:576 lds
  s_mov_b32 m0, 100096
  s_nop 0
  buffer_load_dwordx4 v200, s[28:31], s56 offen offset:256 lds
  s_mov_b32 m0, 112000
  s_nop 0
  buffer_load_dwordx4 v200, s[28:31], s55 offen offset:640 lds
  s_mov_b32 m0, 101056
  s_nop 0
  buffer_load_dwordx4 v200, s[28:31], s56 offen offset:320 lds
  s_mov_b32 m0, 112960
  s_nop 0
  buffer_load_dwordx4 v200, s[28:31], s55 offen offset:704 lds
  s_barrier
  s_mov_b32 s16, s4
  s_and_b32 s17, s5, 0xffff
  s_mov_b32 s18, 19267584
  s_mov_b32 s19, 0x00020000
  s_mov_b32 s24, s14
  s_and_b32 s25, s15, 0xffff
  s_mov_b32 s26, 268435456
  s_mov_b32 s27, 0x00020000
  s_mov_b32 s20, s10
  s_and_b32 s21, s11, 0xffff
  s_mov_b32 s22, 19267584
  s_mov_b32 s23, 0x00020000
  s_mov_b32 s36, s12
  s_and_b32 s37, s13, 0xffff
  s_mov_b32 s38, 256
  s_mov_b32 s39, 0x00020000
  s_lshl_b32 s55, s2, 11
  s_add_u32 s55, s55, 131072
  s_waitcnt vmcnt(0)
  ds_read_b128 v[64:67], v195 offset:0
  ds_read_b128 v[88:91], v195 offset:6144
  ds_read_b128 v[112:115], v195 offset:12288
  ds_read_b128 v[136:139], v195 offset:18432
  ds_read_b128 v[68:71], v195 offset:1024
  ds_read_b128 v[92:95], v195 offset:7168
  ds_read_b128 v[116:119], v195 offset:13312
  ds_read_b128 v[140:143], v195 offset:19456
  ds_read_b128 v[72:75], v195 offset:2048
  ds_read_b128 v[96:99], v195 offset:8192
  ds_read_b128 v[120:123], v195 offset:14336
  ds_read_b128 v[144:147], v195 offset:20480
  s_waitcnt lgkmcnt(9)
  v_mfma_f32_16x16x32_bf16 v[160:163], v[64:67], v[112:115], 0
  v_mfma_f32_16x16x32_bf16 v[164:167], v[88:91], v[112:115], 0
  s_waitcnt lgkmcnt(8)
  v_mfma_f32_16x16x32_bf16 v[168:171], v[64:67], v[136:139], 0
  v_mfma_f32_16x16x32_bf16 v[172:175], v[88:91], v[136:139], 0
  ds_read_b128 v[76:79], v195 offset:3072
  ds_read_b128 v[100:103], v195 offset:9216
  ds_read_b128 v[124:127], v195 offset:15360
  ds_read_b128 v[148:151], v195 offset:21504
  s_waitcnt lgkmcnt(9)
  v_mfma_f32_16x16x32_bf16 v[160:163], v[68:71], v[116:119], v[160:163]
  v_mfma_f32_16x16x32_bf16 v[164:167], v[92:95], v[116:119], v[164:167]
  s_waitcnt lgkmcnt(8)
  v_mfma_f32_16x16x32_bf16 v[168:171], v[68:71], v[140:143], v[168:171]
  v_mfma_f32_16x16x32_bf16 v[172:175], v[92:95], v[140:143], v[172:175]
  ds_read_b128 v[80:83], v195 offset:4096
  ds_read_b128 v[104:107], v195 offset:10240
  ds_read_b128 v[128:131], v195 offset:16384
  ds_read_b128 v[152:155], v195 offset:22528
  s_waitcnt lgkmcnt(9)
  v_mfma_f32_16x16x32_bf16 v[160:163], v[72:75], v[120:123], v[160:163]
  v_mfma_f32_16x16x32_bf16 v[164:167], v[96:99], v[120:123], v[164:167]
  s_waitcnt lgkmcnt(8)
  v_mfma_f32_16x16x32_bf16 v[168:171], v[72:75], v[144:147], v[168:171]
  v_mfma_f32_16x16x32_bf16 v[172:175], v[96:99], v[144:147], v[172:175]
  ds_read_b128 v[84:87], v195 offset:5120
  ds_read_b128 v[108:111], v195 offset:11264
  ds_read_b128 v[132:135], v195 offset:17408
  ds_read_b128 v[156:159], v195 offset:23552
  s_waitcnt lgkmcnt(9)
  v_mfma_f32_16x16x32_bf16 v[160:163], v[76:79], v[124:127], v[160:163]
  v_mfma_f32_16x16x32_bf16 v[164:167], v[100:103], v[124:127], v[164:167]
  s_waitcnt lgkmcnt(8)
  v_mfma_f32_16x16x32_bf16 v[168:171], v[76:79], v[148:151], v[168:171]
  v_mfma_f32_16x16x32_bf16 v[172:175], v[100:103], v[148:151], v[172:175]
  s_waitcnt lgkmcnt(5)
  v_mfma_f32_16x16x32_bf16 v[160:163], v[80:83], v[128:131], v[160:163]
  v_mfma_f32_16x16x32_bf16 v[164:167], v[104:107], v[128:131], v[164:167]
  s_waitcnt lgkmcnt(4)
  v_mfma_f32_16x16x32_bf16 v[168:171], v[80:83], v[152:155], v[168:171]
  v_mfma_f32_16x16x32_bf16 v[172:175], v[104:107], v[152:155], v[172:175]
  s_waitcnt lgkmcnt(1)
  v_mfma_f32_16x16x32_bf16 v[160:163], v[84:87], v[132:135], v[160:163]
  v_mfma_f32_16x16x32_bf16 v[164:167], v[108:111], v[132:135], v[164:167]
  s_waitcnt lgkmcnt(0)
  v_mfma_f32_16x16x32_bf16 v[168:171], v[84:87], v[156:159], v[168:171]
  v_mfma_f32_16x16x32_bf16 v[172:175], v[108:111], v[156:159], v[172:175]
  s_nop 3
  v_cvt_pk_bf16_f32 v176, v160, v161
  v_cvt_pk_bf16_f32 v177, v162, v163
  v_cvt_pk_bf16_f32 v178, v164, v165
  v_cvt_pk_bf16_f32 v179, v166, v167
  buffer_store_dwordx4 v[176:179], v252, s[24:27], s55 offen offset:0 sc1
  v_cvt_pk_bf16_f32 v180, v168, v169
  v_cvt_pk_bf16_f32 v181, v170, v171
  v_cvt_pk_bf16_f32 v182, v172, v173
  v_cvt_pk_bf16_f32 v183, v174, v175
  buffer_store_dwordx4 v[180:183], v252, s[24:27], s55 offen offset:1024 sc1
  v_mov_b32 v192, 1
  v_mov_b32 v193, 0
  s_mov_b64 exec, 1
  s_waitcnt vmcnt(0)
  buffer_atomic_add v192, v193, s[36:39], 0 offen offset:0 sc0 sc1
  s_mov_b64 exec, -1
  s_barrier
  s_waitcnt vmcnt(0)
  v_readfirstlane_b32 s56, v192
  s_nop 0
  s_cmp_lg_u32 s56, 35
  s_cbranch_scc1 H_p1
  s_mov_b64 exec, 1
  buffer_store_dword v192, v193, s[36:39], 0 offen offset:128 sc1
  s_mov_b64 exec, -1
H_p1:
  s_barrier
  s_branch H_join
H_nom:
  s_mov_b32 s32, s8
  s_and_b32 s33, s9, 0xffff
  s_mov_b32 s34, 73728
  s_mov_b32 s35, 0x00020000
  s_cmp_lt_u32 s2, 112
  s_cbranch_scc1 H_nov1
  s_sub_u32 s58, s2, 112
  s_mul_hi_u32 s55, s58, 0x15555556
  s_mul_i32 s56, s55, 12
  s_sub_u32 s56, s58, s56
  s_mul_i32 s57, s55, 18432
  s_mov_b32 m0, 91392
  s_nop 0
  buffer_load_dwordx4 v203, s[28:31], s57 offen offset:768 lds
  s_mov_b32 m0, 92352
  s_nop 0
  buffer_load_dwordx4 v203, s[28:31], s57 offen offset:832 lds
  s_mov_b32 m0, 93312
  s_nop 0
  buffer_load_dwordx4 v203, s[28:31], s57 offen offset:896 lds
  s_mov_b32 m0, 94272
  s_nop 0
  buffer_load_dwordx4 v203, s[28:31], s57 offen offset:960 lds
  s_mov_b32 m0, 95232
  s_nop 0
  buffer_load_dwordx4 v203, s[28:31], s57 offen offset:1024 lds
  s_mov_b32 m0, 96192
  s_nop 0
  buffer_load_dwordx4 v203, s[28:31], s57 offen offset:1088 lds
  v_lshrrev_b32 v112, 1, v1
  v_mul_u32_u24 v112, 384, v112
  v_and_b32 v113, 1, v1
  v_lshl_add_u32 v112, v113, 4, v112
  s_lshl_b32 s57, s56, 5
  s_mov_b32 m0, 98304
  s_nop 0
  buffer_load_dwordx4 v112, s[32:35], s57 offen lds
  s_add_u32 s57, s57, 12288
  s_mov_b32 m0, 99328
  s_nop 0
  buffer_load_dwordx4 v112, s[32:35], s57 offen lds
  s_add_u32 s57, s57, 12288
  s_mov_b32 m0, 100352
  s_nop 0
  buffer_load_dwordx4 v112, s[32:35], s57 offen lds
  s_add_u32 s57, s57, 12288
  s_mov_b32 m0, 101376
  s_nop 0
  buffer_load_dwordx4 v112, s[32:35], s57 offen lds
  s_add_u32 s57, s57, 12288
  s_mov_b32 m0, 102400
  s_nop 0
  buffer_load_dwordx4 v112, s[32:35], s57 offen lds
  s_add_u32 s57, s57, 12288
  s_mov_b32 m0, 103424
  s_nop 0
  buffer_load_dwordx4 v112, s[32:35], s57 offen lds
  s_add_u32 s57, s57, 12288
  s_lshr_b32 s57, s56, 2
  s_mul_i32 s95, s57, 24576
  s_and_b32 s56, s56, 3
  s_lshl_b32 s56, s56, 6
  s_add_u32 s95, s95, s56
  s_lshr_b32 s56, s55, 1
  s_lshl_b32 s56, s56, 11
  s_add_u32 s95, s95, s56
  s_and_b32 s55, s55, 1
  s_lshl_b32 s55, s55, 3
  s_add_u32 s95, s95, s55
H_nov1:
  s_barrier
  s_mov_b32 s16, s4
  s_and_b32 s17, s5, 0xffff
  s_mov_b32 s18, 19267584
  s_mov_b32 s19, 0x00020000
  s_mov_b32 s24, s14
  s_and_b32 s25, s15, 0xffff
  s_mov_b32 s26, 268435456
  s_mov_b32 s27, 0x00020000
  s_mov_b32 s20, s10
  s_and_b32 s21, s11, 0xffff
  s_mov_b32 s22, 19267584
  s_mov_b32 s23, 0x00020000
  s_mov_b32 s36, s12
  s_and_b32 s37, s13, 0xffff
  s_mov_b32 s38, 256
  s_mov_b32 s39, 0x00020000
  s_cmp_lt_u32 s2, 112
  s_cbranch_scc1 H_join
  v_lshlrev_b32 v119, 3, v3
  v_lshl_add_u32 v119, v2, 8, v119
  v_add_u32 v119, 90112, v119
  s_waitcnt vmcnt(0)
  ds_read_b128 v[64:67], v195 offset:2048
  ds_read_b128 v[68:71], v195 offset:3072
  ds_read_b128 v[72:75], v195 offset:4096
  ds_read_b128 v[76:79], v195 offset:5120
  ds_read_b128 v[80:83], v195 offset:6144
  ds_read_b128 v[84:87], v195 offset:7168
  s_waitcnt lgkmcnt(2)
  ds_read_b64_tr_b16 v[88:89], v119 offset:8192
  ds_read_b64_tr_b16 v[90:91], v119 offset:8320
  ds_read_b64_tr_b16 v[92:93], v119 offset:9216
  ds_read_b64_tr_b16 v[94:95], v119 offset:9344
  ds_read_b64_tr_b16 v[96:97], v119 offset:10240
  ds_read_b64_tr_b16 v[98:99], v119 offset:10368
  ds_read_b64_tr_b16 v[100:101], v119 offset:11264
  ds_read_b64_tr_b16 v[102:103], v119 offset:11392
  ds_read_b64_tr_b16 v[104:105], v119 offset:12288
  ds_read_b64_tr_b16 v[106:107], v119 offset:12416
  ds_read_b64_tr_b16 v[108:109], v119 offset:13312
  ds_read_b64_tr_b16 v[110:111], v119 offset:13440
  s_waitcnt lgkmcnt(0)
  v_mfma_f32_16x16x32_bf16 v[112:115], v[64:67], v[88:91], 0
  v_mfma_f32_16x16x32_bf16 v[112:115], v[68:71], v[92:95], v[112:115]
  v_mfma_f32_16x16x32_bf16 v[112:115], v[72:75], v[96:99], v[112:115]
  v_mfma_f32_16x16x32_bf16 v[112:115], v[76:79], v[100:103], v[112:115]
  v_mfma_f32_16x16x32_bf16 v[112:115], v[80:83], v[104:107], v[112:115]
  v_mfma_f32_16x16x32_bf16 v[112:115], v[84:87], v[108:111], v[112:115]
  v_bfe_u32 v118, v3, 1, 1
  v_mul_u32_u24 v118, 12288, v118
  v_and_b32 v119, 1, v3
  v_lshl_add_u32 v118, v119, 10, v118
  v_lshrrev_b32 v119, 2, v3
  v_lshl_add_u32 v118, v119, 4, v118
  v_lshl_add_u32 v118, v2, 8, v118
  s_nop 0
  v_cvt_pk_bf16_f32 v116, v112, v113
  v_cvt_pk_bf16_f32 v117, v114, v115
  buffer_store_dwordx2 v[116:117], v118, s[24:27], s95 offen sc1
  s_branch H_join
M_comp:
  s_and_b32 s55, s2, 7
  s_lshr_b32 s56, s2, 3
  s_lshr_b32 s41, s55, 2
  s_bfe_u32 s42, s55, 0x10001
  s_and_b32 s55, s55, 1
  s_lshl_b32 s55, s55, 2
  s_lshr_b32 s43, s56, 3
  s_add_u32 s43, s43, s55
  s_and_b32 s44, s56, 7
  s_mul_i32 s43, s43, 14
  s_mul_i32 s44, s44, 14
  s_mul_i32 s61, s41, 13
  s_add_i32 s61, s61, -6
  s_mul_i32 s62, s42, 13
  s_add_i32 s62, s62, -6
  s_cmp_ge_u32 s40, 4
  s_cselect_b32 s53, -4, 3
  s_add_i32 s53, s53, s40
  s_lshl_b32 s53, s53, 1
  s_add_u32 s88, s43, s53
  s_mov_b32 s89, 86016
  s_movk_i32 s90, 384
  v_lshrrev_b32 v4, 3, v1
  v_and_b32 v5, 7, v1
  v_and_b32 v6, 6, v4
  v_xor_b32 v5, v5, v6
  v_add_u32 v6, 1, v4
  v_lshrrev_b32 v6, 3, v6
  v_lshlrev_b32 v6, 26, v6
  v_or_b32 v5, v5, v6
  v_add_u32 v4, s44, v4
  v_lshl_add_u32 v6, v4, 1, s62
  v_add_u32 v7, 112, v4
  v_med3_i32 v6, v6, v4, v7
  v_mul_u32_u24 v6, 384, v6
  v_lshl_add_u32 v168, v5, 4, v6
  v_add_u32 v4, 7, v4
  v_lshl_add_u32 v6, v4, 1, s62
  v_add_u32 v7, 112, v4
  v_med3_i32 v6, v6, v4, v7
  v_mul_u32_u24 v6, 384, v6
  v_lshl_add_u32 v169, v5, 4, v6
  s_add_u32 s55, s88, 0
  s_lshl_b32 s56, s55, 1
  s_add_i32 s56, s56, s61
  s_max_i32 s56, s56, s55
  s_add_i32 s55, s55, 112
  s_min_i32 s56, s56, s55
  s_mul_i32 s84, s56, 86016
  s_add_u32 s55, s88, 1
  s_lshl_b32 s56, s55, 1
  s_add_i32 s56, s56, s61
  s_max_i32 s56, s56, s55
  s_add_i32 s55, s55, 112
  s_min_i32 s56, s56, s55
  s_mul_i32 s85, s56, 86016
  s_lshl_b32 s86, s53, 12
  s_lshl_b32 s87, s53, 11
  s_waitcnt lgkmcnt(0)
  s_mov_b32 s16, s4
  s_and_b32 s17, s5, 0xffff
  s_mov_b32 s18, 19267584
  s_mov_b32 s19, 0x00020000
  s_barrier
  s_add_u32 m0, s86, 512
  s_nop 0
  buffer_load_dwordx4 v168, s[16:19], s84 offen offset:0 lds
  s_add_u32 m0, s86, 1536
  s_nop 0
  buffer_load_dwordx4 v168, s[16:19], s85 offen offset:0 lds
  s_add_u32 m0, s86, 2560
  s_nop 0
  buffer_load_dwordx4 v169, s[16:19], s84 offen offset:0 lds
  s_add_u32 m0, s86, 3584
  s_nop 0
  buffer_load_dwordx4 v169, s[16:19], s85 offen offset:0 lds
  s_cmp_lt_u32 s2, 36
  s_cbranch_scc1 M_x1
  s_add_u32 m0, s86, 4480
  s_nop 0
  buffer_load_dwordx4 v168, s[16:19], s84 offen offset:128 lds
  s_add_u32 m0, s86, 5504
  s_nop 0
  buffer_load_dwordx4 v168, s[16:19], s85 offen offset:128 lds
  s_add_u32 m0, s86, 6528
  s_nop 0
  buffer_load_dwordx4 v169, s[16:19], s84 offen offset:128 lds
  s_add_u32 m0, s86, 7552
  s_nop 0
  buffer_load_dwordx4 v169, s[16:19], s85 offen offset:128 lds
  s_add_u32 m0, s87, 61184
  s_nop 0
  buffer_load_dwordx4 v168, s[16:19], s84 offen offset:256 lds
  s_add_u32 m0, s87, 62208
  s_nop 0
  buffer_load_dwordx4 v168, s[16:19], s85 offen offset:256 lds
  s_add_u32 m0, s87, 63232
  s_nop 0
  buffer_load_dwordx4 v169, s[16:19], s84 offen offset:256 lds
  s_add_u32 m0, s87, 64256
  s_nop 0
  buffer_load_dwordx4 v169, s[16:19], s85 offen offset:256 lds
M_x1:
  s_mov_b32 s24, s14
  s_and_b32 s25, s15, 0xffff
  s_mov_b32 s26, 268435456
  s_mov_b32 s27, 0x00020000
  s_mov_b32 s20, s10
  s_and_b32 s21, s11, 0xffff
  s_mov_b32 s22, 19267584
  s_mov_b32 s23, 0x00020000
  s_mov_b32 s36, s12
  s_and_b32 s37, s13, 0xffff
  s_mov_b32 s38, 256
  s_mov_b32 s39, 0x00020000
  s_mul_i32 s55, s41, 6
  s_add_i32 s45, s43, s55
  s_add_i32 s45, s45, -6
  s_cmp_eq_i32 s45, -6
  s_cselect_b32 s47, 6, 0
  s_cmp_eq_i32 s45, 98
  s_cselect_b32 s48, 7, 13
  s_cselect_b32 s49, 2, 0
  s_sub_i32 s45, s45, s49
  s_mul_i32 s55, s42, 6
  s_add_i32 s56, s44, s55
  s_add_i32 s56, s56, -6
  s_cmp_eq_i32 s56, -6
  s_cselect_b32 s50, 6, 0
  s_cmp_eq_i32 s56, 98
  s_cselect_b32 s51, 7, 13
  s_lshl_b32 s56, s56, 1
  s_add_i32 s56, s56, s42
  s_mul_i32 s46, s56, 384
  s_max_i32 s92, s53, s47
  s_min_i32 s92, s92, s48
  s_and_b32 s92, s92, -2
  s_add_u32 s52, s92, s49
  s_mov_b32 s54, 4286578688
  s_mov_b32 s63, 1037384597
  s_and_b32 s93, s40, 1
  s_lshl_b32 s93, s93, 3
  s_and_b32 s56, s40, 6
  s_or_b32 s93, s93, s56
  s_add_u32 s56, s40, 8
  s_add_i32 s100, s45, s56
  s_lshl_b32 s100, s100, 1
  s_add_i32 s100, s100, s41
  s_max_i32 s100, s100, 0
  s_min_i32 s100, s100, 223
  s_mul_i32 s100, s100, 86016
  s_mul_i32 s101, s56, 7680
  v_lshrrev_b32 v4, 3, v3
  v_add_u32 v4, s53, v4
  v_max_i32 v4, s47, v4
  v_min_i32 v4, s48, v4
  v_subrev_u32 v4, s92, v4
  v_and_b32 v5, 1, v2
  v_sub_u32 v6, v5, v4
  v_ashrrev_i32 v12, 31, v6
  v_and_b32 v12, s54, v12
  v_sub_u32 v6, v4, v5
  v_ashrrev_i32 v13, 31, v6
  v_and_b32 v13, s54, v13
  v_and_b32 v4, 7, v3
  v_lshrrev_b32 v5, 1, v2
  v_subrev_u32 v7, 7, v4
  v_ashrrev_i32 v7, 31, v7
  v_and_b32 v7, 0x7f, v7
  v_add_u32 v6, 0, v4
  v_max_i32 v6, s50, v6
  v_min_i32 v6, s51, v6
  v_lshlrev_b32 v6, v6, v7
  v_lshrrev_b32 v6, v5, v6
  v_not_b32 v14, v6
  v_add_u32 v6, 7, v4
  v_max_i32 v6, s50, v6
  v_min_i32 v6, s51, v6
  v_lshlrev_b32 v6, v6, v7
  v_lshrrev_b32 v6, v5, v6
  v_not_b32 v15, v6
  v_add_u32 v4, s52, v4
  v_and_b32 v5, 1, v4
  v_lshlrev_b32 v5, 3, v5
  v_and_or_b32 v5, v4, 6, v5
  v_mul_u32_u24 v4, 7680, v4
  v_lshrrev_b32 v6, 3, v3
  v_mul_u32_u24 v6, 24, v6
  v_add_u32 v6, v6, v2
  v_add_u32 v7, 0, v6
  v_xor_b32 v7, v7, v5
  v_lshl_add_u32 v240, v7, 4, v4
  v_add_u32 v7, 4, v6
  v_xor_b32 v7, v7, v5
  v_lshl_add_u32 v241, v7, 4, v4
  v_add_u32 v7, 8, v6
  v_xor_b32 v7, v7, v5
  v_lshl_add_u32 v242, v7, 4, v4
  v_add_u32 v7, 12, v6
  v_xor_b32 v7, v7, v5
  v_lshl_add_u32 v243, v7, 4, v4
  v_and_b32 v4, 1, v2
  v_lshlrev_b32 v4, 2, v4
  v_lshrrev_b32 v5, 2, v3
  v_add3_u32 v4, v4, v5, s52
  v_and_b32 v5, 1, v4
  v_lshlrev_b32 v5, 3, v5
  v_and_or_b32 v5, v4, 6, v5
  v_mul_u32_u24 v4, 7680, v4
  v_and_b32 v6, 1, v3
  v_lshl_add_u32 v4, v6, 3, v4
  v_lshrrev_b32 v6, 1, v2
  v_mul_u32_u24 v6, 24, v6
  v_bfe_u32 v7, v3, 1, 1
  v_add_u32 v6, v6, v7
  v_add_u32 v7, 0, v6
  v_xor_b32 v7, v7, v5
  v_lshl_add_u32 v244, v7, 4, v4
  v_add_u32 v7, 2, v6
  v_xor_b32 v7, v7, v5
  v_lshl_add_u32 v245, v7, 4, v4
  v_add_u32 v7, 4, v6
  v_xor_b32 v7, v7, v5
  v_lshl_add_u32 v246, v7, 4, v4
  v_add_u32 v7, 6, v6
  v_xor_b32 v7, v7, v5
  v_lshl_add_u32 v247, v7, 4, v4
  v_add_u32 v7, 8, v6
  v_xor_b32 v7, v7, v5
  v_lshl_add_u32 v248, v7, 4, v4
  v_add_u32 v7, 10, v6
  v_xor_b32 v7, v7, v5
  v_lshl_add_u32 v249, v7, 4, v4
  v_add_u32 v7, 12, v6
  v_xor_b32 v7, v7, v5
  v_lshl_add_u32 v250, v7, 4, v4
  v_add_u32 v7, 14, v6
  v_xor_b32 v7, v7, v5
  v_lshl_add_u32 v251, v7, 4, v4
  v_add_u32 v253, 153600, v252
  v_add_u32 v254, 90112, v252
  v_add_u32 v4, 0, v1
  v_xor_b32 v4, s93, v4
  v_mul_u32_u24 v5, 2731, v4
  v_lshrrev_b32 v5, 16, v5
  v_mul_u32_u24 v5, 384, v5
  v_lshl_add_u32 v4, v4, 4, v5
  v_add_u32 v232, s46, v4
  v_add_u32 v235, 6144, v232
  v_add_u32 v238, 12288, v232
  v_max_i32 v232, 0, v232
  v_add_u32 v4, 64, v1
  v_xor_b32 v4, s93, v4
  v_mul_u32_u24 v5, 2731, v4
  v_lshrrev_b32 v5, 16, v5
  v_mul_u32_u24 v5, 384, v5
  v_lshl_add_u32 v4, v4, 4, v5
  v_add_u32 v233, s46, v4
  v_add_u32 v236, 6144, v233
  v_max_i32 v233, 0, v233
  v_add_u32 v4, 128, v1
  v_xor_b32 v4, s93, v4
  v_mul_u32_u24 v5, 2731, v4
  v_lshrrev_b32 v5, 16, v5
  v_mul_u32_u24 v5, 384, v5
  v_lshl_add_u32 v4, v4, 4, v5
  v_add_u32 v234, s46, v4
  v_add_u32 v237, 6144, v234
  v_max_i32 v234, 0, v234
  v_add_u32 v4, 416, v1
  v_xor_b32 v4, s93, v4
  v_mul_u32_u24 v5, 2731, v4
  v_lshrrev_b32 v5, 16, v5
  v_mul_u32_u24 v5, 384, v5
  v_lshl_add_u32 v4, v4, 4, v5
  v_add_u32 v239, s46, v4
  v_lshrrev_b32 v197, 1, v2
  v_and_b32 v255, 1, v2
  v_add_u32 v197, s88, v197
  v_lshl_add_u32 v0, v255, 2, s44
  v_lshl_add_u32 v198, v197, 1, s61
  v_add_u32 v199, 112, v197
  v_lshlrev_b32 v255, 30, v255
  v_med3_i32 v197, v198, v197, v199
  v_mul_lo_u32 v197, v197, s89
  v_lshl_add_u32 v197, v3, 3, v197
  v_add_u32 v4, 0, v0
  v_lshl_add_u32 v198, v4, 1, s62
  v_add_u32 v199, 112, v4
  v_med3_i32 v4, v198, v4, v199
  v_mad_u32_u24 v4, v4, s90, v197
  v_add_u32 v5, 1, v0
  v_lshl_add_u32 v198, v5, 1, s62
  v_add_u32 v199, 112, v5
  v_med3_i32 v5, v198, v5, v199
  v_mad_u32_u24 v5, v5, s90, v197
  v_add_u32 v6, 2, v0
  v_lshl_add_u32 v198, v6, 1, s62
  v_add_u32 v199, 112, v6
  v_med3_i32 v6, v198, v6, v199
  v_mad_u32_u24 v6, v6, s90, v197
  v_add_u32 v7, 3, v0
  v_lshl_add_u32 v198, v7, 1, s62
  v_add_u32 v199, 112, v7
  v_med3_i32 v7, v198, v7, v199
  v_mad_u32_u24 v7, v7, s90, v197
  v_add_u32 v7, v7, v255
  v_add_u32 v8, 7, v0
  v_lshl_add_u32 v198, v8, 1, s62
  v_add_u32 v199, 112, v8
  v_med3_i32 v8, v198, v8, v199
  v_mad_u32_u24 v8, v8, s90, v197
  v_add_u32 v9, 8, v0
  v_lshl_add_u32 v198, v9, 1, s62
  v_add_u32 v199, 112, v9
  v_med3_i32 v9, v198, v9, v199
  v_mad_u32_u24 v9, v9, s90, v197
  v_add_u32 v10, 9, v0
  v_lshl_add_u32 v198, v10, 1, s62
  v_add_u32 v199, 112, v10
  v_med3_i32 v10, v198, v10, v199
  v_mad_u32_u24 v10, v10, s90, v197
  v_add_u32 v11, 10, v0
  v_lshl_add_u32 v198, v11, 1, s62
  v_add_u32 v199, 112, v11
  v_med3_i32 v11, v198, v11, v199
  v_mad_u32_u24 v11, v11, s90, v197
  v_add_u32 v11, v11, v255
  v_bfe_i32 v66, v14, 0, 1
  v_bfe_i32 v94, v15, 6, 1
  v_and_b32 v65, s54, v66
  v_and_b32 v93, s54, v94
  v_and_b32 v66, s54, v66
  v_and_b32 v94, s54, v94
  v_or_b32 v64, v65, v12
  v_or_b32 v92, v93, v12
  v_or_b32 v67, v65, v13
  v_or_b32 v95, v93, v13
  v_bfe_i32 v70, v14, 2, 1
  v_bfe_i32 v98, v15, 8, 1
  v_and_b32 v69, s54, v70
  v_and_b32 v97, s54, v98
  v_and_b32 v70, s54, v70
  v_and_b32 v98, s54, v98
  v_or_b32 v68, v69, v12
  v_or_b32 v96, v97, v12
  v_or_b32 v71, v69, v13
  v_or_b32 v99, v97, v13
  v_bfe_i32 v74, v14, 4, 1
  v_bfe_i32 v102, v15, 10, 1
  v_and_b32 v73, s54, v74
  v_and_b32 v101, s54, v102
  v_and_b32 v74, s54, v74
  v_and_b32 v102, s54, v102
  v_or_b32 v72, v73, v12
  v_or_b32 v100, v101, v12
  v_or_b32 v75, v73, v13
  v_or_b32 v103, v101, v13
  v_bfe_i32 v78, v14, 6, 1
  v_bfe_i32 v106, v15, 12, 1
  v_and_b32 v77, s54, v78
  v_and_b32 v105, s54, v106
  v_and_b32 v78, s54, v78
  v_and_b32 v106, s54, v106
  v_or_b32 v76, v77, v12
  v_or_b32 v104, v105, v12
  v_or_b32 v79, v77, v13
  v_or_b32 v107, v105, v13
  v_bfe_i32 v82, v14, 8, 1
  v_bfe_i32 v110, v15, 14, 1
  v_and_b32 v81, s54, v82
  v_and_b32 v109, s54, v110
  v_and_b32 v82, s54, v82
  v_and_b32 v110, s54, v110
  v_or_b32 v80, v81, v12
  v_or_b32 v108, v109, v12
  v_or_b32 v83, v81, v13
  v_or_b32 v111, v109, v13
  v_bfe_i32 v86, v14, 10, 1
  v_bfe_i32 v114, v15, 16, 1
  v_and_b32 v85, s54, v86
  v_and_b32 v113, s54, v114
  v_and_b32 v86, s54, v86
  v_and_b32 v114, s54, v114
  v_or_b32 v84, v85, v12
  v_or_b32 v112, v113, v12
  v_or_b32 v87, v85, v13
  v_or_b32 v115, v113, v13
  v_bfe_i32 v90, v14, 12, 1
  v_bfe_i32 v118, v15, 18, 1
  v_and_b32 v89, s54, v90
  v_and_b32 v117, s54, v118
  v_and_b32 v90, s54, v90
  v_and_b32 v118, s54, v118
  v_or_b32 v88, v89, v12
  v_or_b32 v116, v117, v12
  v_or_b32 v91, v89, v13
  v_or_b32 v119, v117, v13
  v_and_b32 v170, 6, v3
  v_xor_b32 v170, v170, v2
  v_lshlrev_b32 v174, 7, v3
  v_xor_b32 v171, 4, v170
  v_lshl_add_u32 v170, v170, 4, v174
  v_lshl_add_u32 v171, v171, 4, v174
  v_add_u32 v172, s87, v170
  v_add_u32 v170, s86, v170
  v_add_u32 v173, s87, v171
  v_add_u32 v171, s86, v171
  s_cmp_ge_u32 s2, 36
  s_cbranch_scc1 M_x2
  s_barrier
  s_add_u32 m0, s86, 4480
  s_nop 0
  buffer_load_dwordx4 v168, s[16:19], s84 offen offset:128 lds
  s_add_u32 m0, s86, 5504
  s_nop 0
  buffer_load_dwordx4 v168, s[16:19], s85 offen offset:128 lds
  s_add_u32 m0, s86, 6528
  s_nop 0
  buffer_load_dwordx4 v169, s[16:19], s84 offen offset:128 lds
  s_add_u32 m0, s86, 7552
  s_nop 0
  buffer_load_dwordx4 v169, s[16:19], s85 offen offset:128 lds
  s_barrier
  s_add_u32 m0, s87, 61184
  s_nop 0
  buffer_load_dwordx4 v168, s[16:19], s84 offen offset:256 lds
  s_add_u32 m0, s87, 62208
  s_nop 0
  buffer_load_dwordx4 v168, s[16:19], s85 offen offset:256 lds
  s_add_u32 m0, s87, 63232
  s_nop 0
  buffer_load_dwordx4 v169, s[16:19], s84 offen offset:256 lds
  s_add_u32 m0, s87, 64256
  s_nop 0
  buffer_load_dwordx4 v169, s[16:19], s85 offen offset:256 lds
M_x2:
  s_waitcnt vmcnt(8)
  ds_read_b128 v[16:19], v170 offset:512
  ds_read_b128 v[20:23], v171 offset:512
  ds_read_b128 v[40:43], v170 offset:2560
  ds_read_b128 v[44:47], v171 offset:2560
  s_waitcnt vmcnt(4)
  ds_read_b128 v[24:27], v170 offset:4608
  ds_read_b128 v[28:31], v171 offset:4608
  ds_read_b128 v[48:51], v170 offset:6656
  ds_read_b128 v[52:55], v171 offset:6656
  s_waitcnt vmcnt(0)
  ds_read_b128 v[32:35], v172 offset:61440
  ds_read_b128 v[36:39], v173 offset:61440
  ds_read_b128 v[56:59], v172 offset:63488
  ds_read_b128 v[60:63], v173 offset:63488
  s_add_i32 s57, s45, s40
  s_lshl_b32 s57, s57, 1
  s_add_i32 s57, s57, s41
  s_max_i32 s57, s57, 0
  s_min_i32 s57, s57, 223
  s_mul_i32 s57, s57, 86016
  s_waitcnt lgkmcnt(0)
  s_barrier
  s_cmp_lt_u32 s40, 1
  s_cbranch_scc1 M_er
  s_add_u32 m0, s101, -61440
  s_nop 0
  buffer_load_dwordx4 v232, s[16:19], s57 offen lds
  s_add_u32 m0, s101, -60416
  s_nop 0
  buffer_load_dwordx4 v233, s[16:19], s57 offen lds
  s_add_u32 m0, s101, -59392
  s_nop 0
  buffer_load_dwordx4 v234, s[16:19], s57 offen lds
  s_add_u32 m0, s101, -58368
  s_nop 0
  buffer_load_dwordx4 v235, s[16:19], s57 offen lds
  s_add_u32 m0, s101, -57344
  s_nop 0
  buffer_load_dwordx4 v236, s[16:19], s57 offen lds
  s_add_u32 m0, s101, -56320
  s_nop 0
  buffer_load_dwordx4 v237, s[16:19], s57 offen lds
  s_add_u32 m0, s101, -55296
  s_nop 0
  buffer_load_dwordx4 v238, s[16:19], s57 offen lds
  s_add_u32 m0, s101, -54784
  s_nop 0
  buffer_load_dwordx4 v239, s[16:19], s57 offen lds
M_er:
  s_barrier
  s_cmp_lt_u32 s40, 4
  s_cbranch_scc1 M_xl
  s_setprio 1
  s_barrier
  s_branch M_pa
M_xl:
  s_lshl_b32 s55, s40, 10
  s_add_u32 s55, s55, 131072
  s_sub_u32 m0, s55, 40960
  s_nop 0
  buffer_load_dwordx4 v252, s[24:27], s55 offen sc1 lds
  s_add_u32 s55, s55, 4096
  s_sub_u32 m0, s55, 40960
  s_nop 0
  buffer_load_dwordx4 v252, s[24:27], s55 offen sc1 lds
  s_add_u32 s55, s55, 4096
  s_sub_u32 m0, s55, 40960
  s_nop 0
  buffer_load_dwordx4 v252, s[24:27], s55 offen sc1 lds
  s_add_u32 s55, s55, 4096
  s_sub_u32 m0, s55, 40960
  s_nop 0
  buffer_load_dwordx4 v252, s[24:27], s55 offen sc1 lds
  s_add_u32 s55, s55, 4096
  s_sub_u32 m0, s55, 40960
  s_nop 0
  buffer_load_dwordx4 v252, s[24:27], s55 offen sc1 lds
  s_add_u32 s55, s55, 4096
  s_sub_u32 m0, s55, 40960
  s_nop 0
  buffer_load_dwordx4 v252, s[24:27], s55 offen sc1 lds
  s_add_u32 s55, s55, 4096
  s_sub_u32 m0, s55, 40960
  s_nop 0
  buffer_load_dwordx4 v252, s[24:27], s55 offen sc1 lds
  s_add_u32 s55, s55, 4096
  s_sub_u32 m0, s55, 40960
  s_nop 0
  buffer_load_dwordx4 v252, s[24:27], s55 offen sc1 lds
  s_add_u32 s55, s55, 4096
  s_sub_u32 m0, s55, 40960
  s_nop 0
  buffer_load_dwordx4 v252, s[24:27], s55 offen sc1 lds
  s_add_u32 s55, s55, 4096
  s_sub_u32 m0, s55, 40960
  s_nop 0
  buffer_load_dwordx4 v252, s[24:27], s55 offen sc1 lds
  s_add_u32 s55, s55, 4096
  s_sub_u32 m0, s55, 40960
  s_nop 0
  buffer_load_dwordx4 v252, s[24:27], s55 offen sc1 lds
  s_add_u32 s55, s55, 4096
  s_sub_u32 m0, s55, 40960
  s_nop 0
  buffer_load_dwordx4 v252, s[24:27], s55 offen sc1 lds
  s_waitcnt vmcnt(6)
  s_barrier
  s_lshl_b32 s55, s40, 10
  s_add_u32 s55, s55, 180224
  s_sub_u32 m0, s55, 40960
  s_nop 0
  buffer_load_dwordx4 v252, s[24:27], s55 offen sc1 lds
  s_add_u32 s55, s55, 4096
  s_sub_u32 m0, s55, 40960
  s_nop 0
  buffer_load_dwordx4 v252, s[24:27], s55 offen sc1 lds
  s_add_u32 s55, s55, 4096
  s_sub_u32 m0, s55, 40960
  s_nop 0
  buffer_load_dwordx4 v252, s[24:27], s55 offen sc1 lds
  s_add_u32 s55, s55, 4096
  s_sub_u32 m0, s55, 40960
  s_nop 0
  buffer_load_dwordx4 v252, s[24:27], s55 offen sc1 lds
  s_add_u32 s55, s55, 4096
  s_sub_u32 m0, s55, 40960
  s_nop 0
  buffer_load_dwordx4 v252, s[24:27], s55 offen sc1 lds
  s_add_u32 s55, s55, 4096
  s_sub_u32 m0, s55, 40960
  s_nop 0
  buffer_load_dwordx4 v252, s[24:27], s55 offen sc1 lds
M_pa:
  ds_read_b128 v[200:203], v254 offset:0
  ds_read_b128 v[204:207], v254 offset:1024
  ds_read_b128 v[208:211], v254 offset:2048
  ds_read_b128 v[212:215], v254 offset:3072
  ds_read_b128 v[216:219], v254 offset:4096
  ds_read_b128 v[220:223], v254 offset:5120
  s_waitcnt lgkmcnt(5)
  v_mfma_f32_16x16x32_bf16 v[168:171], v[200:203], v[16:19], 0
  ds_read_b128 v[224:227], v254 offset:6144
  v_mfma_f32_16x16x32_bf16 v[176:179], v[200:203], v[40:43], 0
  s_waitcnt lgkmcnt(5)
  v_mfma_f32_16x16x32_bf16 v[172:175], v[204:207], v[16:19], 0
  ds_read_b128 v[228:231], v254 offset:7168
  v_mfma_f32_16x16x32_bf16 v[180:183], v[204:207], v[40:43], 0
  s_waitcnt lgkmcnt(5)
  v_mfma_f32_16x16x32_bf16 v[168:171], v[208:211], v[20:23], v[168:171]
  ds_read_b128 v[200:203], v254 offset:8192
  v_mfma_f32_16x16x32_bf16 v[176:179], v[208:211], v[44:47], v[176:179]
  s_waitcnt lgkmcnt(5)
  v_mfma_f32_16x16x32_bf16 v[172:175], v[212:215], v[20:23], v[172:175]
  ds_read_b128 v[204:207], v254 offset:9216
  v_mfma_f32_16x16x32_bf16 v[180:183], v[212:215], v[44:47], v[180:183]
  s_waitcnt lgkmcnt(5)
  v_mfma_f32_16x16x32_bf16 v[168:171], v[216:219], v[24:27], v[168:171]
  ds_read_b128 v[208:211], v254 offset:10240
  v_mfma_f32_16x16x32_bf16 v[176:179], v[216:219], v[48:51], v[176:179]
  s_waitcnt lgkmcnt(5)
  v_mfma_f32_16x16x32_bf16 v[172:175], v[220:223], v[24:27], v[172:175]
  ds_read_b128 v[212:215], v254 offset:11264
  v_mfma_f32_16x16x32_bf16 v[180:183], v[220:223], v[48:51], v[180:183]
  s_waitcnt lgkmcnt(5)
  v_mfma_f32_16x16x32_bf16 v[168:171], v[224:227], v[28:31], v[168:171]
  ds_read_b128 v[216:219], v254 offset:12288
  v_mfma_f32_16x16x32_bf16 v[176:179], v[224:227], v[52:55], v[176:179]
  s_waitcnt lgkmcnt(5)
  v_mfma_f32_16x16x32_bf16 v[172:175], v[228:231], v[28:31], v[172:175]
  ds_read_b128 v[220:223], v254 offset:13312
  v_mfma_f32_16x16x32_bf16 v[180:183], v[228:231], v[52:55], v[180:183]
  s_waitcnt lgkmcnt(5)
  v_mfma_f32_16x16x32_bf16 v[168:171], v[200:203], v[32:35], v[168:171]
  ds_read_b128 v[224:227], v254 offset:14336
  v_mfma_f32_16x16x32_bf16 v[176:179], v[200:203], v[56:59], v[176:179]
  s_waitcnt lgkmcnt(5)
  v_mfma_f32_16x16x32_bf16 v[172:175], v[204:207], v[32:35], v[172:175]
  ds_read_b128 v[228:231], v254 offset:15360
  v_mfma_f32_16x16x32_bf16 v[180:183], v[204:207], v[56:59], v[180:183]
  s_waitcnt lgkmcnt(5)
  v_mfma_f32_16x16x32_bf16 v[168:171], v[208:211], v[36:39], v[168:171]
  ds_read_b128 v[200:203], v254 offset:16384
  v_mfma_f32_16x16x32_bf16 v[176:179], v[208:211], v[60:63], v[176:179]
  s_waitcnt lgkmcnt(5)
  v_mfma_f32_16x16x32_bf16 v[172:175], v[212:215], v[36:39], v[172:175]
  ds_read_b128 v[204:207], v254 offset:17408
  v_mfma_f32_16x16x32_bf16 v[180:183], v[212:215], v[60:63], v[180:183]
  s_waitcnt lgkmcnt(5)
  v_mfma_f32_16x16x32_bf16 v[184:187], v[216:219], v[16:19], 0
  ds_read_b128 v[208:211], v254 offset:18432
  v_mfma_f32_16x16x32_bf16 v[192:195], v[216:219], v[40:43], 0
  s_waitcnt lgkmcnt(5)
  v_mfma_f32_16x16x32_bf16 v[188:191], v[220:223], v[16:19], 0
  ds_read_b128 v[212:215], v254 offset:19456
  v_cvt_pk_bf16_f32 v120, v168, v169
  v_mfma_f32_16x16x32_bf16 v[196:199], v[220:223], v[40:43], 0
  s_waitcnt lgkmcnt(5)
  v_cvt_pk_bf16_f32 v121, v170, v171
  v_cvt_pk_bf16_f32 v122, v172, v173
  v_mfma_f32_16x16x32_bf16 v[184:187], v[224:227], v[20:23], v[184:187]
  ds_read_b128 v[216:219], v254 offset:20480
  v_cvt_pk_bf16_f32 v123, v174, v175
  v_mfma_f32_16x16x32_bf16 v[192:195], v[224:227], v[44:47], v[192:195]
  s_waitcnt lgkmcnt(5)
  v_cvt_pk_bf16_f32 v144, v176, v177
  v_cvt_pk_bf16_f32 v145, v178, v179
  v_mfma_f32_16x16x32_bf16 v[188:191], v[228:231], v[20:23], v[188:191]
  ds_read_b128 v[220:223], v254 offset:21504
  v_cvt_pk_bf16_f32 v146, v180, v181
  v_mfma_f32_16x16x32_bf16 v[196:199], v[228:231], v[44:47], v[196:199]
  s_waitcnt lgkmcnt(5)
  v_cvt_pk_bf16_f32 v147, v182, v183
  v_mfma_f32_16x16x32_bf16 v[184:187], v[200:203], v[24:27], v[184:187]
  ds_read_b128 v[224:227], v254 offset:22528
  v_mfma_f32_16x16x32_bf16 v[192:195], v[200:203], v[48:51], v[192:195]
  s_waitcnt lgkmcnt(5)
  v_mfma_f32_16x16x32_bf16 v[188:191], v[204:207], v[24:27], v[188:191]
  ds_read_b128 v[228:231], v254 offset:23552
  v_mfma_f32_16x16x32_bf16 v[196:199], v[204:207], v[48:51], v[196:199]
  s_waitcnt vmcnt(0)
  s_barrier
  s_waitcnt lgkmcnt(5)
  v_mfma_f32_16x16x32_bf16 v[184:187], v[208:211], v[28:31], v[184:187]
  ds_read_b128 v[200:203], v254 offset:24576
  v_mfma_f32_16x16x32_bf16 v[192:195], v[208:211], v[52:55], v[192:195]
  s_waitcnt lgkmcnt(5)
  v_mfma_f32_16x16x32_bf16 v[188:191], v[212:215], v[28:31], v[188:191]
  ds_read_b128 v[204:207], v254 offset:25600
  v_mfma_f32_16x16x32_bf16 v[196:199], v[212:215], v[52:55], v[196:199]
  s_waitcnt lgkmcnt(5)
  v_mfma_f32_16x16x32_bf16 v[184:187], v[216:219], v[32:35], v[184:187]
  ds_read_b128 v[208:211], v254 offset:26624
  v_mfma_f32_16x16x32_bf16 v[192:195], v[216:219], v[56:59], v[192:195]
  s_waitcnt lgkmcnt(5)
  v_mfma_f32_16x16x32_bf16 v[188:191], v[220:223], v[32:35], v[188:191]
  ds_read_b128 v[212:215], v254 offset:27648
  v_mfma_f32_16x16x32_bf16 v[196:199], v[220:223], v[56:59], v[196:199]
  s_waitcnt lgkmcnt(5)
  v_mfma_f32_16x16x32_bf16 v[184:187], v[224:227], v[36:39], v[184:187]
  ds_read_b128 v[216:219], v254 offset:28672
  v_mfma_f32_16x16x32_bf16 v[192:195], v[224:227], v[60:63], v[192:195]
  s_waitcnt lgkmcnt(5)
  v_mfma_f32_16x16x32_bf16 v[188:191], v[228:231], v[36:39], v[188:191]
  ds_read_b128 v[220:223], v254 offset:29696
  v_mfma_f32_16x16x32_bf16 v[196:199], v[228:231], v[60:63], v[196:199]
  s_waitcnt lgkmcnt(5)
  v_mfma_f32_16x16x32_bf16 v[168:171], v[200:203], v[16:19], 0
  ds_read_b128 v[224:227], v254 offset:30720
  v_mfma_f32_16x16x32_bf16 v[176:179], v[200:203], v[40:43], 0
  s_waitcnt lgkmcnt(5)
  v_mfma_f32_16x16x32_bf16 v[172:175], v[204:207], v[16:19], 0
  ds_read_b128 v[228:231], v254 offset:31744
  v_cvt_pk_bf16_f32 v124, v184, v185
  v_mfma_f32_16x16x32_bf16 v[180:183], v[204:207], v[40:43], 0
  s_waitcnt lgkmcnt(5)
  v_cvt_pk_bf16_f32 v125, v186, v187
  v_cvt_pk_bf16_f32 v126, v188, v189
  v_mfma_f32_16x16x32_bf16 v[168:171], v[208:211], v[20:23], v[168:171]
  ds_read_b128 v[200:203], v254 offset:32768
  v_cvt_pk_bf16_f32 v127, v190, v191
  v_mfma_f32_16x16x32_bf16 v[176:179], v[208:211], v[44:47], v[176:179]
  s_waitcnt lgkmcnt(5)
  v_cvt_pk_bf16_f32 v148, v192, v193
  v_cvt_pk_bf16_f32 v149, v194, v195
  v_mfma_f32_16x16x32_bf16 v[172:175], v[212:215], v[20:23], v[172:175]
  ds_read_b128 v[204:207], v254 offset:33792
  v_cvt_pk_bf16_f32 v150, v196, v197
  v_mfma_f32_16x16x32_bf16 v[180:183], v[212:215], v[44:47], v[180:183]
  s_waitcnt lgkmcnt(5)
  v_cvt_pk_bf16_f32 v151, v198, v199
  v_mfma_f32_16x16x32_bf16 v[168:171], v[216:219], v[24:27], v[168:171]
  ds_read_b128 v[208:211], v254 offset:34816
  v_mfma_f32_16x16x32_bf16 v[176:179], v[216:219], v[48:51], v[176:179]
  s_waitcnt lgkmcnt(5)
  v_mfma_f32_16x16x32_bf16 v[172:175], v[220:223], v[24:27], v[172:175]
  ds_read_b128 v[212:215], v254 offset:35840
  v_mfma_f32_16x16x32_bf16 v[180:183], v[220:223], v[48:51], v[180:183]
  s_waitcnt lgkmcnt(5)
  v_mfma_f32_16x16x32_bf16 v[168:171], v[224:227], v[28:31], v[168:171]
  ds_read_b128 v[216:219], v254 offset:36864
  v_mfma_f32_16x16x32_bf16 v[176:179], v[224:227], v[52:55], v[176:179]
  s_waitcnt lgkmcnt(5)
  v_mfma_f32_16x16x32_bf16 v[172:175], v[228:231], v[28:31], v[172:175]
  ds_read_b128 v[220:223], v254 offset:37888
  v_mfma_f32_16x16x32_bf16 v[180:183], v[228:231], v[52:55], v[180:183]
  s_waitcnt lgkmcnt(5)
  v_mfma_f32_16x16x32_bf16 v[168:171], v[200:203], v[32:35], v[168:171]
  ds_read_b128 v[224:227], v254 offset:38912
  v_mfma_f32_16x16x32_bf16 v[176:179], v[200:203], v[56:59], v[176:179]
  s_waitcnt lgkmcnt(5)
  v_mfma_f32_16x16x32_bf16 v[172:175], v[204:207], v[32:35], v[172:175]
  ds_read_b128 v[228:231], v254 offset:39936
  v_mfma_f32_16x16x32_bf16 v[180:183], v[204:207], v[56:59], v[180:183]
  s_waitcnt lgkmcnt(5)
  v_mfma_f32_16x16x32_bf16 v[168:171], v[208:211], v[36:39], v[168:171]
  ds_read_b128 v[200:203], v254 offset:40960
  v_mfma_f32_16x16x32_bf16 v[176:179], v[208:211], v[60:63], v[176:179]
  s_waitcnt lgkmcnt(5)
  v_mfma_f32_16x16x32_bf16 v[172:175], v[212:215], v[36:39], v[172:175]
  ds_read_b128 v[204:207], v254 offset:41984
  v_mfma_f32_16x16x32_bf16 v[180:183], v[212:215], v[60:63], v[180:183]
  s_barrier
  s_waitcnt lgkmcnt(5)
  v_mfma_f32_16x16x32_bf16 v[184:187], v[216:219], v[16:19], 0
  ds_read_b128 v[208:211], v254 offset:43008
  s_add_u32 m0, s101, 0
  s_nop 0
  buffer_load_dwordx4 v232, s[16:19], s100 offen lds
  v_mfma_f32_16x16x32_bf16 v[192:195], v[216:219], v[40:43], 0
  s_waitcnt lgkmcnt(5)
  s_add_u32 m0, s101, 1024
  s_nop 0
  buffer_load_dwordx4 v233, s[16:19], s100 offen lds
  s_add_u32 m0, s101, 2048
  s_nop 0
  buffer_load_dwordx4 v234, s[16:19], s100 offen lds
  v_mfma_f32_16x16x32_bf16 v[188:191], v[220:223], v[16:19], 0
  ds_read_b128 v[212:215], v254 offset:44032
  v_cvt_pk_bf16_f32 v128, v168, v169
  v_mfma_f32_16x16x32_bf16 v[196:199], v[220:223], v[40:43], 0
  s_waitcnt lgkmcnt(5)
  v_cvt_pk_bf16_f32 v129, v170, v171
  v_cvt_pk_bf16_f32 v130, v172, v173
  v_mfma_f32_16x16x32_bf16 v[184:187], v[224:227], v[20:23], v[184:187]
  ds_read_b128 v[216:219], v254 offset:45056
  v_cvt_pk_bf16_f32 v131, v174, v175
  v_mfma_f32_16x16x32_bf16 v[192:195], v[224:227], v[44:47], v[192:195]
  s_waitcnt lgkmcnt(5)
  v_cvt_pk_bf16_f32 v152, v176, v177
  v_cvt_pk_bf16_f32 v153, v178, v179
  v_mfma_f32_16x16x32_bf16 v[188:191], v[228:231], v[20:23], v[188:191]
  ds_read_b128 v[220:223], v254 offset:46080
  v_cvt_pk_bf16_f32 v154, v180, v181
  v_mfma_f32_16x16x32_bf16 v[196:199], v[228:231], v[44:47], v[196:199]
  s_waitcnt lgkmcnt(5)
  v_cvt_pk_bf16_f32 v155, v182, v183
  s_add_u32 m0, s101, 3072
  s_nop 0
  buffer_load_dwordx4 v235, s[16:19], s100 offen lds
  v_mfma_f32_16x16x32_bf16 v[184:187], v[200:203], v[24:27], v[184:187]
  ds_read_b128 v[224:227], v254 offset:47104
  s_add_u32 m0, s101, 4096
  s_nop 0
  buffer_load_dwordx4 v236, s[16:19], s100 offen lds
  v_mfma_f32_16x16x32_bf16 v[192:195], v[200:203], v[48:51], v[192:195]
  s_waitcnt lgkmcnt(5)
  s_add_u32 m0, s101, 5120
  s_nop 0
  buffer_load_dwordx4 v237, s[16:19], s100 offen lds
  s_add_u32 m0, s101, 6144
  s_nop 0
  buffer_load_dwordx4 v238, s[16:19], s100 offen lds
  v_mfma_f32_16x16x32_bf16 v[188:191], v[204:207], v[24:27], v[188:191]
  ds_read_b128 v[228:231], v254 offset:48128
  s_add_u32 m0, s101, 6656
  s_nop 0
  buffer_load_dwordx4 v239, s[16:19], s100 offen lds
  v_mfma_f32_16x16x32_bf16 v[196:199], v[204:207], v[48:51], v[196:199]
  s_waitcnt lgkmcnt(5)
  v_mfma_f32_16x16x32_bf16 v[184:187], v[208:211], v[28:31], v[184:187]
  ds_read_b128 v[200:203], v254 offset:49152
  v_mfma_f32_16x16x32_bf16 v[192:195], v[208:211], v[52:55], v[192:195]
  s_waitcnt lgkmcnt(5)
  v_mfma_f32_16x16x32_bf16 v[188:191], v[212:215], v[28:31], v[188:191]
  ds_read_b128 v[204:207], v254 offset:50176
  v_mfma_f32_16x16x32_bf16 v[196:199], v[212:215], v[52:55], v[196:199]
  s_waitcnt lgkmcnt(5)
  v_mfma_f32_16x16x32_bf16 v[184:187], v[216:219], v[32:35], v[184:187]
  ds_read_b128 v[208:211], v254 offset:51200
  v_mfma_f32_16x16x32_bf16 v[192:195], v[216:219], v[56:59], v[192:195]
  s_waitcnt lgkmcnt(5)
  v_mfma_f32_16x16x32_bf16 v[188:191], v[220:223], v[32:35], v[188:191]
  ds_read_b128 v[212:215], v254 offset:52224
  v_mfma_f32_16x16x32_bf16 v[196:199], v[220:223], v[56:59], v[196:199]
  s_waitcnt lgkmcnt(5)
  v_mfma_f32_16x16x32_bf16 v[184:187], v[224:227], v[36:39], v[184:187]
  ds_read_b128 v[216:219], v254 offset:53248
  v_mfma_f32_16x16x32_bf16 v[192:195], v[224:227], v[60:63], v[192:195]
  s_waitcnt lgkmcnt(5)
  v_mfma_f32_16x16x32_bf16 v[188:191], v[228:231], v[36:39], v[188:191]
  ds_read_b128 v[220:223], v254 offset:54272
  v_mfma_f32_16x16x32_bf16 v[196:199], v[228:231], v[60:63], v[196:199]
  s_waitcnt lgkmcnt(5)
  v_mfma_f32_16x16x32_bf16 v[168:171], v[200:203], v[16:19], 0
  ds_read_b128 v[224:227], v254 offset:55296
  v_mfma_f32_16x16x32_bf16 v[176:179], v[200:203], v[40:43], 0
  s_waitcnt lgkmcnt(5)
  ds_read_b128 v[232:235], v254 offset:61440
  v_mfma_f32_16x16x32_bf16 v[172:175], v[204:207], v[16:19], 0
  ds_read_b128 v[228:231], v254 offset:56320
  v_cvt_pk_bf16_f32 v132, v184, v185
  v_mfma_f32_16x16x32_bf16 v[180:183], v[204:207], v[40:43], 0
  s_waitcnt lgkmcnt(6)
  ds_read_b128 v[236:239], v254 offset:62464
  v_cvt_pk_bf16_f32 v133, v186, v187
  v_mfma_f32_16x16x32_bf16 v[168:171], v[208:211], v[20:23], v[168:171]
  ds_read_b128 v[200:203], v254 offset:57344
  v_cvt_pk_bf16_f32 v134, v188, v189
  v_mfma_f32_16x16x32_bf16 v[176:179], v[208:211], v[44:47], v[176:179]
  s_waitcnt lgkmcnt(7)
  v_cvt_pk_bf16_f32 v135, v190, v191
  v_cvt_pk_bf16_f32 v156, v192, v193
  v_mfma_f32_16x16x32_bf16 v[172:175], v[212:215], v[20:23], v[172:175]
  ds_read_b128 v[204:207], v254 offset:58368
  v_cvt_pk_bf16_f32 v157, v194, v195
  v_mfma_f32_16x16x32_bf16 v[180:183], v[212:215], v[44:47], v[180:183]
  s_waitcnt lgkmcnt(7)
  v_cvt_pk_bf16_f32 v158, v196, v197
  v_cvt_pk_bf16_f32 v159, v198, v199
  v_mfma_f32_16x16x32_bf16 v[168:171], v[216:219], v[24:27], v[168:171]
  ds_read_b128 v[208:211], v254 offset:59392
  v_mfma_f32_16x16x32_bf16 v[176:179], v[216:219], v[48:51], v[176:179]
  s_waitcnt lgkmcnt(7)
  v_mfma_f32_16x16x32_bf16 v[172:175], v[220:223], v[24:27], v[172:175]
  ds_read_b128 v[212:215], v254 offset:60416
  v_mfma_f32_16x16x32_bf16 v[180:183], v[220:223], v[48:51], v[180:183]
  s_waitcnt lgkmcnt(7)
  v_mfma_f32_16x16x32_bf16 v[168:171], v[224:227], v[28:31], v[168:171]
  v_mfma_f32_16x16x32_bf16 v[176:179], v[224:227], v[52:55], v[176:179]
  s_waitcnt lgkmcnt(5)
  v_mfma_f32_16x16x32_bf16 v[172:175], v[228:231], v[28:31], v[172:175]
  v_mfma_f32_16x16x32_bf16 v[180:183], v[228:231], v[52:55], v[180:183]
  s_waitcnt lgkmcnt(3)
  v_mfma_f32_16x16x32_bf16 v[168:171], v[200:203], v[32:35], v[168:171]
  ds_read_b128 v[224:227], v253 offset:0
  v_mfma_f32_16x16x32_bf16 v[176:179], v[200:203], v[56:59], v[176:179]
  s_waitcnt lgkmcnt(3)
  v_mfma_f32_16x16x32_bf16 v[172:175], v[204:207], v[32:35], v[172:175]
  ds_read_b128 v[228:231], v253 offset:1024
  v_mfma_f32_16x16x32_bf16 v[180:183], v[204:207], v[56:59], v[180:183]
  s_waitcnt lgkmcnt(3)
  v_mfma_f32_16x16x32_bf16 v[168:171], v[208:211], v[36:39], v[168:171]
  ds_read_b128 v[200:203], v253 offset:2048
  v_mfma_f32_16x16x32_bf16 v[176:179], v[208:211], v[60:63], v[176:179]
  s_waitcnt lgkmcnt(3)
  v_mfma_f32_16x16x32_bf16 v[172:175], v[212:215], v[36:39], v[172:175]
  ds_read_b128 v[204:207], v253 offset:3072
  v_mfma_f32_16x16x32_bf16 v[180:183], v[212:215], v[60:63], v[180:183]
  s_waitcnt vmcnt(0)
  s_barrier
  s_setprio 2
  s_cmp_lt_u32 s40, 4
  s_cbranch_scc1 M_pr1
  s_setprio 3
M_pr1:
  v_mfma_f32_16x16x32_bf16 v[184:187], v[232:235], v[16:19], 0
  ds_read_b128 v[208:211], v253 offset:4096
  v_mfma_f32_16x16x32_bf16 v[192:195], v[232:235], v[40:43], 0
  v_mfma_f32_16x16x32_bf16 v[188:191], v[236:239], v[16:19], 0
  ds_read_b128 v[212:215], v253 offset:5120
  v_cvt_pk_bf16_f32 v136, v168, v169
  v_mfma_f32_16x16x32_bf16 v[196:199], v[236:239], v[40:43], 0
  s_waitcnt lgkmcnt(5)
  v_cvt_pk_bf16_f32 v137, v170, v171
  v_cvt_pk_bf16_f32 v138, v172, v173
  v_mfma_f32_16x16x32_bf16 v[184:187], v[224:227], v[20:23], v[184:187]
  ds_read_b128 v[216:219], v253 offset:6144
  v_cvt_pk_bf16_f32 v139, v174, v175
  v_mfma_f32_16x16x32_bf16 v[192:195], v[224:227], v[44:47], v[192:195]
  s_waitcnt lgkmcnt(5)
  v_cvt_pk_bf16_f32 v160, v176, v177
  v_cvt_pk_bf16_f32 v161, v178, v179
  v_mfma_f32_16x16x32_bf16 v[188:191], v[228:231], v[20:23], v[188:191]
  ds_read_b128 v[220:223], v253 offset:7168
  v_cvt_pk_bf16_f32 v162, v180, v181
  v_mfma_f32_16x16x32_bf16 v[196:199], v[228:231], v[44:47], v[196:199]
  s_waitcnt lgkmcnt(5)
  v_cvt_pk_bf16_f32 v163, v182, v183
  v_mfma_f32_16x16x32_bf16 v[184:187], v[200:203], v[24:27], v[184:187]
  ds_read_b128 v[224:227], v253 offset:8192
  v_mfma_f32_16x16x32_bf16 v[192:195], v[200:203], v[48:51], v[192:195]
  s_waitcnt lgkmcnt(5)
  v_mfma_f32_16x16x32_bf16 v[188:191], v[204:207], v[24:27], v[188:191]
  ds_read_b128 v[228:231], v253 offset:9216
  v_mfma_f32_16x16x32_bf16 v[196:199], v[204:207], v[48:51], v[196:199]
  s_waitcnt lgkmcnt(5)
  v_mfma_f32_16x16x32_bf16 v[184:187], v[208:211], v[28:31], v[184:187]
  v_mfma_f32_16x16x32_bf16 v[192:195], v[208:211], v[52:55], v[192:195]
  s_waitcnt lgkmcnt(4)
  v_mfma_f32_16x16x32_bf16 v[188:191], v[212:215], v[28:31], v[188:191]
  v_mfma_f32_16x16x32_bf16 v[196:199], v[212:215], v[52:55], v[196:199]
  s_waitcnt lgkmcnt(3)
  v_mfma_f32_16x16x32_bf16 v[184:187], v[216:219], v[32:35], v[184:187]
  v_mfma_f32_16x16x32_bf16 v[192:195], v[216:219], v[56:59], v[192:195]
  s_waitcnt lgkmcnt(2)
  v_mfma_f32_16x16x32_bf16 v[188:191], v[220:223], v[32:35], v[188:191]
  v_mfma_f32_16x16x32_bf16 v[196:199], v[220:223], v[56:59], v[196:199]
  s_waitcnt lgkmcnt(1)
  v_mfma_f32_16x16x32_bf16 v[184:187], v[224:227], v[36:39], v[184:187]
  v_mfma_f32_16x16x32_bf16 v[192:195], v[224:227], v[60:63], v[192:195]
  s_waitcnt lgkmcnt(0)
  v_mfma_f32_16x16x32_bf16 v[188:191], v[228:231], v[36:39], v[188:191]
  v_mfma_f32_16x16x32_bf16 v[196:199], v[228:231], v[60:63], v[196:199]
  s_cmp_ge_u32 s40, 4
  s_cbranch_scc1 M_l1
  s_barrier
M_l1:
  ds_read_b128 v[200:203], v240 offset:0
  ds_read_b128 v[204:207], v240 offset:2304
  ds_read_b128 v[208:211], v241 offset:0
  ds_read_b128 v[212:215], v241 offset:2304
  ds_read_b128 v[216:219], v242 offset:0
  ds_read_b128 v[220:223], v242 offset:2304
  ds_read_b128 v[224:227], v243 offset:0
  v_cvt_pk_bf16_f32 v140, v184, v185
  v_cvt_pk_bf16_f32 v141, v186, v187
  v_cvt_pk_bf16_f32 v142, v188, v189
  v_cvt_pk_bf16_f32 v143, v190, v191
  v_cvt_pk_bf16_f32 v164, v192, v193
  v_cvt_pk_bf16_f32 v165, v194, v195
  v_cvt_pk_bf16_f32 v166, v196, v197
  v_cvt_pk_bf16_f32 v167, v198, v199
  s_mov_b32 s56, 0xff7fffff
  s_waitcnt lgkmcnt(6)
  v_mfma_f32_16x16x32_bf16 v[64:67], v[200:203], v[120:123], v[64:67]
  s_waitcnt lgkmcnt(5)
  ds_read_b128 v[228:231], v243 offset:2304
  v_mov_b32 v30, 0
  v_mfma_f32_16x16x32_bf16 v[76:79], v[204:207], v[120:123], v[76:79]
  v_mov_b32 v31, 0
  v_mov_b32 v32, 0
  v_mfma_f32_16x16x32_bf16 v[92:95], v[204:207], v[144:147], v[92:95]
  s_waitcnt lgkmcnt(5)
  ds_read_b128 v[200:203], v240 offset:256
  v_mov_b32 v33, 0
  v_mfma_f32_16x16x32_bf16 v[64:67], v[208:211], v[124:127], v[64:67]
  s_waitcnt lgkmcnt(5)
  ds_read_b128 v[204:207], v240 offset:2560
  v_mov_b32 v48, 0x3f803f80
  v_mfma_f32_16x16x32_bf16 v[76:79], v[212:215], v[124:127], v[76:79]
  v_mov_b32 v49, 0x3f803f80
  v_mov_b32 v50, 0x3f803f80
  v_mfma_f32_16x16x32_bf16 v[92:95], v[212:215], v[148:151], v[92:95]
  s_waitcnt lgkmcnt(5)
  ds_read_b128 v[208:211], v241 offset:256
  v_mov_b32 v51, 0x3f803f80
  v_mfma_f32_16x16x32_bf16 v[64:67], v[216:219], v[128:131], v[64:67]
  s_waitcnt lgkmcnt(5)
  ds_read_b128 v[212:215], v241 offset:2560
  v_mfma_f32_16x16x32_bf16 v[76:79], v[220:223], v[128:131], v[76:79]
  v_mfma_f32_16x16x32_bf16 v[92:95], v[220:223], v[152:155], v[92:95]
  s_waitcnt lgkmcnt(5)
  ds_read_b128 v[216:219], v240 offset:768
  v_mfma_f32_16x16x32_bf16 v[64:67], v[224:227], v[132:135], v[64:67]
  s_waitcnt lgkmcnt(5)
  ds_read_b128 v[220:223], v240 offset:3072
  v_mfma_f32_16x16x32_bf16 v[76:79], v[228:231], v[132:135], v[76:79]
  v_mfma_f32_16x16x32_bf16 v[92:95], v[228:231], v[156:159], v[92:95]
  s_waitcnt lgkmcnt(5)
  ds_read_b128 v[224:227], v241 offset:768
  v_mfma_f32_16x16x32_bf16 v[64:67], v[200:203], v[136:139], v[64:67]
  s_waitcnt lgkmcnt(5)
  ds_read_b128 v[228:231], v241 offset:3072
  v_mfma_f32_16x16x32_bf16 v[76:79], v[204:207], v[136:139], v[76:79]
  v_mfma_f32_16x16x32_bf16 v[92:95], v[204:207], v[160:163], v[92:95]
  s_waitcnt lgkmcnt(5)
  ds_read_b128 v[200:203], v242 offset:768
  v_mfma_f32_16x16x32_bf16 v[64:67], v[208:211], v[140:143], v[64:67]
  s_waitcnt lgkmcnt(5)
  ds_read_b128 v[204:207], v242 offset:3072
  v_mfma_f32_16x16x32_bf16 v[76:79], v[212:215], v[140:143], v[76:79]
  v_mfma_f32_16x16x32_bf16 v[92:95], v[212:215], v[164:167], v[92:95]
  s_waitcnt lgkmcnt(5)
  ds_read_b128 v[208:211], v243 offset:768
  v_mfma_f32_16x16x32_bf16 v[68:71], v[216:219], v[120:123], v[68:71]
  s_waitcnt lgkmcnt(5)
  ds_read_b128 v[212:215], v243 offset:3072
  v_mfma_f32_16x16x32_bf16 v[80:83], v[220:223], v[120:123], v[80:83]
  v_max3_f32 v12, v64, v65, s56
  v_max3_f32 v12, v66, v67, v12
  v_mfma_f32_16x16x32_bf16 v[96:99], v[220:223], v[144:147], v[96:99]
  s_waitcnt lgkmcnt(5)
  ds_read_b128 v[216:219], v240 offset:1024
  v_max3_f32 v12, v76, v77, v12
  v_mfma_f32_16x16x32_bf16 v[68:71], v[224:227], v[124:127], v[68:71]
  s_waitcnt lgkmcnt(5)
  ds_read_b128 v[220:223], v240 offset:3328
  v_max3_f32 v12, v78, v79, v12
  v_mfma_f32_16x16x32_bf16 v[80:83], v[228:231], v[124:127], v[80:83]
  v_max3_f32 v13, v92, v93, s56
  v_max3_f32 v13, v94, v95, v13
  v_mfma_f32_16x16x32_bf16 v[96:99], v[228:231], v[148:151], v[96:99]
  s_waitcnt lgkmcnt(5)
  ds_read_b128 v[224:227], v241 offset:1024
  v_mfma_f32_16x16x32_bf16 v[68:71], v[200:203], v[128:131], v[68:71]
  s_waitcnt lgkmcnt(5)
  ds_read_b128 v[228:231], v241 offset:3328
  v_mfma_f32_16x16x32_bf16 v[80:83], v[204:207], v[128:131], v[80:83]
  v_mfma_f32_16x16x32_bf16 v[96:99], v[204:207], v[152:155], v[96:99]
  s_waitcnt lgkmcnt(5)
  ds_read_b128 v[200:203], v240 offset:1536
  v_mfma_f32_16x16x32_bf16 v[68:71], v[208:211], v[132:135], v[68:71]
  s_waitcnt lgkmcnt(5)
  ds_read_b128 v[204:207], v240 offset:3840
  v_mfma_f32_16x16x32_bf16 v[80:83], v[212:215], v[132:135], v[80:83]
  v_mfma_f32_16x16x32_bf16 v[96:99], v[212:215], v[156:159], v[96:99]
  s_waitcnt lgkmcnt(5)
  ds_read_b128 v[208:211], v241 offset:1536
  v_mfma_f32_16x16x32_bf16 v[68:71], v[216:219], v[136:139], v[68:71]
  s_waitcnt lgkmcnt(5)
  ds_read_b128 v[212:215], v241 offset:3840
  v_mfma_f32_16x16x32_bf16 v[80:83], v[220:223], v[136:139], v[80:83]
  v_mfma_f32_16x16x32_bf16 v[96:99], v[220:223], v[160:163], v[96:99]
  s_waitcnt lgkmcnt(5)
  ds_read_b128 v[216:219], v242 offset:1536
  v_mfma_f32_16x16x32_bf16 v[68:71], v[224:227], v[140:143], v[68:71]
  s_waitcnt lgkmcnt(5)
  ds_read_b128 v[220:223], v242 offset:3840
  v_mfma_f32_16x16x32_bf16 v[80:83], v[228:231], v[140:143], v[80:83]
  v_mfma_f32_16x16x32_bf16 v[96:99], v[228:231], v[164:167], v[96:99]
  s_waitcnt lgkmcnt(5)
  ds_read_b128 v[224:227], v243 offset:1536
  v_mfma_f32_16x16x32_bf16 v[72:75], v[200:203], v[120:123], v[72:75]
  s_waitcnt lgkmcnt(5)
  ds_read_b128 v[228:231], v243 offset:3840
  v_mfma_f32_16x16x32_bf16 v[84:87], v[204:207], v[120:123], v[84:87]
  v_max3_f32 v12, v68, v69, v12
  v_max3_f32 v12, v70, v71, v12
  v_mfma_f32_16x16x32_bf16 v[100:103], v[204:207], v[144:147], v[100:103]
  s_waitcnt lgkmcnt(5)
  ds_read_b128 v[200:203], v240 offset:1792
  v_max3_f32 v12, v80, v81, v12
  v_mfma_f32_16x16x32_bf16 v[72:75], v[208:211], v[124:127], v[72:75]
  s_waitcnt lgkmcnt(5)
  ds_read_b128 v[204:207], v240 offset:4096
  v_max3_f32 v12, v82, v83, v12
  v_mfma_f32_16x16x32_bf16 v[84:87], v[212:215], v[124:127], v[84:87]
  v_max3_f32 v13, v96, v97, v13
  v_max3_f32 v13, v98, v99, v13
  v_mfma_f32_16x16x32_bf16 v[100:103], v[212:215], v[148:151], v[100:103]
  s_waitcnt lgkmcnt(5)
  ds_read_b128 v[208:211], v241 offset:1792
  v_mfma_f32_16x16x32_bf16 v[72:75], v[216:219], v[128:131], v[72:75]
  s_waitcnt lgkmcnt(5)
  ds_read_b128 v[212:215], v241 offset:4096
  v_mfma_f32_16x16x32_bf16 v[84:87], v[220:223], v[128:131], v[84:87]
  v_mfma_f32_16x16x32_bf16 v[100:103], v[220:223], v[152:155], v[100:103]
  s_waitcnt lgkmcnt(5)
  ds_read_b128 v[216:219], v240 offset:5376
  v_mfma_f32_16x16x32_bf16 v[72:75], v[224:227], v[132:135], v[72:75]
  s_waitcnt lgkmcnt(5)
  ds_read_b128 v[220:223], v240 offset:4608
  v_mfma_f32_16x16x32_bf16 v[84:87], v[228:231], v[132:135], v[84:87]
  v_mfma_f32_16x16x32_bf16 v[100:103], v[228:231], v[156:159], v[100:103]
  s_waitcnt lgkmcnt(5)
  ds_read_b128 v[224:227], v241 offset:5376
  v_mfma_f32_16x16x32_bf16 v[72:75], v[200:203], v[136:139], v[72:75]
  s_waitcnt lgkmcnt(5)
  ds_read_b128 v[228:231], v241 offset:4608
  v_mfma_f32_16x16x32_bf16 v[84:87], v[204:207], v[136:139], v[84:87]
  v_mfma_f32_16x16x32_bf16 v[100:103], v[204:207], v[160:163], v[100:103]
  s_waitcnt lgkmcnt(5)
  ds_read_b128 v[200:203], v242 offset:5376
  v_mfma_f32_16x16x32_bf16 v[72:75], v[208:211], v[140:143], v[72:75]
  s_waitcnt lgkmcnt(5)
  ds_read_b128 v[204:207], v242 offset:4608
  v_mfma_f32_16x16x32_bf16 v[84:87], v[212:215], v[140:143], v[84:87]
  v_mfma_f32_16x16x32_bf16 v[100:103], v[212:215], v[164:167], v[100:103]
  s_waitcnt lgkmcnt(5)
  ds_read_b128 v[208:211], v243 offset:5376
  v_mfma_f32_16x16x32_bf16 v[108:111], v[216:219], v[144:147], v[108:111]
  s_waitcnt lgkmcnt(5)
  ds_read_b128 v[212:215], v243 offset:4608
  v_mfma_f32_16x16x32_bf16 v[88:91], v[220:223], v[120:123], v[88:91]
  v_max3_f32 v12, v72, v73, v12
  v_max3_f32 v12, v74, v75, v12
  v_mfma_f32_16x16x32_bf16 v[104:107], v[220:223], v[144:147], v[104:107]
  s_waitcnt lgkmcnt(5)
  ds_read_b128 v[216:219], v240 offset:5632
  v_max3_f32 v12, v84, v85, v12
  v_mfma_f32_16x16x32_bf16 v[108:111], v[224:227], v[148:151], v[108:111]
  s_waitcnt lgkmcnt(5)
  ds_read_b128 v[220:223], v240 offset:4864
  v_max3_f32 v12, v86, v87, v12
  v_mfma_f32_16x16x32_bf16 v[88:91], v[228:231], v[124:127], v[88:91]
  v_max3_f32 v13, v100, v101, v13
  v_max3_f32 v13, v102, v103, v13
  v_mfma_f32_16x16x32_bf16 v[104:107], v[228:231], v[148:151], v[104:107]
  s_waitcnt lgkmcnt(5)
  ds_read_b128 v[224:227], v241 offset:5632
  v_mfma_f32_16x16x32_bf16 v[108:111], v[200:203], v[152:155], v[108:111]
  s_waitcnt lgkmcnt(5)
  ds_read_b128 v[228:231], v241 offset:4864
  v_mfma_f32_16x16x32_bf16 v[88:91], v[204:207], v[128:131], v[88:91]
  v_mfma_f32_16x16x32_bf16 v[104:107], v[204:207], v[152:155], v[104:107]
  s_waitcnt lgkmcnt(5)
  ds_read_b128 v[200:203], v240 offset:6144
  v_mfma_f32_16x16x32_bf16 v[108:111], v[208:211], v[156:159], v[108:111]
  s_waitcnt lgkmcnt(5)
  ds_read_b128 v[204:207], v240 offset:6912
  v_mfma_f32_16x16x32_bf16 v[88:91], v[212:215], v[132:135], v[88:91]
  v_mfma_f32_16x16x32_bf16 v[104:107], v[212:215], v[156:159], v[104:107]
  s_waitcnt lgkmcnt(5)
  ds_read_b128 v[208:211], v241 offset:6144
  v_mfma_f32_16x16x32_bf16 v[108:111], v[216:219], v[160:163], v[108:111]
  s_waitcnt lgkmcnt(5)
  ds_read_b128 v[212:215], v241 offset:6912
  v_mfma_f32_16x16x32_bf16 v[88:91], v[220:223], v[136:139], v[88:91]
  v_mfma_f32_16x16x32_bf16 v[104:107], v[220:223], v[160:163], v[104:107]
  s_waitcnt lgkmcnt(5)
  ds_read_b128 v[216:219], v242 offset:6144
  v_mfma_f32_16x16x32_bf16 v[108:111], v[224:227], v[164:167], v[108:111]
  s_waitcnt lgkmcnt(5)
  ds_read_b128 v[220:223], v242 offset:6912
  v_mfma_f32_16x16x32_bf16 v[88:91], v[228:231], v[140:143], v[88:91]
  v_mfma_f32_16x16x32_bf16 v[104:107], v[228:231], v[164:167], v[104:107]
  s_waitcnt lgkmcnt(5)
  ds_read_b128 v[224:227], v243 offset:6144
  v_mfma_f32_16x16x32_bf16 v[112:115], v[200:203], v[144:147], v[112:115]
  s_waitcnt lgkmcnt(5)
  ds_read_b128 v[228:231], v243 offset:6912
  v_mfma_f32_16x16x32_bf16 v[116:119], v[204:207], v[144:147], v[116:119]
  s_waitcnt lgkmcnt(5)
  ds_read_b128 v[200:203], v240 offset:6400
  v_max3_f32 v13, v108, v109, v13
  v_mfma_f32_16x16x32_bf16 v[112:115], v[208:211], v[148:151], v[112:115]
  s_waitcnt lgkmcnt(5)
  ds_read_b128 v[204:207], v240 offset:7168
  v_max3_f32 v13, v110, v111, v13
  v_mfma_f32_16x16x32_bf16 v[116:119], v[212:215], v[148:151], v[116:119]
  s_waitcnt lgkmcnt(5)
  ds_read_b128 v[208:211], v241 offset:6400
  v_max3_f32 v12, v88, v89, v12
  v_mfma_f32_16x16x32_bf16 v[112:115], v[216:219], v[152:155], v[112:115]
  s_waitcnt lgkmcnt(5)
  ds_read_b128 v[212:215], v241 offset:7168
  v_max3_f32 v12, v90, v91, v12
  v_mfma_f32_16x16x32_bf16 v[116:119], v[220:223], v[152:155], v[116:119]
  s_waitcnt lgkmcnt(5)
  v_max3_f32 v13, v104, v105, v13
  v_max3_f32 v13, v106, v107, v13
  v_mfma_f32_16x16x32_bf16 v[112:115], v[224:227], v[156:159], v[112:115]
  s_waitcnt lgkmcnt(4)
  v_mov_b32 v14, v12
  s_nop 1
  v_permlane32_swap_b32 v12, v14
  v_mfma_f32_16x16x32_bf16 v[116:119], v[228:231], v[156:159], v[116:119]
  s_waitcnt lgkmcnt(3)
  v_max_f32 v12, v12, v14
  v_mfma_f32_16x16x32_bf16 v[112:115], v[200:203], v[160:163], v[112:115]
  s_waitcnt lgkmcnt(2)
  v_mfma_f32_16x16x32_bf16 v[116:119], v[204:207], v[160:163], v[116:119]
  s_waitcnt lgkmcnt(1)
  v_mov_b32 v14, v12
  v_mfma_f32_16x16x32_bf16 v[112:115], v[208:211], v[164:167], v[112:115]
  s_waitcnt lgkmcnt(0)
  v_mfma_f32_16x16x32_bf16 v[116:119], v[212:215], v[164:167], v[116:119]
  v_permlane16_swap_b32 v12, v14
  s_setprio 0
  s_cmp_lt_u32 s40, 4
  s_cbranch_scc1 M_pr2
  s_setprio 1
M_pr2:
  v_max_f32 v12, v12, v14
  v_mul_f32 v12, s63, v12
  v_max3_f32 v13, v112, v113, v13
  v_max3_f32 v13, v114, v115, v13
  v_max3_f32 v13, v116, v117, v13
  v_max3_f32 v13, v118, v119, v13
  v_mov_b32 v15, v13
  s_nop 1
  v_permlane32_swap_b32 v13, v15
  v_max_f32 v13, v13, v15
  v_mov_b32 v15, v13
  s_nop 1
  v_permlane16_swap_b32 v13, v15
  v_max_f32 v13, v13, v15
  v_mul_f32 v13, s63, v13
  v_fma_f32 v64, v64, s63, -v12
  v_fma_f32 v65, v65, s63, -v12
  v_fma_f32 v66, v66, s63, -v12
  v_fma_f32 v67, v67, s63, -v12
  v_exp_f32 v64, v64
  v_exp_f32 v65, v65
  v_exp_f32 v66, v66
  v_exp_f32 v67, v67
  v_fma_f32 v92, v92, s63, -v13
  v_fma_f32 v93, v93, s63, -v13
  v_fma_f32 v94, v94, s63, -v13
  v_fma_f32 v95, v95, s63, -v13
  v_exp_f32 v92, v92
  v_exp_f32 v93, v93
  v_exp_f32 v94, v94
  v_exp_f32 v95, v95
  v_cvt_pk_bf16_f32 v16, v64, v65
  v_cvt_pk_bf16_f32 v17, v66, v67
  v_cvt_pk_bf16_f32 v34, v92, v93
  v_cvt_pk_bf16_f32 v35, v94, v95
  v_fma_f32 v68, v68, s63, -v12
  v_fma_f32 v69, v69, s63, -v12
  v_fma_f32 v70, v70, s63, -v12
  v_fma_f32 v71, v71, s63, -v12
  v_exp_f32 v68, v68
  v_exp_f32 v69, v69
  v_exp_f32 v70, v70
  v_exp_f32 v71, v71
  v_fma_f32 v96, v96, s63, -v13
  v_fma_f32 v97, v97, s63, -v13
  v_fma_f32 v98, v98, s63, -v13
  v_fma_f32 v99, v99, s63, -v13
  v_exp_f32 v96, v96
  v_exp_f32 v97, v97
  v_exp_f32 v98, v98
  v_exp_f32 v99, v99
  v_cvt_pk_bf16_f32 v18, v68, v69
  v_cvt_pk_bf16_f32 v19, v70, v71
  v_cvt_pk_bf16_f32 v36, v96, v97
  v_cvt_pk_bf16_f32 v37, v98, v99
  s_cmp_lt_u32 s40, 4
  s_cbranch_scc1 M_e2
  s_barrier
M_e2:
  s_mov_b32 s55, 10240
  buffer_load_dwordx4 v[64:67], v252, s[24:27], s55 offen offset:0 sc1
  buffer_load_dwordx4 v[92:95], v252, s[24:27], s55 offen offset:1024 sc1
  buffer_load_dwordx4 v[68:71], v252, s[24:27], s55 offen offset:2048 sc1
  buffer_load_dwordx4 v[96:99], v252, s[24:27], s55 offen offset:3072 sc1
  v_fma_f32 v72, v72, s63, -v12
  v_fma_f32 v73, v73, s63, -v12
  v_fma_f32 v74, v74, s63, -v12
  v_fma_f32 v75, v75, s63, -v12
  v_exp_f32 v72, v72
  v_exp_f32 v73, v73
  v_exp_f32 v74, v74
  v_exp_f32 v75, v75
  v_fma_f32 v100, v100, s63, -v13
  v_fma_f32 v101, v101, s63, -v13
  v_fma_f32 v102, v102, s63, -v13
  v_fma_f32 v103, v103, s63, -v13
  v_exp_f32 v100, v100
  v_exp_f32 v101, v101
  v_exp_f32 v102, v102
  v_exp_f32 v103, v103
  v_cvt_pk_bf16_f32 v20, v72, v73
  v_cvt_pk_bf16_f32 v21, v74, v75
  v_cvt_pk_bf16_f32 v38, v100, v101
  v_cvt_pk_bf16_f32 v39, v102, v103
  s_mov_b32 s55, 14336
  buffer_load_dwordx4 v[72:75], v252, s[24:27], s55 offen offset:0 sc1
  buffer_load_dwordx4 v[100:103], v252, s[24:27], s55 offen offset:1024 sc1
  v_fma_f32 v76, v76, s63, -v12
  v_fma_f32 v77, v77, s63, -v12
  v_fma_f32 v78, v78, s63, -v12
  v_fma_f32 v79, v79, s63, -v12
  v_exp_f32 v76, v76
  v_exp_f32 v77, v77
  v_exp_f32 v78, v78
  v_exp_f32 v79, v79
  v_fma_f32 v104, v104, s63, -v13
  v_fma_f32 v105, v105, s63, -v13
  v_fma_f32 v106, v106, s63, -v13
  v_fma_f32 v107, v107, s63, -v13
  v_exp_f32 v104, v104
  v_exp_f32 v105, v105
  v_exp_f32 v106, v106
  v_exp_f32 v107, v107
  v_cvt_pk_bf16_f32 v22, v76, v77
  v_cvt_pk_bf16_f32 v23, v78, v79
  v_cvt_pk_bf16_f32 v40, v104, v105
  v_cvt_pk_bf16_f32 v41, v106, v107
  buffer_load_dwordx4 v[76:79], v252, s[24:27], s55 offen offset:2048 sc1
  buffer_load_dwordx4 v[104:107], v252, s[24:27], s55 offen offset:3072 sc1
  v_fma_f32 v80, v80, s63, -v12
  v_fma_f32 v81, v81, s63, -v12
  v_fma_f32 v82, v82, s63, -v12
  v_fma_f32 v83, v83, s63, -v12
  v_exp_f32 v80, v80
  v_exp_f32 v81, v81
  v_exp_f32 v82, v82
  v_exp_f32 v83, v83
  v_fma_f32 v108, v108, s63, -v13
  v_fma_f32 v109, v109, s63, -v13
  v_fma_f32 v110, v110, s63, -v13
  v_fma_f32 v111, v111, s63, -v13
  v_exp_f32 v108, v108
  v_exp_f32 v109, v109
  v_exp_f32 v110, v110
  v_exp_f32 v111, v111
  v_cvt_pk_bf16_f32 v24, v80, v81
  v_cvt_pk_bf16_f32 v25, v82, v83
  v_cvt_pk_bf16_f32 v42, v108, v109
  v_cvt_pk_bf16_f32 v43, v110, v111
  s_mov_b32 s55, 18432
  buffer_load_dwordx4 v[80:83], v252, s[24:27], s55 offen offset:0 sc1
  buffer_load_dwordx4 v[108:111], v252, s[24:27], s55 offen offset:1024 sc1
  v_fma_f32 v84, v84, s63, -v12
  v_fma_f32 v85, v85, s63, -v12
  v_fma_f32 v86, v86, s63, -v12
  v_fma_f32 v87, v87, s63, -v12
  v_exp_f32 v84, v84
  v_exp_f32 v85, v85
  v_exp_f32 v86, v86
  v_exp_f32 v87, v87
  v_fma_f32 v112, v112, s63, -v13
  v_fma_f32 v113, v113, s63, -v13
  v_fma_f32 v114, v114, s63, -v13
  v_fma_f32 v115, v115, s63, -v13
  v_exp_f32 v112, v112
  v_exp_f32 v113, v113
  v_exp_f32 v114, v114
  v_exp_f32 v115, v115
  v_cvt_pk_bf16_f32 v26, v84, v85
  v_cvt_pk_bf16_f32 v27, v86, v87
  v_cvt_pk_bf16_f32 v44, v112, v113
  v_cvt_pk_bf16_f32 v45, v114, v115
  buffer_load_dwordx4 v[84:87], v252, s[24:27], s55 offen offset:2048 sc1
  buffer_load_dwordx4 v[112:115], v252, s[24:27], s55 offen offset:3072 sc1
  ds_read_b64_tr_b16 v[200:201], v244 offset:0
  ds_read_b64_tr_b16 v[202:203], v244 offset:768
  ds_read_b64_tr_b16 v[204:205], v245 offset:0
  ds_read_b64_tr_b16 v[206:207], v245 offset:768
  ds_read_b64_tr_b16 v[208:209], v244 offset:1536
  ds_read_b64_tr_b16 v[210:211], v244 offset:2304
  ds_read_b64_tr_b16 v[212:213], v245 offset:1536
  ds_read_b64_tr_b16 v[214:215], v245 offset:2304
  ds_read_b64_tr_b16 v[216:217], v244 offset:3072
  ds_read_b64_tr_b16 v[218:219], v244 offset:3840
  ds_read_b64_tr_b16 v[220:221], v245 offset:3072
  ds_read_b64_tr_b16 v[222:223], v245 offset:3840
  v_fma_f32 v88, v88, s63, -v12
  v_fma_f32 v89, v89, s63, -v12
  v_fma_f32 v90, v90, s63, -v12
  v_fma_f32 v91, v91, s63, -v12
  v_exp_f32 v88, v88
  v_exp_f32 v89, v89
  v_exp_f32 v90, v90
  v_exp_f32 v91, v91
  v_fma_f32 v116, v116, s63, -v13
  v_fma_f32 v117, v117, s63, -v13
  v_fma_f32 v118, v118, s63, -v13
  v_fma_f32 v119, v119, s63, -v13
  v_exp_f32 v116, v116
  v_exp_f32 v117, v117
  v_exp_f32 v118, v118
  v_exp_f32 v119, v119
  v_cvt_pk_bf16_f32 v28, v88, v89
  v_cvt_pk_bf16_f32 v29, v90, v91
  v_cvt_pk_bf16_f32 v46, v116, v117
  v_cvt_pk_bf16_f32 v47, v118, v119
  s_mov_b32 s55, 22528
  buffer_load_dwordx4 v[88:91], v252, s[24:27], s55 offen offset:0 sc1
  buffer_load_dwordx4 v[116:119], v252, s[24:27], s55 offen offset:1024 sc1
  s_cmp_ge_u32 s40, 4
  s_cbranch_scc1 M_l2
  s_barrier
M_l2:
  s_setprio 2
  s_cmp_lt_u32 s40, 4
  s_cbranch_scc1 M_pr3
  s_setprio 3
M_pr3:
  s_waitcnt lgkmcnt(10)
  v_mfma_f32_16x16x32_bf16 v[168:171], v[200:203], v[16:19], 0
  s_waitcnt lgkmcnt(8)
  ds_read_b64_tr_b16 v[224:225], v244 offset:4608
  ds_read_b64_tr_b16 v[226:227], v244 offset:5376
  v_mfma_f32_16x16x32_bf16 v[172:175], v[204:207], v[16:19], 0
  s_waitcnt lgkmcnt(8)
  ds_read_b64_tr_b16 v[228:229], v245 offset:4608
  v_mfma_f32_16x16x32_bf16 v[168:171], v[208:211], v[20:23], v[168:171]
  ds_read_b64_tr_b16 v[230:231], v245 offset:5376
  v_mfma_f32_16x16x32_bf16 v[176:179], v[208:211], v[32:35], 0
  s_waitcnt lgkmcnt(8)
  ds_read_b64_tr_b16 v[200:201], v244 offset:6144
  v_mfma_f32_16x16x32_bf16 v[172:175], v[212:215], v[20:23], v[172:175]
  ds_read_b64_tr_b16 v[202:203], v244 offset:6912
  v_mfma_f32_16x16x32_bf16 v[180:183], v[212:215], v[32:35], 0
  s_waitcnt lgkmcnt(8)
  ds_read_b64_tr_b16 v[204:205], v245 offset:6144
  v_mfma_f32_16x16x32_bf16 v[168:171], v[216:219], v[24:27], v[168:171]
  ds_read_b64_tr_b16 v[206:207], v245 offset:6912
  v_mfma_f32_16x16x32_bf16 v[176:179], v[216:219], v[36:39], v[176:179]
  s_waitcnt lgkmcnt(8)
  ds_read_b64_tr_b16 v[208:209], v246 offset:0
  v_mfma_f32_16x16x32_bf16 v[172:175], v[220:223], v[24:27], v[172:175]
  ds_read_b64_tr_b16 v[210:211], v246 offset:768
  v_mfma_f32_16x16x32_bf16 v[180:183], v[220:223], v[36:39], v[180:183]
  s_waitcnt lgkmcnt(8)
  ds_read_b64_tr_b16 v[212:213], v247 offset:0
  ds_read_b64_tr_b16 v[214:215], v247 offset:768
  v_mfma_f32_16x16x32_bf16 v[168:171], v[224:227], v[28:31], v[168:171]
  ds_read_b64_tr_b16 v[216:217], v246 offset:1536
  v_mfma_f32_16x16x32_bf16 v[176:179], v[224:227], v[40:43], v[176:179]
  s_waitcnt lgkmcnt(9)
  ds_read_b64_tr_b16 v[218:219], v246 offset:2304
  v_mfma_f32_16x16x32_bf16 v[172:175], v[228:231], v[28:31], v[172:175]
  ds_read_b64_tr_b16 v[220:221], v247 offset:1536
  v_mfma_f32_16x16x32_bf16 v[180:183], v[228:231], v[40:43], v[180:183]
  s_waitcnt lgkmcnt(9)
  ds_read_b64_tr_b16 v[222:223], v247 offset:2304
  v_mfma_f32_16x16x32_bf16 v[176:179], v[200:203], v[44:47], v[176:179]
  s_waitcnt lgkmcnt(8)
  ds_read_b64_tr_b16 v[224:225], v246 offset:3072
  v_mfma_f32_16x16x32_bf16 v[180:183], v[204:207], v[44:47], v[180:183]
  s_waitcnt lgkmcnt(7)
  ds_read_b64_tr_b16 v[226:227], v246 offset:3840
  v_mfma_f32_16x16x32_bf16 v[184:187], v[208:211], v[16:19], 0
  s_waitcnt lgkmcnt(6)
  ds_read_b64_tr_b16 v[228:229], v247 offset:3072
  v_mfma_f32_16x16x32_bf16 v[188:191], v[212:215], v[16:19], 0
  ds_read_b64_tr_b16 v[230:231], v247 offset:3840
  v_mfma_f32_16x16x32_bf16 v[56:59], v[16:19], v[48:51], 0
  s_waitcnt lgkmcnt(6)
  ds_read_b64_tr_b16 v[200:201], v246 offset:4608
  v_mfma_f32_16x16x32_bf16 v[184:187], v[216:219], v[20:23], v[184:187]
  ds_read_b64_tr_b16 v[202:203], v246 offset:5376
  ds_read_b64_tr_b16 v[204:205], v247 offset:4608
  v_mfma_f32_16x16x32_bf16 v[192:195], v[216:219], v[32:35], 0
  s_waitcnt lgkmcnt(7)
  ds_read_b64_tr_b16 v[206:207], v247 offset:5376
  v_cvt_pk_bf16_f32 v120, v168, v169
  v_mfma_f32_16x16x32_bf16 v[188:191], v[220:223], v[20:23], v[188:191]
  ds_read_b64_tr_b16 v[208:209], v246 offset:6144
  v_cvt_pk_bf16_f32 v121, v170, v171
  v_mfma_f32_16x16x32_bf16 v[196:199], v[220:223], v[32:35], 0
  s_waitcnt lgkmcnt(7)
  ds_read_b64_tr_b16 v[210:211], v246 offset:6912
  v_cvt_pk_bf16_f32 v122, v172, v173
  v_mfma_f32_16x16x32_bf16 v[184:187], v[224:227], v[24:27], v[184:187]
  ds_read_b64_tr_b16 v[212:213], v247 offset:6144
  v_cvt_pk_bf16_f32 v123, v174, v175
  v_mfma_f32_16x16x32_bf16 v[192:195], v[224:227], v[36:39], v[192:195]
  s_waitcnt lgkmcnt(7)
  ds_read_b64_tr_b16 v[214:215], v247 offset:6912
  v_cvt_pk_bf16_f32 v144, v176, v177
  v_mfma_f32_16x16x32_bf16 v[188:191], v[228:231], v[24:27], v[188:191]
  ds_read_b64_tr_b16 v[216:217], v248 offset:0
  v_cvt_pk_bf16_f32 v145, v178, v179
  v_mfma_f32_16x16x32_bf16 v[196:199], v[228:231], v[36:39], v[196:199]
  s_waitcnt lgkmcnt(7)
  ds_read_b64_tr_b16 v[218:219], v248 offset:768
  v_cvt_pk_bf16_f32 v146, v180, v181
  v_mfma_f32_16x16x32_bf16 v[184:187], v[200:203], v[28:31], v[184:187]
  ds_read_b64_tr_b16 v[220:221], v249 offset:0
  v_cvt_pk_bf16_f32 v147, v182, v183
  v_mfma_f32_16x16x32_bf16 v[192:195], v[200:203], v[40:43], v[192:195]
  s_waitcnt lgkmcnt(7)
  ds_read_b64_tr_b16 v[222:223], v249 offset:768
  v_mfma_f32_16x16x32_bf16 v[188:191], v[204:207], v[28:31], v[188:191]
  ds_read_b64_tr_b16 v[224:225], v248 offset:1536
  ds_read_b64_tr_b16 v[226:227], v248 offset:2304
  v_mfma_f32_16x16x32_bf16 v[196:199], v[204:207], v[40:43], v[196:199]
  s_waitcnt lgkmcnt(8)
  ds_read_b64_tr_b16 v[228:229], v249 offset:1536
  v_mfma_f32_16x16x32_bf16 v[192:195], v[208:211], v[44:47], v[192:195]
  s_waitcnt lgkmcnt(7)
  ds_read_b64_tr_b16 v[230:231], v249 offset:2304
  v_mfma_f32_16x16x32_bf16 v[196:199], v[212:215], v[44:47], v[196:199]
  ds_read_b64_tr_b16 v[200:201], v248 offset:3072
  v_mfma_f32_16x16x32_bf16 v[60:63], v[32:35], v[48:51], 0
  ds_read_b64_tr_b16 v[202:203], v248 offset:3840
  s_cmp_ge_u32 s40, 4
  s_cbranch_scc1 M_l3
  s_barrier
M_l3:
  s_waitcnt lgkmcnt(8)
  v_mfma_f32_16x16x32_bf16 v[168:171], v[216:219], v[16:19], 0
  s_waitcnt lgkmcnt(6)
  ds_read_b64_tr_b16 v[204:205], v249 offset:3072
  v_mfma_f32_16x16x32_bf16 v[172:175], v[220:223], v[16:19], 0
  ds_read_b64_tr_b16 v[206:207], v249 offset:3840
  v_mfma_f32_16x16x32_bf16 v[56:59], v[20:23], v[48:51], v[56:59]
  s_waitcnt lgkmcnt(6)
  ds_read_b64_tr_b16 v[208:209], v248 offset:4608
  v_mfma_f32_16x16x32_bf16 v[168:171], v[224:227], v[20:23], v[168:171]
  ds_read_b64_tr_b16 v[210:211], v248 offset:5376
  v_cvt_pk_bf16_f32 v124, v184, v185
  v_mfma_f32_16x16x32_bf16 v[176:179], v[224:227], v[32:35], 0
  s_waitcnt lgkmcnt(6)
  ds_read_b64_tr_b16 v[212:213], v249 offset:4608
  v_cvt_pk_bf16_f32 v125, v186, v187
  v_mfma_f32_16x16x32_bf16 v[172:175], v[228:231], v[20:23], v[172:175]
  ds_read_b64_tr_b16 v[214:215], v249 offset:5376
  ds_read_b64_tr_b16 v[216:217], v248 offset:6144
  v_mfma_f32_16x16x32_bf16 v[180:183], v[228:231], v[32:35], 0
  s_waitcnt lgkmcnt(7)
  ds_read_b64_tr_b16 v[218:219], v248 offset:6912
  v_cvt_pk_bf16_f32 v126, v188, v189
  v_mfma_f32_16x16x32_bf16 v[168:171], v[200:203], v[24:27], v[168:171]
  ds_read_b64_tr_b16 v[220:221], v249 offset:6144
  v_cvt_pk_bf16_f32 v127, v190, v191
  v_mfma_f32_16x16x32_bf16 v[176:179], v[200:203], v[36:39], v[176:179]
  s_waitcnt lgkmcnt(7)
  ds_read_b64_tr_b16 v[222:223], v249 offset:6912
  v_cvt_pk_bf16_f32 v148, v192, v193
  v_mfma_f32_16x16x32_bf16 v[172:175], v[204:207], v[24:27], v[172:175]
  ds_read_b64_tr_b16 v[224:225], v250 offset:0
  v_cvt_pk_bf16_f32 v149, v194, v195
  v_mfma_f32_16x16x32_bf16 v[180:183], v[204:207], v[36:39], v[180:183]
  s_waitcnt lgkmcnt(7)
  ds_read_b64_tr_b16 v[226:227], v250 offset:768
  v_cvt_pk_bf16_f32 v150, v196, v197
  v_mfma_f32_16x16x32_bf16 v[168:171], v[208:211], v[28:31], v[168:171]
  ds_read_b64_tr_b16 v[228:229], v251 offset:0
  v_cvt_pk_bf16_f32 v151, v198, v199
  v_mfma_f32_16x16x32_bf16 v[176:179], v[208:211], v[40:43], v[176:179]
  s_waitcnt lgkmcnt(7)
  ds_read_b64_tr_b16 v[230:231], v251 offset:768
  v_mfma_f32_16x16x32_bf16 v[172:175], v[212:215], v[28:31], v[172:175]
  ds_read_b64_tr_b16 v[200:201], v250 offset:1536
  v_mfma_f32_16x16x32_bf16 v[180:183], v[212:215], v[40:43], v[180:183]
  s_waitcnt lgkmcnt(7)
  ds_read_b64_tr_b16 v[202:203], v250 offset:2304
  v_mfma_f32_16x16x32_bf16 v[176:179], v[216:219], v[44:47], v[176:179]
  s_waitcnt lgkmcnt(6)
  ds_read_b64_tr_b16 v[204:205], v251 offset:1536
  ds_read_b64_tr_b16 v[206:207], v251 offset:2304
  v_mfma_f32_16x16x32_bf16 v[180:183], v[220:223], v[44:47], v[180:183]
  ds_read_b64_tr_b16 v[208:209], v250 offset:3072
  v_mfma_f32_16x16x32_bf16 v[60:63], v[36:39], v[48:51], v[60:63]
  s_waitcnt lgkmcnt(7)
  ds_read_b64_tr_b16 v[210:211], v250 offset:3840
  v_mfma_f32_16x16x32_bf16 v[184:187], v[224:227], v[16:19], 0
  s_waitcnt lgkmcnt(6)
  ds_read_b64_tr_b16 v[212:213], v251 offset:3072
  v_mfma_f32_16x16x32_bf16 v[188:191], v[228:231], v[16:19], 0
  ds_read_b64_tr_b16 v[214:215], v251 offset:3840
  v_mfma_f32_16x16x32_bf16 v[56:59], v[24:27], v[48:51], v[56:59]
  s_waitcnt lgkmcnt(6)
  ds_read_b64_tr_b16 v[216:217], v250 offset:4608
  v_mfma_f32_16x16x32_bf16 v[184:187], v[200:203], v[20:23], v[184:187]
  ds_read_b64_tr_b16 v[218:219], v250 offset:5376
  v_cvt_pk_bf16_f32 v128, v168, v169
  v_mfma_f32_16x16x32_bf16 v[192:195], v[200:203], v[32:35], 0
  s_waitcnt lgkmcnt(6)
  ds_read_b64_tr_b16 v[220:221], v251 offset:4608
  v_cvt_pk_bf16_f32 v129, v170, v171
  v_mfma_f32_16x16x32_bf16 v[188:191], v[204:207], v[20:23], v[188:191]
  ds_read_b64_tr_b16 v[222:223], v251 offset:5376
  v_cvt_pk_bf16_f32 v130, v172, v173
  v_mfma_f32_16x16x32_bf16 v[196:199], v[204:207], v[32:35], 0
  s_waitcnt lgkmcnt(6)
  ds_read_b64_tr_b16 v[224:225], v250 offset:6144
  ds_read_b64_tr_b16 v[226:227], v250 offset:6912
  v_mfma_f32_16x16x32_bf16 v[184:187], v[208:211], v[24:27], v[184:187]
  ds_read_b64_tr_b16 v[228:229], v251 offset:6144
  v_cvt_pk_bf16_f32 v131, v174, v175
  v_mfma_f32_16x16x32_bf16 v[192:195], v[208:211], v[36:39], v[192:195]
  s_waitcnt lgkmcnt(7)
  ds_read_b64_tr_b16 v[230:231], v251 offset:6912
  v_cvt_pk_bf16_f32 v152, v176, v177
  v_mfma_f32_16x16x32_bf16 v[188:191], v[212:215], v[24:27], v[188:191]
  ds_read_b64_tr_b16 v[200:201], v244 offset:256
  v_cvt_pk_bf16_f32 v153, v178, v179
  v_mfma_f32_16x16x32_bf16 v[196:199], v[212:215], v[36:39], v[196:199]
  s_waitcnt lgkmcnt(7)
  ds_read_b64_tr_b16 v[202:203], v244 offset:1024
  v_cvt_pk_bf16_f32 v154, v180, v181
  v_mfma_f32_16x16x32_bf16 v[184:187], v[216:219], v[28:31], v[184:187]
  ds_read_b64_tr_b16 v[204:205], v245 offset:256
  v_cvt_pk_bf16_f32 v155, v182, v183
  v_mfma_f32_16x16x32_bf16 v[192:195], v[216:219], v[40:43], v[192:195]
  s_waitcnt lgkmcnt(7)
  ds_read_b64_tr_b16 v[206:207], v245 offset:1024
  v_mfma_f32_16x16x32_bf16 v[188:191], v[220:223], v[28:31], v[188:191]
  ds_read_b64_tr_b16 v[208:209], v244 offset:1792
  v_mfma_f32_16x16x32_bf16 v[196:199], v[220:223], v[40:43], v[196:199]
  s_waitcnt lgkmcnt(7)
  ds_read_b64_tr_b16 v[210:211], v244 offset:2560
  v_mfma_f32_16x16x32_bf16 v[192:195], v[224:227], v[44:47], v[192:195]
  s_waitcnt lgkmcnt(6)
  ds_read_b64_tr_b16 v[212:213], v245 offset:1792
  v_mfma_f32_16x16x32_bf16 v[196:199], v[228:231], v[44:47], v[196:199]
  ds_read_b64_tr_b16 v[214:215], v245 offset:2560
  ds_read_b64_tr_b16 v[216:217], v244 offset:3328
  v_mfma_f32_16x16x32_bf16 v[60:63], v[40:43], v[48:51], v[60:63]
  s_waitcnt lgkmcnt(7)
  ds_read_b64_tr_b16 v[218:219], v244 offset:4096
  v_mfma_f32_16x16x32_bf16 v[168:171], v[200:203], v[16:19], 0
  s_waitcnt lgkmcnt(6)
  ds_read_b64_tr_b16 v[220:221], v245 offset:3328
  v_mfma_f32_16x16x32_bf16 v[172:175], v[204:207], v[16:19], 0
  ds_read_b64_tr_b16 v[222:223], v245 offset:4096
  v_mfma_f32_16x16x32_bf16 v[56:59], v[28:31], v[48:51], v[56:59]
  s_waitcnt lgkmcnt(6)
  ds_read_b64_tr_b16 v[224:225], v244 offset:4864
  v_mfma_f32_16x16x32_bf16 v[168:171], v[208:211], v[20:23], v[168:171]
  ds_read_b64_tr_b16 v[226:227], v244 offset:5632
  v_cvt_pk_bf16_f32 v132, v184, v185
  v_mfma_f32_16x16x32_bf16 v[176:179], v[208:211], v[32:35], 0
  s_waitcnt lgkmcnt(6)
  ds_read_b64_tr_b16 v[228:229], v245 offset:4864
  v_cvt_pk_bf16_f32 v133, v186, v187
  v_mfma_f32_16x16x32_bf16 v[172:175], v[212:215], v[20:23], v[172:175]
  ds_read_b64_tr_b16 v[230:231], v245 offset:5632
  v_cvt_pk_bf16_f32 v134, v188, v189
  v_mfma_f32_16x16x32_bf16 v[180:183], v[212:215], v[32:35], 0
  s_waitcnt lgkmcnt(6)
  ds_read_b64_tr_b16 v[200:201], v244 offset:6400
  v_cvt_pk_bf16_f32 v135, v190, v191
  v_mfma_f32_16x16x32_bf16 v[168:171], v[216:219], v[24:27], v[168:171]
  ds_read_b64_tr_b16 v[202:203], v244 offset:7168
  v_cvt_pk_bf16_f32 v156, v192, v193
  v_mfma_f32_16x16x32_bf16 v[176:179], v[216:219], v[36:39], v[176:179]
  s_waitcnt lgkmcnt(6)
  ds_read_b64_tr_b16 v[204:205], v245 offset:6400
  ds_read_b64_tr_b16 v[206:207], v245 offset:7168
  v_mfma_f32_16x16x32_bf16 v[172:175], v[220:223], v[24:27], v[172:175]
  ds_read_b64_tr_b16 v[208:209], v246 offset:256
  v_cvt_pk_bf16_f32 v157, v194, v195
  v_mfma_f32_16x16x32_bf16 v[180:183], v[220:223], v[36:39], v[180:183]
  s_waitcnt lgkmcnt(7)
  ds_read_b64_tr_b16 v[210:211], v246 offset:1024
  v_cvt_pk_bf16_f32 v158, v196, v197
  v_mfma_f32_16x16x32_bf16 v[168:171], v[224:227], v[28:31], v[168:171]
  ds_read_b64_tr_b16 v[212:213], v247 offset:256
  v_cvt_pk_bf16_f32 v159, v198, v199
  v_mfma_f32_16x16x32_bf16 v[176:179], v[224:227], v[40:43], v[176:179]
  s_waitcnt lgkmcnt(7)
  ds_read_b64_tr_b16 v[214:215], v247 offset:1024
  v_mfma_f32_16x16x32_bf16 v[172:175], v[228:231], v[28:31], v[172:175]
  ds_read_b64_tr_b16 v[216:217], v246 offset:1792
  v_mfma_f32_16x16x32_bf16 v[180:183], v[228:231], v[40:43], v[180:183]
  s_waitcnt lgkmcnt(7)
  ds_read_b64_tr_b16 v[218:219], v246 offset:2560
  v_mfma_f32_16x16x32_bf16 v[176:179], v[200:203], v[44:47], v[176:179]
  s_waitcnt lgkmcnt(6)
  ds_read_b64_tr_b16 v[220:221], v247 offset:1792
  v_mfma_f32_16x16x32_bf16 v[180:183], v[204:207], v[44:47], v[180:183]
  ds_read_b64_tr_b16 v[222:223], v247 offset:2560
  v_mfma_f32_16x16x32_bf16 v[60:63], v[44:47], v[48:51], v[60:63]
  s_waitcnt lgkmcnt(6)
  ds_read_b64_tr_b16 v[224:225], v246 offset:3328
  v_mfma_f32_16x16x32_bf16 v[184:187], v[208:211], v[16:19], 0
  s_waitcnt lgkmcnt(5)
  ds_read_b64_tr_b16 v[226:227], v246 offset:4096
  ds_read_b64_tr_b16 v[228:229], v247 offset:3328
  v_mfma_f32_16x16x32_bf16 v[188:191], v[212:215], v[16:19], 0
  s_waitcnt lgkmcnt(5)
  ds_read_b64_tr_b16 v[230:231], v247 offset:4096
  v_mfma_f32_16x16x32_bf16 v[184:187], v[216:219], v[20:23], v[184:187]
  ds_read_b64_tr_b16 v[200:201], v246 offset:4864
  v_mfma_f32_16x16x32_bf16 v[192:195], v[216:219], v[32:35], 0
  s_waitcnt lgkmcnt(5)
  ds_read_b64_tr_b16 v[202:203], v246 offset:5632
  v_cvt_pk_bf16_f32 v136, v168, v169
  v_mfma_f32_16x16x32_bf16 v[188:191], v[220:223], v[20:23], v[188:191]
  ds_read_b64_tr_b16 v[204:205], v247 offset:4864
  v_cvt_pk_bf16_f32 v137, v170, v171
  v_mfma_f32_16x16x32_bf16 v[196:199], v[220:223], v[32:35], 0
  s_waitcnt lgkmcnt(5)
  ds_read_b64_tr_b16 v[206:207], v247 offset:5632
  v_cvt_pk_bf16_f32 v138, v172, v173
  v_mfma_f32_16x16x32_bf16 v[184:187], v[224:227], v[24:27], v[184:187]
  ds_read_b64_tr_b16 v[208:209], v246 offset:6400
  v_cvt_pk_bf16_f32 v139, v174, v175
  v_mfma_f32_16x16x32_bf16 v[192:195], v[224:227], v[36:39], v[192:195]
  s_waitcnt lgkmcnt(5)
  ds_read_b64_tr_b16 v[210:211], v246 offset:7168
  v_cvt_pk_bf16_f32 v160, v176, v177
  v_mfma_f32_16x16x32_bf16 v[188:191], v[228:231], v[24:27], v[188:191]
  ds_read_b64_tr_b16 v[212:213], v247 offset:6400
  v_cvt_pk_bf16_f32 v161, v178, v179
  v_mfma_f32_16x16x32_bf16 v[196:199], v[228:231], v[36:39], v[196:199]
  s_waitcnt lgkmcnt(5)
  ds_read_b64_tr_b16 v[214:215], v247 offset:7168
  v_cvt_pk_bf16_f32 v162, v180, v181
  v_mfma_f32_16x16x32_bf16 v[184:187], v[200:203], v[28:31], v[184:187]
  v_cvt_pk_bf16_f32 v163, v182, v183
  v_mfma_f32_16x16x32_bf16 v[192:195], v[200:203], v[40:43], v[192:195]
  s_waitcnt lgkmcnt(4)
  v_mfma_f32_16x16x32_bf16 v[188:191], v[204:207], v[28:31], v[188:191]
  v_mfma_f32_16x16x32_bf16 v[196:199], v[204:207], v[40:43], v[196:199]
  s_waitcnt lgkmcnt(2)
  v_mfma_f32_16x16x32_bf16 v[192:195], v[208:211], v[44:47], v[192:195]
  s_waitcnt lgkmcnt(0)
  v_mfma_f32_16x16x32_bf16 v[196:199], v[212:215], v[44:47], v[196:199]
  s_waitcnt vmcnt(0)
  s_cmp_lt_u32 s40, 4
  s_cbranch_scc1 M_e3
  s_barrier
  s_mul_i32 s55, s40, 9216
  s_sub_u32 s55, s55, 24576
  s_add_u32 s59, s55, 24576
  s_mov_b32 m0, s55
  s_add_u32 s55, s55, 3072
  buffer_load_dwordx4 v252, s[24:27], s59 offen offset:0 sc1 lds
  buffer_load_dwordx4 v252, s[24:27], s59 offen offset:1024 sc1 lds
  buffer_load_dwordx4 v252, s[24:27], s59 offen offset:2048 sc1 lds
  s_add_u32 s59, s59, 3072
  s_mov_b32 m0, s55
  s_add_u32 s55, s55, 3072
  buffer_load_dwordx4 v252, s[24:27], s59 offen offset:0 sc1 lds
  buffer_load_dwordx4 v252, s[24:27], s59 offen offset:1024 sc1 lds
  buffer_load_dwordx4 v252, s[24:27], s59 offen offset:2048 sc1 lds
  s_add_u32 s59, s59, 3072
  s_mov_b32 m0, s55
  s_add_u32 s55, s55, 3072
  buffer_load_dwordx4 v252, s[24:27], s59 offen offset:0 sc1 lds
  buffer_load_dwordx4 v252, s[24:27], s59 offen offset:1024 sc1 lds
  buffer_load_dwordx4 v252, s[24:27], s59 offen offset:2048 sc1 lds
  s_add_u32 s59, s59, 3072
M_e3:
  v_cvt_pk_bf16_f32 v140, v184, v185
  v_cvt_pk_bf16_f32 v141, v186, v187
  v_cvt_pk_bf16_f32 v142, v188, v189
  v_cvt_pk_bf16_f32 v143, v190, v191
  v_cvt_pk_bf16_f32 v164, v192, v193
  v_cvt_pk_bf16_f32 v165, v194, v195
  v_cvt_pk_bf16_f32 v166, v196, v197
  v_cvt_pk_bf16_f32 v167, v198, v199
  ds_read_b128 v[200:203], v253 offset:0
  ds_read_b128 v[204:207], v253 offset:1024
  ds_read_b128 v[208:211], v253 offset:2048
  ds_read_b128 v[212:215], v253 offset:3072
  s_waitcnt lgkmcnt(3)
  v_mfma_f32_16x16x32_bf16 v[168:171], v[120:123], v[200:203], 0
  ds_read_b128 v[216:219], v253 offset:4096
  v_rcp_f32 v56, v56
  v_mfma_f32_16x16x32_bf16 v[176:179], v[144:147], v[200:203], 0
  s_waitcnt lgkmcnt(3)
  v_rcp_f32 v57, v57
  v_rcp_f32 v58, v58
  v_mfma_f32_16x16x32_bf16 v[172:175], v[120:123], v[204:207], 0
  ds_read_b128 v[220:223], v253 offset:5120
  v_rcp_f32 v59, v59
  v_mfma_f32_16x16x32_bf16 v[180:183], v[144:147], v[204:207], 0
  s_waitcnt lgkmcnt(3)
  v_rcp_f32 v60, v60
  v_rcp_f32 v61, v61
  v_mfma_f32_16x16x32_bf16 v[168:171], v[124:127], v[208:211], v[168:171]
  ds_read_b128 v[224:227], v253 offset:6144
  v_rcp_f32 v62, v62
  v_mfma_f32_16x16x32_bf16 v[176:179], v[148:151], v[208:211], v[176:179]
  s_waitcnt lgkmcnt(3)
  v_rcp_f32 v63, v63
  v_mfma_f32_16x16x32_bf16 v[172:175], v[124:127], v[212:215], v[172:175]
  ds_read_b128 v[228:231], v253 offset:7168
  v_mfma_f32_16x16x32_bf16 v[180:183], v[148:151], v[212:215], v[180:183]
  s_waitcnt lgkmcnt(3)
  v_mfma_f32_16x16x32_bf16 v[168:171], v[128:131], v[216:219], v[168:171]
  ds_read_b128 v[200:203], v253 offset:8192
  v_mfma_f32_16x16x32_bf16 v[176:179], v[152:155], v[216:219], v[176:179]
  s_waitcnt lgkmcnt(3)
  v_mfma_f32_16x16x32_bf16 v[172:175], v[128:131], v[220:223], v[172:175]
  ds_read_b128 v[204:207], v253 offset:9216
  v_mfma_f32_16x16x32_bf16 v[180:183], v[152:155], v[220:223], v[180:183]
  s_waitcnt lgkmcnt(3)
  v_mfma_f32_16x16x32_bf16 v[168:171], v[132:135], v[224:227], v[168:171]
  v_mfma_f32_16x16x32_bf16 v[176:179], v[156:159], v[224:227], v[176:179]
  s_waitcnt lgkmcnt(2)
  v_mfma_f32_16x16x32_bf16 v[172:175], v[132:135], v[228:231], v[172:175]
  v_mfma_f32_16x16x32_bf16 v[180:183], v[156:159], v[228:231], v[180:183]
  s_waitcnt lgkmcnt(1)
  v_mfma_f32_16x16x32_bf16 v[168:171], v[136:139], v[200:203], v[168:171]
  v_mfma_f32_16x16x32_bf16 v[176:179], v[160:163], v[200:203], v[176:179]
  s_waitcnt lgkmcnt(0)
  v_mfma_f32_16x16x32_bf16 v[172:175], v[136:139], v[204:207], v[172:175]
  v_mfma_f32_16x16x32_bf16 v[180:183], v[160:163], v[204:207], v[180:183]
  v_mfma_f32_16x16x32_bf16 v[168:171], v[140:143], v[64:67], v[168:171]
  v_mfma_f32_16x16x32_bf16 v[176:179], v[164:167], v[64:67], v[176:179]
  v_mfma_f32_16x16x32_bf16 v[172:175], v[140:143], v[92:95], v[172:175]
  v_mfma_f32_16x16x32_bf16 v[180:183], v[164:167], v[92:95], v[180:183]
  v_mfma_f32_16x16x32_bf16 v[184:187], v[120:123], v[68:71], 0
  v_mfma_f32_16x16x32_bf16 v[192:195], v[144:147], v[68:71], 0
  v_mfma_f32_16x16x32_bf16 v[188:191], v[120:123], v[96:99], 0
  s_nop 1
  v_mul_f32 v168, v168, v56
  s_nop 0
  v_mul_f32 v172, v172, v56
  v_mfma_f32_16x16x32_bf16 v[196:199], v[144:147], v[96:99], 0
  v_cvt_pk_bf16_f32 v16, v168, v172
  v_mul_f32 v169, v169, v57
  v_mfma_f32_16x16x32_bf16 v[184:187], v[124:127], v[72:75], v[184:187]
  v_mul_f32 v173, v173, v57
  v_cvt_pk_bf16_f32 v18, v169, v173
  v_mfma_f32_16x16x32_bf16 v[192:195], v[148:151], v[72:75], v[192:195]
  v_mul_f32 v170, v170, v58
  v_mul_f32 v174, v174, v58
  v_mfma_f32_16x16x32_bf16 v[188:191], v[124:127], v[100:103], v[188:191]
  v_cvt_pk_bf16_f32 v20, v170, v174
  v_mul_f32 v171, v171, v59
  v_mfma_f32_16x16x32_bf16 v[196:199], v[148:151], v[100:103], v[196:199]
  v_mul_f32 v175, v175, v59
  v_cvt_pk_bf16_f32 v22, v171, v175
  v_mfma_f32_16x16x32_bf16 v[184:187], v[128:131], v[76:79], v[184:187]
  v_mul_f32 v176, v176, v60
  v_mul_f32 v180, v180, v60
  v_mfma_f32_16x16x32_bf16 v[192:195], v[152:155], v[76:79], v[192:195]
  v_cvt_pk_bf16_f32 v24, v176, v180
  v_mul_f32 v177, v177, v61
  v_mfma_f32_16x16x32_bf16 v[188:191], v[128:131], v[104:107], v[188:191]
  v_mul_f32 v181, v181, v61
  v_cvt_pk_bf16_f32 v26, v177, v181
  v_mfma_f32_16x16x32_bf16 v[196:199], v[152:155], v[104:107], v[196:199]
  v_mul_f32 v178, v178, v62
  v_mul_f32 v182, v182, v62
  v_mfma_f32_16x16x32_bf16 v[184:187], v[132:135], v[80:83], v[184:187]
  v_cvt_pk_bf16_f32 v28, v178, v182
  v_mul_f32 v179, v179, v63
  v_mfma_f32_16x16x32_bf16 v[192:195], v[156:159], v[80:83], v[192:195]
  v_mul_f32 v183, v183, v63
  v_cvt_pk_bf16_f32 v30, v179, v183
  v_mfma_f32_16x16x32_bf16 v[188:191], v[132:135], v[108:111], v[188:191]
  v_mfma_f32_16x16x32_bf16 v[196:199], v[156:159], v[108:111], v[196:199]
  s_cmp_lt_u32 s40, 4
  s_cbranch_scc1 M_e4
  s_waitcnt vmcnt(0)
  s_barrier
M_e4:
  v_mfma_f32_16x16x32_bf16 v[184:187], v[136:139], v[84:87], v[184:187]
  ds_read_b128 v[200:203], v252 offset:0
  v_mfma_f32_16x16x32_bf16 v[192:195], v[160:163], v[84:87], v[192:195]
  v_mfma_f32_16x16x32_bf16 v[188:191], v[136:139], v[112:115], v[188:191]
  ds_read_b128 v[204:207], v252 offset:1024
  v_mfma_f32_16x16x32_bf16 v[196:199], v[160:163], v[112:115], v[196:199]
  v_mfma_f32_16x16x32_bf16 v[184:187], v[140:143], v[88:91], v[184:187]
  ds_read_b128 v[208:211], v252 offset:2048
  v_mfma_f32_16x16x32_bf16 v[192:195], v[164:167], v[88:91], v[192:195]
  v_mfma_f32_16x16x32_bf16 v[188:191], v[140:143], v[116:119], v[188:191]
  ds_read_b128 v[212:215], v252 offset:3072
  v_mfma_f32_16x16x32_bf16 v[196:199], v[164:167], v[116:119], v[196:199]
  s_waitcnt lgkmcnt(3)
  v_mfma_f32_16x16x32_bf16 v[168:171], v[120:123], v[200:203], 0
  ds_read_b128 v[216:219], v252 offset:4096
  v_mfma_f32_16x16x32_bf16 v[176:179], v[144:147], v[200:203], 0
  s_waitcnt lgkmcnt(3)
  v_mfma_f32_16x16x32_bf16 v[172:175], v[120:123], v[204:207], 0
  ds_read_b128 v[220:223], v252 offset:5120
  v_mul_f32 v184, v184, v56
  v_mfma_f32_16x16x32_bf16 v[180:183], v[144:147], v[204:207], 0
  s_waitcnt lgkmcnt(3)
  v_mul_f32 v188, v188, v56
  v_cvt_pk_bf16_f32 v17, v184, v188
  v_mfma_f32_16x16x32_bf16 v[168:171], v[124:127], v[208:211], v[168:171]
  ds_read_b128 v[224:227], v252 offset:6144
  v_mul_f32 v185, v185, v57
  v_mfma_f32_16x16x32_bf16 v[176:179], v[148:151], v[208:211], v[176:179]
  s_waitcnt lgkmcnt(3)
  buffer_store_dwordx2 v[16:17], v4, s[20:23], 0 offen offset:0 sc1
  v_mul_f32 v189, v189, v57
  v_mfma_f32_16x16x32_bf16 v[172:175], v[124:127], v[212:215], v[172:175]
  ds_read_b128 v[228:231], v252 offset:7168
  v_cvt_pk_bf16_f32 v19, v185, v189
  v_mfma_f32_16x16x32_bf16 v[180:183], v[148:151], v[212:215], v[180:183]
  s_waitcnt lgkmcnt(3)
  v_mul_f32 v186, v186, v58
  v_mul_f32 v190, v190, v58
  v_mfma_f32_16x16x32_bf16 v[168:171], v[128:131], v[216:219], v[168:171]
  ds_read_b128 v[200:203], v252 offset:8192
  v_cvt_pk_bf16_f32 v21, v186, v190
  v_mfma_f32_16x16x32_bf16 v[176:179], v[152:155], v[216:219], v[176:179]
  s_waitcnt lgkmcnt(3)
  buffer_store_dwordx2 v[18:19], v5, s[20:23], 0 offen offset:0 sc1
  v_mul_f32 v187, v187, v59
  v_mfma_f32_16x16x32_bf16 v[172:175], v[128:131], v[220:223], v[172:175]
  ds_read_b128 v[204:207], v252 offset:9216
  v_mul_f32 v191, v191, v59
  v_mfma_f32_16x16x32_bf16 v[180:183], v[152:155], v[220:223], v[180:183]
  s_waitcnt lgkmcnt(3)
  v_cvt_pk_bf16_f32 v23, v187, v191
  v_mul_f32 v192, v192, v60
  v_mfma_f32_16x16x32_bf16 v[168:171], v[132:135], v[224:227], v[168:171]
  ds_read_b128 v[208:211], v252 offset:10240
  v_mul_f32 v196, v196, v60
  v_mfma_f32_16x16x32_bf16 v[176:179], v[156:159], v[224:227], v[176:179]
  s_waitcnt lgkmcnt(3)
  buffer_store_dwordx2 v[20:21], v6, s[20:23], 0 offen offset:0 sc1
  v_cvt_pk_bf16_f32 v25, v192, v196
  v_mfma_f32_16x16x32_bf16 v[172:175], v[132:135], v[228:231], v[172:175]
  ds_read_b128 v[212:215], v252 offset:11264
  v_mul_f32 v193, v193, v61
  v_mfma_f32_16x16x32_bf16 v[180:183], v[156:159], v[228:231], v[180:183]
  s_waitcnt lgkmcnt(3)
  v_mul_f32 v197, v197, v61
  v_cvt_pk_bf16_f32 v27, v193, v197
  v_mfma_f32_16x16x32_bf16 v[168:171], v[136:139], v[200:203], v[168:171]
  ds_read_b128 v[216:219], v252 offset:12288
  v_mul_f32 v194, v194, v62
  v_mfma_f32_16x16x32_bf16 v[176:179], v[160:163], v[200:203], v[176:179]
  s_waitcnt lgkmcnt(3)
  buffer_store_dwordx2 v[22:23], v7, s[20:23], 0 offen offset:0 sc1
  v_mul_f32 v198, v198, v62
  v_mfma_f32_16x16x32_bf16 v[172:175], v[136:139], v[204:207], v[172:175]
  ds_read_b128 v[220:223], v252 offset:13312
  v_cvt_pk_bf16_f32 v29, v194, v198
  v_mfma_f32_16x16x32_bf16 v[180:183], v[160:163], v[204:207], v[180:183]
  s_waitcnt lgkmcnt(3)
  v_mul_f32 v195, v195, v63
  v_mul_f32 v199, v199, v63
  v_mfma_f32_16x16x32_bf16 v[168:171], v[140:143], v[208:211], v[168:171]
  ds_read_b128 v[224:227], v252 offset:14336
  v_cvt_pk_bf16_f32 v31, v195, v199
  v_mfma_f32_16x16x32_bf16 v[176:179], v[164:167], v[208:211], v[176:179]
  s_waitcnt lgkmcnt(3)
  buffer_store_dwordx2 v[24:25], v8, s[20:23], 0 offen offset:0 sc1
  v_mfma_f32_16x16x32_bf16 v[172:175], v[140:143], v[212:215], v[172:175]
  ds_read_b128 v[228:231], v252 offset:15360
  v_mfma_f32_16x16x32_bf16 v[180:183], v[164:167], v[212:215], v[180:183]
  s_waitcnt lgkmcnt(3)
  v_mfma_f32_16x16x32_bf16 v[184:187], v[120:123], v[216:219], 0
  ds_read_b128 v[200:203], v252 offset:16384
  v_mfma_f32_16x16x32_bf16 v[192:195], v[144:147], v[216:219], 0
  s_waitcnt lgkmcnt(3)
  buffer_store_dwordx2 v[26:27], v9, s[20:23], 0 offen offset:0 sc1
  v_mfma_f32_16x16x32_bf16 v[188:191], v[120:123], v[220:223], 0
  ds_read_b128 v[204:207], v252 offset:17408
  v_mul_f32 v168, v168, v56
  v_mfma_f32_16x16x32_bf16 v[196:199], v[144:147], v[220:223], 0
  s_waitcnt lgkmcnt(3)
  v_mul_f32 v172, v172, v56
  v_cvt_pk_bf16_f32 v16, v168, v172
  v_mfma_f32_16x16x32_bf16 v[184:187], v[124:127], v[224:227], v[184:187]
  ds_read_b128 v[208:211], v252 offset:18432
  v_mul_f32 v169, v169, v57
  v_mfma_f32_16x16x32_bf16 v[192:195], v[148:151], v[224:227], v[192:195]
  s_waitcnt lgkmcnt(3)
  buffer_store_dwordx2 v[28:29], v10, s[20:23], 0 offen offset:0 sc1
  v_mul_f32 v173, v173, v57
  v_mfma_f32_16x16x32_bf16 v[188:191], v[124:127], v[228:231], v[188:191]
  ds_read_b128 v[212:215], v252 offset:19456
  v_cvt_pk_bf16_f32 v18, v169, v173
  v_mfma_f32_16x16x32_bf16 v[196:199], v[148:151], v[228:231], v[196:199]
  s_waitcnt lgkmcnt(3)
  v_mul_f32 v170, v170, v58
  v_mul_f32 v174, v174, v58
  v_mfma_f32_16x16x32_bf16 v[184:187], v[128:131], v[200:203], v[184:187]
  ds_read_b128 v[216:219], v252 offset:20480
  v_cvt_pk_bf16_f32 v20, v170, v174
  v_mfma_f32_16x16x32_bf16 v[192:195], v[152:155], v[200:203], v[192:195]
  s_waitcnt lgkmcnt(3)
  buffer_store_dwordx2 v[30:31], v11, s[20:23], 0 offen offset:0 sc1
  v_mul_f32 v171, v171, v59
  v_mfma_f32_16x16x32_bf16 v[188:191], v[128:131], v[204:207], v[188:191]
  ds_read_b128 v[220:223], v252 offset:21504
  v_mul_f32 v175, v175, v59
  v_mfma_f32_16x16x32_bf16 v[196:199], v[152:155], v[204:207], v[196:199]
  s_waitcnt lgkmcnt(3)
  v_cvt_pk_bf16_f32 v22, v171, v175
  v_mul_f32 v176, v176, v60
  v_mfma_f32_16x16x32_bf16 v[184:187], v[132:135], v[208:211], v[184:187]
  ds_read_b128 v[224:227], v252 offset:22528
  v_mul_f32 v180, v180, v60
  v_mfma_f32_16x16x32_bf16 v[192:195], v[156:159], v[208:211], v[192:195]
  s_waitcnt lgkmcnt(3)
  v_cvt_pk_bf16_f32 v24, v176, v180
  v_mul_f32 v177, v177, v61
  v_mfma_f32_16x16x32_bf16 v[188:191], v[132:135], v[212:215], v[188:191]
  ds_read_b128 v[228:231], v252 offset:23552
  v_mul_f32 v181, v181, v61
  v_mfma_f32_16x16x32_bf16 v[196:199], v[156:159], v[212:215], v[196:199]
  s_waitcnt lgkmcnt(3)
  v_cvt_pk_bf16_f32 v26, v177, v181
  v_mul_f32 v178, v178, v62
  v_mfma_f32_16x16x32_bf16 v[184:187], v[136:139], v[216:219], v[184:187]
  ds_read_b128 v[200:203], v252 offset:24576
  v_mul_f32 v182, v182, v62
  v_mfma_f32_16x16x32_bf16 v[192:195], v[160:163], v[216:219], v[192:195]
  s_waitcnt lgkmcnt(3)
  v_cvt_pk_bf16_f32 v28, v178, v182
  v_mul_f32 v179, v179, v63
  v_mfma_f32_16x16x32_bf16 v[188:191], v[136:139], v[220:223], v[188:191]
  ds_read_b128 v[204:207], v252 offset:25600
  v_mul_f32 v183, v183, v63
  v_mfma_f32_16x16x32_bf16 v[196:199], v[160:163], v[220:223], v[196:199]
  s_waitcnt lgkmcnt(3)
  v_cvt_pk_bf16_f32 v30, v179, v183
  v_mfma_f32_16x16x32_bf16 v[184:187], v[140:143], v[224:227], v[184:187]
  ds_read_b128 v[208:211], v252 offset:26624
  v_mfma_f32_16x16x32_bf16 v[192:195], v[164:167], v[224:227], v[192:195]
  s_waitcnt lgkmcnt(3)
  v_mfma_f32_16x16x32_bf16 v[188:191], v[140:143], v[228:231], v[188:191]
  ds_read_b128 v[212:215], v252 offset:27648
  v_mfma_f32_16x16x32_bf16 v[196:199], v[164:167], v[228:231], v[196:199]
  s_waitcnt lgkmcnt(3)
  v_mfma_f32_16x16x32_bf16 v[168:171], v[120:123], v[200:203], 0
  ds_read_b128 v[216:219], v252 offset:28672
  v_mfma_f32_16x16x32_bf16 v[176:179], v[144:147], v[200:203], 0
  s_waitcnt lgkmcnt(3)
  v_mfma_f32_16x16x32_bf16 v[172:175], v[120:123], v[204:207], 0
  ds_read_b128 v[220:223], v252 offset:29696
  v_mul_f32 v184, v184, v56
  v_mfma_f32_16x16x32_bf16 v[180:183], v[144:147], v[204:207], 0
  s_waitcnt lgkmcnt(3)
  v_mul_f32 v188, v188, v56
  v_cvt_pk_bf16_f32 v17, v184, v188
  v_mfma_f32_16x16x32_bf16 v[168:171], v[124:127], v[208:211], v[168:171]
  ds_read_b128 v[224:227], v252 offset:30720
  v_mul_f32 v185, v185, v57
  v_mfma_f32_16x16x32_bf16 v[176:179], v[148:151], v[208:211], v[176:179]
  s_waitcnt lgkmcnt(3)
  buffer_store_dwordx2 v[16:17], v4, s[20:23], 0 offen offset:128 sc1
  v_mul_f32 v189, v189, v57
  v_mfma_f32_16x16x32_bf16 v[172:175], v[124:127], v[212:215], v[172:175]
  ds_read_b128 v[228:231], v252 offset:31744
  v_cvt_pk_bf16_f32 v19, v185, v189
  v_mfma_f32_16x16x32_bf16 v[180:183], v[148:151], v[212:215], v[180:183]
  s_waitcnt lgkmcnt(3)
  v_mul_f32 v186, v186, v58
  v_mul_f32 v190, v190, v58
  v_mfma_f32_16x16x32_bf16 v[168:171], v[128:131], v[216:219], v[168:171]
  ds_read_b128 v[200:203], v252 offset:32768
  v_cvt_pk_bf16_f32 v21, v186, v190
  v_mfma_f32_16x16x32_bf16 v[176:179], v[152:155], v[216:219], v[176:179]
  s_waitcnt lgkmcnt(3)
  buffer_store_dwordx2 v[18:19], v5, s[20:23], 0 offen offset:128 sc1
  v_mul_f32 v187, v187, v59
  v_mfma_f32_16x16x32_bf16 v[172:175], v[128:131], v[220:223], v[172:175]
  ds_read_b128 v[204:207], v252 offset:33792
  v_mul_f32 v191, v191, v59
  v_mfma_f32_16x16x32_bf16 v[180:183], v[152:155], v[220:223], v[180:183]
  s_waitcnt lgkmcnt(3)
  v_cvt_pk_bf16_f32 v23, v187, v191
  v_mul_f32 v192, v192, v60
  v_mfma_f32_16x16x32_bf16 v[168:171], v[132:135], v[224:227], v[168:171]
  ds_read_b128 v[208:211], v252 offset:34816
  v_mul_f32 v196, v196, v60
  v_mfma_f32_16x16x32_bf16 v[176:179], v[156:159], v[224:227], v[176:179]
  s_waitcnt lgkmcnt(3)
  buffer_store_dwordx2 v[20:21], v6, s[20:23], 0 offen offset:128 sc1
  v_cvt_pk_bf16_f32 v25, v192, v196
  v_mfma_f32_16x16x32_bf16 v[172:175], v[132:135], v[228:231], v[172:175]
  ds_read_b128 v[212:215], v252 offset:35840
  v_mul_f32 v193, v193, v61
  v_mfma_f32_16x16x32_bf16 v[180:183], v[156:159], v[228:231], v[180:183]
  s_waitcnt lgkmcnt(3)
  v_mul_f32 v197, v197, v61
  v_cvt_pk_bf16_f32 v27, v193, v197
  v_mfma_f32_16x16x32_bf16 v[168:171], v[136:139], v[200:203], v[168:171]
  ds_read_b128 v[216:219], v252 offset:36864
  v_mul_f32 v194, v194, v62
  v_mfma_f32_16x16x32_bf16 v[176:179], v[160:163], v[200:203], v[176:179]
  s_waitcnt lgkmcnt(3)
  buffer_store_dwordx2 v[22:23], v7, s[20:23], 0 offen offset:128 sc1
  v_mul_f32 v198, v198, v62
  v_mfma_f32_16x16x32_bf16 v[172:175], v[136:139], v[204:207], v[172:175]
  ds_read_b128 v[220:223], v252 offset:37888
  v_cvt_pk_bf16_f32 v29, v194, v198
  v_mfma_f32_16x16x32_bf16 v[180:183], v[160:163], v[204:207], v[180:183]
  s_waitcnt lgkmcnt(3)
  v_mul_f32 v195, v195, v63
  v_mul_f32 v199, v199, v63
  v_mfma_f32_16x16x32_bf16 v[168:171], v[140:143], v[208:211], v[168:171]
  ds_read_b128 v[224:227], v252 offset:38912
  v_cvt_pk_bf16_f32 v31, v195, v199
  v_mfma_f32_16x16x32_bf16 v[176:179], v[164:167], v[208:211], v[176:179]
  s_waitcnt lgkmcnt(3)
  buffer_store_dwordx2 v[24:25], v8, s[20:23], 0 offen offset:128 sc1
  v_mfma_f32_16x16x32_bf16 v[172:175], v[140:143], v[212:215], v[172:175]
  ds_read_b128 v[228:231], v252 offset:39936
  v_mfma_f32_16x16x32_bf16 v[180:183], v[164:167], v[212:215], v[180:183]
  s_waitcnt lgkmcnt(3)
  v_mfma_f32_16x16x32_bf16 v[184:187], v[120:123], v[216:219], 0
  ds_read_b128 v[200:203], v252 offset:40960
  v_mfma_f32_16x16x32_bf16 v[192:195], v[144:147], v[216:219], 0
  s_waitcnt lgkmcnt(3)
  buffer_store_dwordx2 v[26:27], v9, s[20:23], 0 offen offset:128 sc1
  v_mfma_f32_16x16x32_bf16 v[188:191], v[120:123], v[220:223], 0
  ds_read_b128 v[204:207], v252 offset:41984
  v_mul_f32 v168, v168, v56
  v_mfma_f32_16x16x32_bf16 v[196:199], v[144:147], v[220:223], 0
  s_waitcnt lgkmcnt(3)
  v_mul_f32 v172, v172, v56
  v_cvt_pk_bf16_f32 v16, v168, v172
  v_mfma_f32_16x16x32_bf16 v[184:187], v[124:127], v[224:227], v[184:187]
  ds_read_b128 v[208:211], v252 offset:43008
  v_mul_f32 v169, v169, v57
  v_mfma_f32_16x16x32_bf16 v[192:195], v[148:151], v[224:227], v[192:195]
  s_waitcnt lgkmcnt(3)
  buffer_store_dwordx2 v[28:29], v10, s[20:23], 0 offen offset:128 sc1
  v_mul_f32 v173, v173, v57
  v_mfma_f32_16x16x32_bf16 v[188:191], v[124:127], v[228:231], v[188:191]
  ds_read_b128 v[212:215], v252 offset:44032
  v_cvt_pk_bf16_f32 v18, v169, v173
  v_mfma_f32_16x16x32_bf16 v[196:199], v[148:151], v[228:231], v[196:199]
  s_waitcnt lgkmcnt(3)
  v_mul_f32 v170, v170, v58
  v_mul_f32 v174, v174, v58
  v_mfma_f32_16x16x32_bf16 v[184:187], v[128:131], v[200:203], v[184:187]
  ds_read_b128 v[216:219], v252 offset:45056
  v_cvt_pk_bf16_f32 v20, v170, v174
  v_mfma_f32_16x16x32_bf16 v[192:195], v[152:155], v[200:203], v[192:195]
  s_waitcnt lgkmcnt(3)
  buffer_store_dwordx2 v[30:31], v11, s[20:23], 0 offen offset:128 sc1
  v_mul_f32 v171, v171, v59
  v_mfma_f32_16x16x32_bf16 v[188:191], v[128:131], v[204:207], v[188:191]
  ds_read_b128 v[220:223], v252 offset:46080
  v_mul_f32 v175, v175, v59
  v_mfma_f32_16x16x32_bf16 v[196:199], v[152:155], v[204:207], v[196:199]
  s_waitcnt lgkmcnt(3)
  v_cvt_pk_bf16_f32 v22, v171, v175
  v_mul_f32 v176, v176, v60
  v_mfma_f32_16x16x32_bf16 v[184:187], v[132:135], v[208:211], v[184:187]
  ds_read_b128 v[224:227], v252 offset:47104
  v_mul_f32 v180, v180, v60
  v_mfma_f32_16x16x32_bf16 v[192:195], v[156:159], v[208:211], v[192:195]
  s_waitcnt lgkmcnt(3)
  v_cvt_pk_bf16_f32 v24, v176, v180
  v_mul_f32 v177, v177, v61
  v_mfma_f32_16x16x32_bf16 v[188:191], v[132:135], v[212:215], v[188:191]
  ds_read_b128 v[228:231], v252 offset:48128
  v_mul_f32 v181, v181, v61
  v_mfma_f32_16x16x32_bf16 v[196:199], v[156:159], v[212:215], v[196:199]
  s_waitcnt lgkmcnt(3)
  v_cvt_pk_bf16_f32 v26, v177, v181
  v_mul_f32 v178, v178, v62
  v_mfma_f32_16x16x32_bf16 v[184:187], v[136:139], v[216:219], v[184:187]
  v_mul_f32 v182, v182, v62
  v_cvt_pk_bf16_f32 v28, v178, v182
  v_mfma_f32_16x16x32_bf16 v[192:195], v[160:163], v[216:219], v[192:195]
  s_waitcnt lgkmcnt(2)
  v_mul_f32 v179, v179, v63
  v_mul_f32 v183, v183, v63
  v_mfma_f32_16x16x32_bf16 v[188:191], v[136:139], v[220:223], v[188:191]
  v_cvt_pk_bf16_f32 v30, v179, v183
  v_mfma_f32_16x16x32_bf16 v[196:199], v[160:163], v[220:223], v[196:199]
  s_waitcnt lgkmcnt(1)
  v_mfma_f32_16x16x32_bf16 v[184:187], v[140:143], v[224:227], v[184:187]
  v_mfma_f32_16x16x32_bf16 v[192:195], v[164:167], v[224:227], v[192:195]
  s_waitcnt lgkmcnt(0)
  v_mfma_f32_16x16x32_bf16 v[188:191], v[140:143], v[228:231], v[188:191]
  v_mfma_f32_16x16x32_bf16 v[196:199], v[164:167], v[228:231], v[196:199]
  s_nop 3
  v_mul_f32 v184, v184, v56
  s_nop 1
  v_mul_f32 v188, v188, v56
  v_cvt_pk_bf16_f32 v17, v184, v188
  buffer_store_dwordx2 v[16:17], v4, s[20:23], 0 offen offset:256 sc1
  v_mul_f32 v185, v185, v57
  v_mul_f32 v189, v189, v57
  v_cvt_pk_bf16_f32 v19, v185, v189
  buffer_store_dwordx2 v[18:19], v5, s[20:23], 0 offen offset:256 sc1
  v_mul_f32 v186, v186, v58
  v_mul_f32 v190, v190, v58
  v_cvt_pk_bf16_f32 v21, v186, v190
  buffer_store_dwordx2 v[20:21], v6, s[20:23], 0 offen offset:256 sc1
  v_mul_f32 v187, v187, v59
  v_mul_f32 v191, v191, v59
  v_cvt_pk_bf16_f32 v23, v187, v191
  buffer_store_dwordx2 v[22:23], v7, s[20:23], 0 offen offset:256 sc1
  v_mul_f32 v192, v192, v60
  v_mul_f32 v196, v196, v60
  v_cvt_pk_bf16_f32 v25, v192, v196
  buffer_store_dwordx2 v[24:25], v8, s[20:23], 0 offen offset:256 sc1
  v_mul_f32 v193, v193, v61
  v_mul_f32 v197, v197, v61
  v_cvt_pk_bf16_f32 v27, v193, v197
  buffer_store_dwordx2 v[26:27], v9, s[20:23], 0 offen offset:256 sc1
  v_mul_f32 v194, v194, v62
  v_mul_f32 v198, v198, v62
  v_cvt_pk_bf16_f32 v29, v194, v198
  buffer_store_dwordx2 v[28:29], v10, s[20:23], 0 offen offset:256 sc1
  v_mul_f32 v195, v195, v63
  v_mul_f32 v199, v199, v63
  v_cvt_pk_bf16_f32 v31, v195, v199
  buffer_store_dwordx2 v[30:31], v11, s[20:23], 0 offen offset:256 sc1
  s_endpgm
M_helper:
H_join:
  s_and_b32 s55, s2, 7
  s_lshr_b32 s56, s2, 3
  s_lshr_b32 s41, s55, 2
  s_bfe_u32 s42, s55, 0x10001
  s_and_b32 s55, s55, 1
  s_lshl_b32 s55, s55, 2
  s_lshr_b32 s43, s56, 3
  s_add_u32 s43, s43, s55
  s_and_b32 s44, s56, 7
  s_mul_i32 s43, s43, 14
  s_mul_i32 s44, s44, 14
  s_mul_i32 s61, s41, 13
  s_add_i32 s61, s61, -6
  s_mul_i32 s62, s42, 13
  s_add_i32 s62, s62, -6
  s_cmp_ge_u32 s40, 4
  s_cselect_b32 s53, -4, 3
  s_add_i32 s53, s53, s40
  s_lshl_b32 s53, s53, 1
  s_add_u32 s88, s43, s53
  s_mov_b32 s89, 86016
  s_movk_i32 s90, 384
  s_mul_i32 s55, s41, 6
  s_add_i32 s45, s43, s55
  s_add_i32 s45, s45, -6
  s_cmp_eq_i32 s45, -6
  s_cselect_b32 s47, 6, 0
  s_cmp_eq_i32 s45, 98
  s_cselect_b32 s48, 7, 13
  s_cselect_b32 s49, 2, 0
  s_sub_i32 s45, s45, s49
  s_mul_i32 s55, s42, 6
  s_add_i32 s56, s44, s55
  s_add_i32 s56, s56, -6
  s_cmp_eq_i32 s56, -6
  s_cselect_b32 s50, 6, 0
  s_cmp_eq_i32 s56, 98
  s_cselect_b32 s51, 7, 13
  s_lshl_b32 s56, s56, 1
  s_add_i32 s56, s56, s42
  s_mul_i32 s46, s56, 384
  s_max_i32 s92, s53, s47
  s_min_i32 s92, s92, s48
  s_and_b32 s92, s92, -2
  s_add_u32 s52, s92, s49
  s_mov_b32 s54, 4286578688
  s_mov_b32 s63, 1037384597
  s_and_b32 s93, s40, 1
  s_lshl_b32 s93, s93, 3
  s_and_b32 s56, s40, 6
  s_or_b32 s93, s93, s56
  s_add_u32 s56, s40, 8
  s_add_i32 s100, s45, s56
  s_lshl_b32 s100, s100, 1
  s_add_i32 s100, s100, s41
  s_max_i32 s100, s100, 0
  s_min_i32 s100, s100, 223
  s_mul_i32 s100, s100, 86016
  s_mul_i32 s101, s56, 7680
  v_add_u32 v4, 0, v1
  v_xor_b32 v4, 0, v4
  v_mul_u32_u24 v5, 2731, v4
  v_lshrrev_b32 v5, 16, v5
  v_mul_u32_u24 v5, 384, v5
  v_lshl_add_u32 v4, v4, 4, v5
  v_add_u32 v232, s46, v4
  v_add_u32 v235, 6144, v232
  v_add_u32 v238, 12288, v232
  v_max_i32 v232, 0, v232
  v_add_u32 v4, 64, v1
  v_xor_b32 v4, 0, v4
  v_mul_u32_u24 v5, 2731, v4
  v_lshrrev_b32 v5, 16, v5
  v_mul_u32_u24 v5, 384, v5
  v_lshl_add_u32 v4, v4, 4, v5
  v_add_u32 v233, s46, v4
  v_add_u32 v236, 6144, v233
  v_max_i32 v233, 0, v233
  v_add_u32 v4, 128, v1
  v_xor_b32 v4, 0, v4
  v_mul_u32_u24 v5, 2731, v4
  v_lshrrev_b32 v5, 16, v5
  v_mul_u32_u24 v5, 384, v5
  v_lshl_add_u32 v4, v4, 4, v5
  v_add_u32 v234, s46, v4
  v_add_u32 v237, 6144, v234
  v_max_i32 v234, 0, v234
  v_add_u32 v4, 416, v1
  v_xor_b32 v4, 0, v4
  v_mul_u32_u24 v5, 2731, v4
  v_lshrrev_b32 v5, 16, v5
  v_mul_u32_u24 v5, 384, v5
  v_lshl_add_u32 v4, v4, 4, v5
  v_add_u32 v239, s46, v4
  v_add_u32 v4, 0, v1
  v_xor_b32 v4, 8, v4
  v_mul_u32_u24 v5, 2731, v4
  v_lshrrev_b32 v5, 16, v5
  v_mul_u32_u24 v5, 384, v5
  v_lshl_add_u32 v4, v4, 4, v5
  v_add_u32 v244, s46, v4
  v_add_u32 v247, 6144, v244
  v_add_u32 v250, 12288, v244
  v_max_i32 v244, 0, v244
  v_add_u32 v4, 64, v1
  v_xor_b32 v4, 8, v4
  v_mul_u32_u24 v5, 2731, v4
  v_lshrrev_b32 v5, 16, v5
  v_mul_u32_u24 v5, 384, v5
  v_lshl_add_u32 v4, v4, 4, v5
  v_add_u32 v245, s46, v4
  v_add_u32 v248, 6144, v245
  v_max_i32 v245, 0, v245
  v_add_u32 v4, 128, v1
  v_xor_b32 v4, 8, v4
  v_mul_u32_u24 v5, 2731, v4
  v_lshrrev_b32 v5, 16, v5
  v_mul_u32_u24 v5, 384, v5
  v_lshl_add_u32 v4, v4, 4, v5
  v_add_u32 v246, s46, v4
  v_add_u32 v249, 6144, v246
  v_max_i32 v246, 0, v246
  v_add_u32 v4, 416, v1
  v_xor_b32 v4, 8, v4
  v_mul_u32_u24 v5, 2731, v4
  v_lshrrev_b32 v5, 16, v5
  v_mul_u32_u24 v5, 384, v5
  v_lshl_add_u32 v4, v4, 4, v5
  v_add_u32 v251, s46, v4
  s_barrier
  v_mov_b32 v6, 0
  s_mov_b32 s59, 0
  s_mov_b64 exec, 1
H_pollM:
  buffer_load_dword v7, v6, s[36:39], 0 offen offset:128 sc1
  s_waitcnt vmcnt(0)
  v_cmp_eq_u32 vcc, 0, v7
  s_add_u32 s59, s59, 1
  s_cmp_gt_u32 s59, 200000
  s_cbranch_scc1 H_pollM_x
  s_cmp_lg_u64 vcc, 0
  s_cbranch_scc0 H_pollM_x
  s_sleep 2
  s_branch H_pollM
H_pollM_x:
  s_mov_b64 exec, -1
  s_lshr_b32 s55, s2, 3
  s_mul_i32 s55, s55, 2304
  s_add_u32 s55, s55, 131072
  buffer_load_dwordx4 v[80:83], v252, s[24:27], s55 offen offset:0 sc1
  buffer_load_dwordx4 v[84:87], v252, s[24:27], s55 offen offset:1024 sc1
  buffer_load_dwordx4 v[88:91], v252, s[24:27], s55 offen offset:2048 sc1
  s_barrier
  s_lshl_b32 s55, s40, 10
  s_add_u32 s55, s55, 131072
  s_sub_u32 m0, s55, 40960
  s_nop 0
  buffer_load_dwordx4 v252, s[24:27], s55 offen sc1 lds
  s_add_u32 s55, s55, 4096
  s_sub_u32 m0, s55, 40960
  s_nop 0
  buffer_load_dwordx4 v252, s[24:27], s55 offen sc1 lds
  s_add_u32 s55, s55, 4096
  s_sub_u32 m0, s55, 40960
  s_nop 0
  buffer_load_dwordx4 v252, s[24:27], s55 offen sc1 lds
  s_add_u32 s55, s55, 4096
  s_sub_u32 m0, s55, 40960
  s_nop 0
  buffer_load_dwordx4 v252, s[24:27], s55 offen sc1 lds
  s_add_u32 s55, s55, 4096
  s_sub_u32 m0, s55, 40960
  s_nop 0
  buffer_load_dwordx4 v252, s[24:27], s55 offen sc1 lds
  s_add_u32 s55, s55, 4096
  s_sub_u32 m0, s55, 40960
  s_nop 0
  buffer_load_dwordx4 v252, s[24:27], s55 offen sc1 lds
  s_add_u32 s55, s55, 4096
  s_sub_u32 m0, s55, 40960
  s_nop 0
  buffer_load_dwordx4 v252, s[24:27], s55 offen sc1 lds
  s_add_u32 s55, s55, 4096
  s_sub_u32 m0, s55, 40960
  s_nop 0
  buffer_load_dwordx4 v252, s[24:27], s55 offen sc1 lds
  s_add_u32 s55, s55, 4096
  s_sub_u32 m0, s55, 40960
  s_nop 0
  buffer_load_dwordx4 v252, s[24:27], s55 offen sc1 lds
  s_add_u32 s55, s55, 4096
  s_sub_u32 m0, s55, 40960
  s_nop 0
  buffer_load_dwordx4 v252, s[24:27], s55 offen sc1 lds
  s_add_u32 s55, s55, 4096
  s_sub_u32 m0, s55, 40960
  s_nop 0
  buffer_load_dwordx4 v252, s[24:27], s55 offen sc1 lds
  s_add_u32 s55, s55, 4096
  s_sub_u32 m0, s55, 40960
  s_nop 0
  buffer_load_dwordx4 v252, s[24:27], s55 offen sc1 lds
  s_waitcnt vmcnt(6)
  s_barrier
  s_lshl_b32 s55, s40, 10
  s_add_u32 s55, s55, 180224
  s_sub_u32 m0, s55, 40960
  s_nop 0
  buffer_load_dwordx4 v252, s[24:27], s55 offen sc1 lds
  s_add_u32 s55, s55, 4096
  s_sub_u32 m0, s55, 40960
  s_nop 0
  buffer_load_dwordx4 v252, s[24:27], s55 offen sc1 lds
  s_add_u32 s55, s55, 4096
  s_sub_u32 m0, s55, 40960
  s_nop 0
  buffer_load_dwordx4 v252, s[24:27], s55 offen sc1 lds
  s_add_u32 s55, s55, 4096
  s_sub_u32 m0, s55, 40960
  s_nop 0
  buffer_load_dwordx4 v252, s[24:27], s55 offen sc1 lds
  s_add_u32 s55, s55, 4096
  s_sub_u32 m0, s55, 40960
  s_nop 0
  buffer_load_dwordx4 v252, s[24:27], s55 offen sc1 lds
  s_add_u32 s55, s55, 4096
  s_sub_u32 m0, s55, 40960
  s_nop 0
  buffer_load_dwordx4 v252, s[24:27], s55 offen sc1 lds
  v_mov_b32 v192, 1
  v_mov_b32 v193, 0
  s_waitcnt vmcnt(0)
  s_cmp_lt_u32 s2, 112
  s_cbranch_scc1 H_nov2
  v_mov_b32 v192, 1
  v_mov_b32 v193, 0
  s_mov_b64 exec, 1
  s_waitcnt vmcnt(0)
  buffer_atomic_add v192, v193, s[36:39], 0 offen offset:4 sc0 sc1
  s_mov_b64 exec, -1
H_nov2:
  s_add_i32 s56, s45, 0
  s_lshl_b32 s56, s56, 1
  s_add_i32 s56, s56, s41
  s_max_i32 s56, s56, 0
  s_min_i32 s56, s56, 223
  s_mul_i32 s56, s56, 86016
  s_mov_b32 m0, 0
  s_nop 0
  buffer_load_dwordx4 v232, s[16:19], s56 offen lds
  s_mov_b32 m0, 1024
  s_nop 0
  buffer_load_dwordx4 v233, s[16:19], s56 offen lds
  s_mov_b32 m0, 2048
  s_nop 0
  buffer_load_dwordx4 v234, s[16:19], s56 offen lds
  s_mov_b32 m0, 3072
  s_nop 0
  buffer_load_dwordx4 v235, s[16:19], s56 offen lds
  s_mov_b32 m0, 4096
  s_nop 0
  buffer_load_dwordx4 v236, s[16:19], s56 offen lds
  s_mov_b32 m0, 5120
  s_nop 0
  buffer_load_dwordx4 v237, s[16:19], s56 offen lds
  s_mov_b32 m0, 6144
  s_nop 0
  buffer_load_dwordx4 v238, s[16:19], s56 offen lds
  s_mov_b32 m0, 6656
  s_nop 0
  buffer_load_dwordx4 v239, s[16:19], s56 offen lds
  s_add_i32 s56, s45, 8
  s_lshl_b32 s56, s56, 1
  s_add_i32 s56, s56, s41
  s_max_i32 s56, s56, 0
  s_min_i32 s56, s56, 223
  s_mul_i32 s56, s56, 86016
  s_mov_b32 m0, 61440
  s_nop 0
  buffer_load_dwordx4 v232, s[16:19], s56 offen lds
  s_mov_b32 m0, 62464
  s_nop 0
  buffer_load_dwordx4 v233, s[16:19], s56 offen lds
  s_mov_b32 m0, 63488
  s_nop 0
  buffer_load_dwordx4 v234, s[16:19], s56 offen lds
  s_mov_b32 m0, 64512
  s_nop 0
  buffer_load_dwordx4 v235, s[16:19], s56 offen lds
  s_mov_b32 m0, 65536
  s_nop 0
  buffer_load_dwordx4 v236, s[16:19], s56 offen lds
  s_mov_b32 m0, 66560
  s_nop 0
  buffer_load_dwordx4 v237, s[16:19], s56 offen lds
  s_mov_b32 m0, 67584
  s_nop 0
  buffer_load_dwordx4 v238, s[16:19], s56 offen lds
  s_mov_b32 m0, 68096
  s_nop 0
  buffer_load_dwordx4 v239, s[16:19], s56 offen lds
  s_barrier
  s_barrier
  s_waitcnt vmcnt(0)
  v_readfirstlane_b32 s56, v192
  s_nop 0
  s_cmp_lg_u32 s56, 143
  s_cbranch_scc1 H_p2
  s_mov_b64 exec, 1
  buffer_store_dword v192, v193, s[36:39], 0 offen offset:132 sc1
  s_mov_b64 exec, -1
H_p2:
  s_barrier
  s_add_i32 s56, s45, 16
  s_lshl_b32 s56, s56, 1
  s_add_i32 s56, s56, s41
  s_max_i32 s56, s56, 0
  s_min_i32 s56, s56, 223
  s_mul_i32 s56, s56, 86016
  s_mov_b32 m0, 122880
  s_nop 0
  buffer_load_dwordx4 v232, s[16:19], s56 offen lds
  s_mov_b32 m0, 123904
  s_nop 0
  buffer_load_dwordx4 v233, s[16:19], s56 offen lds
  s_mov_b32 m0, 124928
  s_nop 0
  buffer_load_dwordx4 v234, s[16:19], s56 offen lds
  s_mov_b32 m0, 125952
  s_nop 0
  buffer_load_dwordx4 v235, s[16:19], s56 offen lds
  s_mov_b32 m0, 126976
  s_nop 0
  buffer_load_dwordx4 v236, s[16:19], s56 offen lds
  s_mov_b32 m0, 128000
  s_nop 0
  buffer_load_dwordx4 v237, s[16:19], s56 offen lds
  s_mov_b32 m0, 129024
  s_nop 0
  buffer_load_dwordx4 v238, s[16:19], s56 offen lds
  s_mov_b32 m0, 129536
  s_nop 0
  buffer_load_dwordx4 v239, s[16:19], s56 offen lds
  s_add_i32 s56, s45, 17
  s_lshl_b32 s56, s56, 1
  s_add_i32 s56, s56, s41
  s_max_i32 s56, s56, 0
  s_min_i32 s56, s56, 223
  s_mul_i32 s56, s56, 86016
  s_mov_b32 m0, 130560
  s_nop 0
  buffer_load_dwordx4 v244, s[16:19], s56 offen lds
  s_mov_b32 m0, 131584
  s_nop 0
  buffer_load_dwordx4 v245, s[16:19], s56 offen lds
  s_mov_b32 m0, 132608
  s_nop 0
  buffer_load_dwordx4 v246, s[16:19], s56 offen lds
  s_mov_b32 m0, 133632
  s_nop 0
  buffer_load_dwordx4 v247, s[16:19], s56 offen lds
  s_mov_b32 m0, 134656
  s_nop 0
  buffer_load_dwordx4 v248, s[16:19], s56 offen lds
  s_mov_b32 m0, 135680
  s_nop 0
  buffer_load_dwordx4 v249, s[16:19], s56 offen lds
  s_mov_b32 m0, 136704
  s_nop 0
  buffer_load_dwordx4 v250, s[16:19], s56 offen lds
  s_mov_b32 m0, 137216
  s_nop 0
  buffer_load_dwordx4 v251, s[16:19], s56 offen lds
  s_add_i32 s56, s45, 18
  s_lshl_b32 s56, s56, 1
  s_add_i32 s56, s56, s41
  s_max_i32 s56, s56, 0
  s_min_i32 s56, s56, 223
  s_mul_i32 s56, s56, 86016
  v_xor_b32 v64, 32, v232
  s_mov_b32 m0, 138240
  s_nop 0
  buffer_load_dwordx4 v64, s[16:19], s56 offen lds
  v_xor_b32 v65, 32, v233
  s_mov_b32 m0, 139264
  s_nop 0
  buffer_load_dwordx4 v65, s[16:19], s56 offen lds
  v_xor_b32 v66, 32, v234
  s_mov_b32 m0, 140288
  s_nop 0
  buffer_load_dwordx4 v66, s[16:19], s56 offen lds
  v_xor_b32 v67, 32, v235
  s_mov_b32 m0, 141312
  s_nop 0
  buffer_load_dwordx4 v67, s[16:19], s56 offen lds
  v_xor_b32 v68, 32, v236
  s_mov_b32 m0, 142336
  s_nop 0
  buffer_load_dwordx4 v68, s[16:19], s56 offen lds
  v_xor_b32 v69, 32, v237
  s_mov_b32 m0, 143360
  s_nop 0
  buffer_load_dwordx4 v69, s[16:19], s56 offen lds
  v_xor_b32 v70, 32, v238
  s_mov_b32 m0, 144384
  s_nop 0
  buffer_load_dwordx4 v70, s[16:19], s56 offen lds
  v_xor_b32 v71, 32, v239
  s_mov_b32 m0, 144896
  s_nop 0
  buffer_load_dwordx4 v71, s[16:19], s56 offen lds
  s_add_i32 s56, s45, 19
  s_lshl_b32 s56, s56, 1
  s_add_i32 s56, s56, s41
  s_max_i32 s56, s56, 0
  s_min_i32 s56, s56, 223
  s_mul_i32 s56, s56, 86016
  v_xor_b32 v64, 32, v244
  s_mov_b32 m0, 145920
  s_nop 0
  buffer_load_dwordx4 v64, s[16:19], s56 offen lds
  v_xor_b32 v65, 32, v245
  s_mov_b32 m0, 146944
  s_nop 0
  buffer_load_dwordx4 v65, s[16:19], s56 offen lds
  v_xor_b32 v66, 32, v246
  s_mov_b32 m0, 147968
  s_nop 0
  buffer_load_dwordx4 v66, s[16:19], s56 offen lds
  v_xor_b32 v67, 32, v247
  s_mov_b32 m0, 148992
  s_nop 0
  buffer_load_dwordx4 v67, s[16:19], s56 offen lds
  v_xor_b32 v68, 32, v248
  s_mov_b32 m0, 150016
  s_nop 0
  buffer_load_dwordx4 v68, s[16:19], s56 offen lds
  v_xor_b32 v69, 32, v249
  s_mov_b32 m0, 151040
  s_nop 0
  buffer_load_dwordx4 v69, s[16:19], s56 offen lds
  v_xor_b32 v70, 32, v250
  s_mov_b32 m0, 152064
  s_nop 0
  buffer_load_dwordx4 v70, s[16:19], s56 offen lds
  v_xor_b32 v71, 32, v251
  s_mov_b32 m0, 152576
  s_nop 0
  buffer_load_dwordx4 v71, s[16:19], s56 offen lds
  s_waitcnt vmcnt(0)
  v_mov_b32 v6, 0
  s_mov_b32 s59, 0
  s_mov_b64 exec, 1
H_pollV:
  buffer_load_dword v7, v6, s[36:39], 0 offen offset:132 sc1
  s_waitcnt vmcnt(0)
  v_cmp_eq_u32 vcc, 0, v7
  s_add_u32 s59, s59, 1
  s_cmp_gt_u32 s59, 200000
  s_cbranch_scc1 H_pollV_x
  s_cmp_lg_u64 vcc, 0
  s_cbranch_scc0 H_pollV_x
  s_sleep 2
  s_branch H_pollV
H_pollV_x:
  s_mov_b64 exec, -1
  s_lshr_b32 s55, s2, 3
  s_mul_i32 s55, s55, 2304
  buffer_load_dwordx4 v[80:83], v252, s[24:27], s55 offen offset:0 sc1
  buffer_load_dwordx4 v[84:87], v252, s[24:27], s55 offen offset:1024 sc1
  buffer_load_dwordx4 v[88:91], v252, s[24:27], s55 offen offset:2048 sc1
  s_barrier
  s_mov_b32 m0, 153600
  s_mov_b32 s59, 0
  buffer_load_dwordx4 v252, s[24:27], s59 offen offset:0 sc1 lds
  buffer_load_dwordx4 v252, s[24:27], s59 offen offset:1024 sc1 lds
  buffer_load_dwordx4 v252, s[24:27], s59 offen offset:2048 sc1 lds
  buffer_load_dwordx4 v252, s[24:27], s59 offen offset:3072 sc1 lds
  s_mov_b32 m0, 157696
  s_mov_b32 s59, 4096
  buffer_load_dwordx4 v252, s[24:27], s59 offen offset:0 sc1 lds
  buffer_load_dwordx4 v252, s[24:27], s59 offen offset:1024 sc1 lds
  buffer_load_dwordx4 v252, s[24:27], s59 offen offset:2048 sc1 lds
  buffer_load_dwordx4 v252, s[24:27], s59 offen offset:3072 sc1 lds
  s_mov_b32 m0, 161792
  s_mov_b32 s59, 8192
  buffer_load_dwordx4 v252, s[24:27], s59 offen offset:0 sc1 lds
  buffer_load_dwordx4 v252, s[24:27], s59 offen offset:1024 sc1 lds
  s_waitcnt vmcnt(0)
  s_barrier
  s_mov_b32 m0, 0
  s_mov_b32 s59, 24576
  buffer_load_dwordx4 v252, s[24:27], s59 offen offset:0 sc1 lds
  buffer_load_dwordx4 v252, s[24:27], s59 offen offset:1024 sc1 lds
  buffer_load_dwordx4 v252, s[24:27], s59 offen offset:2048 sc1 lds
  buffer_load_dwordx4 v252, s[24:27], s59 offen offset:3072 sc1 lds
  s_mov_b32 m0, 4096
  s_mov_b32 s59, 28672
  buffer_load_dwordx4 v252, s[24:27], s59 offen offset:0 sc1 lds
  buffer_load_dwordx4 v252, s[24:27], s59 offen offset:1024 sc1 lds
  buffer_load_dwordx4 v252, s[24:27], s59 offen offset:2048 sc1 lds
  buffer_load_dwordx4 v252, s[24:27], s59 offen offset:3072 sc1 lds
  s_mov_b32 m0, 8192
  s_mov_b32 s59, 32768
  buffer_load_dwordx4 v252, s[24:27], s59 offen offset:0 sc1 lds
  buffer_load_dwordx4 v252, s[24:27], s59 offen offset:1024 sc1 lds
  buffer_load_dwordx4 v252, s[24:27], s59 offen offset:2048 sc1 lds
  buffer_load_dwordx4 v252, s[24:27], s59 offen offset:3072 sc1 lds
  s_waitcnt vmcnt(0)
  s_barrier
M_done:
  s_endpgm
CODE_END:
.section .rodata,"a"
.p2align 6
.amdhsa_kernel standalone__neighborhood_nat__vision_kernel
  .amdhsa_next_free_vgpr 256
  .amdhsa_next_free_sgpr 102
  .amdhsa_accum_offset 256
  .amdhsa_group_segment_fixed_size 0
  .amdhsa_kernarg_size 48
  .amdhsa_user_sgpr_count 2
  .amdhsa_user_sgpr_kernarg_segment_ptr 1
  .amdhsa_system_sgpr_workgroup_id_x 1
.end_amdhsa_kernel
```

```asm
; @launch grid=(256,1,1) block=(512,1,1) lds=163840
.amdgcn_target "amdgcn-amd-amdhsa--gfx950"
.text
.globl standalone__neighborhood_nat__vision_kernel
.p2align 8
.type standalone__neighborhood_nat__vision_kernel,@function
standalone__neighborhood_nat__vision_kernel:
  s_cmp_ge_u32 s2, 256
  s_cbranch_scc1 M_done
  s_load_dwordx8 s[4:11], s[0:1], 0
  s_load_dwordx4 s[12:15], s[0:1], 32
  v_lshrrev_b32 v4, 6, v0
  v_and_b32 v1, 63, v0
  v_readfirstlane_b32 s40, v4
  v_lshrrev_b32 v2, 4, v1
  v_and_b32 v3, 15, v1
  v_lshlrev_b32 v252, 4, v1
  s_getpc_b64 s[16:17]
  s_and_b32 s16, s16, -256
  s_and_b32 s17, s17, 0xffff
  s_mov_b32 s18, CODE_END-standalone__neighborhood_nat__vision_kernel
  s_mov_b32 s19, 0x00020000
  s_lshr_b32 s55, s2, 3
  s_lshl_b32 s55, s55, 10
  s_cmp_lg_u32 s40, 3
  s_cbranch_scc1 M_nocpf
  buffer_load_dwordx4 v[136:139], v252, s[16:19], s55 offen
M_nocpf:
  s_cmp_lg_u32 s40, 0
  s_cbranch_scc1 M_comp
  v_bfe_u32 v5, v1, 2, 2
  v_lshrrev_b32 v6, 5, v1
  v_lshlrev_b32 v7, 1, v6
  v_and_b32 v8, 3, v1
  v_xor_b32 v7, v7, v8
  v_lshlrev_b32 v7, 4, v7
  s_movk_i32 s60, 1152
  v_lshl_add_u32 v4, v2, 3, v5
  v_mad_u32_u24 v200, v4, s60, v7
  v_lshrrev_b32 v4, 2, v1
  v_mad_u32_u24 v203, v4, s60, v7
  v_lshrrev_b32 v4, 3, v3
  v_lshlrev_b32 v4, 1, v4
  v_xor_b32 v4, v4, v2
  v_lshl_add_u32 v4, v3, 2, v4
  v_lshlrev_b32 v195, 4, v4
  v_add_u32 v195, 90112, v195
  s_waitcnt lgkmcnt(0)
  s_mov_b32 s28, s6
  s_and_b32 s29, s7, 0xffff
  s_mov_b32 s30, 221184
  s_mov_b32 s31, 0x00020000
  s_cmp_ge_u32 s2, 36
  s_cbranch_scc1 H_nom
  s_mul_hi_u32 s55, s2, 0x2aaaaaab
  s_mul_i32 s56, s55, 6
  s_sub_u32 s56, s2, s56
  s_mul_i32 s55, s55, 36864
  s_mul_i32 s56, s56, 36864
  s_mov_b32 m0, 90112
  s_nop 0
  buffer_load_dwordx4 v200, s[28:31], s56 offen offset:0 lds
  s_mov_b32 m0, 102016
  s_nop 0
  buffer_load_dwordx4 v200, s[28:31], s55 offen offset:384 lds
  s_mov_b32 m0, 91072
  s_nop 0
  buffer_load_dwordx4 v200, s[28:31], s56 offen offset:64 lds
  s_mov_b32 m0, 102976
  s_nop 0
  buffer_load_dwordx4 v200, s[28:31], s55 offen offset:448 lds
  s_mov_b32 m0, 92032
  s_nop 0
  buffer_load_dwordx4 v200, s[28:31], s56 offen offset:128 lds
  s_mov_b32 m0, 103936
  s_nop 0
  buffer_load_dwordx4 v200, s[28:31], s55 offen offset:512 lds
  s_mov_b32 m0, 92992
  s_nop 0
  buffer_load_dwordx4 v200, s[28:31], s56 offen offset:192 lds
  s_mov_b32 m0, 104896
  s_nop 0
  buffer_load_dwordx4 v200, s[28:31], s55 offen offset:576 lds
  s_mov_b32 m0, 93952
  s_nop 0
  buffer_load_dwordx4 v200, s[28:31], s56 offen offset:256 lds
  s_mov_b32 m0, 105856
  s_nop 0
  buffer_load_dwordx4 v200, s[28:31], s55 offen offset:640 lds
  s_mov_b32 m0, 94912
  s_nop 0
  buffer_load_dwordx4 v200, s[28:31], s56 offen offset:320 lds
  s_mov_b32 m0, 106816
  s_nop 0
  buffer_load_dwordx4 v200, s[28:31], s55 offen offset:704 lds
  s_add_u32 s55, s55, 4608
  s_add_u32 s56, s56, 4608
  s_mov_b32 m0, 96256
  s_nop 0
  buffer_load_dwordx4 v200, s[28:31], s56 offen offset:0 lds
  s_mov_b32 m0, 108160
  s_nop 0
  buffer_load_dwordx4 v200, s[28:31], s55 offen offset:384 lds
  s_mov_b32 m0, 97216
  s_nop 0
  buffer_load_dwordx4 v200, s[28:31], s56 offen offset:64 lds
  s_mov_b32 m0, 109120
  s_nop 0
  buffer_load_dwordx4 v200, s[28:31], s55 offen offset:448 lds
  s_mov_b32 m0, 98176
  s_nop 0
  buffer_load_dwordx4 v200, s[28:31], s56 offen offset:128 lds
  s_mov_b32 m0, 110080
  s_nop 0
  buffer_load_dwordx4 v200, s[28:31], s55 offen offset:512 lds
  s_mov_b32 m0, 99136
  s_nop 0
  buffer_load_dwordx4 v200, s[28:31], s56 offen offset:192 lds
  s_mov_b32 m0, 111040
  s_nop 0
  buffer_load_dwordx4 v200, s[28:31], s55 offen offset:576 lds
  s_mov_b32 m0, 100096
  s_nop 0
  buffer_load_dwordx4 v200, s[28:31], s56 offen offset:256 lds
  s_mov_b32 m0, 112000
  s_nop 0
  buffer_load_dwordx4 v200, s[28:31], s55 offen offset:640 lds
  s_mov_b32 m0, 101056
  s_nop 0
  buffer_load_dwordx4 v200, s[28:31], s56 offen offset:320 lds
  s_mov_b32 m0, 112960
  s_nop 0
  buffer_load_dwordx4 v200, s[28:31], s55 offen offset:704 lds
  s_mov_b32 s16, s4
  s_and_b32 s17, s5, 0xffff
  s_mov_b32 s18, 19267584
  s_mov_b32 s19, 0x00020000
  s_mov_b32 s24, s14
  s_and_b32 s25, s15, 0xffff
  s_mov_b32 s26, 268435456
  s_mov_b32 s27, 0x00020000
  s_mov_b32 s20, s10
  s_and_b32 s21, s11, 0xffff
  s_mov_b32 s22, 19267584
  s_mov_b32 s23, 0x00020000
  s_mov_b32 s36, s12
  s_and_b32 s37, s13, 0xffff
  s_mov_b32 s38, 256
  s_mov_b32 s39, 0x00020000
  s_lshl_b32 s55, s2, 11
  s_add_u32 s55, s55, 131072
  s_barrier
  s_waitcnt vmcnt(0)
  ds_read_b128 v[64:67], v195 offset:0
  ds_read_b128 v[88:91], v195 offset:6144
  ds_read_b128 v[112:115], v195 offset:12288
  ds_read_b128 v[136:139], v195 offset:18432
  ds_read_b128 v[68:71], v195 offset:1024
  ds_read_b128 v[92:95], v195 offset:7168
  ds_read_b128 v[116:119], v195 offset:13312
  ds_read_b128 v[140:143], v195 offset:19456
  ds_read_b128 v[72:75], v195 offset:2048
  ds_read_b128 v[96:99], v195 offset:8192
  ds_read_b128 v[120:123], v195 offset:14336
  ds_read_b128 v[144:147], v195 offset:20480
  s_waitcnt lgkmcnt(9)
  v_mfma_f32_16x16x32_bf16 v[160:163], v[64:67], v[112:115], 0
  v_mfma_f32_16x16x32_bf16 v[164:167], v[88:91], v[112:115], 0
  s_waitcnt lgkmcnt(8)
  v_mfma_f32_16x16x32_bf16 v[168:171], v[64:67], v[136:139], 0
  v_mfma_f32_16x16x32_bf16 v[172:175], v[88:91], v[136:139], 0
  ds_read_b128 v[76:79], v195 offset:3072
  ds_read_b128 v[100:103], v195 offset:9216
  ds_read_b128 v[124:127], v195 offset:15360
  ds_read_b128 v[148:151], v195 offset:21504
  s_waitcnt lgkmcnt(9)
  v_mfma_f32_16x16x32_bf16 v[160:163], v[68:71], v[116:119], v[160:163]
  v_mfma_f32_16x16x32_bf16 v[164:167], v[92:95], v[116:119], v[164:167]
  s_waitcnt lgkmcnt(8)
  v_mfma_f32_16x16x32_bf16 v[168:171], v[68:71], v[140:143], v[168:171]
  v_mfma_f32_16x16x32_bf16 v[172:175], v[92:95], v[140:143], v[172:175]
  ds_read_b128 v[80:83], v195 offset:4096
  ds_read_b128 v[104:107], v195 offset:10240
  ds_read_b128 v[128:131], v195 offset:16384
  ds_read_b128 v[152:155], v195 offset:22528
  s_waitcnt lgkmcnt(9)
  v_mfma_f32_16x16x32_bf16 v[160:163], v[72:75], v[120:123], v[160:163]
  v_mfma_f32_16x16x32_bf16 v[164:167], v[96:99], v[120:123], v[164:167]
  s_waitcnt lgkmcnt(8)
  v_mfma_f32_16x16x32_bf16 v[168:171], v[72:75], v[144:147], v[168:171]
  v_mfma_f32_16x16x32_bf16 v[172:175], v[96:99], v[144:147], v[172:175]
  ds_read_b128 v[84:87], v195 offset:5120
  ds_read_b128 v[108:111], v195 offset:11264
  ds_read_b128 v[132:135], v195 offset:17408
  ds_read_b128 v[156:159], v195 offset:23552
  s_waitcnt lgkmcnt(9)
  v_mfma_f32_16x16x32_bf16 v[160:163], v[76:79], v[124:127], v[160:163]
  v_mfma_f32_16x16x32_bf16 v[164:167], v[100:103], v[124:127], v[164:167]
  s_waitcnt lgkmcnt(8)
  v_mfma_f32_16x16x32_bf16 v[168:171], v[76:79], v[148:151], v[168:171]
  v_mfma_f32_16x16x32_bf16 v[172:175], v[100:103], v[148:151], v[172:175]
  s_waitcnt lgkmcnt(5)
  v_mfma_f32_16x16x32_bf16 v[160:163], v[80:83], v[128:131], v[160:163]
  v_mfma_f32_16x16x32_bf16 v[164:167], v[104:107], v[128:131], v[164:167]
  s_waitcnt lgkmcnt(4)
  v_mfma_f32_16x16x32_bf16 v[168:171], v[80:83], v[152:155], v[168:171]
  v_mfma_f32_16x16x32_bf16 v[172:175], v[104:107], v[152:155], v[172:175]
  s_waitcnt lgkmcnt(1)
  v_mfma_f32_16x16x32_bf16 v[160:163], v[84:87], v[132:135], v[160:163]
  v_mfma_f32_16x16x32_bf16 v[164:167], v[108:111], v[132:135], v[164:167]
  s_waitcnt lgkmcnt(0)
  v_mfma_f32_16x16x32_bf16 v[168:171], v[84:87], v[156:159], v[168:171]
  v_mfma_f32_16x16x32_bf16 v[172:175], v[108:111], v[156:159], v[172:175]
  s_nop 3
  v_cvt_pk_bf16_f32 v176, v160, v161
  v_cvt_pk_bf16_f32 v177, v162, v163
  v_cvt_pk_bf16_f32 v178, v164, v165
  v_cvt_pk_bf16_f32 v179, v166, v167
  buffer_store_dwordx4 v[176:179], v252, s[24:27], s55 offen offset:0 sc1
  v_cvt_pk_bf16_f32 v180, v168, v169
  v_cvt_pk_bf16_f32 v181, v170, v171
  v_cvt_pk_bf16_f32 v182, v172, v173
  v_cvt_pk_bf16_f32 v183, v174, v175
  buffer_store_dwordx4 v[180:183], v252, s[24:27], s55 offen offset:1024 sc1
  v_mov_b32 v192, 1
  v_mov_b32 v193, 0
  s_mov_b64 exec, 1
  s_waitcnt vmcnt(0)
  buffer_atomic_add v192, v193, s[36:39], 0 offen offset:0 sc0 sc1
  s_mov_b64 exec, -1
  s_barrier
  s_waitcnt vmcnt(0)
  v_readfirstlane_b32 s56, v192
  s_nop 0
  s_cmp_lg_u32 s56, 35
  s_cbranch_scc1 H_p1
  s_mov_b64 exec, 1
  buffer_store_dword v192, v193, s[36:39], 0 offen offset:128 sc1
  s_mov_b64 exec, -1
H_p1:
  s_barrier
  s_branch H_join
H_nom:
  s_mov_b32 s32, s8
  s_and_b32 s33, s9, 0xffff
  s_mov_b32 s34, 73728
  s_mov_b32 s35, 0x00020000
  s_cmp_ge_u32 s2, 180
  s_cbranch_scc1 H_nov1
  s_sub_u32 s58, s2, 36
  s_mul_hi_u32 s55, s58, 0x15555556
  s_mul_i32 s56, s55, 12
  s_sub_u32 s56, s58, s56
  s_mul_i32 s57, s55, 18432
  s_mov_b32 m0, 91392
  s_nop 0
  buffer_load_dwordx4 v203, s[28:31], s57 offen offset:768 lds
  s_mov_b32 m0, 92352
  s_nop 0
  buffer_load_dwordx4 v203, s[28:31], s57 offen offset:832 lds
  s_mov_b32 m0, 93312
  s_nop 0
  buffer_load_dwordx4 v203, s[28:31], s57 offen offset:896 lds
  s_mov_b32 m0, 94272
  s_nop 0
  buffer_load_dwordx4 v203, s[28:31], s57 offen offset:960 lds
  s_mov_b32 m0, 95232
  s_nop 0
  buffer_load_dwordx4 v203, s[28:31], s57 offen offset:1024 lds
  s_mov_b32 m0, 96192
  s_nop 0
  buffer_load_dwordx4 v203, s[28:31], s57 offen offset:1088 lds
  v_lshrrev_b32 v112, 1, v1
  v_mul_u32_u24 v112, 384, v112
  v_and_b32 v113, 1, v1
  v_lshl_add_u32 v112, v113, 4, v112
  s_lshl_b32 s57, s56, 5
  s_mov_b32 m0, 98304
  s_nop 0
  buffer_load_dwordx4 v112, s[32:35], s57 offen lds
  s_add_u32 s57, s57, 12288
  s_mov_b32 m0, 99328
  s_nop 0
  buffer_load_dwordx4 v112, s[32:35], s57 offen lds
  s_add_u32 s57, s57, 12288
  s_mov_b32 m0, 100352
  s_nop 0
  buffer_load_dwordx4 v112, s[32:35], s57 offen lds
  s_add_u32 s57, s57, 12288
  s_mov_b32 m0, 101376
  s_nop 0
  buffer_load_dwordx4 v112, s[32:35], s57 offen lds
  s_add_u32 s57, s57, 12288
  s_mov_b32 m0, 102400
  s_nop 0
  buffer_load_dwordx4 v112, s[32:35], s57 offen lds
  s_add_u32 s57, s57, 12288
  s_mov_b32 m0, 103424
  s_nop 0
  buffer_load_dwordx4 v112, s[32:35], s57 offen lds
  s_add_u32 s57, s57, 12288
  s_lshr_b32 s57, s56, 2
  s_mul_i32 s95, s57, 24576
  s_and_b32 s56, s56, 3
  s_lshl_b32 s56, s56, 6
  s_add_u32 s95, s95, s56
  s_lshr_b32 s56, s55, 1
  s_lshl_b32 s56, s56, 11
  s_add_u32 s95, s95, s56
  s_and_b32 s55, s55, 1
  s_lshl_b32 s55, s55, 3
  s_add_u32 s95, s95, s55
H_nov1:
  s_barrier
  s_mov_b32 s16, s4
  s_and_b32 s17, s5, 0xffff
  s_mov_b32 s18, 19267584
  s_mov_b32 s19, 0x00020000
  s_mov_b32 s24, s14
  s_and_b32 s25, s15, 0xffff
  s_mov_b32 s26, 268435456
  s_mov_b32 s27, 0x00020000
  s_mov_b32 s20, s10
  s_and_b32 s21, s11, 0xffff
  s_mov_b32 s22, 19267584
  s_mov_b32 s23, 0x00020000
  s_mov_b32 s36, s12
  s_and_b32 s37, s13, 0xffff
  s_mov_b32 s38, 256
  s_mov_b32 s39, 0x00020000
  s_cmp_ge_u32 s2, 180
  s_cbranch_scc1 H_join
  v_lshlrev_b32 v119, 3, v3
  v_lshl_add_u32 v119, v2, 8, v119
  v_add_u32 v119, 90112, v119
  s_waitcnt vmcnt(0)
  ds_read_b128 v[64:67], v195 offset:2048
  ds_read_b128 v[68:71], v195 offset:3072
  ds_read_b128 v[72:75], v195 offset:4096
  ds_read_b128 v[76:79], v195 offset:5120
  ds_read_b128 v[80:83], v195 offset:6144
  ds_read_b128 v[84:87], v195 offset:7168
  s_waitcnt lgkmcnt(2)
  ds_read_b64_tr_b16 v[88:89], v119 offset:8192
  ds_read_b64_tr_b16 v[90:91], v119 offset:8320
  ds_read_b64_tr_b16 v[92:93], v119 offset:9216
  ds_read_b64_tr_b16 v[94:95], v119 offset:9344
  ds_read_b64_tr_b16 v[96:97], v119 offset:10240
  ds_read_b64_tr_b16 v[98:99], v119 offset:10368
  ds_read_b64_tr_b16 v[100:101], v119 offset:11264
  ds_read_b64_tr_b16 v[102:103], v119 offset:11392
  ds_read_b64_tr_b16 v[104:105], v119 offset:12288
  ds_read_b64_tr_b16 v[106:107], v119 offset:12416
  ds_read_b64_tr_b16 v[108:109], v119 offset:13312
  ds_read_b64_tr_b16 v[110:111], v119 offset:13440
  s_waitcnt lgkmcnt(0)
  v_mfma_f32_16x16x32_bf16 v[112:115], v[64:67], v[88:91], 0
  v_mfma_f32_16x16x32_bf16 v[112:115], v[68:71], v[92:95], v[112:115]
  v_mfma_f32_16x16x32_bf16 v[112:115], v[72:75], v[96:99], v[112:115]
  v_mfma_f32_16x16x32_bf16 v[112:115], v[76:79], v[100:103], v[112:115]
  v_mfma_f32_16x16x32_bf16 v[112:115], v[80:83], v[104:107], v[112:115]
  v_mfma_f32_16x16x32_bf16 v[112:115], v[84:87], v[108:111], v[112:115]
  v_bfe_u32 v118, v3, 1, 1
  v_mul_u32_u24 v118, 12288, v118
  v_and_b32 v119, 1, v3
  v_lshl_add_u32 v118, v119, 10, v118
  v_lshrrev_b32 v119, 2, v3
  v_lshl_add_u32 v118, v119, 4, v118
  v_lshl_add_u32 v118, v2, 8, v118
  s_nop 0
  v_cvt_pk_bf16_f32 v116, v112, v113
  v_cvt_pk_bf16_f32 v117, v114, v115
  buffer_store_dwordx2 v[116:117], v118, s[24:27], s95 offen sc1
  s_branch H_join
M_comp:
  s_and_b32 s55, s2, 7
  s_lshr_b32 s56, s2, 3
  s_lshr_b32 s41, s55, 2
  s_bfe_u32 s42, s55, 0x10001
  s_and_b32 s55, s55, 1
  s_lshl_b32 s55, s55, 2
  s_lshr_b32 s43, s56, 3
  s_add_u32 s43, s43, s55
  s_and_b32 s44, s56, 7
  s_mul_i32 s43, s43, 14
  s_mul_i32 s44, s44, 14
  s_mul_i32 s61, s41, 13
  s_add_i32 s61, s61, -6
  s_mul_i32 s62, s42, 13
  s_add_i32 s62, s62, -6
  s_cmp_ge_u32 s40, 4
  s_cselect_b32 s53, -4, 3
  s_add_i32 s53, s53, s40
  s_lshl_b32 s53, s53, 1
  s_add_u32 s88, s43, s53
  s_mov_b32 s89, 86016
  s_movk_i32 s90, 384
  v_lshrrev_b32 v4, 3, v1
  v_and_b32 v5, 7, v1
  v_and_b32 v6, 6, v4
  v_xor_b32 v5, v5, v6
  v_add_u32 v6, 1, v4
  v_lshrrev_b32 v6, 3, v6
  v_lshlrev_b32 v6, 26, v6
  v_or_b32 v5, v5, v6
  v_add_u32 v4, s44, v4
  v_lshl_add_u32 v6, v4, 1, s62
  v_add_u32 v7, 112, v4
  v_med3_i32 v6, v6, v4, v7
  v_mul_u32_u24 v6, 384, v6
  v_lshl_add_u32 v168, v5, 4, v6
  v_add_u32 v4, 7, v4
  v_lshl_add_u32 v6, v4, 1, s62
  v_add_u32 v7, 112, v4
  v_med3_i32 v6, v6, v4, v7
  v_mul_u32_u24 v6, 384, v6
  v_lshl_add_u32 v169, v5, 4, v6
  s_add_u32 s55, s88, 0
  s_lshl_b32 s56, s55, 1
  s_add_i32 s56, s56, s61
  s_max_i32 s56, s56, s55
  s_add_i32 s55, s55, 112
  s_min_i32 s56, s56, s55
  s_mul_i32 s84, s56, 86016
  s_add_u32 s55, s88, 1
  s_lshl_b32 s56, s55, 1
  s_add_i32 s56, s56, s61
  s_max_i32 s56, s56, s55
  s_add_i32 s55, s55, 112
  s_min_i32 s56, s56, s55
  s_mul_i32 s85, s56, 86016
  s_lshl_b32 s86, s53, 12
  s_lshl_b32 s87, s53, 11
  s_waitcnt lgkmcnt(0)
  s_mov_b32 s16, s4
  s_and_b32 s17, s5, 0xffff
  s_mov_b32 s18, 19267584
  s_mov_b32 s19, 0x00020000
  s_barrier
  s_add_u32 m0, s86, 512
  s_nop 0
  buffer_load_dwordx4 v168, s[16:19], s84 offen offset:0 lds
  s_add_u32 m0, s86, 1536
  s_nop 0
  buffer_load_dwordx4 v168, s[16:19], s85 offen offset:0 lds
  s_add_u32 m0, s86, 2560
  s_nop 0
  buffer_load_dwordx4 v169, s[16:19], s84 offen offset:0 lds
  s_add_u32 m0, s86, 3584
  s_nop 0
  buffer_load_dwordx4 v169, s[16:19], s85 offen offset:0 lds
  s_cmp_lt_u32 s2, 36
  s_cbranch_scc1 M_x1
  s_add_u32 m0, s86, 4480
  s_nop 0
  buffer_load_dwordx4 v168, s[16:19], s84 offen offset:128 lds
  s_add_u32 m0, s86, 5504
  s_nop 0
  buffer_load_dwordx4 v168, s[16:19], s85 offen offset:128 lds
  s_add_u32 m0, s86, 6528
  s_nop 0
  buffer_load_dwordx4 v169, s[16:19], s84 offen offset:128 lds
  s_add_u32 m0, s86, 7552
  s_nop 0
  buffer_load_dwordx4 v169, s[16:19], s85 offen offset:128 lds
  s_add_u32 m0, s87, 61184
  s_nop 0
  buffer_load_dwordx4 v168, s[16:19], s84 offen offset:256 lds
  s_add_u32 m0, s87, 62208
  s_nop 0
  buffer_load_dwordx4 v168, s[16:19], s85 offen offset:256 lds
  s_add_u32 m0, s87, 63232
  s_nop 0
  buffer_load_dwordx4 v169, s[16:19], s84 offen offset:256 lds
  s_add_u32 m0, s87, 64256
  s_nop 0
  buffer_load_dwordx4 v169, s[16:19], s85 offen offset:256 lds
M_x1:
  s_mov_b32 s24, s14
  s_and_b32 s25, s15, 0xffff
  s_mov_b32 s26, 268435456
  s_mov_b32 s27, 0x00020000
  s_mov_b32 s20, s10
  s_and_b32 s21, s11, 0xffff
  s_mov_b32 s22, 19267584
  s_mov_b32 s23, 0x00020000
  s_mov_b32 s36, s12
  s_and_b32 s37, s13, 0xffff
  s_mov_b32 s38, 256
  s_mov_b32 s39, 0x00020000
  s_mul_i32 s55, s41, 6
  s_add_i32 s45, s43, s55
  s_add_i32 s45, s45, -6
  s_cmp_eq_i32 s45, -6
  s_cselect_b32 s47, 6, 0
  s_cmp_eq_i32 s45, 98
  s_cselect_b32 s48, 7, 13
  s_cselect_b32 s49, 2, 0
  s_sub_i32 s45, s45, s49
  s_mul_i32 s55, s42, 6
  s_add_i32 s56, s44, s55
  s_add_i32 s56, s56, -6
  s_cmp_eq_i32 s56, -6
  s_cselect_b32 s50, 6, 0
  s_cmp_eq_i32 s56, 98
  s_cselect_b32 s51, 7, 13
  s_lshl_b32 s56, s56, 1
  s_add_i32 s56, s56, s42
  s_mul_i32 s46, s56, 384
  s_max_i32 s92, s53, s47
  s_min_i32 s92, s92, s48
  s_and_b32 s92, s92, -2
  s_add_u32 s52, s92, s49
  s_mov_b32 s54, 4286578688
  s_mov_b32 s63, 1037384597
  s_and_b32 s93, s40, 1
  s_lshl_b32 s93, s93, 3
  s_and_b32 s56, s40, 6
  s_or_b32 s93, s93, s56
  s_add_u32 s56, s40, 8
  s_add_i32 s100, s45, s56
  s_lshl_b32 s100, s100, 1
  s_add_i32 s100, s100, s41
  s_max_i32 s100, s100, 0
  s_min_i32 s100, s100, 223
  s_mul_i32 s100, s100, 86016
  s_mul_i32 s101, s56, 7680
  v_lshrrev_b32 v4, 3, v3
  v_add_u32 v4, s53, v4
  v_max_i32 v4, s47, v4
  v_min_i32 v4, s48, v4
  v_subrev_u32 v4, s92, v4
  v_and_b32 v5, 1, v2
  v_sub_u32 v6, v5, v4
  v_ashrrev_i32 v12, 31, v6
  v_and_b32 v12, s54, v12
  v_sub_u32 v6, v4, v5
  v_ashrrev_i32 v13, 31, v6
  v_and_b32 v13, s54, v13
  v_and_b32 v4, 7, v3
  v_lshrrev_b32 v5, 1, v2
  v_subrev_u32 v7, 7, v4
  v_ashrrev_i32 v7, 31, v7
  v_and_b32 v7, 0x7f, v7
  v_add_u32 v6, 0, v4
  v_max_i32 v6, s50, v6
  v_min_i32 v6, s51, v6
  v_lshlrev_b32 v6, v6, v7
  v_lshrrev_b32 v6, v5, v6
  v_not_b32 v14, v6
  v_add_u32 v6, 7, v4
  v_max_i32 v6, s50, v6
  v_min_i32 v6, s51, v6
  v_lshlrev_b32 v6, v6, v7
  v_lshrrev_b32 v6, v5, v6
  v_not_b32 v15, v6
  v_add_u32 v4, s52, v4
  v_and_b32 v5, 1, v4
  v_lshlrev_b32 v5, 3, v5
  v_and_or_b32 v5, v4, 6, v5
  v_mul_u32_u24 v4, 7680, v4
  v_lshrrev_b32 v6, 3, v3
  v_mul_u32_u24 v6, 24, v6
  v_add_u32 v6, v6, v2
  v_add_u32 v7, 0, v6
  v_xor_b32 v7, v7, v5
  v_lshl_add_u32 v240, v7, 4, v4
  v_add_u32 v7, 4, v6
  v_xor_b32 v7, v7, v5
  v_lshl_add_u32 v241, v7, 4, v4
  v_add_u32 v7, 8, v6
  v_xor_b32 v7, v7, v5
  v_lshl_add_u32 v242, v7, 4, v4
  v_add_u32 v7, 12, v6
  v_xor_b32 v7, v7, v5
  v_lshl_add_u32 v243, v7, 4, v4
  v_and_b32 v4, 1, v2
  v_lshlrev_b32 v4, 2, v4
  v_lshrrev_b32 v5, 2, v3
  v_add3_u32 v4, v4, v5, s52
  v_and_b32 v5, 1, v4
  v_lshlrev_b32 v5, 3, v5
  v_and_or_b32 v5, v4, 6, v5
  v_mul_u32_u24 v4, 7680, v4
  v_and_b32 v6, 1, v3
  v_lshl_add_u32 v4, v6, 3, v4
  v_lshrrev_b32 v6, 1, v2
  v_mul_u32_u24 v6, 24, v6
  v_bfe_u32 v7, v3, 1, 1
  v_add_u32 v6, v6, v7
  v_add_u32 v7, 0, v6
  v_xor_b32 v7, v7, v5
  v_lshl_add_u32 v244, v7, 4, v4
  v_add_u32 v7, 2, v6
  v_xor_b32 v7, v7, v5
  v_lshl_add_u32 v245, v7, 4, v4
  v_add_u32 v7, 4, v6
  v_xor_b32 v7, v7, v5
  v_lshl_add_u32 v246, v7, 4, v4
  v_add_u32 v7, 6, v6
  v_xor_b32 v7, v7, v5
  v_lshl_add_u32 v247, v7, 4, v4
  v_add_u32 v7, 8, v6
  v_xor_b32 v7, v7, v5
  v_lshl_add_u32 v248, v7, 4, v4
  v_add_u32 v7, 10, v6
  v_xor_b32 v7, v7, v5
  v_lshl_add_u32 v249, v7, 4, v4
  v_add_u32 v7, 12, v6
  v_xor_b32 v7, v7, v5
  v_lshl_add_u32 v250, v7, 4, v4
  v_add_u32 v7, 14, v6
  v_xor_b32 v7, v7, v5
  v_lshl_add_u32 v251, v7, 4, v4
  v_add_u32 v253, 153600, v252
  v_add_u32 v254, 90112, v252
  v_add_u32 v4, 0, v1
  v_xor_b32 v4, s93, v4
  v_mul_u32_u24 v5, 2731, v4
  v_lshrrev_b32 v5, 16, v5
  v_mul_u32_u24 v5, 384, v5
  v_lshl_add_u32 v4, v4, 4, v5
  v_add_u32 v232, s46, v4
  v_add_u32 v235, 6144, v232
  v_add_u32 v238, 12288, v232
  v_max_i32 v232, 0, v232
  v_add_u32 v4, 64, v1
  v_xor_b32 v4, s93, v4
  v_mul_u32_u24 v5, 2731, v4
  v_lshrrev_b32 v5, 16, v5
  v_mul_u32_u24 v5, 384, v5
  v_lshl_add_u32 v4, v4, 4, v5
  v_add_u32 v233, s46, v4
  v_add_u32 v236, 6144, v233
  v_max_i32 v233, 0, v233
  v_add_u32 v4, 128, v1
  v_xor_b32 v4, s93, v4
  v_mul_u32_u24 v5, 2731, v4
  v_lshrrev_b32 v5, 16, v5
  v_mul_u32_u24 v5, 384, v5
  v_lshl_add_u32 v4, v4, 4, v5
  v_add_u32 v234, s46, v4
  v_add_u32 v237, 6144, v234
  v_max_i32 v234, 0, v234
  v_add_u32 v4, 416, v1
  v_xor_b32 v4, s93, v4
  v_mul_u32_u24 v5, 2731, v4
  v_lshrrev_b32 v5, 16, v5
  v_mul_u32_u24 v5, 384, v5
  v_lshl_add_u32 v4, v4, 4, v5
  v_add_u32 v239, s46, v4
  v_lshrrev_b32 v197, 1, v2
  v_and_b32 v255, 1, v2
  v_add_u32 v197, s88, v197
  v_lshl_add_u32 v0, v255, 2, s44
  v_lshl_add_u32 v198, v197, 1, s61
  v_add_u32 v199, 112, v197
  v_lshlrev_b32 v255, 30, v255
  v_med3_i32 v197, v198, v197, v199
  v_mul_lo_u32 v197, v197, s89
  v_lshl_add_u32 v197, v3, 3, v197
  v_add_u32 v4, 0, v0
  v_lshl_add_u32 v198, v4, 1, s62
  v_add_u32 v199, 112, v4
  v_med3_i32 v4, v198, v4, v199
  v_mad_u32_u24 v4, v4, s90, v197
  v_add_u32 v5, 1, v0
  v_lshl_add_u32 v198, v5, 1, s62
  v_add_u32 v199, 112, v5
  v_med3_i32 v5, v198, v5, v199
  v_mad_u32_u24 v5, v5, s90, v197
  v_add_u32 v6, 2, v0
  v_lshl_add_u32 v198, v6, 1, s62
  v_add_u32 v199, 112, v6
  v_med3_i32 v6, v198, v6, v199
  v_mad_u32_u24 v6, v6, s90, v197
  v_add_u32 v7, 3, v0
  v_lshl_add_u32 v198, v7, 1, s62
  v_add_u32 v199, 112, v7
  v_med3_i32 v7, v198, v7, v199
  v_mad_u32_u24 v7, v7, s90, v197
  v_add_u32 v7, v7, v255
  v_add_u32 v8, 7, v0
  v_lshl_add_u32 v198, v8, 1, s62
  v_add_u32 v199, 112, v8
  v_med3_i32 v8, v198, v8, v199
  v_mad_u32_u24 v8, v8, s90, v197
  v_add_u32 v9, 8, v0
  v_lshl_add_u32 v198, v9, 1, s62
  v_add_u32 v199, 112, v9
  v_med3_i32 v9, v198, v9, v199
  v_mad_u32_u24 v9, v9, s90, v197
  v_add_u32 v10, 9, v0
  v_lshl_add_u32 v198, v10, 1, s62
  v_add_u32 v199, 112, v10
  v_med3_i32 v10, v198, v10, v199
  v_mad_u32_u24 v10, v10, s90, v197
  v_add_u32 v11, 10, v0
  v_lshl_add_u32 v198, v11, 1, s62
  v_add_u32 v199, 112, v11
  v_med3_i32 v11, v198, v11, v199
  v_mad_u32_u24 v11, v11, s90, v197
  v_add_u32 v11, v11, v255
  v_bfe_i32 v66, v14, 0, 1
  v_bfe_i32 v94, v15, 6, 1
  v_and_b32 v65, s54, v66
  v_and_b32 v93, s54, v94
  v_and_b32 v66, s54, v66
  v_and_b32 v94, s54, v94
  v_or_b32 v64, v65, v12
  v_or_b32 v92, v93, v12
  v_or_b32 v67, v65, v13
  v_or_b32 v95, v93, v13
  v_bfe_i32 v70, v14, 2, 1
  v_bfe_i32 v98, v15, 8, 1
  v_and_b32 v69, s54, v70
  v_and_b32 v97, s54, v98
  v_and_b32 v70, s54, v70
  v_and_b32 v98, s54, v98
  v_or_b32 v68, v69, v12
  v_or_b32 v96, v97, v12
  v_or_b32 v71, v69, v13
  v_or_b32 v99, v97, v13
  v_bfe_i32 v74, v14, 4, 1
  v_bfe_i32 v102, v15, 10, 1
  v_and_b32 v73, s54, v74
  v_and_b32 v101, s54, v102
  v_and_b32 v74, s54, v74
  v_and_b32 v102, s54, v102
  v_or_b32 v72, v73, v12
  v_or_b32 v100, v101, v12
  v_or_b32 v75, v73, v13
  v_or_b32 v103, v101, v13
  v_bfe_i32 v78, v14, 6, 1
  v_bfe_i32 v106, v15, 12, 1
  v_and_b32 v77, s54, v78
  v_and_b32 v105, s54, v106
  v_and_b32 v78, s54, v78
  v_and_b32 v106, s54, v106
  v_or_b32 v76, v77, v12
  v_or_b32 v104, v105, v12
  v_or_b32 v79, v77, v13
  v_or_b32 v107, v105, v13
  v_bfe_i32 v82, v14, 8, 1
  v_bfe_i32 v110, v15, 14, 1
  v_and_b32 v81, s54, v82
  v_and_b32 v109, s54, v110
  v_and_b32 v82, s54, v82
  v_and_b32 v110, s54, v110
  v_or_b32 v80, v81, v12
  v_or_b32 v108, v109, v12
  v_or_b32 v83, v81, v13
  v_or_b32 v111, v109, v13
  v_bfe_i32 v86, v14, 10, 1
  v_bfe_i32 v114, v15, 16, 1
  v_and_b32 v85, s54, v86
  v_and_b32 v113, s54, v114
  v_and_b32 v86, s54, v86
  v_and_b32 v114, s54, v114
  v_or_b32 v84, v85, v12
  v_or_b32 v112, v113, v12
  v_or_b32 v87, v85, v13
  v_or_b32 v115, v113, v13
  v_bfe_i32 v90, v14, 12, 1
  v_bfe_i32 v118, v15, 18, 1
  v_and_b32 v89, s54, v90
  v_and_b32 v117, s54, v118
  v_and_b32 v90, s54, v90
  v_and_b32 v118, s54, v118
  v_or_b32 v88, v89, v12
  v_or_b32 v116, v117, v12
  v_or_b32 v91, v89, v13
  v_or_b32 v119, v117, v13
  v_and_b32 v170, 6, v3
  v_xor_b32 v170, v170, v2
  v_lshlrev_b32 v174, 7, v3
  v_xor_b32 v171, 4, v170
  v_lshl_add_u32 v170, v170, 4, v174
  v_lshl_add_u32 v171, v171, 4, v174
  v_add_u32 v172, s87, v170
  v_add_u32 v170, s86, v170
  v_add_u32 v173, s87, v171
  v_add_u32 v171, s86, v171
  s_cmp_ge_u32 s2, 36
  s_cbranch_scc1 M_x2
  s_barrier
  s_add_u32 m0, s86, 4480
  s_nop 0
  buffer_load_dwordx4 v168, s[16:19], s84 offen offset:128 lds
  s_add_u32 m0, s86, 5504
  s_nop 0
  buffer_load_dwordx4 v168, s[16:19], s85 offen offset:128 lds
  s_add_u32 m0, s86, 6528
  s_nop 0
  buffer_load_dwordx4 v169, s[16:19], s84 offen offset:128 lds
  s_add_u32 m0, s86, 7552
  s_nop 0
  buffer_load_dwordx4 v169, s[16:19], s85 offen offset:128 lds
  s_barrier
  s_add_u32 m0, s87, 61184
  s_nop 0
  buffer_load_dwordx4 v168, s[16:19], s84 offen offset:256 lds
  s_add_u32 m0, s87, 62208
  s_nop 0
  buffer_load_dwordx4 v168, s[16:19], s85 offen offset:256 lds
  s_add_u32 m0, s87, 63232
  s_nop 0
  buffer_load_dwordx4 v169, s[16:19], s84 offen offset:256 lds
  s_add_u32 m0, s87, 64256
  s_nop 0
  buffer_load_dwordx4 v169, s[16:19], s85 offen offset:256 lds
M_x2:
  s_waitcnt vmcnt(8)
  ds_read_b128 v[16:19], v170 offset:512
  ds_read_b128 v[20:23], v171 offset:512
  ds_read_b128 v[40:43], v170 offset:2560
  ds_read_b128 v[44:47], v171 offset:2560
  s_waitcnt vmcnt(4)
  ds_read_b128 v[24:27], v170 offset:4608
  ds_read_b128 v[28:31], v171 offset:4608
  ds_read_b128 v[48:51], v170 offset:6656
  ds_read_b128 v[52:55], v171 offset:6656
  s_waitcnt vmcnt(0)
  ds_read_b128 v[32:35], v172 offset:61440
  ds_read_b128 v[36:39], v173 offset:61440
  ds_read_b128 v[56:59], v172 offset:63488
  ds_read_b128 v[60:63], v173 offset:63488
  s_add_i32 s57, s45, s40
  s_lshl_b32 s57, s57, 1
  s_add_i32 s57, s57, s41
  s_max_i32 s57, s57, 0
  s_min_i32 s57, s57, 223
  s_mul_i32 s57, s57, 86016
  s_waitcnt lgkmcnt(0)
  s_barrier
  s_cmp_lt_u32 s40, 1
  s_cbranch_scc1 M_er
  s_add_u32 m0, s101, -61440
  s_nop 0
  buffer_load_dwordx4 v232, s[16:19], s57 offen lds
  s_add_u32 m0, s101, -60416
  s_nop 0
  buffer_load_dwordx4 v233, s[16:19], s57 offen lds
  s_add_u32 m0, s101, -59392
  s_nop 0
  buffer_load_dwordx4 v234, s[16:19], s57 offen lds
  s_add_u32 m0, s101, -58368
  s_nop 0
  buffer_load_dwordx4 v235, s[16:19], s57 offen lds
  s_add_u32 m0, s101, -57344
  s_nop 0
  buffer_load_dwordx4 v236, s[16:19], s57 offen lds
  s_add_u32 m0, s101, -56320
  s_nop 0
  buffer_load_dwordx4 v237, s[16:19], s57 offen lds
  s_add_u32 m0, s101, -55296
  s_nop 0
  buffer_load_dwordx4 v238, s[16:19], s57 offen lds
  s_add_u32 m0, s101, -54784
  s_nop 0
  buffer_load_dwordx4 v239, s[16:19], s57 offen lds
M_er:
  s_barrier
  s_cmp_lt_u32 s40, 4
  s_cbranch_scc1 M_xl
  s_setprio 1
  s_barrier
  s_branch M_pa
M_xl:
  s_lshl_b32 s55, s40, 10
  s_add_u32 s55, s55, 131072
  s_sub_u32 m0, s55, 40960
  s_nop 0
  buffer_load_dwordx4 v252, s[24:27], s55 offen sc1 lds
  s_add_u32 s55, s55, 4096
  s_sub_u32 m0, s55, 40960
  s_nop 0
  buffer_load_dwordx4 v252, s[24:27], s55 offen sc1 lds
  s_add_u32 s55, s55, 4096
  s_sub_u32 m0, s55, 40960
  s_nop 0
  buffer_load_dwordx4 v252, s[24:27], s55 offen sc1 lds
  s_add_u32 s55, s55, 4096
  s_sub_u32 m0, s55, 40960
  s_nop 0
  buffer_load_dwordx4 v252, s[24:27], s55 offen sc1 lds
  s_add_u32 s55, s55, 4096
  s_sub_u32 m0, s55, 40960
  s_nop 0
  buffer_load_dwordx4 v252, s[24:27], s55 offen sc1 lds
  s_add_u32 s55, s55, 4096
  s_sub_u32 m0, s55, 40960
  s_nop 0
  buffer_load_dwordx4 v252, s[24:27], s55 offen sc1 lds
  s_add_u32 s55, s55, 4096
  s_sub_u32 m0, s55, 40960
  s_nop 0
  buffer_load_dwordx4 v252, s[24:27], s55 offen sc1 lds
  s_add_u32 s55, s55, 4096
  s_sub_u32 m0, s55, 40960
  s_nop 0
  buffer_load_dwordx4 v252, s[24:27], s55 offen sc1 lds
  s_add_u32 s55, s55, 4096
  s_sub_u32 m0, s55, 40960
  s_nop 0
  buffer_load_dwordx4 v252, s[24:27], s55 offen sc1 lds
  s_add_u32 s55, s55, 4096
  s_sub_u32 m0, s55, 40960
  s_nop 0
  buffer_load_dwordx4 v252, s[24:27], s55 offen sc1 lds
  s_add_u32 s55, s55, 4096
  s_sub_u32 m0, s55, 40960
  s_nop 0
  buffer_load_dwordx4 v252, s[24:27], s55 offen sc1 lds
  s_add_u32 s55, s55, 4096
  s_sub_u32 m0, s55, 40960
  s_nop 0
  buffer_load_dwordx4 v252, s[24:27], s55 offen sc1 lds
  s_waitcnt vmcnt(6)
  s_barrier
  s_lshl_b32 s55, s40, 10
  s_add_u32 s55, s55, 180224
  s_sub_u32 m0, s55, 40960
  s_nop 0
  buffer_load_dwordx4 v252, s[24:27], s55 offen sc1 lds
  s_add_u32 s55, s55, 4096
  s_sub_u32 m0, s55, 40960
  s_nop 0
  buffer_load_dwordx4 v252, s[24:27], s55 offen sc1 lds
  s_add_u32 s55, s55, 4096
  s_sub_u32 m0, s55, 40960
  s_nop 0
  buffer_load_dwordx4 v252, s[24:27], s55 offen sc1 lds
  s_add_u32 s55, s55, 4096
  s_sub_u32 m0, s55, 40960
  s_nop 0
  buffer_load_dwordx4 v252, s[24:27], s55 offen sc1 lds
  s_add_u32 s55, s55, 4096
  s_sub_u32 m0, s55, 40960
  s_nop 0
  buffer_load_dwordx4 v252, s[24:27], s55 offen sc1 lds
  s_add_u32 s55, s55, 4096
  s_sub_u32 m0, s55, 40960
  s_nop 0
  buffer_load_dwordx4 v252, s[24:27], s55 offen sc1 lds
M_pa:
  ds_read_b128 v[200:203], v254 offset:0
  ds_read_b128 v[204:207], v254 offset:1024
  ds_read_b128 v[208:211], v254 offset:2048
  ds_read_b128 v[212:215], v254 offset:3072
  ds_read_b128 v[216:219], v254 offset:4096
  ds_read_b128 v[220:223], v254 offset:5120
  s_waitcnt lgkmcnt(5)
  v_mfma_f32_16x16x32_bf16 v[168:171], v[200:203], v[16:19], 0
  ds_read_b128 v[224:227], v254 offset:6144
  v_mfma_f32_16x16x32_bf16 v[176:179], v[200:203], v[40:43], 0
  s_waitcnt lgkmcnt(5)
  v_mfma_f32_16x16x32_bf16 v[172:175], v[204:207], v[16:19], 0
  ds_read_b128 v[228:231], v254 offset:7168
  v_mfma_f32_16x16x32_bf16 v[180:183], v[204:207], v[40:43], 0
  s_waitcnt lgkmcnt(5)
  v_mfma_f32_16x16x32_bf16 v[168:171], v[208:211], v[20:23], v[168:171]
  ds_read_b128 v[200:203], v254 offset:8192
  v_mfma_f32_16x16x32_bf16 v[176:179], v[208:211], v[44:47], v[176:179]
  s_waitcnt lgkmcnt(5)
  v_mfma_f32_16x16x32_bf16 v[172:175], v[212:215], v[20:23], v[172:175]
  ds_read_b128 v[204:207], v254 offset:9216
  v_mfma_f32_16x16x32_bf16 v[180:183], v[212:215], v[44:47], v[180:183]
  s_waitcnt lgkmcnt(5)
  v_mfma_f32_16x16x32_bf16 v[168:171], v[216:219], v[24:27], v[168:171]
  ds_read_b128 v[208:211], v254 offset:10240
  v_mfma_f32_16x16x32_bf16 v[176:179], v[216:219], v[48:51], v[176:179]
  s_waitcnt lgkmcnt(5)
  v_mfma_f32_16x16x32_bf16 v[172:175], v[220:223], v[24:27], v[172:175]
  ds_read_b128 v[212:215], v254 offset:11264
  v_mfma_f32_16x16x32_bf16 v[180:183], v[220:223], v[48:51], v[180:183]
  s_waitcnt lgkmcnt(5)
  v_mfma_f32_16x16x32_bf16 v[168:171], v[224:227], v[28:31], v[168:171]
  ds_read_b128 v[216:219], v254 offset:12288
  v_mfma_f32_16x16x32_bf16 v[176:179], v[224:227], v[52:55], v[176:179]
  s_waitcnt lgkmcnt(5)
  v_mfma_f32_16x16x32_bf16 v[172:175], v[228:231], v[28:31], v[172:175]
  ds_read_b128 v[220:223], v254 offset:13312
  v_mfma_f32_16x16x32_bf16 v[180:183], v[228:231], v[52:55], v[180:183]
  s_waitcnt lgkmcnt(5)
  v_mfma_f32_16x16x32_bf16 v[168:171], v[200:203], v[32:35], v[168:171]
  ds_read_b128 v[224:227], v254 offset:14336
  v_mfma_f32_16x16x32_bf16 v[176:179], v[200:203], v[56:59], v[176:179]
  s_waitcnt lgkmcnt(5)
  v_mfma_f32_16x16x32_bf16 v[172:175], v[204:207], v[32:35], v[172:175]
  ds_read_b128 v[228:231], v254 offset:15360
  v_mfma_f32_16x16x32_bf16 v[180:183], v[204:207], v[56:59], v[180:183]
  s_waitcnt lgkmcnt(5)
  v_mfma_f32_16x16x32_bf16 v[168:171], v[208:211], v[36:39], v[168:171]
  ds_read_b128 v[200:203], v254 offset:16384
  v_mfma_f32_16x16x32_bf16 v[176:179], v[208:211], v[60:63], v[176:179]
  s_waitcnt lgkmcnt(5)
  v_mfma_f32_16x16x32_bf16 v[172:175], v[212:215], v[36:39], v[172:175]
  ds_read_b128 v[204:207], v254 offset:17408
  v_mfma_f32_16x16x32_bf16 v[180:183], v[212:215], v[60:63], v[180:183]
  s_waitcnt lgkmcnt(5)
  v_mfma_f32_16x16x32_bf16 v[184:187], v[216:219], v[16:19], 0
  ds_read_b128 v[208:211], v254 offset:18432
  v_mfma_f32_16x16x32_bf16 v[192:195], v[216:219], v[40:43], 0
  s_waitcnt lgkmcnt(5)
  v_mfma_f32_16x16x32_bf16 v[188:191], v[220:223], v[16:19], 0
  ds_read_b128 v[212:215], v254 offset:19456
  v_cvt_pk_bf16_f32 v120, v168, v169
  v_mfma_f32_16x16x32_bf16 v[196:199], v[220:223], v[40:43], 0
  s_waitcnt lgkmcnt(5)
  v_cvt_pk_bf16_f32 v121, v170, v171
  v_cvt_pk_bf16_f32 v122, v172, v173
  v_mfma_f32_16x16x32_bf16 v[184:187], v[224:227], v[20:23], v[184:187]
  ds_read_b128 v[216:219], v254 offset:20480
  v_cvt_pk_bf16_f32 v123, v174, v175
  v_mfma_f32_16x16x32_bf16 v[192:195], v[224:227], v[44:47], v[192:195]
  s_waitcnt lgkmcnt(5)
  v_cvt_pk_bf16_f32 v144, v176, v177
  v_cvt_pk_bf16_f32 v145, v178, v179
  v_mfma_f32_16x16x32_bf16 v[188:191], v[228:231], v[20:23], v[188:191]
  ds_read_b128 v[220:223], v254 offset:21504
  v_cvt_pk_bf16_f32 v146, v180, v181
  v_mfma_f32_16x16x32_bf16 v[196:199], v[228:231], v[44:47], v[196:199]
  s_waitcnt lgkmcnt(5)
  v_cvt_pk_bf16_f32 v147, v182, v183
  v_mfma_f32_16x16x32_bf16 v[184:187], v[200:203], v[24:27], v[184:187]
  ds_read_b128 v[224:227], v254 offset:22528
  v_mfma_f32_16x16x32_bf16 v[192:195], v[200:203], v[48:51], v[192:195]
  s_waitcnt lgkmcnt(5)
  v_mfma_f32_16x16x32_bf16 v[188:191], v[204:207], v[24:27], v[188:191]
  ds_read_b128 v[228:231], v254 offset:23552
  v_mfma_f32_16x16x32_bf16 v[196:199], v[204:207], v[48:51], v[196:199]
  s_waitcnt vmcnt(0)
  s_barrier
  s_waitcnt lgkmcnt(5)
  v_mfma_f32_16x16x32_bf16 v[184:187], v[208:211], v[28:31], v[184:187]
  ds_read_b128 v[200:203], v254 offset:24576
  v_mfma_f32_16x16x32_bf16 v[192:195], v[208:211], v[52:55], v[192:195]
  s_waitcnt lgkmcnt(5)
  v_mfma_f32_16x16x32_bf16 v[188:191], v[212:215], v[28:31], v[188:191]
  ds_read_b128 v[204:207], v254 offset:25600
  v_mfma_f32_16x16x32_bf16 v[196:199], v[212:215], v[52:55], v[196:199]
  s_waitcnt lgkmcnt(5)
  v_mfma_f32_16x16x32_bf16 v[184:187], v[216:219], v[32:35], v[184:187]
  ds_read_b128 v[208:211], v254 offset:26624
  v_mfma_f32_16x16x32_bf16 v[192:195], v[216:219], v[56:59], v[192:195]
  s_waitcnt lgkmcnt(5)
  v_mfma_f32_16x16x32_bf16 v[188:191], v[220:223], v[32:35], v[188:191]
  ds_read_b128 v[212:215], v254 offset:27648
  v_mfma_f32_16x16x32_bf16 v[196:199], v[220:223], v[56:59], v[196:199]
  s_waitcnt lgkmcnt(5)
  v_mfma_f32_16x16x32_bf16 v[184:187], v[224:227], v[36:39], v[184:187]
  ds_read_b128 v[216:219], v254 offset:28672
  v_mfma_f32_16x16x32_bf16 v[192:195], v[224:227], v[60:63], v[192:195]
  s_waitcnt lgkmcnt(5)
  v_mfma_f32_16x16x32_bf16 v[188:191], v[228:231], v[36:39], v[188:191]
  ds_read_b128 v[220:223], v254 offset:29696
  v_mfma_f32_16x16x32_bf16 v[196:199], v[228:231], v[60:63], v[196:199]
  s_waitcnt lgkmcnt(5)
  v_mfma_f32_16x16x32_bf16 v[168:171], v[200:203], v[16:19], 0
  ds_read_b128 v[224:227], v254 offset:30720
  v_mfma_f32_16x16x32_bf16 v[176:179], v[200:203], v[40:43], 0
  s_waitcnt lgkmcnt(5)
  v_mfma_f32_16x16x32_bf16 v[172:175], v[204:207], v[16:19], 0
  ds_read_b128 v[228:231], v254 offset:31744
  v_cvt_pk_bf16_f32 v124, v184, v185
  v_mfma_f32_16x16x32_bf16 v[180:183], v[204:207], v[40:43], 0
  s_waitcnt lgkmcnt(5)
  v_cvt_pk_bf16_f32 v125, v186, v187
  v_cvt_pk_bf16_f32 v126, v188, v189
  v_mfma_f32_16x16x32_bf16 v[168:171], v[208:211], v[20:23], v[168:171]
  ds_read_b128 v[200:203], v254 offset:32768
  v_cvt_pk_bf16_f32 v127, v190, v191
  v_mfma_f32_16x16x32_bf16 v[176:179], v[208:211], v[44:47], v[176:179]
  s_waitcnt lgkmcnt(5)
  v_cvt_pk_bf16_f32 v148, v192, v193
  v_cvt_pk_bf16_f32 v149, v194, v195
  v_mfma_f32_16x16x32_bf16 v[172:175], v[212:215], v[20:23], v[172:175]
  ds_read_b128 v[204:207], v254 offset:33792
  v_cvt_pk_bf16_f32 v150, v196, v197
  v_mfma_f32_16x16x32_bf16 v[180:183], v[212:215], v[44:47], v[180:183]
  s_waitcnt lgkmcnt(5)
  v_cvt_pk_bf16_f32 v151, v198, v199
  v_mfma_f32_16x16x32_bf16 v[168:171], v[216:219], v[24:27], v[168:171]
  ds_read_b128 v[208:211], v254 offset:34816
  v_mfma_f32_16x16x32_bf16 v[176:179], v[216:219], v[48:51], v[176:179]
  s_waitcnt lgkmcnt(5)
  v_mfma_f32_16x16x32_bf16 v[172:175], v[220:223], v[24:27], v[172:175]
  ds_read_b128 v[212:215], v254 offset:35840
  v_mfma_f32_16x16x32_bf16 v[180:183], v[220:223], v[48:51], v[180:183]
  s_waitcnt lgkmcnt(5)
  v_mfma_f32_16x16x32_bf16 v[168:171], v[224:227], v[28:31], v[168:171]
  ds_read_b128 v[216:219], v254 offset:36864
  v_mfma_f32_16x16x32_bf16 v[176:179], v[224:227], v[52:55], v[176:179]
  s_waitcnt lgkmcnt(5)
  v_mfma_f32_16x16x32_bf16 v[172:175], v[228:231], v[28:31], v[172:175]
  ds_read_b128 v[220:223], v254 offset:37888
  v_mfma_f32_16x16x32_bf16 v[180:183], v[228:231], v[52:55], v[180:183]
  s_waitcnt lgkmcnt(5)
  v_mfma_f32_16x16x32_bf16 v[168:171], v[200:203], v[32:35], v[168:171]
  ds_read_b128 v[224:227], v254 offset:38912
  v_mfma_f32_16x16x32_bf16 v[176:179], v[200:203], v[56:59], v[176:179]
  s_waitcnt lgkmcnt(5)
  v_mfma_f32_16x16x32_bf16 v[172:175], v[204:207], v[32:35], v[172:175]
  ds_read_b128 v[228:231], v254 offset:39936
  v_mfma_f32_16x16x32_bf16 v[180:183], v[204:207], v[56:59], v[180:183]
  s_waitcnt lgkmcnt(5)
  v_mfma_f32_16x16x32_bf16 v[168:171], v[208:211], v[36:39], v[168:171]
  ds_read_b128 v[200:203], v254 offset:40960
  v_mfma_f32_16x16x32_bf16 v[176:179], v[208:211], v[60:63], v[176:179]
  s_waitcnt lgkmcnt(5)
  v_mfma_f32_16x16x32_bf16 v[172:175], v[212:215], v[36:39], v[172:175]
  ds_read_b128 v[204:207], v254 offset:41984
  v_mfma_f32_16x16x32_bf16 v[180:183], v[212:215], v[60:63], v[180:183]
  s_barrier
  s_waitcnt lgkmcnt(5)
  v_mfma_f32_16x16x32_bf16 v[184:187], v[216:219], v[16:19], 0
  ds_read_b128 v[208:211], v254 offset:43008
  s_add_u32 m0, s101, 0
  s_nop 0
  buffer_load_dwordx4 v232, s[16:19], s100 offen lds
  v_mfma_f32_16x16x32_bf16 v[192:195], v[216:219], v[40:43], 0
  s_waitcnt lgkmcnt(5)
  s_add_u32 m0, s101, 1024
  s_nop 0
  buffer_load_dwordx4 v233, s[16:19], s100 offen lds
  s_add_u32 m0, s101, 2048
  s_nop 0
  buffer_load_dwordx4 v234, s[16:19], s100 offen lds
  v_mfma_f32_16x16x32_bf16 v[188:191], v[220:223], v[16:19], 0
  ds_read_b128 v[212:215], v254 offset:44032
  v_cvt_pk_bf16_f32 v128, v168, v169
  v_mfma_f32_16x16x32_bf16 v[196:199], v[220:223], v[40:43], 0
  s_waitcnt lgkmcnt(5)
  v_cvt_pk_bf16_f32 v129, v170, v171
  v_cvt_pk_bf16_f32 v130, v172, v173
  v_mfma_f32_16x16x32_bf16 v[184:187], v[224:227], v[20:23], v[184:187]
  ds_read_b128 v[216:219], v254 offset:45056
  v_cvt_pk_bf16_f32 v131, v174, v175
  v_mfma_f32_16x16x32_bf16 v[192:195], v[224:227], v[44:47], v[192:195]
  s_waitcnt lgkmcnt(5)
  v_cvt_pk_bf16_f32 v152, v176, v177
  v_cvt_pk_bf16_f32 v153, v178, v179
  v_mfma_f32_16x16x32_bf16 v[188:191], v[228:231], v[20:23], v[188:191]
  ds_read_b128 v[220:223], v254 offset:46080
  v_cvt_pk_bf16_f32 v154, v180, v181
  v_mfma_f32_16x16x32_bf16 v[196:199], v[228:231], v[44:47], v[196:199]
  s_waitcnt lgkmcnt(5)
  v_cvt_pk_bf16_f32 v155, v182, v183
  s_add_u32 m0, s101, 3072
  s_nop 0
  buffer_load_dwordx4 v235, s[16:19], s100 offen lds
  v_mfma_f32_16x16x32_bf16 v[184:187], v[200:203], v[24:27], v[184:187]
  ds_read_b128 v[224:227], v254 offset:47104
  s_add_u32 m0, s101, 4096
  s_nop 0
  buffer_load_dwordx4 v236, s[16:19], s100 offen lds
  v_mfma_f32_16x16x32_bf16 v[192:195], v[200:203], v[48:51], v[192:195]
  s_waitcnt lgkmcnt(5)
  s_add_u32 m0, s101, 5120
  s_nop 0
  buffer_load_dwordx4 v237, s[16:19], s100 offen lds
  s_add_u32 m0, s101, 6144
  s_nop 0
  buffer_load_dwordx4 v238, s[16:19], s100 offen lds
  v_mfma_f32_16x16x32_bf16 v[188:191], v[204:207], v[24:27], v[188:191]
  ds_read_b128 v[228:231], v254 offset:48128
  s_add_u32 m0, s101, 6656
  s_nop 0
  buffer_load_dwordx4 v239, s[16:19], s100 offen lds
  v_mfma_f32_16x16x32_bf16 v[196:199], v[204:207], v[48:51], v[196:199]
  s_waitcnt lgkmcnt(5)
  v_mfma_f32_16x16x32_bf16 v[184:187], v[208:211], v[28:31], v[184:187]
  ds_read_b128 v[200:203], v254 offset:49152
  v_mfma_f32_16x16x32_bf16 v[192:195], v[208:211], v[52:55], v[192:195]
  s_waitcnt lgkmcnt(5)
  v_mfma_f32_16x16x32_bf16 v[188:191], v[212:215], v[28:31], v[188:191]
  ds_read_b128 v[204:207], v254 offset:50176
  v_mfma_f32_16x16x32_bf16 v[196:199], v[212:215], v[52:55], v[196:199]
  s_waitcnt lgkmcnt(5)
  v_mfma_f32_16x16x32_bf16 v[184:187], v[216:219], v[32:35], v[184:187]
  ds_read_b128 v[208:211], v254 offset:51200
  v_mfma_f32_16x16x32_bf16 v[192:195], v[216:219], v[56:59], v[192:195]
  s_waitcnt lgkmcnt(5)
  v_mfma_f32_16x16x32_bf16 v[188:191], v[220:223], v[32:35], v[188:191]
  ds_read_b128 v[212:215], v254 offset:52224
  v_mfma_f32_16x16x32_bf16 v[196:199], v[220:223], v[56:59], v[196:199]
  s_waitcnt lgkmcnt(5)
  v_mfma_f32_16x16x32_bf16 v[184:187], v[224:227], v[36:39], v[184:187]
  ds_read_b128 v[216:219], v254 offset:53248
  v_mfma_f32_16x16x32_bf16 v[192:195], v[224:227], v[60:63], v[192:195]
  s_waitcnt lgkmcnt(5)
  v_mfma_f32_16x16x32_bf16 v[188:191], v[228:231], v[36:39], v[188:191]
  ds_read_b128 v[220:223], v254 offset:54272
  v_mfma_f32_16x16x32_bf16 v[196:199], v[228:231], v[60:63], v[196:199]
  s_waitcnt lgkmcnt(5)
  v_mfma_f32_16x16x32_bf16 v[168:171], v[200:203], v[16:19], 0
  ds_read_b128 v[224:227], v254 offset:55296
  v_mfma_f32_16x16x32_bf16 v[176:179], v[200:203], v[40:43], 0
  s_waitcnt lgkmcnt(5)
  ds_read_b128 v[232:235], v254 offset:61440
  v_mfma_f32_16x16x32_bf16 v[172:175], v[204:207], v[16:19], 0
  ds_read_b128 v[228:231], v254 offset:56320
  v_cvt_pk_bf16_f32 v132, v184, v185
  v_mfma_f32_16x16x32_bf16 v[180:183], v[204:207], v[40:43], 0
  s_waitcnt lgkmcnt(6)
  ds_read_b128 v[236:239], v254 offset:62464
  v_cvt_pk_bf16_f32 v133, v186, v187
  v_mfma_f32_16x16x32_bf16 v[168:171], v[208:211], v[20:23], v[168:171]
  ds_read_b128 v[200:203], v254 offset:57344
  v_cvt_pk_bf16_f32 v134, v188, v189
  v_mfma_f32_16x16x32_bf16 v[176:179], v[208:211], v[44:47], v[176:179]
  s_waitcnt lgkmcnt(7)
  v_cvt_pk_bf16_f32 v135, v190, v191
  v_cvt_pk_bf16_f32 v156, v192, v193
  v_mfma_f32_16x16x32_bf16 v[172:175], v[212:215], v[20:23], v[172:175]
  ds_read_b128 v[204:207], v254 offset:58368
  v_cvt_pk_bf16_f32 v157, v194, v195
  v_mfma_f32_16x16x32_bf16 v[180:183], v[212:215], v[44:47], v[180:183]
  s_waitcnt lgkmcnt(7)
  v_cvt_pk_bf16_f32 v158, v196, v197
  v_cvt_pk_bf16_f32 v159, v198, v199
  v_mfma_f32_16x16x32_bf16 v[168:171], v[216:219], v[24:27], v[168:171]
  ds_read_b128 v[208:211], v254 offset:59392
  v_mfma_f32_16x16x32_bf16 v[176:179], v[216:219], v[48:51], v[176:179]
  s_waitcnt lgkmcnt(7)
  v_mfma_f32_16x16x32_bf16 v[172:175], v[220:223], v[24:27], v[172:175]
  ds_read_b128 v[212:215], v254 offset:60416
  v_mfma_f32_16x16x32_bf16 v[180:183], v[220:223], v[48:51], v[180:183]
  s_waitcnt lgkmcnt(7)
  v_mfma_f32_16x16x32_bf16 v[168:171], v[224:227], v[28:31], v[168:171]
  v_mfma_f32_16x16x32_bf16 v[176:179], v[224:227], v[52:55], v[176:179]
  s_waitcnt lgkmcnt(5)
  v_mfma_f32_16x16x32_bf16 v[172:175], v[228:231], v[28:31], v[172:175]
  v_mfma_f32_16x16x32_bf16 v[180:183], v[228:231], v[52:55], v[180:183]
  s_waitcnt lgkmcnt(3)
  v_mfma_f32_16x16x32_bf16 v[168:171], v[200:203], v[32:35], v[168:171]
  ds_read_b128 v[224:227], v253 offset:0
  v_mfma_f32_16x16x32_bf16 v[176:179], v[200:203], v[56:59], v[176:179]
  s_waitcnt lgkmcnt(3)
  v_mfma_f32_16x16x32_bf16 v[172:175], v[204:207], v[32:35], v[172:175]
  ds_read_b128 v[228:231], v253 offset:1024
  v_mfma_f32_16x16x32_bf16 v[180:183], v[204:207], v[56:59], v[180:183]
  s_waitcnt lgkmcnt(3)
  v_mfma_f32_16x16x32_bf16 v[168:171], v[208:211], v[36:39], v[168:171]
  ds_read_b128 v[200:203], v253 offset:2048
  v_mfma_f32_16x16x32_bf16 v[176:179], v[208:211], v[60:63], v[176:179]
  s_waitcnt lgkmcnt(3)
  v_mfma_f32_16x16x32_bf16 v[172:175], v[212:215], v[36:39], v[172:175]
  ds_read_b128 v[204:207], v253 offset:3072
  v_mfma_f32_16x16x32_bf16 v[180:183], v[212:215], v[60:63], v[180:183]
  s_waitcnt vmcnt(0)
  s_barrier
  s_setprio 2
  s_cmp_lt_u32 s40, 4
  s_cbranch_scc1 M_pr1
  s_setprio 3
M_pr1:
  v_mfma_f32_16x16x32_bf16 v[184:187], v[232:235], v[16:19], 0
  ds_read_b128 v[208:211], v253 offset:4096
  v_mfma_f32_16x16x32_bf16 v[192:195], v[232:235], v[40:43], 0
  v_mfma_f32_16x16x32_bf16 v[188:191], v[236:239], v[16:19], 0
  ds_read_b128 v[212:215], v253 offset:5120
  v_cvt_pk_bf16_f32 v136, v168, v169
  v_mfma_f32_16x16x32_bf16 v[196:199], v[236:239], v[40:43], 0
  s_waitcnt lgkmcnt(5)
  v_cvt_pk_bf16_f32 v137, v170, v171
  v_cvt_pk_bf16_f32 v138, v172, v173
  v_mfma_f32_16x16x32_bf16 v[184:187], v[224:227], v[20:23], v[184:187]
  ds_read_b128 v[216:219], v253 offset:6144
  v_cvt_pk_bf16_f32 v139, v174, v175
  v_mfma_f32_16x16x32_bf16 v[192:195], v[224:227], v[44:47], v[192:195]
  s_waitcnt lgkmcnt(5)
  v_cvt_pk_bf16_f32 v160, v176, v177
  v_cvt_pk_bf16_f32 v161, v178, v179
  v_mfma_f32_16x16x32_bf16 v[188:191], v[228:231], v[20:23], v[188:191]
  ds_read_b128 v[220:223], v253 offset:7168
  v_cvt_pk_bf16_f32 v162, v180, v181
  v_mfma_f32_16x16x32_bf16 v[196:199], v[228:231], v[44:47], v[196:199]
  s_waitcnt lgkmcnt(5)
  v_cvt_pk_bf16_f32 v163, v182, v183
  v_mfma_f32_16x16x32_bf16 v[184:187], v[200:203], v[24:27], v[184:187]
  ds_read_b128 v[224:227], v253 offset:8192
  v_mfma_f32_16x16x32_bf16 v[192:195], v[200:203], v[48:51], v[192:195]
  s_waitcnt lgkmcnt(5)
  v_mfma_f32_16x16x32_bf16 v[188:191], v[204:207], v[24:27], v[188:191]
  ds_read_b128 v[228:231], v253 offset:9216
  v_mfma_f32_16x16x32_bf16 v[196:199], v[204:207], v[48:51], v[196:199]
  s_waitcnt lgkmcnt(5)
  v_mfma_f32_16x16x32_bf16 v[184:187], v[208:211], v[28:31], v[184:187]
  v_mfma_f32_16x16x32_bf16 v[192:195], v[208:211], v[52:55], v[192:195]
  s_waitcnt lgkmcnt(4)
  v_mfma_f32_16x16x32_bf16 v[188:191], v[212:215], v[28:31], v[188:191]
  v_mfma_f32_16x16x32_bf16 v[196:199], v[212:215], v[52:55], v[196:199]
  s_waitcnt lgkmcnt(3)
  v_mfma_f32_16x16x32_bf16 v[184:187], v[216:219], v[32:35], v[184:187]
  v_mfma_f32_16x16x32_bf16 v[192:195], v[216:219], v[56:59], v[192:195]
  s_waitcnt lgkmcnt(2)
  v_mfma_f32_16x16x32_bf16 v[188:191], v[220:223], v[32:35], v[188:191]
  v_mfma_f32_16x16x32_bf16 v[196:199], v[220:223], v[56:59], v[196:199]
  s_waitcnt lgkmcnt(1)
  v_mfma_f32_16x16x32_bf16 v[184:187], v[224:227], v[36:39], v[184:187]
  v_mfma_f32_16x16x32_bf16 v[192:195], v[224:227], v[60:63], v[192:195]
  s_waitcnt lgkmcnt(0)
  v_mfma_f32_16x16x32_bf16 v[188:191], v[228:231], v[36:39], v[188:191]
  v_mfma_f32_16x16x32_bf16 v[196:199], v[228:231], v[60:63], v[196:199]
  s_cmp_ge_u32 s40, 4
  s_cbranch_scc1 M_l1
  s_barrier
M_l1:
  ds_read_b128 v[200:203], v240 offset:0
  ds_read_b128 v[204:207], v240 offset:2304
  ds_read_b128 v[208:211], v241 offset:0
  ds_read_b128 v[212:215], v241 offset:2304
  ds_read_b128 v[216:219], v242 offset:0
  ds_read_b128 v[220:223], v242 offset:2304
  ds_read_b128 v[224:227], v243 offset:0
  v_cvt_pk_bf16_f32 v140, v184, v185
  v_cvt_pk_bf16_f32 v141, v186, v187
  v_cvt_pk_bf16_f32 v142, v188, v189
  v_cvt_pk_bf16_f32 v143, v190, v191
  v_cvt_pk_bf16_f32 v164, v192, v193
  v_cvt_pk_bf16_f32 v165, v194, v195
  v_cvt_pk_bf16_f32 v166, v196, v197
  v_cvt_pk_bf16_f32 v167, v198, v199
  s_mov_b32 s56, 0xff7fffff
  s_waitcnt lgkmcnt(6)
  v_mfma_f32_16x16x32_bf16 v[64:67], v[200:203], v[120:123], v[64:67]
  s_waitcnt lgkmcnt(5)
  ds_read_b128 v[228:231], v243 offset:2304
  v_mov_b32 v30, 0
  v_mfma_f32_16x16x32_bf16 v[76:79], v[204:207], v[120:123], v[76:79]
  v_mov_b32 v31, 0
  v_mov_b32 v32, 0
  v_mfma_f32_16x16x32_bf16 v[92:95], v[204:207], v[144:147], v[92:95]
  s_waitcnt lgkmcnt(5)
  ds_read_b128 v[200:203], v240 offset:256
  v_mov_b32 v33, 0
  v_mfma_f32_16x16x32_bf16 v[64:67], v[208:211], v[124:127], v[64:67]
  s_waitcnt lgkmcnt(5)
  ds_read_b128 v[204:207], v240 offset:2560
  v_mov_b32 v48, 0x3f803f80
  v_mfma_f32_16x16x32_bf16 v[76:79], v[212:215], v[124:127], v[76:79]
  v_mov_b32 v49, 0x3f803f80
  v_mov_b32 v50, 0x3f803f80
  v_mfma_f32_16x16x32_bf16 v[92:95], v[212:215], v[148:151], v[92:95]
  s_waitcnt lgkmcnt(5)
  ds_read_b128 v[208:211], v241 offset:256
  v_mov_b32 v51, 0x3f803f80
  v_mfma_f32_16x16x32_bf16 v[64:67], v[216:219], v[128:131], v[64:67]
  s_waitcnt lgkmcnt(5)
  ds_read_b128 v[212:215], v241 offset:2560
  v_mfma_f32_16x16x32_bf16 v[76:79], v[220:223], v[128:131], v[76:79]
  v_mfma_f32_16x16x32_bf16 v[92:95], v[220:223], v[152:155], v[92:95]
  s_waitcnt lgkmcnt(5)
  ds_read_b128 v[216:219], v240 offset:768
  v_mfma_f32_16x16x32_bf16 v[64:67], v[224:227], v[132:135], v[64:67]
  s_waitcnt lgkmcnt(5)
  ds_read_b128 v[220:223], v240 offset:3072
  v_mfma_f32_16x16x32_bf16 v[76:79], v[228:231], v[132:135], v[76:79]
  v_mfma_f32_16x16x32_bf16 v[92:95], v[228:231], v[156:159], v[92:95]
  s_waitcnt lgkmcnt(5)
  ds_read_b128 v[224:227], v241 offset:768
  v_mfma_f32_16x16x32_bf16 v[64:67], v[200:203], v[136:139], v[64:67]
  s_waitcnt lgkmcnt(5)
  ds_read_b128 v[228:231], v241 offset:3072
  v_mfma_f32_16x16x32_bf16 v[76:79], v[204:207], v[136:139], v[76:79]
  v_mfma_f32_16x16x32_bf16 v[92:95], v[204:207], v[160:163], v[92:95]
  s_waitcnt lgkmcnt(5)
  ds_read_b128 v[200:203], v242 offset:768
  v_mfma_f32_16x16x32_bf16 v[64:67], v[208:211], v[140:143], v[64:67]
  s_waitcnt lgkmcnt(5)
  ds_read_b128 v[204:207], v242 offset:3072
  v_mfma_f32_16x16x32_bf16 v[76:79], v[212:215], v[140:143], v[76:79]
  v_mfma_f32_16x16x32_bf16 v[92:95], v[212:215], v[164:167], v[92:95]
  s_waitcnt lgkmcnt(5)
  ds_read_b128 v[208:211], v243 offset:768
  v_mfma_f32_16x16x32_bf16 v[68:71], v[216:219], v[120:123], v[68:71]
  s_waitcnt lgkmcnt(5)
  ds_read_b128 v[212:215], v243 offset:3072
  v_mfma_f32_16x16x32_bf16 v[80:83], v[220:223], v[120:123], v[80:83]
  v_max3_f32 v12, v64, v65, s56
  v_max3_f32 v12, v66, v67, v12
  v_mfma_f32_16x16x32_bf16 v[96:99], v[220:223], v[144:147], v[96:99]
  s_waitcnt lgkmcnt(5)
  ds_read_b128 v[216:219], v240 offset:1024
  v_max3_f32 v12, v76, v77, v12
  v_mfma_f32_16x16x32_bf16 v[68:71], v[224:227], v[124:127], v[68:71]
  s_waitcnt lgkmcnt(5)
  ds_read_b128 v[220:223], v240 offset:3328
  v_max3_f32 v12, v78, v79, v12
  v_mfma_f32_16x16x32_bf16 v[80:83], v[228:231], v[124:127], v[80:83]
  v_max3_f32 v13, v92, v93, s56
  v_max3_f32 v13, v94, v95, v13
  v_mfma_f32_16x16x32_bf16 v[96:99], v[228:231], v[148:151], v[96:99]
  s_waitcnt lgkmcnt(5)
  ds_read_b128 v[224:227], v241 offset:1024
  v_mfma_f32_16x16x32_bf16 v[68:71], v[200:203], v[128:131], v[68:71]
  s_waitcnt lgkmcnt(5)
  ds_read_b128 v[228:231], v241 offset:3328
  v_mfma_f32_16x16x32_bf16 v[80:83], v[204:207], v[128:131], v[80:83]
  v_mfma_f32_16x16x32_bf16 v[96:99], v[204:207], v[152:155], v[96:99]
  s_waitcnt lgkmcnt(5)
  ds_read_b128 v[200:203], v240 offset:1536
  v_mfma_f32_16x16x32_bf16 v[68:71], v[208:211], v[132:135], v[68:71]
  s_waitcnt lgkmcnt(5)
  ds_read_b128 v[204:207], v240 offset:3840
  v_mfma_f32_16x16x32_bf16 v[80:83], v[212:215], v[132:135], v[80:83]
  v_mfma_f32_16x16x32_bf16 v[96:99], v[212:215], v[156:159], v[96:99]
  s_waitcnt lgkmcnt(5)
  ds_read_b128 v[208:211], v241 offset:1536
  v_mfma_f32_16x16x32_bf16 v[68:71], v[216:219], v[136:139], v[68:71]
  s_waitcnt lgkmcnt(5)
  ds_read_b128 v[212:215], v241 offset:3840
  v_mfma_f32_16x16x32_bf16 v[80:83], v[220:223], v[136:139], v[80:83]
  v_mfma_f32_16x16x32_bf16 v[96:99], v[220:223], v[160:163], v[96:99]
  s_waitcnt lgkmcnt(5)
  ds_read_b128 v[216:219], v242 offset:1536
  v_mfma_f32_16x16x32_bf16 v[68:71], v[224:227], v[140:143], v[68:71]
  s_waitcnt lgkmcnt(5)
  ds_read_b128 v[220:223], v242 offset:3840
  v_mfma_f32_16x16x32_bf16 v[80:83], v[228:231], v[140:143], v[80:83]
  v_mfma_f32_16x16x32_bf16 v[96:99], v[228:231], v[164:167], v[96:99]
  s_waitcnt lgkmcnt(5)
  ds_read_b128 v[224:227], v243 offset:1536
  v_mfma_f32_16x16x32_bf16 v[72:75], v[200:203], v[120:123], v[72:75]
  s_waitcnt lgkmcnt(5)
  ds_read_b128 v[228:231], v243 offset:3840
  v_mfma_f32_16x16x32_bf16 v[84:87], v[204:207], v[120:123], v[84:87]
  v_max3_f32 v12, v68, v69, v12
  v_max3_f32 v12, v70, v71, v12
  v_mfma_f32_16x16x32_bf16 v[100:103], v[204:207], v[144:147], v[100:103]
  s_waitcnt lgkmcnt(5)
  ds_read_b128 v[200:203], v240 offset:1792
  v_max3_f32 v12, v80, v81, v12
  v_mfma_f32_16x16x32_bf16 v[72:75], v[208:211], v[124:127], v[72:75]
  s_waitcnt lgkmcnt(5)
  ds_read_b128 v[204:207], v240 offset:4096
  v_max3_f32 v12, v82, v83, v12
  v_mfma_f32_16x16x32_bf16 v[84:87], v[212:215], v[124:127], v[84:87]
  v_max3_f32 v13, v96, v97, v13
  v_max3_f32 v13, v98, v99, v13
  v_mfma_f32_16x16x32_bf16 v[100:103], v[212:215], v[148:151], v[100:103]
  s_waitcnt lgkmcnt(5)
  ds_read_b128 v[208:211], v241 offset:1792
  v_mfma_f32_16x16x32_bf16 v[72:75], v[216:219], v[128:131], v[72:75]
  s_waitcnt lgkmcnt(5)
  ds_read_b128 v[212:215], v241 offset:4096
  v_mfma_f32_16x16x32_bf16 v[84:87], v[220:223], v[128:131], v[84:87]
  v_mfma_f32_16x16x32_bf16 v[100:103], v[220:223], v[152:155], v[100:103]
  s_waitcnt lgkmcnt(5)
  ds_read_b128 v[216:219], v240 offset:5376
  v_mfma_f32_16x16x32_bf16 v[72:75], v[224:227], v[132:135], v[72:75]
  s_waitcnt lgkmcnt(5)
  ds_read_b128 v[220:223], v240 offset:4608
  v_mfma_f32_16x16x32_bf16 v[84:87], v[228:231], v[132:135], v[84:87]
  v_mfma_f32_16x16x32_bf16 v[100:103], v[228:231], v[156:159], v[100:103]
  s_waitcnt lgkmcnt(5)
  ds_read_b128 v[224:227], v241 offset:5376
  v_mfma_f32_16x16x32_bf16 v[72:75], v[200:203], v[136:139], v[72:75]
  s_waitcnt lgkmcnt(5)
  ds_read_b128 v[228:231], v241 offset:4608
  v_mfma_f32_16x16x32_bf16 v[84:87], v[204:207], v[136:139], v[84:87]
  v_mfma_f32_16x16x32_bf16 v[100:103], v[204:207], v[160:163], v[100:103]
  s_waitcnt lgkmcnt(5)
  ds_read_b128 v[200:203], v242 offset:5376
  v_mfma_f32_16x16x32_bf16 v[72:75], v[208:211], v[140:143], v[72:75]
  s_waitcnt lgkmcnt(5)
  ds_read_b128 v[204:207], v242 offset:4608
  v_mfma_f32_16x16x32_bf16 v[84:87], v[212:215], v[140:143], v[84:87]
  v_mfma_f32_16x16x32_bf16 v[100:103], v[212:215], v[164:167], v[100:103]
  s_waitcnt lgkmcnt(5)
  ds_read_b128 v[208:211], v243 offset:5376
  v_mfma_f32_16x16x32_bf16 v[108:111], v[216:219], v[144:147], v[108:111]
  s_waitcnt lgkmcnt(5)
  ds_read_b128 v[212:215], v243 offset:4608
  v_mfma_f32_16x16x32_bf16 v[88:91], v[220:223], v[120:123], v[88:91]
  v_max3_f32 v12, v72, v73, v12
  v_max3_f32 v12, v74, v75, v12
  v_mfma_f32_16x16x32_bf16 v[104:107], v[220:223], v[144:147], v[104:107]
  s_waitcnt lgkmcnt(5)
  ds_read_b128 v[216:219], v240 offset:5632
  v_max3_f32 v12, v84, v85, v12
  v_mfma_f32_16x16x32_bf16 v[108:111], v[224:227], v[148:151], v[108:111]
  s_waitcnt lgkmcnt(5)
  ds_read_b128 v[220:223], v240 offset:4864
  v_max3_f32 v12, v86, v87, v12
  v_mfma_f32_16x16x32_bf16 v[88:91], v[228:231], v[124:127], v[88:91]
  v_max3_f32 v13, v100, v101, v13
  v_max3_f32 v13, v102, v103, v13
  v_mfma_f32_16x16x32_bf16 v[104:107], v[228:231], v[148:151], v[104:107]
  s_waitcnt lgkmcnt(5)
  ds_read_b128 v[224:227], v241 offset:5632
  v_mfma_f32_16x16x32_bf16 v[108:111], v[200:203], v[152:155], v[108:111]
  s_waitcnt lgkmcnt(5)
  ds_read_b128 v[228:231], v241 offset:4864
  v_mfma_f32_16x16x32_bf16 v[88:91], v[204:207], v[128:131], v[88:91]
  v_mfma_f32_16x16x32_bf16 v[104:107], v[204:207], v[152:155], v[104:107]
  s_waitcnt lgkmcnt(5)
  ds_read_b128 v[200:203], v240 offset:6144
  v_mfma_f32_16x16x32_bf16 v[108:111], v[208:211], v[156:159], v[108:111]
  s_waitcnt lgkmcnt(5)
  ds_read_b128 v[204:207], v240 offset:6912
  v_mfma_f32_16x16x32_bf16 v[88:91], v[212:215], v[132:135], v[88:91]
  v_mfma_f32_16x16x32_bf16 v[104:107], v[212:215], v[156:159], v[104:107]
  s_waitcnt lgkmcnt(5)
  ds_read_b128 v[208:211], v241 offset:6144
  v_mfma_f32_16x16x32_bf16 v[108:111], v[216:219], v[160:163], v[108:111]
  s_waitcnt lgkmcnt(5)
  ds_read_b128 v[212:215], v241 offset:6912
  v_mfma_f32_16x16x32_bf16 v[88:91], v[220:223], v[136:139], v[88:91]
  v_mfma_f32_16x16x32_bf16 v[104:107], v[220:223], v[160:163], v[104:107]
  s_waitcnt lgkmcnt(5)
  ds_read_b128 v[216:219], v242 offset:6144
  v_mfma_f32_16x16x32_bf16 v[108:111], v[224:227], v[164:167], v[108:111]
  s_waitcnt lgkmcnt(5)
  ds_read_b128 v[220:223], v242 offset:6912
  v_mfma_f32_16x16x32_bf16 v[88:91], v[228:231], v[140:143], v[88:91]
  v_mfma_f32_16x16x32_bf16 v[104:107], v[228:231], v[164:167], v[104:107]
  s_waitcnt lgkmcnt(5)
  ds_read_b128 v[224:227], v243 offset:6144
  v_mfma_f32_16x16x32_bf16 v[112:115], v[200:203], v[144:147], v[112:115]
  s_waitcnt lgkmcnt(5)
  ds_read_b128 v[228:231], v243 offset:6912
  v_mfma_f32_16x16x32_bf16 v[116:119], v[204:207], v[144:147], v[116:119]
  s_waitcnt lgkmcnt(5)
  ds_read_b128 v[200:203], v240 offset:6400
  v_max3_f32 v13, v108, v109, v13
  v_mfma_f32_16x16x32_bf16 v[112:115], v[208:211], v[148:151], v[112:115]
  s_waitcnt lgkmcnt(5)
  ds_read_b128 v[204:207], v240 offset:7168
  v_max3_f32 v13, v110, v111, v13
  v_mfma_f32_16x16x32_bf16 v[116:119], v[212:215], v[148:151], v[116:119]
  s_waitcnt lgkmcnt(5)
  ds_read_b128 v[208:211], v241 offset:6400
  v_max3_f32 v12, v88, v89, v12
  v_mfma_f32_16x16x32_bf16 v[112:115], v[216:219], v[152:155], v[112:115]
  s_waitcnt lgkmcnt(5)
  ds_read_b128 v[212:215], v241 offset:7168
  v_max3_f32 v12, v90, v91, v12
  v_mfma_f32_16x16x32_bf16 v[116:119], v[220:223], v[152:155], v[116:119]
  s_waitcnt lgkmcnt(5)
  v_max3_f32 v13, v104, v105, v13
  v_max3_f32 v13, v106, v107, v13
  v_mfma_f32_16x16x32_bf16 v[112:115], v[224:227], v[156:159], v[112:115]
  s_waitcnt lgkmcnt(4)
  v_mov_b32 v14, v12
  s_nop 1
  v_permlane32_swap_b32 v12, v14
  v_mfma_f32_16x16x32_bf16 v[116:119], v[228:231], v[156:159], v[116:119]
  s_waitcnt lgkmcnt(3)
  v_max_f32 v12, v12, v14
  v_mfma_f32_16x16x32_bf16 v[112:115], v[200:203], v[160:163], v[112:115]
  s_waitcnt lgkmcnt(2)
  v_mfma_f32_16x16x32_bf16 v[116:119], v[204:207], v[160:163], v[116:119]
  s_waitcnt lgkmcnt(1)
  v_mov_b32 v14, v12
  v_mfma_f32_16x16x32_bf16 v[112:115], v[208:211], v[164:167], v[112:115]
  s_waitcnt lgkmcnt(0)
  v_mfma_f32_16x16x32_bf16 v[116:119], v[212:215], v[164:167], v[116:119]
  v_permlane16_swap_b32 v12, v14
  s_setprio 0
  s_cmp_lt_u32 s40, 4
  s_cbranch_scc1 M_pr2
  s_setprio 1
M_pr2:
  v_max_f32 v12, v12, v14
  v_mul_f32 v12, s63, v12
  v_max3_f32 v13, v112, v113, v13
  v_max3_f32 v13, v114, v115, v13
  v_max3_f32 v13, v116, v117, v13
  v_max3_f32 v13, v118, v119, v13
  v_mov_b32 v15, v13
  s_nop 1
  v_permlane32_swap_b32 v13, v15
  v_max_f32 v13, v13, v15
  v_mov_b32 v15, v13
  s_nop 1
  v_permlane16_swap_b32 v13, v15
  v_max_f32 v13, v13, v15
  v_mul_f32 v13, s63, v13
  v_fma_f32 v64, v64, s63, -v12
  v_fma_f32 v65, v65, s63, -v12
  v_fma_f32 v66, v66, s63, -v12
  v_fma_f32 v67, v67, s63, -v12
  v_exp_f32 v64, v64
  v_exp_f32 v65, v65
  v_exp_f32 v66, v66
  v_exp_f32 v67, v67
  v_fma_f32 v92, v92, s63, -v13
  v_fma_f32 v93, v93, s63, -v13
  v_fma_f32 v94, v94, s63, -v13
  v_fma_f32 v95, v95, s63, -v13
  v_exp_f32 v92, v92
  v_exp_f32 v93, v93
  v_exp_f32 v94, v94
  v_exp_f32 v95, v95
  v_cvt_pk_bf16_f32 v16, v64, v65
  v_cvt_pk_bf16_f32 v17, v66, v67
  v_cvt_pk_bf16_f32 v34, v92, v93
  v_cvt_pk_bf16_f32 v35, v94, v95
  v_fma_f32 v68, v68, s63, -v12
  v_fma_f32 v69, v69, s63, -v12
  v_fma_f32 v70, v70, s63, -v12
  v_fma_f32 v71, v71, s63, -v12
  v_exp_f32 v68, v68
  v_exp_f32 v69, v69
  v_exp_f32 v70, v70
  v_exp_f32 v71, v71
  v_fma_f32 v96, v96, s63, -v13
  v_fma_f32 v97, v97, s63, -v13
  v_fma_f32 v98, v98, s63, -v13
  v_fma_f32 v99, v99, s63, -v13
  v_exp_f32 v96, v96
  v_exp_f32 v97, v97
  v_exp_f32 v98, v98
  v_exp_f32 v99, v99
  v_cvt_pk_bf16_f32 v18, v68, v69
  v_cvt_pk_bf16_f32 v19, v70, v71
  v_cvt_pk_bf16_f32 v36, v96, v97
  v_cvt_pk_bf16_f32 v37, v98, v99
  s_cmp_lt_u32 s40, 4
  s_cbranch_scc1 M_e2
  s_barrier
M_e2:
  s_mov_b32 s55, 10240
  buffer_load_dwordx4 v[64:67], v252, s[24:27], s55 offen offset:0 sc1
  buffer_load_dwordx4 v[92:95], v252, s[24:27], s55 offen offset:1024 sc1
  buffer_load_dwordx4 v[68:71], v252, s[24:27], s55 offen offset:2048 sc1
  buffer_load_dwordx4 v[96:99], v252, s[24:27], s55 offen offset:3072 sc1
  v_fma_f32 v72, v72, s63, -v12
  v_fma_f32 v73, v73, s63, -v12
  v_fma_f32 v74, v74, s63, -v12
  v_fma_f32 v75, v75, s63, -v12
  v_exp_f32 v72, v72
  v_exp_f32 v73, v73
  v_exp_f32 v74, v74
  v_exp_f32 v75, v75
  v_fma_f32 v100, v100, s63, -v13
  v_fma_f32 v101, v101, s63, -v13
  v_fma_f32 v102, v102, s63, -v13
  v_fma_f32 v103, v103, s63, -v13
  v_exp_f32 v100, v100
  v_exp_f32 v101, v101
  v_exp_f32 v102, v102
  v_exp_f32 v103, v103
  v_cvt_pk_bf16_f32 v20, v72, v73
  v_cvt_pk_bf16_f32 v21, v74, v75
  v_cvt_pk_bf16_f32 v38, v100, v101
  v_cvt_pk_bf16_f32 v39, v102, v103
  s_mov_b32 s55, 14336
  buffer_load_dwordx4 v[72:75], v252, s[24:27], s55 offen offset:0 sc1
  buffer_load_dwordx4 v[100:103], v252, s[24:27], s55 offen offset:1024 sc1
  v_fma_f32 v76, v76, s63, -v12
  v_fma_f32 v77, v77, s63, -v12
  v_fma_f32 v78, v78, s63, -v12
  v_fma_f32 v79, v79, s63, -v12
  v_exp_f32 v76, v76
  v_exp_f32 v77, v77
  v_exp_f32 v78, v78
  v_exp_f32 v79, v79
  v_fma_f32 v104, v104, s63, -v13
  v_fma_f32 v105, v105, s63, -v13
  v_fma_f32 v106, v106, s63, -v13
  v_fma_f32 v107, v107, s63, -v13
  v_exp_f32 v104, v104
  v_exp_f32 v105, v105
  v_exp_f32 v106, v106
  v_exp_f32 v107, v107
  v_cvt_pk_bf16_f32 v22, v76, v77
  v_cvt_pk_bf16_f32 v23, v78, v79
  v_cvt_pk_bf16_f32 v40, v104, v105
  v_cvt_pk_bf16_f32 v41, v106, v107
  buffer_load_dwordx4 v[76:79], v252, s[24:27], s55 offen offset:2048 sc1
  buffer_load_dwordx4 v[104:107], v252, s[24:27], s55 offen offset:3072 sc1
  v_fma_f32 v80, v80, s63, -v12
  v_fma_f32 v81, v81, s63, -v12
  v_fma_f32 v82, v82, s63, -v12
  v_fma_f32 v83, v83, s63, -v12
  v_exp_f32 v80, v80
  v_exp_f32 v81, v81
  v_exp_f32 v82, v82
  v_exp_f32 v83, v83
  v_fma_f32 v108, v108, s63, -v13
  v_fma_f32 v109, v109, s63, -v13
  v_fma_f32 v110, v110, s63, -v13
  v_fma_f32 v111, v111, s63, -v13
  v_exp_f32 v108, v108
  v_exp_f32 v109, v109
  v_exp_f32 v110, v110
  v_exp_f32 v111, v111
  v_cvt_pk_bf16_f32 v24, v80, v81
  v_cvt_pk_bf16_f32 v25, v82, v83
  v_cvt_pk_bf16_f32 v42, v108, v109
  v_cvt_pk_bf16_f32 v43, v110, v111
  s_mov_b32 s55, 18432
  buffer_load_dwordx4 v[80:83], v252, s[24:27], s55 offen offset:0 sc1
  buffer_load_dwordx4 v[108:111], v252, s[24:27], s55 offen offset:1024 sc1
  v_fma_f32 v84, v84, s63, -v12
  v_fma_f32 v85, v85, s63, -v12
  v_fma_f32 v86, v86, s63, -v12
  v_fma_f32 v87, v87, s63, -v12
  v_exp_f32 v84, v84
  v_exp_f32 v85, v85
  v_exp_f32 v86, v86
  v_exp_f32 v87, v87
  v_fma_f32 v112, v112, s63, -v13
  v_fma_f32 v113, v113, s63, -v13
  v_fma_f32 v114, v114, s63, -v13
  v_fma_f32 v115, v115, s63, -v13
  v_exp_f32 v112, v112
  v_exp_f32 v113, v113
  v_exp_f32 v114, v114
  v_exp_f32 v115, v115
  v_cvt_pk_bf16_f32 v26, v84, v85
  v_cvt_pk_bf16_f32 v27, v86, v87
  v_cvt_pk_bf16_f32 v44, v112, v113
  v_cvt_pk_bf16_f32 v45, v114, v115
  buffer_load_dwordx4 v[84:87], v252, s[24:27], s55 offen offset:2048 sc1
  buffer_load_dwordx4 v[112:115], v252, s[24:27], s55 offen offset:3072 sc1
  ds_read_b64_tr_b16 v[200:201], v244 offset:0
  ds_read_b64_tr_b16 v[202:203], v244 offset:768
  ds_read_b64_tr_b16 v[204:205], v245 offset:0
  ds_read_b64_tr_b16 v[206:207], v245 offset:768
  ds_read_b64_tr_b16 v[208:209], v244 offset:1536
  ds_read_b64_tr_b16 v[210:211], v244 offset:2304
  ds_read_b64_tr_b16 v[212:213], v245 offset:1536
  ds_read_b64_tr_b16 v[214:215], v245 offset:2304
  ds_read_b64_tr_b16 v[216:217], v244 offset:3072
  ds_read_b64_tr_b16 v[218:219], v244 offset:3840
  ds_read_b64_tr_b16 v[220:221], v245 offset:3072
  ds_read_b64_tr_b16 v[222:223], v245 offset:3840
  v_fma_f32 v88, v88, s63, -v12
  v_fma_f32 v89, v89, s63, -v12
  v_fma_f32 v90, v90, s63, -v12
  v_fma_f32 v91, v91, s63, -v12
  v_exp_f32 v88, v88
  v_exp_f32 v89, v89
  v_exp_f32 v90, v90
  v_exp_f32 v91, v91
  v_fma_f32 v116, v116, s63, -v13
  v_fma_f32 v117, v117, s63, -v13
  v_fma_f32 v118, v118, s63, -v13
  v_fma_f32 v119, v119, s63, -v13
  v_exp_f32 v116, v116
  v_exp_f32 v117, v117
  v_exp_f32 v118, v118
  v_exp_f32 v119, v119
  v_cvt_pk_bf16_f32 v28, v88, v89
  v_cvt_pk_bf16_f32 v29, v90, v91
  v_cvt_pk_bf16_f32 v46, v116, v117
  v_cvt_pk_bf16_f32 v47, v118, v119
  s_mov_b32 s55, 22528
  buffer_load_dwordx4 v[88:91], v252, s[24:27], s55 offen offset:0 sc1
  buffer_load_dwordx4 v[116:119], v252, s[24:27], s55 offen offset:1024 sc1
  s_cmp_ge_u32 s40, 4
  s_cbranch_scc1 M_l2
  s_barrier
M_l2:
  s_setprio 2
  s_cmp_lt_u32 s40, 4
  s_cbranch_scc1 M_pr3
  s_setprio 3
M_pr3:
  s_waitcnt lgkmcnt(10)
  v_mfma_f32_16x16x32_bf16 v[168:171], v[200:203], v[16:19], 0
  s_waitcnt lgkmcnt(8)
  ds_read_b64_tr_b16 v[224:225], v244 offset:4608
  ds_read_b64_tr_b16 v[226:227], v244 offset:5376
  v_mfma_f32_16x16x32_bf16 v[172:175], v[204:207], v[16:19], 0
  s_waitcnt lgkmcnt(8)
  ds_read_b64_tr_b16 v[228:229], v245 offset:4608
  v_mfma_f32_16x16x32_bf16 v[168:171], v[208:211], v[20:23], v[168:171]
  ds_read_b64_tr_b16 v[230:231], v245 offset:5376
  v_mfma_f32_16x16x32_bf16 v[176:179], v[208:211], v[32:35], 0
  s_waitcnt lgkmcnt(8)
  ds_read_b64_tr_b16 v[200:201], v244 offset:6144
  v_mfma_f32_16x16x32_bf16 v[172:175], v[212:215], v[20:23], v[172:175]
  ds_read_b64_tr_b16 v[202:203], v244 offset:6912
  v_mfma_f32_16x16x32_bf16 v[180:183], v[212:215], v[32:35], 0
  s_waitcnt lgkmcnt(8)
  ds_read_b64_tr_b16 v[204:205], v245 offset:6144
  v_mfma_f32_16x16x32_bf16 v[168:171], v[216:219], v[24:27], v[168:171]
  ds_read_b64_tr_b16 v[206:207], v245 offset:6912
  v_mfma_f32_16x16x32_bf16 v[176:179], v[216:219], v[36:39], v[176:179]
  s_waitcnt lgkmcnt(8)
  ds_read_b64_tr_b16 v[208:209], v246 offset:0
  v_mfma_f32_16x16x32_bf16 v[172:175], v[220:223], v[24:27], v[172:175]
  ds_read_b64_tr_b16 v[210:211], v246 offset:768
  v_mfma_f32_16x16x32_bf16 v[180:183], v[220:223], v[36:39], v[180:183]
  s_waitcnt lgkmcnt(8)
  ds_read_b64_tr_b16 v[212:213], v247 offset:0
  ds_read_b64_tr_b16 v[214:215], v247 offset:768
  v_mfma_f32_16x16x32_bf16 v[168:171], v[224:227], v[28:31], v[168:171]
  ds_read_b64_tr_b16 v[216:217], v246 offset:1536
  v_mfma_f32_16x16x32_bf16 v[176:179], v[224:227], v[40:43], v[176:179]
  s_waitcnt lgkmcnt(9)
  ds_read_b64_tr_b16 v[218:219], v246 offset:2304
  v_mfma_f32_16x16x32_bf16 v[172:175], v[228:231], v[28:31], v[172:175]
  ds_read_b64_tr_b16 v[220:221], v247 offset:1536
  v_mfma_f32_16x16x32_bf16 v[180:183], v[228:231], v[40:43], v[180:183]
  s_waitcnt lgkmcnt(9)
  ds_read_b64_tr_b16 v[222:223], v247 offset:2304
  v_mfma_f32_16x16x32_bf16 v[176:179], v[200:203], v[44:47], v[176:179]
  s_waitcnt lgkmcnt(8)
  ds_read_b64_tr_b16 v[224:225], v246 offset:3072
  v_mfma_f32_16x16x32_bf16 v[180:183], v[204:207], v[44:47], v[180:183]
  s_waitcnt lgkmcnt(7)
  ds_read_b64_tr_b16 v[226:227], v246 offset:3840
  v_mfma_f32_16x16x32_bf16 v[184:187], v[208:211], v[16:19], 0
  s_waitcnt lgkmcnt(6)
  ds_read_b64_tr_b16 v[228:229], v247 offset:3072
  v_mfma_f32_16x16x32_bf16 v[188:191], v[212:215], v[16:19], 0
  ds_read_b64_tr_b16 v[230:231], v247 offset:3840
  v_mfma_f32_16x16x32_bf16 v[56:59], v[16:19], v[48:51], 0
  s_waitcnt lgkmcnt(6)
  ds_read_b64_tr_b16 v[200:201], v246 offset:4608
  v_mfma_f32_16x16x32_bf16 v[184:187], v[216:219], v[20:23], v[184:187]
  ds_read_b64_tr_b16 v[202:203], v246 offset:5376
  ds_read_b64_tr_b16 v[204:205], v247 offset:4608
  v_mfma_f32_16x16x32_bf16 v[192:195], v[216:219], v[32:35], 0
  s_waitcnt lgkmcnt(7)
  ds_read_b64_tr_b16 v[206:207], v247 offset:5376
  v_cvt_pk_bf16_f32 v120, v168, v169
  v_mfma_f32_16x16x32_bf16 v[188:191], v[220:223], v[20:23], v[188:191]
  ds_read_b64_tr_b16 v[208:209], v246 offset:6144
  v_cvt_pk_bf16_f32 v121, v170, v171
  v_mfma_f32_16x16x32_bf16 v[196:199], v[220:223], v[32:35], 0
  s_waitcnt lgkmcnt(7)
  ds_read_b64_tr_b16 v[210:211], v246 offset:6912
  v_cvt_pk_bf16_f32 v122, v172, v173
  v_mfma_f32_16x16x32_bf16 v[184:187], v[224:227], v[24:27], v[184:187]
  ds_read_b64_tr_b16 v[212:213], v247 offset:6144
  v_cvt_pk_bf16_f32 v123, v174, v175
  v_mfma_f32_16x16x32_bf16 v[192:195], v[224:227], v[36:39], v[192:195]
  s_waitcnt lgkmcnt(7)
  ds_read_b64_tr_b16 v[214:215], v247 offset:6912
  v_cvt_pk_bf16_f32 v144, v176, v177
  v_mfma_f32_16x16x32_bf16 v[188:191], v[228:231], v[24:27], v[188:191]
  ds_read_b64_tr_b16 v[216:217], v248 offset:0
  v_cvt_pk_bf16_f32 v145, v178, v179
  v_mfma_f32_16x16x32_bf16 v[196:199], v[228:231], v[36:39], v[196:199]
  s_waitcnt lgkmcnt(7)
  ds_read_b64_tr_b16 v[218:219], v248 offset:768
  v_cvt_pk_bf16_f32 v146, v180, v181
  v_mfma_f32_16x16x32_bf16 v[184:187], v[200:203], v[28:31], v[184:187]
  ds_read_b64_tr_b16 v[220:221], v249 offset:0
  v_cvt_pk_bf16_f32 v147, v182, v183
  v_mfma_f32_16x16x32_bf16 v[192:195], v[200:203], v[40:43], v[192:195]
  s_waitcnt lgkmcnt(7)
  ds_read_b64_tr_b16 v[222:223], v249 offset:768
  v_mfma_f32_16x16x32_bf16 v[188:191], v[204:207], v[28:31], v[188:191]
  ds_read_b64_tr_b16 v[224:225], v248 offset:1536
  ds_read_b64_tr_b16 v[226:227], v248 offset:2304
  v_mfma_f32_16x16x32_bf16 v[196:199], v[204:207], v[40:43], v[196:199]
  s_waitcnt lgkmcnt(8)
  ds_read_b64_tr_b16 v[228:229], v249 offset:1536
  v_mfma_f32_16x16x32_bf16 v[192:195], v[208:211], v[44:47], v[192:195]
  s_waitcnt lgkmcnt(7)
  ds_read_b64_tr_b16 v[230:231], v249 offset:2304
  v_mfma_f32_16x16x32_bf16 v[196:199], v[212:215], v[44:47], v[196:199]
  ds_read_b64_tr_b16 v[200:201], v248 offset:3072
  v_mfma_f32_16x16x32_bf16 v[60:63], v[32:35], v[48:51], 0
  ds_read_b64_tr_b16 v[202:203], v248 offset:3840
  s_cmp_ge_u32 s40, 4
  s_cbranch_scc1 M_l3
  s_barrier
M_l3:
  s_waitcnt lgkmcnt(8)
  v_mfma_f32_16x16x32_bf16 v[168:171], v[216:219], v[16:19], 0
  s_waitcnt lgkmcnt(6)
  ds_read_b64_tr_b16 v[204:205], v249 offset:3072
  v_mfma_f32_16x16x32_bf16 v[172:175], v[220:223], v[16:19], 0
  ds_read_b64_tr_b16 v[206:207], v249 offset:3840
  v_mfma_f32_16x16x32_bf16 v[56:59], v[20:23], v[48:51], v[56:59]
  s_waitcnt lgkmcnt(6)
  ds_read_b64_tr_b16 v[208:209], v248 offset:4608
  v_mfma_f32_16x16x32_bf16 v[168:171], v[224:227], v[20:23], v[168:171]
  ds_read_b64_tr_b16 v[210:211], v248 offset:5376
  v_cvt_pk_bf16_f32 v124, v184, v185
  v_mfma_f32_16x16x32_bf16 v[176:179], v[224:227], v[32:35], 0
  s_waitcnt lgkmcnt(6)
  ds_read_b64_tr_b16 v[212:213], v249 offset:4608
  v_cvt_pk_bf16_f32 v125, v186, v187
  v_mfma_f32_16x16x32_bf16 v[172:175], v[228:231], v[20:23], v[172:175]
  ds_read_b64_tr_b16 v[214:215], v249 offset:5376
  ds_read_b64_tr_b16 v[216:217], v248 offset:6144
  v_mfma_f32_16x16x32_bf16 v[180:183], v[228:231], v[32:35], 0
  s_waitcnt lgkmcnt(7)
  ds_read_b64_tr_b16 v[218:219], v248 offset:6912
  v_cvt_pk_bf16_f32 v126, v188, v189
  v_mfma_f32_16x16x32_bf16 v[168:171], v[200:203], v[24:27], v[168:171]
  ds_read_b64_tr_b16 v[220:221], v249 offset:6144
  v_cvt_pk_bf16_f32 v127, v190, v191
  v_mfma_f32_16x16x32_bf16 v[176:179], v[200:203], v[36:39], v[176:179]
  s_waitcnt lgkmcnt(7)
  ds_read_b64_tr_b16 v[222:223], v249 offset:6912
  v_cvt_pk_bf16_f32 v148, v192, v193
  v_mfma_f32_16x16x32_bf16 v[172:175], v[204:207], v[24:27], v[172:175]
  ds_read_b64_tr_b16 v[224:225], v250 offset:0
  v_cvt_pk_bf16_f32 v149, v194, v195
  v_mfma_f32_16x16x32_bf16 v[180:183], v[204:207], v[36:39], v[180:183]
  s_waitcnt lgkmcnt(7)
  ds_read_b64_tr_b16 v[226:227], v250 offset:768
  v_cvt_pk_bf16_f32 v150, v196, v197
  v_mfma_f32_16x16x32_bf16 v[168:171], v[208:211], v[28:31], v[168:171]
  ds_read_b64_tr_b16 v[228:229], v251 offset:0
  v_cvt_pk_bf16_f32 v151, v198, v199
  v_mfma_f32_16x16x32_bf16 v[176:179], v[208:211], v[40:43], v[176:179]
  s_waitcnt lgkmcnt(7)
  ds_read_b64_tr_b16 v[230:231], v251 offset:768
  v_mfma_f32_16x16x32_bf16 v[172:175], v[212:215], v[28:31], v[172:175]
  ds_read_b64_tr_b16 v[200:201], v250 offset:1536
  v_mfma_f32_16x16x32_bf16 v[180:183], v[212:215], v[40:43], v[180:183]
  s_waitcnt lgkmcnt(7)
  ds_read_b64_tr_b16 v[202:203], v250 offset:2304
  v_mfma_f32_16x16x32_bf16 v[176:179], v[216:219], v[44:47], v[176:179]
  s_waitcnt lgkmcnt(6)
  ds_read_b64_tr_b16 v[204:205], v251 offset:1536
  ds_read_b64_tr_b16 v[206:207], v251 offset:2304
  v_mfma_f32_16x16x32_bf16 v[180:183], v[220:223], v[44:47], v[180:183]
  ds_read_b64_tr_b16 v[208:209], v250 offset:3072
  v_mfma_f32_16x16x32_bf16 v[60:63], v[36:39], v[48:51], v[60:63]
  s_waitcnt lgkmcnt(7)
  ds_read_b64_tr_b16 v[210:211], v250 offset:3840
  v_mfma_f32_16x16x32_bf16 v[184:187], v[224:227], v[16:19], 0
  s_waitcnt lgkmcnt(6)
  ds_read_b64_tr_b16 v[212:213], v251 offset:3072
  v_mfma_f32_16x16x32_bf16 v[188:191], v[228:231], v[16:19], 0
  ds_read_b64_tr_b16 v[214:215], v251 offset:3840
  v_mfma_f32_16x16x32_bf16 v[56:59], v[24:27], v[48:51], v[56:59]
  s_waitcnt lgkmcnt(6)
  ds_read_b64_tr_b16 v[216:217], v250 offset:4608
  v_mfma_f32_16x16x32_bf16 v[184:187], v[200:203], v[20:23], v[184:187]
  ds_read_b64_tr_b16 v[218:219], v250 offset:5376
  v_cvt_pk_bf16_f32 v128, v168, v169
  v_mfma_f32_16x16x32_bf16 v[192:195], v[200:203], v[32:35], 0
  s_waitcnt lgkmcnt(6)
  ds_read_b64_tr_b16 v[220:221], v251 offset:4608
  v_cvt_pk_bf16_f32 v129, v170, v171
  v_mfma_f32_16x16x32_bf16 v[188:191], v[204:207], v[20:23], v[188:191]
  ds_read_b64_tr_b16 v[222:223], v251 offset:5376
  v_cvt_pk_bf16_f32 v130, v172, v173
  v_mfma_f32_16x16x32_bf16 v[196:199], v[204:207], v[32:35], 0
  s_waitcnt lgkmcnt(6)
  ds_read_b64_tr_b16 v[224:225], v250 offset:6144
  ds_read_b64_tr_b16 v[226:227], v250 offset:6912
  v_mfma_f32_16x16x32_bf16 v[184:187], v[208:211], v[24:27], v[184:187]
  ds_read_b64_tr_b16 v[228:229], v251 offset:6144
  v_cvt_pk_bf16_f32 v131, v174, v175
  v_mfma_f32_16x16x32_bf16 v[192:195], v[208:211], v[36:39], v[192:195]
  s_waitcnt lgkmcnt(7)
  ds_read_b64_tr_b16 v[230:231], v251 offset:6912
  v_cvt_pk_bf16_f32 v152, v176, v177
  v_mfma_f32_16x16x32_bf16 v[188:191], v[212:215], v[24:27], v[188:191]
  ds_read_b64_tr_b16 v[200:201], v244 offset:256
  v_cvt_pk_bf16_f32 v153, v178, v179
  v_mfma_f32_16x16x32_bf16 v[196:199], v[212:215], v[36:39], v[196:199]
  s_waitcnt lgkmcnt(7)
  ds_read_b64_tr_b16 v[202:203], v244 offset:1024
  v_cvt_pk_bf16_f32 v154, v180, v181
  v_mfma_f32_16x16x32_bf16 v[184:187], v[216:219], v[28:31], v[184:187]
  ds_read_b64_tr_b16 v[204:205], v245 offset:256
  v_cvt_pk_bf16_f32 v155, v182, v183
  v_mfma_f32_16x16x32_bf16 v[192:195], v[216:219], v[40:43], v[192:195]
  s_waitcnt lgkmcnt(7)
  ds_read_b64_tr_b16 v[206:207], v245 offset:1024
  v_mfma_f32_16x16x32_bf16 v[188:191], v[220:223], v[28:31], v[188:191]
  ds_read_b64_tr_b16 v[208:209], v244 offset:1792
  v_mfma_f32_16x16x32_bf16 v[196:199], v[220:223], v[40:43], v[196:199]
  s_waitcnt lgkmcnt(7)
  ds_read_b64_tr_b16 v[210:211], v244 offset:2560
  v_mfma_f32_16x16x32_bf16 v[192:195], v[224:227], v[44:47], v[192:195]
  s_waitcnt lgkmcnt(6)
  ds_read_b64_tr_b16 v[212:213], v245 offset:1792
  v_mfma_f32_16x16x32_bf16 v[196:199], v[228:231], v[44:47], v[196:199]
  ds_read_b64_tr_b16 v[214:215], v245 offset:2560
  ds_read_b64_tr_b16 v[216:217], v244 offset:3328
  v_mfma_f32_16x16x32_bf16 v[60:63], v[40:43], v[48:51], v[60:63]
  s_waitcnt lgkmcnt(7)
  ds_read_b64_tr_b16 v[218:219], v244 offset:4096
  v_mfma_f32_16x16x32_bf16 v[168:171], v[200:203], v[16:19], 0
  s_waitcnt lgkmcnt(6)
  ds_read_b64_tr_b16 v[220:221], v245 offset:3328
  v_mfma_f32_16x16x32_bf16 v[172:175], v[204:207], v[16:19], 0
  ds_read_b64_tr_b16 v[222:223], v245 offset:4096
  v_mfma_f32_16x16x32_bf16 v[56:59], v[28:31], v[48:51], v[56:59]
  s_waitcnt lgkmcnt(6)
  ds_read_b64_tr_b16 v[224:225], v244 offset:4864
  v_mfma_f32_16x16x32_bf16 v[168:171], v[208:211], v[20:23], v[168:171]
  ds_read_b64_tr_b16 v[226:227], v244 offset:5632
  v_cvt_pk_bf16_f32 v132, v184, v185
  v_mfma_f32_16x16x32_bf16 v[176:179], v[208:211], v[32:35], 0
  s_waitcnt lgkmcnt(6)
  ds_read_b64_tr_b16 v[228:229], v245 offset:4864
  v_cvt_pk_bf16_f32 v133, v186, v187
  v_mfma_f32_16x16x32_bf16 v[172:175], v[212:215], v[20:23], v[172:175]
  ds_read_b64_tr_b16 v[230:231], v245 offset:5632
  v_cvt_pk_bf16_f32 v134, v188, v189
  v_mfma_f32_16x16x32_bf16 v[180:183], v[212:215], v[32:35], 0
  s_waitcnt lgkmcnt(6)
  ds_read_b64_tr_b16 v[200:201], v244 offset:6400
  v_cvt_pk_bf16_f32 v135, v190, v191
  v_mfma_f32_16x16x32_bf16 v[168:171], v[216:219], v[24:27], v[168:171]
  ds_read_b64_tr_b16 v[202:203], v244 offset:7168
  v_cvt_pk_bf16_f32 v156, v192, v193
  v_mfma_f32_16x16x32_bf16 v[176:179], v[216:219], v[36:39], v[176:179]
  s_waitcnt lgkmcnt(6)
  ds_read_b64_tr_b16 v[204:205], v245 offset:6400
  ds_read_b64_tr_b16 v[206:207], v245 offset:7168
  v_mfma_f32_16x16x32_bf16 v[172:175], v[220:223], v[24:27], v[172:175]
  ds_read_b64_tr_b16 v[208:209], v246 offset:256
  v_cvt_pk_bf16_f32 v157, v194, v195
  v_mfma_f32_16x16x32_bf16 v[180:183], v[220:223], v[36:39], v[180:183]
  s_waitcnt lgkmcnt(7)
  ds_read_b64_tr_b16 v[210:211], v246 offset:1024
  v_cvt_pk_bf16_f32 v158, v196, v197
  v_mfma_f32_16x16x32_bf16 v[168:171], v[224:227], v[28:31], v[168:171]
  ds_read_b64_tr_b16 v[212:213], v247 offset:256
  v_cvt_pk_bf16_f32 v159, v198, v199
  v_mfma_f32_16x16x32_bf16 v[176:179], v[224:227], v[40:43], v[176:179]
  s_waitcnt lgkmcnt(7)
  ds_read_b64_tr_b16 v[214:215], v247 offset:1024
  v_mfma_f32_16x16x32_bf16 v[172:175], v[228:231], v[28:31], v[172:175]
  ds_read_b64_tr_b16 v[216:217], v246 offset:1792
  v_mfma_f32_16x16x32_bf16 v[180:183], v[228:231], v[40:43], v[180:183]
  s_waitcnt lgkmcnt(7)
  ds_read_b64_tr_b16 v[218:219], v246 offset:2560
  v_mfma_f32_16x16x32_bf16 v[176:179], v[200:203], v[44:47], v[176:179]
  s_waitcnt lgkmcnt(6)
  ds_read_b64_tr_b16 v[220:221], v247 offset:1792
  v_mfma_f32_16x16x32_bf16 v[180:183], v[204:207], v[44:47], v[180:183]
  ds_read_b64_tr_b16 v[222:223], v247 offset:2560
  v_mfma_f32_16x16x32_bf16 v[60:63], v[44:47], v[48:51], v[60:63]
  s_waitcnt lgkmcnt(6)
  ds_read_b64_tr_b16 v[224:225], v246 offset:3328
  v_mfma_f32_16x16x32_bf16 v[184:187], v[208:211], v[16:19], 0
  s_waitcnt lgkmcnt(5)
  ds_read_b64_tr_b16 v[226:227], v246 offset:4096
  ds_read_b64_tr_b16 v[228:229], v247 offset:3328
  v_mfma_f32_16x16x32_bf16 v[188:191], v[212:215], v[16:19], 0
  s_waitcnt lgkmcnt(5)
  ds_read_b64_tr_b16 v[230:231], v247 offset:4096
  v_mfma_f32_16x16x32_bf16 v[184:187], v[216:219], v[20:23], v[184:187]
  ds_read_b64_tr_b16 v[200:201], v246 offset:4864
  v_mfma_f32_16x16x32_bf16 v[192:195], v[216:219], v[32:35], 0
  s_waitcnt lgkmcnt(5)
  ds_read_b64_tr_b16 v[202:203], v246 offset:5632
  v_cvt_pk_bf16_f32 v136, v168, v169
  v_mfma_f32_16x16x32_bf16 v[188:191], v[220:223], v[20:23], v[188:191]
  ds_read_b64_tr_b16 v[204:205], v247 offset:4864
  v_cvt_pk_bf16_f32 v137, v170, v171
  v_mfma_f32_16x16x32_bf16 v[196:199], v[220:223], v[32:35], 0
  s_waitcnt lgkmcnt(5)
  ds_read_b64_tr_b16 v[206:207], v247 offset:5632
  v_cvt_pk_bf16_f32 v138, v172, v173
  v_mfma_f32_16x16x32_bf16 v[184:187], v[224:227], v[24:27], v[184:187]
  ds_read_b64_tr_b16 v[208:209], v246 offset:6400
  v_cvt_pk_bf16_f32 v139, v174, v175
  v_mfma_f32_16x16x32_bf16 v[192:195], v[224:227], v[36:39], v[192:195]
  s_waitcnt lgkmcnt(5)
  ds_read_b64_tr_b16 v[210:211], v246 offset:7168
  v_cvt_pk_bf16_f32 v160, v176, v177
  v_mfma_f32_16x16x32_bf16 v[188:191], v[228:231], v[24:27], v[188:191]
  ds_read_b64_tr_b16 v[212:213], v247 offset:6400
  v_cvt_pk_bf16_f32 v161, v178, v179
  v_mfma_f32_16x16x32_bf16 v[196:199], v[228:231], v[36:39], v[196:199]
  s_waitcnt lgkmcnt(5)
  ds_read_b64_tr_b16 v[214:215], v247 offset:7168
  v_cvt_pk_bf16_f32 v162, v180, v181
  v_mfma_f32_16x16x32_bf16 v[184:187], v[200:203], v[28:31], v[184:187]
  v_cvt_pk_bf16_f32 v163, v182, v183
  v_mfma_f32_16x16x32_bf16 v[192:195], v[200:203], v[40:43], v[192:195]
  s_waitcnt lgkmcnt(4)
  v_mfma_f32_16x16x32_bf16 v[188:191], v[204:207], v[28:31], v[188:191]
  v_mfma_f32_16x16x32_bf16 v[196:199], v[204:207], v[40:43], v[196:199]
  s_waitcnt lgkmcnt(2)
  v_mfma_f32_16x16x32_bf16 v[192:195], v[208:211], v[44:47], v[192:195]
  s_waitcnt lgkmcnt(0)
  v_mfma_f32_16x16x32_bf16 v[196:199], v[212:215], v[44:47], v[196:199]
  s_waitcnt vmcnt(0)
  s_cmp_lt_u32 s40, 4
  s_cbranch_scc1 M_e3
  s_barrier
  s_mul_i32 s55, s40, 9216
  s_sub_u32 s55, s55, 24576
  s_add_u32 s59, s55, 24576
  s_mov_b32 m0, s55
  s_add_u32 s55, s55, 3072
  buffer_load_dwordx4 v252, s[24:27], s59 offen offset:0 sc1 lds
  buffer_load_dwordx4 v252, s[24:27], s59 offen offset:1024 sc1 lds
  buffer_load_dwordx4 v252, s[24:27], s59 offen offset:2048 sc1 lds
  s_add_u32 s59, s59, 3072
  s_mov_b32 m0, s55
  s_add_u32 s55, s55, 3072
  buffer_load_dwordx4 v252, s[24:27], s59 offen offset:0 sc1 lds
  buffer_load_dwordx4 v252, s[24:27], s59 offen offset:1024 sc1 lds
  buffer_load_dwordx4 v252, s[24:27], s59 offen offset:2048 sc1 lds
  s_add_u32 s59, s59, 3072
  s_mov_b32 m0, s55
  s_add_u32 s55, s55, 3072
  buffer_load_dwordx4 v252, s[24:27], s59 offen offset:0 sc1 lds
  buffer_load_dwordx4 v252, s[24:27], s59 offen offset:1024 sc1 lds
  buffer_load_dwordx4 v252, s[24:27], s59 offen offset:2048 sc1 lds
  s_add_u32 s59, s59, 3072
M_e3:
  v_cvt_pk_bf16_f32 v140, v184, v185
  v_cvt_pk_bf16_f32 v141, v186, v187
  v_cvt_pk_bf16_f32 v142, v188, v189
  v_cvt_pk_bf16_f32 v143, v190, v191
  v_cvt_pk_bf16_f32 v164, v192, v193
  v_cvt_pk_bf16_f32 v165, v194, v195
  v_cvt_pk_bf16_f32 v166, v196, v197
  v_cvt_pk_bf16_f32 v167, v198, v199
  ds_read_b128 v[200:203], v253 offset:0
  ds_read_b128 v[204:207], v253 offset:1024
  ds_read_b128 v[208:211], v253 offset:2048
  ds_read_b128 v[212:215], v253 offset:3072
  s_waitcnt lgkmcnt(3)
  v_mfma_f32_16x16x32_bf16 v[168:171], v[120:123], v[200:203], 0
  ds_read_b128 v[216:219], v253 offset:4096
  v_rcp_f32 v56, v56
  v_mfma_f32_16x16x32_bf16 v[176:179], v[144:147], v[200:203], 0
  s_waitcnt lgkmcnt(3)
  v_rcp_f32 v57, v57
  v_rcp_f32 v58, v58
  v_mfma_f32_16x16x32_bf16 v[172:175], v[120:123], v[204:207], 0
  ds_read_b128 v[220:223], v253 offset:5120
  v_rcp_f32 v59, v59
  v_mfma_f32_16x16x32_bf16 v[180:183], v[144:147], v[204:207], 0
  s_waitcnt lgkmcnt(3)
  v_rcp_f32 v60, v60
  v_rcp_f32 v61, v61
  v_mfma_f32_16x16x32_bf16 v[168:171], v[124:127], v[208:211], v[168:171]
  ds_read_b128 v[224:227], v253 offset:6144
  v_rcp_f32 v62, v62
  v_mfma_f32_16x16x32_bf16 v[176:179], v[148:151], v[208:211], v[176:179]
  s_waitcnt lgkmcnt(3)
  v_rcp_f32 v63, v63
  v_mfma_f32_16x16x32_bf16 v[172:175], v[124:127], v[212:215], v[172:175]
  ds_read_b128 v[228:231], v253 offset:7168
  v_mfma_f32_16x16x32_bf16 v[180:183], v[148:151], v[212:215], v[180:183]
  s_waitcnt lgkmcnt(3)
  v_mfma_f32_16x16x32_bf16 v[168:171], v[128:131], v[216:219], v[168:171]
  ds_read_b128 v[200:203], v253 offset:8192
  v_mfma_f32_16x16x32_bf16 v[176:179], v[152:155], v[216:219], v[176:179]
  s_waitcnt lgkmcnt(3)
  v_mfma_f32_16x16x32_bf16 v[172:175], v[128:131], v[220:223], v[172:175]
  ds_read_b128 v[204:207], v253 offset:9216
  v_mfma_f32_16x16x32_bf16 v[180:183], v[152:155], v[220:223], v[180:183]
  s_waitcnt lgkmcnt(3)
  v_mfma_f32_16x16x32_bf16 v[168:171], v[132:135], v[224:227], v[168:171]
  v_mfma_f32_16x16x32_bf16 v[176:179], v[156:159], v[224:227], v[176:179]
  s_waitcnt lgkmcnt(2)
  v_mfma_f32_16x16x32_bf16 v[172:175], v[132:135], v[228:231], v[172:175]
  v_mfma_f32_16x16x32_bf16 v[180:183], v[156:159], v[228:231], v[180:183]
  s_waitcnt lgkmcnt(1)
  v_mfma_f32_16x16x32_bf16 v[168:171], v[136:139], v[200:203], v[168:171]
  v_mfma_f32_16x16x32_bf16 v[176:179], v[160:163], v[200:203], v[176:179]
  s_waitcnt lgkmcnt(0)
  v_mfma_f32_16x16x32_bf16 v[172:175], v[136:139], v[204:207], v[172:175]
  v_mfma_f32_16x16x32_bf16 v[180:183], v[160:163], v[204:207], v[180:183]
  v_mfma_f32_16x16x32_bf16 v[168:171], v[140:143], v[64:67], v[168:171]
  v_mfma_f32_16x16x32_bf16 v[176:179], v[164:167], v[64:67], v[176:179]
  v_mfma_f32_16x16x32_bf16 v[172:175], v[140:143], v[92:95], v[172:175]
  v_mfma_f32_16x16x32_bf16 v[180:183], v[164:167], v[92:95], v[180:183]
  v_mfma_f32_16x16x32_bf16 v[184:187], v[120:123], v[68:71], 0
  v_mfma_f32_16x16x32_bf16 v[192:195], v[144:147], v[68:71], 0
  v_mfma_f32_16x16x32_bf16 v[188:191], v[120:123], v[96:99], 0
  s_nop 1
  v_mul_f32 v168, v168, v56
  s_nop 0
  v_mul_f32 v172, v172, v56
  v_mfma_f32_16x16x32_bf16 v[196:199], v[144:147], v[96:99], 0
  v_cvt_pk_bf16_f32 v16, v168, v172
  v_mul_f32 v169, v169, v57
  v_mfma_f32_16x16x32_bf16 v[184:187], v[124:127], v[72:75], v[184:187]
  v_mul_f32 v173, v173, v57
  v_cvt_pk_bf16_f32 v18, v169, v173
  v_mfma_f32_16x16x32_bf16 v[192:195], v[148:151], v[72:75], v[192:195]
  v_mul_f32 v170, v170, v58
  v_mul_f32 v174, v174, v58
  v_mfma_f32_16x16x32_bf16 v[188:191], v[124:127], v[100:103], v[188:191]
  v_cvt_pk_bf16_f32 v20, v170, v174
  v_mul_f32 v171, v171, v59
  v_mfma_f32_16x16x32_bf16 v[196:199], v[148:151], v[100:103], v[196:199]
  v_mul_f32 v175, v175, v59
  v_cvt_pk_bf16_f32 v22, v171, v175
  v_mfma_f32_16x16x32_bf16 v[184:187], v[128:131], v[76:79], v[184:187]
  v_mul_f32 v176, v176, v60
  v_mul_f32 v180, v180, v60
  v_mfma_f32_16x16x32_bf16 v[192:195], v[152:155], v[76:79], v[192:195]
  v_cvt_pk_bf16_f32 v24, v176, v180
  v_mul_f32 v177, v177, v61
  v_mfma_f32_16x16x32_bf16 v[188:191], v[128:131], v[104:107], v[188:191]
  v_mul_f32 v181, v181, v61
  v_cvt_pk_bf16_f32 v26, v177, v181
  v_mfma_f32_16x16x32_bf16 v[196:199], v[152:155], v[104:107], v[196:199]
  v_mul_f32 v178, v178, v62
  v_mul_f32 v182, v182, v62
  v_mfma_f32_16x16x32_bf16 v[184:187], v[132:135], v[80:83], v[184:187]
  v_cvt_pk_bf16_f32 v28, v178, v182
  v_mul_f32 v179, v179, v63
  v_mfma_f32_16x16x32_bf16 v[192:195], v[156:159], v[80:83], v[192:195]
  v_mul_f32 v183, v183, v63
  v_cvt_pk_bf16_f32 v30, v179, v183
  v_mfma_f32_16x16x32_bf16 v[188:191], v[132:135], v[108:111], v[188:191]
  v_mfma_f32_16x16x32_bf16 v[196:199], v[156:159], v[108:111], v[196:199]
  s_cmp_lt_u32 s40, 4
  s_cbranch_scc1 M_e4
  s_waitcnt vmcnt(0)
  s_barrier
M_e4:
  v_mfma_f32_16x16x32_bf16 v[184:187], v[136:139], v[84:87], v[184:187]
  ds_read_b128 v[200:203], v252 offset:0
  v_mfma_f32_16x16x32_bf16 v[192:195], v[160:163], v[84:87], v[192:195]
  v_mfma_f32_16x16x32_bf16 v[188:191], v[136:139], v[112:115], v[188:191]
  ds_read_b128 v[204:207], v252 offset:1024
  v_mfma_f32_16x16x32_bf16 v[196:199], v[160:163], v[112:115], v[196:199]
  v_mfma_f32_16x16x32_bf16 v[184:187], v[140:143], v[88:91], v[184:187]
  ds_read_b128 v[208:211], v252 offset:2048
  v_mfma_f32_16x16x32_bf16 v[192:195], v[164:167], v[88:91], v[192:195]
  v_mfma_f32_16x16x32_bf16 v[188:191], v[140:143], v[116:119], v[188:191]
  ds_read_b128 v[212:215], v252 offset:3072
  v_mfma_f32_16x16x32_bf16 v[196:199], v[164:167], v[116:119], v[196:199]
  s_waitcnt lgkmcnt(3)
  v_mfma_f32_16x16x32_bf16 v[168:171], v[120:123], v[200:203], 0
  ds_read_b128 v[216:219], v252 offset:4096
  v_mfma_f32_16x16x32_bf16 v[176:179], v[144:147], v[200:203], 0
  s_waitcnt lgkmcnt(3)
  v_mfma_f32_16x16x32_bf16 v[172:175], v[120:123], v[204:207], 0
  ds_read_b128 v[220:223], v252 offset:5120
  v_mul_f32 v184, v184, v56
  v_mfma_f32_16x16x32_bf16 v[180:183], v[144:147], v[204:207], 0
  s_waitcnt lgkmcnt(3)
  v_mul_f32 v188, v188, v56
  v_cvt_pk_bf16_f32 v17, v184, v188
  v_mfma_f32_16x16x32_bf16 v[168:171], v[124:127], v[208:211], v[168:171]
  ds_read_b128 v[224:227], v252 offset:6144
  v_mul_f32 v185, v185, v57
  v_mfma_f32_16x16x32_bf16 v[176:179], v[148:151], v[208:211], v[176:179]
  s_waitcnt lgkmcnt(3)
  buffer_store_dwordx2 v[16:17], v4, s[20:23], 0 offen offset:0 sc1
  v_mul_f32 v189, v189, v57
  v_mfma_f32_16x16x32_bf16 v[172:175], v[124:127], v[212:215], v[172:175]
  ds_read_b128 v[228:231], v252 offset:7168
  v_cvt_pk_bf16_f32 v19, v185, v189
  v_mfma_f32_16x16x32_bf16 v[180:183], v[148:151], v[212:215], v[180:183]
  s_waitcnt lgkmcnt(3)
  v_mul_f32 v186, v186, v58
  v_mul_f32 v190, v190, v58
  v_mfma_f32_16x16x32_bf16 v[168:171], v[128:131], v[216:219], v[168:171]
  ds_read_b128 v[200:203], v252 offset:8192
  v_cvt_pk_bf16_f32 v21, v186, v190
  v_mfma_f32_16x16x32_bf16 v[176:179], v[152:155], v[216:219], v[176:179]
  s_waitcnt lgkmcnt(3)
  buffer_store_dwordx2 v[18:19], v5, s[20:23], 0 offen offset:0 sc1
  v_mul_f32 v187, v187, v59
  v_mfma_f32_16x16x32_bf16 v[172:175], v[128:131], v[220:223], v[172:175]
  ds_read_b128 v[204:207], v252 offset:9216
  v_mul_f32 v191, v191, v59
  v_mfma_f32_16x16x32_bf16 v[180:183], v[152:155], v[220:223], v[180:183]
  s_waitcnt lgkmcnt(3)
  v_cvt_pk_bf16_f32 v23, v187, v191
  v_mul_f32 v192, v192, v60
  v_mfma_f32_16x16x32_bf16 v[168:171], v[132:135], v[224:227], v[168:171]
  ds_read_b128 v[208:211], v252 offset:10240
  v_mul_f32 v196, v196, v60
  v_mfma_f32_16x16x32_bf16 v[176:179], v[156:159], v[224:227], v[176:179]
  s_waitcnt lgkmcnt(3)
  buffer_store_dwordx2 v[20:21], v6, s[20:23], 0 offen offset:0 sc1
  v_cvt_pk_bf16_f32 v25, v192, v196
  v_mfma_f32_16x16x32_bf16 v[172:175], v[132:135], v[228:231], v[172:175]
  ds_read_b128 v[212:215], v252 offset:11264
  v_mul_f32 v193, v193, v61
  v_mfma_f32_16x16x32_bf16 v[180:183], v[156:159], v[228:231], v[180:183]
  s_waitcnt lgkmcnt(3)
  v_mul_f32 v197, v197, v61
  v_cvt_pk_bf16_f32 v27, v193, v197
  v_mfma_f32_16x16x32_bf16 v[168:171], v[136:139], v[200:203], v[168:171]
  ds_read_b128 v[216:219], v252 offset:12288
  v_mul_f32 v194, v194, v62
  v_mfma_f32_16x16x32_bf16 v[176:179], v[160:163], v[200:203], v[176:179]
  s_waitcnt lgkmcnt(3)
  buffer_store_dwordx2 v[22:23], v7, s[20:23], 0 offen offset:0 sc1
  v_mul_f32 v198, v198, v62
  v_mfma_f32_16x16x32_bf16 v[172:175], v[136:139], v[204:207], v[172:175]
  ds_read_b128 v[220:223], v252 offset:13312
  v_cvt_pk_bf16_f32 v29, v194, v198
  v_mfma_f32_16x16x32_bf16 v[180:183], v[160:163], v[204:207], v[180:183]
  s_waitcnt lgkmcnt(3)
  v_mul_f32 v195, v195, v63
  v_mul_f32 v199, v199, v63
  v_mfma_f32_16x16x32_bf16 v[168:171], v[140:143], v[208:211], v[168:171]
  ds_read_b128 v[224:227], v252 offset:14336
  v_cvt_pk_bf16_f32 v31, v195, v199
  v_mfma_f32_16x16x32_bf16 v[176:179], v[164:167], v[208:211], v[176:179]
  s_waitcnt lgkmcnt(3)
  buffer_store_dwordx2 v[24:25], v8, s[20:23], 0 offen offset:0 sc1
  v_mfma_f32_16x16x32_bf16 v[172:175], v[140:143], v[212:215], v[172:175]
  ds_read_b128 v[228:231], v252 offset:15360
  v_mfma_f32_16x16x32_bf16 v[180:183], v[164:167], v[212:215], v[180:183]
  s_waitcnt lgkmcnt(3)
  v_mfma_f32_16x16x32_bf16 v[184:187], v[120:123], v[216:219], 0
  ds_read_b128 v[200:203], v252 offset:16384
  v_mfma_f32_16x16x32_bf16 v[192:195], v[144:147], v[216:219], 0
  s_waitcnt lgkmcnt(3)
  buffer_store_dwordx2 v[26:27], v9, s[20:23], 0 offen offset:0 sc1
  v_mfma_f32_16x16x32_bf16 v[188:191], v[120:123], v[220:223], 0
  ds_read_b128 v[204:207], v252 offset:17408
  v_mul_f32 v168, v168, v56
  v_mfma_f32_16x16x32_bf16 v[196:199], v[144:147], v[220:223], 0
  s_waitcnt lgkmcnt(3)
  v_mul_f32 v172, v172, v56
  v_cvt_pk_bf16_f32 v16, v168, v172
  v_mfma_f32_16x16x32_bf16 v[184:187], v[124:127], v[224:227], v[184:187]
  ds_read_b128 v[208:211], v252 offset:18432
  v_mul_f32 v169, v169, v57
  v_mfma_f32_16x16x32_bf16 v[192:195], v[148:151], v[224:227], v[192:195]
  s_waitcnt lgkmcnt(3)
  buffer_store_dwordx2 v[28:29], v10, s[20:23], 0 offen offset:0 sc1
  v_mul_f32 v173, v173, v57
  v_mfma_f32_16x16x32_bf16 v[188:191], v[124:127], v[228:231], v[188:191]
  ds_read_b128 v[212:215], v252 offset:19456
  v_cvt_pk_bf16_f32 v18, v169, v173
  v_mfma_f32_16x16x32_bf16 v[196:199], v[148:151], v[228:231], v[196:199]
  s_waitcnt lgkmcnt(3)
  v_mul_f32 v170, v170, v58
  v_mul_f32 v174, v174, v58
  v_mfma_f32_16x16x32_bf16 v[184:187], v[128:131], v[200:203], v[184:187]
  ds_read_b128 v[216:219], v252 offset:20480
  v_cvt_pk_bf16_f32 v20, v170, v174
  v_mfma_f32_16x16x32_bf16 v[192:195], v[152:155], v[200:203], v[192:195]
  s_waitcnt lgkmcnt(3)
  buffer_store_dwordx2 v[30:31], v11, s[20:23], 0 offen offset:0 sc1
  v_mul_f32 v171, v171, v59
  v_mfma_f32_16x16x32_bf16 v[188:191], v[128:131], v[204:207], v[188:191]
  ds_read_b128 v[220:223], v252 offset:21504
  v_mul_f32 v175, v175, v59
  v_mfma_f32_16x16x32_bf16 v[196:199], v[152:155], v[204:207], v[196:199]
  s_waitcnt lgkmcnt(3)
  v_cvt_pk_bf16_f32 v22, v171, v175
  v_mul_f32 v176, v176, v60
  v_mfma_f32_16x16x32_bf16 v[184:187], v[132:135], v[208:211], v[184:187]
  ds_read_b128 v[224:227], v252 offset:22528
  v_mul_f32 v180, v180, v60
  v_mfma_f32_16x16x32_bf16 v[192:195], v[156:159], v[208:211], v[192:195]
  s_waitcnt lgkmcnt(3)
  v_cvt_pk_bf16_f32 v24, v176, v180
  v_mul_f32 v177, v177, v61
  v_mfma_f32_16x16x32_bf16 v[188:191], v[132:135], v[212:215], v[188:191]
  ds_read_b128 v[228:231], v252 offset:23552
  v_mul_f32 v181, v181, v61
  v_mfma_f32_16x16x32_bf16 v[196:199], v[156:159], v[212:215], v[196:199]
  s_waitcnt lgkmcnt(3)
  v_cvt_pk_bf16_f32 v26, v177, v181
  v_mul_f32 v178, v178, v62
  v_mfma_f32_16x16x32_bf16 v[184:187], v[136:139], v[216:219], v[184:187]
  ds_read_b128 v[200:203], v252 offset:24576
  v_mul_f32 v182, v182, v62
  v_mfma_f32_16x16x32_bf16 v[192:195], v[160:163], v[216:219], v[192:195]
  s_waitcnt lgkmcnt(3)
  v_cvt_pk_bf16_f32 v28, v178, v182
  v_mul_f32 v179, v179, v63
  v_mfma_f32_16x16x32_bf16 v[188:191], v[136:139], v[220:223], v[188:191]
  ds_read_b128 v[204:207], v252 offset:25600
  v_mul_f32 v183, v183, v63
  v_mfma_f32_16x16x32_bf16 v[196:199], v[160:163], v[220:223], v[196:199]
  s_waitcnt lgkmcnt(3)
  v_cvt_pk_bf16_f32 v30, v179, v183
  v_mfma_f32_16x16x32_bf16 v[184:187], v[140:143], v[224:227], v[184:187]
  ds_read_b128 v[208:211], v252 offset:26624
  v_mfma_f32_16x16x32_bf16 v[192:195], v[164:167], v[224:227], v[192:195]
  s_waitcnt lgkmcnt(3)
  v_mfma_f32_16x16x32_bf16 v[188:191], v[140:143], v[228:231], v[188:191]
  ds_read_b128 v[212:215], v252 offset:27648
  v_mfma_f32_16x16x32_bf16 v[196:199], v[164:167], v[228:231], v[196:199]
  s_waitcnt lgkmcnt(3)
  v_mfma_f32_16x16x32_bf16 v[168:171], v[120:123], v[200:203], 0
  ds_read_b128 v[216:219], v252 offset:28672
  v_mfma_f32_16x16x32_bf16 v[176:179], v[144:147], v[200:203], 0
  s_waitcnt lgkmcnt(3)
  v_mfma_f32_16x16x32_bf16 v[172:175], v[120:123], v[204:207], 0
  ds_read_b128 v[220:223], v252 offset:29696
  v_mul_f32 v184, v184, v56
  v_mfma_f32_16x16x32_bf16 v[180:183], v[144:147], v[204:207], 0
  s_waitcnt lgkmcnt(3)
  v_mul_f32 v188, v188, v56
  v_cvt_pk_bf16_f32 v17, v184, v188
  v_mfma_f32_16x16x32_bf16 v[168:171], v[124:127], v[208:211], v[168:171]
  ds_read_b128 v[224:227], v252 offset:30720
  v_mul_f32 v185, v185, v57
  v_mfma_f32_16x16x32_bf16 v[176:179], v[148:151], v[208:211], v[176:179]
  s_waitcnt lgkmcnt(3)
  buffer_store_dwordx2 v[16:17], v4, s[20:23], 0 offen offset:128 sc1
  v_mul_f32 v189, v189, v57
  v_mfma_f32_16x16x32_bf16 v[172:175], v[124:127], v[212:215], v[172:175]
  ds_read_b128 v[228:231], v252 offset:31744
  v_cvt_pk_bf16_f32 v19, v185, v189
  v_mfma_f32_16x16x32_bf16 v[180:183], v[148:151], v[212:215], v[180:183]
  s_waitcnt lgkmcnt(3)
  v_mul_f32 v186, v186, v58
  v_mul_f32 v190, v190, v58
  v_mfma_f32_16x16x32_bf16 v[168:171], v[128:131], v[216:219], v[168:171]
  ds_read_b128 v[200:203], v252 offset:32768
  v_cvt_pk_bf16_f32 v21, v186, v190
  v_mfma_f32_16x16x32_bf16 v[176:179], v[152:155], v[216:219], v[176:179]
  s_waitcnt lgkmcnt(3)
  buffer_store_dwordx2 v[18:19], v5, s[20:23], 0 offen offset:128 sc1
  v_mul_f32 v187, v187, v59
  v_mfma_f32_16x16x32_bf16 v[172:175], v[128:131], v[220:223], v[172:175]
  ds_read_b128 v[204:207], v252 offset:33792
  v_mul_f32 v191, v191, v59
  v_mfma_f32_16x16x32_bf16 v[180:183], v[152:155], v[220:223], v[180:183]
  s_waitcnt lgkmcnt(3)
  v_cvt_pk_bf16_f32 v23, v187, v191
  v_mul_f32 v192, v192, v60
  v_mfma_f32_16x16x32_bf16 v[168:171], v[132:135], v[224:227], v[168:171]
  ds_read_b128 v[208:211], v252 offset:34816
  v_mul_f32 v196, v196, v60
  v_mfma_f32_16x16x32_bf16 v[176:179], v[156:159], v[224:227], v[176:179]
  s_waitcnt lgkmcnt(3)
  buffer_store_dwordx2 v[20:21], v6, s[20:23], 0 offen offset:128 sc1
  v_cvt_pk_bf16_f32 v25, v192, v196
  v_mfma_f32_16x16x32_bf16 v[172:175], v[132:135], v[228:231], v[172:175]
  ds_read_b128 v[212:215], v252 offset:35840
  v_mul_f32 v193, v193, v61
  v_mfma_f32_16x16x32_bf16 v[180:183], v[156:159], v[228:231], v[180:183]
  s_waitcnt lgkmcnt(3)
  v_mul_f32 v197, v197, v61
  v_cvt_pk_bf16_f32 v27, v193, v197
  v_mfma_f32_16x16x32_bf16 v[168:171], v[136:139], v[200:203], v[168:171]
  ds_read_b128 v[216:219], v252 offset:36864
  v_mul_f32 v194, v194, v62
  v_mfma_f32_16x16x32_bf16 v[176:179], v[160:163], v[200:203], v[176:179]
  s_waitcnt lgkmcnt(3)
  buffer_store_dwordx2 v[22:23], v7, s[20:23], 0 offen offset:128 sc1
  v_mul_f32 v198, v198, v62
  v_mfma_f32_16x16x32_bf16 v[172:175], v[136:139], v[204:207], v[172:175]
  ds_read_b128 v[220:223], v252 offset:37888
  v_cvt_pk_bf16_f32 v29, v194, v198
  v_mfma_f32_16x16x32_bf16 v[180:183], v[160:163], v[204:207], v[180:183]
  s_waitcnt lgkmcnt(3)
  v_mul_f32 v195, v195, v63
  v_mul_f32 v199, v199, v63
  v_mfma_f32_16x16x32_bf16 v[168:171], v[140:143], v[208:211], v[168:171]
  ds_read_b128 v[224:227], v252 offset:38912
  v_cvt_pk_bf16_f32 v31, v195, v199
  v_mfma_f32_16x16x32_bf16 v[176:179], v[164:167], v[208:211], v[176:179]
  s_waitcnt lgkmcnt(3)
  buffer_store_dwordx2 v[24:25], v8, s[20:23], 0 offen offset:128 sc1
  v_mfma_f32_16x16x32_bf16 v[172:175], v[140:143], v[212:215], v[172:175]
  ds_read_b128 v[228:231], v252 offset:39936
  v_mfma_f32_16x16x32_bf16 v[180:183], v[164:167], v[212:215], v[180:183]
  s_waitcnt lgkmcnt(3)
  v_mfma_f32_16x16x32_bf16 v[184:187], v[120:123], v[216:219], 0
  ds_read_b128 v[200:203], v252 offset:40960
  v_mfma_f32_16x16x32_bf16 v[192:195], v[144:147], v[216:219], 0
  s_waitcnt lgkmcnt(3)
  buffer_store_dwordx2 v[26:27], v9, s[20:23], 0 offen offset:128 sc1
  v_mfma_f32_16x16x32_bf16 v[188:191], v[120:123], v[220:223], 0
  ds_read_b128 v[204:207], v252 offset:41984
  v_mul_f32 v168, v168, v56
  v_mfma_f32_16x16x32_bf16 v[196:199], v[144:147], v[220:223], 0
  s_waitcnt lgkmcnt(3)
  v_mul_f32 v172, v172, v56
  v_cvt_pk_bf16_f32 v16, v168, v172
  v_mfma_f32_16x16x32_bf16 v[184:187], v[124:127], v[224:227], v[184:187]
  ds_read_b128 v[208:211], v252 offset:43008
  v_mul_f32 v169, v169, v57
  v_mfma_f32_16x16x32_bf16 v[192:195], v[148:151], v[224:227], v[192:195]
  s_waitcnt lgkmcnt(3)
  buffer_store_dwordx2 v[28:29], v10, s[20:23], 0 offen offset:128 sc1
  v_mul_f32 v173, v173, v57
  v_mfma_f32_16x16x32_bf16 v[188:191], v[124:127], v[228:231], v[188:191]
  ds_read_b128 v[212:215], v252 offset:44032
  v_cvt_pk_bf16_f32 v18, v169, v173
  v_mfma_f32_16x16x32_bf16 v[196:199], v[148:151], v[228:231], v[196:199]
  s_waitcnt lgkmcnt(3)
  v_mul_f32 v170, v170, v58
  v_mul_f32 v174, v174, v58
  v_mfma_f32_16x16x32_bf16 v[184:187], v[128:131], v[200:203], v[184:187]
  ds_read_b128 v[216:219], v252 offset:45056
  v_cvt_pk_bf16_f32 v20, v170, v174
  v_mfma_f32_16x16x32_bf16 v[192:195], v[152:155], v[200:203], v[192:195]
  s_waitcnt lgkmcnt(3)
  buffer_store_dwordx2 v[30:31], v11, s[20:23], 0 offen offset:128 sc1
  v_mul_f32 v171, v171, v59
  v_mfma_f32_16x16x32_bf16 v[188:191], v[128:131], v[204:207], v[188:191]
  ds_read_b128 v[220:223], v252 offset:46080
  v_mul_f32 v175, v175, v59
  v_mfma_f32_16x16x32_bf16 v[196:199], v[152:155], v[204:207], v[196:199]
  s_waitcnt lgkmcnt(3)
  v_cvt_pk_bf16_f32 v22, v171, v175
  v_mul_f32 v176, v176, v60
  v_mfma_f32_16x16x32_bf16 v[184:187], v[132:135], v[208:211], v[184:187]
  ds_read_b128 v[224:227], v252 offset:47104
  v_mul_f32 v180, v180, v60
  v_mfma_f32_16x16x32_bf16 v[192:195], v[156:159], v[208:211], v[192:195]
  s_waitcnt lgkmcnt(3)
  v_cvt_pk_bf16_f32 v24, v176, v180
  v_mul_f32 v177, v177, v61
  v_mfma_f32_16x16x32_bf16 v[188:191], v[132:135], v[212:215], v[188:191]
  ds_read_b128 v[228:231], v252 offset:48128
  v_mul_f32 v181, v181, v61
  v_mfma_f32_16x16x32_bf16 v[196:199], v[156:159], v[212:215], v[196:199]
  s_waitcnt lgkmcnt(3)
  v_cvt_pk_bf16_f32 v26, v177, v181
  v_mul_f32 v178, v178, v62
  v_mfma_f32_16x16x32_bf16 v[184:187], v[136:139], v[216:219], v[184:187]
  v_mul_f32 v182, v182, v62
  v_cvt_pk_bf16_f32 v28, v178, v182
  v_mfma_f32_16x16x32_bf16 v[192:195], v[160:163], v[216:219], v[192:195]
  s_waitcnt lgkmcnt(2)
  v_mul_f32 v179, v179, v63
  v_mul_f32 v183, v183, v63
  v_mfma_f32_16x16x32_bf16 v[188:191], v[136:139], v[220:223], v[188:191]
  v_cvt_pk_bf16_f32 v30, v179, v183
  v_mfma_f32_16x16x32_bf16 v[196:199], v[160:163], v[220:223], v[196:199]
  s_waitcnt lgkmcnt(1)
  v_mfma_f32_16x16x32_bf16 v[184:187], v[140:143], v[224:227], v[184:187]
  v_mfma_f32_16x16x32_bf16 v[192:195], v[164:167], v[224:227], v[192:195]
  s_waitcnt lgkmcnt(0)
  v_mfma_f32_16x16x32_bf16 v[188:191], v[140:143], v[228:231], v[188:191]
  v_mfma_f32_16x16x32_bf16 v[196:199], v[164:167], v[228:231], v[196:199]
  s_nop 3
  v_mul_f32 v184, v184, v56
  s_nop 1
  v_mul_f32 v188, v188, v56
  v_cvt_pk_bf16_f32 v17, v184, v188
  buffer_store_dwordx2 v[16:17], v4, s[20:23], 0 offen offset:256 sc1
  v_mul_f32 v185, v185, v57
  v_mul_f32 v189, v189, v57
  v_cvt_pk_bf16_f32 v19, v185, v189
  buffer_store_dwordx2 v[18:19], v5, s[20:23], 0 offen offset:256 sc1
  v_mul_f32 v186, v186, v58
  v_mul_f32 v190, v190, v58
  v_cvt_pk_bf16_f32 v21, v186, v190
  buffer_store_dwordx2 v[20:21], v6, s[20:23], 0 offen offset:256 sc1
  v_mul_f32 v187, v187, v59
  v_mul_f32 v191, v191, v59
  v_cvt_pk_bf16_f32 v23, v187, v191
  buffer_store_dwordx2 v[22:23], v7, s[20:23], 0 offen offset:256 sc1
  v_mul_f32 v192, v192, v60
  v_mul_f32 v196, v196, v60
  v_cvt_pk_bf16_f32 v25, v192, v196
  buffer_store_dwordx2 v[24:25], v8, s[20:23], 0 offen offset:256 sc1
  v_mul_f32 v193, v193, v61
  v_mul_f32 v197, v197, v61
  v_cvt_pk_bf16_f32 v27, v193, v197
  buffer_store_dwordx2 v[26:27], v9, s[20:23], 0 offen offset:256 sc1
  v_mul_f32 v194, v194, v62
  v_mul_f32 v198, v198, v62
  v_cvt_pk_bf16_f32 v29, v194, v198
  buffer_store_dwordx2 v[28:29], v10, s[20:23], 0 offen offset:256 sc1
  v_mul_f32 v195, v195, v63
  v_mul_f32 v199, v199, v63
  v_cvt_pk_bf16_f32 v31, v195, v199
  buffer_store_dwordx2 v[30:31], v11, s[20:23], 0 offen offset:256 sc1
  s_endpgm
M_helper:
H_join:
  s_and_b32 s55, s2, 7
  s_lshr_b32 s56, s2, 3
  s_lshr_b32 s41, s55, 2
  s_bfe_u32 s42, s55, 0x10001
  s_and_b32 s55, s55, 1
  s_lshl_b32 s55, s55, 2
  s_lshr_b32 s43, s56, 3
  s_add_u32 s43, s43, s55
  s_and_b32 s44, s56, 7
  s_mul_i32 s43, s43, 14
  s_mul_i32 s44, s44, 14
  s_mul_i32 s61, s41, 13
  s_add_i32 s61, s61, -6
  s_mul_i32 s62, s42, 13
  s_add_i32 s62, s62, -6
  s_cmp_ge_u32 s40, 4
  s_cselect_b32 s53, -4, 3
  s_add_i32 s53, s53, s40
  s_lshl_b32 s53, s53, 1
  s_add_u32 s88, s43, s53
  s_mov_b32 s89, 86016
  s_movk_i32 s90, 384
  s_mul_i32 s55, s41, 6
  s_add_i32 s45, s43, s55
  s_add_i32 s45, s45, -6
  s_cmp_eq_i32 s45, -6
  s_cselect_b32 s47, 6, 0
  s_cmp_eq_i32 s45, 98
  s_cselect_b32 s48, 7, 13
  s_cselect_b32 s49, 2, 0
  s_sub_i32 s45, s45, s49
  s_mul_i32 s55, s42, 6
  s_add_i32 s56, s44, s55
  s_add_i32 s56, s56, -6
  s_cmp_eq_i32 s56, -6
  s_cselect_b32 s50, 6, 0
  s_cmp_eq_i32 s56, 98
  s_cselect_b32 s51, 7, 13
  s_lshl_b32 s56, s56, 1
  s_add_i32 s56, s56, s42
  s_mul_i32 s46, s56, 384
  s_max_i32 s92, s53, s47
  s_min_i32 s92, s92, s48
  s_and_b32 s92, s92, -2
  s_add_u32 s52, s92, s49
  s_mov_b32 s54, 4286578688
  s_mov_b32 s63, 1037384597
  s_and_b32 s93, s40, 1
  s_lshl_b32 s93, s93, 3
  s_and_b32 s56, s40, 6
  s_or_b32 s93, s93, s56
  s_add_u32 s56, s40, 8
  s_add_i32 s100, s45, s56
  s_lshl_b32 s100, s100, 1
  s_add_i32 s100, s100, s41
  s_max_i32 s100, s100, 0
  s_min_i32 s100, s100, 223
  s_mul_i32 s100, s100, 86016
  s_mul_i32 s101, s56, 7680
  v_add_u32 v4, 0, v1
  v_xor_b32 v4, 0, v4
  v_mul_u32_u24 v5, 2731, v4
  v_lshrrev_b32 v5, 16, v5
  v_mul_u32_u24 v5, 384, v5
  v_lshl_add_u32 v4, v4, 4, v5
  v_add_u32 v232, s46, v4
  v_add_u32 v235, 6144, v232
  v_add_u32 v238, 12288, v232
  v_max_i32 v232, 0, v232
  v_add_u32 v4, 64, v1
  v_xor_b32 v4, 0, v4
  v_mul_u32_u24 v5, 2731, v4
  v_lshrrev_b32 v5, 16, v5
  v_mul_u32_u24 v5, 384, v5
  v_lshl_add_u32 v4, v4, 4, v5
  v_add_u32 v233, s46, v4
  v_add_u32 v236, 6144, v233
  v_max_i32 v233, 0, v233
  v_add_u32 v4, 128, v1
  v_xor_b32 v4, 0, v4
  v_mul_u32_u24 v5, 2731, v4
  v_lshrrev_b32 v5, 16, v5
  v_mul_u32_u24 v5, 384, v5
  v_lshl_add_u32 v4, v4, 4, v5
  v_add_u32 v234, s46, v4
  v_add_u32 v237, 6144, v234
  v_max_i32 v234, 0, v234
  v_add_u32 v4, 416, v1
  v_xor_b32 v4, 0, v4
  v_mul_u32_u24 v5, 2731, v4
  v_lshrrev_b32 v5, 16, v5
  v_mul_u32_u24 v5, 384, v5
  v_lshl_add_u32 v4, v4, 4, v5
  v_add_u32 v239, s46, v4
  v_add_u32 v4, 0, v1
  v_xor_b32 v4, 8, v4
  v_mul_u32_u24 v5, 2731, v4
  v_lshrrev_b32 v5, 16, v5
  v_mul_u32_u24 v5, 384, v5
  v_lshl_add_u32 v4, v4, 4, v5
  v_add_u32 v244, s46, v4
  v_add_u32 v247, 6144, v244
  v_add_u32 v250, 12288, v244
  v_max_i32 v244, 0, v244
  v_add_u32 v4, 64, v1
  v_xor_b32 v4, 8, v4
  v_mul_u32_u24 v5, 2731, v4
  v_lshrrev_b32 v5, 16, v5
  v_mul_u32_u24 v5, 384, v5
  v_lshl_add_u32 v4, v4, 4, v5
  v_add_u32 v245, s46, v4
  v_add_u32 v248, 6144, v245
  v_max_i32 v245, 0, v245
  v_add_u32 v4, 128, v1
  v_xor_b32 v4, 8, v4
  v_mul_u32_u24 v5, 2731, v4
  v_lshrrev_b32 v5, 16, v5
  v_mul_u32_u24 v5, 384, v5
  v_lshl_add_u32 v4, v4, 4, v5
  v_add_u32 v246, s46, v4
  v_add_u32 v249, 6144, v246
  v_max_i32 v246, 0, v246
  v_add_u32 v4, 416, v1
  v_xor_b32 v4, 8, v4
  v_mul_u32_u24 v5, 2731, v4
  v_lshrrev_b32 v5, 16, v5
  v_mul_u32_u24 v5, 384, v5
  v_lshl_add_u32 v4, v4, 4, v5
  v_add_u32 v251, s46, v4
  s_barrier
  v_mov_b32 v6, 0
  s_mov_b32 s59, 0
  s_mov_b64 exec, 1
H_pollM:
  buffer_load_dword v7, v6, s[36:39], 0 offen offset:128 sc1
  s_waitcnt vmcnt(0)
  v_cmp_eq_u32 vcc, 0, v7
  s_add_u32 s59, s59, 1
  s_cmp_gt_u32 s59, 200000
  s_cbranch_scc1 H_pollM_x
  s_cmp_lg_u64 vcc, 0
  s_cbranch_scc0 H_pollM_x
  s_sleep 2
  s_branch H_pollM
H_pollM_x:
  s_mov_b64 exec, -1
  s_lshr_b32 s55, s2, 3
  s_mul_i32 s55, s55, 2304
  s_add_u32 s55, s55, 131072
  buffer_load_dwordx4 v[80:83], v252, s[24:27], s55 offen offset:0 sc1
  buffer_load_dwordx4 v[84:87], v252, s[24:27], s55 offen offset:1024 sc1
  buffer_load_dwordx4 v[88:91], v252, s[24:27], s55 offen offset:2048 sc1
  s_barrier
  s_lshl_b32 s55, s40, 10
  s_add_u32 s55, s55, 131072
  s_sub_u32 m0, s55, 40960
  s_nop 0
  buffer_load_dwordx4 v252, s[24:27], s55 offen sc1 lds
  s_add_u32 s55, s55, 4096
  s_sub_u32 m0, s55, 40960
  s_nop 0
  buffer_load_dwordx4 v252, s[24:27], s55 offen sc1 lds
  s_add_u32 s55, s55, 4096
  s_sub_u32 m0, s55, 40960
  s_nop 0
  buffer_load_dwordx4 v252, s[24:27], s55 offen sc1 lds
  s_add_u32 s55, s55, 4096
  s_sub_u32 m0, s55, 40960
  s_nop 0
  buffer_load_dwordx4 v252, s[24:27], s55 offen sc1 lds
  s_add_u32 s55, s55, 4096
  s_sub_u32 m0, s55, 40960
  s_nop 0
  buffer_load_dwordx4 v252, s[24:27], s55 offen sc1 lds
  s_add_u32 s55, s55, 4096
  s_sub_u32 m0, s55, 40960
  s_nop 0
  buffer_load_dwordx4 v252, s[24:27], s55 offen sc1 lds
  s_add_u32 s55, s55, 4096
  s_sub_u32 m0, s55, 40960
  s_nop 0
  buffer_load_dwordx4 v252, s[24:27], s55 offen sc1 lds
  s_add_u32 s55, s55, 4096
  s_sub_u32 m0, s55, 40960
  s_nop 0
  buffer_load_dwordx4 v252, s[24:27], s55 offen sc1 lds
  s_add_u32 s55, s55, 4096
  s_sub_u32 m0, s55, 40960
  s_nop 0
  buffer_load_dwordx4 v252, s[24:27], s55 offen sc1 lds
  s_add_u32 s55, s55, 4096
  s_sub_u32 m0, s55, 40960
  s_nop 0
  buffer_load_dwordx4 v252, s[24:27], s55 offen sc1 lds
  s_add_u32 s55, s55, 4096
  s_sub_u32 m0, s55, 40960
  s_nop 0
  buffer_load_dwordx4 v252, s[24:27], s55 offen sc1 lds
  s_add_u32 s55, s55, 4096
  s_sub_u32 m0, s55, 40960
  s_nop 0
  buffer_load_dwordx4 v252, s[24:27], s55 offen sc1 lds
  s_waitcnt vmcnt(6)
  s_barrier
  s_lshl_b32 s55, s40, 10
  s_add_u32 s55, s55, 180224
  s_sub_u32 m0, s55, 40960
  s_nop 0
  buffer_load_dwordx4 v252, s[24:27], s55 offen sc1 lds
  s_add_u32 s55, s55, 4096
  s_sub_u32 m0, s55, 40960
  s_nop 0
  buffer_load_dwordx4 v252, s[24:27], s55 offen sc1 lds
  s_add_u32 s55, s55, 4096
  s_sub_u32 m0, s55, 40960
  s_nop 0
  buffer_load_dwordx4 v252, s[24:27], s55 offen sc1 lds
  s_add_u32 s55, s55, 4096
  s_sub_u32 m0, s55, 40960
  s_nop 0
  buffer_load_dwordx4 v252, s[24:27], s55 offen sc1 lds
  s_add_u32 s55, s55, 4096
  s_sub_u32 m0, s55, 40960
  s_nop 0
  buffer_load_dwordx4 v252, s[24:27], s55 offen sc1 lds
  s_add_u32 s55, s55, 4096
  s_sub_u32 m0, s55, 40960
  s_nop 0
  buffer_load_dwordx4 v252, s[24:27], s55 offen sc1 lds
  v_mov_b32 v192, 1
  v_mov_b32 v193, 0
  s_waitcnt vmcnt(0)
  s_sub_u32 s58, s2, 36
  s_cmp_ge_u32 s58, 144
  s_cbranch_scc1 H_nov2
  v_mov_b32 v192, 1
  v_mov_b32 v193, 0
  s_mov_b64 exec, 1
  s_waitcnt vmcnt(0)
  buffer_atomic_add v192, v193, s[36:39], 0 offen offset:4 sc0 sc1
  s_mov_b64 exec, -1
H_nov2:
  s_add_i32 s56, s45, 0
  s_lshl_b32 s56, s56, 1
  s_add_i32 s56, s56, s41
  s_max_i32 s56, s56, 0
  s_min_i32 s56, s56, 223
  s_mul_i32 s56, s56, 86016
  s_mov_b32 m0, 0
  s_nop 0
  buffer_load_dwordx4 v232, s[16:19], s56 offen lds
  s_mov_b32 m0, 1024
  s_nop 0
  buffer_load_dwordx4 v233, s[16:19], s56 offen lds
  s_mov_b32 m0, 2048
  s_nop 0
  buffer_load_dwordx4 v234, s[16:19], s56 offen lds
  s_mov_b32 m0, 3072
  s_nop 0
  buffer_load_dwordx4 v235, s[16:19], s56 offen lds
  s_mov_b32 m0, 4096
  s_nop 0
  buffer_load_dwordx4 v236, s[16:19], s56 offen lds
  s_mov_b32 m0, 5120
  s_nop 0
  buffer_load_dwordx4 v237, s[16:19], s56 offen lds
  s_mov_b32 m0, 6144
  s_nop 0
  buffer_load_dwordx4 v238, s[16:19], s56 offen lds
  s_mov_b32 m0, 6656
  s_nop 0
  buffer_load_dwordx4 v239, s[16:19], s56 offen lds
  s_add_i32 s56, s45, 8
  s_lshl_b32 s56, s56, 1
  s_add_i32 s56, s56, s41
  s_max_i32 s56, s56, 0
  s_min_i32 s56, s56, 223
  s_mul_i32 s56, s56, 86016
  s_mov_b32 m0, 61440
  s_nop 0
  buffer_load_dwordx4 v232, s[16:19], s56 offen lds
  s_mov_b32 m0, 62464
  s_nop 0
  buffer_load_dwordx4 v233, s[16:19], s56 offen lds
  s_mov_b32 m0, 63488
  s_nop 0
  buffer_load_dwordx4 v234, s[16:19], s56 offen lds
  s_mov_b32 m0, 64512
  s_nop 0
  buffer_load_dwordx4 v235, s[16:19], s56 offen lds
  s_mov_b32 m0, 65536
  s_nop 0
  buffer_load_dwordx4 v236, s[16:19], s56 offen lds
  s_mov_b32 m0, 66560
  s_nop 0
  buffer_load_dwordx4 v237, s[16:19], s56 offen lds
  s_mov_b32 m0, 67584
  s_nop 0
  buffer_load_dwordx4 v238, s[16:19], s56 offen lds
  s_mov_b32 m0, 68096
  s_nop 0
  buffer_load_dwordx4 v239, s[16:19], s56 offen lds
  s_barrier
  s_barrier
  s_waitcnt vmcnt(0)
  v_readfirstlane_b32 s56, v192
  s_nop 0
  s_cmp_lg_u32 s56, 143
  s_cbranch_scc1 H_p2
  s_mov_b64 exec, 1
  buffer_store_dword v192, v193, s[36:39], 0 offen offset:132 sc1
  s_mov_b64 exec, -1
H_p2:
  s_barrier
  s_add_i32 s56, s45, 16
  s_lshl_b32 s56, s56, 1
  s_add_i32 s56, s56, s41
  s_max_i32 s56, s56, 0
  s_min_i32 s56, s56, 223
  s_mul_i32 s56, s56, 86016
  s_mov_b32 m0, 122880
  s_nop 0
  buffer_load_dwordx4 v232, s[16:19], s56 offen lds
  s_mov_b32 m0, 123904
  s_nop 0
  buffer_load_dwordx4 v233, s[16:19], s56 offen lds
  s_mov_b32 m0, 124928
  s_nop 0
  buffer_load_dwordx4 v234, s[16:19], s56 offen lds
  s_mov_b32 m0, 125952
  s_nop 0
  buffer_load_dwordx4 v235, s[16:19], s56 offen lds
  s_mov_b32 m0, 126976
  s_nop 0
  buffer_load_dwordx4 v236, s[16:19], s56 offen lds
  s_mov_b32 m0, 128000
  s_nop 0
  buffer_load_dwordx4 v237, s[16:19], s56 offen lds
  s_mov_b32 m0, 129024
  s_nop 0
  buffer_load_dwordx4 v238, s[16:19], s56 offen lds
  s_mov_b32 m0, 129536
  s_nop 0
  buffer_load_dwordx4 v239, s[16:19], s56 offen lds
  s_add_i32 s56, s45, 17
  s_lshl_b32 s56, s56, 1
  s_add_i32 s56, s56, s41
  s_max_i32 s56, s56, 0
  s_min_i32 s56, s56, 223
  s_mul_i32 s56, s56, 86016
  s_mov_b32 m0, 130560
  s_nop 0
  buffer_load_dwordx4 v244, s[16:19], s56 offen lds
  s_mov_b32 m0, 131584
  s_nop 0
  buffer_load_dwordx4 v245, s[16:19], s56 offen lds
  s_mov_b32 m0, 132608
  s_nop 0
  buffer_load_dwordx4 v246, s[16:19], s56 offen lds
  s_mov_b32 m0, 133632
  s_nop 0
  buffer_load_dwordx4 v247, s[16:19], s56 offen lds
  s_mov_b32 m0, 134656
  s_nop 0
  buffer_load_dwordx4 v248, s[16:19], s56 offen lds
  s_mov_b32 m0, 135680
  s_nop 0
  buffer_load_dwordx4 v249, s[16:19], s56 offen lds
  s_mov_b32 m0, 136704
  s_nop 0
  buffer_load_dwordx4 v250, s[16:19], s56 offen lds
  s_mov_b32 m0, 137216
  s_nop 0
  buffer_load_dwordx4 v251, s[16:19], s56 offen lds
  s_add_i32 s56, s45, 18
  s_lshl_b32 s56, s56, 1
  s_add_i32 s56, s56, s41
  s_max_i32 s56, s56, 0
  s_min_i32 s56, s56, 223
  s_mul_i32 s56, s56, 86016
  v_xor_b32 v64, 32, v232
  s_mov_b32 m0, 138240
  s_nop 0
  buffer_load_dwordx4 v64, s[16:19], s56 offen lds
  v_xor_b32 v65, 32, v233
  s_mov_b32 m0, 139264
  s_nop 0
  buffer_load_dwordx4 v65, s[16:19], s56 offen lds
  v_xor_b32 v66, 32, v234
  s_mov_b32 m0, 140288
  s_nop 0
  buffer_load_dwordx4 v66, s[16:19], s56 offen lds
  v_xor_b32 v67, 32, v235
  s_mov_b32 m0, 141312
  s_nop 0
  buffer_load_dwordx4 v67, s[16:19], s56 offen lds
  v_xor_b32 v68, 32, v236
  s_mov_b32 m0, 142336
  s_nop 0
  buffer_load_dwordx4 v68, s[16:19], s56 offen lds
  v_xor_b32 v69, 32, v237
  s_mov_b32 m0, 143360
  s_nop 0
  buffer_load_dwordx4 v69, s[16:19], s56 offen lds
  v_xor_b32 v70, 32, v238
  s_mov_b32 m0, 144384
  s_nop 0
  buffer_load_dwordx4 v70, s[16:19], s56 offen lds
  v_xor_b32 v71, 32, v239
  s_mov_b32 m0, 144896
  s_nop 0
  buffer_load_dwordx4 v71, s[16:19], s56 offen lds
  s_add_i32 s56, s45, 19
  s_lshl_b32 s56, s56, 1
  s_add_i32 s56, s56, s41
  s_max_i32 s56, s56, 0
  s_min_i32 s56, s56, 223
  s_mul_i32 s56, s56, 86016
  v_xor_b32 v64, 32, v244
  s_mov_b32 m0, 145920
  s_nop 0
  buffer_load_dwordx4 v64, s[16:19], s56 offen lds
  v_xor_b32 v65, 32, v245
  s_mov_b32 m0, 146944
  s_nop 0
  buffer_load_dwordx4 v65, s[16:19], s56 offen lds
  v_xor_b32 v66, 32, v246
  s_mov_b32 m0, 147968
  s_nop 0
  buffer_load_dwordx4 v66, s[16:19], s56 offen lds
  v_xor_b32 v67, 32, v247
  s_mov_b32 m0, 148992
  s_nop 0
  buffer_load_dwordx4 v67, s[16:19], s56 offen lds
  v_xor_b32 v68, 32, v248
  s_mov_b32 m0, 150016
  s_nop 0
  buffer_load_dwordx4 v68, s[16:19], s56 offen lds
  v_xor_b32 v69, 32, v249
  s_mov_b32 m0, 151040
  s_nop 0
  buffer_load_dwordx4 v69, s[16:19], s56 offen lds
  v_xor_b32 v70, 32, v250
  s_mov_b32 m0, 152064
  s_nop 0
  buffer_load_dwordx4 v70, s[16:19], s56 offen lds
  v_xor_b32 v71, 32, v251
  s_mov_b32 m0, 152576
  s_nop 0
  buffer_load_dwordx4 v71, s[16:19], s56 offen lds
  s_waitcnt vmcnt(0)
  v_mov_b32 v6, 0
  s_mov_b32 s59, 0
  s_mov_b64 exec, 1
H_pollV:
  buffer_load_dword v7, v6, s[36:39], 0 offen offset:132 sc1
  s_waitcnt vmcnt(0)
  v_cmp_eq_u32 vcc, 0, v7
  s_add_u32 s59, s59, 1
  s_cmp_gt_u32 s59, 200000
  s_cbranch_scc1 H_pollV_x
  s_cmp_lg_u64 vcc, 0
  s_cbranch_scc0 H_pollV_x
  s_sleep 2
  s_branch H_pollV
H_pollV_x:
  s_mov_b64 exec, -1
  s_lshr_b32 s55, s2, 3
  s_mul_i32 s55, s55, 2304
  buffer_load_dwordx4 v[80:83], v252, s[24:27], s55 offen offset:0 sc1
  buffer_load_dwordx4 v[84:87], v252, s[24:27], s55 offen offset:1024 sc1
  buffer_load_dwordx4 v[88:91], v252, s[24:27], s55 offen offset:2048 sc1
  s_barrier
  s_mov_b32 m0, 153600
  s_mov_b32 s59, 0
  buffer_load_dwordx4 v252, s[24:27], s59 offen offset:0 sc1 lds
  buffer_load_dwordx4 v252, s[24:27], s59 offen offset:1024 sc1 lds
  buffer_load_dwordx4 v252, s[24:27], s59 offen offset:2048 sc1 lds
  buffer_load_dwordx4 v252, s[24:27], s59 offen offset:3072 sc1 lds
  s_mov_b32 m0, 157696
  s_mov_b32 s59, 4096
  buffer_load_dwordx4 v252, s[24:27], s59 offen offset:0 sc1 lds
  buffer_load_dwordx4 v252, s[24:27], s59 offen offset:1024 sc1 lds
  buffer_load_dwordx4 v252, s[24:27], s59 offen offset:2048 sc1 lds
  buffer_load_dwordx4 v252, s[24:27], s59 offen offset:3072 sc1 lds
  s_mov_b32 m0, 161792
  s_mov_b32 s59, 8192
  buffer_load_dwordx4 v252, s[24:27], s59 offen offset:0 sc1 lds
  buffer_load_dwordx4 v252, s[24:27], s59 offen offset:1024 sc1 lds
  s_waitcnt vmcnt(0)
  s_barrier
  s_mov_b32 m0, 0
  s_mov_b32 s59, 24576
  buffer_load_dwordx4 v252, s[24:27], s59 offen offset:0 sc1 lds
  buffer_load_dwordx4 v252, s[24:27], s59 offen offset:1024 sc1 lds
  buffer_load_dwordx4 v252, s[24:27], s59 offen offset:2048 sc1 lds
  buffer_load_dwordx4 v252, s[24:27], s59 offen offset:3072 sc1 lds
  s_mov_b32 m0, 4096
  s_mov_b32 s59, 28672
  buffer_load_dwordx4 v252, s[24:27], s59 offen offset:0 sc1 lds
  buffer_load_dwordx4 v252, s[24:27], s59 offen offset:1024 sc1 lds
  buffer_load_dwordx4 v252, s[24:27], s59 offen offset:2048 sc1 lds
  buffer_load_dwordx4 v252, s[24:27], s59 offen offset:3072 sc1 lds
  s_mov_b32 m0, 8192
  s_mov_b32 s59, 32768
  buffer_load_dwordx4 v252, s[24:27], s59 offen offset:0 sc1 lds
  buffer_load_dwordx4 v252, s[24:27], s59 offen offset:1024 sc1 lds
  buffer_load_dwordx4 v252, s[24:27], s59 offen offset:2048 sc1 lds
  buffer_load_dwordx4 v252, s[24:27], s59 offen offset:3072 sc1 lds
  s_waitcnt vmcnt(0)
  s_barrier
M_done:
  s_endpgm
CODE_END:
.section .rodata,"a"
.p2align 6
.amdhsa_kernel standalone__neighborhood_nat__vision_kernel
  .amdhsa_next_free_vgpr 256
  .amdhsa_next_free_sgpr 102
  .amdhsa_accum_offset 256
  .amdhsa_group_segment_fixed_size 0
  .amdhsa_kernarg_size 48
  .amdhsa_user_sgpr_count 2
  .amdhsa_user_sgpr_kernarg_segment_ptr 1
  .amdhsa_system_sgpr_workgroup_id_x 1
.end_amdhsa_kernel
```

```asm
; @launch grid=(256,1,1) block=(512,1,1) lds=163840
.amdgcn_target "amdgcn-amd-amdhsa--gfx950"
.text
.globl standalone__neighborhood_nat__vision_kernel
.p2align 8
.type standalone__neighborhood_nat__vision_kernel,@function
standalone__neighborhood_nat__vision_kernel:
  s_cmp_ge_u32 s2, 256
  s_cbranch_scc1 M_done
  s_load_dwordx8 s[4:11], s[0:1], 0
  s_load_dwordx4 s[12:15], s[0:1], 32
  v_lshrrev_b32 v4, 6, v0
  v_and_b32 v1, 63, v0
  v_readfirstlane_b32 s40, v4
  v_lshrrev_b32 v2, 4, v1
  v_and_b32 v3, 15, v1
  v_lshlrev_b32 v252, 4, v1
  s_getpc_b64 s[16:17]
  s_and_b32 s16, s16, -256
  s_and_b32 s17, s17, 0xffff
  s_mov_b32 s18, CODE_END-standalone__neighborhood_nat__vision_kernel
  s_mov_b32 s19, 0x00020000
  s_lshr_b32 s55, s2, 3
  s_lshl_b32 s55, s55, 10
  s_cmp_lg_u32 s40, 3
  s_cbranch_scc1 M_nocpf
  buffer_load_dwordx4 v[136:139], v252, s[16:19], s55 offen
M_nocpf:
  s_cmp_lg_u32 s40, 0
  s_cbranch_scc1 M_comp
  v_bfe_u32 v5, v1, 2, 2
  v_lshrrev_b32 v6, 5, v1
  v_lshlrev_b32 v7, 1, v6
  v_and_b32 v8, 3, v1
  v_xor_b32 v7, v7, v8
  v_lshlrev_b32 v7, 4, v7
  s_movk_i32 s60, 1152
  v_lshl_add_u32 v4, v2, 3, v5
  v_mad_u32_u24 v200, v4, s60, v7
  v_lshrrev_b32 v4, 2, v1
  v_mad_u32_u24 v203, v4, s60, v7
  v_lshrrev_b32 v4, 3, v3
  v_lshlrev_b32 v4, 1, v4
  v_xor_b32 v4, v4, v2
  v_lshl_add_u32 v4, v3, 2, v4
  v_lshlrev_b32 v195, 4, v4
  v_add_u32 v195, 90112, v195
  s_waitcnt lgkmcnt(0)
  s_mov_b32 s28, s6
  s_and_b32 s29, s7, 0xffff
  s_mov_b32 s30, 221184
  s_mov_b32 s31, 0x00020000
  s_cmp_ge_u32 s2, 36
  s_cbranch_scc1 H_nom
  s_mul_hi_u32 s55, s2, 0x2aaaaaab
  s_mul_i32 s56, s55, 6
  s_sub_u32 s56, s2, s56
  s_mul_i32 s55, s55, 36864
  s_mul_i32 s56, s56, 36864
  s_mov_b32 m0, 90112
  s_nop 0
  buffer_load_dwordx4 v200, s[28:31], s56 offen offset:0 lds
  s_mov_b32 m0, 102016
  s_nop 0
  buffer_load_dwordx4 v200, s[28:31], s55 offen offset:384 lds
  s_mov_b32 m0, 91072
  s_nop 0
  buffer_load_dwordx4 v200, s[28:31], s56 offen offset:64 lds
  s_mov_b32 m0, 102976
  s_nop 0
  buffer_load_dwordx4 v200, s[28:31], s55 offen offset:448 lds
  s_mov_b32 m0, 92032
  s_nop 0
  buffer_load_dwordx4 v200, s[28:31], s56 offen offset:128 lds
  s_mov_b32 m0, 103936
  s_nop 0
  buffer_load_dwordx4 v200, s[28:31], s55 offen offset:512 lds
  s_mov_b32 m0, 92992
  s_nop 0
  buffer_load_dwordx4 v200, s[28:31], s56 offen offset:192 lds
  s_mov_b32 m0, 104896
  s_nop 0
  buffer_load_dwordx4 v200, s[28:31], s55 offen offset:576 lds
  s_mov_b32 m0, 93952
  s_nop 0
  buffer_load_dwordx4 v200, s[28:31], s56 offen offset:256 lds
  s_mov_b32 m0, 105856
  s_nop 0
  buffer_load_dwordx4 v200, s[28:31], s55 offen offset:640 lds
  s_mov_b32 m0, 94912
  s_nop 0
  buffer_load_dwordx4 v200, s[28:31], s56 offen offset:320 lds
  s_mov_b32 m0, 106816
  s_nop 0
  buffer_load_dwordx4 v200, s[28:31], s55 offen offset:704 lds
  s_add_u32 s55, s55, 4608
  s_add_u32 s56, s56, 4608
  s_mov_b32 m0, 96256
  s_nop 0
  buffer_load_dwordx4 v200, s[28:31], s56 offen offset:0 lds
  s_mov_b32 m0, 108160
  s_nop 0
  buffer_load_dwordx4 v200, s[28:31], s55 offen offset:384 lds
  s_mov_b32 m0, 97216
  s_nop 0
  buffer_load_dwordx4 v200, s[28:31], s56 offen offset:64 lds
  s_mov_b32 m0, 109120
  s_nop 0
  buffer_load_dwordx4 v200, s[28:31], s55 offen offset:448 lds
  s_mov_b32 m0, 98176
  s_nop 0
  buffer_load_dwordx4 v200, s[28:31], s56 offen offset:128 lds
  s_mov_b32 m0, 110080
  s_nop 0
  buffer_load_dwordx4 v200, s[28:31], s55 offen offset:512 lds
  s_mov_b32 m0, 99136
  s_nop 0
  buffer_load_dwordx4 v200, s[28:31], s56 offen offset:192 lds
  s_mov_b32 m0, 111040
  s_nop 0
  buffer_load_dwordx4 v200, s[28:31], s55 offen offset:576 lds
  s_mov_b32 m0, 100096
  s_nop 0
  buffer_load_dwordx4 v200, s[28:31], s56 offen offset:256 lds
  s_mov_b32 m0, 112000
  s_nop 0
  buffer_load_dwordx4 v200, s[28:31], s55 offen offset:640 lds
  s_mov_b32 m0, 101056
  s_nop 0
  buffer_load_dwordx4 v200, s[28:31], s56 offen offset:320 lds
  s_mov_b32 m0, 112960
  s_nop 0
  buffer_load_dwordx4 v200, s[28:31], s55 offen offset:704 lds
  s_mov_b32 s16, s4
  s_and_b32 s17, s5, 0xffff
  s_mov_b32 s18, 19267584
  s_mov_b32 s19, 0x00020000
  s_mov_b32 s24, s14
  s_and_b32 s25, s15, 0xffff
  s_mov_b32 s26, 268435456
  s_mov_b32 s27, 0x00020000
  s_mov_b32 s20, s10
  s_and_b32 s21, s11, 0xffff
  s_mov_b32 s22, 19267584
  s_mov_b32 s23, 0x00020000
  s_mov_b32 s36, s12
  s_and_b32 s37, s13, 0xffff
  s_mov_b32 s38, 256
  s_mov_b32 s39, 0x00020000
  s_lshl_b32 s55, s2, 11
  s_add_u32 s55, s55, 131072
  s_barrier
  s_waitcnt vmcnt(0)
  ds_read_b128 v[64:67], v195 offset:0
  ds_read_b128 v[88:91], v195 offset:6144
  ds_read_b128 v[112:115], v195 offset:12288
  ds_read_b128 v[136:139], v195 offset:18432
  ds_read_b128 v[68:71], v195 offset:1024
  ds_read_b128 v[92:95], v195 offset:7168
  ds_read_b128 v[116:119], v195 offset:13312
  ds_read_b128 v[140:143], v195 offset:19456
  ds_read_b128 v[72:75], v195 offset:2048
  ds_read_b128 v[96:99], v195 offset:8192
  ds_read_b128 v[120:123], v195 offset:14336
  ds_read_b128 v[144:147], v195 offset:20480
  s_waitcnt lgkmcnt(9)
  v_mfma_f32_16x16x32_bf16 v[160:163], v[64:67], v[112:115], 0
  v_mfma_f32_16x16x32_bf16 v[164:167], v[88:91], v[112:115], 0
  s_waitcnt lgkmcnt(8)
  v_mfma_f32_16x16x32_bf16 v[168:171], v[64:67], v[136:139], 0
  v_mfma_f32_16x16x32_bf16 v[172:175], v[88:91], v[136:139], 0
  ds_read_b128 v[76:79], v195 offset:3072
  ds_read_b128 v[100:103], v195 offset:9216
  ds_read_b128 v[124:127], v195 offset:15360
  ds_read_b128 v[148:151], v195 offset:21504
  s_waitcnt lgkmcnt(9)
  v_mfma_f32_16x16x32_bf16 v[160:163], v[68:71], v[116:119], v[160:163]
  v_mfma_f32_16x16x32_bf16 v[164:167], v[92:95], v[116:119], v[164:167]
  s_waitcnt lgkmcnt(8)
  v_mfma_f32_16x16x32_bf16 v[168:171], v[68:71], v[140:143], v[168:171]
  v_mfma_f32_16x16x32_bf16 v[172:175], v[92:95], v[140:143], v[172:175]
  ds_read_b128 v[80:83], v195 offset:4096
  ds_read_b128 v[104:107], v195 offset:10240
  ds_read_b128 v[128:131], v195 offset:16384
  ds_read_b128 v[152:155], v195 offset:22528
  s_waitcnt lgkmcnt(9)
  v_mfma_f32_16x16x32_bf16 v[160:163], v[72:75], v[120:123], v[160:163]
  v_mfma_f32_16x16x32_bf16 v[164:167], v[96:99], v[120:123], v[164:167]
  s_waitcnt lgkmcnt(8)
  v_mfma_f32_16x16x32_bf16 v[168:171], v[72:75], v[144:147], v[168:171]
  v_mfma_f32_16x16x32_bf16 v[172:175], v[96:99], v[144:147], v[172:175]
  ds_read_b128 v[84:87], v195 offset:5120
  ds_read_b128 v[108:111], v195 offset:11264
  ds_read_b128 v[132:135], v195 offset:17408
  ds_read_b128 v[156:159], v195 offset:23552
  s_waitcnt lgkmcnt(9)
  v_mfma_f32_16x16x32_bf16 v[160:163], v[76:79], v[124:127], v[160:163]
  v_mfma_f32_16x16x32_bf16 v[164:167], v[100:103], v[124:127], v[164:167]
  s_waitcnt lgkmcnt(8)
  v_mfma_f32_16x16x32_bf16 v[168:171], v[76:79], v[148:151], v[168:171]
  v_mfma_f32_16x16x32_bf16 v[172:175], v[100:103], v[148:151], v[172:175]
  s_waitcnt lgkmcnt(5)
  v_mfma_f32_16x16x32_bf16 v[160:163], v[80:83], v[128:131], v[160:163]
  v_mfma_f32_16x16x32_bf16 v[164:167], v[104:107], v[128:131], v[164:167]
  s_waitcnt lgkmcnt(4)
  v_mfma_f32_16x16x32_bf16 v[168:171], v[80:83], v[152:155], v[168:171]
  v_mfma_f32_16x16x32_bf16 v[172:175], v[104:107], v[152:155], v[172:175]
  s_waitcnt lgkmcnt(1)
  v_mfma_f32_16x16x32_bf16 v[160:163], v[84:87], v[132:135], v[160:163]
  v_mfma_f32_16x16x32_bf16 v[164:167], v[108:111], v[132:135], v[164:167]
  s_waitcnt lgkmcnt(0)
  v_mfma_f32_16x16x32_bf16 v[168:171], v[84:87], v[156:159], v[168:171]
  v_mfma_f32_16x16x32_bf16 v[172:175], v[108:111], v[156:159], v[172:175]
  s_nop 3
  v_cvt_pk_bf16_f32 v176, v160, v161
  v_cvt_pk_bf16_f32 v177, v162, v163
  v_cvt_pk_bf16_f32 v178, v164, v165
  v_cvt_pk_bf16_f32 v179, v166, v167
  buffer_store_dwordx4 v[176:179], v252, s[24:27], s55 offen offset:0 sc1
  v_cvt_pk_bf16_f32 v180, v168, v169
  v_cvt_pk_bf16_f32 v181, v170, v171
  v_cvt_pk_bf16_f32 v182, v172, v173
  v_cvt_pk_bf16_f32 v183, v174, v175
  buffer_store_dwordx4 v[180:183], v252, s[24:27], s55 offen offset:1024 sc1
  v_mov_b32 v192, 1
  v_mov_b32 v193, 0
  s_mov_b64 exec, 1
  s_waitcnt vmcnt(0)
  buffer_atomic_add v192, v193, s[36:39], 0 offen offset:0 sc0 sc1
  s_mov_b64 exec, -1
  s_barrier
  s_waitcnt vmcnt(0)
  v_readfirstlane_b32 s56, v192
  s_nop 0
  s_cmp_lg_u32 s56, 35
  s_cbranch_scc1 H_p1
  s_mov_b64 exec, 1
  buffer_store_dword v192, v193, s[36:39], 0 offen offset:128 sc1
  s_mov_b64 exec, -1
H_p1:
  s_barrier
  s_branch H_join
H_nom:
  s_mov_b32 s32, s8
  s_and_b32 s33, s9, 0xffff
  s_mov_b32 s34, 73728
  s_mov_b32 s35, 0x00020000
  s_cmp_ge_u32 s2, 180
  s_cbranch_scc1 H_nov1
  s_sub_u32 s58, s2, 36
  s_mul_hi_u32 s55, s58, 0x15555556
  s_mul_i32 s56, s55, 12
  s_sub_u32 s56, s58, s56
  s_mul_i32 s57, s55, 18432
  s_mov_b32 m0, 91392
  s_nop 0
  buffer_load_dwordx4 v203, s[28:31], s57 offen offset:768 lds
  s_mov_b32 m0, 92352
  s_nop 0
  buffer_load_dwordx4 v203, s[28:31], s57 offen offset:832 lds
  s_mov_b32 m0, 93312
  s_nop 0
  buffer_load_dwordx4 v203, s[28:31], s57 offen offset:896 lds
  s_mov_b32 m0, 94272
  s_nop 0
  buffer_load_dwordx4 v203, s[28:31], s57 offen offset:960 lds
  s_mov_b32 m0, 95232
  s_nop 0
  buffer_load_dwordx4 v203, s[28:31], s57 offen offset:1024 lds
  s_mov_b32 m0, 96192
  s_nop 0
  buffer_load_dwordx4 v203, s[28:31], s57 offen offset:1088 lds
  v_lshrrev_b32 v112, 1, v1
  v_mul_u32_u24 v112, 384, v112
  v_and_b32 v113, 1, v1
  v_lshl_add_u32 v112, v113, 4, v112
  s_lshl_b32 s57, s56, 5
  s_mov_b32 m0, 98304
  s_nop 0
  buffer_load_dwordx4 v112, s[32:35], s57 offen lds
  s_add_u32 s57, s57, 12288
  s_mov_b32 m0, 99328
  s_nop 0
  buffer_load_dwordx4 v112, s[32:35], s57 offen lds
  s_add_u32 s57, s57, 12288
  s_mov_b32 m0, 100352
  s_nop 0
  buffer_load_dwordx4 v112, s[32:35], s57 offen lds
  s_add_u32 s57, s57, 12288
  s_mov_b32 m0, 101376
  s_nop 0
  buffer_load_dwordx4 v112, s[32:35], s57 offen lds
  s_add_u32 s57, s57, 12288
  s_mov_b32 m0, 102400
  s_nop 0
  buffer_load_dwordx4 v112, s[32:35], s57 offen lds
  s_add_u32 s57, s57, 12288
  s_mov_b32 m0, 103424
  s_nop 0
  buffer_load_dwordx4 v112, s[32:35], s57 offen lds
  s_add_u32 s57, s57, 12288
  s_lshr_b32 s57, s56, 2
  s_mul_i32 s95, s57, 24576
  s_and_b32 s56, s56, 3
  s_lshl_b32 s56, s56, 6
  s_add_u32 s95, s95, s56
  s_lshr_b32 s56, s55, 1
  s_lshl_b32 s56, s56, 11
  s_add_u32 s95, s95, s56
  s_and_b32 s55, s55, 1
  s_lshl_b32 s55, s55, 3
  s_add_u32 s95, s95, s55
H_nov1:
  s_barrier
  s_mov_b32 s16, s4
  s_and_b32 s17, s5, 0xffff
  s_mov_b32 s18, 19267584
  s_mov_b32 s19, 0x00020000
  s_mov_b32 s24, s14
  s_and_b32 s25, s15, 0xffff
  s_mov_b32 s26, 268435456
  s_mov_b32 s27, 0x00020000
  s_mov_b32 s20, s10
  s_and_b32 s21, s11, 0xffff
  s_mov_b32 s22, 19267584
  s_mov_b32 s23, 0x00020000
  s_mov_b32 s36, s12
  s_and_b32 s37, s13, 0xffff
  s_mov_b32 s38, 256
  s_mov_b32 s39, 0x00020000
  s_cmp_ge_u32 s2, 180
  s_cbranch_scc1 H_join
  v_lshlrev_b32 v119, 3, v3
  v_lshl_add_u32 v119, v2, 8, v119
  v_add_u32 v119, 90112, v119
  s_waitcnt vmcnt(0)
  ds_read_b128 v[64:67], v195 offset:2048
  ds_read_b128 v[68:71], v195 offset:3072
  ds_read_b128 v[72:75], v195 offset:4096
  ds_read_b128 v[76:79], v195 offset:5120
  ds_read_b128 v[80:83], v195 offset:6144
  ds_read_b128 v[84:87], v195 offset:7168
  s_waitcnt lgkmcnt(2)
  ds_read_b64_tr_b16 v[88:89], v119 offset:8192
  ds_read_b64_tr_b16 v[90:91], v119 offset:8320
  ds_read_b64_tr_b16 v[92:93], v119 offset:9216
  ds_read_b64_tr_b16 v[94:95], v119 offset:9344
  ds_read_b64_tr_b16 v[96:97], v119 offset:10240
  ds_read_b64_tr_b16 v[98:99], v119 offset:10368
  ds_read_b64_tr_b16 v[100:101], v119 offset:11264
  ds_read_b64_tr_b16 v[102:103], v119 offset:11392
  ds_read_b64_tr_b16 v[104:105], v119 offset:12288
  ds_read_b64_tr_b16 v[106:107], v119 offset:12416
  ds_read_b64_tr_b16 v[108:109], v119 offset:13312
  ds_read_b64_tr_b16 v[110:111], v119 offset:13440
  s_waitcnt lgkmcnt(0)
  v_mfma_f32_16x16x32_bf16 v[112:115], v[64:67], v[88:91], 0
  v_mfma_f32_16x16x32_bf16 v[112:115], v[68:71], v[92:95], v[112:115]
  v_mfma_f32_16x16x32_bf16 v[112:115], v[72:75], v[96:99], v[112:115]
  v_mfma_f32_16x16x32_bf16 v[112:115], v[76:79], v[100:103], v[112:115]
  v_mfma_f32_16x16x32_bf16 v[112:115], v[80:83], v[104:107], v[112:115]
  v_mfma_f32_16x16x32_bf16 v[112:115], v[84:87], v[108:111], v[112:115]
  v_bfe_u32 v118, v3, 1, 1
  v_mul_u32_u24 v118, 12288, v118
  v_and_b32 v119, 1, v3
  v_lshl_add_u32 v118, v119, 10, v118
  v_lshrrev_b32 v119, 2, v3
  v_lshl_add_u32 v118, v119, 4, v118
  v_lshl_add_u32 v118, v2, 8, v118
  s_nop 0
  v_cvt_pk_bf16_f32 v116, v112, v113
  v_cvt_pk_bf16_f32 v117, v114, v115
  buffer_store_dwordx2 v[116:117], v118, s[24:27], s95 offen sc1
  s_branch H_join
M_comp:
  s_and_b32 s55, s2, 7
  s_lshr_b32 s56, s2, 3
  s_lshr_b32 s41, s55, 2
  s_bfe_u32 s42, s55, 0x10001
  s_and_b32 s55, s55, 1
  s_lshl_b32 s55, s55, 2
  s_lshr_b32 s43, s56, 3
  s_add_u32 s43, s43, s55
  s_and_b32 s44, s56, 7
  s_mul_i32 s43, s43, 14
  s_mul_i32 s44, s44, 14
  s_mul_i32 s61, s41, 13
  s_add_i32 s61, s61, -6
  s_cmp_eq_u32 s42, 0
  s_cselect_b32 s62, 85632, 0
  s_cselect_b32 s50, -1, 1
  s_mulk_i32 s50, 384
  s_cmp_ge_u32 s40, 4
  s_cselect_b32 s53, -4, 3
  s_add_i32 s53, s53, s40
  s_lshl_b32 s53, s53, 1
  s_add_u32 s88, s43, s53
  s_mov_b32 s89, 86016
  v_lshrrev_b32 v4, 3, v1
  v_and_b32 v5, 7, v1
  v_and_b32 v6, 6, v4
  v_xor_b32 v5, v5, v6
  v_lshl_add_u32 v5, v5, 4, s62
  v_add_u32 v8, 2, v4
  v_lshrrev_b32 v8, 3, v8
  v_add_u32 v4, s44, v4
  v_lshl_add_u32 v6, v4, 1, 7
  v_add_u32 v7, 112, v4
  v_min_u32 v6, v6, v7
  v_mad_i32_i24 v168, v6, s50, v5
  v_lshl_add_u32 v6, v4, 1, 19
  v_add_u32 v7, 118, v4
  v_min_u32 v6, v6, v7
  v_mad_i32_i24 v169, v6, s50, v5
  v_lshl_add_u32 v168, v8, 30, v168
  s_add_u32 s55, s88, 0
  s_lshl_b32 s56, s55, 1
  s_add_i32 s56, s56, s61
  s_max_i32 s56, s56, s55
  s_add_i32 s55, s55, 112
  s_min_i32 s56, s56, s55
  s_mul_i32 s84, s56, 86016
  s_add_u32 s55, s88, 1
  s_lshl_b32 s56, s55, 1
  s_add_i32 s56, s56, s61
  s_max_i32 s56, s56, s55
  s_add_i32 s55, s55, 112
  s_min_i32 s56, s56, s55
  s_mul_i32 s85, s56, 86016
  s_lshl_b32 s86, s53, 12
  s_lshl_b32 s87, s53, 11
  s_waitcnt lgkmcnt(0)
  s_mov_b32 s16, s4
  s_and_b32 s17, s5, 0xffff
  s_mov_b32 s18, 19267584
  s_mov_b32 s19, 0x00020000
  s_barrier
  s_add_u32 m0, s86, 512
  s_nop 0
  buffer_load_dwordx4 v168, s[16:19], s84 offen offset:0 lds
  s_add_u32 m0, s86, 1536
  s_nop 0
  buffer_load_dwordx4 v168, s[16:19], s85 offen offset:0 lds
  s_add_u32 m0, s86, 2560
  s_nop 0
  buffer_load_dwordx4 v169, s[16:19], s84 offen offset:0 lds
  s_add_u32 m0, s86, 3584
  s_nop 0
  buffer_load_dwordx4 v169, s[16:19], s85 offen offset:0 lds
  s_cmp_lt_u32 s2, 36
  s_cbranch_scc1 M_x1
  s_add_u32 m0, s86, 4480
  s_nop 0
  buffer_load_dwordx4 v168, s[16:19], s84 offen offset:128 lds
  s_add_u32 m0, s86, 5504
  s_nop 0
  buffer_load_dwordx4 v168, s[16:19], s85 offen offset:128 lds
  s_add_u32 m0, s86, 6528
  s_nop 0
  buffer_load_dwordx4 v169, s[16:19], s84 offen offset:128 lds
  s_add_u32 m0, s86, 7552
  s_nop 0
  buffer_load_dwordx4 v169, s[16:19], s85 offen offset:128 lds
  s_add_u32 m0, s87, 61184
  s_nop 0
  buffer_load_dwordx4 v168, s[16:19], s84 offen offset:256 lds
  s_add_u32 m0, s87, 62208
  s_nop 0
  buffer_load_dwordx4 v168, s[16:19], s85 offen offset:256 lds
  s_add_u32 m0, s87, 63232
  s_nop 0
  buffer_load_dwordx4 v169, s[16:19], s84 offen offset:256 lds
  s_add_u32 m0, s87, 64256
  s_nop 0
  buffer_load_dwordx4 v169, s[16:19], s85 offen offset:256 lds
M_x1:
  s_mov_b32 s24, s14
  s_and_b32 s25, s15, 0xffff
  s_mov_b32 s26, 268435456
  s_mov_b32 s27, 0x00020000
  s_mov_b32 s20, s10
  s_and_b32 s21, s11, 0xffff
  s_mov_b32 s22, 19267584
  s_mov_b32 s23, 0x00020000
  s_mov_b32 s36, s12
  s_and_b32 s37, s13, 0xffff
  s_mov_b32 s38, 256
  s_mov_b32 s39, 0x00020000
  s_mul_i32 s55, s41, 6
  s_add_i32 s45, s43, s55
  s_add_i32 s45, s45, -6
  s_cmp_eq_i32 s45, -6
  s_cselect_b32 s47, 6, 0
  s_cmp_eq_i32 s45, 98
  s_cselect_b32 s48, 7, 13
  s_cselect_b32 s49, 2, 0
  s_sub_i32 s45, s45, s49
  s_cmp_eq_i32 s44, 98
  s_cselect_b32 s51, 7, 13
  s_lshl_b32 s56, s44, 1
  s_add_i32 s56, s56, 1
  s_mul_i32 s46, s56, s50
  s_add_i32 s46, s46, s62
  s_lshl_b32 s91, s50, 1
  s_lshl_b32 s3, s91, 3
  s_add_i32 s91, s91, -384
  s_max_i32 s92, s53, s47
  s_min_i32 s92, s92, s48
  s_and_b32 s92, s92, -2
  s_add_u32 s52, s92, s49
  s_mov_b32 s54, 4286578688
  s_mov_b32 s63, 1037384597
  s_and_b32 s93, s40, 1
  s_lshl_b32 s93, s93, 3
  s_and_b32 s56, s40, 6
  s_or_b32 s93, s93, s56
  s_add_u32 s56, s40, 8
  s_add_i32 s100, s45, s56
  s_lshl_b32 s100, s100, 1
  s_add_i32 s100, s100, s41
  s_max_i32 s100, s100, 0
  s_min_i32 s100, s100, 223
  s_mul_i32 s100, s100, 86016
  s_mul_i32 s101, s56, 7680
  v_lshrrev_b32 v4, 3, v3
  v_add_u32 v4, s53, v4
  v_max_i32 v4, s47, v4
  v_min_i32 v4, s48, v4
  v_subrev_u32 v4, s92, v4
  v_and_b32 v5, 1, v2
  v_sub_u32 v6, v5, v4
  v_ashrrev_i32 v12, 31, v6
  v_and_b32 v12, s54, v12
  v_sub_u32 v6, v4, v5
  v_ashrrev_i32 v13, 31, v6
  v_and_b32 v13, s54, v13
  v_and_b32 v4, 7, v3
  v_lshrrev_b32 v5, 1, v2
  v_subrev_u32 v7, 6, v4
  v_ashrrev_i32 v7, 31, v7
  v_and_b32 v7, 0x7f, v7
  v_add_u32 v6, 0, v4
  v_min_i32 v6, s51, v6
  v_lshlrev_b32 v6, v6, v7
  v_lshrrev_b32 v6, v5, v6
  v_not_b32 v14, v6
  v_mov_b32 v7, 0x7f
  v_add_u32 v6, 6, v4
  v_min_i32 v6, s51, v6
  v_lshlrev_b32 v6, v6, v7
  v_lshrrev_b32 v6, v5, v6
  v_not_b32 v15, v6
  v_add_u32 v4, s52, v4
  v_and_b32 v5, 1, v4
  v_lshlrev_b32 v5, 3, v5
  v_and_or_b32 v5, v4, 6, v5
  v_mul_u32_u24 v4, 7680, v4
  v_lshrrev_b32 v6, 3, v3
  v_mul_u32_u24 v6, 24, v6
  v_add_u32 v6, v6, v2
  v_add_u32 v7, 0, v6
  v_xor_b32 v7, v7, v5
  v_lshl_add_u32 v240, v7, 4, v4
  v_add_u32 v7, 4, v6
  v_xor_b32 v7, v7, v5
  v_lshl_add_u32 v241, v7, 4, v4
  v_add_u32 v7, 8, v6
  v_xor_b32 v7, v7, v5
  v_lshl_add_u32 v242, v7, 4, v4
  v_add_u32 v7, 12, v6
  v_xor_b32 v7, v7, v5
  v_lshl_add_u32 v243, v7, 4, v4
  v_and_b32 v4, 1, v2
  v_lshlrev_b32 v4, 2, v4
  v_lshrrev_b32 v5, 2, v3
  v_add3_u32 v4, v4, v5, s52
  v_and_b32 v5, 1, v4
  v_lshlrev_b32 v5, 3, v5
  v_and_or_b32 v5, v4, 6, v5
  v_mul_u32_u24 v4, 7680, v4
  v_and_b32 v6, 1, v3
  v_lshl_add_u32 v4, v6, 3, v4
  v_lshrrev_b32 v6, 1, v2
  v_mul_u32_u24 v6, 24, v6
  v_bfe_u32 v7, v3, 1, 1
  v_add_u32 v6, v6, v7
  v_add_u32 v7, 0, v6
  v_xor_b32 v7, v7, v5
  v_lshl_add_u32 v244, v7, 4, v4
  v_add_u32 v7, 2, v6
  v_xor_b32 v7, v7, v5
  v_lshl_add_u32 v245, v7, 4, v4
  v_add_u32 v7, 4, v6
  v_xor_b32 v7, v7, v5
  v_lshl_add_u32 v246, v7, 4, v4
  v_add_u32 v7, 6, v6
  v_xor_b32 v7, v7, v5
  v_lshl_add_u32 v247, v7, 4, v4
  v_add_u32 v7, 8, v6
  v_xor_b32 v7, v7, v5
  v_lshl_add_u32 v248, v7, 4, v4
  v_add_u32 v7, 10, v6
  v_xor_b32 v7, v7, v5
  v_lshl_add_u32 v249, v7, 4, v4
  v_add_u32 v7, 12, v6
  v_xor_b32 v7, v7, v5
  v_lshl_add_u32 v250, v7, 4, v4
  v_add_u32 v7, 14, v6
  v_xor_b32 v7, v7, v5
  v_lshl_add_u32 v251, v7, 4, v4
  v_add_u32 v253, 153600, v252
  v_add_u32 v254, 90112, v252
  v_add_u32 v4, 0, v1
  v_xor_b32 v4, s93, v4
  v_mul_u32_u24 v5, 2731, v4
  v_lshrrev_b32 v5, 16, v5
  v_mul_i32_i24 v5, s91, v5
  v_lshl_add_u32 v4, v4, 4, v5
  v_add_u32 v232, s46, v4
  v_add_u32 v235, s3, v232
  v_add_u32 v238, s3, v235
  v_add_u32 v4, 64, v1
  v_xor_b32 v4, s93, v4
  v_mul_u32_u24 v5, 2731, v4
  v_lshrrev_b32 v5, 16, v5
  v_mul_i32_i24 v5, s91, v5
  v_lshl_add_u32 v4, v4, 4, v5
  v_add_u32 v233, s46, v4
  v_add_u32 v236, s3, v233
  v_add_u32 v4, 128, v1
  v_xor_b32 v4, s93, v4
  v_mul_u32_u24 v5, 2731, v4
  v_lshrrev_b32 v5, 16, v5
  v_mul_i32_i24 v5, s91, v5
  v_lshl_add_u32 v4, v4, 4, v5
  v_add_u32 v234, s46, v4
  v_add_u32 v237, s3, v234
  v_add_u32 v4, 416, v1
  v_xor_b32 v4, s93, v4
  v_mul_u32_u24 v5, 2731, v4
  v_lshrrev_b32 v5, 16, v5
  v_mul_i32_i24 v5, s91, v5
  v_lshl_add_u32 v4, v4, 4, v5
  v_add_u32 v239, s46, v4
  v_max_i32 v237, 0, v237
  v_max_i32 v238, 0, v238
  v_max_i32 v239, 0, v239
  v_lshrrev_b32 v197, 1, v2
  v_and_b32 v255, 1, v2
  v_add_u32 v197, s88, v197
  v_lshl_add_u32 v0, v255, 2, s44
  v_lshl_add_u32 v198, v197, 1, s61
  v_add_u32 v199, 112, v197
  v_lshlrev_b32 v255, 30, v255
  v_med3_i32 v197, v198, v197, v199
  v_mul_lo_u32 v197, v197, s89
  v_lshl_add_u32 v197, v3, 3, v197
  v_add_u32 v197, s62, v197
  v_lshl_add_u32 v198, v0, 1, 7
  v_add_u32 v199, 112, v0
  v_min_u32 v4, v198, v199
  v_mad_i32_i24 v4, v4, s50, v197
  v_lshl_add_u32 v198, v0, 1, 9
  v_add_u32 v199, 113, v0
  v_min_u32 v5, v198, v199
  v_mad_i32_i24 v5, v5, s50, v197
  v_lshl_add_u32 v198, v0, 1, 11
  v_add_u32 v199, 114, v0
  v_min_u32 v6, v198, v199
  v_mad_i32_i24 v6, v6, s50, v197
  v_add_u32 v6, v6, v255
  v_lshl_add_u32 v198, v0, 1, 13
  v_add_u32 v199, 115, v0
  v_min_u32 v7, v198, v199
  v_mad_i32_i24 v7, v7, s50, v197
  v_add_u32 v7, v7, v255
  v_lshl_add_u32 v198, v0, 1, 19
  v_add_u32 v199, 118, v0
  v_min_u32 v8, v198, v199
  v_mad_i32_i24 v8, v8, s50, v197
  v_lshl_add_u32 v198, v0, 1, 21
  v_add_u32 v199, 119, v0
  v_min_u32 v9, v198, v199
  v_mad_i32_i24 v9, v9, s50, v197
  v_lshl_add_u32 v198, v0, 1, 23
  v_add_u32 v199, 120, v0
  v_min_u32 v10, v198, v199
  v_mad_i32_i24 v10, v10, s50, v197
  v_lshl_add_u32 v198, v0, 1, 25
  v_add_u32 v199, 121, v0
  v_min_u32 v11, v198, v199
  v_mad_i32_i24 v11, v11, s50, v197
  v_bfe_i32 v66, v14, 0, 1
  v_and_b32 v65, s54, v66
  v_and_b32 v66, s54, v66
  v_or_b32 v64, v65, v12
  v_or_b32 v67, v65, v13
  v_bfe_i32 v70, v14, 2, 1
  v_and_b32 v69, s54, v70
  v_and_b32 v70, s54, v70
  v_or_b32 v68, v69, v12
  v_or_b32 v71, v69, v13
  v_bfe_i32 v74, v14, 4, 1
  v_and_b32 v73, s54, v74
  v_and_b32 v74, s54, v74
  v_or_b32 v72, v73, v12
  v_or_b32 v75, v73, v13
  v_bfe_i32 v78, v14, 6, 1
  v_and_b32 v77, s54, v78
  v_and_b32 v78, s54, v78
  v_or_b32 v76, v77, v12
  v_or_b32 v79, v77, v13
  v_bfe_i32 v82, v14, 8, 1
  v_and_b32 v81, s54, v82
  v_and_b32 v82, s54, v82
  v_or_b32 v80, v81, v12
  v_or_b32 v83, v81, v13
  v_bfe_i32 v86, v14, 10, 1
  v_and_b32 v85, s54, v86
  v_and_b32 v86, s54, v86
  v_or_b32 v84, v85, v12
  v_or_b32 v87, v85, v13
  v_bfe_i32 v90, v15, 6, 1
  v_and_b32 v89, s54, v90
  v_and_b32 v90, s54, v90
  v_or_b32 v88, v89, v12
  v_or_b32 v91, v89, v13
  v_bfe_i32 v94, v15, 8, 1
  v_and_b32 v93, s54, v94
  v_and_b32 v94, s54, v94
  v_or_b32 v92, v93, v12
  v_or_b32 v95, v93, v13
  v_bfe_i32 v98, v15, 10, 1
  v_and_b32 v97, s54, v98
  v_and_b32 v98, s54, v98
  v_or_b32 v96, v97, v12
  v_or_b32 v99, v97, v13
  v_bfe_i32 v102, v15, 12, 1
  v_and_b32 v101, s54, v102
  v_and_b32 v102, s54, v102
  v_or_b32 v100, v101, v12
  v_or_b32 v103, v101, v13
  v_bfe_i32 v106, v15, 14, 1
  v_and_b32 v105, s54, v106
  v_and_b32 v106, s54, v106
  v_or_b32 v104, v105, v12
  v_or_b32 v107, v105, v13
  v_bfe_i32 v110, v15, 16, 1
  v_and_b32 v109, s54, v110
  v_and_b32 v110, s54, v110
  v_or_b32 v108, v109, v12
  v_or_b32 v111, v109, v13
  v_bfe_i32 v114, v15, 18, 1
  v_and_b32 v113, s54, v114
  v_and_b32 v114, s54, v114
  v_or_b32 v112, v113, v12
  v_or_b32 v115, v113, v13
  v_and_b32 v170, 6, v3
  v_xor_b32 v170, v170, v2
  v_lshlrev_b32 v174, 7, v3
  v_xor_b32 v171, 4, v170
  v_lshl_add_u32 v170, v170, 4, v174
  v_lshl_add_u32 v171, v171, 4, v174
  v_add_u32 v172, s87, v170
  v_add_u32 v170, s86, v170
  v_add_u32 v173, s87, v171
  v_add_u32 v171, s86, v171
  s_cmp_ge_u32 s2, 36
  s_cbranch_scc1 M_x2
  s_barrier
  s_add_u32 m0, s86, 4480
  s_nop 0
  buffer_load_dwordx4 v168, s[16:19], s84 offen offset:128 lds
  s_add_u32 m0, s86, 5504
  s_nop 0
  buffer_load_dwordx4 v168, s[16:19], s85 offen offset:128 lds
  s_add_u32 m0, s86, 6528
  s_nop 0
  buffer_load_dwordx4 v169, s[16:19], s84 offen offset:128 lds
  s_add_u32 m0, s86, 7552
  s_nop 0
  buffer_load_dwordx4 v169, s[16:19], s85 offen offset:128 lds
  s_barrier
  s_add_u32 m0, s87, 61184
  s_nop 0
  buffer_load_dwordx4 v168, s[16:19], s84 offen offset:256 lds
  s_add_u32 m0, s87, 62208
  s_nop 0
  buffer_load_dwordx4 v168, s[16:19], s85 offen offset:256 lds
  s_add_u32 m0, s87, 63232
  s_nop 0
  buffer_load_dwordx4 v169, s[16:19], s84 offen offset:256 lds
  s_add_u32 m0, s87, 64256
  s_nop 0
  buffer_load_dwordx4 v169, s[16:19], s85 offen offset:256 lds
M_x2:
  s_waitcnt vmcnt(8)
  ds_read_b128 v[16:19], v170 offset:512
  ds_read_b128 v[20:23], v171 offset:512
  ds_read_b128 v[40:43], v170 offset:2560
  ds_read_b128 v[44:47], v171 offset:2560
  s_waitcnt vmcnt(4)
  ds_read_b128 v[24:27], v170 offset:4608
  ds_read_b128 v[28:31], v171 offset:4608
  ds_read_b128 v[48:51], v170 offset:6656
  ds_read_b128 v[52:55], v171 offset:6656
  s_waitcnt vmcnt(0)
  ds_read_b128 v[32:35], v172 offset:61440
  ds_read_b128 v[36:39], v173 offset:61440
  ds_read_b128 v[56:59], v172 offset:63488
  ds_read_b128 v[60:63], v173 offset:63488
  s_add_i32 s57, s45, s40
  s_lshl_b32 s57, s57, 1
  s_add_i32 s57, s57, s41
  s_max_i32 s57, s57, 0
  s_min_i32 s57, s57, 223
  s_mul_i32 s57, s57, 86016
  s_waitcnt lgkmcnt(0)
  s_barrier
  s_cmp_lt_u32 s40, 1
  s_cbranch_scc1 M_er
  s_add_u32 m0, s101, -61440
  s_nop 0
  buffer_load_dwordx4 v232, s[16:19], s57 offen lds
  s_add_u32 m0, s101, -60416
  s_nop 0
  buffer_load_dwordx4 v233, s[16:19], s57 offen lds
  s_add_u32 m0, s101, -59392
  s_nop 0
  buffer_load_dwordx4 v234, s[16:19], s57 offen lds
  s_add_u32 m0, s101, -58368
  s_nop 0
  buffer_load_dwordx4 v235, s[16:19], s57 offen lds
  s_add_u32 m0, s101, -57344
  s_nop 0
  buffer_load_dwordx4 v236, s[16:19], s57 offen lds
  s_add_u32 m0, s101, -56320
  s_nop 0
  buffer_load_dwordx4 v237, s[16:19], s57 offen lds
  s_add_u32 m0, s101, -55296
  s_nop 0
  buffer_load_dwordx4 v238, s[16:19], s57 offen lds
  s_add_u32 m0, s101, -54784
  s_nop 0
  buffer_load_dwordx4 v239, s[16:19], s57 offen lds
M_er:
  s_barrier
  s_cmp_lt_u32 s40, 4
  s_cbranch_scc1 M_xl
  s_setprio 1
  s_barrier
  s_branch M_pa
M_xl:
  s_lshl_b32 s55, s40, 10
  s_add_u32 s55, s55, 131072
  s_sub_u32 m0, s55, 40960
  s_nop 0
  buffer_load_dwordx4 v252, s[24:27], s55 offen sc1 lds
  s_add_u32 s55, s55, 4096
  s_sub_u32 m0, s55, 40960
  s_nop 0
  buffer_load_dwordx4 v252, s[24:27], s55 offen sc1 lds
  s_add_u32 s55, s55, 4096
  s_sub_u32 m0, s55, 40960
  s_nop 0
  buffer_load_dwordx4 v252, s[24:27], s55 offen sc1 lds
  s_add_u32 s55, s55, 4096
  s_sub_u32 m0, s55, 40960
  s_nop 0
  buffer_load_dwordx4 v252, s[24:27], s55 offen sc1 lds
  s_add_u32 s55, s55, 4096
  s_sub_u32 m0, s55, 40960
  s_nop 0
  buffer_load_dwordx4 v252, s[24:27], s55 offen sc1 lds
  s_add_u32 s55, s55, 4096
  s_sub_u32 m0, s55, 40960
  s_nop 0
  buffer_load_dwordx4 v252, s[24:27], s55 offen sc1 lds
  s_add_u32 s55, s55, 4096
  s_sub_u32 m0, s55, 40960
  s_nop 0
  buffer_load_dwordx4 v252, s[24:27], s55 offen sc1 lds
  s_add_u32 s55, s55, 4096
  s_sub_u32 m0, s55, 40960
  s_nop 0
  buffer_load_dwordx4 v252, s[24:27], s55 offen sc1 lds
  s_add_u32 s55, s55, 4096
  s_sub_u32 m0, s55, 40960
  s_nop 0
  buffer_load_dwordx4 v252, s[24:27], s55 offen sc1 lds
  s_add_u32 s55, s55, 4096
  s_sub_u32 m0, s55, 40960
  s_nop 0
  buffer_load_dwordx4 v252, s[24:27], s55 offen sc1 lds
  s_add_u32 s55, s55, 4096
  s_sub_u32 m0, s55, 40960
  s_nop 0
  buffer_load_dwordx4 v252, s[24:27], s55 offen sc1 lds
  s_add_u32 s55, s55, 4096
  s_sub_u32 m0, s55, 40960
  s_nop 0
  buffer_load_dwordx4 v252, s[24:27], s55 offen sc1 lds
  s_waitcnt vmcnt(6)
  s_barrier
  s_lshl_b32 s55, s40, 10
  s_add_u32 s55, s55, 180224
  s_sub_u32 m0, s55, 40960
  s_nop 0
  buffer_load_dwordx4 v252, s[24:27], s55 offen sc1 lds
  s_add_u32 s55, s55, 4096
  s_sub_u32 m0, s55, 40960
  s_nop 0
  buffer_load_dwordx4 v252, s[24:27], s55 offen sc1 lds
  s_add_u32 s55, s55, 4096
  s_sub_u32 m0, s55, 40960
  s_nop 0
  buffer_load_dwordx4 v252, s[24:27], s55 offen sc1 lds
  s_add_u32 s55, s55, 4096
  s_sub_u32 m0, s55, 40960
  s_nop 0
  buffer_load_dwordx4 v252, s[24:27], s55 offen sc1 lds
  s_add_u32 s55, s55, 4096
  s_sub_u32 m0, s55, 40960
  s_nop 0
  buffer_load_dwordx4 v252, s[24:27], s55 offen sc1 lds
  s_add_u32 s55, s55, 4096
  s_sub_u32 m0, s55, 40960
  s_nop 0
  buffer_load_dwordx4 v252, s[24:27], s55 offen sc1 lds
M_pa:
  ds_read_b128 v[200:203], v254 offset:0
  ds_read_b128 v[204:207], v254 offset:1024
  ds_read_b128 v[208:211], v254 offset:2048
  ds_read_b128 v[212:215], v254 offset:3072
  ds_read_b128 v[216:219], v254 offset:4096
  ds_read_b128 v[220:223], v254 offset:5120
  s_waitcnt lgkmcnt(5)
  v_mfma_f32_16x16x32_bf16 v[168:171], v[200:203], v[16:19], 0
  ds_read_b128 v[224:227], v254 offset:6144
  v_mfma_f32_16x16x32_bf16 v[176:179], v[200:203], v[40:43], 0
  s_waitcnt lgkmcnt(5)
  v_mfma_f32_16x16x32_bf16 v[172:175], v[204:207], v[16:19], 0
  ds_read_b128 v[228:231], v254 offset:7168
  v_mfma_f32_16x16x32_bf16 v[180:183], v[204:207], v[40:43], 0
  s_waitcnt lgkmcnt(5)
  v_mfma_f32_16x16x32_bf16 v[168:171], v[208:211], v[20:23], v[168:171]
  ds_read_b128 v[200:203], v254 offset:8192
  v_mfma_f32_16x16x32_bf16 v[176:179], v[208:211], v[44:47], v[176:179]
  s_waitcnt lgkmcnt(5)
  v_mfma_f32_16x16x32_bf16 v[172:175], v[212:215], v[20:23], v[172:175]
  ds_read_b128 v[204:207], v254 offset:9216
  v_mfma_f32_16x16x32_bf16 v[180:183], v[212:215], v[44:47], v[180:183]
  s_waitcnt lgkmcnt(5)
  v_mfma_f32_16x16x32_bf16 v[168:171], v[216:219], v[24:27], v[168:171]
  ds_read_b128 v[208:211], v254 offset:10240
  v_mfma_f32_16x16x32_bf16 v[176:179], v[216:219], v[48:51], v[176:179]
  s_waitcnt lgkmcnt(5)
  v_mfma_f32_16x16x32_bf16 v[172:175], v[220:223], v[24:27], v[172:175]
  ds_read_b128 v[212:215], v254 offset:11264
  v_mfma_f32_16x16x32_bf16 v[180:183], v[220:223], v[48:51], v[180:183]
  s_waitcnt lgkmcnt(5)
  v_mfma_f32_16x16x32_bf16 v[168:171], v[224:227], v[28:31], v[168:171]
  ds_read_b128 v[216:219], v254 offset:12288
  v_mfma_f32_16x16x32_bf16 v[176:179], v[224:227], v[52:55], v[176:179]
  s_waitcnt lgkmcnt(5)
  v_mfma_f32_16x16x32_bf16 v[172:175], v[228:231], v[28:31], v[172:175]
  ds_read_b128 v[220:223], v254 offset:13312
  v_mfma_f32_16x16x32_bf16 v[180:183], v[228:231], v[52:55], v[180:183]
  s_waitcnt lgkmcnt(5)
  v_mfma_f32_16x16x32_bf16 v[168:171], v[200:203], v[32:35], v[168:171]
  ds_read_b128 v[224:227], v254 offset:14336
  v_mfma_f32_16x16x32_bf16 v[176:179], v[200:203], v[56:59], v[176:179]
  s_waitcnt lgkmcnt(5)
  v_mfma_f32_16x16x32_bf16 v[172:175], v[204:207], v[32:35], v[172:175]
  ds_read_b128 v[228:231], v254 offset:15360
  v_mfma_f32_16x16x32_bf16 v[180:183], v[204:207], v[56:59], v[180:183]
  s_waitcnt lgkmcnt(5)
  v_mfma_f32_16x16x32_bf16 v[168:171], v[208:211], v[36:39], v[168:171]
  ds_read_b128 v[200:203], v254 offset:16384
  v_mfma_f32_16x16x32_bf16 v[176:179], v[208:211], v[60:63], v[176:179]
  s_waitcnt lgkmcnt(5)
  v_mfma_f32_16x16x32_bf16 v[172:175], v[212:215], v[36:39], v[172:175]
  ds_read_b128 v[204:207], v254 offset:17408
  v_mfma_f32_16x16x32_bf16 v[180:183], v[212:215], v[60:63], v[180:183]
  s_waitcnt lgkmcnt(5)
  v_mfma_f32_16x16x32_bf16 v[184:187], v[216:219], v[16:19], 0
  ds_read_b128 v[208:211], v254 offset:18432
  v_mfma_f32_16x16x32_bf16 v[192:195], v[216:219], v[40:43], 0
  s_waitcnt lgkmcnt(5)
  v_mfma_f32_16x16x32_bf16 v[188:191], v[220:223], v[16:19], 0
  ds_read_b128 v[212:215], v254 offset:19456
  v_cvt_pk_bf16_f32 v120, v168, v169
  v_mfma_f32_16x16x32_bf16 v[196:199], v[220:223], v[40:43], 0
  s_waitcnt lgkmcnt(5)
  v_cvt_pk_bf16_f32 v121, v170, v171
  v_cvt_pk_bf16_f32 v122, v172, v173
  v_mfma_f32_16x16x32_bf16 v[184:187], v[224:227], v[20:23], v[184:187]
  ds_read_b128 v[216:219], v254 offset:20480
  v_cvt_pk_bf16_f32 v123, v174, v175
  v_mfma_f32_16x16x32_bf16 v[192:195], v[224:227], v[44:47], v[192:195]
  s_waitcnt lgkmcnt(5)
  v_cvt_pk_bf16_f32 v144, v176, v177
  v_cvt_pk_bf16_f32 v145, v178, v179
  v_mfma_f32_16x16x32_bf16 v[188:191], v[228:231], v[20:23], v[188:191]
  ds_read_b128 v[220:223], v254 offset:21504
  v_cvt_pk_bf16_f32 v146, v180, v181
  v_mfma_f32_16x16x32_bf16 v[196:199], v[228:231], v[44:47], v[196:199]
  s_waitcnt lgkmcnt(5)
  v_cvt_pk_bf16_f32 v147, v182, v183
  v_mfma_f32_16x16x32_bf16 v[184:187], v[200:203], v[24:27], v[184:187]
  ds_read_b128 v[224:227], v254 offset:22528
  v_mfma_f32_16x16x32_bf16 v[192:195], v[200:203], v[48:51], v[192:195]
  s_waitcnt lgkmcnt(5)
  v_mfma_f32_16x16x32_bf16 v[188:191], v[204:207], v[24:27], v[188:191]
  ds_read_b128 v[228:231], v254 offset:23552
  v_mfma_f32_16x16x32_bf16 v[196:199], v[204:207], v[48:51], v[196:199]
  s_waitcnt vmcnt(0)
  s_barrier
  s_waitcnt lgkmcnt(5)
  v_mfma_f32_16x16x32_bf16 v[184:187], v[208:211], v[28:31], v[184:187]
  ds_read_b128 v[200:203], v254 offset:24576
  v_mfma_f32_16x16x32_bf16 v[192:195], v[208:211], v[52:55], v[192:195]
  s_waitcnt lgkmcnt(5)
  v_mfma_f32_16x16x32_bf16 v[188:191], v[212:215], v[28:31], v[188:191]
  ds_read_b128 v[204:207], v254 offset:25600
  v_mfma_f32_16x16x32_bf16 v[196:199], v[212:215], v[52:55], v[196:199]
  s_waitcnt lgkmcnt(5)
  v_mfma_f32_16x16x32_bf16 v[184:187], v[216:219], v[32:35], v[184:187]
  ds_read_b128 v[208:211], v254 offset:26624
  v_mfma_f32_16x16x32_bf16 v[192:195], v[216:219], v[56:59], v[192:195]
  s_waitcnt lgkmcnt(5)
  v_mfma_f32_16x16x32_bf16 v[188:191], v[220:223], v[32:35], v[188:191]
  ds_read_b128 v[212:215], v254 offset:27648
  v_mfma_f32_16x16x32_bf16 v[196:199], v[220:223], v[56:59], v[196:199]
  s_waitcnt lgkmcnt(5)
  v_mfma_f32_16x16x32_bf16 v[184:187], v[224:227], v[36:39], v[184:187]
  ds_read_b128 v[216:219], v254 offset:28672
  v_mfma_f32_16x16x32_bf16 v[192:195], v[224:227], v[60:63], v[192:195]
  s_waitcnt lgkmcnt(5)
  v_mfma_f32_16x16x32_bf16 v[188:191], v[228:231], v[36:39], v[188:191]
  ds_read_b128 v[220:223], v254 offset:29696
  v_mfma_f32_16x16x32_bf16 v[196:199], v[228:231], v[60:63], v[196:199]
  s_waitcnt lgkmcnt(5)
  v_mfma_f32_16x16x32_bf16 v[168:171], v[200:203], v[16:19], 0
  ds_read_b128 v[224:227], v254 offset:30720
  v_mfma_f32_16x16x32_bf16 v[176:179], v[200:203], v[40:43], 0
  s_waitcnt lgkmcnt(5)
  v_mfma_f32_16x16x32_bf16 v[172:175], v[204:207], v[16:19], 0
  ds_read_b128 v[228:231], v254 offset:31744
  v_cvt_pk_bf16_f32 v124, v184, v185
  v_mfma_f32_16x16x32_bf16 v[180:183], v[204:207], v[40:43], 0
  s_waitcnt lgkmcnt(5)
  v_cvt_pk_bf16_f32 v125, v186, v187
  v_cvt_pk_bf16_f32 v126, v188, v189
  v_mfma_f32_16x16x32_bf16 v[168:171], v[208:211], v[20:23], v[168:171]
  ds_read_b128 v[200:203], v254 offset:32768
  v_cvt_pk_bf16_f32 v127, v190, v191
  v_mfma_f32_16x16x32_bf16 v[176:179], v[208:211], v[44:47], v[176:179]
  s_waitcnt lgkmcnt(5)
  v_cvt_pk_bf16_f32 v148, v192, v193
  v_cvt_pk_bf16_f32 v149, v194, v195
  v_mfma_f32_16x16x32_bf16 v[172:175], v[212:215], v[20:23], v[172:175]
  ds_read_b128 v[204:207], v254 offset:33792
  v_cvt_pk_bf16_f32 v150, v196, v197
  v_mfma_f32_16x16x32_bf16 v[180:183], v[212:215], v[44:47], v[180:183]
  s_waitcnt lgkmcnt(5)
  v_cvt_pk_bf16_f32 v151, v198, v199
  v_mfma_f32_16x16x32_bf16 v[168:171], v[216:219], v[24:27], v[168:171]
  ds_read_b128 v[208:211], v254 offset:34816
  v_mfma_f32_16x16x32_bf16 v[176:179], v[216:219], v[48:51], v[176:179]
  s_waitcnt lgkmcnt(5)
  v_mfma_f32_16x16x32_bf16 v[172:175], v[220:223], v[24:27], v[172:175]
  ds_read_b128 v[212:215], v254 offset:35840
  v_mfma_f32_16x16x32_bf16 v[180:183], v[220:223], v[48:51], v[180:183]
  s_waitcnt lgkmcnt(5)
  v_mfma_f32_16x16x32_bf16 v[168:171], v[224:227], v[28:31], v[168:171]
  ds_read_b128 v[216:219], v254 offset:36864
  v_mfma_f32_16x16x32_bf16 v[176:179], v[224:227], v[52:55], v[176:179]
  s_waitcnt lgkmcnt(5)
  v_mfma_f32_16x16x32_bf16 v[172:175], v[228:231], v[28:31], v[172:175]
  ds_read_b128 v[220:223], v254 offset:37888
  v_mfma_f32_16x16x32_bf16 v[180:183], v[228:231], v[52:55], v[180:183]
  s_waitcnt lgkmcnt(5)
  v_mfma_f32_16x16x32_bf16 v[168:171], v[200:203], v[32:35], v[168:171]
  ds_read_b128 v[224:227], v254 offset:38912
  v_mfma_f32_16x16x32_bf16 v[176:179], v[200:203], v[56:59], v[176:179]
  s_waitcnt lgkmcnt(5)
  v_mfma_f32_16x16x32_bf16 v[172:175], v[204:207], v[32:35], v[172:175]
  ds_read_b128 v[228:231], v254 offset:39936
  v_mfma_f32_16x16x32_bf16 v[180:183], v[204:207], v[56:59], v[180:183]
  s_waitcnt lgkmcnt(5)
  v_mfma_f32_16x16x32_bf16 v[168:171], v[208:211], v[36:39], v[168:171]
  ds_read_b128 v[200:203], v254 offset:40960
  v_mfma_f32_16x16x32_bf16 v[176:179], v[208:211], v[60:63], v[176:179]
  s_waitcnt lgkmcnt(5)
  v_mfma_f32_16x16x32_bf16 v[172:175], v[212:215], v[36:39], v[172:175]
  ds_read_b128 v[204:207], v254 offset:41984
  v_mfma_f32_16x16x32_bf16 v[180:183], v[212:215], v[60:63], v[180:183]
  s_barrier
  s_waitcnt lgkmcnt(5)
  v_mfma_f32_16x16x32_bf16 v[184:187], v[216:219], v[16:19], 0
  ds_read_b128 v[208:211], v254 offset:43008
  v_mfma_f32_16x16x32_bf16 v[192:195], v[216:219], v[40:43], 0
  s_waitcnt lgkmcnt(5)
  v_mfma_f32_16x16x32_bf16 v[188:191], v[220:223], v[16:19], 0
  ds_read_b128 v[212:215], v254 offset:44032
  v_cvt_pk_bf16_f32 v128, v168, v169
  v_mfma_f32_16x16x32_bf16 v[196:199], v[220:223], v[40:43], 0
  s_waitcnt lgkmcnt(5)
  v_cvt_pk_bf16_f32 v129, v170, v171
  v_cvt_pk_bf16_f32 v130, v172, v173
  v_mfma_f32_16x16x32_bf16 v[184:187], v[224:227], v[20:23], v[184:187]
  ds_read_b128 v[216:219], v254 offset:45056
  v_cvt_pk_bf16_f32 v131, v174, v175
  v_mfma_f32_16x16x32_bf16 v[192:195], v[224:227], v[44:47], v[192:195]
  s_waitcnt lgkmcnt(5)
  v_cvt_pk_bf16_f32 v152, v176, v177
  v_cvt_pk_bf16_f32 v153, v178, v179
  v_mfma_f32_16x16x32_bf16 v[188:191], v[228:231], v[20:23], v[188:191]
  ds_read_b128 v[220:223], v254 offset:46080
  v_cvt_pk_bf16_f32 v154, v180, v181
  v_mfma_f32_16x16x32_bf16 v[196:199], v[228:231], v[44:47], v[196:199]
  s_waitcnt lgkmcnt(5)
  v_cvt_pk_bf16_f32 v155, v182, v183
  v_mfma_f32_16x16x32_bf16 v[184:187], v[200:203], v[24:27], v[184:187]
  ds_read_b128 v[224:227], v254 offset:47104
  v_mfma_f32_16x16x32_bf16 v[192:195], v[200:203], v[48:51], v[192:195]
  s_waitcnt lgkmcnt(5)
  v_mfma_f32_16x16x32_bf16 v[188:191], v[204:207], v[24:27], v[188:191]
  ds_read_b128 v[228:231], v254 offset:48128
  v_mfma_f32_16x16x32_bf16 v[196:199], v[204:207], v[48:51], v[196:199]
  s_waitcnt lgkmcnt(5)
  v_mfma_f32_16x16x32_bf16 v[184:187], v[208:211], v[28:31], v[184:187]
  ds_read_b128 v[200:203], v254 offset:49152
  v_mfma_f32_16x16x32_bf16 v[192:195], v[208:211], v[52:55], v[192:195]
  s_waitcnt lgkmcnt(5)
  v_mfma_f32_16x16x32_bf16 v[188:191], v[212:215], v[28:31], v[188:191]
  ds_read_b128 v[204:207], v254 offset:50176
  v_mfma_f32_16x16x32_bf16 v[196:199], v[212:215], v[52:55], v[196:199]
  s_waitcnt lgkmcnt(5)
  v_mfma_f32_16x16x32_bf16 v[184:187], v[216:219], v[32:35], v[184:187]
  ds_read_b128 v[208:211], v254 offset:51200
  v_mfma_f32_16x16x32_bf16 v[192:195], v[216:219], v[56:59], v[192:195]
  s_waitcnt lgkmcnt(5)
  v_mfma_f32_16x16x32_bf16 v[188:191], v[220:223], v[32:35], v[188:191]
  ds_read_b128 v[212:215], v254 offset:52224
  v_mfma_f32_16x16x32_bf16 v[196:199], v[220:223], v[56:59], v[196:199]
  s_waitcnt lgkmcnt(5)
  v_mfma_f32_16x16x32_bf16 v[184:187], v[224:227], v[36:39], v[184:187]
  ds_read_b128 v[216:219], v254 offset:53248
  v_mfma_f32_16x16x32_bf16 v[192:195], v[224:227], v[60:63], v[192:195]
  s_waitcnt lgkmcnt(5)
  v_mfma_f32_16x16x32_bf16 v[188:191], v[228:231], v[36:39], v[188:191]
  ds_read_b128 v[220:223], v254 offset:54272
  v_mfma_f32_16x16x32_bf16 v[196:199], v[228:231], v[60:63], v[196:199]
  s_waitcnt lgkmcnt(5)
  v_mfma_f32_16x16x32_bf16 v[168:171], v[200:203], v[16:19], 0
  ds_read_b128 v[224:227], v254 offset:55296
  v_mfma_f32_16x16x32_bf16 v[176:179], v[200:203], v[40:43], 0
  s_waitcnt lgkmcnt(5)
  ds_read_b128 v[232:235], v254 offset:61440
  v_mfma_f32_16x16x32_bf16 v[172:175], v[204:207], v[16:19], 0
  ds_read_b128 v[228:231], v254 offset:56320
  v_cvt_pk_bf16_f32 v132, v184, v185
  v_mfma_f32_16x16x32_bf16 v[180:183], v[204:207], v[40:43], 0
  s_waitcnt lgkmcnt(6)
  ds_read_b128 v[236:239], v254 offset:62464
  v_cvt_pk_bf16_f32 v133, v186, v187
  v_mfma_f32_16x16x32_bf16 v[168:171], v[208:211], v[20:23], v[168:171]
  ds_read_b128 v[200:203], v254 offset:57344
  v_cvt_pk_bf16_f32 v134, v188, v189
  v_mfma_f32_16x16x32_bf16 v[176:179], v[208:211], v[44:47], v[176:179]
  s_waitcnt lgkmcnt(7)
  v_cvt_pk_bf16_f32 v135, v190, v191
  v_cvt_pk_bf16_f32 v156, v192, v193
  v_mfma_f32_16x16x32_bf16 v[172:175], v[212:215], v[20:23], v[172:175]
  ds_read_b128 v[204:207], v254 offset:58368
  v_cvt_pk_bf16_f32 v157, v194, v195
  v_mfma_f32_16x16x32_bf16 v[180:183], v[212:215], v[44:47], v[180:183]
  s_waitcnt lgkmcnt(7)
  v_cvt_pk_bf16_f32 v158, v196, v197
  v_cvt_pk_bf16_f32 v159, v198, v199
  v_mfma_f32_16x16x32_bf16 v[168:171], v[216:219], v[24:27], v[168:171]
  ds_read_b128 v[208:211], v254 offset:59392
  v_mfma_f32_16x16x32_bf16 v[176:179], v[216:219], v[48:51], v[176:179]
  s_waitcnt lgkmcnt(7)
  v_mfma_f32_16x16x32_bf16 v[172:175], v[220:223], v[24:27], v[172:175]
  ds_read_b128 v[212:215], v254 offset:60416
  v_mfma_f32_16x16x32_bf16 v[180:183], v[220:223], v[48:51], v[180:183]
  s_waitcnt lgkmcnt(7)
  v_mfma_f32_16x16x32_bf16 v[168:171], v[224:227], v[28:31], v[168:171]
  v_mfma_f32_16x16x32_bf16 v[176:179], v[224:227], v[52:55], v[176:179]
  s_waitcnt lgkmcnt(5)
  v_mfma_f32_16x16x32_bf16 v[172:175], v[228:231], v[28:31], v[172:175]
  v_mfma_f32_16x16x32_bf16 v[180:183], v[228:231], v[52:55], v[180:183]
  s_waitcnt lgkmcnt(3)
  v_mfma_f32_16x16x32_bf16 v[168:171], v[200:203], v[32:35], v[168:171]
  ds_read_b128 v[224:227], v253 offset:0
  v_mfma_f32_16x16x32_bf16 v[176:179], v[200:203], v[56:59], v[176:179]
  s_waitcnt lgkmcnt(3)
  v_mfma_f32_16x16x32_bf16 v[172:175], v[204:207], v[32:35], v[172:175]
  ds_read_b128 v[228:231], v253 offset:1024
  v_mfma_f32_16x16x32_bf16 v[180:183], v[204:207], v[56:59], v[180:183]
  s_waitcnt lgkmcnt(3)
  v_mfma_f32_16x16x32_bf16 v[168:171], v[208:211], v[36:39], v[168:171]
  ds_read_b128 v[200:203], v253 offset:2048
  v_mfma_f32_16x16x32_bf16 v[176:179], v[208:211], v[60:63], v[176:179]
  s_waitcnt lgkmcnt(3)
  v_mfma_f32_16x16x32_bf16 v[172:175], v[212:215], v[36:39], v[172:175]
  ds_read_b128 v[204:207], v253 offset:3072
  v_mfma_f32_16x16x32_bf16 v[180:183], v[212:215], v[60:63], v[180:183]
  s_waitcnt vmcnt(0)
  s_barrier
  s_setprio 2
  s_cmp_lt_u32 s40, 4
  s_cbranch_scc1 M_pr1
  s_setprio 3
M_pr1:
  v_mfma_f32_16x16x32_bf16 v[184:187], v[232:235], v[16:19], 0
  ds_read_b128 v[208:211], v253 offset:4096
  v_mfma_f32_16x16x32_bf16 v[192:195], v[232:235], v[40:43], 0
  v_mfma_f32_16x16x32_bf16 v[188:191], v[236:239], v[16:19], 0
  ds_read_b128 v[212:215], v253 offset:5120
  v_cvt_pk_bf16_f32 v136, v168, v169
  v_mfma_f32_16x16x32_bf16 v[196:199], v[236:239], v[40:43], 0
  s_waitcnt lgkmcnt(5)
  v_cvt_pk_bf16_f32 v137, v170, v171
  v_cvt_pk_bf16_f32 v138, v172, v173
  v_mfma_f32_16x16x32_bf16 v[184:187], v[224:227], v[20:23], v[184:187]
  ds_read_b128 v[216:219], v253 offset:6144
  v_cvt_pk_bf16_f32 v139, v174, v175
  v_mfma_f32_16x16x32_bf16 v[192:195], v[224:227], v[44:47], v[192:195]
  s_waitcnt lgkmcnt(5)
  v_cvt_pk_bf16_f32 v160, v176, v177
  v_cvt_pk_bf16_f32 v161, v178, v179
  v_mfma_f32_16x16x32_bf16 v[188:191], v[228:231], v[20:23], v[188:191]
  ds_read_b128 v[220:223], v253 offset:7168
  v_cvt_pk_bf16_f32 v162, v180, v181
  v_mfma_f32_16x16x32_bf16 v[196:199], v[228:231], v[44:47], v[196:199]
  s_waitcnt lgkmcnt(5)
  v_cvt_pk_bf16_f32 v163, v182, v183
  v_mfma_f32_16x16x32_bf16 v[184:187], v[200:203], v[24:27], v[184:187]
  ds_read_b128 v[224:227], v253 offset:8192
  v_mfma_f32_16x16x32_bf16 v[192:195], v[200:203], v[48:51], v[192:195]
  s_waitcnt lgkmcnt(5)
  v_mfma_f32_16x16x32_bf16 v[188:191], v[204:207], v[24:27], v[188:191]
  ds_read_b128 v[228:231], v253 offset:9216
  v_mfma_f32_16x16x32_bf16 v[196:199], v[204:207], v[48:51], v[196:199]
  s_waitcnt lgkmcnt(5)
  v_mfma_f32_16x16x32_bf16 v[184:187], v[208:211], v[28:31], v[184:187]
  v_mfma_f32_16x16x32_bf16 v[192:195], v[208:211], v[52:55], v[192:195]
  s_waitcnt lgkmcnt(4)
  v_mfma_f32_16x16x32_bf16 v[188:191], v[212:215], v[28:31], v[188:191]
  v_mfma_f32_16x16x32_bf16 v[196:199], v[212:215], v[52:55], v[196:199]
  s_waitcnt lgkmcnt(3)
  v_mfma_f32_16x16x32_bf16 v[184:187], v[216:219], v[32:35], v[184:187]
  v_mfma_f32_16x16x32_bf16 v[192:195], v[216:219], v[56:59], v[192:195]
  s_waitcnt lgkmcnt(2)
  v_mfma_f32_16x16x32_bf16 v[188:191], v[220:223], v[32:35], v[188:191]
  v_mfma_f32_16x16x32_bf16 v[196:199], v[220:223], v[56:59], v[196:199]
  s_waitcnt lgkmcnt(1)
  v_mfma_f32_16x16x32_bf16 v[184:187], v[224:227], v[36:39], v[184:187]
  v_mfma_f32_16x16x32_bf16 v[192:195], v[224:227], v[60:63], v[192:195]
  s_waitcnt lgkmcnt(0)
  v_mfma_f32_16x16x32_bf16 v[188:191], v[228:231], v[36:39], v[188:191]
  v_mfma_f32_16x16x32_bf16 v[196:199], v[228:231], v[60:63], v[196:199]
  s_cmp_ge_u32 s40, 4
  s_cbranch_scc1 M_l1
  s_barrier
M_l1:
  ds_read_b128 v[200:203], v240 offset:0
  ds_read_b128 v[204:207], v240 offset:2304
  ds_read_b128 v[208:211], v241 offset:0
  ds_read_b128 v[212:215], v241 offset:2304
  ds_read_b128 v[216:219], v242 offset:0
  ds_read_b128 v[220:223], v242 offset:2304
  ds_read_b128 v[224:227], v243 offset:0
  v_cvt_pk_bf16_f32 v140, v184, v185
  v_cvt_pk_bf16_f32 v141, v186, v187
  v_cvt_pk_bf16_f32 v142, v188, v189
  v_cvt_pk_bf16_f32 v143, v190, v191
  v_cvt_pk_bf16_f32 v164, v192, v193
  v_cvt_pk_bf16_f32 v165, v194, v195
  v_cvt_pk_bf16_f32 v166, v196, v197
  v_cvt_pk_bf16_f32 v167, v198, v199
  s_mov_b32 s56, 0xff7fffff
  s_waitcnt lgkmcnt(6)
  v_mfma_f32_16x16x32_bf16 v[64:67], v[200:203], v[120:123], v[64:67]
  s_waitcnt lgkmcnt(5)
  ds_read_b128 v[228:231], v243 offset:2304
  v_mov_b32 v32, 0
  v_mfma_f32_16x16x32_bf16 v[76:79], v[204:207], v[120:123], v[76:79]
  v_mov_b32 v33, 0
  v_mov_b32 v48, 0x3f803f80
  v_mfma_f32_16x16x32_bf16 v[88:91], v[204:207], v[144:147], v[88:91]
  s_waitcnt lgkmcnt(5)
  ds_read_b128 v[200:203], v240 offset:256
  v_mov_b32 v49, 0x3f803f80
  v_mfma_f32_16x16x32_bf16 v[64:67], v[208:211], v[124:127], v[64:67]
  s_waitcnt lgkmcnt(5)
  ds_read_b128 v[204:207], v240 offset:2560
  v_mov_b32 v50, 0x3f803f80
  v_mfma_f32_16x16x32_bf16 v[76:79], v[212:215], v[124:127], v[76:79]
  v_mov_b32 v51, 0x3f803f80
  v_mfma_f32_16x16x32_bf16 v[88:91], v[212:215], v[148:151], v[88:91]
  s_waitcnt lgkmcnt(5)
  ds_read_b128 v[208:211], v241 offset:256
  v_mfma_f32_16x16x32_bf16 v[64:67], v[216:219], v[128:131], v[64:67]
  s_waitcnt lgkmcnt(5)
  ds_read_b128 v[212:215], v241 offset:2560
  v_mfma_f32_16x16x32_bf16 v[76:79], v[220:223], v[128:131], v[76:79]
  v_mfma_f32_16x16x32_bf16 v[88:91], v[220:223], v[152:155], v[88:91]
  s_waitcnt lgkmcnt(5)
  ds_read_b128 v[216:219], v240 offset:768
  v_mfma_f32_16x16x32_bf16 v[64:67], v[224:227], v[132:135], v[64:67]
  s_waitcnt lgkmcnt(5)
  ds_read_b128 v[220:223], v240 offset:3072
  v_mfma_f32_16x16x32_bf16 v[76:79], v[228:231], v[132:135], v[76:79]
  v_mfma_f32_16x16x32_bf16 v[88:91], v[228:231], v[156:159], v[88:91]
  s_waitcnt lgkmcnt(5)
  ds_read_b128 v[224:227], v241 offset:768
  v_mfma_f32_16x16x32_bf16 v[64:67], v[200:203], v[136:139], v[64:67]
  s_waitcnt lgkmcnt(5)
  ds_read_b128 v[228:231], v241 offset:3072
  v_mfma_f32_16x16x32_bf16 v[76:79], v[204:207], v[136:139], v[76:79]
  v_mfma_f32_16x16x32_bf16 v[88:91], v[204:207], v[160:163], v[88:91]
  s_waitcnt lgkmcnt(5)
  ds_read_b128 v[200:203], v242 offset:768
  v_mfma_f32_16x16x32_bf16 v[64:67], v[208:211], v[140:143], v[64:67]
  s_waitcnt lgkmcnt(5)
  ds_read_b128 v[204:207], v242 offset:3072
  v_mfma_f32_16x16x32_bf16 v[76:79], v[212:215], v[140:143], v[76:79]
  v_mfma_f32_16x16x32_bf16 v[88:91], v[212:215], v[164:167], v[88:91]
  s_waitcnt lgkmcnt(5)
  ds_read_b128 v[208:211], v243 offset:768
  v_mfma_f32_16x16x32_bf16 v[68:71], v[216:219], v[120:123], v[68:71]
  s_waitcnt lgkmcnt(5)
  ds_read_b128 v[212:215], v243 offset:3072
  v_mfma_f32_16x16x32_bf16 v[80:83], v[220:223], v[120:123], v[80:83]
  v_max3_f32 v12, v64, v65, s56
  v_max3_f32 v12, v66, v67, v12
  v_mfma_f32_16x16x32_bf16 v[92:95], v[220:223], v[144:147], v[92:95]
  s_waitcnt lgkmcnt(5)
  ds_read_b128 v[216:219], v240 offset:1024
  v_max3_f32 v12, v76, v77, v12
  v_mfma_f32_16x16x32_bf16 v[68:71], v[224:227], v[124:127], v[68:71]
  s_waitcnt lgkmcnt(5)
  ds_read_b128 v[220:223], v240 offset:3328
  v_max3_f32 v12, v78, v79, v12
  v_mfma_f32_16x16x32_bf16 v[80:83], v[228:231], v[124:127], v[80:83]
  v_max3_f32 v13, v88, v89, s56
  v_max3_f32 v13, v90, v91, v13
  v_mfma_f32_16x16x32_bf16 v[92:95], v[228:231], v[148:151], v[92:95]
  s_waitcnt lgkmcnt(5)
  ds_read_b128 v[224:227], v241 offset:1024
  v_mfma_f32_16x16x32_bf16 v[68:71], v[200:203], v[128:131], v[68:71]
  s_waitcnt lgkmcnt(5)
  ds_read_b128 v[228:231], v241 offset:3328
  v_mfma_f32_16x16x32_bf16 v[80:83], v[204:207], v[128:131], v[80:83]
  v_mfma_f32_16x16x32_bf16 v[92:95], v[204:207], v[152:155], v[92:95]
  s_waitcnt lgkmcnt(5)
  ds_read_b128 v[200:203], v240 offset:1536
  v_mfma_f32_16x16x32_bf16 v[68:71], v[208:211], v[132:135], v[68:71]
  s_waitcnt lgkmcnt(5)
  ds_read_b128 v[204:207], v240 offset:3840
  v_mfma_f32_16x16x32_bf16 v[80:83], v[212:215], v[132:135], v[80:83]
  v_mfma_f32_16x16x32_bf16 v[92:95], v[212:215], v[156:159], v[92:95]
  s_waitcnt lgkmcnt(5)
  ds_read_b128 v[208:211], v241 offset:1536
  v_mfma_f32_16x16x32_bf16 v[68:71], v[216:219], v[136:139], v[68:71]
  s_waitcnt lgkmcnt(5)
  ds_read_b128 v[212:215], v241 offset:3840
  v_mfma_f32_16x16x32_bf16 v[80:83], v[220:223], v[136:139], v[80:83]
  v_mfma_f32_16x16x32_bf16 v[92:95], v[220:223], v[160:163], v[92:95]
  s_waitcnt lgkmcnt(5)
  ds_read_b128 v[216:219], v242 offset:1536
  v_mfma_f32_16x16x32_bf16 v[68:71], v[224:227], v[140:143], v[68:71]
  s_waitcnt lgkmcnt(5)
  ds_read_b128 v[220:223], v242 offset:3840
  v_mfma_f32_16x16x32_bf16 v[80:83], v[228:231], v[140:143], v[80:83]
  v_mfma_f32_16x16x32_bf16 v[92:95], v[228:231], v[164:167], v[92:95]
  s_waitcnt lgkmcnt(5)
  ds_read_b128 v[224:227], v243 offset:1536
  v_mfma_f32_16x16x32_bf16 v[72:75], v[200:203], v[120:123], v[72:75]
  s_waitcnt lgkmcnt(5)
  ds_read_b128 v[228:231], v243 offset:3840
  v_mfma_f32_16x16x32_bf16 v[84:87], v[204:207], v[120:123], v[84:87]
  v_max3_f32 v12, v68, v69, v12
  v_max3_f32 v12, v70, v71, v12
  v_mfma_f32_16x16x32_bf16 v[96:99], v[204:207], v[144:147], v[96:99]
  s_waitcnt lgkmcnt(5)
  ds_read_b128 v[200:203], v240 offset:1792
  v_max3_f32 v12, v80, v81, v12
  v_mfma_f32_16x16x32_bf16 v[72:75], v[208:211], v[124:127], v[72:75]
  s_waitcnt lgkmcnt(5)
  ds_read_b128 v[204:207], v240 offset:4096
  v_max3_f32 v12, v82, v83, v12
  v_mfma_f32_16x16x32_bf16 v[84:87], v[212:215], v[124:127], v[84:87]
  v_max3_f32 v13, v92, v93, v13
  v_max3_f32 v13, v94, v95, v13
  v_mfma_f32_16x16x32_bf16 v[96:99], v[212:215], v[148:151], v[96:99]
  s_waitcnt lgkmcnt(5)
  ds_read_b128 v[208:211], v241 offset:1792
  v_mfma_f32_16x16x32_bf16 v[72:75], v[216:219], v[128:131], v[72:75]
  s_waitcnt lgkmcnt(5)
  ds_read_b128 v[212:215], v241 offset:4096
  v_mfma_f32_16x16x32_bf16 v[84:87], v[220:223], v[128:131], v[84:87]
  v_mfma_f32_16x16x32_bf16 v[96:99], v[220:223], v[152:155], v[96:99]
  s_waitcnt lgkmcnt(5)
  ds_read_b128 v[216:219], v240 offset:4608
  v_mfma_f32_16x16x32_bf16 v[72:75], v[224:227], v[132:135], v[72:75]
  s_waitcnt lgkmcnt(5)
  ds_read_b128 v[220:223], v240 offset:5376
  v_mfma_f32_16x16x32_bf16 v[84:87], v[228:231], v[132:135], v[84:87]
  v_mfma_f32_16x16x32_bf16 v[96:99], v[228:231], v[156:159], v[96:99]
  s_waitcnt lgkmcnt(5)
  ds_read_b128 v[224:227], v241 offset:4608
  v_mfma_f32_16x16x32_bf16 v[72:75], v[200:203], v[136:139], v[72:75]
  s_waitcnt lgkmcnt(5)
  ds_read_b128 v[228:231], v241 offset:5376
  v_mfma_f32_16x16x32_bf16 v[84:87], v[204:207], v[136:139], v[84:87]
  v_mfma_f32_16x16x32_bf16 v[96:99], v[204:207], v[160:163], v[96:99]
  s_waitcnt lgkmcnt(5)
  ds_read_b128 v[200:203], v242 offset:4608
  v_mfma_f32_16x16x32_bf16 v[72:75], v[208:211], v[140:143], v[72:75]
  s_waitcnt lgkmcnt(5)
  ds_read_b128 v[204:207], v242 offset:5376
  v_mfma_f32_16x16x32_bf16 v[84:87], v[212:215], v[140:143], v[84:87]
  v_mfma_f32_16x16x32_bf16 v[96:99], v[212:215], v[164:167], v[96:99]
  s_waitcnt lgkmcnt(5)
  ds_read_b128 v[208:211], v243 offset:4608
  v_mfma_f32_16x16x32_bf16 v[100:103], v[216:219], v[144:147], v[100:103]
  s_waitcnt lgkmcnt(5)
  ds_read_b128 v[212:215], v243 offset:5376
  v_mfma_f32_16x16x32_bf16 v[104:107], v[220:223], v[144:147], v[104:107]
  s_waitcnt lgkmcnt(5)
  ds_read_b128 v[216:219], v240 offset:4864
  v_max3_f32 v12, v72, v73, v12
  v_mfma_f32_16x16x32_bf16 v[100:103], v[224:227], v[148:151], v[100:103]
  s_waitcnt lgkmcnt(5)
  ds_read_b128 v[220:223], v240 offset:5632
  v_max3_f32 v12, v74, v75, v12
  v_mfma_f32_16x16x32_bf16 v[104:107], v[228:231], v[148:151], v[104:107]
  s_waitcnt lgkmcnt(5)
  ds_read_b128 v[224:227], v241 offset:4864
  v_max3_f32 v12, v84, v85, v12
  v_mfma_f32_16x16x32_bf16 v[100:103], v[200:203], v[152:155], v[100:103]
  s_waitcnt lgkmcnt(5)
  ds_read_b128 v[228:231], v241 offset:5632
  v_max3_f32 v12, v86, v87, v12
  v_mfma_f32_16x16x32_bf16 v[104:107], v[204:207], v[152:155], v[104:107]
  s_waitcnt lgkmcnt(5)
  ds_read_b128 v[200:203], v240 offset:6144
  v_max3_f32 v13, v96, v97, v13
  v_mfma_f32_16x16x32_bf16 v[100:103], v[208:211], v[156:159], v[100:103]
  s_waitcnt lgkmcnt(5)
  ds_read_b128 v[204:207], v240 offset:6912
  v_max3_f32 v13, v98, v99, v13
  v_mfma_f32_16x16x32_bf16 v[104:107], v[212:215], v[156:159], v[104:107]
  s_waitcnt lgkmcnt(5)
  ds_read_b128 v[208:211], v241 offset:6144
  v_mov_b32 v14, v12
  v_mfma_f32_16x16x32_bf16 v[100:103], v[216:219], v[160:163], v[100:103]
  s_waitcnt lgkmcnt(5)
  ds_read_b128 v[212:215], v241 offset:6912
  v_permlane32_swap_b32 v12, v14
  v_mfma_f32_16x16x32_bf16 v[104:107], v[220:223], v[160:163], v[104:107]
  s_waitcnt lgkmcnt(5)
  ds_read_b128 v[216:219], v242 offset:6144
  v_max_f32 v12, v12, v14
  v_mfma_f32_16x16x32_bf16 v[100:103], v[224:227], v[164:167], v[100:103]
  s_waitcnt lgkmcnt(5)
  ds_read_b128 v[220:223], v242 offset:6912
  v_mov_b32 v14, v12
  v_mfma_f32_16x16x32_bf16 v[104:107], v[228:231], v[164:167], v[104:107]
  s_waitcnt lgkmcnt(5)
  ds_read_b128 v[224:227], v243 offset:6144
  v_permlane16_swap_b32 v12, v14
  v_mfma_f32_16x16x32_bf16 v[108:111], v[200:203], v[144:147], v[108:111]
  s_waitcnt lgkmcnt(5)
  ds_read_b128 v[228:231], v243 offset:6912
  v_mfma_f32_16x16x32_bf16 v[112:115], v[204:207], v[144:147], v[112:115]
  s_waitcnt lgkmcnt(5)
  ds_read_b128 v[200:203], v240 offset:6400
  v_max_f32 v12, v12, v14
  v_mfma_f32_16x16x32_bf16 v[108:111], v[208:211], v[148:151], v[108:111]
  s_waitcnt lgkmcnt(5)
  ds_read_b128 v[204:207], v240 offset:7168
  v_mfma_f32_16x16x32_bf16 v[112:115], v[212:215], v[148:151], v[112:115]
  s_waitcnt lgkmcnt(5)
  ds_read_b128 v[208:211], v241 offset:6400
  v_mul_f32 v12, s63, v12
  v_mfma_f32_16x16x32_bf16 v[108:111], v[216:219], v[152:155], v[108:111]
  s_waitcnt lgkmcnt(5)
  ds_read_b128 v[212:215], v241 offset:7168
  v_max3_f32 v13, v100, v101, v13
  v_mfma_f32_16x16x32_bf16 v[112:115], v[220:223], v[152:155], v[112:115]
  s_waitcnt lgkmcnt(5)
  v_max3_f32 v13, v102, v103, v13
  v_max3_f32 v13, v104, v105, v13
  v_mfma_f32_16x16x32_bf16 v[108:111], v[224:227], v[156:159], v[108:111]
  s_waitcnt lgkmcnt(4)
  v_max3_f32 v13, v106, v107, v13
  v_mfma_f32_16x16x32_bf16 v[112:115], v[228:231], v[156:159], v[112:115]
  s_waitcnt lgkmcnt(3)
  v_mfma_f32_16x16x32_bf16 v[108:111], v[200:203], v[160:163], v[108:111]
  s_waitcnt lgkmcnt(2)
  v_mfma_f32_16x16x32_bf16 v[112:115], v[204:207], v[160:163], v[112:115]
  s_waitcnt lgkmcnt(1)
  v_mfma_f32_16x16x32_bf16 v[108:111], v[208:211], v[164:167], v[108:111]
  s_waitcnt lgkmcnt(0)
  v_mfma_f32_16x16x32_bf16 v[112:115], v[212:215], v[164:167], v[112:115]
  s_setprio 0
  s_cmp_lt_u32 s40, 4
  s_cbranch_scc1 M_pr2
  s_setprio 1
M_pr2:
  s_nop 2
  v_max3_f32 v13, v108, v109, v13
  v_max3_f32 v13, v110, v111, v13
  v_max3_f32 v13, v112, v113, v13
  v_max3_f32 v13, v114, v115, v13
  v_mov_b32 v15, v13
  s_nop 1
  v_permlane32_swap_b32 v13, v15
  v_max_f32 v13, v13, v15
  v_mov_b32 v15, v13
  s_nop 1
  v_permlane16_swap_b32 v13, v15
  v_max_f32 v13, v13, v15
  v_mul_f32 v13, s63, v13
  v_fma_f32 v64, v64, s63, -v12
  v_fma_f32 v65, v65, s63, -v12
  v_fma_f32 v66, v66, s63, -v12
  v_fma_f32 v67, v67, s63, -v12
  v_exp_f32 v64, v64
  v_exp_f32 v65, v65
  v_exp_f32 v66, v66
  v_exp_f32 v67, v67
  v_fma_f32 v88, v88, s63, -v13
  v_fma_f32 v89, v89, s63, -v13
  v_fma_f32 v90, v90, s63, -v13
  v_fma_f32 v91, v91, s63, -v13
  v_exp_f32 v88, v88
  v_exp_f32 v89, v89
  v_exp_f32 v90, v90
  v_exp_f32 v91, v91
  v_cvt_pk_bf16_f32 v16, v64, v65
  v_cvt_pk_bf16_f32 v17, v66, v67
  v_cvt_pk_bf16_f32 v34, v88, v89
  v_cvt_pk_bf16_f32 v35, v90, v91
  v_fma_f32 v68, v68, s63, -v12
  v_fma_f32 v69, v69, s63, -v12
  v_fma_f32 v70, v70, s63, -v12
  v_fma_f32 v71, v71, s63, -v12
  v_exp_f32 v68, v68
  v_exp_f32 v69, v69
  v_exp_f32 v70, v70
  v_exp_f32 v71, v71
  v_fma_f32 v92, v92, s63, -v13
  v_fma_f32 v93, v93, s63, -v13
  v_fma_f32 v94, v94, s63, -v13
  v_fma_f32 v95, v95, s63, -v13
  v_exp_f32 v92, v92
  v_exp_f32 v93, v93
  v_exp_f32 v94, v94
  v_exp_f32 v95, v95
  v_cvt_pk_bf16_f32 v18, v68, v69
  v_cvt_pk_bf16_f32 v19, v70, v71
  v_cvt_pk_bf16_f32 v36, v92, v93
  v_cvt_pk_bf16_f32 v37, v94, v95
  s_cmp_lt_u32 s40, 4
  s_cbranch_scc1 M_e2
  s_barrier
M_e2:
  s_mov_b32 s55, 10240
  buffer_load_dwordx4 v[64:67], v252, s[24:27], s55 offen offset:0 sc1
  buffer_load_dwordx4 v[88:91], v252, s[24:27], s55 offen offset:1024 sc1
  buffer_load_dwordx4 v[68:71], v252, s[24:27], s55 offen offset:2048 sc1
  buffer_load_dwordx4 v[92:95], v252, s[24:27], s55 offen offset:3072 sc1
  v_fma_f32 v72, v72, s63, -v12
  v_fma_f32 v73, v73, s63, -v12
  v_fma_f32 v74, v74, s63, -v12
  v_fma_f32 v75, v75, s63, -v12
  v_exp_f32 v72, v72
  v_exp_f32 v73, v73
  v_exp_f32 v74, v74
  v_exp_f32 v75, v75
  v_fma_f32 v96, v96, s63, -v13
  v_fma_f32 v97, v97, s63, -v13
  v_fma_f32 v98, v98, s63, -v13
  v_fma_f32 v99, v99, s63, -v13
  v_exp_f32 v96, v96
  v_exp_f32 v97, v97
  v_exp_f32 v98, v98
  v_exp_f32 v99, v99
  v_cvt_pk_bf16_f32 v20, v72, v73
  v_cvt_pk_bf16_f32 v21, v74, v75
  v_cvt_pk_bf16_f32 v38, v96, v97
  v_cvt_pk_bf16_f32 v39, v98, v99
  s_mov_b32 s55, 14336
  buffer_load_dwordx4 v[72:75], v252, s[24:27], s55 offen offset:0 sc1
  buffer_load_dwordx4 v[96:99], v252, s[24:27], s55 offen offset:1024 sc1
  v_fma_f32 v76, v76, s63, -v12
  v_fma_f32 v77, v77, s63, -v12
  v_fma_f32 v78, v78, s63, -v12
  v_fma_f32 v79, v79, s63, -v12
  v_exp_f32 v76, v76
  v_exp_f32 v77, v77
  v_exp_f32 v78, v78
  v_exp_f32 v79, v79
  v_fma_f32 v100, v100, s63, -v13
  v_fma_f32 v101, v101, s63, -v13
  v_fma_f32 v102, v102, s63, -v13
  v_fma_f32 v103, v103, s63, -v13
  v_exp_f32 v100, v100
  v_exp_f32 v101, v101
  v_exp_f32 v102, v102
  v_exp_f32 v103, v103
  v_cvt_pk_bf16_f32 v22, v76, v77
  v_cvt_pk_bf16_f32 v23, v78, v79
  v_cvt_pk_bf16_f32 v40, v100, v101
  v_cvt_pk_bf16_f32 v41, v102, v103
  buffer_load_dwordx4 v[76:79], v252, s[24:27], s55 offen offset:2048 sc1
  buffer_load_dwordx4 v[100:103], v252, s[24:27], s55 offen offset:3072 sc1
  v_fma_f32 v80, v80, s63, -v12
  v_fma_f32 v81, v81, s63, -v12
  v_fma_f32 v82, v82, s63, -v12
  v_fma_f32 v83, v83, s63, -v12
  v_exp_f32 v80, v80
  v_exp_f32 v81, v81
  v_exp_f32 v82, v82
  v_exp_f32 v83, v83
  v_fma_f32 v104, v104, s63, -v13
  v_fma_f32 v105, v105, s63, -v13
  v_fma_f32 v106, v106, s63, -v13
  v_fma_f32 v107, v107, s63, -v13
  v_exp_f32 v104, v104
  v_exp_f32 v105, v105
  v_exp_f32 v106, v106
  v_exp_f32 v107, v107
  v_cvt_pk_bf16_f32 v24, v80, v81
  v_cvt_pk_bf16_f32 v25, v82, v83
  v_cvt_pk_bf16_f32 v42, v104, v105
  v_cvt_pk_bf16_f32 v43, v106, v107
  s_mov_b32 s55, 18432
  buffer_load_dwordx4 v[80:83], v252, s[24:27], s55 offen offset:0 sc1
  buffer_load_dwordx4 v[104:107], v252, s[24:27], s55 offen offset:1024 sc1
  v_fma_f32 v84, v84, s63, -v12
  v_fma_f32 v85, v85, s63, -v12
  v_fma_f32 v86, v86, s63, -v12
  v_fma_f32 v87, v87, s63, -v12
  v_exp_f32 v84, v84
  v_exp_f32 v85, v85
  v_exp_f32 v86, v86
  v_exp_f32 v87, v87
  v_fma_f32 v108, v108, s63, -v13
  v_fma_f32 v109, v109, s63, -v13
  v_fma_f32 v110, v110, s63, -v13
  v_fma_f32 v111, v111, s63, -v13
  v_exp_f32 v108, v108
  v_exp_f32 v109, v109
  v_exp_f32 v110, v110
  v_exp_f32 v111, v111
  v_cvt_pk_bf16_f32 v26, v84, v85
  v_cvt_pk_bf16_f32 v27, v86, v87
  v_cvt_pk_bf16_f32 v44, v108, v109
  v_cvt_pk_bf16_f32 v45, v110, v111
  buffer_load_dwordx4 v[84:87], v252, s[24:27], s55 offen offset:2048 sc1
  buffer_load_dwordx4 v[108:111], v252, s[24:27], s55 offen offset:3072 sc1
  ds_read_b64_tr_b16 v[200:201], v244 offset:0
  ds_read_b64_tr_b16 v[202:203], v244 offset:768
  ds_read_b64_tr_b16 v[204:205], v245 offset:0
  ds_read_b64_tr_b16 v[206:207], v245 offset:768
  ds_read_b64_tr_b16 v[208:209], v244 offset:1536
  ds_read_b64_tr_b16 v[210:211], v244 offset:2304
  ds_read_b64_tr_b16 v[212:213], v245 offset:1536
  ds_read_b64_tr_b16 v[214:215], v245 offset:2304
  ds_read_b64_tr_b16 v[216:217], v244 offset:3072
  ds_read_b64_tr_b16 v[218:219], v244 offset:3840
  ds_read_b64_tr_b16 v[220:221], v245 offset:3072
  ds_read_b64_tr_b16 v[222:223], v245 offset:3840
  v_fma_f32 v112, v112, s63, -v13
  v_fma_f32 v113, v113, s63, -v13
  v_fma_f32 v114, v114, s63, -v13
  v_fma_f32 v115, v115, s63, -v13
  v_exp_f32 v112, v112
  v_exp_f32 v113, v113
  v_exp_f32 v114, v114
  v_exp_f32 v115, v115
  v_cvt_pk_bf16_f32 v46, v112, v113
  v_cvt_pk_bf16_f32 v47, v114, v115
  s_mov_b32 s55, 22528
  buffer_load_dwordx4 v[232:235], v252, s[24:27], s55 offen offset:0 sc1
  buffer_load_dwordx4 v[112:115], v252, s[24:27], s55 offen offset:1024 sc1
  s_cmp_ge_u32 s40, 4
  s_cbranch_scc1 M_l2
  s_barrier
M_l2:
  s_setprio 2
  s_cmp_lt_u32 s40, 4
  s_cbranch_scc1 M_pr3
  s_setprio 3
M_pr3:
  s_waitcnt lgkmcnt(10)
  v_mfma_f32_16x16x32_bf16 v[168:171], v[200:203], v[16:19], 0
  s_waitcnt lgkmcnt(8)
  ds_read_b64_tr_b16 v[224:225], v244 offset:4608
  ds_read_b64_tr_b16 v[226:227], v244 offset:5376
  v_mfma_f32_16x16x32_bf16 v[172:175], v[204:207], v[16:19], 0
  s_waitcnt lgkmcnt(8)
  ds_read_b64_tr_b16 v[228:229], v245 offset:4608
  v_mfma_f32_16x16x32_bf16 v[168:171], v[208:211], v[20:23], v[168:171]
  ds_read_b64_tr_b16 v[230:231], v245 offset:5376
  v_mfma_f32_16x16x32_bf16 v[176:179], v[208:211], v[32:35], 0
  s_waitcnt lgkmcnt(8)
  ds_read_b64_tr_b16 v[200:201], v244 offset:6144
  ds_read_b64_tr_b16 v[202:203], v244 offset:6912
  v_mfma_f32_16x16x32_bf16 v[172:175], v[212:215], v[20:23], v[172:175]
  ds_read_b64_tr_b16 v[204:205], v245 offset:6144
  v_mfma_f32_16x16x32_bf16 v[180:183], v[212:215], v[32:35], 0
  s_waitcnt lgkmcnt(9)
  ds_read_b64_tr_b16 v[206:207], v245 offset:6912
  v_mfma_f32_16x16x32_bf16 v[168:171], v[216:219], v[24:27], v[168:171]
  ds_read_b64_tr_b16 v[208:209], v246 offset:0
  v_mfma_f32_16x16x32_bf16 v[176:179], v[216:219], v[36:39], v[176:179]
  s_waitcnt lgkmcnt(9)
  ds_read_b64_tr_b16 v[210:211], v246 offset:768
  ds_read_b64_tr_b16 v[212:213], v247 offset:0
  v_mfma_f32_16x16x32_bf16 v[172:175], v[220:223], v[24:27], v[172:175]
  ds_read_b64_tr_b16 v[214:215], v247 offset:768
  v_mfma_f32_16x16x32_bf16 v[180:183], v[220:223], v[36:39], v[180:183]
  s_waitcnt lgkmcnt(10)
  ds_read_b64_tr_b16 v[216:217], v246 offset:1536
  v_mfma_f32_16x16x32_bf16 v[176:179], v[224:227], v[40:43], v[176:179]
  s_waitcnt lgkmcnt(9)
  ds_read_b64_tr_b16 v[218:219], v246 offset:2304
  v_mfma_f32_16x16x32_bf16 v[180:183], v[228:231], v[40:43], v[180:183]
  ds_read_b64_tr_b16 v[220:221], v247 offset:1536
  ds_read_b64_tr_b16 v[222:223], v247 offset:2304
  v_mfma_f32_16x16x32_bf16 v[56:59], v[16:19], v[48:51], 0
  s_waitcnt lgkmcnt(10)
  ds_read_b64_tr_b16 v[224:225], v246 offset:3072
  v_mfma_f32_16x16x32_bf16 v[176:179], v[200:203], v[44:47], v[176:179]
  s_waitcnt lgkmcnt(9)
  ds_read_b64_tr_b16 v[226:227], v246 offset:3840
  v_mfma_f32_16x16x32_bf16 v[180:183], v[204:207], v[44:47], v[180:183]
  s_waitcnt lgkmcnt(8)
  ds_read_b64_tr_b16 v[228:229], v247 offset:3072
  ds_read_b64_tr_b16 v[230:231], v247 offset:3840
  v_mfma_f32_16x16x32_bf16 v[184:187], v[208:211], v[16:19], 0
  s_waitcnt lgkmcnt(8)
  ds_read_b64_tr_b16 v[200:201], v246 offset:4608
  v_mfma_f32_16x16x32_bf16 v[188:191], v[212:215], v[16:19], 0
  ds_read_b64_tr_b16 v[202:203], v246 offset:5376
  v_mfma_f32_16x16x32_bf16 v[60:63], v[32:35], v[48:51], 0
  s_waitcnt lgkmcnt(8)
  ds_read_b64_tr_b16 v[204:205], v247 offset:4608
  v_mfma_f32_16x16x32_bf16 v[184:187], v[216:219], v[20:23], v[184:187]
  ds_read_b64_tr_b16 v[206:207], v247 offset:5376
  ds_read_b64_tr_b16 v[208:209], v246 offset:6144
  v_mfma_f32_16x16x32_bf16 v[192:195], v[216:219], v[32:35], 0
  s_waitcnt lgkmcnt(9)
  ds_read_b64_tr_b16 v[210:211], v246 offset:6912
  v_cvt_pk_bf16_f32 v120, v168, v169
  v_mfma_f32_16x16x32_bf16 v[188:191], v[220:223], v[20:23], v[188:191]
  ds_read_b64_tr_b16 v[212:213], v247 offset:6144
  v_cvt_pk_bf16_f32 v121, v170, v171
  v_mfma_f32_16x16x32_bf16 v[196:199], v[220:223], v[32:35], 0
  s_waitcnt lgkmcnt(9)
  ds_read_b64_tr_b16 v[214:215], v247 offset:6912
  v_cvt_pk_bf16_f32 v122, v172, v173
  v_mfma_f32_16x16x32_bf16 v[184:187], v[224:227], v[24:27], v[184:187]
  ds_read_b64_tr_b16 v[216:217], v248 offset:0
  ds_read_b64_tr_b16 v[218:219], v248 offset:768
  v_mfma_f32_16x16x32_bf16 v[192:195], v[224:227], v[36:39], v[192:195]
  s_waitcnt lgkmcnt(10)
  ds_read_b64_tr_b16 v[220:221], v249 offset:0
  v_cvt_pk_bf16_f32 v123, v174, v175
  v_mfma_f32_16x16x32_bf16 v[188:191], v[228:231], v[24:27], v[188:191]
  ds_read_b64_tr_b16 v[222:223], v249 offset:768
  v_cvt_pk_bf16_f32 v144, v176, v177
  v_mfma_f32_16x16x32_bf16 v[196:199], v[228:231], v[36:39], v[196:199]
  s_waitcnt lgkmcnt(10)
  ds_read_b64_tr_b16 v[224:225], v248 offset:1536
  ds_read_b64_tr_b16 v[226:227], v248 offset:2304
  v_mfma_f32_16x16x32_bf16 v[192:195], v[200:203], v[40:43], v[192:195]
  s_waitcnt lgkmcnt(10)
  ds_read_b64_tr_b16 v[228:229], v249 offset:1536
  v_cvt_pk_bf16_f32 v145, v178, v179
  v_mfma_f32_16x16x32_bf16 v[196:199], v[204:207], v[40:43], v[196:199]
  ds_read_b64_tr_b16 v[230:231], v249 offset:2304
  v_cvt_pk_bf16_f32 v146, v180, v181
  v_mfma_f32_16x16x32_bf16 v[56:59], v[20:23], v[48:51], v[56:59]
  s_waitcnt lgkmcnt(10)
  ds_read_b64_tr_b16 v[200:201], v248 offset:3072
  v_cvt_pk_bf16_f32 v147, v182, v183
  v_mfma_f32_16x16x32_bf16 v[192:195], v[208:211], v[44:47], v[192:195]
  s_waitcnt lgkmcnt(9)
  ds_read_b64_tr_b16 v[202:203], v248 offset:3840
  ds_read_b64_tr_b16 v[204:205], v249 offset:3072
  v_mfma_f32_16x16x32_bf16 v[196:199], v[212:215], v[44:47], v[196:199]
  ds_read_b64_tr_b16 v[206:207], v249 offset:3840
  s_cmp_ge_u32 s40, 4
  s_cbranch_scc1 M_l3
  s_barrier
M_l3:
  s_waitcnt lgkmcnt(10)
  v_mfma_f32_16x16x32_bf16 v[168:171], v[216:219], v[16:19], 0
  s_waitcnt lgkmcnt(8)
  ds_read_b64_tr_b16 v[208:209], v248 offset:4608
  v_mfma_f32_16x16x32_bf16 v[172:175], v[220:223], v[16:19], 0
  s_waitcnt lgkmcnt(7)
  ds_read_b64_tr_b16 v[210:211], v248 offset:5376
  v_mfma_f32_16x16x32_bf16 v[168:171], v[224:227], v[20:23], v[168:171]
  ds_read_b64_tr_b16 v[212:213], v249 offset:4608
  ds_read_b64_tr_b16 v[214:215], v249 offset:5376
  v_mfma_f32_16x16x32_bf16 v[176:179], v[224:227], v[32:35], 0
  s_waitcnt lgkmcnt(8)
  ds_read_b64_tr_b16 v[216:217], v248 offset:6144
  v_cvt_pk_bf16_f32 v124, v184, v185
  v_mfma_f32_16x16x32_bf16 v[172:175], v[228:231], v[20:23], v[172:175]
  ds_read_b64_tr_b16 v[218:219], v248 offset:6912
  v_cvt_pk_bf16_f32 v125, v186, v187
  v_mfma_f32_16x16x32_bf16 v[180:183], v[228:231], v[32:35], 0
  s_waitcnt lgkmcnt(8)
  ds_read_b64_tr_b16 v[220:221], v249 offset:6144
  ds_read_b64_tr_b16 v[222:223], v249 offset:6912
  v_mfma_f32_16x16x32_bf16 v[168:171], v[200:203], v[24:27], v[168:171]
  ds_read_b64_tr_b16 v[224:225], v250 offset:0
  v_cvt_pk_bf16_f32 v126, v188, v189
  v_mfma_f32_16x16x32_bf16 v[176:179], v[200:203], v[36:39], v[176:179]
  s_waitcnt lgkmcnt(9)
  ds_read_b64_tr_b16 v[226:227], v250 offset:768
  v_cvt_pk_bf16_f32 v127, v190, v191
  v_mfma_f32_16x16x32_bf16 v[172:175], v[204:207], v[24:27], v[172:175]
  ds_read_b64_tr_b16 v[228:229], v251 offset:0
  v_cvt_pk_bf16_f32 v148, v192, v193
  v_mfma_f32_16x16x32_bf16 v[180:183], v[204:207], v[36:39], v[180:183]
  s_waitcnt lgkmcnt(9)
  ds_read_b64_tr_b16 v[230:231], v251 offset:768
  ds_read_b64_tr_b16 v[200:201], v250 offset:1536
  v_mfma_f32_16x16x32_bf16 v[176:179], v[208:211], v[40:43], v[176:179]
  s_waitcnt lgkmcnt(9)
  ds_read_b64_tr_b16 v[202:203], v250 offset:2304
  v_cvt_pk_bf16_f32 v149, v194, v195
  v_mfma_f32_16x16x32_bf16 v[180:183], v[212:215], v[40:43], v[180:183]
  ds_read_b64_tr_b16 v[204:205], v251 offset:1536
  v_cvt_pk_bf16_f32 v150, v196, v197
  v_mfma_f32_16x16x32_bf16 v[60:63], v[36:39], v[48:51], v[60:63]
  s_waitcnt lgkmcnt(9)
  ds_read_b64_tr_b16 v[206:207], v251 offset:2304
  v_cvt_pk_bf16_f32 v151, v198, v199
  v_mfma_f32_16x16x32_bf16 v[176:179], v[216:219], v[44:47], v[176:179]
  s_waitcnt lgkmcnt(8)
  ds_read_b64_tr_b16 v[208:209], v250 offset:3072
  ds_read_b64_tr_b16 v[210:211], v250 offset:3840
  v_mfma_f32_16x16x32_bf16 v[180:183], v[220:223], v[44:47], v[180:183]
  s_waitcnt lgkmcnt(8)
  ds_read_b64_tr_b16 v[212:213], v251 offset:3072
  v_mfma_f32_16x16x32_bf16 v[184:187], v[224:227], v[16:19], 0
  s_waitcnt lgkmcnt(7)
  ds_read_b64_tr_b16 v[214:215], v251 offset:3840
  v_mfma_f32_16x16x32_bf16 v[188:191], v[228:231], v[16:19], 0
  s_waitcnt lgkmcnt(6)
  ds_read_b64_tr_b16 v[216:217], v250 offset:4608
  v_mfma_f32_16x16x32_bf16 v[184:187], v[200:203], v[20:23], v[184:187]
  ds_read_b64_tr_b16 v[218:219], v250 offset:5376
  ds_read_b64_tr_b16 v[220:221], v251 offset:4608
  v_mfma_f32_16x16x32_bf16 v[192:195], v[200:203], v[32:35], 0
  s_waitcnt lgkmcnt(7)
  ds_read_b64_tr_b16 v[222:223], v251 offset:5376
  v_cvt_pk_bf16_f32 v128, v168, v169
  v_mfma_f32_16x16x32_bf16 v[188:191], v[204:207], v[20:23], v[188:191]
  ds_read_b64_tr_b16 v[224:225], v250 offset:6144
  v_cvt_pk_bf16_f32 v129, v170, v171
  v_mfma_f32_16x16x32_bf16 v[196:199], v[204:207], v[32:35], 0
  s_waitcnt lgkmcnt(7)
  ds_read_b64_tr_b16 v[226:227], v250 offset:6912
  ds_read_b64_tr_b16 v[228:229], v251 offset:6144
  v_mfma_f32_16x16x32_bf16 v[184:187], v[208:211], v[24:27], v[184:187]
  ds_read_b64_tr_b16 v[230:231], v251 offset:6912
  v_cvt_pk_bf16_f32 v130, v172, v173
  v_mfma_f32_16x16x32_bf16 v[192:195], v[208:211], v[36:39], v[192:195]
  s_waitcnt lgkmcnt(8)
  ds_read_b64_tr_b16 v[200:201], v244 offset:256
  v_cvt_pk_bf16_f32 v131, v174, v175
  v_mfma_f32_16x16x32_bf16 v[188:191], v[212:215], v[24:27], v[188:191]
  ds_read_b64_tr_b16 v[202:203], v244 offset:1024
  v_cvt_pk_bf16_f32 v152, v176, v177
  v_mfma_f32_16x16x32_bf16 v[196:199], v[212:215], v[36:39], v[196:199]
  s_waitcnt lgkmcnt(8)
  ds_read_b64_tr_b16 v[204:205], v245 offset:256
  ds_read_b64_tr_b16 v[206:207], v245 offset:1024
  v_mfma_f32_16x16x32_bf16 v[192:195], v[216:219], v[40:43], v[192:195]
  s_waitcnt lgkmcnt(8)
  ds_read_b64_tr_b16 v[208:209], v244 offset:1792
  v_cvt_pk_bf16_f32 v153, v178, v179
  v_mfma_f32_16x16x32_bf16 v[196:199], v[220:223], v[40:43], v[196:199]
  ds_read_b64_tr_b16 v[210:211], v244 offset:2560
  v_cvt_pk_bf16_f32 v154, v180, v181
  v_mfma_f32_16x16x32_bf16 v[56:59], v[24:27], v[48:51], v[56:59]
  s_waitcnt lgkmcnt(8)
  ds_read_b64_tr_b16 v[212:213], v245 offset:1792
  v_cvt_pk_bf16_f32 v155, v182, v183
  v_mfma_f32_16x16x32_bf16 v[192:195], v[224:227], v[44:47], v[192:195]
  s_waitcnt lgkmcnt(7)
  ds_read_b64_tr_b16 v[214:215], v245 offset:2560
  ds_read_b64_tr_b16 v[216:217], v244 offset:3328
  v_mfma_f32_16x16x32_bf16 v[196:199], v[228:231], v[44:47], v[196:199]
  s_waitcnt lgkmcnt(7)
  ds_read_b64_tr_b16 v[218:219], v244 offset:4096
  v_mfma_f32_16x16x32_bf16 v[168:171], v[200:203], v[16:19], 0
  s_waitcnt lgkmcnt(6)
  ds_read_b64_tr_b16 v[220:221], v245 offset:3328
  v_mfma_f32_16x16x32_bf16 v[172:175], v[204:207], v[16:19], 0
  s_waitcnt lgkmcnt(5)
  ds_read_b64_tr_b16 v[222:223], v245 offset:4096
  ds_read_b64_tr_b16 v[224:225], v244 offset:4864
  v_mfma_f32_16x16x32_bf16 v[168:171], v[208:211], v[20:23], v[168:171]
  ds_read_b64_tr_b16 v[226:227], v244 offset:5632
  v_mfma_f32_16x16x32_bf16 v[176:179], v[208:211], v[32:35], 0
  s_waitcnt lgkmcnt(6)
  ds_read_b64_tr_b16 v[228:229], v245 offset:4864
  v_cvt_pk_bf16_f32 v132, v184, v185
  v_mfma_f32_16x16x32_bf16 v[172:175], v[212:215], v[20:23], v[172:175]
  ds_read_b64_tr_b16 v[230:231], v245 offset:5632
  v_cvt_pk_bf16_f32 v133, v186, v187
  v_mfma_f32_16x16x32_bf16 v[180:183], v[212:215], v[32:35], 0
  s_waitcnt lgkmcnt(6)
  ds_read_b64_tr_b16 v[200:201], v244 offset:6400
  ds_read_b64_tr_b16 v[202:203], v244 offset:7168
  v_mfma_f32_16x16x32_bf16 v[168:171], v[216:219], v[24:27], v[168:171]
  ds_read_b64_tr_b16 v[204:205], v245 offset:6400
  v_cvt_pk_bf16_f32 v134, v188, v189
  v_mfma_f32_16x16x32_bf16 v[176:179], v[216:219], v[36:39], v[176:179]
  s_waitcnt lgkmcnt(7)
  ds_read_b64_tr_b16 v[206:207], v245 offset:7168
  v_cvt_pk_bf16_f32 v135, v190, v191
  v_mfma_f32_16x16x32_bf16 v[172:175], v[220:223], v[24:27], v[172:175]
  ds_read_b64_tr_b16 v[208:209], v246 offset:256
  v_cvt_pk_bf16_f32 v156, v192, v193
  v_mfma_f32_16x16x32_bf16 v[180:183], v[220:223], v[36:39], v[180:183]
  s_waitcnt lgkmcnt(7)
  ds_read_b64_tr_b16 v[210:211], v246 offset:1024
  ds_read_b64_tr_b16 v[212:213], v247 offset:256
  v_mfma_f32_16x16x32_bf16 v[176:179], v[224:227], v[40:43], v[176:179]
  s_waitcnt lgkmcnt(7)
  ds_read_b64_tr_b16 v[214:215], v247 offset:1024
  v_cvt_pk_bf16_f32 v157, v194, v195
  v_mfma_f32_16x16x32_bf16 v[180:183], v[228:231], v[40:43], v[180:183]
  ds_read_b64_tr_b16 v[216:217], v246 offset:1792
  v_cvt_pk_bf16_f32 v158, v196, v197
  v_mfma_f32_16x16x32_bf16 v[60:63], v[40:43], v[48:51], v[60:63]
  s_waitcnt lgkmcnt(7)
  ds_read_b64_tr_b16 v[218:219], v246 offset:2560
  ds_read_b64_tr_b16 v[220:221], v247 offset:1792
  v_mfma_f32_16x16x32_bf16 v[176:179], v[200:203], v[44:47], v[176:179]
  s_waitcnt lgkmcnt(7)
  ds_read_b64_tr_b16 v[222:223], v247 offset:2560
  v_cvt_pk_bf16_f32 v159, v198, v199
  v_mfma_f32_16x16x32_bf16 v[180:183], v[204:207], v[44:47], v[180:183]
  s_waitcnt lgkmcnt(6)
  ds_read_b64_tr_b16 v[224:225], v246 offset:3328
  v_mfma_f32_16x16x32_bf16 v[184:187], v[208:211], v[16:19], 0
  s_waitcnt lgkmcnt(5)
  ds_read_b64_tr_b16 v[226:227], v246 offset:4096
  v_mfma_f32_16x16x32_bf16 v[188:191], v[212:215], v[16:19], 0
  s_waitcnt lgkmcnt(4)
  ds_read_b64_tr_b16 v[228:229], v247 offset:3328
  ds_read_b64_tr_b16 v[230:231], v247 offset:4096
  v_mfma_f32_16x16x32_bf16 v[184:187], v[216:219], v[20:23], v[184:187]
  ds_read_b64_tr_b16 v[200:201], v246 offset:4864
  v_mfma_f32_16x16x32_bf16 v[192:195], v[216:219], v[32:35], 0
  s_waitcnt lgkmcnt(5)
  ds_read_b64_tr_b16 v[202:203], v246 offset:5632
  v_cvt_pk_bf16_f32 v136, v168, v169
  v_mfma_f32_16x16x32_bf16 v[188:191], v[220:223], v[20:23], v[188:191]
  ds_read_b64_tr_b16 v[204:205], v247 offset:4864
  v_cvt_pk_bf16_f32 v137, v170, v171
  v_mfma_f32_16x16x32_bf16 v[196:199], v[220:223], v[32:35], 0
  s_waitcnt lgkmcnt(5)
  ds_read_b64_tr_b16 v[206:207], v247 offset:5632
  ds_read_b64_tr_b16 v[208:209], v246 offset:6400
  v_mfma_f32_16x16x32_bf16 v[184:187], v[224:227], v[24:27], v[184:187]
  ds_read_b64_tr_b16 v[210:211], v246 offset:7168
  v_cvt_pk_bf16_f32 v138, v172, v173
  v_mfma_f32_16x16x32_bf16 v[192:195], v[224:227], v[36:39], v[192:195]
  s_waitcnt lgkmcnt(6)
  ds_read_b64_tr_b16 v[212:213], v247 offset:6400
  v_cvt_pk_bf16_f32 v139, v174, v175
  v_mfma_f32_16x16x32_bf16 v[188:191], v[228:231], v[24:27], v[188:191]
  ds_read_b64_tr_b16 v[214:215], v247 offset:7168
  v_cvt_pk_bf16_f32 v160, v176, v177
  v_mfma_f32_16x16x32_bf16 v[196:199], v[228:231], v[36:39], v[196:199]
  s_waitcnt lgkmcnt(6)
  v_cvt_pk_bf16_f32 v161, v178, v179
  v_cvt_pk_bf16_f32 v162, v180, v181
  v_mfma_f32_16x16x32_bf16 v[192:195], v[200:203], v[40:43], v[192:195]
  s_waitcnt lgkmcnt(4)
  v_cvt_pk_bf16_f32 v163, v182, v183
  v_mfma_f32_16x16x32_bf16 v[196:199], v[204:207], v[40:43], v[196:199]
  v_mfma_f32_16x16x32_bf16 v[60:63], v[44:47], v[48:51], v[60:63]
  s_waitcnt lgkmcnt(2)
  v_mfma_f32_16x16x32_bf16 v[192:195], v[208:211], v[44:47], v[192:195]
  s_waitcnt lgkmcnt(0)
  v_mfma_f32_16x16x32_bf16 v[196:199], v[212:215], v[44:47], v[196:199]
  s_waitcnt vmcnt(0)
  s_cmp_lt_u32 s40, 4
  s_cbranch_scc1 M_e3
  s_cmp_lg_u32 s40, 4
  s_cbranch_scc1 M_e3a
  s_mov_b32 m0, 0
  s_mov_b32 s59, 24576
  buffer_load_dwordx4 v252, s[24:27], s59 offen offset:0 sc1 lds
  buffer_load_dwordx4 v252, s[24:27], s59 offen offset:1024 sc1 lds
  buffer_load_dwordx4 v252, s[24:27], s59 offen offset:2048 sc1 lds
  buffer_load_dwordx4 v252, s[24:27], s59 offen offset:3072 sc1 lds
  s_mov_b32 m0, 4096
  s_mov_b32 s59, 28672
  buffer_load_dwordx4 v252, s[24:27], s59 offen offset:0 sc1 lds
  buffer_load_dwordx4 v252, s[24:27], s59 offen offset:1024 sc1 lds
  buffer_load_dwordx4 v252, s[24:27], s59 offen offset:2048 sc1 lds
  buffer_load_dwordx4 v252, s[24:27], s59 offen offset:3072 sc1 lds
  s_mov_b32 m0, 8192
  s_mov_b32 s59, 32768
  buffer_load_dwordx4 v252, s[24:27], s59 offen offset:0 sc1 lds
  buffer_load_dwordx4 v252, s[24:27], s59 offen offset:1024 sc1 lds
  buffer_load_dwordx4 v252, s[24:27], s59 offen offset:2048 sc1 lds
  buffer_load_dwordx4 v252, s[24:27], s59 offen offset:3072 sc1 lds
  s_mov_b32 m0, 12288
  s_mov_b32 s59, 36864
  buffer_load_dwordx4 v252, s[24:27], s59 offen offset:0 sc1 lds
  buffer_load_dwordx4 v252, s[24:27], s59 offen offset:1024 sc1 lds
  buffer_load_dwordx4 v252, s[24:27], s59 offen offset:2048 sc1 lds
  s_waitcnt vmcnt(0)
  s_barrier
  s_mov_b32 m0, 15360
  s_mov_b32 s59, 39936
  buffer_load_dwordx4 v252, s[24:27], s59 offen offset:0 sc1 lds
  buffer_load_dwordx4 v252, s[24:27], s59 offen offset:1024 sc1 lds
  buffer_load_dwordx4 v252, s[24:27], s59 offen offset:2048 sc1 lds
  buffer_load_dwordx4 v252, s[24:27], s59 offen offset:3072 sc1 lds
  s_mov_b32 m0, 19456
  s_mov_b32 s59, 44032
  buffer_load_dwordx4 v252, s[24:27], s59 offen offset:0 sc1 lds
  buffer_load_dwordx4 v252, s[24:27], s59 offen offset:1024 sc1 lds
  buffer_load_dwordx4 v252, s[24:27], s59 offen offset:2048 sc1 lds
  buffer_load_dwordx4 v252, s[24:27], s59 offen offset:3072 sc1 lds
  s_mov_b32 m0, 23552
  s_mov_b32 s59, 48128
  buffer_load_dwordx4 v252, s[24:27], s59 offen offset:0 sc1 lds
  buffer_load_dwordx4 v252, s[24:27], s59 offen offset:1024 sc1 lds
  buffer_load_dwordx4 v252, s[24:27], s59 offen offset:2048 sc1 lds
  buffer_load_dwordx4 v252, s[24:27], s59 offen offset:3072 sc1 lds
  s_mov_b32 m0, 27648
  s_mov_b32 s59, 52224
  buffer_load_dwordx4 v252, s[24:27], s59 offen offset:0 sc1 lds
  buffer_load_dwordx4 v252, s[24:27], s59 offen offset:1024 sc1 lds
  buffer_load_dwordx4 v252, s[24:27], s59 offen offset:2048 sc1 lds
  buffer_load_dwordx4 v252, s[24:27], s59 offen offset:3072 sc1 lds
  s_branch M_e3
M_e3a:
  s_barrier
M_e3:
  v_cvt_pk_bf16_f32 v140, v184, v185
  v_cvt_pk_bf16_f32 v141, v186, v187
  v_cvt_pk_bf16_f32 v142, v188, v189
  v_cvt_pk_bf16_f32 v143, v190, v191
  v_cvt_pk_bf16_f32 v164, v192, v193
  v_cvt_pk_bf16_f32 v165, v194, v195
  v_cvt_pk_bf16_f32 v166, v196, v197
  v_cvt_pk_bf16_f32 v167, v198, v199
  ds_read_b128 v[200:203], v253 offset:0
  ds_read_b128 v[204:207], v253 offset:1024
  ds_read_b128 v[208:211], v253 offset:2048
  ds_read_b128 v[212:215], v253 offset:3072
  s_waitcnt lgkmcnt(3)
  v_mfma_f32_16x16x32_bf16 v[168:171], v[120:123], v[200:203], 0
  ds_read_b128 v[216:219], v253 offset:4096
  v_rcp_f32 v56, v56
  v_mfma_f32_16x16x32_bf16 v[176:179], v[144:147], v[200:203], 0
  s_waitcnt lgkmcnt(3)
  v_rcp_f32 v57, v57
  v_rcp_f32 v58, v58
  v_mfma_f32_16x16x32_bf16 v[172:175], v[120:123], v[204:207], 0
  ds_read_b128 v[220:223], v253 offset:5120
  v_rcp_f32 v59, v59
  v_mfma_f32_16x16x32_bf16 v[180:183], v[144:147], v[204:207], 0
  s_waitcnt lgkmcnt(3)
  v_rcp_f32 v60, v60
  v_rcp_f32 v61, v61
  v_mfma_f32_16x16x32_bf16 v[168:171], v[124:127], v[208:211], v[168:171]
  ds_read_b128 v[224:227], v253 offset:6144
  v_rcp_f32 v62, v62
  v_mfma_f32_16x16x32_bf16 v[176:179], v[148:151], v[208:211], v[176:179]
  s_waitcnt lgkmcnt(3)
  v_rcp_f32 v63, v63
  v_mfma_f32_16x16x32_bf16 v[172:175], v[124:127], v[212:215], v[172:175]
  ds_read_b128 v[228:231], v253 offset:7168
  v_mfma_f32_16x16x32_bf16 v[180:183], v[148:151], v[212:215], v[180:183]
  s_waitcnt lgkmcnt(3)
  v_mfma_f32_16x16x32_bf16 v[168:171], v[128:131], v[216:219], v[168:171]
  ds_read_b128 v[200:203], v253 offset:8192
  v_mfma_f32_16x16x32_bf16 v[176:179], v[152:155], v[216:219], v[176:179]
  s_waitcnt lgkmcnt(3)
  v_mfma_f32_16x16x32_bf16 v[172:175], v[128:131], v[220:223], v[172:175]
  ds_read_b128 v[204:207], v253 offset:9216
  v_mfma_f32_16x16x32_bf16 v[180:183], v[152:155], v[220:223], v[180:183]
  s_waitcnt lgkmcnt(3)
  v_mfma_f32_16x16x32_bf16 v[168:171], v[132:135], v[224:227], v[168:171]
  v_mfma_f32_16x16x32_bf16 v[176:179], v[156:159], v[224:227], v[176:179]
  s_waitcnt lgkmcnt(2)
  v_mfma_f32_16x16x32_bf16 v[172:175], v[132:135], v[228:231], v[172:175]
  v_mfma_f32_16x16x32_bf16 v[180:183], v[156:159], v[228:231], v[180:183]
  s_waitcnt lgkmcnt(1)
  v_mfma_f32_16x16x32_bf16 v[168:171], v[136:139], v[200:203], v[168:171]
  v_mfma_f32_16x16x32_bf16 v[176:179], v[160:163], v[200:203], v[176:179]
  s_waitcnt lgkmcnt(0)
  v_mfma_f32_16x16x32_bf16 v[172:175], v[136:139], v[204:207], v[172:175]
  v_mfma_f32_16x16x32_bf16 v[180:183], v[160:163], v[204:207], v[180:183]
  v_mfma_f32_16x16x32_bf16 v[168:171], v[140:143], v[64:67], v[168:171]
  v_mfma_f32_16x16x32_bf16 v[176:179], v[164:167], v[64:67], v[176:179]
  v_mfma_f32_16x16x32_bf16 v[172:175], v[140:143], v[88:91], v[172:175]
  v_mfma_f32_16x16x32_bf16 v[180:183], v[164:167], v[88:91], v[180:183]
  v_mfma_f32_16x16x32_bf16 v[184:187], v[120:123], v[68:71], 0
  v_mfma_f32_16x16x32_bf16 v[192:195], v[144:147], v[68:71], 0
  v_mfma_f32_16x16x32_bf16 v[188:191], v[120:123], v[92:95], 0
  s_nop 1
  v_mul_f32 v168, v168, v56
  s_nop 0
  v_mul_f32 v172, v172, v56
  v_mfma_f32_16x16x32_bf16 v[196:199], v[144:147], v[92:95], 0
  v_cvt_pk_bf16_f32 v16, v168, v172
  v_mul_f32 v169, v169, v57
  v_mfma_f32_16x16x32_bf16 v[184:187], v[124:127], v[72:75], v[184:187]
  v_mul_f32 v173, v173, v57
  v_cvt_pk_bf16_f32 v18, v169, v173
  v_mfma_f32_16x16x32_bf16 v[192:195], v[148:151], v[72:75], v[192:195]
  v_mul_f32 v170, v170, v58
  v_mul_f32 v174, v174, v58
  v_mfma_f32_16x16x32_bf16 v[188:191], v[124:127], v[96:99], v[188:191]
  v_cvt_pk_bf16_f32 v20, v170, v174
  v_mul_f32 v171, v171, v59
  v_mfma_f32_16x16x32_bf16 v[196:199], v[148:151], v[96:99], v[196:199]
  v_mul_f32 v175, v175, v59
  v_cvt_pk_bf16_f32 v22, v171, v175
  v_mfma_f32_16x16x32_bf16 v[184:187], v[128:131], v[76:79], v[184:187]
  v_mul_f32 v176, v176, v60
  v_mul_f32 v180, v180, v60
  v_mfma_f32_16x16x32_bf16 v[192:195], v[152:155], v[76:79], v[192:195]
  v_cvt_pk_bf16_f32 v24, v176, v180
  v_mul_f32 v177, v177, v61
  v_mfma_f32_16x16x32_bf16 v[188:191], v[128:131], v[100:103], v[188:191]
  v_mul_f32 v181, v181, v61
  v_cvt_pk_bf16_f32 v26, v177, v181
  v_mfma_f32_16x16x32_bf16 v[196:199], v[152:155], v[100:103], v[196:199]
  v_mul_f32 v178, v178, v62
  v_mul_f32 v182, v182, v62
  v_mfma_f32_16x16x32_bf16 v[184:187], v[132:135], v[80:83], v[184:187]
  v_cvt_pk_bf16_f32 v28, v178, v182
  v_mul_f32 v179, v179, v63
  v_mfma_f32_16x16x32_bf16 v[192:195], v[156:159], v[80:83], v[192:195]
  v_mul_f32 v183, v183, v63
  v_cvt_pk_bf16_f32 v30, v179, v183
  v_mfma_f32_16x16x32_bf16 v[188:191], v[132:135], v[104:107], v[188:191]
  v_mfma_f32_16x16x32_bf16 v[196:199], v[156:159], v[104:107], v[196:199]
  v_mfma_f32_16x16x32_bf16 v[184:187], v[136:139], v[84:87], v[184:187]
  ds_read_b128 v[200:203], v252 offset:0
  v_mfma_f32_16x16x32_bf16 v[192:195], v[160:163], v[84:87], v[192:195]
  v_mfma_f32_16x16x32_bf16 v[188:191], v[136:139], v[108:111], v[188:191]
  ds_read_b128 v[204:207], v252 offset:1024
  v_mfma_f32_16x16x32_bf16 v[196:199], v[160:163], v[108:111], v[196:199]
  v_mfma_f32_16x16x32_bf16 v[184:187], v[140:143], v[232:235], v[184:187]
  ds_read_b128 v[208:211], v252 offset:2048
  v_mfma_f32_16x16x32_bf16 v[192:195], v[164:167], v[232:235], v[192:195]
  v_mfma_f32_16x16x32_bf16 v[188:191], v[140:143], v[112:115], v[188:191]
  ds_read_b128 v[212:215], v252 offset:3072
  v_mfma_f32_16x16x32_bf16 v[196:199], v[164:167], v[112:115], v[196:199]
  s_waitcnt lgkmcnt(3)
  v_mfma_f32_16x16x32_bf16 v[168:171], v[120:123], v[200:203], 0
  ds_read_b128 v[216:219], v252 offset:4096
  v_mfma_f32_16x16x32_bf16 v[176:179], v[144:147], v[200:203], 0
  s_waitcnt lgkmcnt(3)
  v_mfma_f32_16x16x32_bf16 v[172:175], v[120:123], v[204:207], 0
  ds_read_b128 v[220:223], v252 offset:5120
  v_mul_f32 v184, v184, v56
  v_mfma_f32_16x16x32_bf16 v[180:183], v[144:147], v[204:207], 0
  s_waitcnt lgkmcnt(3)
  v_mul_f32 v188, v188, v56
  v_cvt_pk_bf16_f32 v17, v184, v188
  v_mfma_f32_16x16x32_bf16 v[168:171], v[124:127], v[208:211], v[168:171]
  ds_read_b128 v[224:227], v252 offset:6144
  v_mul_f32 v185, v185, v57
  v_mfma_f32_16x16x32_bf16 v[176:179], v[148:151], v[208:211], v[176:179]
  s_waitcnt lgkmcnt(3)
  buffer_store_dwordx2 v[16:17], v4, s[20:23], 0 offen offset:0 sc1
  v_mul_f32 v189, v189, v57
  v_mfma_f32_16x16x32_bf16 v[172:175], v[124:127], v[212:215], v[172:175]
  ds_read_b128 v[228:231], v252 offset:7168
  v_cvt_pk_bf16_f32 v19, v185, v189
  v_mfma_f32_16x16x32_bf16 v[180:183], v[148:151], v[212:215], v[180:183]
  s_waitcnt lgkmcnt(3)
  v_mul_f32 v186, v186, v58
  v_mul_f32 v190, v190, v58
  v_mfma_f32_16x16x32_bf16 v[168:171], v[128:131], v[216:219], v[168:171]
  ds_read_b128 v[200:203], v252 offset:8192
  v_cvt_pk_bf16_f32 v21, v186, v190
  v_mfma_f32_16x16x32_bf16 v[176:179], v[152:155], v[216:219], v[176:179]
  s_waitcnt lgkmcnt(3)
  buffer_store_dwordx2 v[18:19], v5, s[20:23], 0 offen offset:0 sc1
  v_mul_f32 v187, v187, v59
  v_mfma_f32_16x16x32_bf16 v[172:175], v[128:131], v[220:223], v[172:175]
  ds_read_b128 v[204:207], v252 offset:9216
  v_mul_f32 v191, v191, v59
  v_mfma_f32_16x16x32_bf16 v[180:183], v[152:155], v[220:223], v[180:183]
  s_waitcnt lgkmcnt(3)
  v_cvt_pk_bf16_f32 v23, v187, v191
  v_mul_f32 v192, v192, v60
  v_mfma_f32_16x16x32_bf16 v[168:171], v[132:135], v[224:227], v[168:171]
  ds_read_b128 v[208:211], v252 offset:10240
  v_mul_f32 v196, v196, v60
  v_mfma_f32_16x16x32_bf16 v[176:179], v[156:159], v[224:227], v[176:179]
  s_waitcnt lgkmcnt(3)
  buffer_store_dwordx2 v[20:21], v6, s[20:23], 0 offen offset:0 sc1
  v_cvt_pk_bf16_f32 v25, v192, v196
  v_mfma_f32_16x16x32_bf16 v[172:175], v[132:135], v[228:231], v[172:175]
  ds_read_b128 v[212:215], v252 offset:11264
  v_mul_f32 v193, v193, v61
  v_mfma_f32_16x16x32_bf16 v[180:183], v[156:159], v[228:231], v[180:183]
  s_waitcnt lgkmcnt(3)
  v_mul_f32 v197, v197, v61
  v_cvt_pk_bf16_f32 v27, v193, v197
  v_mfma_f32_16x16x32_bf16 v[168:171], v[136:139], v[200:203], v[168:171]
  ds_read_b128 v[216:219], v252 offset:12288
  v_mul_f32 v194, v194, v62
  v_mfma_f32_16x16x32_bf16 v[176:179], v[160:163], v[200:203], v[176:179]
  s_waitcnt lgkmcnt(3)
  buffer_store_dwordx2 v[22:23], v7, s[20:23], 0 offen offset:0 sc1
  v_mul_f32 v198, v198, v62
  v_mfma_f32_16x16x32_bf16 v[172:175], v[136:139], v[204:207], v[172:175]
  ds_read_b128 v[220:223], v252 offset:13312
  v_cvt_pk_bf16_f32 v29, v194, v198
  v_mfma_f32_16x16x32_bf16 v[180:183], v[160:163], v[204:207], v[180:183]
  s_waitcnt lgkmcnt(3)
  v_mul_f32 v195, v195, v63
  v_mul_f32 v199, v199, v63
  v_mfma_f32_16x16x32_bf16 v[168:171], v[140:143], v[208:211], v[168:171]
  ds_read_b128 v[224:227], v252 offset:14336
  v_cvt_pk_bf16_f32 v31, v195, v199
  v_mfma_f32_16x16x32_bf16 v[176:179], v[164:167], v[208:211], v[176:179]
  buffer_store_dwordx2 v[24:25], v8, s[20:23], 0 offen offset:0 sc1
  s_cmp_lt_u32 s40, 4
  s_cbranch_scc1 M_e4
  s_waitcnt vmcnt(5)
  s_barrier
M_e4:
  s_waitcnt lgkmcnt(3)
  v_mfma_f32_16x16x32_bf16 v[172:175], v[140:143], v[212:215], v[172:175]
  ds_read_b128 v[228:231], v252 offset:15360
  v_mfma_f32_16x16x32_bf16 v[180:183], v[164:167], v[212:215], v[180:183]
  s_waitcnt lgkmcnt(3)
  v_mfma_f32_16x16x32_bf16 v[184:187], v[120:123], v[216:219], 0
  ds_read_b128 v[200:203], v252 offset:16384
  v_mfma_f32_16x16x32_bf16 v[192:195], v[144:147], v[216:219], 0
  s_waitcnt lgkmcnt(3)
  buffer_store_dwordx2 v[26:27], v9, s[20:23], 0 offen offset:0 sc1
  v_mfma_f32_16x16x32_bf16 v[188:191], v[120:123], v[220:223], 0
  ds_read_b128 v[204:207], v252 offset:17408
  v_mul_f32 v168, v168, v56
  v_mfma_f32_16x16x32_bf16 v[196:199], v[144:147], v[220:223], 0
  s_waitcnt lgkmcnt(3)
  v_mul_f32 v172, v172, v56
  v_cvt_pk_bf16_f32 v16, v168, v172
  v_mfma_f32_16x16x32_bf16 v[184:187], v[124:127], v[224:227], v[184:187]
  ds_read_b128 v[208:211], v252 offset:18432
  v_mul_f32 v169, v169, v57
  v_mfma_f32_16x16x32_bf16 v[192:195], v[148:151], v[224:227], v[192:195]
  s_waitcnt lgkmcnt(3)
  buffer_store_dwordx2 v[28:29], v10, s[20:23], 0 offen offset:0 sc1
  v_mul_f32 v173, v173, v57
  v_mfma_f32_16x16x32_bf16 v[188:191], v[124:127], v[228:231], v[188:191]
  ds_read_b128 v[212:215], v252 offset:19456
  v_cvt_pk_bf16_f32 v18, v169, v173
  v_mfma_f32_16x16x32_bf16 v[196:199], v[148:151], v[228:231], v[196:199]
  s_waitcnt lgkmcnt(3)
  v_mul_f32 v170, v170, v58
  v_mul_f32 v174, v174, v58
  v_mfma_f32_16x16x32_bf16 v[184:187], v[128:131], v[200:203], v[184:187]
  ds_read_b128 v[216:219], v252 offset:20480
  v_cvt_pk_bf16_f32 v20, v170, v174
  v_mfma_f32_16x16x32_bf16 v[192:195], v[152:155], v[200:203], v[192:195]
  s_waitcnt lgkmcnt(3)
  buffer_store_dwordx2 v[30:31], v11, s[20:23], 0 offen offset:0 sc1
  v_mul_f32 v171, v171, v59
  v_mfma_f32_16x16x32_bf16 v[188:191], v[128:131], v[204:207], v[188:191]
  ds_read_b128 v[220:223], v252 offset:21504
  v_mul_f32 v175, v175, v59
  v_mfma_f32_16x16x32_bf16 v[196:199], v[152:155], v[204:207], v[196:199]
  s_waitcnt lgkmcnt(3)
  v_cvt_pk_bf16_f32 v22, v171, v175
  v_mul_f32 v176, v176, v60
  v_mfma_f32_16x16x32_bf16 v[184:187], v[132:135], v[208:211], v[184:187]
  ds_read_b128 v[224:227], v252 offset:22528
  v_mul_f32 v180, v180, v60
  v_mfma_f32_16x16x32_bf16 v[192:195], v[156:159], v[208:211], v[192:195]
  s_waitcnt lgkmcnt(3)
  v_cvt_pk_bf16_f32 v24, v176, v180
  v_mul_f32 v177, v177, v61
  v_mfma_f32_16x16x32_bf16 v[188:191], v[132:135], v[212:215], v[188:191]
  ds_read_b128 v[228:231], v252 offset:23552
  v_mul_f32 v181, v181, v61
  v_mfma_f32_16x16x32_bf16 v[196:199], v[156:159], v[212:215], v[196:199]
  s_waitcnt lgkmcnt(3)
  v_cvt_pk_bf16_f32 v26, v177, v181
  v_mul_f32 v178, v178, v62
  v_mfma_f32_16x16x32_bf16 v[184:187], v[136:139], v[216:219], v[184:187]
  ds_read_b128 v[200:203], v252 offset:24576
  v_mul_f32 v182, v182, v62
  v_mfma_f32_16x16x32_bf16 v[192:195], v[160:163], v[216:219], v[192:195]
  s_waitcnt lgkmcnt(3)
  v_cvt_pk_bf16_f32 v28, v178, v182
  v_mul_f32 v179, v179, v63
  v_mfma_f32_16x16x32_bf16 v[188:191], v[136:139], v[220:223], v[188:191]
  ds_read_b128 v[204:207], v252 offset:25600
  v_mul_f32 v183, v183, v63
  v_mfma_f32_16x16x32_bf16 v[196:199], v[160:163], v[220:223], v[196:199]
  s_waitcnt lgkmcnt(3)
  v_cvt_pk_bf16_f32 v30, v179, v183
  v_mfma_f32_16x16x32_bf16 v[184:187], v[140:143], v[224:227], v[184:187]
  ds_read_b128 v[208:211], v252 offset:26624
  v_mfma_f32_16x16x32_bf16 v[192:195], v[164:167], v[224:227], v[192:195]
  s_waitcnt lgkmcnt(3)
  v_mfma_f32_16x16x32_bf16 v[188:191], v[140:143], v[228:231], v[188:191]
  ds_read_b128 v[212:215], v252 offset:27648
  v_mfma_f32_16x16x32_bf16 v[196:199], v[164:167], v[228:231], v[196:199]
  s_waitcnt lgkmcnt(3)
  v_mfma_f32_16x16x32_bf16 v[168:171], v[120:123], v[200:203], 0
  ds_read_b128 v[216:219], v252 offset:28672
  v_mfma_f32_16x16x32_bf16 v[176:179], v[144:147], v[200:203], 0
  s_waitcnt lgkmcnt(3)
  v_mfma_f32_16x16x32_bf16 v[172:175], v[120:123], v[204:207], 0
  ds_read_b128 v[220:223], v252 offset:29696
  v_mul_f32 v184, v184, v56
  v_mfma_f32_16x16x32_bf16 v[180:183], v[144:147], v[204:207], 0
  s_waitcnt lgkmcnt(3)
  v_mul_f32 v188, v188, v56
  v_cvt_pk_bf16_f32 v17, v184, v188
  v_mfma_f32_16x16x32_bf16 v[168:171], v[124:127], v[208:211], v[168:171]
  ds_read_b128 v[224:227], v252 offset:30720
  v_mul_f32 v185, v185, v57
  v_mfma_f32_16x16x32_bf16 v[176:179], v[148:151], v[208:211], v[176:179]
  s_waitcnt lgkmcnt(3)
  buffer_store_dwordx2 v[16:17], v4, s[20:23], 0 offen offset:128 sc1
  v_mul_f32 v189, v189, v57
  v_mfma_f32_16x16x32_bf16 v[172:175], v[124:127], v[212:215], v[172:175]
  ds_read_b128 v[228:231], v252 offset:31744
  v_cvt_pk_bf16_f32 v19, v185, v189
  v_mfma_f32_16x16x32_bf16 v[180:183], v[148:151], v[212:215], v[180:183]
  s_waitcnt lgkmcnt(3)
  v_mul_f32 v186, v186, v58
  v_mul_f32 v190, v190, v58
  v_mfma_f32_16x16x32_bf16 v[168:171], v[128:131], v[216:219], v[168:171]
  ds_read_b128 v[200:203], v252 offset:32768
  v_cvt_pk_bf16_f32 v21, v186, v190
  v_mfma_f32_16x16x32_bf16 v[176:179], v[152:155], v[216:219], v[176:179]
  s_waitcnt lgkmcnt(3)
  buffer_store_dwordx2 v[18:19], v5, s[20:23], 0 offen offset:128 sc1
  v_mul_f32 v187, v187, v59
  v_mfma_f32_16x16x32_bf16 v[172:175], v[128:131], v[220:223], v[172:175]
  ds_read_b128 v[204:207], v252 offset:33792
  v_mul_f32 v191, v191, v59
  v_mfma_f32_16x16x32_bf16 v[180:183], v[152:155], v[220:223], v[180:183]
  s_waitcnt lgkmcnt(3)
  v_cvt_pk_bf16_f32 v23, v187, v191
  v_mul_f32 v192, v192, v60
  v_mfma_f32_16x16x32_bf16 v[168:171], v[132:135], v[224:227], v[168:171]
  ds_read_b128 v[208:211], v252 offset:34816
  v_mul_f32 v196, v196, v60
  v_mfma_f32_16x16x32_bf16 v[176:179], v[156:159], v[224:227], v[176:179]
  s_waitcnt lgkmcnt(3)
  buffer_store_dwordx2 v[20:21], v6, s[20:23], 0 offen offset:128 sc1
  v_cvt_pk_bf16_f32 v25, v192, v196
  v_mfma_f32_16x16x32_bf16 v[172:175], v[132:135], v[228:231], v[172:175]
  ds_read_b128 v[212:215], v252 offset:35840
  v_mul_f32 v193, v193, v61
  v_mfma_f32_16x16x32_bf16 v[180:183], v[156:159], v[228:231], v[180:183]
  s_waitcnt lgkmcnt(3)
  v_mul_f32 v197, v197, v61
  v_cvt_pk_bf16_f32 v27, v193, v197
  v_mfma_f32_16x16x32_bf16 v[168:171], v[136:139], v[200:203], v[168:171]
  ds_read_b128 v[216:219], v252 offset:36864
  v_mul_f32 v194, v194, v62
  v_mfma_f32_16x16x32_bf16 v[176:179], v[160:163], v[200:203], v[176:179]
  s_waitcnt lgkmcnt(3)
  buffer_store_dwordx2 v[22:23], v7, s[20:23], 0 offen offset:128 sc1
  v_mul_f32 v198, v198, v62
  v_mfma_f32_16x16x32_bf16 v[172:175], v[136:139], v[204:207], v[172:175]
  ds_read_b128 v[220:223], v252 offset:37888
  v_cvt_pk_bf16_f32 v29, v194, v198
  v_mfma_f32_16x16x32_bf16 v[180:183], v[160:163], v[204:207], v[180:183]
  s_waitcnt lgkmcnt(3)
  v_mul_f32 v195, v195, v63
  v_mul_f32 v199, v199, v63
  v_mfma_f32_16x16x32_bf16 v[168:171], v[140:143], v[208:211], v[168:171]
  ds_read_b128 v[224:227], v252 offset:38912
  v_cvt_pk_bf16_f32 v31, v195, v199
  v_mfma_f32_16x16x32_bf16 v[176:179], v[164:167], v[208:211], v[176:179]
  s_waitcnt lgkmcnt(3)
  buffer_store_dwordx2 v[24:25], v8, s[20:23], 0 offen offset:128 sc1
  v_mfma_f32_16x16x32_bf16 v[172:175], v[140:143], v[212:215], v[172:175]
  ds_read_b128 v[228:231], v252 offset:39936
  v_mfma_f32_16x16x32_bf16 v[180:183], v[164:167], v[212:215], v[180:183]
  s_waitcnt lgkmcnt(3)
  v_mfma_f32_16x16x32_bf16 v[184:187], v[120:123], v[216:219], 0
  ds_read_b128 v[200:203], v252 offset:40960
  v_mfma_f32_16x16x32_bf16 v[192:195], v[144:147], v[216:219], 0
  s_waitcnt lgkmcnt(3)
  buffer_store_dwordx2 v[26:27], v9, s[20:23], 0 offen offset:128 sc1
  v_mfma_f32_16x16x32_bf16 v[188:191], v[120:123], v[220:223], 0
  ds_read_b128 v[204:207], v252 offset:41984
  v_mul_f32 v168, v168, v56
  v_mfma_f32_16x16x32_bf16 v[196:199], v[144:147], v[220:223], 0
  s_waitcnt lgkmcnt(3)
  v_mul_f32 v172, v172, v56
  v_cvt_pk_bf16_f32 v16, v168, v172
  v_mfma_f32_16x16x32_bf16 v[184:187], v[124:127], v[224:227], v[184:187]
  ds_read_b128 v[208:211], v252 offset:43008
  v_mul_f32 v169, v169, v57
  v_mfma_f32_16x16x32_bf16 v[192:195], v[148:151], v[224:227], v[192:195]
  s_waitcnt lgkmcnt(3)
  buffer_store_dwordx2 v[28:29], v10, s[20:23], 0 offen offset:128 sc1
  v_mul_f32 v173, v173, v57
  v_mfma_f32_16x16x32_bf16 v[188:191], v[124:127], v[228:231], v[188:191]
  ds_read_b128 v[212:215], v252 offset:44032
  v_cvt_pk_bf16_f32 v18, v169, v173
  v_mfma_f32_16x16x32_bf16 v[196:199], v[148:151], v[228:231], v[196:199]
  s_waitcnt lgkmcnt(3)
  v_mul_f32 v170, v170, v58
  v_mul_f32 v174, v174, v58
  v_mfma_f32_16x16x32_bf16 v[184:187], v[128:131], v[200:203], v[184:187]
  ds_read_b128 v[216:219], v252 offset:45056
  v_cvt_pk_bf16_f32 v20, v170, v174
  v_mfma_f32_16x16x32_bf16 v[192:195], v[152:155], v[200:203], v[192:195]
  s_waitcnt lgkmcnt(3)
  buffer_store_dwordx2 v[30:31], v11, s[20:23], 0 offen offset:128 sc1
  v_mul_f32 v171, v171, v59
  v_mfma_f32_16x16x32_bf16 v[188:191], v[128:131], v[204:207], v[188:191]
  ds_read_b128 v[220:223], v252 offset:46080
  v_mul_f32 v175, v175, v59
  v_mfma_f32_16x16x32_bf16 v[196:199], v[152:155], v[204:207], v[196:199]
  s_waitcnt lgkmcnt(3)
  v_cvt_pk_bf16_f32 v22, v171, v175
  v_mul_f32 v176, v176, v60
  v_mfma_f32_16x16x32_bf16 v[184:187], v[132:135], v[208:211], v[184:187]
  ds_read_b128 v[224:227], v252 offset:47104
  v_mul_f32 v180, v180, v60
  v_mfma_f32_16x16x32_bf16 v[192:195], v[156:159], v[208:211], v[192:195]
  s_waitcnt lgkmcnt(3)
  v_cvt_pk_bf16_f32 v24, v176, v180
  v_mul_f32 v177, v177, v61
  v_mfma_f32_16x16x32_bf16 v[188:191], v[132:135], v[212:215], v[188:191]
  ds_read_b128 v[228:231], v252 offset:48128
  v_mul_f32 v181, v181, v61
  v_mfma_f32_16x16x32_bf16 v[196:199], v[156:159], v[212:215], v[196:199]
  s_waitcnt lgkmcnt(3)
  v_cvt_pk_bf16_f32 v26, v177, v181
  v_mul_f32 v178, v178, v62
  v_mfma_f32_16x16x32_bf16 v[184:187], v[136:139], v[216:219], v[184:187]
  v_mul_f32 v182, v182, v62
  v_cvt_pk_bf16_f32 v28, v178, v182
  v_mfma_f32_16x16x32_bf16 v[192:195], v[160:163], v[216:219], v[192:195]
  s_waitcnt lgkmcnt(2)
  v_mul_f32 v179, v179, v63
  v_mul_f32 v183, v183, v63
  v_mfma_f32_16x16x32_bf16 v[188:191], v[136:139], v[220:223], v[188:191]
  v_cvt_pk_bf16_f32 v30, v179, v183
  v_mfma_f32_16x16x32_bf16 v[196:199], v[160:163], v[220:223], v[196:199]
  s_waitcnt lgkmcnt(1)
  v_mfma_f32_16x16x32_bf16 v[184:187], v[140:143], v[224:227], v[184:187]
  v_mfma_f32_16x16x32_bf16 v[192:195], v[164:167], v[224:227], v[192:195]
  s_waitcnt lgkmcnt(0)
  v_mfma_f32_16x16x32_bf16 v[188:191], v[140:143], v[228:231], v[188:191]
  v_mfma_f32_16x16x32_bf16 v[196:199], v[164:167], v[228:231], v[196:199]
  s_nop 3
  v_mul_f32 v184, v184, v56
  s_nop 1
  v_mul_f32 v188, v188, v56
  v_cvt_pk_bf16_f32 v17, v184, v188
  buffer_store_dwordx2 v[16:17], v4, s[20:23], 0 offen offset:256 sc1
  v_mul_f32 v185, v185, v57
  v_mul_f32 v189, v189, v57
  v_cvt_pk_bf16_f32 v19, v185, v189
  buffer_store_dwordx2 v[18:19], v5, s[20:23], 0 offen offset:256 sc1
  v_mul_f32 v186, v186, v58
  v_mul_f32 v190, v190, v58
  v_cvt_pk_bf16_f32 v21, v186, v190
  buffer_store_dwordx2 v[20:21], v6, s[20:23], 0 offen offset:256 sc1
  v_mul_f32 v187, v187, v59
  v_mul_f32 v191, v191, v59
  v_cvt_pk_bf16_f32 v23, v187, v191
  buffer_store_dwordx2 v[22:23], v7, s[20:23], 0 offen offset:256 sc1
  v_mul_f32 v192, v192, v60
  v_mul_f32 v196, v196, v60
  v_cvt_pk_bf16_f32 v25, v192, v196
  buffer_store_dwordx2 v[24:25], v8, s[20:23], 0 offen offset:256 sc1
  v_mul_f32 v193, v193, v61
  v_mul_f32 v197, v197, v61
  v_cvt_pk_bf16_f32 v27, v193, v197
  buffer_store_dwordx2 v[26:27], v9, s[20:23], 0 offen offset:256 sc1
  v_mul_f32 v194, v194, v62
  v_mul_f32 v198, v198, v62
  v_cvt_pk_bf16_f32 v29, v194, v198
  buffer_store_dwordx2 v[28:29], v10, s[20:23], 0 offen offset:256 sc1
  v_mul_f32 v195, v195, v63
  v_mul_f32 v199, v199, v63
  v_cvt_pk_bf16_f32 v31, v195, v199
  buffer_store_dwordx2 v[30:31], v11, s[20:23], 0 offen offset:256 sc1
  s_endpgm
M_helper:
H_join:
  s_and_b32 s55, s2, 7
  s_lshr_b32 s56, s2, 3
  s_lshr_b32 s41, s55, 2
  s_bfe_u32 s42, s55, 0x10001
  s_and_b32 s55, s55, 1
  s_lshl_b32 s55, s55, 2
  s_lshr_b32 s43, s56, 3
  s_add_u32 s43, s43, s55
  s_and_b32 s44, s56, 7
  s_mul_i32 s43, s43, 14
  s_mul_i32 s44, s44, 14
  s_mul_i32 s61, s41, 13
  s_add_i32 s61, s61, -6
  s_cmp_eq_u32 s42, 0
  s_cselect_b32 s62, 85632, 0
  s_cselect_b32 s50, -1, 1
  s_mulk_i32 s50, 384
  s_cmp_ge_u32 s40, 4
  s_cselect_b32 s53, -4, 3
  s_add_i32 s53, s53, s40
  s_lshl_b32 s53, s53, 1
  s_add_u32 s88, s43, s53
  s_mov_b32 s89, 86016
  s_mul_i32 s55, s41, 6
  s_add_i32 s45, s43, s55
  s_add_i32 s45, s45, -6
  s_cmp_eq_i32 s45, -6
  s_cselect_b32 s47, 6, 0
  s_cmp_eq_i32 s45, 98
  s_cselect_b32 s48, 7, 13
  s_cselect_b32 s49, 2, 0
  s_sub_i32 s45, s45, s49
  s_cmp_eq_i32 s44, 98
  s_cselect_b32 s51, 7, 13
  s_lshl_b32 s56, s44, 1
  s_add_i32 s56, s56, 1
  s_mul_i32 s46, s56, s50
  s_add_i32 s46, s46, s62
  s_lshl_b32 s91, s50, 1
  s_lshl_b32 s3, s91, 3
  s_add_i32 s91, s91, -384
  s_max_i32 s92, s53, s47
  s_min_i32 s92, s92, s48
  s_and_b32 s92, s92, -2
  s_add_u32 s52, s92, s49
  s_mov_b32 s54, 4286578688
  s_mov_b32 s63, 1037384597
  s_and_b32 s93, s40, 1
  s_lshl_b32 s93, s93, 3
  s_and_b32 s56, s40, 6
  s_or_b32 s93, s93, s56
  s_add_u32 s56, s40, 8
  s_add_i32 s100, s45, s56
  s_lshl_b32 s100, s100, 1
  s_add_i32 s100, s100, s41
  s_max_i32 s100, s100, 0
  s_min_i32 s100, s100, 223
  s_mul_i32 s100, s100, 86016
  s_mul_i32 s101, s56, 7680
  v_add_u32 v4, 0, v1
  v_xor_b32 v4, 0, v4
  v_mul_u32_u24 v5, 2731, v4
  v_lshrrev_b32 v5, 16, v5
  v_mul_i32_i24 v5, s91, v5
  v_lshl_add_u32 v4, v4, 4, v5
  v_add_u32 v232, s46, v4
  v_add_u32 v235, s3, v232
  v_add_u32 v238, s3, v235
  v_add_u32 v4, 64, v1
  v_xor_b32 v4, 0, v4
  v_mul_u32_u24 v5, 2731, v4
  v_lshrrev_b32 v5, 16, v5
  v_mul_i32_i24 v5, s91, v5
  v_lshl_add_u32 v4, v4, 4, v5
  v_add_u32 v233, s46, v4
  v_add_u32 v236, s3, v233
  v_add_u32 v4, 128, v1
  v_xor_b32 v4, 0, v4
  v_mul_u32_u24 v5, 2731, v4
  v_lshrrev_b32 v5, 16, v5
  v_mul_i32_i24 v5, s91, v5
  v_lshl_add_u32 v4, v4, 4, v5
  v_add_u32 v234, s46, v4
  v_add_u32 v237, s3, v234
  v_add_u32 v4, 416, v1
  v_xor_b32 v4, 0, v4
  v_mul_u32_u24 v5, 2731, v4
  v_lshrrev_b32 v5, 16, v5
  v_mul_i32_i24 v5, s91, v5
  v_lshl_add_u32 v4, v4, 4, v5
  v_add_u32 v239, s46, v4
  v_max_i32 v237, 0, v237
  v_max_i32 v238, 0, v238
  v_max_i32 v239, 0, v239
  v_add_u32 v4, 0, v1
  v_xor_b32 v4, 8, v4
  v_mul_u32_u24 v5, 2731, v4
  v_lshrrev_b32 v5, 16, v5
  v_mul_i32_i24 v5, s91, v5
  v_lshl_add_u32 v4, v4, 4, v5
  v_add_u32 v244, s46, v4
  v_add_u32 v247, s3, v244
  v_add_u32 v250, s3, v247
  v_add_u32 v4, 64, v1
  v_xor_b32 v4, 8, v4
  v_mul_u32_u24 v5, 2731, v4
  v_lshrrev_b32 v5, 16, v5
  v_mul_i32_i24 v5, s91, v5
  v_lshl_add_u32 v4, v4, 4, v5
  v_add_u32 v245, s46, v4
  v_add_u32 v248, s3, v245
  v_add_u32 v4, 128, v1
  v_xor_b32 v4, 8, v4
  v_mul_u32_u24 v5, 2731, v4
  v_lshrrev_b32 v5, 16, v5
  v_mul_i32_i24 v5, s91, v5
  v_lshl_add_u32 v4, v4, 4, v5
  v_add_u32 v246, s46, v4
  v_add_u32 v249, s3, v246
  v_add_u32 v4, 416, v1
  v_xor_b32 v4, 8, v4
  v_mul_u32_u24 v5, 2731, v4
  v_lshrrev_b32 v5, 16, v5
  v_mul_i32_i24 v5, s91, v5
  v_lshl_add_u32 v4, v4, 4, v5
  v_add_u32 v251, s46, v4
  v_max_i32 v249, 0, v249
  v_max_i32 v250, 0, v250
  v_max_i32 v251, 0, v251
  s_barrier
  v_mov_b32 v6, 0
  s_mov_b32 s59, 0
  s_mov_b64 exec, 1
H_pollM:
  buffer_load_dword v7, v6, s[36:39], 0 offen offset:128 sc1
  s_waitcnt vmcnt(0)
  v_cmp_eq_u32 vcc, 0, v7
  s_add_u32 s59, s59, 1
  s_cmp_gt_u32 s59, 200000
  s_cbranch_scc1 H_pollM_x
  s_cmp_lg_u64 vcc, 0
  s_cbranch_scc0 H_pollM_x
  s_sleep 2
  s_branch H_pollM
H_pollM_x:
  s_mov_b64 exec, -1
  s_lshr_b32 s55, s2, 3
  s_mul_i32 s55, s55, 2304
  s_add_u32 s55, s55, 131072
  buffer_load_dwordx4 v[80:83], v252, s[24:27], s55 offen offset:0 sc1
  buffer_load_dwordx4 v[84:87], v252, s[24:27], s55 offen offset:1024 sc1
  buffer_load_dwordx4 v[88:91], v252, s[24:27], s55 offen offset:2048 sc1
  s_barrier
  s_lshl_b32 s55, s40, 10
  s_add_u32 s55, s55, 131072
  s_sub_u32 m0, s55, 40960
  s_nop 0
  buffer_load_dwordx4 v252, s[24:27], s55 offen sc1 lds
  s_add_u32 s55, s55, 4096
  s_sub_u32 m0, s55, 40960
  s_nop 0
  buffer_load_dwordx4 v252, s[24:27], s55 offen sc1 lds
  s_add_u32 s55, s55, 4096
  s_sub_u32 m0, s55, 40960
  s_nop 0
  buffer_load_dwordx4 v252, s[24:27], s55 offen sc1 lds
  s_add_u32 s55, s55, 4096
  s_sub_u32 m0, s55, 40960
  s_nop 0
  buffer_load_dwordx4 v252, s[24:27], s55 offen sc1 lds
  s_add_u32 s55, s55, 4096
  s_sub_u32 m0, s55, 40960
  s_nop 0
  buffer_load_dwordx4 v252, s[24:27], s55 offen sc1 lds
  s_add_u32 s55, s55, 4096
  s_sub_u32 m0, s55, 40960
  s_nop 0
  buffer_load_dwordx4 v252, s[24:27], s55 offen sc1 lds
  s_add_u32 s55, s55, 4096
  s_sub_u32 m0, s55, 40960
  s_nop 0
  buffer_load_dwordx4 v252, s[24:27], s55 offen sc1 lds
  s_add_u32 s55, s55, 4096
  s_sub_u32 m0, s55, 40960
  s_nop 0
  buffer_load_dwordx4 v252, s[24:27], s55 offen sc1 lds
  s_add_u32 s55, s55, 4096
  s_sub_u32 m0, s55, 40960
  s_nop 0
  buffer_load_dwordx4 v252, s[24:27], s55 offen sc1 lds
  s_add_u32 s55, s55, 4096
  s_sub_u32 m0, s55, 40960
  s_nop 0
  buffer_load_dwordx4 v252, s[24:27], s55 offen sc1 lds
  s_add_u32 s55, s55, 4096
  s_sub_u32 m0, s55, 40960
  s_nop 0
  buffer_load_dwordx4 v252, s[24:27], s55 offen sc1 lds
  s_add_u32 s55, s55, 4096
  s_sub_u32 m0, s55, 40960
  s_nop 0
  buffer_load_dwordx4 v252, s[24:27], s55 offen sc1 lds
  s_waitcnt vmcnt(6)
  s_barrier
  s_lshl_b32 s55, s40, 10
  s_add_u32 s55, s55, 180224
  s_sub_u32 m0, s55, 40960
  s_nop 0
  buffer_load_dwordx4 v252, s[24:27], s55 offen sc1 lds
  s_add_u32 s55, s55, 4096
  s_sub_u32 m0, s55, 40960
  s_nop 0
  buffer_load_dwordx4 v252, s[24:27], s55 offen sc1 lds
  s_add_u32 s55, s55, 4096
  s_sub_u32 m0, s55, 40960
  s_nop 0
  buffer_load_dwordx4 v252, s[24:27], s55 offen sc1 lds
  s_add_u32 s55, s55, 4096
  s_sub_u32 m0, s55, 40960
  s_nop 0
  buffer_load_dwordx4 v252, s[24:27], s55 offen sc1 lds
  s_add_u32 s55, s55, 4096
  s_sub_u32 m0, s55, 40960
  s_nop 0
  buffer_load_dwordx4 v252, s[24:27], s55 offen sc1 lds
  s_add_u32 s55, s55, 4096
  s_sub_u32 m0, s55, 40960
  s_nop 0
  buffer_load_dwordx4 v252, s[24:27], s55 offen sc1 lds
  v_mov_b32 v192, 1
  v_mov_b32 v193, 0
  s_waitcnt vmcnt(0)
  s_sub_u32 s58, s2, 36
  s_cmp_ge_u32 s58, 144
  s_cbranch_scc1 H_nov2
  v_mov_b32 v192, 1
  v_mov_b32 v193, 0
  s_mov_b64 exec, 1
  s_waitcnt vmcnt(0)
  buffer_atomic_add v192, v193, s[36:39], 0 offen offset:4 sc0 sc1
  s_mov_b64 exec, -1
H_nov2:
  s_add_i32 s56, s45, 0
  s_lshl_b32 s56, s56, 1
  s_add_i32 s56, s56, s41
  s_max_i32 s56, s56, 0
  s_min_i32 s56, s56, 223
  s_mul_i32 s56, s56, 86016
  s_mov_b32 m0, 0
  s_nop 0
  buffer_load_dwordx4 v232, s[16:19], s56 offen lds
  s_mov_b32 m0, 1024
  s_nop 0
  buffer_load_dwordx4 v233, s[16:19], s56 offen lds
  s_mov_b32 m0, 2048
  s_nop 0
  buffer_load_dwordx4 v234, s[16:19], s56 offen lds
  s_mov_b32 m0, 3072
  s_nop 0
  buffer_load_dwordx4 v235, s[16:19], s56 offen lds
  s_mov_b32 m0, 4096
  s_nop 0
  buffer_load_dwordx4 v236, s[16:19], s56 offen lds
  s_mov_b32 m0, 5120
  s_nop 0
  buffer_load_dwordx4 v237, s[16:19], s56 offen lds
  s_mov_b32 m0, 6144
  s_nop 0
  buffer_load_dwordx4 v238, s[16:19], s56 offen lds
  s_mov_b32 m0, 6656
  s_nop 0
  buffer_load_dwordx4 v239, s[16:19], s56 offen lds
  s_add_i32 s56, s45, 8
  s_lshl_b32 s56, s56, 1
  s_add_i32 s56, s56, s41
  s_max_i32 s56, s56, 0
  s_min_i32 s56, s56, 223
  s_mul_i32 s56, s56, 86016
  s_mov_b32 m0, 61440
  s_nop 0
  buffer_load_dwordx4 v232, s[16:19], s56 offen lds
  s_mov_b32 m0, 62464
  s_nop 0
  buffer_load_dwordx4 v233, s[16:19], s56 offen lds
  s_mov_b32 m0, 63488
  s_nop 0
  buffer_load_dwordx4 v234, s[16:19], s56 offen lds
  s_mov_b32 m0, 64512
  s_nop 0
  buffer_load_dwordx4 v235, s[16:19], s56 offen lds
  s_mov_b32 m0, 65536
  s_nop 0
  buffer_load_dwordx4 v236, s[16:19], s56 offen lds
  s_mov_b32 m0, 66560
  s_nop 0
  buffer_load_dwordx4 v237, s[16:19], s56 offen lds
  s_mov_b32 m0, 67584
  s_nop 0
  buffer_load_dwordx4 v238, s[16:19], s56 offen lds
  s_mov_b32 m0, 68096
  s_nop 0
  buffer_load_dwordx4 v239, s[16:19], s56 offen lds
  s_barrier
  s_add_i32 s56, s45, 9
  s_lshl_b32 s56, s56, 1
  s_add_i32 s56, s56, s41
  s_max_i32 s56, s56, 0
  s_min_i32 s56, s56, 223
  s_mul_i32 s56, s56, 86016
  s_mov_b32 m0, 69120
  s_nop 0
  buffer_load_dwordx4 v244, s[16:19], s56 offen lds
  s_mov_b32 m0, 70144
  s_nop 0
  buffer_load_dwordx4 v245, s[16:19], s56 offen lds
  s_mov_b32 m0, 71168
  s_nop 0
  buffer_load_dwordx4 v246, s[16:19], s56 offen lds
  s_mov_b32 m0, 72192
  s_nop 0
  buffer_load_dwordx4 v247, s[16:19], s56 offen lds
  s_mov_b32 m0, 73216
  s_nop 0
  buffer_load_dwordx4 v248, s[16:19], s56 offen lds
  s_mov_b32 m0, 74240
  s_nop 0
  buffer_load_dwordx4 v249, s[16:19], s56 offen lds
  s_mov_b32 m0, 75264
  s_nop 0
  buffer_load_dwordx4 v250, s[16:19], s56 offen lds
  s_mov_b32 m0, 75776
  s_nop 0
  buffer_load_dwordx4 v251, s[16:19], s56 offen lds
  s_add_i32 s56, s45, 10
  s_lshl_b32 s56, s56, 1
  s_add_i32 s56, s56, s41
  s_max_i32 s56, s56, 0
  s_min_i32 s56, s56, 223
  s_mul_i32 s56, s56, 86016
  v_xor_b32 v64, 32, v232
  s_mov_b32 m0, 76800
  s_nop 0
  buffer_load_dwordx4 v64, s[16:19], s56 offen lds
  v_xor_b32 v65, 32, v233
  s_mov_b32 m0, 77824
  s_nop 0
  buffer_load_dwordx4 v65, s[16:19], s56 offen lds
  v_xor_b32 v66, 32, v234
  s_mov_b32 m0, 78848
  s_nop 0
  buffer_load_dwordx4 v66, s[16:19], s56 offen lds
  v_xor_b32 v67, 32, v235
  s_mov_b32 m0, 79872
  s_nop 0
  buffer_load_dwordx4 v67, s[16:19], s56 offen lds
  v_xor_b32 v68, 32, v236
  s_mov_b32 m0, 80896
  s_nop 0
  buffer_load_dwordx4 v68, s[16:19], s56 offen lds
  v_xor_b32 v69, 32, v237
  s_mov_b32 m0, 81920
  s_nop 0
  buffer_load_dwordx4 v69, s[16:19], s56 offen lds
  v_xor_b32 v70, 32, v238
  s_mov_b32 m0, 82944
  s_nop 0
  buffer_load_dwordx4 v70, s[16:19], s56 offen lds
  v_xor_b32 v71, 32, v239
  s_mov_b32 m0, 83456
  s_nop 0
  buffer_load_dwordx4 v71, s[16:19], s56 offen lds
  s_barrier
  s_add_i32 s56, s45, 11
  s_lshl_b32 s56, s56, 1
  s_add_i32 s56, s56, s41
  s_max_i32 s56, s56, 0
  s_min_i32 s56, s56, 223
  s_mul_i32 s56, s56, 86016
  v_xor_b32 v64, 32, v244
  s_mov_b32 m0, 84480
  s_nop 0
  buffer_load_dwordx4 v64, s[16:19], s56 offen lds
  v_xor_b32 v65, 32, v245
  s_mov_b32 m0, 85504
  s_nop 0
  buffer_load_dwordx4 v65, s[16:19], s56 offen lds
  v_xor_b32 v66, 32, v246
  s_mov_b32 m0, 86528
  s_nop 0
  buffer_load_dwordx4 v66, s[16:19], s56 offen lds
  v_xor_b32 v67, 32, v247
  s_mov_b32 m0, 87552
  s_nop 0
  buffer_load_dwordx4 v67, s[16:19], s56 offen lds
  v_xor_b32 v68, 32, v248
  s_mov_b32 m0, 88576
  s_nop 0
  buffer_load_dwordx4 v68, s[16:19], s56 offen lds
  v_xor_b32 v69, 32, v249
  s_mov_b32 m0, 89600
  s_nop 0
  buffer_load_dwordx4 v69, s[16:19], s56 offen lds
  v_xor_b32 v70, 32, v250
  s_mov_b32 m0, 90624
  s_nop 0
  buffer_load_dwordx4 v70, s[16:19], s56 offen lds
  v_xor_b32 v71, 32, v251
  s_mov_b32 m0, 91136
  s_nop 0
  buffer_load_dwordx4 v71, s[16:19], s56 offen lds
  s_add_i32 s56, s45, 12
  s_lshl_b32 s56, s56, 1
  s_add_i32 s56, s56, s41
  s_max_i32 s56, s56, 0
  s_min_i32 s56, s56, 223
  s_mul_i32 s56, s56, 86016
  v_xor_b32 v64, 64, v232
  s_mov_b32 m0, 92160
  s_nop 0
  buffer_load_dwordx4 v64, s[16:19], s56 offen lds
  v_xor_b32 v65, 64, v233
  s_mov_b32 m0, 93184
  s_nop 0
  buffer_load_dwordx4 v65, s[16:19], s56 offen lds
  v_xor_b32 v66, 64, v234
  s_mov_b32 m0, 94208
  s_nop 0
  buffer_load_dwordx4 v66, s[16:19], s56 offen lds
  v_xor_b32 v67, 64, v235
  s_mov_b32 m0, 95232
  s_nop 0
  buffer_load_dwordx4 v67, s[16:19], s56 offen lds
  v_xor_b32 v68, 64, v236
  s_mov_b32 m0, 96256
  s_nop 0
  buffer_load_dwordx4 v68, s[16:19], s56 offen lds
  v_xor_b32 v69, 64, v237
  s_mov_b32 m0, 97280
  s_nop 0
  buffer_load_dwordx4 v69, s[16:19], s56 offen lds
  v_xor_b32 v70, 64, v238
  s_mov_b32 m0, 98304
  s_nop 0
  buffer_load_dwordx4 v70, s[16:19], s56 offen lds
  v_xor_b32 v71, 64, v239
  s_mov_b32 m0, 98816
  s_nop 0
  buffer_load_dwordx4 v71, s[16:19], s56 offen lds
  s_waitcnt vmcnt(16)
  v_readfirstlane_b32 s56, v192
  s_nop 0
  s_cmp_lg_u32 s56, 143
  s_cbranch_scc1 H_p2
  s_mov_b64 exec, 1
  buffer_store_dword v192, v193, s[36:39], 0 offen offset:132 sc1
  s_mov_b64 exec, -1
H_p2:
  s_add_i32 s56, s45, 13
  s_lshl_b32 s56, s56, 1
  s_add_i32 s56, s56, s41
  s_max_i32 s56, s56, 0
  s_min_i32 s56, s56, 223
  s_mul_i32 s56, s56, 86016
  v_xor_b32 v64, 64, v244
  s_mov_b32 m0, 99840
  s_nop 0
  buffer_load_dwordx4 v64, s[16:19], s56 offen lds
  v_xor_b32 v65, 64, v245
  s_mov_b32 m0, 100864
  s_nop 0
  buffer_load_dwordx4 v65, s[16:19], s56 offen lds
  v_xor_b32 v66, 64, v246
  s_mov_b32 m0, 101888
  s_nop 0
  buffer_load_dwordx4 v66, s[16:19], s56 offen lds
  v_xor_b32 v67, 64, v247
  s_mov_b32 m0, 102912
  s_nop 0
  buffer_load_dwordx4 v67, s[16:19], s56 offen lds
  v_xor_b32 v68, 64, v248
  s_mov_b32 m0, 103936
  s_nop 0
  buffer_load_dwordx4 v68, s[16:19], s56 offen lds
  v_xor_b32 v69, 64, v249
  s_mov_b32 m0, 104960
  s_nop 0
  buffer_load_dwordx4 v69, s[16:19], s56 offen lds
  v_xor_b32 v70, 64, v250
  s_mov_b32 m0, 105984
  s_nop 0
  buffer_load_dwordx4 v70, s[16:19], s56 offen lds
  v_xor_b32 v71, 64, v251
  s_mov_b32 m0, 106496
  s_nop 0
  buffer_load_dwordx4 v71, s[16:19], s56 offen lds
  s_add_i32 s56, s45, 14
  s_lshl_b32 s56, s56, 1
  s_add_i32 s56, s56, s41
  s_max_i32 s56, s56, 0
  s_min_i32 s56, s56, 223
  s_mul_i32 s56, s56, 86016
  v_xor_b32 v64, 96, v232
  s_mov_b32 m0, 107520
  s_nop 0
  buffer_load_dwordx4 v64, s[16:19], s56 offen lds
  v_xor_b32 v65, 96, v233
  s_mov_b32 m0, 108544
  s_nop 0
  buffer_load_dwordx4 v65, s[16:19], s56 offen lds
  v_xor_b32 v66, 96, v234
  s_mov_b32 m0, 109568
  s_nop 0
  buffer_load_dwordx4 v66, s[16:19], s56 offen lds
  v_xor_b32 v67, 96, v235
  s_mov_b32 m0, 110592
  s_nop 0
  buffer_load_dwordx4 v67, s[16:19], s56 offen lds
  v_xor_b32 v68, 96, v236
  s_mov_b32 m0, 111616
  s_nop 0
  buffer_load_dwordx4 v68, s[16:19], s56 offen lds
  v_xor_b32 v69, 96, v237
  s_mov_b32 m0, 112640
  s_nop 0
  buffer_load_dwordx4 v69, s[16:19], s56 offen lds
  v_xor_b32 v70, 96, v238
  s_mov_b32 m0, 113664
  s_nop 0
  buffer_load_dwordx4 v70, s[16:19], s56 offen lds
  v_xor_b32 v71, 96, v239
  s_mov_b32 m0, 114176
  s_nop 0
  buffer_load_dwordx4 v71, s[16:19], s56 offen lds
  s_add_i32 s56, s45, 15
  s_lshl_b32 s56, s56, 1
  s_add_i32 s56, s56, s41
  s_max_i32 s56, s56, 0
  s_min_i32 s56, s56, 223
  s_mul_i32 s56, s56, 86016
  v_xor_b32 v64, 96, v244
  s_mov_b32 m0, 115200
  s_nop 0
  buffer_load_dwordx4 v64, s[16:19], s56 offen lds
  v_xor_b32 v65, 96, v245
  s_mov_b32 m0, 116224
  s_nop 0
  buffer_load_dwordx4 v65, s[16:19], s56 offen lds
  v_xor_b32 v66, 96, v246
  s_mov_b32 m0, 117248
  s_nop 0
  buffer_load_dwordx4 v66, s[16:19], s56 offen lds
  v_xor_b32 v67, 96, v247
  s_mov_b32 m0, 118272
  s_nop 0
  buffer_load_dwordx4 v67, s[16:19], s56 offen lds
  v_xor_b32 v68, 96, v248
  s_mov_b32 m0, 119296
  s_nop 0
  buffer_load_dwordx4 v68, s[16:19], s56 offen lds
  v_xor_b32 v69, 96, v249
  s_mov_b32 m0, 120320
  s_nop 0
  buffer_load_dwordx4 v69, s[16:19], s56 offen lds
  v_xor_b32 v70, 96, v250
  s_mov_b32 m0, 121344
  s_nop 0
  buffer_load_dwordx4 v70, s[16:19], s56 offen lds
  v_xor_b32 v71, 96, v251
  s_mov_b32 m0, 121856
  s_nop 0
  buffer_load_dwordx4 v71, s[16:19], s56 offen lds
  s_waitcnt vmcnt(0)
  s_barrier
  s_add_i32 s56, s45, 16
  s_lshl_b32 s56, s56, 1
  s_add_i32 s56, s56, s41
  s_max_i32 s56, s56, 0
  s_min_i32 s56, s56, 223
  s_mul_i32 s56, s56, 86016
  s_mov_b32 m0, 122880
  s_nop 0
  buffer_load_dwordx4 v232, s[16:19], s56 offen lds
  s_mov_b32 m0, 123904
  s_nop 0
  buffer_load_dwordx4 v233, s[16:19], s56 offen lds
  s_mov_b32 m0, 124928
  s_nop 0
  buffer_load_dwordx4 v234, s[16:19], s56 offen lds
  s_mov_b32 m0, 125952
  s_nop 0
  buffer_load_dwordx4 v235, s[16:19], s56 offen lds
  s_mov_b32 m0, 126976
  s_nop 0
  buffer_load_dwordx4 v236, s[16:19], s56 offen lds
  s_mov_b32 m0, 128000
  s_nop 0
  buffer_load_dwordx4 v237, s[16:19], s56 offen lds
  s_mov_b32 m0, 129024
  s_nop 0
  buffer_load_dwordx4 v238, s[16:19], s56 offen lds
  s_mov_b32 m0, 129536
  s_nop 0
  buffer_load_dwordx4 v239, s[16:19], s56 offen lds
  s_add_i32 s56, s45, 17
  s_lshl_b32 s56, s56, 1
  s_add_i32 s56, s56, s41
  s_max_i32 s56, s56, 0
  s_min_i32 s56, s56, 223
  s_mul_i32 s56, s56, 86016
  s_mov_b32 m0, 130560
  s_nop 0
  buffer_load_dwordx4 v244, s[16:19], s56 offen lds
  s_mov_b32 m0, 131584
  s_nop 0
  buffer_load_dwordx4 v245, s[16:19], s56 offen lds
  s_mov_b32 m0, 132608
  s_nop 0
  buffer_load_dwordx4 v246, s[16:19], s56 offen lds
  s_mov_b32 m0, 133632
  s_nop 0
  buffer_load_dwordx4 v247, s[16:19], s56 offen lds
  s_mov_b32 m0, 134656
  s_nop 0
  buffer_load_dwordx4 v248, s[16:19], s56 offen lds
  s_mov_b32 m0, 135680
  s_nop 0
  buffer_load_dwordx4 v249, s[16:19], s56 offen lds
  s_mov_b32 m0, 136704
  s_nop 0
  buffer_load_dwordx4 v250, s[16:19], s56 offen lds
  s_mov_b32 m0, 137216
  s_nop 0
  buffer_load_dwordx4 v251, s[16:19], s56 offen lds
  s_add_i32 s56, s45, 18
  s_lshl_b32 s56, s56, 1
  s_add_i32 s56, s56, s41
  s_max_i32 s56, s56, 0
  s_min_i32 s56, s56, 223
  s_mul_i32 s56, s56, 86016
  v_xor_b32 v64, 32, v232
  s_mov_b32 m0, 138240
  s_nop 0
  buffer_load_dwordx4 v64, s[16:19], s56 offen lds
  v_xor_b32 v65, 32, v233
  s_mov_b32 m0, 139264
  s_nop 0
  buffer_load_dwordx4 v65, s[16:19], s56 offen lds
  v_xor_b32 v66, 32, v234
  s_mov_b32 m0, 140288
  s_nop 0
  buffer_load_dwordx4 v66, s[16:19], s56 offen lds
  v_xor_b32 v67, 32, v235
  s_mov_b32 m0, 141312
  s_nop 0
  buffer_load_dwordx4 v67, s[16:19], s56 offen lds
  v_xor_b32 v68, 32, v236
  s_mov_b32 m0, 142336
  s_nop 0
  buffer_load_dwordx4 v68, s[16:19], s56 offen lds
  v_xor_b32 v69, 32, v237
  s_mov_b32 m0, 143360
  s_nop 0
  buffer_load_dwordx4 v69, s[16:19], s56 offen lds
  v_xor_b32 v70, 32, v238
  s_mov_b32 m0, 144384
  s_nop 0
  buffer_load_dwordx4 v70, s[16:19], s56 offen lds
  v_xor_b32 v71, 32, v239
  s_mov_b32 m0, 144896
  s_nop 0
  buffer_load_dwordx4 v71, s[16:19], s56 offen lds
  s_add_i32 s56, s45, 19
  s_lshl_b32 s56, s56, 1
  s_add_i32 s56, s56, s41
  s_max_i32 s56, s56, 0
  s_min_i32 s56, s56, 223
  s_mul_i32 s56, s56, 86016
  v_xor_b32 v64, 32, v244
  s_mov_b32 m0, 145920
  s_nop 0
  buffer_load_dwordx4 v64, s[16:19], s56 offen lds
  v_xor_b32 v65, 32, v245
  s_mov_b32 m0, 146944
  s_nop 0
  buffer_load_dwordx4 v65, s[16:19], s56 offen lds
  v_xor_b32 v66, 32, v246
  s_mov_b32 m0, 147968
  s_nop 0
  buffer_load_dwordx4 v66, s[16:19], s56 offen lds
  v_xor_b32 v67, 32, v247
  s_mov_b32 m0, 148992
  s_nop 0
  buffer_load_dwordx4 v67, s[16:19], s56 offen lds
  v_xor_b32 v68, 32, v248
  s_mov_b32 m0, 150016
  s_nop 0
  buffer_load_dwordx4 v68, s[16:19], s56 offen lds
  v_xor_b32 v69, 32, v249
  s_mov_b32 m0, 151040
  s_nop 0
  buffer_load_dwordx4 v69, s[16:19], s56 offen lds
  v_xor_b32 v70, 32, v250
  s_mov_b32 m0, 152064
  s_nop 0
  buffer_load_dwordx4 v70, s[16:19], s56 offen lds
  v_xor_b32 v71, 32, v251
  s_mov_b32 m0, 152576
  s_nop 0
  buffer_load_dwordx4 v71, s[16:19], s56 offen lds
  s_waitcnt vmcnt(0)
  v_mov_b32 v6, 0
  s_mov_b32 s59, 0
  s_mov_b64 exec, 1
H_pollV:
  buffer_load_dword v7, v6, s[36:39], 0 offen offset:132 sc1
  s_waitcnt vmcnt(0)
  v_cmp_eq_u32 vcc, 0, v7
  s_add_u32 s59, s59, 1
  s_cmp_gt_u32 s59, 200000
  s_cbranch_scc1 H_pollV_x
  s_cmp_lg_u64 vcc, 0
  s_cbranch_scc0 H_pollV_x
  s_sleep 2
  s_branch H_pollV
H_pollV_x:
  s_mov_b64 exec, -1
  s_lshr_b32 s55, s2, 3
  s_mul_i32 s55, s55, 2304
  buffer_load_dwordx4 v[80:83], v252, s[24:27], s55 offen offset:0 sc1
  buffer_load_dwordx4 v[84:87], v252, s[24:27], s55 offen offset:1024 sc1
  buffer_load_dwordx4 v[88:91], v252, s[24:27], s55 offen offset:2048 sc1
  s_barrier
  s_mov_b32 m0, 153600
  s_mov_b32 s59, 0
  buffer_load_dwordx4 v252, s[24:27], s59 offen offset:0 sc1 lds
  buffer_load_dwordx4 v252, s[24:27], s59 offen offset:1024 sc1 lds
  buffer_load_dwordx4 v252, s[24:27], s59 offen offset:2048 sc1 lds
  buffer_load_dwordx4 v252, s[24:27], s59 offen offset:3072 sc1 lds
  s_mov_b32 m0, 157696
  s_mov_b32 s59, 4096
  buffer_load_dwordx4 v252, s[24:27], s59 offen offset:0 sc1 lds
  buffer_load_dwordx4 v252, s[24:27], s59 offen offset:1024 sc1 lds
  buffer_load_dwordx4 v252, s[24:27], s59 offen offset:2048 sc1 lds
  buffer_load_dwordx4 v252, s[24:27], s59 offen offset:3072 sc1 lds
  s_mov_b32 m0, 161792
  s_mov_b32 s59, 8192
  buffer_load_dwordx4 v252, s[24:27], s59 offen offset:0 sc1 lds
  buffer_load_dwordx4 v252, s[24:27], s59 offen offset:1024 sc1 lds
  s_waitcnt vmcnt(0)
  s_barrier
  s_mov_b32 m0, 31744
  s_mov_b32 s59, 56320
  buffer_load_dwordx4 v252, s[24:27], s59 offen offset:0 sc1 lds
  buffer_load_dwordx4 v252, s[24:27], s59 offen offset:1024 sc1 lds
  buffer_load_dwordx4 v252, s[24:27], s59 offen offset:2048 sc1 lds
  buffer_load_dwordx4 v252, s[24:27], s59 offen offset:3072 sc1 lds
  s_mov_b32 m0, 35840
  s_mov_b32 s59, 60416
  buffer_load_dwordx4 v252, s[24:27], s59 offen offset:0 sc1 lds
  buffer_load_dwordx4 v252, s[24:27], s59 offen offset:1024 sc1 lds
  buffer_load_dwordx4 v252, s[24:27], s59 offen offset:2048 sc1 lds
  buffer_load_dwordx4 v252, s[24:27], s59 offen offset:3072 sc1 lds
  s_mov_b32 m0, 39936
  s_mov_b32 s59, 64512
  buffer_load_dwordx4 v252, s[24:27], s59 offen offset:0 sc1 lds
  buffer_load_dwordx4 v252, s[24:27], s59 offen offset:1024 sc1 lds
  buffer_load_dwordx4 v252, s[24:27], s59 offen offset:2048 sc1 lds
  buffer_load_dwordx4 v252, s[24:27], s59 offen offset:3072 sc1 lds
  s_mov_b32 m0, 44032
  s_mov_b32 s59, 68608
  buffer_load_dwordx4 v252, s[24:27], s59 offen offset:0 sc1 lds
  buffer_load_dwordx4 v252, s[24:27], s59 offen offset:1024 sc1 lds
  buffer_load_dwordx4 v252, s[24:27], s59 offen offset:2048 sc1 lds
  buffer_load_dwordx4 v252, s[24:27], s59 offen offset:3072 sc1 lds
  s_mov_b32 m0, 48128
  s_mov_b32 s59, 72704
  buffer_load_dwordx4 v252, s[24:27], s59 offen offset:0 sc1 lds
  s_waitcnt vmcnt(0)
  s_barrier
M_done:
  s_endpgm
CODE_END:
.section .rodata,"a"
.p2align 6
.amdhsa_kernel standalone__neighborhood_nat__vision_kernel
  .amdhsa_next_free_vgpr 256
  .amdhsa_next_free_sgpr 102
  .amdhsa_accum_offset 256
  .amdhsa_group_segment_fixed_size 0
  .amdhsa_kernarg_size 48
  .amdhsa_user_sgpr_count 2
  .amdhsa_user_sgpr_kernarg_segment_ptr 1
  .amdhsa_system_sgpr_workgroup_id_x 1
.end_amdhsa_kernel
```

```asm
; @launch grid=(256,1,1) block=(512,1,1) lds=163840
.amdgcn_target "amdgcn-amd-amdhsa--gfx950"
.text
.globl standalone__neighborhood_nat__vision_kernel
.p2align 8
.type standalone__neighborhood_nat__vision_kernel,@function
standalone__neighborhood_nat__vision_kernel:
  s_cmp_ge_u32 s2, 256
  s_cbranch_scc1 M_done
  s_load_dwordx8 s[4:11], s[0:1], 0
  s_load_dwordx4 s[12:15], s[0:1], 32
  v_lshrrev_b32 v4, 6, v0
  v_and_b32 v1, 63, v0
  v_readfirstlane_b32 s40, v4
  v_lshrrev_b32 v2, 4, v1
  v_and_b32 v3, 15, v1
  v_lshlrev_b32 v252, 4, v1
  s_getpc_b64 s[16:17]
  s_and_b32 s16, s16, -256
  s_and_b32 s17, s17, 0xffff
  s_mov_b32 s18, CODE_END-standalone__neighborhood_nat__vision_kernel
  s_mov_b32 s19, 0x00020000
  s_lshr_b32 s55, s2, 3
  s_lshl_b32 s55, s55, 10
  s_cmp_lg_u32 s40, 3
  s_cbranch_scc1 M_nocpf
  buffer_load_dwordx4 v[136:139], v252, s[16:19], s55 offen
M_nocpf:
  s_cmp_lg_u32 s40, 0
  s_cbranch_scc1 M_comp
  v_bfe_u32 v5, v1, 2, 2
  v_lshrrev_b32 v6, 5, v1
  v_lshlrev_b32 v7, 1, v6
  v_and_b32 v8, 3, v1
  v_xor_b32 v7, v7, v8
  v_lshlrev_b32 v7, 4, v7
  s_movk_i32 s60, 1152
  v_lshl_add_u32 v4, v2, 3, v5
  v_mad_u32_u24 v200, v4, s60, v7
  v_lshrrev_b32 v4, 2, v1
  v_mad_u32_u24 v203, v4, s60, v7
  v_lshrrev_b32 v4, 3, v3
  v_lshlrev_b32 v4, 1, v4
  v_xor_b32 v4, v4, v2
  v_lshl_add_u32 v4, v3, 2, v4
  v_lshlrev_b32 v195, 4, v4
  v_add_u32 v195, 90112, v195
  s_waitcnt lgkmcnt(0)
  s_mov_b32 s28, s6
  s_and_b32 s29, s7, 0xffff
  s_mov_b32 s30, 221184
  s_mov_b32 s31, 0x00020000
  s_cmp_ge_u32 s2, 36
  s_cbranch_scc1 H_nom
  s_mul_hi_u32 s55, s2, 0x2aaaaaab
  s_mul_i32 s56, s55, 6
  s_sub_u32 s56, s2, s56
  s_mul_i32 s55, s55, 36864
  s_mul_i32 s56, s56, 36864
  s_mov_b32 m0, 90112
  s_nop 0
  buffer_load_dwordx4 v200, s[28:31], s56 offen offset:0 lds
  s_mov_b32 m0, 102016
  s_nop 0
  buffer_load_dwordx4 v200, s[28:31], s55 offen offset:384 lds
  s_mov_b32 m0, 91072
  s_nop 0
  buffer_load_dwordx4 v200, s[28:31], s56 offen offset:64 lds
  s_mov_b32 m0, 102976
  s_nop 0
  buffer_load_dwordx4 v200, s[28:31], s55 offen offset:448 lds
  s_mov_b32 m0, 92032
  s_nop 0
  buffer_load_dwordx4 v200, s[28:31], s56 offen offset:128 lds
  s_mov_b32 m0, 103936
  s_nop 0
  buffer_load_dwordx4 v200, s[28:31], s55 offen offset:512 lds
  s_mov_b32 m0, 92992
  s_nop 0
  buffer_load_dwordx4 v200, s[28:31], s56 offen offset:192 lds
  s_mov_b32 m0, 104896
  s_nop 0
  buffer_load_dwordx4 v200, s[28:31], s55 offen offset:576 lds
  s_mov_b32 m0, 93952
  s_nop 0
  buffer_load_dwordx4 v200, s[28:31], s56 offen offset:256 lds
  s_mov_b32 m0, 105856
  s_nop 0
  buffer_load_dwordx4 v200, s[28:31], s55 offen offset:640 lds
  s_mov_b32 m0, 94912
  s_nop 0
  buffer_load_dwordx4 v200, s[28:31], s56 offen offset:320 lds
  s_mov_b32 m0, 106816
  s_nop 0
  buffer_load_dwordx4 v200, s[28:31], s55 offen offset:704 lds
  s_add_u32 s55, s55, 4608
  s_add_u32 s56, s56, 4608
  s_mov_b32 m0, 96256
  s_nop 0
  buffer_load_dwordx4 v200, s[28:31], s56 offen offset:0 lds
  s_mov_b32 m0, 108160
  s_nop 0
  buffer_load_dwordx4 v200, s[28:31], s55 offen offset:384 lds
  s_mov_b32 m0, 97216
  s_nop 0
  buffer_load_dwordx4 v200, s[28:31], s56 offen offset:64 lds
  s_mov_b32 m0, 109120
  s_nop 0
  buffer_load_dwordx4 v200, s[28:31], s55 offen offset:448 lds
  s_mov_b32 m0, 98176
  s_nop 0
  buffer_load_dwordx4 v200, s[28:31], s56 offen offset:128 lds
  s_mov_b32 m0, 110080
  s_nop 0
  buffer_load_dwordx4 v200, s[28:31], s55 offen offset:512 lds
  s_mov_b32 m0, 99136
  s_nop 0
  buffer_load_dwordx4 v200, s[28:31], s56 offen offset:192 lds
  s_mov_b32 m0, 111040
  s_nop 0
  buffer_load_dwordx4 v200, s[28:31], s55 offen offset:576 lds
  s_mov_b32 m0, 100096
  s_nop 0
  buffer_load_dwordx4 v200, s[28:31], s56 offen offset:256 lds
  s_mov_b32 m0, 112000
  s_nop 0
  buffer_load_dwordx4 v200, s[28:31], s55 offen offset:640 lds
  s_mov_b32 m0, 101056
  s_nop 0
  buffer_load_dwordx4 v200, s[28:31], s56 offen offset:320 lds
  s_mov_b32 m0, 112960
  s_nop 0
  buffer_load_dwordx4 v200, s[28:31], s55 offen offset:704 lds
  s_mov_b32 s16, s4
  s_and_b32 s17, s5, 0xffff
  s_mov_b32 s18, 19267584
  s_mov_b32 s19, 0x00020000
  s_mov_b32 s24, s14
  s_and_b32 s25, s15, 0xffff
  s_mov_b32 s26, 268435456
  s_mov_b32 s27, 0x00020000
  s_mov_b32 s20, s10
  s_and_b32 s21, s11, 0xffff
  s_mov_b32 s22, 19267584
  s_mov_b32 s23, 0x00020000
  s_mov_b32 s36, s12
  s_and_b32 s37, s13, 0xffff
  s_mov_b32 s38, 256
  s_mov_b32 s39, 0x00020000
  s_lshl_b32 s55, s2, 11
  s_add_u32 s55, s55, 131072
  s_barrier
  s_waitcnt vmcnt(0)
  ds_read_b128 v[64:67], v195 offset:0
  ds_read_b128 v[88:91], v195 offset:6144
  ds_read_b128 v[112:115], v195 offset:12288
  ds_read_b128 v[136:139], v195 offset:18432
  ds_read_b128 v[68:71], v195 offset:1024
  ds_read_b128 v[92:95], v195 offset:7168
  ds_read_b128 v[116:119], v195 offset:13312
  ds_read_b128 v[140:143], v195 offset:19456
  ds_read_b128 v[72:75], v195 offset:2048
  ds_read_b128 v[96:99], v195 offset:8192
  ds_read_b128 v[120:123], v195 offset:14336
  ds_read_b128 v[144:147], v195 offset:20480
  s_waitcnt lgkmcnt(9)
  v_mfma_f32_16x16x32_bf16 v[160:163], v[64:67], v[112:115], 0
  v_mfma_f32_16x16x32_bf16 v[164:167], v[88:91], v[112:115], 0
  s_waitcnt lgkmcnt(8)
  v_mfma_f32_16x16x32_bf16 v[168:171], v[64:67], v[136:139], 0
  v_mfma_f32_16x16x32_bf16 v[172:175], v[88:91], v[136:139], 0
  ds_read_b128 v[76:79], v195 offset:3072
  ds_read_b128 v[100:103], v195 offset:9216
  ds_read_b128 v[124:127], v195 offset:15360
  ds_read_b128 v[148:151], v195 offset:21504
  s_waitcnt lgkmcnt(9)
  v_mfma_f32_16x16x32_bf16 v[160:163], v[68:71], v[116:119], v[160:163]
  v_mfma_f32_16x16x32_bf16 v[164:167], v[92:95], v[116:119], v[164:167]
  s_waitcnt lgkmcnt(8)
  v_mfma_f32_16x16x32_bf16 v[168:171], v[68:71], v[140:143], v[168:171]
  v_mfma_f32_16x16x32_bf16 v[172:175], v[92:95], v[140:143], v[172:175]
  ds_read_b128 v[80:83], v195 offset:4096
  ds_read_b128 v[104:107], v195 offset:10240
  ds_read_b128 v[128:131], v195 offset:16384
  ds_read_b128 v[152:155], v195 offset:22528
  s_waitcnt lgkmcnt(9)
  v_mfma_f32_16x16x32_bf16 v[160:163], v[72:75], v[120:123], v[160:163]
  v_mfma_f32_16x16x32_bf16 v[164:167], v[96:99], v[120:123], v[164:167]
  s_waitcnt lgkmcnt(8)
  v_mfma_f32_16x16x32_bf16 v[168:171], v[72:75], v[144:147], v[168:171]
  v_mfma_f32_16x16x32_bf16 v[172:175], v[96:99], v[144:147], v[172:175]
  ds_read_b128 v[84:87], v195 offset:5120
  ds_read_b128 v[108:111], v195 offset:11264
  ds_read_b128 v[132:135], v195 offset:17408
  ds_read_b128 v[156:159], v195 offset:23552
  s_waitcnt lgkmcnt(9)
  v_mfma_f32_16x16x32_bf16 v[160:163], v[76:79], v[124:127], v[160:163]
  v_mfma_f32_16x16x32_bf16 v[164:167], v[100:103], v[124:127], v[164:167]
  s_waitcnt lgkmcnt(8)
  v_mfma_f32_16x16x32_bf16 v[168:171], v[76:79], v[148:151], v[168:171]
  v_mfma_f32_16x16x32_bf16 v[172:175], v[100:103], v[148:151], v[172:175]
  s_waitcnt lgkmcnt(5)
  v_mfma_f32_16x16x32_bf16 v[160:163], v[80:83], v[128:131], v[160:163]
  v_mfma_f32_16x16x32_bf16 v[164:167], v[104:107], v[128:131], v[164:167]
  s_waitcnt lgkmcnt(4)
  v_mfma_f32_16x16x32_bf16 v[168:171], v[80:83], v[152:155], v[168:171]
  v_mfma_f32_16x16x32_bf16 v[172:175], v[104:107], v[152:155], v[172:175]
  s_waitcnt lgkmcnt(1)
  v_mfma_f32_16x16x32_bf16 v[160:163], v[84:87], v[132:135], v[160:163]
  v_mfma_f32_16x16x32_bf16 v[164:167], v[108:111], v[132:135], v[164:167]
  s_waitcnt lgkmcnt(0)
  v_mfma_f32_16x16x32_bf16 v[168:171], v[84:87], v[156:159], v[168:171]
  v_mfma_f32_16x16x32_bf16 v[172:175], v[108:111], v[156:159], v[172:175]
  s_nop 3
  v_cvt_pk_bf16_f32 v176, v160, v161
  v_cvt_pk_bf16_f32 v177, v162, v163
  v_cvt_pk_bf16_f32 v178, v164, v165
  v_cvt_pk_bf16_f32 v179, v166, v167
  buffer_store_dwordx4 v[176:179], v252, s[24:27], s55 offen offset:0 sc1
  v_cvt_pk_bf16_f32 v180, v168, v169
  v_cvt_pk_bf16_f32 v181, v170, v171
  v_cvt_pk_bf16_f32 v182, v172, v173
  v_cvt_pk_bf16_f32 v183, v174, v175
  buffer_store_dwordx4 v[180:183], v252, s[24:27], s55 offen offset:1024 sc1
  v_mov_b32 v192, 1
  v_mov_b32 v193, 0
  s_mov_b64 exec, 1
  s_waitcnt vmcnt(0)
  buffer_atomic_add v192, v193, s[36:39], 0 offen offset:0 sc0 sc1
  s_mov_b64 exec, -1
  s_barrier
  s_waitcnt vmcnt(0)
  v_readfirstlane_b32 s56, v192
  s_nop 0
  s_cmp_lg_u32 s56, 35
  s_cbranch_scc1 H_p1
  s_mov_b64 exec, 1
  buffer_store_dword v192, v193, s[36:39], 0 offen offset:128 sc1
  s_mov_b64 exec, -1
H_p1:
  s_barrier
  s_branch H_join
H_nom:
  s_mov_b32 s32, s8
  s_and_b32 s33, s9, 0xffff
  s_mov_b32 s34, 73728
  s_mov_b32 s35, 0x00020000
  s_cmp_ge_u32 s2, 180
  s_cbranch_scc1 H_nov1
  s_sub_u32 s58, s2, 36
  s_mul_hi_u32 s55, s58, 0x15555556
  s_mul_i32 s56, s55, 12
  s_sub_u32 s56, s58, s56
  s_mul_i32 s57, s55, 18432
  s_mov_b32 m0, 91392
  s_nop 0
  buffer_load_dwordx4 v203, s[28:31], s57 offen offset:768 lds
  s_mov_b32 m0, 92352
  s_nop 0
  buffer_load_dwordx4 v203, s[28:31], s57 offen offset:832 lds
  s_mov_b32 m0, 93312
  s_nop 0
  buffer_load_dwordx4 v203, s[28:31], s57 offen offset:896 lds
  s_mov_b32 m0, 94272
  s_nop 0
  buffer_load_dwordx4 v203, s[28:31], s57 offen offset:960 lds
  s_mov_b32 m0, 95232
  s_nop 0
  buffer_load_dwordx4 v203, s[28:31], s57 offen offset:1024 lds
  s_mov_b32 m0, 96192
  s_nop 0
  buffer_load_dwordx4 v203, s[28:31], s57 offen offset:1088 lds
  v_lshrrev_b32 v112, 1, v1
  v_mul_u32_u24 v112, 384, v112
  v_and_b32 v113, 1, v1
  v_lshl_add_u32 v112, v113, 4, v112
  s_lshl_b32 s57, s56, 5
  s_mov_b32 m0, 98304
  s_nop 0
  buffer_load_dwordx4 v112, s[32:35], s57 offen lds
  s_add_u32 s57, s57, 12288
  s_mov_b32 m0, 99328
  s_nop 0
  buffer_load_dwordx4 v112, s[32:35], s57 offen lds
  s_add_u32 s57, s57, 12288
  s_mov_b32 m0, 100352
  s_nop 0
  buffer_load_dwordx4 v112, s[32:35], s57 offen lds
  s_add_u32 s57, s57, 12288
  s_mov_b32 m0, 101376
  s_nop 0
  buffer_load_dwordx4 v112, s[32:35], s57 offen lds
  s_add_u32 s57, s57, 12288
  s_mov_b32 m0, 102400
  s_nop 0
  buffer_load_dwordx4 v112, s[32:35], s57 offen lds
  s_add_u32 s57, s57, 12288
  s_mov_b32 m0, 103424
  s_nop 0
  buffer_load_dwordx4 v112, s[32:35], s57 offen lds
  s_add_u32 s57, s57, 12288
  s_lshr_b32 s57, s56, 2
  s_mul_i32 s95, s57, 24576
  s_and_b32 s56, s56, 3
  s_lshl_b32 s56, s56, 6
  s_add_u32 s95, s95, s56
  s_lshr_b32 s56, s55, 1
  s_lshl_b32 s56, s56, 11
  s_add_u32 s95, s95, s56
  s_and_b32 s55, s55, 1
  s_lshl_b32 s55, s55, 3
  s_add_u32 s95, s95, s55
H_nov1:
  s_barrier
  s_mov_b32 s16, s4
  s_and_b32 s17, s5, 0xffff
  s_mov_b32 s18, 19267584
  s_mov_b32 s19, 0x00020000
  s_mov_b32 s24, s14
  s_and_b32 s25, s15, 0xffff
  s_mov_b32 s26, 268435456
  s_mov_b32 s27, 0x00020000
  s_mov_b32 s20, s10
  s_and_b32 s21, s11, 0xffff
  s_mov_b32 s22, 19267584
  s_mov_b32 s23, 0x00020000
  s_mov_b32 s36, s12
  s_and_b32 s37, s13, 0xffff
  s_mov_b32 s38, 256
  s_mov_b32 s39, 0x00020000
  s_cmp_ge_u32 s2, 180
  s_cbranch_scc1 H_join
  v_lshlrev_b32 v119, 3, v3
  v_lshl_add_u32 v119, v2, 8, v119
  v_add_u32 v119, 90112, v119
  s_waitcnt vmcnt(0)
  ds_read_b128 v[64:67], v195 offset:2048
  ds_read_b128 v[68:71], v195 offset:3072
  ds_read_b128 v[72:75], v195 offset:4096
  ds_read_b128 v[76:79], v195 offset:5120
  ds_read_b128 v[80:83], v195 offset:6144
  ds_read_b128 v[84:87], v195 offset:7168
  s_waitcnt lgkmcnt(2)
  ds_read_b64_tr_b16 v[88:89], v119 offset:8192
  ds_read_b64_tr_b16 v[90:91], v119 offset:8320
  ds_read_b64_tr_b16 v[92:93], v119 offset:9216
  ds_read_b64_tr_b16 v[94:95], v119 offset:9344
  ds_read_b64_tr_b16 v[96:97], v119 offset:10240
  ds_read_b64_tr_b16 v[98:99], v119 offset:10368
  ds_read_b64_tr_b16 v[100:101], v119 offset:11264
  ds_read_b64_tr_b16 v[102:103], v119 offset:11392
  ds_read_b64_tr_b16 v[104:105], v119 offset:12288
  ds_read_b64_tr_b16 v[106:107], v119 offset:12416
  ds_read_b64_tr_b16 v[108:109], v119 offset:13312
  ds_read_b64_tr_b16 v[110:111], v119 offset:13440
  s_waitcnt lgkmcnt(0)
  v_mfma_f32_16x16x32_bf16 v[112:115], v[64:67], v[88:91], 0
  v_mfma_f32_16x16x32_bf16 v[112:115], v[68:71], v[92:95], v[112:115]
  v_mfma_f32_16x16x32_bf16 v[112:115], v[72:75], v[96:99], v[112:115]
  v_mfma_f32_16x16x32_bf16 v[112:115], v[76:79], v[100:103], v[112:115]
  v_mfma_f32_16x16x32_bf16 v[112:115], v[80:83], v[104:107], v[112:115]
  v_mfma_f32_16x16x32_bf16 v[112:115], v[84:87], v[108:111], v[112:115]
  v_bfe_u32 v118, v3, 1, 1
  v_mul_u32_u24 v118, 12288, v118
  v_and_b32 v119, 1, v3
  v_lshl_add_u32 v118, v119, 10, v118
  v_lshrrev_b32 v119, 2, v3
  v_lshl_add_u32 v118, v119, 4, v118
  v_lshl_add_u32 v118, v2, 8, v118
  s_nop 0
  v_cvt_pk_bf16_f32 v116, v112, v113
  v_cvt_pk_bf16_f32 v117, v114, v115
  buffer_store_dwordx2 v[116:117], v118, s[24:27], s95 offen sc1
  s_branch H_join
M_comp:
  s_and_b32 s55, s2, 7
  s_lshr_b32 s56, s2, 3
  s_lshr_b32 s41, s55, 2
  s_bfe_u32 s42, s55, 0x10001
  s_and_b32 s55, s55, 1
  s_lshl_b32 s55, s55, 2
  s_lshr_b32 s43, s56, 3
  s_add_u32 s43, s43, s55
  s_and_b32 s44, s56, 7
  s_mul_i32 s43, s43, 14
  s_mul_i32 s44, s44, 14
  s_mul_i32 s61, s41, 13
  s_add_i32 s61, s61, -6
  s_cmp_eq_u32 s42, 0
  s_cselect_b32 s62, 85632, 0
  s_cselect_b32 s50, -1, 1
  s_mulk_i32 s50, 384
  s_cmp_ge_u32 s40, 4
  s_cselect_b32 s53, -4, 3
  s_add_i32 s53, s53, s40
  s_lshl_b32 s53, s53, 1
  s_add_u32 s88, s43, s53
  s_mov_b32 s89, 86016
  v_lshrrev_b32 v4, 3, v1
  v_and_b32 v5, 7, v1
  v_and_b32 v6, 6, v4
  v_xor_b32 v5, v5, v6
  v_lshl_add_u32 v5, v5, 4, s62
  v_add_u32 v8, 2, v4
  v_lshrrev_b32 v8, 3, v8
  v_add_u32 v4, s44, v4
  v_lshl_add_u32 v6, v4, 1, 7
  v_add_u32 v7, 112, v4
  v_min_u32 v6, v6, v7
  v_mad_i32_i24 v168, v6, s50, v5
  v_lshl_add_u32 v6, v4, 1, 19
  v_add_u32 v7, 118, v4
  v_min_u32 v6, v6, v7
  v_mad_i32_i24 v169, v6, s50, v5
  v_lshl_add_u32 v168, v8, 30, v168
  s_add_u32 s55, s88, 0
  s_lshl_b32 s56, s55, 1
  s_add_i32 s56, s56, s61
  s_max_i32 s56, s56, s55
  s_add_i32 s55, s55, 112
  s_min_i32 s56, s56, s55
  s_mul_i32 s84, s56, 86016
  s_add_u32 s55, s88, 1
  s_lshl_b32 s56, s55, 1
  s_add_i32 s56, s56, s61
  s_max_i32 s56, s56, s55
  s_add_i32 s55, s55, 112
  s_min_i32 s56, s56, s55
  s_mul_i32 s85, s56, 86016
  s_lshl_b32 s86, s53, 12
  s_lshl_b32 s87, s53, 11
  s_waitcnt lgkmcnt(0)
  s_mov_b32 s16, s4
  s_and_b32 s17, s5, 0xffff
  s_mov_b32 s18, 19267584
  s_mov_b32 s19, 0x00020000
  s_barrier
  s_add_u32 m0, s86, 512
  s_nop 0
  buffer_load_dwordx4 v168, s[16:19], s84 offen offset:0 lds
  s_add_u32 m0, s86, 1536
  s_nop 0
  buffer_load_dwordx4 v168, s[16:19], s85 offen offset:0 lds
  s_add_u32 m0, s86, 2560
  s_nop 0
  buffer_load_dwordx4 v169, s[16:19], s84 offen offset:0 lds
  s_add_u32 m0, s86, 3584
  s_nop 0
  buffer_load_dwordx4 v169, s[16:19], s85 offen offset:0 lds
  s_cmp_lt_u32 s2, 36
  s_cbranch_scc1 M_x1
  s_add_u32 m0, s86, 4480
  s_nop 0
  buffer_load_dwordx4 v168, s[16:19], s84 offen offset:128 lds
  s_add_u32 m0, s86, 5504
  s_nop 0
  buffer_load_dwordx4 v168, s[16:19], s85 offen offset:128 lds
  s_add_u32 m0, s86, 6528
  s_nop 0
  buffer_load_dwordx4 v169, s[16:19], s84 offen offset:128 lds
  s_add_u32 m0, s86, 7552
  s_nop 0
  buffer_load_dwordx4 v169, s[16:19], s85 offen offset:128 lds
  s_add_u32 m0, s87, 61184
  s_nop 0
  buffer_load_dwordx4 v168, s[16:19], s84 offen offset:256 lds
  s_add_u32 m0, s87, 62208
  s_nop 0
  buffer_load_dwordx4 v168, s[16:19], s85 offen offset:256 lds
  s_add_u32 m0, s87, 63232
  s_nop 0
  buffer_load_dwordx4 v169, s[16:19], s84 offen offset:256 lds
  s_add_u32 m0, s87, 64256
  s_nop 0
  buffer_load_dwordx4 v169, s[16:19], s85 offen offset:256 lds
M_x1:
  s_mov_b32 s24, s14
  s_and_b32 s25, s15, 0xffff
  s_mov_b32 s26, 268435456
  s_mov_b32 s27, 0x00020000
  s_mov_b32 s20, s10
  s_and_b32 s21, s11, 0xffff
  s_mov_b32 s22, 19267584
  s_mov_b32 s23, 0x00020000
  s_mov_b32 s36, s12
  s_and_b32 s37, s13, 0xffff
  s_mov_b32 s38, 256
  s_mov_b32 s39, 0x00020000
  s_mul_i32 s55, s41, 6
  s_add_i32 s45, s43, s55
  s_add_i32 s45, s45, -6
  s_cmp_eq_i32 s45, -6
  s_cselect_b32 s47, 6, 0
  s_cmp_eq_i32 s45, 98
  s_cselect_b32 s48, 7, 13
  s_cselect_b32 s49, 2, 0
  s_sub_i32 s45, s45, s49
  s_cmp_eq_i32 s44, 98
  s_cselect_b32 s51, 7, 13
  s_lshl_b32 s56, s44, 1
  s_add_i32 s56, s56, 1
  s_mul_i32 s46, s56, s50
  s_add_i32 s46, s46, s62
  s_lshl_b32 s91, s50, 1
  s_lshl_b32 s3, s91, 3
  s_add_i32 s91, s91, -384
  s_max_i32 s92, s53, s47
  s_min_i32 s92, s92, s48
  s_and_b32 s92, s92, -2
  s_add_u32 s52, s92, s49
  s_mov_b32 s54, 4286578688
  s_mov_b32 s63, 1037384597
  s_and_b32 s93, s40, 1
  s_lshl_b32 s93, s93, 3
  s_and_b32 s56, s40, 6
  s_or_b32 s93, s93, s56
  s_add_u32 s56, s40, 8
  s_add_i32 s100, s45, s56
  s_lshl_b32 s100, s100, 1
  s_add_i32 s100, s100, s41
  s_max_i32 s100, s100, 0
  s_min_i32 s100, s100, 223
  s_mul_i32 s100, s100, 86016
  s_mul_i32 s101, s56, 7680
  v_lshrrev_b32 v4, 3, v3
  v_add_u32 v4, s53, v4
  v_max_i32 v4, s47, v4
  v_min_i32 v4, s48, v4
  v_subrev_u32 v4, s92, v4
  v_and_b32 v5, 1, v2
  v_sub_u32 v6, v5, v4
  v_ashrrev_i32 v12, 31, v6
  v_and_b32 v12, s54, v12
  v_sub_u32 v6, v4, v5
  v_ashrrev_i32 v13, 31, v6
  v_and_b32 v13, s54, v13
  v_and_b32 v4, 7, v3
  v_lshrrev_b32 v5, 1, v2
  v_subrev_u32 v7, 6, v4
  v_ashrrev_i32 v7, 31, v7
  v_and_b32 v7, 0x7f, v7
  v_add_u32 v6, 0, v4
  v_min_i32 v6, s51, v6
  v_lshlrev_b32 v6, v6, v7
  v_lshrrev_b32 v6, v5, v6
  v_not_b32 v14, v6
  v_mov_b32 v7, 0x7f
  v_add_u32 v6, 6, v4
  v_min_i32 v6, s51, v6
  v_lshlrev_b32 v6, v6, v7
  v_lshrrev_b32 v6, v5, v6
  v_not_b32 v15, v6
  v_add_u32 v4, s52, v4
  v_and_b32 v5, 1, v4
  v_lshlrev_b32 v5, 3, v5
  v_and_or_b32 v5, v4, 6, v5
  v_mul_u32_u24 v4, 7680, v4
  v_lshrrev_b32 v6, 3, v3
  v_mul_u32_u24 v6, 24, v6
  v_add_u32 v6, v6, v2
  v_add_u32 v7, 0, v6
  v_xor_b32 v7, v7, v5
  v_lshl_add_u32 v240, v7, 4, v4
  v_add_u32 v7, 4, v6
  v_xor_b32 v7, v7, v5
  v_lshl_add_u32 v241, v7, 4, v4
  v_add_u32 v7, 8, v6
  v_xor_b32 v7, v7, v5
  v_lshl_add_u32 v242, v7, 4, v4
  v_add_u32 v7, 12, v6
  v_xor_b32 v7, v7, v5
  v_lshl_add_u32 v243, v7, 4, v4
  v_and_b32 v4, 1, v2
  v_lshlrev_b32 v4, 2, v4
  v_lshrrev_b32 v5, 2, v3
  v_add3_u32 v4, v4, v5, s52
  v_and_b32 v5, 1, v4
  v_lshlrev_b32 v5, 3, v5
  v_and_or_b32 v5, v4, 6, v5
  v_mul_u32_u24 v4, 7680, v4
  v_and_b32 v6, 1, v3
  v_lshl_add_u32 v4, v6, 3, v4
  v_lshrrev_b32 v6, 1, v2
  v_mul_u32_u24 v6, 24, v6
  v_bfe_u32 v7, v3, 1, 1
  v_add_u32 v6, v6, v7
  v_add_u32 v7, 0, v6
  v_xor_b32 v7, v7, v5
  v_lshl_add_u32 v244, v7, 4, v4
  v_add_u32 v7, 2, v6
  v_xor_b32 v7, v7, v5
  v_lshl_add_u32 v245, v7, 4, v4
  v_add_u32 v7, 4, v6
  v_xor_b32 v7, v7, v5
  v_lshl_add_u32 v246, v7, 4, v4
  v_add_u32 v7, 6, v6
  v_xor_b32 v7, v7, v5
  v_lshl_add_u32 v247, v7, 4, v4
  v_add_u32 v7, 8, v6
  v_xor_b32 v7, v7, v5
  v_lshl_add_u32 v248, v7, 4, v4
  v_add_u32 v7, 10, v6
  v_xor_b32 v7, v7, v5
  v_lshl_add_u32 v249, v7, 4, v4
  v_add_u32 v7, 12, v6
  v_xor_b32 v7, v7, v5
  v_lshl_add_u32 v250, v7, 4, v4
  v_add_u32 v7, 14, v6
  v_xor_b32 v7, v7, v5
  v_lshl_add_u32 v251, v7, 4, v4
  v_add_u32 v253, 153600, v252
  v_add_u32 v254, 90112, v252
  v_add_u32 v4, 0, v1
  v_xor_b32 v4, s93, v4
  v_mul_u32_u24 v5, 2731, v4
  v_lshrrev_b32 v5, 16, v5
  v_mul_i32_i24 v5, s91, v5
  v_lshl_add_u32 v4, v4, 4, v5
  v_add_u32 v232, s46, v4
  v_add_u32 v235, s3, v232
  v_add_u32 v238, s3, v235
  v_add_u32 v4, 64, v1
  v_xor_b32 v4, s93, v4
  v_mul_u32_u24 v5, 2731, v4
  v_lshrrev_b32 v5, 16, v5
  v_mul_i32_i24 v5, s91, v5
  v_lshl_add_u32 v4, v4, 4, v5
  v_add_u32 v233, s46, v4
  v_add_u32 v236, s3, v233
  v_add_u32 v4, 128, v1
  v_xor_b32 v4, s93, v4
  v_mul_u32_u24 v5, 2731, v4
  v_lshrrev_b32 v5, 16, v5
  v_mul_i32_i24 v5, s91, v5
  v_lshl_add_u32 v4, v4, 4, v5
  v_add_u32 v234, s46, v4
  v_add_u32 v237, s3, v234
  v_add_u32 v4, 416, v1
  v_xor_b32 v4, s93, v4
  v_mul_u32_u24 v5, 2731, v4
  v_lshrrev_b32 v5, 16, v5
  v_mul_i32_i24 v5, s91, v5
  v_lshl_add_u32 v4, v4, 4, v5
  v_add_u32 v239, s46, v4
  v_max_i32 v237, 0, v237
  v_max_i32 v238, 0, v238
  v_max_i32 v239, 0, v239
  v_lshrrev_b32 v197, 1, v2
  v_and_b32 v255, 1, v2
  v_add_u32 v197, s88, v197
  v_lshl_add_u32 v0, v255, 2, s44
  v_lshl_add_u32 v198, v197, 1, s61
  v_add_u32 v199, 112, v197
  v_lshlrev_b32 v255, 30, v255
  v_med3_i32 v197, v198, v197, v199
  v_mul_lo_u32 v197, v197, s89
  v_lshl_add_u32 v197, v3, 3, v197
  v_add_u32 v197, s62, v197
  v_lshl_add_u32 v198, v0, 1, 7
  v_add_u32 v199, 112, v0
  v_min_u32 v4, v198, v199
  v_mad_i32_i24 v4, v4, s50, v197
  v_lshl_add_u32 v198, v0, 1, 9
  v_add_u32 v199, 113, v0
  v_min_u32 v5, v198, v199
  v_mad_i32_i24 v5, v5, s50, v197
  v_lshl_add_u32 v198, v0, 1, 11
  v_add_u32 v199, 114, v0
  v_min_u32 v6, v198, v199
  v_mad_i32_i24 v6, v6, s50, v197
  v_add_u32 v6, v6, v255
  v_lshl_add_u32 v198, v0, 1, 13
  v_add_u32 v199, 115, v0
  v_min_u32 v7, v198, v199
  v_mad_i32_i24 v7, v7, s50, v197
  v_add_u32 v7, v7, v255
  v_lshl_add_u32 v198, v0, 1, 19
  v_add_u32 v199, 118, v0
  v_min_u32 v8, v198, v199
  v_mad_i32_i24 v8, v8, s50, v197
  v_lshl_add_u32 v198, v0, 1, 21
  v_add_u32 v199, 119, v0
  v_min_u32 v9, v198, v199
  v_mad_i32_i24 v9, v9, s50, v197
  v_lshl_add_u32 v198, v0, 1, 23
  v_add_u32 v199, 120, v0
  v_min_u32 v10, v198, v199
  v_mad_i32_i24 v10, v10, s50, v197
  v_lshl_add_u32 v198, v0, 1, 25
  v_add_u32 v199, 121, v0
  v_min_u32 v11, v198, v199
  v_mad_i32_i24 v11, v11, s50, v197
  v_bfe_i32 v66, v14, 0, 1
  v_and_b32 v65, s54, v66
  v_and_b32 v66, s54, v66
  v_or_b32 v64, v65, v12
  v_or_b32 v67, v65, v13
  v_bfe_i32 v70, v14, 2, 1
  v_and_b32 v69, s54, v70
  v_and_b32 v70, s54, v70
  v_or_b32 v68, v69, v12
  v_or_b32 v71, v69, v13
  v_bfe_i32 v74, v14, 4, 1
  v_and_b32 v73, s54, v74
  v_and_b32 v74, s54, v74
  v_or_b32 v72, v73, v12
  v_or_b32 v75, v73, v13
  v_bfe_i32 v78, v14, 6, 1
  v_and_b32 v77, s54, v78
  v_and_b32 v78, s54, v78
  v_or_b32 v76, v77, v12
  v_or_b32 v79, v77, v13
  v_bfe_i32 v82, v14, 8, 1
  v_and_b32 v81, s54, v82
  v_and_b32 v82, s54, v82
  v_or_b32 v80, v81, v12
  v_or_b32 v83, v81, v13
  v_bfe_i32 v86, v14, 10, 1
  v_and_b32 v85, s54, v86
  v_and_b32 v86, s54, v86
  v_or_b32 v84, v85, v12
  v_or_b32 v87, v85, v13
  v_bfe_i32 v90, v15, 6, 1
  v_and_b32 v89, s54, v90
  v_and_b32 v90, s54, v90
  v_or_b32 v88, v89, v12
  v_or_b32 v91, v89, v13
  v_bfe_i32 v94, v15, 8, 1
  v_and_b32 v93, s54, v94
  v_and_b32 v94, s54, v94
  v_or_b32 v92, v93, v12
  v_or_b32 v95, v93, v13
  v_bfe_i32 v98, v15, 10, 1
  v_and_b32 v97, s54, v98
  v_and_b32 v98, s54, v98
  v_or_b32 v96, v97, v12
  v_or_b32 v99, v97, v13
  v_bfe_i32 v102, v15, 12, 1
  v_and_b32 v101, s54, v102
  v_and_b32 v102, s54, v102
  v_or_b32 v100, v101, v12
  v_or_b32 v103, v101, v13
  v_bfe_i32 v106, v15, 14, 1
  v_and_b32 v105, s54, v106
  v_and_b32 v106, s54, v106
  v_or_b32 v104, v105, v12
  v_or_b32 v107, v105, v13
  v_bfe_i32 v110, v15, 16, 1
  v_and_b32 v109, s54, v110
  v_and_b32 v110, s54, v110
  v_or_b32 v108, v109, v12
  v_or_b32 v111, v109, v13
  v_bfe_i32 v114, v15, 18, 1
  v_and_b32 v113, s54, v114
  v_and_b32 v114, s54, v114
  v_or_b32 v112, v113, v12
  v_or_b32 v115, v113, v13
  v_and_b32 v170, 6, v3
  v_xor_b32 v170, v170, v2
  v_lshlrev_b32 v174, 7, v3
  v_xor_b32 v171, 4, v170
  v_lshl_add_u32 v170, v170, 4, v174
  v_lshl_add_u32 v171, v171, 4, v174
  v_add_u32 v172, s87, v170
  v_add_u32 v170, s86, v170
  v_add_u32 v173, s87, v171
  v_add_u32 v171, s86, v171
  s_cmp_ge_u32 s2, 36
  s_cbranch_scc1 M_x2
  s_barrier
  s_add_u32 m0, s86, 4480
  s_nop 0
  buffer_load_dwordx4 v168, s[16:19], s84 offen offset:128 lds
  s_add_u32 m0, s86, 5504
  s_nop 0
  buffer_load_dwordx4 v168, s[16:19], s85 offen offset:128 lds
  s_add_u32 m0, s86, 6528
  s_nop 0
  buffer_load_dwordx4 v169, s[16:19], s84 offen offset:128 lds
  s_add_u32 m0, s86, 7552
  s_nop 0
  buffer_load_dwordx4 v169, s[16:19], s85 offen offset:128 lds
  s_barrier
  s_add_u32 m0, s87, 61184
  s_nop 0
  buffer_load_dwordx4 v168, s[16:19], s84 offen offset:256 lds
  s_add_u32 m0, s87, 62208
  s_nop 0
  buffer_load_dwordx4 v168, s[16:19], s85 offen offset:256 lds
  s_add_u32 m0, s87, 63232
  s_nop 0
  buffer_load_dwordx4 v169, s[16:19], s84 offen offset:256 lds
  s_add_u32 m0, s87, 64256
  s_nop 0
  buffer_load_dwordx4 v169, s[16:19], s85 offen offset:256 lds
M_x2:
  s_waitcnt vmcnt(8)
  ds_read_b128 v[16:19], v170 offset:512
  ds_read_b128 v[20:23], v171 offset:512
  ds_read_b128 v[40:43], v170 offset:2560
  ds_read_b128 v[44:47], v171 offset:2560
  s_waitcnt vmcnt(4)
  ds_read_b128 v[24:27], v170 offset:4608
  ds_read_b128 v[28:31], v171 offset:4608
  ds_read_b128 v[48:51], v170 offset:6656
  ds_read_b128 v[52:55], v171 offset:6656
  s_waitcnt vmcnt(0)
  ds_read_b128 v[32:35], v172 offset:61440
  ds_read_b128 v[36:39], v173 offset:61440
  ds_read_b128 v[56:59], v172 offset:63488
  ds_read_b128 v[60:63], v173 offset:63488
  s_add_i32 s57, s45, s40
  s_lshl_b32 s57, s57, 1
  s_add_i32 s57, s57, s41
  s_max_i32 s57, s57, 0
  s_min_i32 s57, s57, 223
  s_mul_i32 s57, s57, 86016
  s_waitcnt lgkmcnt(0)
  s_barrier
  s_cmp_lt_u32 s40, 1
  s_cbranch_scc1 M_er
  s_add_u32 m0, s101, -61440
  s_nop 0
  buffer_load_dwordx4 v232, s[16:19], s57 offen lds
  s_add_u32 m0, s101, -60416
  s_nop 0
  buffer_load_dwordx4 v233, s[16:19], s57 offen lds
  s_add_u32 m0, s101, -59392
  s_nop 0
  buffer_load_dwordx4 v234, s[16:19], s57 offen lds
  s_add_u32 m0, s101, -58368
  s_nop 0
  buffer_load_dwordx4 v235, s[16:19], s57 offen lds
  s_add_u32 m0, s101, -57344
  s_nop 0
  buffer_load_dwordx4 v236, s[16:19], s57 offen lds
  s_add_u32 m0, s101, -56320
  s_nop 0
  buffer_load_dwordx4 v237, s[16:19], s57 offen lds
  s_add_u32 m0, s101, -55296
  s_nop 0
  buffer_load_dwordx4 v238, s[16:19], s57 offen lds
  s_add_u32 m0, s101, -54784
  s_nop 0
  buffer_load_dwordx4 v239, s[16:19], s57 offen lds
M_er:
  s_barrier
  s_cmp_lt_u32 s40, 4
  s_cbranch_scc1 M_xl
  s_setprio 1
  s_barrier
  s_branch M_pa
M_xl:
  s_lshl_b32 s55, s40, 10
  s_add_u32 s55, s55, 131072
  s_sub_u32 m0, s55, 40960
  s_nop 0
  buffer_load_dwordx4 v252, s[24:27], s55 offen sc1 lds
  s_add_u32 s55, s55, 4096
  s_sub_u32 m0, s55, 40960
  s_nop 0
  buffer_load_dwordx4 v252, s[24:27], s55 offen sc1 lds
  s_add_u32 s55, s55, 4096
  s_sub_u32 m0, s55, 40960
  s_nop 0
  buffer_load_dwordx4 v252, s[24:27], s55 offen sc1 lds
  s_add_u32 s55, s55, 4096
  s_sub_u32 m0, s55, 40960
  s_nop 0
  buffer_load_dwordx4 v252, s[24:27], s55 offen sc1 lds
  s_add_u32 s55, s55, 4096
  s_sub_u32 m0, s55, 40960
  s_nop 0
  buffer_load_dwordx4 v252, s[24:27], s55 offen sc1 lds
  s_add_u32 s55, s55, 4096
  s_sub_u32 m0, s55, 40960
  s_nop 0
  buffer_load_dwordx4 v252, s[24:27], s55 offen sc1 lds
  s_add_u32 s55, s55, 4096
  s_sub_u32 m0, s55, 40960
  s_nop 0
  buffer_load_dwordx4 v252, s[24:27], s55 offen sc1 lds
  s_add_u32 s55, s55, 4096
  s_sub_u32 m0, s55, 40960
  s_nop 0
  buffer_load_dwordx4 v252, s[24:27], s55 offen sc1 lds
  s_add_u32 s55, s55, 4096
  s_sub_u32 m0, s55, 40960
  s_nop 0
  buffer_load_dwordx4 v252, s[24:27], s55 offen sc1 lds
  s_add_u32 s55, s55, 4096
  s_sub_u32 m0, s55, 40960
  s_nop 0
  buffer_load_dwordx4 v252, s[24:27], s55 offen sc1 lds
  s_add_u32 s55, s55, 4096
  s_sub_u32 m0, s55, 40960
  s_nop 0
  buffer_load_dwordx4 v252, s[24:27], s55 offen sc1 lds
  s_add_u32 s55, s55, 4096
  s_sub_u32 m0, s55, 40960
  s_nop 0
  buffer_load_dwordx4 v252, s[24:27], s55 offen sc1 lds
  s_waitcnt vmcnt(6)
  s_barrier
  s_lshl_b32 s55, s40, 10
  s_add_u32 s55, s55, 180224
  s_sub_u32 m0, s55, 40960
  s_nop 0
  buffer_load_dwordx4 v252, s[24:27], s55 offen sc1 lds
  s_add_u32 s55, s55, 4096
  s_sub_u32 m0, s55, 40960
  s_nop 0
  buffer_load_dwordx4 v252, s[24:27], s55 offen sc1 lds
  s_add_u32 s55, s55, 4096
  s_sub_u32 m0, s55, 40960
  s_nop 0
  buffer_load_dwordx4 v252, s[24:27], s55 offen sc1 lds
  s_add_u32 s55, s55, 4096
  s_sub_u32 m0, s55, 40960
  s_nop 0
  buffer_load_dwordx4 v252, s[24:27], s55 offen sc1 lds
  s_add_u32 s55, s55, 4096
  s_sub_u32 m0, s55, 40960
  s_nop 0
  buffer_load_dwordx4 v252, s[24:27], s55 offen sc1 lds
  s_add_u32 s55, s55, 4096
  s_sub_u32 m0, s55, 40960
  s_nop 0
  buffer_load_dwordx4 v252, s[24:27], s55 offen sc1 lds
M_pa:
  ds_read_b128 v[200:203], v254 offset:0
  ds_read_b128 v[204:207], v254 offset:1024
  ds_read_b128 v[208:211], v254 offset:2048
  ds_read_b128 v[212:215], v254 offset:3072
  ds_read_b128 v[216:219], v254 offset:4096
  ds_read_b128 v[220:223], v254 offset:5120
  s_waitcnt lgkmcnt(5)
  v_mfma_f32_16x16x32_bf16 v[168:171], v[200:203], v[16:19], 0
  ds_read_b128 v[224:227], v254 offset:6144
  v_mfma_f32_16x16x32_bf16 v[176:179], v[200:203], v[40:43], 0
  s_waitcnt lgkmcnt(5)
  v_mfma_f32_16x16x32_bf16 v[172:175], v[204:207], v[16:19], 0
  ds_read_b128 v[228:231], v254 offset:7168
  v_mfma_f32_16x16x32_bf16 v[180:183], v[204:207], v[40:43], 0
  s_waitcnt lgkmcnt(5)
  v_mfma_f32_16x16x32_bf16 v[168:171], v[208:211], v[20:23], v[168:171]
  ds_read_b128 v[200:203], v254 offset:8192
  v_mfma_f32_16x16x32_bf16 v[176:179], v[208:211], v[44:47], v[176:179]
  s_waitcnt lgkmcnt(5)
  v_mfma_f32_16x16x32_bf16 v[172:175], v[212:215], v[20:23], v[172:175]
  ds_read_b128 v[204:207], v254 offset:9216
  v_mfma_f32_16x16x32_bf16 v[180:183], v[212:215], v[44:47], v[180:183]
  s_waitcnt lgkmcnt(5)
  v_mfma_f32_16x16x32_bf16 v[168:171], v[216:219], v[24:27], v[168:171]
  ds_read_b128 v[208:211], v254 offset:10240
  v_mfma_f32_16x16x32_bf16 v[176:179], v[216:219], v[48:51], v[176:179]
  s_waitcnt lgkmcnt(5)
  v_mfma_f32_16x16x32_bf16 v[172:175], v[220:223], v[24:27], v[172:175]
  ds_read_b128 v[212:215], v254 offset:11264
  v_mfma_f32_16x16x32_bf16 v[180:183], v[220:223], v[48:51], v[180:183]
  s_waitcnt lgkmcnt(5)
  v_mfma_f32_16x16x32_bf16 v[168:171], v[224:227], v[28:31], v[168:171]
  ds_read_b128 v[216:219], v254 offset:12288
  v_mfma_f32_16x16x32_bf16 v[176:179], v[224:227], v[52:55], v[176:179]
  s_waitcnt lgkmcnt(5)
  v_mfma_f32_16x16x32_bf16 v[172:175], v[228:231], v[28:31], v[172:175]
  ds_read_b128 v[220:223], v254 offset:13312
  v_mfma_f32_16x16x32_bf16 v[180:183], v[228:231], v[52:55], v[180:183]
  s_waitcnt lgkmcnt(5)
  v_mfma_f32_16x16x32_bf16 v[168:171], v[200:203], v[32:35], v[168:171]
  ds_read_b128 v[224:227], v254 offset:14336
  v_mfma_f32_16x16x32_bf16 v[176:179], v[200:203], v[56:59], v[176:179]
  s_waitcnt lgkmcnt(5)
  v_mfma_f32_16x16x32_bf16 v[172:175], v[204:207], v[32:35], v[172:175]
  ds_read_b128 v[228:231], v254 offset:15360
  v_mfma_f32_16x16x32_bf16 v[180:183], v[204:207], v[56:59], v[180:183]
  s_waitcnt lgkmcnt(5)
  v_mfma_f32_16x16x32_bf16 v[168:171], v[208:211], v[36:39], v[168:171]
  ds_read_b128 v[200:203], v254 offset:16384
  v_mfma_f32_16x16x32_bf16 v[176:179], v[208:211], v[60:63], v[176:179]
  s_waitcnt lgkmcnt(5)
  v_mfma_f32_16x16x32_bf16 v[172:175], v[212:215], v[36:39], v[172:175]
  ds_read_b128 v[204:207], v254 offset:17408
  v_mfma_f32_16x16x32_bf16 v[180:183], v[212:215], v[60:63], v[180:183]
  s_waitcnt lgkmcnt(5)
  v_mfma_f32_16x16x32_bf16 v[184:187], v[216:219], v[16:19], 0
  ds_read_b128 v[208:211], v254 offset:18432
  v_mfma_f32_16x16x32_bf16 v[192:195], v[216:219], v[40:43], 0
  s_waitcnt lgkmcnt(5)
  v_mfma_f32_16x16x32_bf16 v[188:191], v[220:223], v[16:19], 0
  ds_read_b128 v[212:215], v254 offset:19456
  v_cvt_pk_bf16_f32 v120, v168, v169
  v_mfma_f32_16x16x32_bf16 v[196:199], v[220:223], v[40:43], 0
  s_waitcnt lgkmcnt(5)
  v_cvt_pk_bf16_f32 v121, v170, v171
  v_cvt_pk_bf16_f32 v122, v172, v173
  v_mfma_f32_16x16x32_bf16 v[184:187], v[224:227], v[20:23], v[184:187]
  ds_read_b128 v[216:219], v254 offset:20480
  v_cvt_pk_bf16_f32 v123, v174, v175
  v_mfma_f32_16x16x32_bf16 v[192:195], v[224:227], v[44:47], v[192:195]
  s_waitcnt lgkmcnt(5)
  v_cvt_pk_bf16_f32 v144, v176, v177
  v_cvt_pk_bf16_f32 v145, v178, v179
  v_mfma_f32_16x16x32_bf16 v[188:191], v[228:231], v[20:23], v[188:191]
  ds_read_b128 v[220:223], v254 offset:21504
  v_cvt_pk_bf16_f32 v146, v180, v181
  v_mfma_f32_16x16x32_bf16 v[196:199], v[228:231], v[44:47], v[196:199]
  s_waitcnt lgkmcnt(5)
  v_cvt_pk_bf16_f32 v147, v182, v183
  v_mfma_f32_16x16x32_bf16 v[184:187], v[200:203], v[24:27], v[184:187]
  ds_read_b128 v[224:227], v254 offset:22528
  v_mfma_f32_16x16x32_bf16 v[192:195], v[200:203], v[48:51], v[192:195]
  s_waitcnt lgkmcnt(5)
  v_mfma_f32_16x16x32_bf16 v[188:191], v[204:207], v[24:27], v[188:191]
  ds_read_b128 v[228:231], v254 offset:23552
  v_mfma_f32_16x16x32_bf16 v[196:199], v[204:207], v[48:51], v[196:199]
  s_waitcnt vmcnt(0)
  s_barrier
  s_waitcnt lgkmcnt(5)
  v_mfma_f32_16x16x32_bf16 v[184:187], v[208:211], v[28:31], v[184:187]
  ds_read_b128 v[200:203], v254 offset:24576
  v_mfma_f32_16x16x32_bf16 v[192:195], v[208:211], v[52:55], v[192:195]
  s_waitcnt lgkmcnt(5)
  v_mfma_f32_16x16x32_bf16 v[188:191], v[212:215], v[28:31], v[188:191]
  ds_read_b128 v[204:207], v254 offset:25600
  v_mfma_f32_16x16x32_bf16 v[196:199], v[212:215], v[52:55], v[196:199]
  s_waitcnt lgkmcnt(5)
  v_mfma_f32_16x16x32_bf16 v[184:187], v[216:219], v[32:35], v[184:187]
  ds_read_b128 v[208:211], v254 offset:26624
  v_mfma_f32_16x16x32_bf16 v[192:195], v[216:219], v[56:59], v[192:195]
  s_waitcnt lgkmcnt(5)
  v_mfma_f32_16x16x32_bf16 v[188:191], v[220:223], v[32:35], v[188:191]
  ds_read_b128 v[212:215], v254 offset:27648
  v_mfma_f32_16x16x32_bf16 v[196:199], v[220:223], v[56:59], v[196:199]
  s_waitcnt lgkmcnt(5)
  v_mfma_f32_16x16x32_bf16 v[184:187], v[224:227], v[36:39], v[184:187]
  ds_read_b128 v[216:219], v254 offset:28672
  v_mfma_f32_16x16x32_bf16 v[192:195], v[224:227], v[60:63], v[192:195]
  s_waitcnt lgkmcnt(5)
  v_mfma_f32_16x16x32_bf16 v[188:191], v[228:231], v[36:39], v[188:191]
  ds_read_b128 v[220:223], v254 offset:29696
  v_mfma_f32_16x16x32_bf16 v[196:199], v[228:231], v[60:63], v[196:199]
  s_waitcnt lgkmcnt(5)
  v_mfma_f32_16x16x32_bf16 v[168:171], v[200:203], v[16:19], 0
  ds_read_b128 v[224:227], v254 offset:30720
  v_mfma_f32_16x16x32_bf16 v[176:179], v[200:203], v[40:43], 0
  s_waitcnt lgkmcnt(5)
  v_mfma_f32_16x16x32_bf16 v[172:175], v[204:207], v[16:19], 0
  ds_read_b128 v[228:231], v254 offset:31744
  v_cvt_pk_bf16_f32 v124, v184, v185
  v_mfma_f32_16x16x32_bf16 v[180:183], v[204:207], v[40:43], 0
  s_waitcnt lgkmcnt(5)
  v_cvt_pk_bf16_f32 v125, v186, v187
  v_cvt_pk_bf16_f32 v126, v188, v189
  v_mfma_f32_16x16x32_bf16 v[168:171], v[208:211], v[20:23], v[168:171]
  ds_read_b128 v[200:203], v254 offset:32768
  v_cvt_pk_bf16_f32 v127, v190, v191
  v_mfma_f32_16x16x32_bf16 v[176:179], v[208:211], v[44:47], v[176:179]
  s_waitcnt lgkmcnt(5)
  v_cvt_pk_bf16_f32 v148, v192, v193
  v_cvt_pk_bf16_f32 v149, v194, v195
  v_mfma_f32_16x16x32_bf16 v[172:175], v[212:215], v[20:23], v[172:175]
  ds_read_b128 v[204:207], v254 offset:33792
  v_cvt_pk_bf16_f32 v150, v196, v197
  v_mfma_f32_16x16x32_bf16 v[180:183], v[212:215], v[44:47], v[180:183]
  s_waitcnt lgkmcnt(5)
  v_cvt_pk_bf16_f32 v151, v198, v199
  v_mfma_f32_16x16x32_bf16 v[168:171], v[216:219], v[24:27], v[168:171]
  ds_read_b128 v[208:211], v254 offset:34816
  v_mfma_f32_16x16x32_bf16 v[176:179], v[216:219], v[48:51], v[176:179]
  s_waitcnt lgkmcnt(5)
  v_mfma_f32_16x16x32_bf16 v[172:175], v[220:223], v[24:27], v[172:175]
  ds_read_b128 v[212:215], v254 offset:35840
  v_mfma_f32_16x16x32_bf16 v[180:183], v[220:223], v[48:51], v[180:183]
  s_waitcnt lgkmcnt(5)
  v_mfma_f32_16x16x32_bf16 v[168:171], v[224:227], v[28:31], v[168:171]
  ds_read_b128 v[216:219], v254 offset:36864
  v_mfma_f32_16x16x32_bf16 v[176:179], v[224:227], v[52:55], v[176:179]
  s_waitcnt lgkmcnt(5)
  v_mfma_f32_16x16x32_bf16 v[172:175], v[228:231], v[28:31], v[172:175]
  ds_read_b128 v[220:223], v254 offset:37888
  v_mfma_f32_16x16x32_bf16 v[180:183], v[228:231], v[52:55], v[180:183]
  s_waitcnt lgkmcnt(5)
  v_mfma_f32_16x16x32_bf16 v[168:171], v[200:203], v[32:35], v[168:171]
  ds_read_b128 v[224:227], v254 offset:38912
  v_mfma_f32_16x16x32_bf16 v[176:179], v[200:203], v[56:59], v[176:179]
  s_waitcnt lgkmcnt(5)
  v_mfma_f32_16x16x32_bf16 v[172:175], v[204:207], v[32:35], v[172:175]
  ds_read_b128 v[228:231], v254 offset:39936
  v_mfma_f32_16x16x32_bf16 v[180:183], v[204:207], v[56:59], v[180:183]
  s_waitcnt lgkmcnt(5)
  v_mfma_f32_16x16x32_bf16 v[168:171], v[208:211], v[36:39], v[168:171]
  ds_read_b128 v[200:203], v254 offset:40960
  v_mfma_f32_16x16x32_bf16 v[176:179], v[208:211], v[60:63], v[176:179]
  s_waitcnt lgkmcnt(5)
  v_mfma_f32_16x16x32_bf16 v[172:175], v[212:215], v[36:39], v[172:175]
  ds_read_b128 v[204:207], v254 offset:41984
  v_mfma_f32_16x16x32_bf16 v[180:183], v[212:215], v[60:63], v[180:183]
  s_barrier
  s_waitcnt lgkmcnt(5)
  v_mfma_f32_16x16x32_bf16 v[184:187], v[216:219], v[16:19], 0
  ds_read_b128 v[208:211], v254 offset:43008
  v_mfma_f32_16x16x32_bf16 v[192:195], v[216:219], v[40:43], 0
  s_waitcnt lgkmcnt(5)
  v_mfma_f32_16x16x32_bf16 v[188:191], v[220:223], v[16:19], 0
  ds_read_b128 v[212:215], v254 offset:44032
  v_cvt_pk_bf16_f32 v128, v168, v169
  v_mfma_f32_16x16x32_bf16 v[196:199], v[220:223], v[40:43], 0
  s_waitcnt lgkmcnt(5)
  v_cvt_pk_bf16_f32 v129, v170, v171
  v_cvt_pk_bf16_f32 v130, v172, v173
  v_mfma_f32_16x16x32_bf16 v[184:187], v[224:227], v[20:23], v[184:187]
  ds_read_b128 v[216:219], v254 offset:45056
  v_cvt_pk_bf16_f32 v131, v174, v175
  v_mfma_f32_16x16x32_bf16 v[192:195], v[224:227], v[44:47], v[192:195]
  s_waitcnt lgkmcnt(5)
  v_cvt_pk_bf16_f32 v152, v176, v177
  v_cvt_pk_bf16_f32 v153, v178, v179
  v_mfma_f32_16x16x32_bf16 v[188:191], v[228:231], v[20:23], v[188:191]
  ds_read_b128 v[220:223], v254 offset:46080
  v_cvt_pk_bf16_f32 v154, v180, v181
  v_mfma_f32_16x16x32_bf16 v[196:199], v[228:231], v[44:47], v[196:199]
  s_waitcnt lgkmcnt(5)
  v_cvt_pk_bf16_f32 v155, v182, v183
  v_mfma_f32_16x16x32_bf16 v[184:187], v[200:203], v[24:27], v[184:187]
  ds_read_b128 v[224:227], v254 offset:47104
  v_mfma_f32_16x16x32_bf16 v[192:195], v[200:203], v[48:51], v[192:195]
  s_waitcnt lgkmcnt(5)
  v_mfma_f32_16x16x32_bf16 v[188:191], v[204:207], v[24:27], v[188:191]
  ds_read_b128 v[228:231], v254 offset:48128
  v_mfma_f32_16x16x32_bf16 v[196:199], v[204:207], v[48:51], v[196:199]
  s_waitcnt lgkmcnt(5)
  v_mfma_f32_16x16x32_bf16 v[184:187], v[208:211], v[28:31], v[184:187]
  ds_read_b128 v[200:203], v254 offset:49152
  v_mfma_f32_16x16x32_bf16 v[192:195], v[208:211], v[52:55], v[192:195]
  s_waitcnt lgkmcnt(5)
  v_mfma_f32_16x16x32_bf16 v[188:191], v[212:215], v[28:31], v[188:191]
  ds_read_b128 v[204:207], v254 offset:50176
  v_mfma_f32_16x16x32_bf16 v[196:199], v[212:215], v[52:55], v[196:199]
  s_waitcnt lgkmcnt(5)
  v_mfma_f32_16x16x32_bf16 v[184:187], v[216:219], v[32:35], v[184:187]
  ds_read_b128 v[208:211], v254 offset:51200
  v_mfma_f32_16x16x32_bf16 v[192:195], v[216:219], v[56:59], v[192:195]
  s_waitcnt lgkmcnt(5)
  v_mfma_f32_16x16x32_bf16 v[188:191], v[220:223], v[32:35], v[188:191]
  ds_read_b128 v[212:215], v254 offset:52224
  v_mfma_f32_16x16x32_bf16 v[196:199], v[220:223], v[56:59], v[196:199]
  s_waitcnt lgkmcnt(5)
  v_mfma_f32_16x16x32_bf16 v[184:187], v[224:227], v[36:39], v[184:187]
  ds_read_b128 v[216:219], v254 offset:53248
  v_mfma_f32_16x16x32_bf16 v[192:195], v[224:227], v[60:63], v[192:195]
  s_waitcnt lgkmcnt(5)
  v_mfma_f32_16x16x32_bf16 v[188:191], v[228:231], v[36:39], v[188:191]
  ds_read_b128 v[220:223], v254 offset:54272
  v_mfma_f32_16x16x32_bf16 v[196:199], v[228:231], v[60:63], v[196:199]
  s_waitcnt lgkmcnt(5)
  v_mfma_f32_16x16x32_bf16 v[168:171], v[200:203], v[16:19], 0
  ds_read_b128 v[224:227], v254 offset:55296
  v_mfma_f32_16x16x32_bf16 v[176:179], v[200:203], v[40:43], 0
  s_waitcnt lgkmcnt(5)
  ds_read_b128 v[232:235], v254 offset:61440
  v_mfma_f32_16x16x32_bf16 v[172:175], v[204:207], v[16:19], 0
  ds_read_b128 v[228:231], v254 offset:56320
  v_cvt_pk_bf16_f32 v132, v184, v185
  v_mfma_f32_16x16x32_bf16 v[180:183], v[204:207], v[40:43], 0
  s_waitcnt lgkmcnt(6)
  ds_read_b128 v[236:239], v254 offset:62464
  v_cvt_pk_bf16_f32 v133, v186, v187
  v_mfma_f32_16x16x32_bf16 v[168:171], v[208:211], v[20:23], v[168:171]
  ds_read_b128 v[200:203], v254 offset:57344
  v_cvt_pk_bf16_f32 v134, v188, v189
  v_mfma_f32_16x16x32_bf16 v[176:179], v[208:211], v[44:47], v[176:179]
  s_waitcnt lgkmcnt(7)
  v_cvt_pk_bf16_f32 v135, v190, v191
  v_cvt_pk_bf16_f32 v156, v192, v193
  v_mfma_f32_16x16x32_bf16 v[172:175], v[212:215], v[20:23], v[172:175]
  ds_read_b128 v[204:207], v254 offset:58368
  v_cvt_pk_bf16_f32 v157, v194, v195
  v_mfma_f32_16x16x32_bf16 v[180:183], v[212:215], v[44:47], v[180:183]
  s_waitcnt lgkmcnt(7)
  v_cvt_pk_bf16_f32 v158, v196, v197
  v_cvt_pk_bf16_f32 v159, v198, v199
  v_mfma_f32_16x16x32_bf16 v[168:171], v[216:219], v[24:27], v[168:171]
  ds_read_b128 v[208:211], v254 offset:59392
  v_mfma_f32_16x16x32_bf16 v[176:179], v[216:219], v[48:51], v[176:179]
  s_waitcnt lgkmcnt(7)
  v_mfma_f32_16x16x32_bf16 v[172:175], v[220:223], v[24:27], v[172:175]
  ds_read_b128 v[212:215], v254 offset:60416
  v_mfma_f32_16x16x32_bf16 v[180:183], v[220:223], v[48:51], v[180:183]
  s_waitcnt lgkmcnt(7)
  v_mfma_f32_16x16x32_bf16 v[168:171], v[224:227], v[28:31], v[168:171]
  v_mfma_f32_16x16x32_bf16 v[176:179], v[224:227], v[52:55], v[176:179]
  s_waitcnt lgkmcnt(5)
  v_mfma_f32_16x16x32_bf16 v[172:175], v[228:231], v[28:31], v[172:175]
  v_mfma_f32_16x16x32_bf16 v[180:183], v[228:231], v[52:55], v[180:183]
  s_waitcnt lgkmcnt(3)
  v_mfma_f32_16x16x32_bf16 v[168:171], v[200:203], v[32:35], v[168:171]
  ds_read_b128 v[224:227], v253 offset:0
  v_mfma_f32_16x16x32_bf16 v[176:179], v[200:203], v[56:59], v[176:179]
  s_waitcnt lgkmcnt(3)
  v_mfma_f32_16x16x32_bf16 v[172:175], v[204:207], v[32:35], v[172:175]
  ds_read_b128 v[228:231], v253 offset:1024
  v_mfma_f32_16x16x32_bf16 v[180:183], v[204:207], v[56:59], v[180:183]
  s_waitcnt lgkmcnt(3)
  v_mfma_f32_16x16x32_bf16 v[168:171], v[208:211], v[36:39], v[168:171]
  ds_read_b128 v[200:203], v253 offset:2048
  v_mfma_f32_16x16x32_bf16 v[176:179], v[208:211], v[60:63], v[176:179]
  s_waitcnt lgkmcnt(3)
  v_mfma_f32_16x16x32_bf16 v[172:175], v[212:215], v[36:39], v[172:175]
  ds_read_b128 v[204:207], v253 offset:3072
  v_mfma_f32_16x16x32_bf16 v[180:183], v[212:215], v[60:63], v[180:183]
  s_waitcnt vmcnt(0)
  s_barrier
  s_setprio 2
  s_cmp_lt_u32 s40, 4
  s_cbranch_scc1 M_pr1
  s_setprio 3
M_pr1:
  v_mfma_f32_16x16x32_bf16 v[184:187], v[232:235], v[16:19], 0
  ds_read_b128 v[208:211], v253 offset:4096
  v_mfma_f32_16x16x32_bf16 v[192:195], v[232:235], v[40:43], 0
  v_mfma_f32_16x16x32_bf16 v[188:191], v[236:239], v[16:19], 0
  ds_read_b128 v[212:215], v253 offset:5120
  v_cvt_pk_bf16_f32 v136, v168, v169
  v_mfma_f32_16x16x32_bf16 v[196:199], v[236:239], v[40:43], 0
  s_waitcnt lgkmcnt(5)
  v_cvt_pk_bf16_f32 v137, v170, v171
  v_cvt_pk_bf16_f32 v138, v172, v173
  v_mfma_f32_16x16x32_bf16 v[184:187], v[224:227], v[20:23], v[184:187]
  ds_read_b128 v[216:219], v253 offset:6144
  v_cvt_pk_bf16_f32 v139, v174, v175
  v_mfma_f32_16x16x32_bf16 v[192:195], v[224:227], v[44:47], v[192:195]
  s_waitcnt lgkmcnt(5)
  v_cvt_pk_bf16_f32 v160, v176, v177
  v_cvt_pk_bf16_f32 v161, v178, v179
  v_mfma_f32_16x16x32_bf16 v[188:191], v[228:231], v[20:23], v[188:191]
  ds_read_b128 v[220:223], v253 offset:7168
  v_cvt_pk_bf16_f32 v162, v180, v181
  v_mfma_f32_16x16x32_bf16 v[196:199], v[228:231], v[44:47], v[196:199]
  s_waitcnt lgkmcnt(5)
  v_cvt_pk_bf16_f32 v163, v182, v183
  v_mfma_f32_16x16x32_bf16 v[184:187], v[200:203], v[24:27], v[184:187]
  ds_read_b128 v[224:227], v253 offset:8192
  v_mfma_f32_16x16x32_bf16 v[192:195], v[200:203], v[48:51], v[192:195]
  s_waitcnt lgkmcnt(5)
  v_mfma_f32_16x16x32_bf16 v[188:191], v[204:207], v[24:27], v[188:191]
  ds_read_b128 v[228:231], v253 offset:9216
  v_mfma_f32_16x16x32_bf16 v[196:199], v[204:207], v[48:51], v[196:199]
  s_cmp_ge_u32 s40, 4
  s_cbranch_scc1 M_l1
  s_waitcnt lgkmcnt(0)
  s_barrier
M_l1:
  s_waitcnt lgkmcnt(5)
  v_mfma_f32_16x16x32_bf16 v[184:187], v[208:211], v[28:31], v[184:187]
  ds_read_b128 v[200:203], v240 offset:0
  v_mfma_f32_16x16x32_bf16 v[192:195], v[208:211], v[52:55], v[192:195]
  s_waitcnt lgkmcnt(5)
  v_mfma_f32_16x16x32_bf16 v[188:191], v[212:215], v[28:31], v[188:191]
  ds_read_b128 v[204:207], v240 offset:2304
  v_mfma_f32_16x16x32_bf16 v[196:199], v[212:215], v[52:55], v[196:199]
  s_waitcnt lgkmcnt(5)
  v_mfma_f32_16x16x32_bf16 v[184:187], v[216:219], v[32:35], v[184:187]
  ds_read_b128 v[208:211], v241 offset:0
  v_mfma_f32_16x16x32_bf16 v[192:195], v[216:219], v[56:59], v[192:195]
  s_waitcnt lgkmcnt(5)
  v_mfma_f32_16x16x32_bf16 v[188:191], v[220:223], v[32:35], v[188:191]
  ds_read_b128 v[212:215], v241 offset:2304
  v_mfma_f32_16x16x32_bf16 v[196:199], v[220:223], v[56:59], v[196:199]
  s_waitcnt lgkmcnt(5)
  v_mfma_f32_16x16x32_bf16 v[184:187], v[224:227], v[36:39], v[184:187]
  ds_read_b128 v[216:219], v242 offset:0
  v_mfma_f32_16x16x32_bf16 v[192:195], v[224:227], v[60:63], v[192:195]
  s_waitcnt lgkmcnt(5)
  v_mfma_f32_16x16x32_bf16 v[188:191], v[228:231], v[36:39], v[188:191]
  ds_read_b128 v[220:223], v242 offset:2304
  v_mfma_f32_16x16x32_bf16 v[196:199], v[228:231], v[60:63], v[196:199]
  ds_read_b128 v[224:227], v243 offset:0
  s_mov_b32 s56, 0xff7fffff
  s_waitcnt lgkmcnt(6)
  v_mfma_f32_16x16x32_bf16 v[64:67], v[200:203], v[120:123], v[64:67]
  s_waitcnt lgkmcnt(5)
  ds_read_b128 v[228:231], v243 offset:2304
  v_mov_b32 v32, 0
  v_mfma_f32_16x16x32_bf16 v[76:79], v[204:207], v[120:123], v[76:79]
  v_mov_b32 v33, 0
  v_mov_b32 v48, 0x3f803f80
  v_mfma_f32_16x16x32_bf16 v[88:91], v[204:207], v[144:147], v[88:91]
  s_waitcnt lgkmcnt(5)
  ds_read_b128 v[200:203], v240 offset:256
  v_mov_b32 v49, 0x3f803f80
  v_mfma_f32_16x16x32_bf16 v[64:67], v[208:211], v[124:127], v[64:67]
  s_waitcnt lgkmcnt(5)
  ds_read_b128 v[204:207], v240 offset:2560
  v_cvt_pk_bf16_f32 v140, v184, v185
  v_mfma_f32_16x16x32_bf16 v[76:79], v[212:215], v[124:127], v[76:79]
  v_cvt_pk_bf16_f32 v141, v186, v187
  v_cvt_pk_bf16_f32 v142, v188, v189
  v_mfma_f32_16x16x32_bf16 v[88:91], v[212:215], v[148:151], v[88:91]
  s_waitcnt lgkmcnt(5)
  ds_read_b128 v[208:211], v241 offset:256
  v_cvt_pk_bf16_f32 v143, v190, v191
  v_mfma_f32_16x16x32_bf16 v[64:67], v[216:219], v[128:131], v[64:67]
  s_waitcnt lgkmcnt(5)
  ds_read_b128 v[212:215], v241 offset:2560
  v_cvt_pk_bf16_f32 v164, v192, v193
  v_mfma_f32_16x16x32_bf16 v[76:79], v[220:223], v[128:131], v[76:79]
  v_cvt_pk_bf16_f32 v165, v194, v195
  v_cvt_pk_bf16_f32 v166, v196, v197
  v_mfma_f32_16x16x32_bf16 v[88:91], v[220:223], v[152:155], v[88:91]
  s_waitcnt lgkmcnt(5)
  ds_read_b128 v[216:219], v240 offset:768
  v_cvt_pk_bf16_f32 v167, v198, v199
  v_mfma_f32_16x16x32_bf16 v[64:67], v[224:227], v[132:135], v[64:67]
  s_waitcnt lgkmcnt(5)
  ds_read_b128 v[220:223], v240 offset:3072
  v_mov_b32 v50, 0x3f803f80
  v_mfma_f32_16x16x32_bf16 v[76:79], v[228:231], v[132:135], v[76:79]
  v_mov_b32 v51, 0x3f803f80
  v_mfma_f32_16x16x32_bf16 v[88:91], v[228:231], v[156:159], v[88:91]
  s_waitcnt lgkmcnt(5)
  ds_read_b128 v[224:227], v241 offset:768
  v_mfma_f32_16x16x32_bf16 v[64:67], v[200:203], v[136:139], v[64:67]
  s_waitcnt lgkmcnt(5)
  ds_read_b128 v[228:231], v241 offset:3072
  v_mfma_f32_16x16x32_bf16 v[76:79], v[204:207], v[136:139], v[76:79]
  v_mfma_f32_16x16x32_bf16 v[88:91], v[204:207], v[160:163], v[88:91]
  s_waitcnt lgkmcnt(5)
  ds_read_b128 v[200:203], v242 offset:768
  v_mfma_f32_16x16x32_bf16 v[64:67], v[208:211], v[140:143], v[64:67]
  s_waitcnt lgkmcnt(5)
  ds_read_b128 v[204:207], v242 offset:3072
  v_mfma_f32_16x16x32_bf16 v[76:79], v[212:215], v[140:143], v[76:79]
  v_mfma_f32_16x16x32_bf16 v[88:91], v[212:215], v[164:167], v[88:91]
  s_waitcnt lgkmcnt(5)
  ds_read_b128 v[208:211], v243 offset:768
  v_mfma_f32_16x16x32_bf16 v[68:71], v[216:219], v[120:123], v[68:71]
  s_waitcnt lgkmcnt(5)
  ds_read_b128 v[212:215], v243 offset:3072
  v_mfma_f32_16x16x32_bf16 v[80:83], v[220:223], v[120:123], v[80:83]
  v_max3_f32 v12, v64, v65, s56
  v_max3_f32 v12, v66, v67, v12
  v_mfma_f32_16x16x32_bf16 v[92:95], v[220:223], v[144:147], v[92:95]
  s_waitcnt lgkmcnt(5)
  ds_read_b128 v[216:219], v240 offset:1024
  v_max3_f32 v12, v76, v77, v12
  v_mfma_f32_16x16x32_bf16 v[68:71], v[224:227], v[124:127], v[68:71]
  s_waitcnt lgkmcnt(5)
  ds_read_b128 v[220:223], v240 offset:3328
  v_max3_f32 v12, v78, v79, v12
  v_mfma_f32_16x16x32_bf16 v[80:83], v[228:231], v[124:127], v[80:83]
  v_max3_f32 v13, v88, v89, s56
  v_max3_f32 v13, v90, v91, v13
  v_mfma_f32_16x16x32_bf16 v[92:95], v[228:231], v[148:151], v[92:95]
  s_waitcnt lgkmcnt(5)
  ds_read_b128 v[224:227], v241 offset:1024
  v_mfma_f32_16x16x32_bf16 v[68:71], v[200:203], v[128:131], v[68:71]
  s_waitcnt lgkmcnt(5)
  ds_read_b128 v[228:231], v241 offset:3328
  v_mfma_f32_16x16x32_bf16 v[80:83], v[204:207], v[128:131], v[80:83]
  v_mfma_f32_16x16x32_bf16 v[92:95], v[204:207], v[152:155], v[92:95]
  s_waitcnt lgkmcnt(5)
  ds_read_b128 v[200:203], v240 offset:1536
  v_mfma_f32_16x16x32_bf16 v[68:71], v[208:211], v[132:135], v[68:71]
  s_waitcnt lgkmcnt(5)
  ds_read_b128 v[204:207], v240 offset:3840
  v_mfma_f32_16x16x32_bf16 v[80:83], v[212:215], v[132:135], v[80:83]
  v_mfma_f32_16x16x32_bf16 v[92:95], v[212:215], v[156:159], v[92:95]
  s_waitcnt lgkmcnt(5)
  ds_read_b128 v[208:211], v241 offset:1536
  v_mfma_f32_16x16x32_bf16 v[68:71], v[216:219], v[136:139], v[68:71]
  s_waitcnt lgkmcnt(5)
  ds_read_b128 v[212:215], v241 offset:3840
  v_mfma_f32_16x16x32_bf16 v[80:83], v[220:223], v[136:139], v[80:83]
  v_mfma_f32_16x16x32_bf16 v[92:95], v[220:223], v[160:163], v[92:95]
  s_waitcnt lgkmcnt(5)
  ds_read_b128 v[216:219], v242 offset:1536
  v_mfma_f32_16x16x32_bf16 v[68:71], v[224:227], v[140:143], v[68:71]
  s_waitcnt lgkmcnt(5)
  ds_read_b128 v[220:223], v242 offset:3840
  v_mfma_f32_16x16x32_bf16 v[80:83], v[228:231], v[140:143], v[80:83]
  v_mfma_f32_16x16x32_bf16 v[92:95], v[228:231], v[164:167], v[92:95]
  s_waitcnt lgkmcnt(5)
  ds_read_b128 v[224:227], v243 offset:1536
  v_mfma_f32_16x16x32_bf16 v[72:75], v[200:203], v[120:123], v[72:75]
  s_waitcnt lgkmcnt(5)
  ds_read_b128 v[228:231], v243 offset:3840
  v_mfma_f32_16x16x32_bf16 v[84:87], v[204:207], v[120:123], v[84:87]
  v_max3_f32 v12, v68, v69, v12
  v_max3_f32 v12, v70, v71, v12
  v_mfma_f32_16x16x32_bf16 v[96:99], v[204:207], v[144:147], v[96:99]
  s_waitcnt lgkmcnt(5)
  ds_read_b128 v[200:203], v240 offset:1792
  v_max3_f32 v12, v80, v81, v12
  v_mfma_f32_16x16x32_bf16 v[72:75], v[208:211], v[124:127], v[72:75]
  s_waitcnt lgkmcnt(5)
  ds_read_b128 v[204:207], v240 offset:4096
  v_max3_f32 v12, v82, v83, v12
  v_mfma_f32_16x16x32_bf16 v[84:87], v[212:215], v[124:127], v[84:87]
  v_max3_f32 v13, v92, v93, v13
  v_max3_f32 v13, v94, v95, v13
  v_mfma_f32_16x16x32_bf16 v[96:99], v[212:215], v[148:151], v[96:99]
  s_waitcnt lgkmcnt(5)
  ds_read_b128 v[208:211], v241 offset:1792
  v_mfma_f32_16x16x32_bf16 v[72:75], v[216:219], v[128:131], v[72:75]
  s_waitcnt lgkmcnt(5)
  ds_read_b128 v[212:215], v241 offset:4096
  v_mfma_f32_16x16x32_bf16 v[84:87], v[220:223], v[128:131], v[84:87]
  v_mfma_f32_16x16x32_bf16 v[96:99], v[220:223], v[152:155], v[96:99]
  s_waitcnt lgkmcnt(5)
  ds_read_b128 v[216:219], v240 offset:4608
  v_mfma_f32_16x16x32_bf16 v[72:75], v[224:227], v[132:135], v[72:75]
  s_waitcnt lgkmcnt(5)
  ds_read_b128 v[220:223], v240 offset:5376
  v_mfma_f32_16x16x32_bf16 v[84:87], v[228:231], v[132:135], v[84:87]
  v_mfma_f32_16x16x32_bf16 v[96:99], v[228:231], v[156:159], v[96:99]
  s_waitcnt lgkmcnt(5)
  ds_read_b128 v[224:227], v241 offset:4608
  v_mfma_f32_16x16x32_bf16 v[72:75], v[200:203], v[136:139], v[72:75]
  s_waitcnt lgkmcnt(5)
  ds_read_b128 v[228:231], v241 offset:5376
  v_mfma_f32_16x16x32_bf16 v[84:87], v[204:207], v[136:139], v[84:87]
  v_mfma_f32_16x16x32_bf16 v[96:99], v[204:207], v[160:163], v[96:99]
  s_waitcnt lgkmcnt(5)
  ds_read_b128 v[200:203], v242 offset:4608
  v_mfma_f32_16x16x32_bf16 v[72:75], v[208:211], v[140:143], v[72:75]
  s_waitcnt lgkmcnt(5)
  ds_read_b128 v[204:207], v242 offset:5376
  v_mfma_f32_16x16x32_bf16 v[84:87], v[212:215], v[140:143], v[84:87]
  v_mfma_f32_16x16x32_bf16 v[96:99], v[212:215], v[164:167], v[96:99]
  s_waitcnt lgkmcnt(5)
  ds_read_b128 v[208:211], v243 offset:4608
  v_mfma_f32_16x16x32_bf16 v[100:103], v[216:219], v[144:147], v[100:103]
  s_waitcnt lgkmcnt(5)
  ds_read_b128 v[212:215], v243 offset:5376
  v_mfma_f32_16x16x32_bf16 v[104:107], v[220:223], v[144:147], v[104:107]
  s_waitcnt lgkmcnt(5)
  ds_read_b128 v[216:219], v240 offset:4864
  v_max3_f32 v12, v72, v73, v12
  v_mfma_f32_16x16x32_bf16 v[100:103], v[224:227], v[148:151], v[100:103]
  s_waitcnt lgkmcnt(5)
  ds_read_b128 v[220:223], v240 offset:5632
  v_max3_f32 v12, v74, v75, v12
  v_mfma_f32_16x16x32_bf16 v[104:107], v[228:231], v[148:151], v[104:107]
  s_waitcnt lgkmcnt(5)
  ds_read_b128 v[224:227], v241 offset:4864
  v_max3_f32 v12, v84, v85, v12
  v_mfma_f32_16x16x32_bf16 v[100:103], v[200:203], v[152:155], v[100:103]
  s_waitcnt lgkmcnt(5)
  ds_read_b128 v[228:231], v241 offset:5632
  v_max3_f32 v12, v86, v87, v12
  v_mfma_f32_16x16x32_bf16 v[104:107], v[204:207], v[152:155], v[104:107]
  s_waitcnt lgkmcnt(5)
  ds_read_b128 v[200:203], v240 offset:6144
  v_max3_f32 v13, v96, v97, v13
  v_mfma_f32_16x16x32_bf16 v[100:103], v[208:211], v[156:159], v[100:103]
  s_waitcnt lgkmcnt(5)
  ds_read_b128 v[204:207], v240 offset:6912
  v_max3_f32 v13, v98, v99, v13
  v_mfma_f32_16x16x32_bf16 v[104:107], v[212:215], v[156:159], v[104:107]
  s_waitcnt lgkmcnt(5)
  ds_read_b128 v[208:211], v241 offset:6144
  v_mov_b32 v14, v12
  v_mfma_f32_16x16x32_bf16 v[100:103], v[216:219], v[160:163], v[100:103]
  s_waitcnt lgkmcnt(5)
  ds_read_b128 v[212:215], v241 offset:6912
  v_permlane32_swap_b32 v12, v14
  v_mfma_f32_16x16x32_bf16 v[104:107], v[220:223], v[160:163], v[104:107]
  s_waitcnt lgkmcnt(5)
  ds_read_b128 v[216:219], v242 offset:6144
  v_max_f32 v12, v12, v14
  v_mfma_f32_16x16x32_bf16 v[100:103], v[224:227], v[164:167], v[100:103]
  s_waitcnt lgkmcnt(5)
  ds_read_b128 v[220:223], v242 offset:6912
  v_mov_b32 v14, v12
  v_mfma_f32_16x16x32_bf16 v[104:107], v[228:231], v[164:167], v[104:107]
  s_waitcnt lgkmcnt(5)
  ds_read_b128 v[224:227], v243 offset:6144
  v_permlane16_swap_b32 v12, v14
  v_mfma_f32_16x16x32_bf16 v[108:111], v[200:203], v[144:147], v[108:111]
  s_waitcnt lgkmcnt(5)
  ds_read_b128 v[228:231], v243 offset:6912
  v_max_f32 v12, v12, v14
  v_mfma_f32_16x16x32_bf16 v[112:115], v[204:207], v[144:147], v[112:115]
  s_waitcnt lgkmcnt(5)
  ds_read_b128 v[200:203], v240 offset:6400
  v_mul_f32 v12, s63, v12
  v_mfma_f32_16x16x32_bf16 v[108:111], v[208:211], v[148:151], v[108:111]
  s_waitcnt lgkmcnt(5)
  ds_read_b128 v[204:207], v240 offset:7168
  v_fma_f32 v64, v64, s63, -v12
  v_mfma_f32_16x16x32_bf16 v[112:115], v[212:215], v[148:151], v[112:115]
  s_waitcnt lgkmcnt(5)
  ds_read_b128 v[208:211], v241 offset:6400
  v_fma_f32 v65, v65, s63, -v12
  v_mfma_f32_16x16x32_bf16 v[108:111], v[216:219], v[152:155], v[108:111]
  s_waitcnt lgkmcnt(5)
  ds_read_b128 v[212:215], v241 offset:7168
  v_fma_f32 v66, v66, s63, -v12
  v_mfma_f32_16x16x32_bf16 v[112:115], v[220:223], v[152:155], v[112:115]
  s_waitcnt lgkmcnt(5)
  v_fma_f32 v67, v67, s63, -v12
  v_fma_f32 v68, v68, s63, -v12
  v_mfma_f32_16x16x32_bf16 v[108:111], v[224:227], v[156:159], v[108:111]
  s_waitcnt lgkmcnt(4)
  v_fma_f32 v69, v69, s63, -v12
  v_fma_f32 v70, v70, s63, -v12
  v_mfma_f32_16x16x32_bf16 v[112:115], v[228:231], v[156:159], v[112:115]
  s_waitcnt lgkmcnt(3)
  v_fma_f32 v71, v71, s63, -v12
  v_fma_f32 v72, v72, s63, -v12
  v_mfma_f32_16x16x32_bf16 v[108:111], v[200:203], v[160:163], v[108:111]
  s_waitcnt lgkmcnt(2)
  v_fma_f32 v73, v73, s63, -v12
  v_fma_f32 v74, v74, s63, -v12
  v_mfma_f32_16x16x32_bf16 v[112:115], v[204:207], v[160:163], v[112:115]
  s_waitcnt lgkmcnt(1)
  v_fma_f32 v75, v75, s63, -v12
  v_fma_f32 v76, v76, s63, -v12
  v_mfma_f32_16x16x32_bf16 v[108:111], v[208:211], v[164:167], v[108:111]
  s_waitcnt lgkmcnt(0)
  v_fma_f32 v77, v77, s63, -v12
  v_fma_f32 v78, v78, s63, -v12
  v_mfma_f32_16x16x32_bf16 v[112:115], v[212:215], v[164:167], v[112:115]
  v_fma_f32 v79, v79, s63, -v12
  v_fma_f32 v80, v80, s63, -v12
  s_setprio 0
  s_cmp_lt_u32 s40, 4
  s_cbranch_scc1 M_pr2
  s_setprio 1
M_pr2:
  v_fma_f32 v81, v81, s63, -v12
  v_fma_f32 v82, v82, s63, -v12
  v_fma_f32 v83, v83, s63, -v12
  v_fma_f32 v84, v84, s63, -v12
  v_fma_f32 v85, v85, s63, -v12
  v_fma_f32 v86, v86, s63, -v12
  v_fma_f32 v87, v87, s63, -v12
  v_max3_f32 v13, v100, v101, v13
  v_max3_f32 v13, v102, v103, v13
  v_max3_f32 v13, v104, v105, v13
  v_max3_f32 v13, v106, v107, v13
  v_max3_f32 v13, v108, v109, v13
  v_max3_f32 v13, v110, v111, v13
  v_max3_f32 v13, v112, v113, v13
  v_max3_f32 v13, v114, v115, v13
  v_mov_b32 v15, v13
  s_nop 1
  v_permlane32_swap_b32 v13, v15
  v_max_f32 v13, v13, v15
  v_mov_b32 v15, v13
  s_nop 1
  v_permlane16_swap_b32 v13, v15
  v_max_f32 v13, v13, v15
  v_mul_f32 v13, s63, v13
  v_exp_f32 v64, v64
  v_exp_f32 v65, v65
  v_exp_f32 v66, v66
  v_exp_f32 v67, v67
  v_fma_f32 v88, v88, s63, -v13
  v_fma_f32 v89, v89, s63, -v13
  v_fma_f32 v90, v90, s63, -v13
  v_fma_f32 v91, v91, s63, -v13
  v_exp_f32 v88, v88
  v_exp_f32 v89, v89
  v_exp_f32 v90, v90
  v_exp_f32 v91, v91
  v_cvt_pk_bf16_f32 v16, v64, v65
  v_cvt_pk_bf16_f32 v17, v66, v67
  v_cvt_pk_bf16_f32 v34, v88, v89
  v_cvt_pk_bf16_f32 v35, v90, v91
  v_exp_f32 v68, v68
  v_exp_f32 v69, v69
  v_exp_f32 v70, v70
  v_exp_f32 v71, v71
  v_fma_f32 v92, v92, s63, -v13
  v_fma_f32 v93, v93, s63, -v13
  v_fma_f32 v94, v94, s63, -v13
  v_fma_f32 v95, v95, s63, -v13
  v_exp_f32 v92, v92
  v_exp_f32 v93, v93
  v_exp_f32 v94, v94
  v_exp_f32 v95, v95
  v_cvt_pk_bf16_f32 v18, v68, v69
  v_cvt_pk_bf16_f32 v19, v70, v71
  v_cvt_pk_bf16_f32 v36, v92, v93
  v_cvt_pk_bf16_f32 v37, v94, v95
  s_cmp_lt_u32 s40, 4
  s_cbranch_scc1 M_e2
  s_barrier
M_e2:
  s_mov_b32 s55, 0
  buffer_load_dwordx4 v[64:67], v252, s[24:27], s55 offen offset:0 sc1
  buffer_load_dwordx4 v[88:91], v252, s[24:27], s55 offen offset:1024 sc1
  buffer_load_dwordx4 v[68:71], v252, s[24:27], s55 offen offset:2048 sc1
  buffer_load_dwordx4 v[92:95], v252, s[24:27], s55 offen offset:3072 sc1
  v_exp_f32 v72, v72
  v_exp_f32 v73, v73
  v_exp_f32 v74, v74
  v_exp_f32 v75, v75
  v_fma_f32 v96, v96, s63, -v13
  v_fma_f32 v97, v97, s63, -v13
  v_fma_f32 v98, v98, s63, -v13
  v_fma_f32 v99, v99, s63, -v13
  v_exp_f32 v96, v96
  v_exp_f32 v97, v97
  v_exp_f32 v98, v98
  v_exp_f32 v99, v99
  v_cvt_pk_bf16_f32 v20, v72, v73
  v_cvt_pk_bf16_f32 v21, v74, v75
  v_cvt_pk_bf16_f32 v38, v96, v97
  v_cvt_pk_bf16_f32 v39, v98, v99
  s_mov_b32 s55, 4096
  buffer_load_dwordx4 v[72:75], v252, s[24:27], s55 offen offset:0 sc1
  buffer_load_dwordx4 v[96:99], v252, s[24:27], s55 offen offset:1024 sc1
  v_exp_f32 v76, v76
  v_exp_f32 v77, v77
  v_exp_f32 v78, v78
  v_exp_f32 v79, v79
  v_fma_f32 v100, v100, s63, -v13
  v_fma_f32 v101, v101, s63, -v13
  v_fma_f32 v102, v102, s63, -v13
  v_fma_f32 v103, v103, s63, -v13
  v_exp_f32 v100, v100
  v_exp_f32 v101, v101
  v_exp_f32 v102, v102
  v_exp_f32 v103, v103
  v_cvt_pk_bf16_f32 v22, v76, v77
  v_cvt_pk_bf16_f32 v23, v78, v79
  v_cvt_pk_bf16_f32 v40, v100, v101
  v_cvt_pk_bf16_f32 v41, v102, v103
  buffer_load_dwordx4 v[76:79], v252, s[24:27], s55 offen offset:2048 sc1
  buffer_load_dwordx4 v[100:103], v252, s[24:27], s55 offen offset:3072 sc1
  v_exp_f32 v80, v80
  v_exp_f32 v81, v81
  v_exp_f32 v82, v82
  v_exp_f32 v83, v83
  v_fma_f32 v104, v104, s63, -v13
  v_fma_f32 v105, v105, s63, -v13
  v_fma_f32 v106, v106, s63, -v13
  v_fma_f32 v107, v107, s63, -v13
  v_exp_f32 v104, v104
  v_exp_f32 v105, v105
  v_exp_f32 v106, v106
  v_exp_f32 v107, v107
  v_cvt_pk_bf16_f32 v24, v80, v81
  v_cvt_pk_bf16_f32 v25, v82, v83
  v_cvt_pk_bf16_f32 v42, v104, v105
  v_cvt_pk_bf16_f32 v43, v106, v107
  s_mov_b32 s55, 8192
  buffer_load_dwordx4 v[80:83], v252, s[24:27], s55 offen offset:0 sc1
  buffer_load_dwordx4 v[104:107], v252, s[24:27], s55 offen offset:1024 sc1
  v_exp_f32 v84, v84
  v_exp_f32 v85, v85
  v_exp_f32 v86, v86
  v_exp_f32 v87, v87
  v_fma_f32 v108, v108, s63, -v13
  v_fma_f32 v109, v109, s63, -v13
  v_fma_f32 v110, v110, s63, -v13
  v_fma_f32 v111, v111, s63, -v13
  v_exp_f32 v108, v108
  v_exp_f32 v109, v109
  v_exp_f32 v110, v110
  v_exp_f32 v111, v111
  v_cvt_pk_bf16_f32 v26, v84, v85
  v_cvt_pk_bf16_f32 v27, v86, v87
  v_cvt_pk_bf16_f32 v44, v108, v109
  v_cvt_pk_bf16_f32 v45, v110, v111
  buffer_load_dwordx4 v[84:87], v252, s[24:27], s55 offen offset:2048 sc1
  buffer_load_dwordx4 v[108:111], v252, s[24:27], s55 offen offset:3072 sc1
  ds_read_b64_tr_b16 v[200:201], v244 offset:0
  ds_read_b64_tr_b16 v[202:203], v244 offset:768
  ds_read_b64_tr_b16 v[204:205], v245 offset:0
  ds_read_b64_tr_b16 v[206:207], v245 offset:768
  ds_read_b64_tr_b16 v[208:209], v244 offset:1536
  ds_read_b64_tr_b16 v[210:211], v244 offset:2304
  ds_read_b64_tr_b16 v[212:213], v245 offset:1536
  ds_read_b64_tr_b16 v[214:215], v245 offset:2304
  ds_read_b64_tr_b16 v[216:217], v244 offset:3072
  ds_read_b64_tr_b16 v[218:219], v244 offset:3840
  ds_read_b64_tr_b16 v[220:221], v245 offset:3072
  ds_read_b64_tr_b16 v[222:223], v245 offset:3840
  v_fma_f32 v112, v112, s63, -v13
  v_fma_f32 v113, v113, s63, -v13
  v_fma_f32 v114, v114, s63, -v13
  v_fma_f32 v115, v115, s63, -v13
  v_exp_f32 v112, v112
  v_exp_f32 v113, v113
  v_exp_f32 v114, v114
  v_exp_f32 v115, v115
  v_cvt_pk_bf16_f32 v46, v112, v113
  v_cvt_pk_bf16_f32 v47, v114, v115
  s_mov_b32 s55, 12288
  buffer_load_dwordx4 v[232:235], v252, s[24:27], s55 offen offset:0 sc1
  buffer_load_dwordx4 v[112:115], v252, s[24:27], s55 offen offset:1024 sc1
  s_cmp_ge_u32 s40, 4
  s_cbranch_scc1 M_l2
  s_barrier
M_l2:
  s_setprio 2
  s_cmp_lt_u32 s40, 4
  s_cbranch_scc1 M_pr3
  s_setprio 3
M_pr3:
  s_waitcnt lgkmcnt(10)
  v_mfma_f32_16x16x32_bf16 v[168:171], v[200:203], v[16:19], 0
  s_waitcnt lgkmcnt(8)
  ds_read_b64_tr_b16 v[224:225], v244 offset:4608
  ds_read_b64_tr_b16 v[226:227], v244 offset:5376
  v_mfma_f32_16x16x32_bf16 v[172:175], v[204:207], v[16:19], 0
  s_waitcnt lgkmcnt(8)
  ds_read_b64_tr_b16 v[228:229], v245 offset:4608
  v_mfma_f32_16x16x32_bf16 v[168:171], v[208:211], v[20:23], v[168:171]
  ds_read_b64_tr_b16 v[230:231], v245 offset:5376
  v_mfma_f32_16x16x32_bf16 v[176:179], v[208:211], v[32:35], 0
  s_waitcnt lgkmcnt(8)
  ds_read_b64_tr_b16 v[200:201], v244 offset:6144
  ds_read_b64_tr_b16 v[202:203], v244 offset:6912
  v_mfma_f32_16x16x32_bf16 v[172:175], v[212:215], v[20:23], v[172:175]
  ds_read_b64_tr_b16 v[204:205], v245 offset:6144
  v_mfma_f32_16x16x32_bf16 v[180:183], v[212:215], v[32:35], 0
  s_waitcnt lgkmcnt(9)
  ds_read_b64_tr_b16 v[206:207], v245 offset:6912
  v_mfma_f32_16x16x32_bf16 v[168:171], v[216:219], v[24:27], v[168:171]
  ds_read_b64_tr_b16 v[208:209], v246 offset:0
  v_mfma_f32_16x16x32_bf16 v[176:179], v[216:219], v[36:39], v[176:179]
  s_waitcnt lgkmcnt(9)
  ds_read_b64_tr_b16 v[210:211], v246 offset:768
  ds_read_b64_tr_b16 v[212:213], v247 offset:0
  v_mfma_f32_16x16x32_bf16 v[172:175], v[220:223], v[24:27], v[172:175]
  ds_read_b64_tr_b16 v[214:215], v247 offset:768
  v_mfma_f32_16x16x32_bf16 v[180:183], v[220:223], v[36:39], v[180:183]
  s_waitcnt lgkmcnt(10)
  ds_read_b64_tr_b16 v[216:217], v246 offset:1536
  v_mfma_f32_16x16x32_bf16 v[176:179], v[224:227], v[40:43], v[176:179]
  s_waitcnt lgkmcnt(9)
  ds_read_b64_tr_b16 v[218:219], v246 offset:2304
  v_mfma_f32_16x16x32_bf16 v[180:183], v[228:231], v[40:43], v[180:183]
  ds_read_b64_tr_b16 v[220:221], v247 offset:1536
  ds_read_b64_tr_b16 v[222:223], v247 offset:2304
  v_mfma_f32_16x16x32_bf16 v[56:59], v[16:19], v[48:51], 0
  s_waitcnt lgkmcnt(10)
  ds_read_b64_tr_b16 v[224:225], v246 offset:3072
  v_mfma_f32_16x16x32_bf16 v[176:179], v[200:203], v[44:47], v[176:179]
  s_waitcnt lgkmcnt(9)
  ds_read_b64_tr_b16 v[226:227], v246 offset:3840
  v_mfma_f32_16x16x32_bf16 v[180:183], v[204:207], v[44:47], v[180:183]
  s_waitcnt lgkmcnt(8)
  ds_read_b64_tr_b16 v[228:229], v247 offset:3072
  ds_read_b64_tr_b16 v[230:231], v247 offset:3840
  v_mfma_f32_16x16x32_bf16 v[184:187], v[208:211], v[16:19], 0
  s_waitcnt lgkmcnt(8)
  ds_read_b64_tr_b16 v[200:201], v246 offset:4608
  v_mfma_f32_16x16x32_bf16 v[188:191], v[212:215], v[16:19], 0
  ds_read_b64_tr_b16 v[202:203], v246 offset:5376
  v_mfma_f32_16x16x32_bf16 v[60:63], v[32:35], v[48:51], 0
  s_waitcnt lgkmcnt(8)
  ds_read_b64_tr_b16 v[204:205], v247 offset:4608
  v_mfma_f32_16x16x32_bf16 v[184:187], v[216:219], v[20:23], v[184:187]
  ds_read_b64_tr_b16 v[206:207], v247 offset:5376
  ds_read_b64_tr_b16 v[208:209], v246 offset:6144
  v_mfma_f32_16x16x32_bf16 v[192:195], v[216:219], v[32:35], 0
  s_waitcnt lgkmcnt(9)
  ds_read_b64_tr_b16 v[210:211], v246 offset:6912
  v_cvt_pk_bf16_f32 v120, v168, v169
  v_mfma_f32_16x16x32_bf16 v[188:191], v[220:223], v[20:23], v[188:191]
  ds_read_b64_tr_b16 v[212:213], v247 offset:6144
  v_cvt_pk_bf16_f32 v121, v170, v171
  v_mfma_f32_16x16x32_bf16 v[196:199], v[220:223], v[32:35], 0
  s_waitcnt lgkmcnt(9)
  ds_read_b64_tr_b16 v[214:215], v247 offset:6912
  v_cvt_pk_bf16_f32 v122, v172, v173
  v_mfma_f32_16x16x32_bf16 v[184:187], v[224:227], v[24:27], v[184:187]
  ds_read_b64_tr_b16 v[216:217], v248 offset:0
  ds_read_b64_tr_b16 v[218:219], v248 offset:768
  v_mfma_f32_16x16x32_bf16 v[192:195], v[224:227], v[36:39], v[192:195]
  s_waitcnt lgkmcnt(10)
  ds_read_b64_tr_b16 v[220:221], v249 offset:0
  v_cvt_pk_bf16_f32 v123, v174, v175
  v_mfma_f32_16x16x32_bf16 v[188:191], v[228:231], v[24:27], v[188:191]
  ds_read_b64_tr_b16 v[222:223], v249 offset:768
  v_cvt_pk_bf16_f32 v144, v176, v177
  v_mfma_f32_16x16x32_bf16 v[196:199], v[228:231], v[36:39], v[196:199]
  s_waitcnt lgkmcnt(10)
  ds_read_b64_tr_b16 v[224:225], v248 offset:1536
  ds_read_b64_tr_b16 v[226:227], v248 offset:2304
  v_mfma_f32_16x16x32_bf16 v[192:195], v[200:203], v[40:43], v[192:195]
  s_waitcnt lgkmcnt(10)
  ds_read_b64_tr_b16 v[228:229], v249 offset:1536
  v_cvt_pk_bf16_f32 v145, v178, v179
  v_mfma_f32_16x16x32_bf16 v[196:199], v[204:207], v[40:43], v[196:199]
  ds_read_b64_tr_b16 v[230:231], v249 offset:2304
  v_cvt_pk_bf16_f32 v146, v180, v181
  v_mfma_f32_16x16x32_bf16 v[56:59], v[20:23], v[48:51], v[56:59]
  s_waitcnt lgkmcnt(10)
  ds_read_b64_tr_b16 v[200:201], v248 offset:3072
  v_cvt_pk_bf16_f32 v147, v182, v183
  v_mfma_f32_16x16x32_bf16 v[192:195], v[208:211], v[44:47], v[192:195]
  s_waitcnt lgkmcnt(9)
  ds_read_b64_tr_b16 v[202:203], v248 offset:3840
  ds_read_b64_tr_b16 v[204:205], v249 offset:3072
  v_mfma_f32_16x16x32_bf16 v[196:199], v[212:215], v[44:47], v[196:199]
  ds_read_b64_tr_b16 v[206:207], v249 offset:3840
  s_cmp_ge_u32 s40, 4
  s_cbranch_scc1 M_l3
  s_barrier
M_l3:
  s_waitcnt lgkmcnt(10)
  v_mfma_f32_16x16x32_bf16 v[168:171], v[216:219], v[16:19], 0
  s_waitcnt lgkmcnt(8)
  ds_read_b64_tr_b16 v[208:209], v248 offset:4608
  v_mfma_f32_16x16x32_bf16 v[172:175], v[220:223], v[16:19], 0
  s_waitcnt lgkmcnt(7)
  ds_read_b64_tr_b16 v[210:211], v248 offset:5376
  v_mfma_f32_16x16x32_bf16 v[168:171], v[224:227], v[20:23], v[168:171]
  ds_read_b64_tr_b16 v[212:213], v249 offset:4608
  ds_read_b64_tr_b16 v[214:215], v249 offset:5376
  v_mfma_f32_16x16x32_bf16 v[176:179], v[224:227], v[32:35], 0
  s_waitcnt lgkmcnt(8)
  ds_read_b64_tr_b16 v[216:217], v248 offset:6144
  v_cvt_pk_bf16_f32 v124, v184, v185
  v_mfma_f32_16x16x32_bf16 v[172:175], v[228:231], v[20:23], v[172:175]
  ds_read_b64_tr_b16 v[218:219], v248 offset:6912
  v_cvt_pk_bf16_f32 v125, v186, v187
  v_mfma_f32_16x16x32_bf16 v[180:183], v[228:231], v[32:35], 0
  s_waitcnt lgkmcnt(8)
  ds_read_b64_tr_b16 v[220:221], v249 offset:6144
  ds_read_b64_tr_b16 v[222:223], v249 offset:6912
  v_mfma_f32_16x16x32_bf16 v[168:171], v[200:203], v[24:27], v[168:171]
  ds_read_b64_tr_b16 v[224:225], v250 offset:0
  v_cvt_pk_bf16_f32 v126, v188, v189
  v_mfma_f32_16x16x32_bf16 v[176:179], v[200:203], v[36:39], v[176:179]
  s_waitcnt lgkmcnt(9)
  ds_read_b64_tr_b16 v[226:227], v250 offset:768
  v_cvt_pk_bf16_f32 v127, v190, v191
  v_mfma_f32_16x16x32_bf16 v[172:175], v[204:207], v[24:27], v[172:175]
  ds_read_b64_tr_b16 v[228:229], v251 offset:0
  v_cvt_pk_bf16_f32 v148, v192, v193
  v_mfma_f32_16x16x32_bf16 v[180:183], v[204:207], v[36:39], v[180:183]
  s_waitcnt lgkmcnt(9)
  ds_read_b64_tr_b16 v[230:231], v251 offset:768
  ds_read_b64_tr_b16 v[200:201], v250 offset:1536
  v_mfma_f32_16x16x32_bf16 v[176:179], v[208:211], v[40:43], v[176:179]
  s_waitcnt lgkmcnt(9)
  ds_read_b64_tr_b16 v[202:203], v250 offset:2304
  v_cvt_pk_bf16_f32 v149, v194, v195
  v_mfma_f32_16x16x32_bf16 v[180:183], v[212:215], v[40:43], v[180:183]
  ds_read_b64_tr_b16 v[204:205], v251 offset:1536
  v_cvt_pk_bf16_f32 v150, v196, v197
  v_mfma_f32_16x16x32_bf16 v[60:63], v[36:39], v[48:51], v[60:63]
  s_waitcnt lgkmcnt(9)
  ds_read_b64_tr_b16 v[206:207], v251 offset:2304
  v_cvt_pk_bf16_f32 v151, v198, v199
  v_mfma_f32_16x16x32_bf16 v[176:179], v[216:219], v[44:47], v[176:179]
  s_waitcnt lgkmcnt(8)
  ds_read_b64_tr_b16 v[208:209], v250 offset:3072
  ds_read_b64_tr_b16 v[210:211], v250 offset:3840
  v_mfma_f32_16x16x32_bf16 v[180:183], v[220:223], v[44:47], v[180:183]
  s_waitcnt lgkmcnt(8)
  ds_read_b64_tr_b16 v[212:213], v251 offset:3072
  v_mfma_f32_16x16x32_bf16 v[184:187], v[224:227], v[16:19], 0
  s_waitcnt lgkmcnt(7)
  ds_read_b64_tr_b16 v[214:215], v251 offset:3840
  v_mfma_f32_16x16x32_bf16 v[188:191], v[228:231], v[16:19], 0
  s_waitcnt lgkmcnt(6)
  ds_read_b64_tr_b16 v[216:217], v250 offset:4608
  v_mfma_f32_16x16x32_bf16 v[184:187], v[200:203], v[20:23], v[184:187]
  ds_read_b64_tr_b16 v[218:219], v250 offset:5376
  ds_read_b64_tr_b16 v[220:221], v251 offset:4608
  v_mfma_f32_16x16x32_bf16 v[192:195], v[200:203], v[32:35], 0
  s_waitcnt lgkmcnt(7)
  ds_read_b64_tr_b16 v[222:223], v251 offset:5376
  v_cvt_pk_bf16_f32 v128, v168, v169
  v_mfma_f32_16x16x32_bf16 v[188:191], v[204:207], v[20:23], v[188:191]
  ds_read_b64_tr_b16 v[224:225], v250 offset:6144
  v_cvt_pk_bf16_f32 v129, v170, v171
  v_mfma_f32_16x16x32_bf16 v[196:199], v[204:207], v[32:35], 0
  s_waitcnt lgkmcnt(7)
  ds_read_b64_tr_b16 v[226:227], v250 offset:6912
  ds_read_b64_tr_b16 v[228:229], v251 offset:6144
  v_mfma_f32_16x16x32_bf16 v[184:187], v[208:211], v[24:27], v[184:187]
  ds_read_b64_tr_b16 v[230:231], v251 offset:6912
  v_cvt_pk_bf16_f32 v130, v172, v173
  v_mfma_f32_16x16x32_bf16 v[192:195], v[208:211], v[36:39], v[192:195]
  s_waitcnt lgkmcnt(8)
  ds_read_b64_tr_b16 v[200:201], v244 offset:256
  v_cvt_pk_bf16_f32 v131, v174, v175
  v_mfma_f32_16x16x32_bf16 v[188:191], v[212:215], v[24:27], v[188:191]
  ds_read_b64_tr_b16 v[202:203], v244 offset:1024
  v_cvt_pk_bf16_f32 v152, v176, v177
  v_mfma_f32_16x16x32_bf16 v[196:199], v[212:215], v[36:39], v[196:199]
  s_waitcnt lgkmcnt(8)
  ds_read_b64_tr_b16 v[204:205], v245 offset:256
  ds_read_b64_tr_b16 v[206:207], v245 offset:1024
  v_mfma_f32_16x16x32_bf16 v[192:195], v[216:219], v[40:43], v[192:195]
  s_waitcnt lgkmcnt(8)
  ds_read_b64_tr_b16 v[208:209], v244 offset:1792
  v_cvt_pk_bf16_f32 v153, v178, v179
  v_mfma_f32_16x16x32_bf16 v[196:199], v[220:223], v[40:43], v[196:199]
  ds_read_b64_tr_b16 v[210:211], v244 offset:2560
  v_cvt_pk_bf16_f32 v154, v180, v181
  v_mfma_f32_16x16x32_bf16 v[56:59], v[24:27], v[48:51], v[56:59]
  s_waitcnt lgkmcnt(8)
  ds_read_b64_tr_b16 v[212:213], v245 offset:1792
  v_cvt_pk_bf16_f32 v155, v182, v183
  v_mfma_f32_16x16x32_bf16 v[192:195], v[224:227], v[44:47], v[192:195]
  s_waitcnt lgkmcnt(7)
  ds_read_b64_tr_b16 v[214:215], v245 offset:2560
  ds_read_b64_tr_b16 v[216:217], v244 offset:3328
  v_mfma_f32_16x16x32_bf16 v[196:199], v[228:231], v[44:47], v[196:199]
  s_waitcnt lgkmcnt(7)
  ds_read_b64_tr_b16 v[218:219], v244 offset:4096
  v_mfma_f32_16x16x32_bf16 v[168:171], v[200:203], v[16:19], 0
  s_waitcnt lgkmcnt(6)
  ds_read_b64_tr_b16 v[220:221], v245 offset:3328
  v_mfma_f32_16x16x32_bf16 v[172:175], v[204:207], v[16:19], 0
  s_waitcnt lgkmcnt(5)
  ds_read_b64_tr_b16 v[222:223], v245 offset:4096
  ds_read_b64_tr_b16 v[224:225], v244 offset:4864
  v_mfma_f32_16x16x32_bf16 v[168:171], v[208:211], v[20:23], v[168:171]
  ds_read_b64_tr_b16 v[226:227], v244 offset:5632
  v_mfma_f32_16x16x32_bf16 v[176:179], v[208:211], v[32:35], 0
  s_waitcnt lgkmcnt(6)
  ds_read_b64_tr_b16 v[228:229], v245 offset:4864
  v_cvt_pk_bf16_f32 v132, v184, v185
  v_mfma_f32_16x16x32_bf16 v[172:175], v[212:215], v[20:23], v[172:175]
  ds_read_b64_tr_b16 v[230:231], v245 offset:5632
  v_cvt_pk_bf16_f32 v133, v186, v187
  v_mfma_f32_16x16x32_bf16 v[180:183], v[212:215], v[32:35], 0
  s_waitcnt lgkmcnt(6)
  ds_read_b64_tr_b16 v[200:201], v244 offset:6400
  ds_read_b64_tr_b16 v[202:203], v244 offset:7168
  v_mfma_f32_16x16x32_bf16 v[168:171], v[216:219], v[24:27], v[168:171]
  ds_read_b64_tr_b16 v[204:205], v245 offset:6400
  v_cvt_pk_bf16_f32 v134, v188, v189
  v_mfma_f32_16x16x32_bf16 v[176:179], v[216:219], v[36:39], v[176:179]
  s_waitcnt lgkmcnt(7)
  ds_read_b64_tr_b16 v[206:207], v245 offset:7168
  v_cvt_pk_bf16_f32 v135, v190, v191
  v_mfma_f32_16x16x32_bf16 v[172:175], v[220:223], v[24:27], v[172:175]
  ds_read_b64_tr_b16 v[208:209], v246 offset:256
  v_cvt_pk_bf16_f32 v156, v192, v193
  v_mfma_f32_16x16x32_bf16 v[180:183], v[220:223], v[36:39], v[180:183]
  s_waitcnt lgkmcnt(7)
  ds_read_b64_tr_b16 v[210:211], v246 offset:1024
  ds_read_b64_tr_b16 v[212:213], v247 offset:256
  v_mfma_f32_16x16x32_bf16 v[176:179], v[224:227], v[40:43], v[176:179]
  s_waitcnt lgkmcnt(7)
  ds_read_b64_tr_b16 v[214:215], v247 offset:1024
  v_cvt_pk_bf16_f32 v157, v194, v195
  v_mfma_f32_16x16x32_bf16 v[180:183], v[228:231], v[40:43], v[180:183]
  ds_read_b64_tr_b16 v[216:217], v246 offset:1792
  v_cvt_pk_bf16_f32 v158, v196, v197
  v_mfma_f32_16x16x32_bf16 v[60:63], v[40:43], v[48:51], v[60:63]
  s_waitcnt lgkmcnt(7)
  ds_read_b64_tr_b16 v[218:219], v246 offset:2560
  ds_read_b64_tr_b16 v[220:221], v247 offset:1792
  v_mfma_f32_16x16x32_bf16 v[176:179], v[200:203], v[44:47], v[176:179]
  s_waitcnt lgkmcnt(7)
  ds_read_b64_tr_b16 v[222:223], v247 offset:2560
  v_cvt_pk_bf16_f32 v159, v198, v199
  v_mfma_f32_16x16x32_bf16 v[180:183], v[204:207], v[44:47], v[180:183]
  s_waitcnt lgkmcnt(6)
  ds_read_b64_tr_b16 v[224:225], v246 offset:3328
  v_mfma_f32_16x16x32_bf16 v[184:187], v[208:211], v[16:19], 0
  s_waitcnt lgkmcnt(5)
  ds_read_b64_tr_b16 v[226:227], v246 offset:4096
  v_mfma_f32_16x16x32_bf16 v[188:191], v[212:215], v[16:19], 0
  s_waitcnt lgkmcnt(4)
  ds_read_b64_tr_b16 v[228:229], v247 offset:3328
  ds_read_b64_tr_b16 v[230:231], v247 offset:4096
  v_mfma_f32_16x16x32_bf16 v[184:187], v[216:219], v[20:23], v[184:187]
  ds_read_b64_tr_b16 v[200:201], v246 offset:4864
  v_mfma_f32_16x16x32_bf16 v[192:195], v[216:219], v[32:35], 0
  s_waitcnt lgkmcnt(5)
  ds_read_b64_tr_b16 v[202:203], v246 offset:5632
  v_cvt_pk_bf16_f32 v136, v168, v169
  v_mfma_f32_16x16x32_bf16 v[188:191], v[220:223], v[20:23], v[188:191]
  ds_read_b64_tr_b16 v[204:205], v247 offset:4864
  v_cvt_pk_bf16_f32 v137, v170, v171
  v_mfma_f32_16x16x32_bf16 v[196:199], v[220:223], v[32:35], 0
  s_waitcnt lgkmcnt(5)
  ds_read_b64_tr_b16 v[206:207], v247 offset:5632
  ds_read_b64_tr_b16 v[208:209], v246 offset:6400
  v_mfma_f32_16x16x32_bf16 v[184:187], v[224:227], v[24:27], v[184:187]
  ds_read_b64_tr_b16 v[210:211], v246 offset:7168
  v_cvt_pk_bf16_f32 v138, v172, v173
  v_mfma_f32_16x16x32_bf16 v[192:195], v[224:227], v[36:39], v[192:195]
  s_waitcnt lgkmcnt(6)
  ds_read_b64_tr_b16 v[212:213], v247 offset:6400
  v_cvt_pk_bf16_f32 v139, v174, v175
  v_mfma_f32_16x16x32_bf16 v[188:191], v[228:231], v[24:27], v[188:191]
  ds_read_b64_tr_b16 v[214:215], v247 offset:7168
  v_cvt_pk_bf16_f32 v160, v176, v177
  v_mfma_f32_16x16x32_bf16 v[196:199], v[228:231], v[36:39], v[196:199]
  s_waitcnt lgkmcnt(6)
  v_cvt_pk_bf16_f32 v161, v178, v179
  v_cvt_pk_bf16_f32 v162, v180, v181
  v_mfma_f32_16x16x32_bf16 v[192:195], v[200:203], v[40:43], v[192:195]
  s_waitcnt lgkmcnt(4)
  v_cvt_pk_bf16_f32 v163, v182, v183
  v_mfma_f32_16x16x32_bf16 v[196:199], v[204:207], v[40:43], v[196:199]
  v_mfma_f32_16x16x32_bf16 v[60:63], v[44:47], v[48:51], v[60:63]
  s_waitcnt lgkmcnt(2)
  v_mfma_f32_16x16x32_bf16 v[192:195], v[208:211], v[44:47], v[192:195]
  s_waitcnt lgkmcnt(0)
  v_mfma_f32_16x16x32_bf16 v[196:199], v[212:215], v[44:47], v[196:199]
  s_waitcnt vmcnt(0)
  s_cmp_lg_u32 s40, 4
  s_cbranch_scc1 M_e3b
  s_mov_b32 m0, 0
  s_mov_b32 s59, 24576
  buffer_load_dwordx4 v252, s[24:27], s59 offen offset:0 sc1 lds
  buffer_load_dwordx4 v252, s[24:27], s59 offen offset:1024 sc1 lds
  buffer_load_dwordx4 v252, s[24:27], s59 offen offset:2048 sc1 lds
  buffer_load_dwordx4 v252, s[24:27], s59 offen offset:3072 sc1 lds
  s_mov_b32 m0, 4096
  s_mov_b32 s59, 28672
  buffer_load_dwordx4 v252, s[24:27], s59 offen offset:0 sc1 lds
  buffer_load_dwordx4 v252, s[24:27], s59 offen offset:1024 sc1 lds
  buffer_load_dwordx4 v252, s[24:27], s59 offen offset:2048 sc1 lds
  buffer_load_dwordx4 v252, s[24:27], s59 offen offset:3072 sc1 lds
  s_mov_b32 m0, 8192
  s_mov_b32 s59, 32768
  buffer_load_dwordx4 v252, s[24:27], s59 offen offset:0 sc1 lds
  buffer_load_dwordx4 v252, s[24:27], s59 offen offset:1024 sc1 lds
  buffer_load_dwordx4 v252, s[24:27], s59 offen offset:2048 sc1 lds
  buffer_load_dwordx4 v252, s[24:27], s59 offen offset:3072 sc1 lds
  s_mov_b32 m0, 12288
  s_mov_b32 s59, 36864
  buffer_load_dwordx4 v252, s[24:27], s59 offen offset:0 sc1 lds
  buffer_load_dwordx4 v252, s[24:27], s59 offen offset:1024 sc1 lds
  buffer_load_dwordx4 v252, s[24:27], s59 offen offset:2048 sc1 lds
M_e3b:
  v_mfma_f32_16x16x32_bf16 v[168:171], v[120:123], v[64:67], 0
  v_rcp_f32 v56, v56
  v_mfma_f32_16x16x32_bf16 v[176:179], v[144:147], v[64:67], 0
  v_rcp_f32 v57, v57
  v_mfma_f32_16x16x32_bf16 v[172:175], v[120:123], v[88:91], 0
  v_rcp_f32 v58, v58
  v_mfma_f32_16x16x32_bf16 v[180:183], v[144:147], v[88:91], 0
  v_cvt_pk_bf16_f32 v140, v184, v185
  v_cvt_pk_bf16_f32 v141, v186, v187
  v_mfma_f32_16x16x32_bf16 v[168:171], v[124:127], v[68:71], v[168:171]
  v_cvt_pk_bf16_f32 v142, v188, v189
  v_cvt_pk_bf16_f32 v143, v190, v191
  v_mfma_f32_16x16x32_bf16 v[176:179], v[148:151], v[68:71], v[176:179]
  v_cvt_pk_bf16_f32 v164, v192, v193
  v_cvt_pk_bf16_f32 v165, v194, v195
  v_mfma_f32_16x16x32_bf16 v[172:175], v[124:127], v[92:95], v[172:175]
  v_cvt_pk_bf16_f32 v166, v196, v197
  v_cvt_pk_bf16_f32 v167, v198, v199
  v_mfma_f32_16x16x32_bf16 v[180:183], v[148:151], v[92:95], v[180:183]
  v_rcp_f32 v59, v59
  v_mfma_f32_16x16x32_bf16 v[168:171], v[128:131], v[72:75], v[168:171]
  v_rcp_f32 v60, v60
  v_mfma_f32_16x16x32_bf16 v[176:179], v[152:155], v[72:75], v[176:179]
  v_rcp_f32 v61, v61
  v_mfma_f32_16x16x32_bf16 v[172:175], v[128:131], v[96:99], v[172:175]
  v_rcp_f32 v62, v62
  v_mfma_f32_16x16x32_bf16 v[180:183], v[152:155], v[96:99], v[180:183]
  v_rcp_f32 v63, v63
  v_mfma_f32_16x16x32_bf16 v[168:171], v[132:135], v[76:79], v[168:171]
  v_mfma_f32_16x16x32_bf16 v[176:179], v[156:159], v[76:79], v[176:179]
  s_cmp_lt_u32 s40, 4
  s_cbranch_scc1 M_e3
  s_cmp_lg_u32 s40, 4
  s_cbranch_scc1 M_e3a
  s_waitcnt vmcnt(0)
  s_barrier
  s_mov_b32 m0, 15360
  s_mov_b32 s59, 39936
  buffer_load_dwordx4 v252, s[24:27], s59 offen offset:0 sc1 lds
  buffer_load_dwordx4 v252, s[24:27], s59 offen offset:1024 sc1 lds
  buffer_load_dwordx4 v252, s[24:27], s59 offen offset:2048 sc1 lds
  buffer_load_dwordx4 v252, s[24:27], s59 offen offset:3072 sc1 lds
  s_mov_b32 m0, 19456
  s_mov_b32 s59, 44032
  buffer_load_dwordx4 v252, s[24:27], s59 offen offset:0 sc1 lds
  buffer_load_dwordx4 v252, s[24:27], s59 offen offset:1024 sc1 lds
  buffer_load_dwordx4 v252, s[24:27], s59 offen offset:2048 sc1 lds
  buffer_load_dwordx4 v252, s[24:27], s59 offen offset:3072 sc1 lds
  s_mov_b32 m0, 23552
  s_mov_b32 s59, 48128
  buffer_load_dwordx4 v252, s[24:27], s59 offen offset:0 sc1 lds
  buffer_load_dwordx4 v252, s[24:27], s59 offen offset:1024 sc1 lds
  buffer_load_dwordx4 v252, s[24:27], s59 offen offset:2048 sc1 lds
  buffer_load_dwordx4 v252, s[24:27], s59 offen offset:3072 sc1 lds
  s_mov_b32 m0, 27648
  s_mov_b32 s59, 52224
  buffer_load_dwordx4 v252, s[24:27], s59 offen offset:0 sc1 lds
  buffer_load_dwordx4 v252, s[24:27], s59 offen offset:1024 sc1 lds
  buffer_load_dwordx4 v252, s[24:27], s59 offen offset:2048 sc1 lds
  buffer_load_dwordx4 v252, s[24:27], s59 offen offset:3072 sc1 lds
  s_branch M_e3
M_e3a:
  s_barrier
M_e3:
  v_mfma_f32_16x16x32_bf16 v[172:175], v[132:135], v[100:103], v[172:175]
  v_mfma_f32_16x16x32_bf16 v[180:183], v[156:159], v[100:103], v[180:183]
  v_mfma_f32_16x16x32_bf16 v[168:171], v[136:139], v[80:83], v[168:171]
  v_mfma_f32_16x16x32_bf16 v[176:179], v[160:163], v[80:83], v[176:179]
  v_mfma_f32_16x16x32_bf16 v[172:175], v[136:139], v[104:107], v[172:175]
  v_mfma_f32_16x16x32_bf16 v[180:183], v[160:163], v[104:107], v[180:183]
  v_mfma_f32_16x16x32_bf16 v[168:171], v[140:143], v[84:87], v[168:171]
  ds_read_b128 v[224:227], v253 offset:0
  v_mfma_f32_16x16x32_bf16 v[176:179], v[164:167], v[84:87], v[176:179]
  v_mfma_f32_16x16x32_bf16 v[172:175], v[140:143], v[108:111], v[172:175]
  ds_read_b128 v[228:231], v253 offset:1024
  v_mfma_f32_16x16x32_bf16 v[180:183], v[164:167], v[108:111], v[180:183]
  v_mfma_f32_16x16x32_bf16 v[184:187], v[120:123], v[232:235], 0
  ds_read_b128 v[200:203], v253 offset:2048
  v_mfma_f32_16x16x32_bf16 v[192:195], v[144:147], v[232:235], 0
  v_mfma_f32_16x16x32_bf16 v[188:191], v[120:123], v[112:115], 0
  ds_read_b128 v[204:207], v253 offset:3072
  v_mul_f32 v168, v168, v56
  v_mfma_f32_16x16x32_bf16 v[196:199], v[144:147], v[112:115], 0
  s_waitcnt lgkmcnt(3)
  v_mul_f32 v172, v172, v56
  v_cvt_pk_bf16_f32 v16, v168, v172
  v_mfma_f32_16x16x32_bf16 v[184:187], v[124:127], v[224:227], v[184:187]
  ds_read_b128 v[208:211], v253 offset:4096
  v_mul_f32 v169, v169, v57
  v_mfma_f32_16x16x32_bf16 v[192:195], v[148:151], v[224:227], v[192:195]
  s_waitcnt lgkmcnt(3)
  v_mul_f32 v173, v173, v57
  v_cvt_pk_bf16_f32 v18, v169, v173
  v_mfma_f32_16x16x32_bf16 v[188:191], v[124:127], v[228:231], v[188:191]
  ds_read_b128 v[212:215], v253 offset:5120
  v_mul_f32 v170, v170, v58
  v_mfma_f32_16x16x32_bf16 v[196:199], v[148:151], v[228:231], v[196:199]
  s_waitcnt lgkmcnt(3)
  v_mul_f32 v174, v174, v58
  v_cvt_pk_bf16_f32 v20, v170, v174
  v_mfma_f32_16x16x32_bf16 v[184:187], v[128:131], v[200:203], v[184:187]
  ds_read_b128 v[216:219], v253 offset:6144
  v_mul_f32 v171, v171, v59
  v_mfma_f32_16x16x32_bf16 v[192:195], v[152:155], v[200:203], v[192:195]
  s_waitcnt lgkmcnt(3)
  v_mul_f32 v175, v175, v59
  v_cvt_pk_bf16_f32 v22, v171, v175
  v_mfma_f32_16x16x32_bf16 v[188:191], v[128:131], v[204:207], v[188:191]
  ds_read_b128 v[220:223], v253 offset:7168
  v_mul_f32 v176, v176, v60
  v_mfma_f32_16x16x32_bf16 v[196:199], v[152:155], v[204:207], v[196:199]
  s_waitcnt lgkmcnt(3)
  v_mul_f32 v180, v180, v60
  v_cvt_pk_bf16_f32 v24, v176, v180
  v_mfma_f32_16x16x32_bf16 v[184:187], v[132:135], v[208:211], v[184:187]
  ds_read_b128 v[224:227], v253 offset:8192
  v_mul_f32 v177, v177, v61
  v_mfma_f32_16x16x32_bf16 v[192:195], v[156:159], v[208:211], v[192:195]
  s_waitcnt lgkmcnt(3)
  v_mul_f32 v181, v181, v61
  v_cvt_pk_bf16_f32 v26, v177, v181
  v_mfma_f32_16x16x32_bf16 v[188:191], v[132:135], v[212:215], v[188:191]
  ds_read_b128 v[228:231], v253 offset:9216
  v_mul_f32 v178, v178, v62
  v_mfma_f32_16x16x32_bf16 v[196:199], v[156:159], v[212:215], v[196:199]
  s_waitcnt lgkmcnt(3)
  v_mul_f32 v182, v182, v62
  v_cvt_pk_bf16_f32 v28, v178, v182
  v_mfma_f32_16x16x32_bf16 v[184:187], v[136:139], v[216:219], v[184:187]
  ds_read_b128 v[200:203], v252 offset:0
  v_mul_f32 v179, v179, v63
  v_mfma_f32_16x16x32_bf16 v[192:195], v[160:163], v[216:219], v[192:195]
  s_waitcnt lgkmcnt(3)
  v_mul_f32 v183, v183, v63
  v_cvt_pk_bf16_f32 v30, v179, v183
  v_mfma_f32_16x16x32_bf16 v[188:191], v[136:139], v[220:223], v[188:191]
  ds_read_b128 v[204:207], v252 offset:1024
  v_mfma_f32_16x16x32_bf16 v[196:199], v[160:163], v[220:223], v[196:199]
  s_waitcnt lgkmcnt(3)
  v_mfma_f32_16x16x32_bf16 v[184:187], v[140:143], v[224:227], v[184:187]
  ds_read_b128 v[208:211], v252 offset:2048
  v_mfma_f32_16x16x32_bf16 v[192:195], v[164:167], v[224:227], v[192:195]
  s_waitcnt lgkmcnt(3)
  v_mfma_f32_16x16x32_bf16 v[188:191], v[140:143], v[228:231], v[188:191]
  ds_read_b128 v[212:215], v252 offset:3072
  v_mfma_f32_16x16x32_bf16 v[196:199], v[164:167], v[228:231], v[196:199]
  s_waitcnt lgkmcnt(3)
  v_mfma_f32_16x16x32_bf16 v[168:171], v[120:123], v[200:203], 0
  ds_read_b128 v[216:219], v252 offset:4096
  v_mfma_f32_16x16x32_bf16 v[176:179], v[144:147], v[200:203], 0
  s_waitcnt lgkmcnt(3)
  v_mfma_f32_16x16x32_bf16 v[172:175], v[120:123], v[204:207], 0
  ds_read_b128 v[220:223], v252 offset:5120
  v_mul_f32 v184, v184, v56
  v_mfma_f32_16x16x32_bf16 v[180:183], v[144:147], v[204:207], 0
  s_waitcnt lgkmcnt(3)
  v_mul_f32 v188, v188, v56
  v_cvt_pk_bf16_f32 v17, v184, v188
  v_mfma_f32_16x16x32_bf16 v[168:171], v[124:127], v[208:211], v[168:171]
  ds_read_b128 v[224:227], v252 offset:6144
  v_mul_f32 v185, v185, v57
  v_mfma_f32_16x16x32_bf16 v[176:179], v[148:151], v[208:211], v[176:179]
  s_waitcnt lgkmcnt(3)
  buffer_store_dwordx2 v[16:17], v4, s[20:23], 0 offen offset:0 sc1
  v_mul_f32 v189, v189, v57
  v_mfma_f32_16x16x32_bf16 v[172:175], v[124:127], v[212:215], v[172:175]
  ds_read_b128 v[228:231], v252 offset:7168
  v_cvt_pk_bf16_f32 v19, v185, v189
  v_mfma_f32_16x16x32_bf16 v[180:183], v[148:151], v[212:215], v[180:183]
  s_waitcnt lgkmcnt(3)
  v_mul_f32 v186, v186, v58
  v_mul_f32 v190, v190, v58
  v_mfma_f32_16x16x32_bf16 v[168:171], v[128:131], v[216:219], v[168:171]
  ds_read_b128 v[200:203], v252 offset:8192
  v_cvt_pk_bf16_f32 v21, v186, v190
  v_mfma_f32_16x16x32_bf16 v[176:179], v[152:155], v[216:219], v[176:179]
  s_waitcnt lgkmcnt(3)
  buffer_store_dwordx2 v[18:19], v5, s[20:23], 0 offen offset:0 sc1
  v_mul_f32 v187, v187, v59
  v_mfma_f32_16x16x32_bf16 v[172:175], v[128:131], v[220:223], v[172:175]
  ds_read_b128 v[204:207], v252 offset:9216
  v_mul_f32 v191, v191, v59
  v_mfma_f32_16x16x32_bf16 v[180:183], v[152:155], v[220:223], v[180:183]
  s_waitcnt lgkmcnt(3)
  v_cvt_pk_bf16_f32 v23, v187, v191
  v_mul_f32 v192, v192, v60
  v_mfma_f32_16x16x32_bf16 v[168:171], v[132:135], v[224:227], v[168:171]
  ds_read_b128 v[208:211], v252 offset:10240
  v_mul_f32 v196, v196, v60
  v_mfma_f32_16x16x32_bf16 v[176:179], v[156:159], v[224:227], v[176:179]
  s_waitcnt lgkmcnt(3)
  buffer_store_dwordx2 v[20:21], v6, s[20:23], 0 offen offset:0 sc1
  v_cvt_pk_bf16_f32 v25, v192, v196
  v_mfma_f32_16x16x32_bf16 v[172:175], v[132:135], v[228:231], v[172:175]
  ds_read_b128 v[212:215], v252 offset:11264
  v_mul_f32 v193, v193, v61
  v_mfma_f32_16x16x32_bf16 v[180:183], v[156:159], v[228:231], v[180:183]
  s_waitcnt lgkmcnt(3)
  v_mul_f32 v197, v197, v61
  v_cvt_pk_bf16_f32 v27, v193, v197
  v_mfma_f32_16x16x32_bf16 v[168:171], v[136:139], v[200:203], v[168:171]
  ds_read_b128 v[216:219], v252 offset:12288
  v_mul_f32 v194, v194, v62
  v_mfma_f32_16x16x32_bf16 v[176:179], v[160:163], v[200:203], v[176:179]
  s_waitcnt lgkmcnt(3)
  buffer_store_dwordx2 v[22:23], v7, s[20:23], 0 offen offset:0 sc1
  v_mul_f32 v198, v198, v62
  v_mfma_f32_16x16x32_bf16 v[172:175], v[136:139], v[204:207], v[172:175]
  ds_read_b128 v[220:223], v252 offset:13312
  v_cvt_pk_bf16_f32 v29, v194, v198
  v_mfma_f32_16x16x32_bf16 v[180:183], v[160:163], v[204:207], v[180:183]
  s_waitcnt lgkmcnt(3)
  v_mul_f32 v195, v195, v63
  v_mul_f32 v199, v199, v63
  v_mfma_f32_16x16x32_bf16 v[168:171], v[140:143], v[208:211], v[168:171]
  ds_read_b128 v[224:227], v252 offset:14336
  v_cvt_pk_bf16_f32 v31, v195, v199
  v_mfma_f32_16x16x32_bf16 v[176:179], v[164:167], v[208:211], v[176:179]
  buffer_store_dwordx2 v[24:25], v8, s[20:23], 0 offen offset:0 sc1
  s_cmp_lt_u32 s40, 4
  s_cbranch_scc1 M_e4
  s_waitcnt vmcnt(5)
  s_barrier
M_e4:
  s_waitcnt lgkmcnt(3)
  v_mfma_f32_16x16x32_bf16 v[172:175], v[140:143], v[212:215], v[172:175]
  ds_read_b128 v[228:231], v252 offset:15360
  v_mfma_f32_16x16x32_bf16 v[180:183], v[164:167], v[212:215], v[180:183]
  s_waitcnt lgkmcnt(3)
  v_mfma_f32_16x16x32_bf16 v[184:187], v[120:123], v[216:219], 0
  ds_read_b128 v[200:203], v252 offset:16384
  v_mfma_f32_16x16x32_bf16 v[192:195], v[144:147], v[216:219], 0
  s_waitcnt lgkmcnt(3)
  buffer_store_dwordx2 v[26:27], v9, s[20:23], 0 offen offset:0 sc1
  v_mfma_f32_16x16x32_bf16 v[188:191], v[120:123], v[220:223], 0
  ds_read_b128 v[204:207], v252 offset:17408
  v_mul_f32 v168, v168, v56
  v_mfma_f32_16x16x32_bf16 v[196:199], v[144:147], v[220:223], 0
  s_waitcnt lgkmcnt(3)
  v_mul_f32 v172, v172, v56
  v_cvt_pk_bf16_f32 v16, v168, v172
  v_mfma_f32_16x16x32_bf16 v[184:187], v[124:127], v[224:227], v[184:187]
  ds_read_b128 v[208:211], v252 offset:18432
  v_mul_f32 v169, v169, v57
  v_mfma_f32_16x16x32_bf16 v[192:195], v[148:151], v[224:227], v[192:195]
  s_waitcnt lgkmcnt(3)
  buffer_store_dwordx2 v[28:29], v10, s[20:23], 0 offen offset:0 sc1
  v_mul_f32 v173, v173, v57
  v_mfma_f32_16x16x32_bf16 v[188:191], v[124:127], v[228:231], v[188:191]
  ds_read_b128 v[212:215], v252 offset:19456
  v_cvt_pk_bf16_f32 v18, v169, v173
  v_mfma_f32_16x16x32_bf16 v[196:199], v[148:151], v[228:231], v[196:199]
  s_waitcnt lgkmcnt(3)
  v_mul_f32 v170, v170, v58
  v_mul_f32 v174, v174, v58
  v_mfma_f32_16x16x32_bf16 v[184:187], v[128:131], v[200:203], v[184:187]
  ds_read_b128 v[216:219], v252 offset:20480
  v_cvt_pk_bf16_f32 v20, v170, v174
  v_mfma_f32_16x16x32_bf16 v[192:195], v[152:155], v[200:203], v[192:195]
  s_waitcnt lgkmcnt(3)
  buffer_store_dwordx2 v[30:31], v11, s[20:23], 0 offen offset:0 sc1
  v_mul_f32 v171, v171, v59
  v_mfma_f32_16x16x32_bf16 v[188:191], v[128:131], v[204:207], v[188:191]
  ds_read_b128 v[220:223], v252 offset:21504
  v_mul_f32 v175, v175, v59
  v_mfma_f32_16x16x32_bf16 v[196:199], v[152:155], v[204:207], v[196:199]
  s_waitcnt lgkmcnt(3)
  v_cvt_pk_bf16_f32 v22, v171, v175
  v_mul_f32 v176, v176, v60
  v_mfma_f32_16x16x32_bf16 v[184:187], v[132:135], v[208:211], v[184:187]
  ds_read_b128 v[224:227], v252 offset:22528
  v_mul_f32 v180, v180, v60
  v_mfma_f32_16x16x32_bf16 v[192:195], v[156:159], v[208:211], v[192:195]
  s_waitcnt lgkmcnt(3)
  v_cvt_pk_bf16_f32 v24, v176, v180
  v_mul_f32 v177, v177, v61
  v_mfma_f32_16x16x32_bf16 v[188:191], v[132:135], v[212:215], v[188:191]
  ds_read_b128 v[228:231], v252 offset:23552
  v_mul_f32 v181, v181, v61
  v_mfma_f32_16x16x32_bf16 v[196:199], v[156:159], v[212:215], v[196:199]
  s_waitcnt lgkmcnt(3)
  v_cvt_pk_bf16_f32 v26, v177, v181
  v_mul_f32 v178, v178, v62
  v_mfma_f32_16x16x32_bf16 v[184:187], v[136:139], v[216:219], v[184:187]
  ds_read_b128 v[200:203], v252 offset:24576
  v_mul_f32 v182, v182, v62
  v_mfma_f32_16x16x32_bf16 v[192:195], v[160:163], v[216:219], v[192:195]
  s_waitcnt lgkmcnt(3)
  v_cvt_pk_bf16_f32 v28, v178, v182
  v_mul_f32 v179, v179, v63
  v_mfma_f32_16x16x32_bf16 v[188:191], v[136:139], v[220:223], v[188:191]
  ds_read_b128 v[204:207], v252 offset:25600
  v_mul_f32 v183, v183, v63
  v_mfma_f32_16x16x32_bf16 v[196:199], v[160:163], v[220:223], v[196:199]
  s_waitcnt lgkmcnt(3)
  v_cvt_pk_bf16_f32 v30, v179, v183
  v_mfma_f32_16x16x32_bf16 v[184:187], v[140:143], v[224:227], v[184:187]
  ds_read_b128 v[208:211], v252 offset:26624
  v_mfma_f32_16x16x32_bf16 v[192:195], v[164:167], v[224:227], v[192:195]
  s_waitcnt lgkmcnt(3)
  v_mfma_f32_16x16x32_bf16 v[188:191], v[140:143], v[228:231], v[188:191]
  ds_read_b128 v[212:215], v252 offset:27648
  v_mfma_f32_16x16x32_bf16 v[196:199], v[164:167], v[228:231], v[196:199]
  s_waitcnt lgkmcnt(3)
  v_mfma_f32_16x16x32_bf16 v[168:171], v[120:123], v[200:203], 0
  ds_read_b128 v[216:219], v252 offset:28672
  v_mfma_f32_16x16x32_bf16 v[176:179], v[144:147], v[200:203], 0
  s_waitcnt lgkmcnt(3)
  v_mfma_f32_16x16x32_bf16 v[172:175], v[120:123], v[204:207], 0
  ds_read_b128 v[220:223], v252 offset:29696
  v_mul_f32 v184, v184, v56
  v_mfma_f32_16x16x32_bf16 v[180:183], v[144:147], v[204:207], 0
  s_waitcnt lgkmcnt(3)
  v_mul_f32 v188, v188, v56
  v_cvt_pk_bf16_f32 v17, v184, v188
  v_mfma_f32_16x16x32_bf16 v[168:171], v[124:127], v[208:211], v[168:171]
  ds_read_b128 v[224:227], v252 offset:30720
  v_mul_f32 v185, v185, v57
  v_mfma_f32_16x16x32_bf16 v[176:179], v[148:151], v[208:211], v[176:179]
  s_waitcnt lgkmcnt(3)
  buffer_store_dwordx2 v[16:17], v4, s[20:23], 0 offen offset:128 sc1
  v_mul_f32 v189, v189, v57
  v_mfma_f32_16x16x32_bf16 v[172:175], v[124:127], v[212:215], v[172:175]
  ds_read_b128 v[228:231], v252 offset:31744
  v_cvt_pk_bf16_f32 v19, v185, v189
  v_mfma_f32_16x16x32_bf16 v[180:183], v[148:151], v[212:215], v[180:183]
  s_waitcnt lgkmcnt(3)
  v_mul_f32 v186, v186, v58
  v_mul_f32 v190, v190, v58
  v_mfma_f32_16x16x32_bf16 v[168:171], v[128:131], v[216:219], v[168:171]
  ds_read_b128 v[200:203], v252 offset:32768
  v_cvt_pk_bf16_f32 v21, v186, v190
  v_mfma_f32_16x16x32_bf16 v[176:179], v[152:155], v[216:219], v[176:179]
  s_waitcnt lgkmcnt(3)
  buffer_store_dwordx2 v[18:19], v5, s[20:23], 0 offen offset:128 sc1
  v_mul_f32 v187, v187, v59
  v_mfma_f32_16x16x32_bf16 v[172:175], v[128:131], v[220:223], v[172:175]
  ds_read_b128 v[204:207], v252 offset:33792
  v_mul_f32 v191, v191, v59
  v_mfma_f32_16x16x32_bf16 v[180:183], v[152:155], v[220:223], v[180:183]
  s_waitcnt lgkmcnt(3)
  v_cvt_pk_bf16_f32 v23, v187, v191
  v_mul_f32 v192, v192, v60
  v_mfma_f32_16x16x32_bf16 v[168:171], v[132:135], v[224:227], v[168:171]
  ds_read_b128 v[208:211], v252 offset:34816
  v_mul_f32 v196, v196, v60
  v_mfma_f32_16x16x32_bf16 v[176:179], v[156:159], v[224:227], v[176:179]
  s_waitcnt lgkmcnt(3)
  buffer_store_dwordx2 v[20:21], v6, s[20:23], 0 offen offset:128 sc1
  v_cvt_pk_bf16_f32 v25, v192, v196
  v_mfma_f32_16x16x32_bf16 v[172:175], v[132:135], v[228:231], v[172:175]
  ds_read_b128 v[212:215], v252 offset:35840
  v_mul_f32 v193, v193, v61
  v_mfma_f32_16x16x32_bf16 v[180:183], v[156:159], v[228:231], v[180:183]
  s_waitcnt lgkmcnt(3)
  v_mul_f32 v197, v197, v61
  v_cvt_pk_bf16_f32 v27, v193, v197
  v_mfma_f32_16x16x32_bf16 v[168:171], v[136:139], v[200:203], v[168:171]
  ds_read_b128 v[64:67], v252 offset:36864
  v_mul_f32 v194, v194, v62
  v_mfma_f32_16x16x32_bf16 v[176:179], v[160:163], v[200:203], v[176:179]
  s_waitcnt lgkmcnt(3)
  ds_read_b128 v[68:71], v252 offset:37888
  v_mul_f32 v198, v198, v62
  v_mfma_f32_16x16x32_bf16 v[172:175], v[136:139], v[204:207], v[172:175]
  ds_read_b128 v[72:75], v252 offset:38912
  v_cvt_pk_bf16_f32 v29, v194, v198
  v_mfma_f32_16x16x32_bf16 v[180:183], v[160:163], v[204:207], v[180:183]
  s_waitcnt lgkmcnt(4)
  ds_read_b128 v[76:79], v252 offset:39936
  v_mul_f32 v195, v195, v63
  v_mfma_f32_16x16x32_bf16 v[168:171], v[140:143], v[208:211], v[168:171]
  ds_read_b128 v[80:83], v252 offset:40960
  v_mul_f32 v199, v199, v63
  v_mfma_f32_16x16x32_bf16 v[176:179], v[164:167], v[208:211], v[176:179]
  s_waitcnt lgkmcnt(5)
  ds_read_b128 v[84:87], v252 offset:41984
  v_cvt_pk_bf16_f32 v31, v195, v199
  v_mfma_f32_16x16x32_bf16 v[172:175], v[140:143], v[212:215], v[172:175]
  ds_read_b128 v[88:91], v252 offset:43008
  v_mfma_f32_16x16x32_bf16 v[180:183], v[164:167], v[212:215], v[180:183]
  s_waitcnt lgkmcnt(6)
  ds_read_b128 v[92:95], v252 offset:44032
  v_mfma_f32_16x16x32_bf16 v[184:187], v[120:123], v[64:67], 0
  s_waitcnt lgkmcnt(6)
  ds_read_b128 v[96:99], v252 offset:45056
  v_mfma_f32_16x16x32_bf16 v[188:191], v[120:123], v[68:71], 0
  s_waitcnt lgkmcnt(6)
  ds_read_b128 v[100:103], v252 offset:46080
  v_mfma_f32_16x16x32_bf16 v[184:187], v[124:127], v[72:75], v[184:187]
  s_waitcnt lgkmcnt(6)
  ds_read_b128 v[104:107], v252 offset:47104
  v_mul_f32 v168, v168, v56
  v_mfma_f32_16x16x32_bf16 v[188:191], v[124:127], v[76:79], v[188:191]
  s_waitcnt lgkmcnt(6)
  ds_read_b128 v[108:111], v252 offset:48128
  v_mul_f32 v172, v172, v56
  v_mfma_f32_16x16x32_bf16 v[184:187], v[128:131], v[80:83], v[184:187]
  s_waitcnt lgkmcnt(6)
  buffer_store_dwordx2 v[22:23], v7, s[20:23], 0 offen offset:128 sc1
  v_cvt_pk_bf16_f32 v16, v168, v172
  v_mfma_f32_16x16x32_bf16 v[188:191], v[128:131], v[84:87], v[188:191]
  s_waitcnt lgkmcnt(5)
  buffer_store_dwordx2 v[24:25], v8, s[20:23], 0 offen offset:128 sc1
  v_mul_f32 v169, v169, v57
  v_mfma_f32_16x16x32_bf16 v[184:187], v[132:135], v[88:91], v[184:187]
  s_waitcnt lgkmcnt(4)
  buffer_store_dwordx2 v[26:27], v9, s[20:23], 0 offen offset:128 sc1
  v_mul_f32 v173, v173, v57
  v_mfma_f32_16x16x32_bf16 v[188:191], v[132:135], v[92:95], v[188:191]
  s_waitcnt lgkmcnt(3)
  buffer_store_dwordx2 v[28:29], v10, s[20:23], 0 offen offset:128 sc1
  v_cvt_pk_bf16_f32 v18, v169, v173
  v_mfma_f32_16x16x32_bf16 v[184:187], v[136:139], v[96:99], v[184:187]
  s_waitcnt lgkmcnt(2)
  v_mul_f32 v170, v170, v58
  v_mul_f32 v174, v174, v58
  v_mfma_f32_16x16x32_bf16 v[188:191], v[136:139], v[100:103], v[188:191]
  s_waitcnt lgkmcnt(1)
  buffer_store_dwordx2 v[30:31], v11, s[20:23], 0 offen offset:128 sc1
  v_cvt_pk_bf16_f32 v20, v170, v174
  v_mfma_f32_16x16x32_bf16 v[184:187], v[140:143], v[104:107], v[184:187]
  s_waitcnt lgkmcnt(0)
  v_mul_f32 v171, v171, v59
  v_mul_f32 v175, v175, v59
  v_mfma_f32_16x16x32_bf16 v[188:191], v[140:143], v[108:111], v[188:191]
  v_cvt_pk_bf16_f32 v22, v171, v175
  v_mul_f32 v176, v176, v60
  v_mfma_f32_16x16x32_bf16 v[192:195], v[144:147], v[64:67], 0
  v_mul_f32 v180, v180, v60
  v_cvt_pk_bf16_f32 v24, v176, v180
  v_mfma_f32_16x16x32_bf16 v[196:199], v[144:147], v[68:71], 0
  v_mul_f32 v177, v177, v61
  v_mul_f32 v181, v181, v61
  v_mfma_f32_16x16x32_bf16 v[192:195], v[148:151], v[72:75], v[192:195]
  v_cvt_pk_bf16_f32 v26, v177, v181
  v_mul_f32 v178, v178, v62
  v_mfma_f32_16x16x32_bf16 v[196:199], v[148:151], v[76:79], v[196:199]
  v_mul_f32 v182, v182, v62
  v_cvt_pk_bf16_f32 v28, v178, v182
  v_mfma_f32_16x16x32_bf16 v[192:195], v[152:155], v[80:83], v[192:195]
  v_mul_f32 v179, v179, v63
  v_mul_f32 v183, v183, v63
  v_mfma_f32_16x16x32_bf16 v[196:199], v[152:155], v[84:87], v[196:199]
  v_cvt_pk_bf16_f32 v30, v179, v183
  v_mul_f32 v184, v184, v56
  v_mfma_f32_16x16x32_bf16 v[192:195], v[156:159], v[88:91], v[192:195]
  v_mul_f32 v188, v188, v56
  v_cvt_pk_bf16_f32 v17, v184, v188
  v_mfma_f32_16x16x32_bf16 v[196:199], v[156:159], v[92:95], v[196:199]
  buffer_store_dwordx2 v[16:17], v4, s[20:23], 0 offen offset:256 sc1
  v_mul_f32 v185, v185, v57
  v_mfma_f32_16x16x32_bf16 v[192:195], v[160:163], v[96:99], v[192:195]
  v_mul_f32 v189, v189, v57
  v_cvt_pk_bf16_f32 v19, v185, v189
  v_mfma_f32_16x16x32_bf16 v[196:199], v[160:163], v[100:103], v[196:199]
  buffer_store_dwordx2 v[18:19], v5, s[20:23], 0 offen offset:256 sc1
  v_mul_f32 v186, v186, v58
  v_mfma_f32_16x16x32_bf16 v[192:195], v[164:167], v[104:107], v[192:195]
  v_mul_f32 v190, v190, v58
  v_cvt_pk_bf16_f32 v21, v186, v190
  v_mfma_f32_16x16x32_bf16 v[196:199], v[164:167], v[108:111], v[196:199]
  buffer_store_dwordx2 v[20:21], v6, s[20:23], 0 offen offset:256 sc1
  v_mul_f32 v187, v187, v59
  v_mul_f32 v191, v191, v59
  v_cvt_pk_bf16_f32 v23, v187, v191
  buffer_store_dwordx2 v[22:23], v7, s[20:23], 0 offen offset:256 sc1
  v_mul_f32 v192, v192, v60
  s_nop 1
  v_mul_f32 v196, v196, v60
  v_cvt_pk_bf16_f32 v25, v192, v196
  buffer_store_dwordx2 v[24:25], v8, s[20:23], 0 offen offset:256 sc1
  v_mul_f32 v193, v193, v61
  v_mul_f32 v197, v197, v61
  v_cvt_pk_bf16_f32 v27, v193, v197
  buffer_store_dwordx2 v[26:27], v9, s[20:23], 0 offen offset:256 sc1
  v_mul_f32 v194, v194, v62
  v_mul_f32 v198, v198, v62
  v_cvt_pk_bf16_f32 v29, v194, v198
  buffer_store_dwordx2 v[28:29], v10, s[20:23], 0 offen offset:256 sc1
  v_mul_f32 v195, v195, v63
  v_mul_f32 v199, v199, v63
  v_cvt_pk_bf16_f32 v31, v195, v199
  buffer_store_dwordx2 v[30:31], v11, s[20:23], 0 offen offset:256 sc1
  s_endpgm
M_helper:
H_join:
  s_and_b32 s55, s2, 7
  s_lshr_b32 s56, s2, 3
  s_lshr_b32 s41, s55, 2
  s_bfe_u32 s42, s55, 0x10001
  s_and_b32 s55, s55, 1
  s_lshl_b32 s55, s55, 2
  s_lshr_b32 s43, s56, 3
  s_add_u32 s43, s43, s55
  s_and_b32 s44, s56, 7
  s_mul_i32 s43, s43, 14
  s_mul_i32 s44, s44, 14
  s_mul_i32 s61, s41, 13
  s_add_i32 s61, s61, -6
  s_cmp_eq_u32 s42, 0
  s_cselect_b32 s62, 85632, 0
  s_cselect_b32 s50, -1, 1
  s_mulk_i32 s50, 384
  s_cmp_ge_u32 s40, 4
  s_cselect_b32 s53, -4, 3
  s_add_i32 s53, s53, s40
  s_lshl_b32 s53, s53, 1
  s_add_u32 s88, s43, s53
  s_mov_b32 s89, 86016
  s_mul_i32 s55, s41, 6
  s_add_i32 s45, s43, s55
  s_add_i32 s45, s45, -6
  s_cmp_eq_i32 s45, -6
  s_cselect_b32 s47, 6, 0
  s_cmp_eq_i32 s45, 98
  s_cselect_b32 s48, 7, 13
  s_cselect_b32 s49, 2, 0
  s_sub_i32 s45, s45, s49
  s_cmp_eq_i32 s44, 98
  s_cselect_b32 s51, 7, 13
  s_lshl_b32 s56, s44, 1
  s_add_i32 s56, s56, 1
  s_mul_i32 s46, s56, s50
  s_add_i32 s46, s46, s62
  s_lshl_b32 s91, s50, 1
  s_lshl_b32 s3, s91, 3
  s_add_i32 s91, s91, -384
  s_max_i32 s92, s53, s47
  s_min_i32 s92, s92, s48
  s_and_b32 s92, s92, -2
  s_add_u32 s52, s92, s49
  s_mov_b32 s54, 4286578688
  s_mov_b32 s63, 1037384597
  s_and_b32 s93, s40, 1
  s_lshl_b32 s93, s93, 3
  s_and_b32 s56, s40, 6
  s_or_b32 s93, s93, s56
  s_add_u32 s56, s40, 8
  s_add_i32 s100, s45, s56
  s_lshl_b32 s100, s100, 1
  s_add_i32 s100, s100, s41
  s_max_i32 s100, s100, 0
  s_min_i32 s100, s100, 223
  s_mul_i32 s100, s100, 86016
  s_mul_i32 s101, s56, 7680
  v_add_u32 v4, 0, v1
  v_xor_b32 v4, 0, v4
  v_mul_u32_u24 v5, 2731, v4
  v_lshrrev_b32 v5, 16, v5
  v_mul_i32_i24 v5, s91, v5
  v_lshl_add_u32 v4, v4, 4, v5
  v_add_u32 v232, s46, v4
  v_add_u32 v235, s3, v232
  v_add_u32 v238, s3, v235
  v_add_u32 v4, 64, v1
  v_xor_b32 v4, 0, v4
  v_mul_u32_u24 v5, 2731, v4
  v_lshrrev_b32 v5, 16, v5
  v_mul_i32_i24 v5, s91, v5
  v_lshl_add_u32 v4, v4, 4, v5
  v_add_u32 v233, s46, v4
  v_add_u32 v236, s3, v233
  v_add_u32 v4, 128, v1
  v_xor_b32 v4, 0, v4
  v_mul_u32_u24 v5, 2731, v4
  v_lshrrev_b32 v5, 16, v5
  v_mul_i32_i24 v5, s91, v5
  v_lshl_add_u32 v4, v4, 4, v5
  v_add_u32 v234, s46, v4
  v_add_u32 v237, s3, v234
  v_add_u32 v4, 416, v1
  v_xor_b32 v4, 0, v4
  v_mul_u32_u24 v5, 2731, v4
  v_lshrrev_b32 v5, 16, v5
  v_mul_i32_i24 v5, s91, v5
  v_lshl_add_u32 v4, v4, 4, v5
  v_add_u32 v239, s46, v4
  v_max_i32 v237, 0, v237
  v_max_i32 v238, 0, v238
  v_max_i32 v239, 0, v239
  v_add_u32 v4, 0, v1
  v_xor_b32 v4, 8, v4
  v_mul_u32_u24 v5, 2731, v4
  v_lshrrev_b32 v5, 16, v5
  v_mul_i32_i24 v5, s91, v5
  v_lshl_add_u32 v4, v4, 4, v5
  v_add_u32 v244, s46, v4
  v_add_u32 v247, s3, v244
  v_add_u32 v250, s3, v247
  v_add_u32 v4, 64, v1
  v_xor_b32 v4, 8, v4
  v_mul_u32_u24 v5, 2731, v4
  v_lshrrev_b32 v5, 16, v5
  v_mul_i32_i24 v5, s91, v5
  v_lshl_add_u32 v4, v4, 4, v5
  v_add_u32 v245, s46, v4
  v_add_u32 v248, s3, v245
  v_add_u32 v4, 128, v1
  v_xor_b32 v4, 8, v4
  v_mul_u32_u24 v5, 2731, v4
  v_lshrrev_b32 v5, 16, v5
  v_mul_i32_i24 v5, s91, v5
  v_lshl_add_u32 v4, v4, 4, v5
  v_add_u32 v246, s46, v4
  v_add_u32 v249, s3, v246
  v_add_u32 v4, 416, v1
  v_xor_b32 v4, 8, v4
  v_mul_u32_u24 v5, 2731, v4
  v_lshrrev_b32 v5, 16, v5
  v_mul_i32_i24 v5, s91, v5
  v_lshl_add_u32 v4, v4, 4, v5
  v_add_u32 v251, s46, v4
  v_max_i32 v249, 0, v249
  v_max_i32 v250, 0, v250
  v_max_i32 v251, 0, v251
  s_barrier
  v_mov_b32 v6, 0
  s_mov_b32 s59, 0
  s_mov_b64 exec, 1
H_pollM:
  buffer_load_dword v7, v6, s[36:39], 0 offen offset:128 sc1
  s_waitcnt vmcnt(0)
  v_cmp_eq_u32 vcc, 0, v7
  s_add_u32 s59, s59, 1
  s_cmp_gt_u32 s59, 200000
  s_cbranch_scc1 H_pollM_x
  s_cmp_lg_u64 vcc, 0
  s_cbranch_scc0 H_pollM_x
  s_sleep 2
  s_branch H_pollM
H_pollM_x:
  s_mov_b64 exec, -1
  s_lshr_b32 s55, s2, 3
  s_mul_i32 s55, s55, 2304
  s_add_u32 s55, s55, 131072
  buffer_load_dwordx4 v[80:83], v252, s[24:27], s55 offen offset:0 sc1
  buffer_load_dwordx4 v[84:87], v252, s[24:27], s55 offen offset:1024 sc1
  buffer_load_dwordx4 v[88:91], v252, s[24:27], s55 offen offset:2048 sc1
  s_barrier
  s_lshl_b32 s55, s40, 10
  s_add_u32 s55, s55, 131072
  s_sub_u32 m0, s55, 40960
  s_nop 0
  buffer_load_dwordx4 v252, s[24:27], s55 offen sc1 lds
  s_add_u32 s55, s55, 4096
  s_sub_u32 m0, s55, 40960
  s_nop 0
  buffer_load_dwordx4 v252, s[24:27], s55 offen sc1 lds
  s_add_u32 s55, s55, 4096
  s_sub_u32 m0, s55, 40960
  s_nop 0
  buffer_load_dwordx4 v252, s[24:27], s55 offen sc1 lds
  s_add_u32 s55, s55, 4096
  s_sub_u32 m0, s55, 40960
  s_nop 0
  buffer_load_dwordx4 v252, s[24:27], s55 offen sc1 lds
  s_add_u32 s55, s55, 4096
  s_sub_u32 m0, s55, 40960
  s_nop 0
  buffer_load_dwordx4 v252, s[24:27], s55 offen sc1 lds
  s_add_u32 s55, s55, 4096
  s_sub_u32 m0, s55, 40960
  s_nop 0
  buffer_load_dwordx4 v252, s[24:27], s55 offen sc1 lds
  s_add_u32 s55, s55, 4096
  s_sub_u32 m0, s55, 40960
  s_nop 0
  buffer_load_dwordx4 v252, s[24:27], s55 offen sc1 lds
  s_add_u32 s55, s55, 4096
  s_sub_u32 m0, s55, 40960
  s_nop 0
  buffer_load_dwordx4 v252, s[24:27], s55 offen sc1 lds
  s_add_u32 s55, s55, 4096
  s_sub_u32 m0, s55, 40960
  s_nop 0
  buffer_load_dwordx4 v252, s[24:27], s55 offen sc1 lds
  s_add_u32 s55, s55, 4096
  s_sub_u32 m0, s55, 40960
  s_nop 0
  buffer_load_dwordx4 v252, s[24:27], s55 offen sc1 lds
  s_add_u32 s55, s55, 4096
  s_sub_u32 m0, s55, 40960
  s_nop 0
  buffer_load_dwordx4 v252, s[24:27], s55 offen sc1 lds
  s_add_u32 s55, s55, 4096
  s_sub_u32 m0, s55, 40960
  s_nop 0
  buffer_load_dwordx4 v252, s[24:27], s55 offen sc1 lds
  s_waitcnt vmcnt(6)
  s_barrier
  s_lshl_b32 s55, s40, 10
  s_add_u32 s55, s55, 180224
  s_sub_u32 m0, s55, 40960
  s_nop 0
  buffer_load_dwordx4 v252, s[24:27], s55 offen sc1 lds
  s_add_u32 s55, s55, 4096
  s_sub_u32 m0, s55, 40960
  s_nop 0
  buffer_load_dwordx4 v252, s[24:27], s55 offen sc1 lds
  s_add_u32 s55, s55, 4096
  s_sub_u32 m0, s55, 40960
  s_nop 0
  buffer_load_dwordx4 v252, s[24:27], s55 offen sc1 lds
  s_add_u32 s55, s55, 4096
  s_sub_u32 m0, s55, 40960
  s_nop 0
  buffer_load_dwordx4 v252, s[24:27], s55 offen sc1 lds
  s_add_u32 s55, s55, 4096
  s_sub_u32 m0, s55, 40960
  s_nop 0
  buffer_load_dwordx4 v252, s[24:27], s55 offen sc1 lds
  s_add_u32 s55, s55, 4096
  s_sub_u32 m0, s55, 40960
  s_nop 0
  buffer_load_dwordx4 v252, s[24:27], s55 offen sc1 lds
  v_mov_b32 v192, 1
  v_mov_b32 v193, 0
  s_waitcnt vmcnt(0)
  s_sub_u32 s58, s2, 36
  s_cmp_ge_u32 s58, 144
  s_cbranch_scc1 H_nov2
  v_mov_b32 v192, 1
  v_mov_b32 v193, 0
  s_mov_b64 exec, 1
  s_waitcnt vmcnt(0)
  buffer_atomic_add v192, v193, s[36:39], 0 offen offset:4 sc0 sc1
  s_mov_b64 exec, -1
H_nov2:
  s_add_i32 s56, s45, 0
  s_lshl_b32 s56, s56, 1
  s_add_i32 s56, s56, s41
  s_max_i32 s56, s56, 0
  s_min_i32 s56, s56, 223
  s_mul_i32 s56, s56, 86016
  s_mov_b32 m0, 0
  s_nop 0
  buffer_load_dwordx4 v232, s[16:19], s56 offen lds
  s_mov_b32 m0, 1024
  s_nop 0
  buffer_load_dwordx4 v233, s[16:19], s56 offen lds
  s_mov_b32 m0, 2048
  s_nop 0
  buffer_load_dwordx4 v234, s[16:19], s56 offen lds
  s_mov_b32 m0, 3072
  s_nop 0
  buffer_load_dwordx4 v235, s[16:19], s56 offen lds
  s_mov_b32 m0, 4096
  s_nop 0
  buffer_load_dwordx4 v236, s[16:19], s56 offen lds
  s_mov_b32 m0, 5120
  s_nop 0
  buffer_load_dwordx4 v237, s[16:19], s56 offen lds
  s_mov_b32 m0, 6144
  s_nop 0
  buffer_load_dwordx4 v238, s[16:19], s56 offen lds
  s_mov_b32 m0, 6656
  s_nop 0
  buffer_load_dwordx4 v239, s[16:19], s56 offen lds
  s_add_i32 s56, s45, 8
  s_lshl_b32 s56, s56, 1
  s_add_i32 s56, s56, s41
  s_max_i32 s56, s56, 0
  s_min_i32 s56, s56, 223
  s_mul_i32 s56, s56, 86016
  s_mov_b32 m0, 61440
  s_nop 0
  buffer_load_dwordx4 v232, s[16:19], s56 offen lds
  s_mov_b32 m0, 62464
  s_nop 0
  buffer_load_dwordx4 v233, s[16:19], s56 offen lds
  s_mov_b32 m0, 63488
  s_nop 0
  buffer_load_dwordx4 v234, s[16:19], s56 offen lds
  s_mov_b32 m0, 64512
  s_nop 0
  buffer_load_dwordx4 v235, s[16:19], s56 offen lds
  s_mov_b32 m0, 65536
  s_nop 0
  buffer_load_dwordx4 v236, s[16:19], s56 offen lds
  s_mov_b32 m0, 66560
  s_nop 0
  buffer_load_dwordx4 v237, s[16:19], s56 offen lds
  s_mov_b32 m0, 67584
  s_nop 0
  buffer_load_dwordx4 v238, s[16:19], s56 offen lds
  s_mov_b32 m0, 68096
  s_nop 0
  buffer_load_dwordx4 v239, s[16:19], s56 offen lds
  s_barrier
  s_add_i32 s56, s45, 9
  s_lshl_b32 s56, s56, 1
  s_add_i32 s56, s56, s41
  s_max_i32 s56, s56, 0
  s_min_i32 s56, s56, 223
  s_mul_i32 s56, s56, 86016
  s_mov_b32 m0, 69120
  s_nop 0
  buffer_load_dwordx4 v244, s[16:19], s56 offen lds
  s_mov_b32 m0, 70144
  s_nop 0
  buffer_load_dwordx4 v245, s[16:19], s56 offen lds
  s_mov_b32 m0, 71168
  s_nop 0
  buffer_load_dwordx4 v246, s[16:19], s56 offen lds
  s_mov_b32 m0, 72192
  s_nop 0
  buffer_load_dwordx4 v247, s[16:19], s56 offen lds
  s_mov_b32 m0, 73216
  s_nop 0
  buffer_load_dwordx4 v248, s[16:19], s56 offen lds
  s_mov_b32 m0, 74240
  s_nop 0
  buffer_load_dwordx4 v249, s[16:19], s56 offen lds
  s_mov_b32 m0, 75264
  s_nop 0
  buffer_load_dwordx4 v250, s[16:19], s56 offen lds
  s_mov_b32 m0, 75776
  s_nop 0
  buffer_load_dwordx4 v251, s[16:19], s56 offen lds
  s_add_i32 s56, s45, 10
  s_lshl_b32 s56, s56, 1
  s_add_i32 s56, s56, s41
  s_max_i32 s56, s56, 0
  s_min_i32 s56, s56, 223
  s_mul_i32 s56, s56, 86016
  v_xor_b32 v64, 32, v232
  s_mov_b32 m0, 76800
  s_nop 0
  buffer_load_dwordx4 v64, s[16:19], s56 offen lds
  v_xor_b32 v65, 32, v233
  s_mov_b32 m0, 77824
  s_nop 0
  buffer_load_dwordx4 v65, s[16:19], s56 offen lds
  v_xor_b32 v66, 32, v234
  s_mov_b32 m0, 78848
  s_nop 0
  buffer_load_dwordx4 v66, s[16:19], s56 offen lds
  v_xor_b32 v67, 32, v235
  s_mov_b32 m0, 79872
  s_nop 0
  buffer_load_dwordx4 v67, s[16:19], s56 offen lds
  v_xor_b32 v68, 32, v236
  s_mov_b32 m0, 80896
  s_nop 0
  buffer_load_dwordx4 v68, s[16:19], s56 offen lds
  v_xor_b32 v69, 32, v237
  s_mov_b32 m0, 81920
  s_nop 0
  buffer_load_dwordx4 v69, s[16:19], s56 offen lds
  v_xor_b32 v70, 32, v238
  s_mov_b32 m0, 82944
  s_nop 0
  buffer_load_dwordx4 v70, s[16:19], s56 offen lds
  v_xor_b32 v71, 32, v239
  s_mov_b32 m0, 83456
  s_nop 0
  buffer_load_dwordx4 v71, s[16:19], s56 offen lds
  s_barrier
  s_add_i32 s56, s45, 11
  s_lshl_b32 s56, s56, 1
  s_add_i32 s56, s56, s41
  s_max_i32 s56, s56, 0
  s_min_i32 s56, s56, 223
  s_mul_i32 s56, s56, 86016
  v_xor_b32 v64, 32, v244
  s_mov_b32 m0, 84480
  s_nop 0
  buffer_load_dwordx4 v64, s[16:19], s56 offen lds
  v_xor_b32 v65, 32, v245
  s_mov_b32 m0, 85504
  s_nop 0
  buffer_load_dwordx4 v65, s[16:19], s56 offen lds
  v_xor_b32 v66, 32, v246
  s_mov_b32 m0, 86528
  s_nop 0
  buffer_load_dwordx4 v66, s[16:19], s56 offen lds
  v_xor_b32 v67, 32, v247
  s_mov_b32 m0, 87552
  s_nop 0
  buffer_load_dwordx4 v67, s[16:19], s56 offen lds
  v_xor_b32 v68, 32, v248
  s_mov_b32 m0, 88576
  s_nop 0
  buffer_load_dwordx4 v68, s[16:19], s56 offen lds
  v_xor_b32 v69, 32, v249
  s_mov_b32 m0, 89600
  s_nop 0
  buffer_load_dwordx4 v69, s[16:19], s56 offen lds
  v_xor_b32 v70, 32, v250
  s_mov_b32 m0, 90624
  s_nop 0
  buffer_load_dwordx4 v70, s[16:19], s56 offen lds
  v_xor_b32 v71, 32, v251
  s_mov_b32 m0, 91136
  s_nop 0
  buffer_load_dwordx4 v71, s[16:19], s56 offen lds
  s_add_i32 s56, s45, 12
  s_lshl_b32 s56, s56, 1
  s_add_i32 s56, s56, s41
  s_max_i32 s56, s56, 0
  s_min_i32 s56, s56, 223
  s_mul_i32 s56, s56, 86016
  v_xor_b32 v64, 64, v232
  s_mov_b32 m0, 92160
  s_nop 0
  buffer_load_dwordx4 v64, s[16:19], s56 offen lds
  v_xor_b32 v65, 64, v233
  s_mov_b32 m0, 93184
  s_nop 0
  buffer_load_dwordx4 v65, s[16:19], s56 offen lds
  v_xor_b32 v66, 64, v234
  s_mov_b32 m0, 94208
  s_nop 0
  buffer_load_dwordx4 v66, s[16:19], s56 offen lds
  v_xor_b32 v67, 64, v235
  s_mov_b32 m0, 95232
  s_nop 0
  buffer_load_dwordx4 v67, s[16:19], s56 offen lds
  v_xor_b32 v68, 64, v236
  s_mov_b32 m0, 96256
  s_nop 0
  buffer_load_dwordx4 v68, s[16:19], s56 offen lds
  v_xor_b32 v69, 64, v237
  s_mov_b32 m0, 97280
  s_nop 0
  buffer_load_dwordx4 v69, s[16:19], s56 offen lds
  v_xor_b32 v70, 64, v238
  s_mov_b32 m0, 98304
  s_nop 0
  buffer_load_dwordx4 v70, s[16:19], s56 offen lds
  v_xor_b32 v71, 64, v239
  s_mov_b32 m0, 98816
  s_nop 0
  buffer_load_dwordx4 v71, s[16:19], s56 offen lds
  s_waitcnt vmcnt(16)
  v_readfirstlane_b32 s56, v192
  s_nop 0
  s_cmp_lg_u32 s56, 143
  s_cbranch_scc1 H_p2
  s_mov_b64 exec, 1
  buffer_store_dword v192, v193, s[36:39], 0 offen offset:132 sc1
  s_mov_b64 exec, -1
H_p2:
  s_add_i32 s56, s45, 13
  s_lshl_b32 s56, s56, 1
  s_add_i32 s56, s56, s41
  s_max_i32 s56, s56, 0
  s_min_i32 s56, s56, 223
  s_mul_i32 s56, s56, 86016
  v_xor_b32 v64, 64, v244
  s_mov_b32 m0, 99840
  s_nop 0
  buffer_load_dwordx4 v64, s[16:19], s56 offen lds
  v_xor_b32 v65, 64, v245
  s_mov_b32 m0, 100864
  s_nop 0
  buffer_load_dwordx4 v65, s[16:19], s56 offen lds
  v_xor_b32 v66, 64, v246
  s_mov_b32 m0, 101888
  s_nop 0
  buffer_load_dwordx4 v66, s[16:19], s56 offen lds
  v_xor_b32 v67, 64, v247
  s_mov_b32 m0, 102912
  s_nop 0
  buffer_load_dwordx4 v67, s[16:19], s56 offen lds
  v_xor_b32 v68, 64, v248
  s_mov_b32 m0, 103936
  s_nop 0
  buffer_load_dwordx4 v68, s[16:19], s56 offen lds
  v_xor_b32 v69, 64, v249
  s_mov_b32 m0, 104960
  s_nop 0
  buffer_load_dwordx4 v69, s[16:19], s56 offen lds
  v_xor_b32 v70, 64, v250
  s_mov_b32 m0, 105984
  s_nop 0
  buffer_load_dwordx4 v70, s[16:19], s56 offen lds
  v_xor_b32 v71, 64, v251
  s_mov_b32 m0, 106496
  s_nop 0
  buffer_load_dwordx4 v71, s[16:19], s56 offen lds
  s_add_i32 s56, s45, 14
  s_lshl_b32 s56, s56, 1
  s_add_i32 s56, s56, s41
  s_max_i32 s56, s56, 0
  s_min_i32 s56, s56, 223
  s_mul_i32 s56, s56, 86016
  v_xor_b32 v64, 96, v232
  s_mov_b32 m0, 107520
  s_nop 0
  buffer_load_dwordx4 v64, s[16:19], s56 offen lds
  v_xor_b32 v65, 96, v233
  s_mov_b32 m0, 108544
  s_nop 0
  buffer_load_dwordx4 v65, s[16:19], s56 offen lds
  v_xor_b32 v66, 96, v234
  s_mov_b32 m0, 109568
  s_nop 0
  buffer_load_dwordx4 v66, s[16:19], s56 offen lds
  v_xor_b32 v67, 96, v235
  s_mov_b32 m0, 110592
  s_nop 0
  buffer_load_dwordx4 v67, s[16:19], s56 offen lds
  v_xor_b32 v68, 96, v236
  s_mov_b32 m0, 111616
  s_nop 0
  buffer_load_dwordx4 v68, s[16:19], s56 offen lds
  v_xor_b32 v69, 96, v237
  s_mov_b32 m0, 112640
  s_nop 0
  buffer_load_dwordx4 v69, s[16:19], s56 offen lds
  v_xor_b32 v70, 96, v238
  s_mov_b32 m0, 113664
  s_nop 0
  buffer_load_dwordx4 v70, s[16:19], s56 offen lds
  v_xor_b32 v71, 96, v239
  s_mov_b32 m0, 114176
  s_nop 0
  buffer_load_dwordx4 v71, s[16:19], s56 offen lds
  s_add_i32 s56, s45, 15
  s_lshl_b32 s56, s56, 1
  s_add_i32 s56, s56, s41
  s_max_i32 s56, s56, 0
  s_min_i32 s56, s56, 223
  s_mul_i32 s56, s56, 86016
  v_xor_b32 v64, 96, v244
  s_mov_b32 m0, 115200
  s_nop 0
  buffer_load_dwordx4 v64, s[16:19], s56 offen lds
  v_xor_b32 v65, 96, v245
  s_mov_b32 m0, 116224
  s_nop 0
  buffer_load_dwordx4 v65, s[16:19], s56 offen lds
  v_xor_b32 v66, 96, v246
  s_mov_b32 m0, 117248
  s_nop 0
  buffer_load_dwordx4 v66, s[16:19], s56 offen lds
  v_xor_b32 v67, 96, v247
  s_mov_b32 m0, 118272
  s_nop 0
  buffer_load_dwordx4 v67, s[16:19], s56 offen lds
  v_xor_b32 v68, 96, v248
  s_mov_b32 m0, 119296
  s_nop 0
  buffer_load_dwordx4 v68, s[16:19], s56 offen lds
  v_xor_b32 v69, 96, v249
  s_mov_b32 m0, 120320
  s_nop 0
  buffer_load_dwordx4 v69, s[16:19], s56 offen lds
  v_xor_b32 v70, 96, v250
  s_mov_b32 m0, 121344
  s_nop 0
  buffer_load_dwordx4 v70, s[16:19], s56 offen lds
  v_xor_b32 v71, 96, v251
  s_mov_b32 m0, 121856
  s_nop 0
  buffer_load_dwordx4 v71, s[16:19], s56 offen lds
  s_waitcnt vmcnt(0)
  s_barrier
  s_add_i32 s56, s45, 16
  s_lshl_b32 s56, s56, 1
  s_add_i32 s56, s56, s41
  s_max_i32 s56, s56, 0
  s_min_i32 s56, s56, 223
  s_mul_i32 s56, s56, 86016
  s_mov_b32 m0, 122880
  s_nop 0
  buffer_load_dwordx4 v232, s[16:19], s56 offen lds
  s_mov_b32 m0, 123904
  s_nop 0
  buffer_load_dwordx4 v233, s[16:19], s56 offen lds
  s_mov_b32 m0, 124928
  s_nop 0
  buffer_load_dwordx4 v234, s[16:19], s56 offen lds
  s_mov_b32 m0, 125952
  s_nop 0
  buffer_load_dwordx4 v235, s[16:19], s56 offen lds
  s_mov_b32 m0, 126976
  s_nop 0
  buffer_load_dwordx4 v236, s[16:19], s56 offen lds
  s_mov_b32 m0, 128000
  s_nop 0
  buffer_load_dwordx4 v237, s[16:19], s56 offen lds
  s_mov_b32 m0, 129024
  s_nop 0
  buffer_load_dwordx4 v238, s[16:19], s56 offen lds
  s_mov_b32 m0, 129536
  s_nop 0
  buffer_load_dwordx4 v239, s[16:19], s56 offen lds
  s_add_i32 s56, s45, 17
  s_lshl_b32 s56, s56, 1
  s_add_i32 s56, s56, s41
  s_max_i32 s56, s56, 0
  s_min_i32 s56, s56, 223
  s_mul_i32 s56, s56, 86016
  s_mov_b32 m0, 130560
  s_nop 0
  buffer_load_dwordx4 v244, s[16:19], s56 offen lds
  s_mov_b32 m0, 131584
  s_nop 0
  buffer_load_dwordx4 v245, s[16:19], s56 offen lds
  s_mov_b32 m0, 132608
  s_nop 0
  buffer_load_dwordx4 v246, s[16:19], s56 offen lds
  s_mov_b32 m0, 133632
  s_nop 0
  buffer_load_dwordx4 v247, s[16:19], s56 offen lds
  s_mov_b32 m0, 134656
  s_nop 0
  buffer_load_dwordx4 v248, s[16:19], s56 offen lds
  s_mov_b32 m0, 135680
  s_nop 0
  buffer_load_dwordx4 v249, s[16:19], s56 offen lds
  s_mov_b32 m0, 136704
  s_nop 0
  buffer_load_dwordx4 v250, s[16:19], s56 offen lds
  s_mov_b32 m0, 137216
  s_nop 0
  buffer_load_dwordx4 v251, s[16:19], s56 offen lds
  s_add_i32 s56, s45, 18
  s_lshl_b32 s56, s56, 1
  s_add_i32 s56, s56, s41
  s_max_i32 s56, s56, 0
  s_min_i32 s56, s56, 223
  s_mul_i32 s56, s56, 86016
  v_xor_b32 v64, 32, v232
  s_mov_b32 m0, 138240
  s_nop 0
  buffer_load_dwordx4 v64, s[16:19], s56 offen lds
  v_xor_b32 v65, 32, v233
  s_mov_b32 m0, 139264
  s_nop 0
  buffer_load_dwordx4 v65, s[16:19], s56 offen lds
  v_xor_b32 v66, 32, v234
  s_mov_b32 m0, 140288
  s_nop 0
  buffer_load_dwordx4 v66, s[16:19], s56 offen lds
  v_xor_b32 v67, 32, v235
  s_mov_b32 m0, 141312
  s_nop 0
  buffer_load_dwordx4 v67, s[16:19], s56 offen lds
  v_xor_b32 v68, 32, v236
  s_mov_b32 m0, 142336
  s_nop 0
  buffer_load_dwordx4 v68, s[16:19], s56 offen lds
  v_xor_b32 v69, 32, v237
  s_mov_b32 m0, 143360
  s_nop 0
  buffer_load_dwordx4 v69, s[16:19], s56 offen lds
  v_xor_b32 v70, 32, v238
  s_mov_b32 m0, 144384
  s_nop 0
  buffer_load_dwordx4 v70, s[16:19], s56 offen lds
  v_xor_b32 v71, 32, v239
  s_mov_b32 m0, 144896
  s_nop 0
  buffer_load_dwordx4 v71, s[16:19], s56 offen lds
  s_add_i32 s56, s45, 19
  s_lshl_b32 s56, s56, 1
  s_add_i32 s56, s56, s41
  s_max_i32 s56, s56, 0
  s_min_i32 s56, s56, 223
  s_mul_i32 s56, s56, 86016
  v_xor_b32 v64, 32, v244
  s_mov_b32 m0, 145920
  s_nop 0
  buffer_load_dwordx4 v64, s[16:19], s56 offen lds
  v_xor_b32 v65, 32, v245
  s_mov_b32 m0, 146944
  s_nop 0
  buffer_load_dwordx4 v65, s[16:19], s56 offen lds
  v_xor_b32 v66, 32, v246
  s_mov_b32 m0, 147968
  s_nop 0
  buffer_load_dwordx4 v66, s[16:19], s56 offen lds
  v_xor_b32 v67, 32, v247
  s_mov_b32 m0, 148992
  s_nop 0
  buffer_load_dwordx4 v67, s[16:19], s56 offen lds
  v_xor_b32 v68, 32, v248
  s_mov_b32 m0, 150016
  s_nop 0
  buffer_load_dwordx4 v68, s[16:19], s56 offen lds
  v_xor_b32 v69, 32, v249
  s_mov_b32 m0, 151040
  s_nop 0
  buffer_load_dwordx4 v69, s[16:19], s56 offen lds
  v_xor_b32 v70, 32, v250
  s_mov_b32 m0, 152064
  s_nop 0
  buffer_load_dwordx4 v70, s[16:19], s56 offen lds
  v_xor_b32 v71, 32, v251
  s_mov_b32 m0, 152576
  s_nop 0
  buffer_load_dwordx4 v71, s[16:19], s56 offen lds
  s_waitcnt vmcnt(0)
  v_mov_b32 v6, 0
  s_mov_b32 s59, 0
  s_mov_b64 exec, 1
H_pollV:
  buffer_load_dword v7, v6, s[36:39], 0 offen offset:132 sc1
  s_waitcnt vmcnt(0)
  v_cmp_eq_u32 vcc, 0, v7
  s_add_u32 s59, s59, 1
  s_cmp_gt_u32 s59, 200000
  s_cbranch_scc1 H_pollV_x
  s_cmp_lg_u64 vcc, 0
  s_cbranch_scc0 H_pollV_x
  s_sleep 2
  s_branch H_pollV
H_pollV_x:
  s_mov_b64 exec, -1
  s_lshr_b32 s55, s2, 3
  s_mul_i32 s55, s55, 2304
  buffer_load_dwordx4 v[80:83], v252, s[24:27], s55 offen offset:0 sc1
  buffer_load_dwordx4 v[84:87], v252, s[24:27], s55 offen offset:1024 sc1
  buffer_load_dwordx4 v[88:91], v252, s[24:27], s55 offen offset:2048 sc1
  s_barrier
  s_mov_b32 m0, 153600
  s_mov_b32 s59, 14336
  buffer_load_dwordx4 v252, s[24:27], s59 offen offset:0 sc1 lds
  buffer_load_dwordx4 v252, s[24:27], s59 offen offset:1024 sc1 lds
  buffer_load_dwordx4 v252, s[24:27], s59 offen offset:2048 sc1 lds
  buffer_load_dwordx4 v252, s[24:27], s59 offen offset:3072 sc1 lds
  s_mov_b32 m0, 157696
  s_mov_b32 s59, 18432
  buffer_load_dwordx4 v252, s[24:27], s59 offen offset:0 sc1 lds
  buffer_load_dwordx4 v252, s[24:27], s59 offen offset:1024 sc1 lds
  buffer_load_dwordx4 v252, s[24:27], s59 offen offset:2048 sc1 lds
  buffer_load_dwordx4 v252, s[24:27], s59 offen offset:3072 sc1 lds
  s_mov_b32 m0, 161792
  s_mov_b32 s59, 22528
  buffer_load_dwordx4 v252, s[24:27], s59 offen offset:0 sc1 lds
  buffer_load_dwordx4 v252, s[24:27], s59 offen offset:1024 sc1 lds
  s_waitcnt vmcnt(0)
  s_barrier
  s_mov_b32 m0, 31744
  s_mov_b32 s59, 56320
  buffer_load_dwordx4 v252, s[24:27], s59 offen offset:0 sc1 lds
  buffer_load_dwordx4 v252, s[24:27], s59 offen offset:1024 sc1 lds
  buffer_load_dwordx4 v252, s[24:27], s59 offen offset:2048 sc1 lds
  buffer_load_dwordx4 v252, s[24:27], s59 offen offset:3072 sc1 lds
  s_mov_b32 m0, 35840
  s_mov_b32 s59, 60416
  buffer_load_dwordx4 v252, s[24:27], s59 offen offset:0 sc1 lds
  buffer_load_dwordx4 v252, s[24:27], s59 offen offset:1024 sc1 lds
  buffer_load_dwordx4 v252, s[24:27], s59 offen offset:2048 sc1 lds
  buffer_load_dwordx4 v252, s[24:27], s59 offen offset:3072 sc1 lds
  s_mov_b32 m0, 39936
  s_mov_b32 s59, 64512
  buffer_load_dwordx4 v252, s[24:27], s59 offen offset:0 sc1 lds
  buffer_load_dwordx4 v252, s[24:27], s59 offen offset:1024 sc1 lds
  buffer_load_dwordx4 v252, s[24:27], s59 offen offset:2048 sc1 lds
  buffer_load_dwordx4 v252, s[24:27], s59 offen offset:3072 sc1 lds
  s_mov_b32 m0, 44032
  s_mov_b32 s59, 68608
  buffer_load_dwordx4 v252, s[24:27], s59 offen offset:0 sc1 lds
  buffer_load_dwordx4 v252, s[24:27], s59 offen offset:1024 sc1 lds
  buffer_load_dwordx4 v252, s[24:27], s59 offen offset:2048 sc1 lds
  buffer_load_dwordx4 v252, s[24:27], s59 offen offset:3072 sc1 lds
  s_mov_b32 m0, 48128
  s_mov_b32 s59, 72704
  buffer_load_dwordx4 v252, s[24:27], s59 offen offset:0 sc1 lds
  s_waitcnt vmcnt(0)
  s_barrier
M_done:
  s_endpgm
CODE_END:
.section .rodata,"a"
.p2align 6
.amdhsa_kernel standalone__neighborhood_nat__vision_kernel
  .amdhsa_next_free_vgpr 256
  .amdhsa_next_free_sgpr 102
  .amdhsa_accum_offset 256
  .amdhsa_group_segment_fixed_size 0
  .amdhsa_kernarg_size 48
  .amdhsa_user_sgpr_count 2
  .amdhsa_user_sgpr_kernarg_segment_ptr 1
  .amdhsa_system_sgpr_workgroup_id_x 1
.end_amdhsa_kernel
```

```asm
; @launch grid=(256,1,1) block=(512,1,1) lds=163840
.amdgcn_target "amdgcn-amd-amdhsa--gfx950"
.text
.globl standalone__neighborhood_nat__vision_kernel
.p2align 8
.type standalone__neighborhood_nat__vision_kernel,@function
standalone__neighborhood_nat__vision_kernel:
  s_cmp_ge_u32 s2, 256
  s_cbranch_scc1 M_done
  s_load_dwordx8 s[4:11], s[0:1], 0
  s_load_dwordx4 s[12:15], s[0:1], 32
  v_lshrrev_b32 v4, 6, v0
  v_and_b32 v1, 63, v0
  v_readfirstlane_b32 s40, v4
  v_lshrrev_b32 v2, 4, v1
  v_and_b32 v3, 15, v1
  v_lshlrev_b32 v252, 4, v1
  s_cmp_lg_u32 s40, 0
  s_cbranch_scc1 M_comp
  s_getpc_b64 s[16:17]
H_pcl:
  s_and_b32 s16, s16, -256
  s_and_b32 s17, s17, 0xffff
  s_mov_b32 s18, CODE_END-H_pcl
  s_mov_b32 s19, 0x00020000
  s_lshr_b32 s55, s2, 3
  s_lshl_b32 s55, s55, 10
  buffer_load_dwordx4 v[188:191], v252, s[16:19], s55 offen
  s_cmp_ge_u32 s2, 108
  s_cbranch_scc1 H_nom
  v_bfe_u32 v5, v1, 2, 2
  v_lshrrev_b32 v6, 5, v1
  v_lshlrev_b32 v7, 1, v6
  v_and_b32 v8, 3, v1
  v_xor_b32 v7, v7, v8
  v_lshlrev_b32 v7, 4, v7
  s_movk_i32 s60, 1152
  s_mov_b32 m0, 90112
  s_mov_b32 s30, 221184
  s_mov_b32 s31, 0x00020000
  s_cmp_ge_u32 s2, 36
  s_cbranch_scc1 H_vf
  v_lshl_add_u32 v4, v2, 3, v5
  s_mul_hi_u32 s55, s2, 0x2aaaaaab
  s_mul_i32 s56, s55, 6
  s_sub_u32 s56, s2, s56
  s_mul_i32 s56, s56, 36864
  s_mul_i32 s55, s55, 36864
  s_sub_u32 s55, s55, s56
  s_add_i32 s55, s55, -4224
  s_movk_i32 s57, 4608
  s_mov_b32 s59, 114688
  s_branch H_tl0
H_vf:
  v_lshrrev_b32 v4, 2, v1
  s_sub_u32 s94, s2, 36
  s_mul_hi_u32 s95, s94, 0x15555556
  s_mul_i32 s56, s95, 36864
  s_addk_i32 s56, 768
  s_movk_i32 s57, 18432
  s_mov_b32 s59, 102400
H_tl0:
  v_mad_u32_u24 v200, v4, s60, v7
  s_waitcnt lgkmcnt(0)
  s_mov_b64 s[28:29], s[6:7]
H_tl:
  buffer_load_dwordx4 v200, s[28:31], s56 offen offset:0 lds
  s_addk_i32 m0, 960
  s_nop 0
  buffer_load_dwordx4 v200, s[28:31], s56 offen offset:64 lds
  s_addk_i32 m0, 960
  s_nop 0
  buffer_load_dwordx4 v200, s[28:31], s56 offen offset:128 lds
  s_addk_i32 m0, 960
  s_nop 0
  buffer_load_dwordx4 v200, s[28:31], s56 offen offset:192 lds
  s_addk_i32 m0, 960
  s_nop 0
  buffer_load_dwordx4 v200, s[28:31], s56 offen offset:256 lds
  s_addk_i32 m0, 960
  s_nop 0
  buffer_load_dwordx4 v200, s[28:31], s56 offen offset:320 lds
  s_addk_i32 m0, 1344
  s_add_u32 s56, s56, s57
  s_mov_b32 s58, s57
  s_mov_b32 s57, s55
  s_mov_b32 s55, s58
  s_cmp_lt_u32 m0, s59
  s_cbranch_scc1 H_tl
  s_cmp_ge_u32 s2, 36
  s_cbranch_scc1 H_vf2
  s_barrier
  s_branch H_task2
H_vf2:
  s_mov_b32 s32, s8
  s_and_b32 s33, s9, 0xffff
  s_mov_b32 s34, 73728
  s_mov_b32 s35, 0x00020000
  v_lshrrev_b32 v4, 1, v1
  v_mul_u32_u24 v4, 384, v4
  v_and_b32 v5, 1, v1
  v_lshl_add_u32 v4, v5, 4, v4
  s_mul_i32 s56, s95, 12
  s_sub_u32 s56, s94, s56
  s_lshl_b32 s57, s56, 5
H_tl2:
  buffer_load_dwordx4 v4, s[32:35], s57 offen lds
  s_addk_i32 m0, 1024
  s_addk_i32 s57, 12288
  s_cmp_lt_u32 m0, 108544
  s_cbranch_scc1 H_tl2
  s_branch H_nom
M_comp:
  s_and_b32 s55, s2, 7
  s_lshr_b32 s56, s2, 3
  s_lshr_b32 s41, s55, 2
  s_bfe_u32 s42, s55, 0x10001
  s_and_b32 s55, s55, 1
  s_lshl_b32 s55, s55, 2
  s_lshr_b32 s43, s56, 3
  s_add_u32 s43, s43, s55
  s_and_b32 s44, s56, 7
  s_mul_i32 s43, s43, 14
  s_mul_i32 s44, s44, 14
  s_mul_i32 s61, s41, 13
  s_add_i32 s61, s61, -6
  s_cmp_eq_u32 s42, 0
  s_cselect_b32 s62, 85632, 0
  s_cselect_b32 s50, -1, 1
  s_mulk_i32 s50, 384
  s_cmp_ge_u32 s40, 4
  s_cselect_b32 s53, -4, 3
  s_add_i32 s53, s53, s40
  s_lshl_b32 s53, s53, 1
  s_add_u32 s88, s43, s53
  s_mov_b32 s89, 86016
  v_lshrrev_b32 v4, 3, v1
  v_and_b32 v5, 7, v1
  v_and_b32 v6, 6, v4
  v_xor_b32 v5, v5, v6
  v_lshl_add_u32 v5, v5, 4, s62
  v_add_u32 v8, 2, v4
  v_lshrrev_b32 v8, 3, v8
  v_add_u32 v4, s44, v4
  v_lshl_add_u32 v6, v4, 1, 7
  v_add_u32 v7, 112, v4
  v_min_u32 v6, v6, v7
  v_mad_i32_i24 v168, v6, s50, v5
  v_lshl_add_u32 v6, v4, 1, 19
  v_add_u32 v7, 118, v4
  v_min_u32 v6, v6, v7
  v_mad_i32_i24 v169, v6, s50, v5
  v_lshl_add_u32 v168, v8, 30, v168
  s_add_u32 s55, s88, 0
  s_lshl_b32 s56, s55, 1
  s_add_i32 s56, s56, s61
  s_max_i32 s56, s56, s55
  s_add_i32 s55, s55, 112
  s_min_i32 s56, s56, s55
  s_mul_i32 s84, s56, 86016
  s_add_u32 s55, s88, 1
  s_lshl_b32 s56, s55, 1
  s_add_i32 s56, s56, s61
  s_max_i32 s56, s56, s55
  s_add_i32 s55, s55, 112
  s_min_i32 s56, s56, s55
  s_mul_i32 s85, s56, 86016
  s_lshl_b32 s86, s53, 12
  s_lshl_b32 s87, s53, 11
  s_waitcnt lgkmcnt(0)
  s_mov_b32 s16, s4
  s_and_b32 s17, s5, 0xffff
  s_mov_b32 s18, 19267584
  s_mov_b32 s19, 0x00020000
  s_cmp_ge_u32 s2, 36
  s_cbranch_scc1 M_x0
  s_barrier
M_x0:
  s_add_u32 m0, s86, 512
  s_nop 0
  buffer_load_dwordx4 v168, s[16:19], s84 offen offset:0 lds
  s_add_u32 m0, s86, 1536
  s_nop 0
  buffer_load_dwordx4 v168, s[16:19], s85 offen offset:0 lds
  s_add_u32 m0, s86, 2560
  s_nop 0
  buffer_load_dwordx4 v169, s[16:19], s84 offen offset:0 lds
  s_add_u32 m0, s86, 3584
  s_nop 0
  buffer_load_dwordx4 v169, s[16:19], s85 offen offset:0 lds
  s_sub_u32 s55, s2, 36
  s_cmp_ge_u32 s55, 72
  s_cbranch_scc1 M_x1
  s_add_u32 m0, s86, 4480
  s_nop 0
  buffer_load_dwordx4 v168, s[16:19], s84 offen offset:128 lds
  s_add_u32 m0, s86, 5504
  s_nop 0
  buffer_load_dwordx4 v168, s[16:19], s85 offen offset:128 lds
  s_add_u32 m0, s86, 6528
  s_nop 0
  buffer_load_dwordx4 v169, s[16:19], s84 offen offset:128 lds
  s_add_u32 m0, s86, 7552
  s_nop 0
  buffer_load_dwordx4 v169, s[16:19], s85 offen offset:128 lds
  s_add_u32 m0, s87, 61184
  s_nop 0
  buffer_load_dwordx4 v168, s[16:19], s84 offen offset:256 lds
  s_add_u32 m0, s87, 62208
  s_nop 0
  buffer_load_dwordx4 v168, s[16:19], s85 offen offset:256 lds
  s_add_u32 m0, s87, 63232
  s_nop 0
  buffer_load_dwordx4 v169, s[16:19], s84 offen offset:256 lds
  s_add_u32 m0, s87, 64256
  s_nop 0
  buffer_load_dwordx4 v169, s[16:19], s85 offen offset:256 lds
M_x1:
  s_branch M_c2
H_task2:
  v_lshrrev_b32 v4, 3, v3
  v_lshlrev_b32 v4, 1, v4
  v_xor_b32 v4, v4, v2
  v_lshl_add_u32 v4, v3, 2, v4
  v_lshlrev_b32 v195, 4, v4
  v_add_u32 v195, 90112, v195
  s_mov_b32 s16, s4
  s_and_b32 s17, s5, 0xffff
  s_mov_b32 s18, 19267584
  s_mov_b32 s19, 0x00020000
  s_mov_b32 s24, s14
  s_and_b32 s25, s15, 0xffff
  s_mov_b32 s26, 268435456
  s_mov_b32 s27, 0x00020000
  s_mov_b32 s20, s10
  s_and_b32 s21, s11, 0xffff
  s_mov_b32 s22, 19267584
  s_mov_b32 s23, 0x00020000
  s_mov_b32 s36, s12
  s_and_b32 s37, s13, 0xffff
  s_mov_b32 s38, 256
  s_mov_b32 s39, 0x00020000
  s_lshl_b32 s55, s2, 11
  s_add_u32 s55, s55, 131072
  s_waitcnt vmcnt(0)
  ds_read_b128 v[64:67], v195 offset:0
  ds_read_b128 v[88:91], v195 offset:6144
  ds_read_b128 v[112:115], v195 offset:12288
  ds_read_b128 v[136:139], v195 offset:18432
  ds_read_b128 v[68:71], v195 offset:1024
  ds_read_b128 v[92:95], v195 offset:7168
  ds_read_b128 v[116:119], v195 offset:13312
  ds_read_b128 v[140:143], v195 offset:19456
  ds_read_b128 v[72:75], v195 offset:2048
  ds_read_b128 v[96:99], v195 offset:8192
  ds_read_b128 v[120:123], v195 offset:14336
  ds_read_b128 v[144:147], v195 offset:20480
  s_waitcnt lgkmcnt(9)
  v_mfma_f32_16x16x32_bf16 v[160:163], v[64:67], v[112:115], 0
  v_mfma_f32_16x16x32_bf16 v[164:167], v[88:91], v[112:115], 0
  s_waitcnt lgkmcnt(8)
  v_mfma_f32_16x16x32_bf16 v[168:171], v[64:67], v[136:139], 0
  v_mfma_f32_16x16x32_bf16 v[172:175], v[88:91], v[136:139], 0
  ds_read_b128 v[76:79], v195 offset:3072
  ds_read_b128 v[100:103], v195 offset:9216
  ds_read_b128 v[124:127], v195 offset:15360
  ds_read_b128 v[148:151], v195 offset:21504
  s_waitcnt lgkmcnt(9)
  v_mfma_f32_16x16x32_bf16 v[160:163], v[68:71], v[116:119], v[160:163]
  v_mfma_f32_16x16x32_bf16 v[164:167], v[92:95], v[116:119], v[164:167]
  s_waitcnt lgkmcnt(8)
  v_mfma_f32_16x16x32_bf16 v[168:171], v[68:71], v[140:143], v[168:171]
  v_mfma_f32_16x16x32_bf16 v[172:175], v[92:95], v[140:143], v[172:175]
  ds_read_b128 v[80:83], v195 offset:4096
  ds_read_b128 v[104:107], v195 offset:10240
  ds_read_b128 v[128:131], v195 offset:16384
  ds_read_b128 v[152:155], v195 offset:22528
  s_waitcnt lgkmcnt(9)
  v_mfma_f32_16x16x32_bf16 v[160:163], v[72:75], v[120:123], v[160:163]
  v_mfma_f32_16x16x32_bf16 v[164:167], v[96:99], v[120:123], v[164:167]
  s_waitcnt lgkmcnt(8)
  v_mfma_f32_16x16x32_bf16 v[168:171], v[72:75], v[144:147], v[168:171]
  v_mfma_f32_16x16x32_bf16 v[172:175], v[96:99], v[144:147], v[172:175]
  ds_read_b128 v[84:87], v195 offset:5120
  ds_read_b128 v[108:111], v195 offset:11264
  ds_read_b128 v[132:135], v195 offset:17408
  ds_read_b128 v[156:159], v195 offset:23552
  s_waitcnt lgkmcnt(9)
  v_mfma_f32_16x16x32_bf16 v[160:163], v[76:79], v[124:127], v[160:163]
  v_mfma_f32_16x16x32_bf16 v[164:167], v[100:103], v[124:127], v[164:167]
  s_waitcnt lgkmcnt(8)
  v_mfma_f32_16x16x32_bf16 v[168:171], v[76:79], v[148:151], v[168:171]
  v_mfma_f32_16x16x32_bf16 v[172:175], v[100:103], v[148:151], v[172:175]
  s_waitcnt lgkmcnt(5)
  v_mfma_f32_16x16x32_bf16 v[160:163], v[80:83], v[128:131], v[160:163]
  v_mfma_f32_16x16x32_bf16 v[164:167], v[104:107], v[128:131], v[164:167]
  s_waitcnt lgkmcnt(4)
  v_mfma_f32_16x16x32_bf16 v[168:171], v[80:83], v[152:155], v[168:171]
  v_mfma_f32_16x16x32_bf16 v[172:175], v[104:107], v[152:155], v[172:175]
  s_waitcnt lgkmcnt(1)
  v_mfma_f32_16x16x32_bf16 v[160:163], v[84:87], v[132:135], v[160:163]
  v_mfma_f32_16x16x32_bf16 v[164:167], v[108:111], v[132:135], v[164:167]
  s_waitcnt lgkmcnt(0)
  v_mfma_f32_16x16x32_bf16 v[168:171], v[84:87], v[156:159], v[168:171]
  v_mfma_f32_16x16x32_bf16 v[172:175], v[108:111], v[156:159], v[172:175]
  s_nop 3
  v_cvt_pk_bf16_f32 v176, v160, v161
  v_cvt_pk_bf16_f32 v177, v162, v163
  v_cvt_pk_bf16_f32 v178, v164, v165
  v_cvt_pk_bf16_f32 v179, v166, v167
  buffer_store_dwordx4 v[176:179], v252, s[24:27], s55 offen offset:0 sc1
  v_cvt_pk_bf16_f32 v180, v168, v169
  v_cvt_pk_bf16_f32 v181, v170, v171
  v_cvt_pk_bf16_f32 v182, v172, v173
  v_cvt_pk_bf16_f32 v183, v174, v175
  buffer_store_dwordx4 v[180:183], v252, s[24:27], s55 offen offset:1024 sc1
  v_mov_b32 v192, 1
  v_mov_b32 v193, 0
  s_mov_b64 exec, 1
  s_waitcnt vmcnt(0)
  buffer_atomic_add v192, v193, s[36:39], 0 offen offset:0 sc0 sc1
  s_mov_b64 exec, -1
  s_barrier
  s_waitcnt vmcnt(0)
  v_readfirstlane_b32 s56, v192
  s_nop 0
  s_cmp_lg_u32 s56, 35
  s_cbranch_scc1 H_p1
  s_mov_b64 exec, 1
  buffer_store_dword v192, v193, s[36:39], 0 offen offset:128 sc1
  s_mov_b64 exec, -1
H_p1:
  s_barrier
  s_branch H_join
H_nom:
  s_waitcnt lgkmcnt(0)
  s_mov_b32 s16, s4
  s_and_b32 s17, s5, 0xffff
  s_mov_b32 s18, 19267584
  s_mov_b32 s19, 0x00020000
  s_mov_b32 s24, s14
  s_and_b32 s25, s15, 0xffff
  s_mov_b32 s26, 268435456
  s_mov_b32 s27, 0x00020000
  s_mov_b32 s20, s10
  s_and_b32 s21, s11, 0xffff
  s_mov_b32 s22, 19267584
  s_mov_b32 s23, 0x00020000
  s_mov_b32 s36, s12
  s_and_b32 s37, s13, 0xffff
  s_mov_b32 s38, 256
  s_mov_b32 s39, 0x00020000
  s_branch H_join
M_c2:
  s_mov_b32 s24, s14
  s_and_b32 s25, s15, 0xffff
  s_mov_b32 s26, 268435456
  s_mov_b32 s27, 0x00020000
  s_mov_b32 s20, s10
  s_and_b32 s21, s11, 0xffff
  s_mov_b32 s22, 19267584
  s_mov_b32 s23, 0x00020000
  s_mov_b32 s36, s12
  s_and_b32 s37, s13, 0xffff
  s_mov_b32 s38, 256
  s_mov_b32 s39, 0x00020000
  s_mul_i32 s55, s41, 6
  s_add_i32 s45, s43, s55
  s_add_i32 s45, s45, -6
  s_cmp_eq_i32 s45, -6
  s_cselect_b32 s47, 6, 0
  s_cmp_eq_i32 s45, 98
  s_cselect_b32 s48, 7, 13
  s_cselect_b32 s49, 2, 0
  s_sub_i32 s45, s45, s49
  s_cmp_eq_i32 s44, 98
  s_cselect_b32 s51, 7, 13
  s_lshl_b32 s56, s44, 1
  s_add_i32 s56, s56, 1
  s_mul_i32 s46, s56, s50
  s_add_i32 s46, s46, s62
  s_lshl_b32 s91, s50, 1
  s_lshl_b32 s3, s91, 3
  s_add_i32 s91, s91, -384
  s_max_i32 s92, s53, s47
  s_min_i32 s92, s92, s48
  s_and_b32 s92, s92, -2
  s_add_u32 s52, s92, s49
  s_mov_b32 s54, 4286578688
  s_mov_b32 s63, 1037384597
  s_and_b32 s93, s40, 1
  s_lshl_b32 s93, s93, 3
  s_and_b32 s56, s40, 6
  s_or_b32 s93, s93, s56
  s_add_u32 s56, s40, 8
  s_add_i32 s100, s45, s56
  s_lshl_b32 s100, s100, 1
  s_add_i32 s100, s100, s41
  s_max_i32 s100, s100, 0
  s_min_i32 s100, s100, 223
  s_mul_i32 s100, s100, 86016
  s_mul_i32 s101, s56, 7680
  v_lshrrev_b32 v4, 3, v3
  v_add_u32 v4, s53, v4
  v_max_i32 v4, s47, v4
  v_min_i32 v4, s48, v4
  v_subrev_u32 v4, s92, v4
  v_and_b32 v5, 1, v2
  v_sub_u32 v6, v5, v4
  v_ashrrev_i32 v12, 31, v6
  v_and_b32 v12, s54, v12
  v_sub_u32 v6, v4, v5
  v_ashrrev_i32 v13, 31, v6
  v_and_b32 v13, s54, v13
  v_and_b32 v4, 7, v3
  v_lshrrev_b32 v5, 1, v2
  v_subrev_u32 v7, 6, v4
  v_ashrrev_i32 v7, 31, v7
  v_and_b32 v7, 0x7f, v7
  v_add_u32 v6, 0, v4
  v_min_i32 v6, s51, v6
  v_lshlrev_b32 v6, v6, v7
  v_lshrrev_b32 v6, v5, v6
  v_not_b32 v14, v6
  v_mov_b32 v7, 0x7f
  v_add_u32 v6, 6, v4
  v_min_i32 v6, s51, v6
  v_lshlrev_b32 v6, v6, v7
  s_cmp_lt_u32 s2, 108
  s_cbranch_scc1 M_hk4
  s_waitcnt vmcnt(3)
  s_add_u32 m0, s86, 4480
  s_nop 0
  buffer_load_dwordx4 v168, s[16:19], s84 offen offset:128 lds
M_hk4:
  v_lshrrev_b32 v6, v5, v6
  v_not_b32 v15, v6
  v_add_u32 v4, s52, v4
  v_and_b32 v5, 1, v4
  v_lshlrev_b32 v5, 3, v5
  v_and_or_b32 v5, v4, 6, v5
  v_mul_u32_u24 v4, 7680, v4
  v_lshrrev_b32 v6, 3, v3
  v_mul_u32_u24 v6, 24, v6
  v_add_u32 v6, v6, v2
  v_add_u32 v7, 0, v6
  v_xor_b32 v7, v7, v5
  v_lshl_add_u32 v240, v7, 4, v4
  v_add_u32 v7, 4, v6
  v_xor_b32 v7, v7, v5
  v_lshl_add_u32 v241, v7, 4, v4
  v_add_u32 v7, 8, v6
  v_xor_b32 v7, v7, v5
  v_lshl_add_u32 v242, v7, 4, v4
  v_add_u32 v7, 12, v6
  v_xor_b32 v7, v7, v5
  v_lshl_add_u32 v243, v7, 4, v4
  v_and_b32 v4, 1, v2
  v_lshlrev_b32 v4, 2, v4
  v_lshrrev_b32 v5, 2, v3
  v_add3_u32 v4, v4, v5, s52
  s_cmp_lt_u32 s2, 108
  s_cbranch_scc1 M_hk5
  s_waitcnt vmcnt(3)
  s_add_u32 m0, s86, 5504
  s_nop 0
  buffer_load_dwordx4 v168, s[16:19], s85 offen offset:128 lds
M_hk5:
  v_and_b32 v5, 1, v4
  v_lshlrev_b32 v5, 3, v5
  v_and_or_b32 v5, v4, 6, v5
  v_mul_u32_u24 v4, 7680, v4
  v_and_b32 v6, 1, v3
  v_lshl_add_u32 v4, v6, 3, v4
  v_lshrrev_b32 v6, 1, v2
  v_mul_u32_u24 v6, 24, v6
  v_bfe_u32 v7, v3, 1, 1
  v_add_u32 v6, v6, v7
  v_add_u32 v7, 0, v6
  v_xor_b32 v7, v7, v5
  v_lshl_add_u32 v244, v7, 4, v4
  v_add_u32 v7, 2, v6
  v_xor_b32 v7, v7, v5
  v_lshl_add_u32 v245, v7, 4, v4
  v_add_u32 v7, 4, v6
  v_xor_b32 v7, v7, v5
  v_lshl_add_u32 v246, v7, 4, v4
  v_add_u32 v7, 6, v6
  v_xor_b32 v7, v7, v5
  v_lshl_add_u32 v247, v7, 4, v4
  v_add_u32 v7, 8, v6
  v_xor_b32 v7, v7, v5
  v_lshl_add_u32 v248, v7, 4, v4
  v_add_u32 v7, 10, v6
  s_cmp_lt_u32 s2, 108
  s_cbranch_scc1 M_hk6
  s_waitcnt vmcnt(3)
  s_add_u32 m0, s86, 6528
  s_nop 0
  buffer_load_dwordx4 v169, s[16:19], s84 offen offset:128 lds
M_hk6:
  v_xor_b32 v7, v7, v5
  v_lshl_add_u32 v249, v7, 4, v4
  v_add_u32 v7, 12, v6
  v_xor_b32 v7, v7, v5
  v_lshl_add_u32 v250, v7, 4, v4
  v_add_u32 v7, 14, v6
  v_xor_b32 v7, v7, v5
  v_lshl_add_u32 v251, v7, 4, v4
  v_add_u32 v253, 153600, v252
  v_add_u32 v254, 90112, v252
  v_add_u32 v4, 0, v1
  v_xor_b32 v4, s93, v4
  v_mul_u32_u24 v5, 2731, v4
  v_lshrrev_b32 v5, 16, v5
  v_mul_i32_i24 v5, s91, v5
  v_lshl_add_u32 v4, v4, 4, v5
  v_add_u32 v232, s46, v4
  v_add_u32 v235, s3, v232
  v_add_u32 v238, s3, v235
  v_add_u32 v4, 64, v1
  v_xor_b32 v4, s93, v4
  v_mul_u32_u24 v5, 2731, v4
  v_lshrrev_b32 v5, 16, v5
  v_mul_i32_i24 v5, s91, v5
  v_lshl_add_u32 v4, v4, 4, v5
  v_add_u32 v233, s46, v4
  s_cmp_lt_u32 s2, 108
  s_cbranch_scc1 M_hk7
  s_waitcnt vmcnt(3)
  s_add_u32 m0, s86, 7552
  s_nop 0
  buffer_load_dwordx4 v169, s[16:19], s85 offen offset:128 lds
M_hk7:
  v_add_u32 v236, s3, v233
  v_add_u32 v4, 128, v1
  v_xor_b32 v4, s93, v4
  v_mul_u32_u24 v5, 2731, v4
  v_lshrrev_b32 v5, 16, v5
  v_mul_i32_i24 v5, s91, v5
  v_lshl_add_u32 v4, v4, 4, v5
  v_add_u32 v234, s46, v4
  v_add_u32 v237, s3, v234
  v_add_u32 v4, 416, v1
  v_xor_b32 v4, s93, v4
  v_mul_u32_u24 v5, 2731, v4
  v_lshrrev_b32 v5, 16, v5
  v_mul_i32_i24 v5, s91, v5
  v_lshl_add_u32 v4, v4, 4, v5
  v_add_u32 v239, s46, v4
  v_max_i32 v237, 0, v237
  v_max_i32 v238, 0, v238
  v_max_i32 v239, 0, v239
  v_lshrrev_b32 v197, 1, v2
  v_and_b32 v255, 1, v2
  v_add_u32 v197, s88, v197
  v_lshl_add_u32 v0, v255, 2, s44
  v_lshl_add_u32 v198, v197, 1, s61
  v_add_u32 v199, 112, v197
  v_lshlrev_b32 v255, 30, v255
  s_cmp_lt_u32 s2, 108
  s_cbranch_scc1 M_hk8
  s_waitcnt vmcnt(3)
  s_add_u32 m0, s87, 61184
  s_nop 0
  buffer_load_dwordx4 v168, s[16:19], s84 offen offset:256 lds
M_hk8:
  v_med3_i32 v197, v198, v197, v199
  v_mul_lo_u32 v197, v197, s89
  v_lshl_add_u32 v197, v3, 3, v197
  v_add_u32 v197, s62, v197
  v_lshl_add_u32 v198, v0, 1, 7
  v_add_u32 v199, 112, v0
  v_min_u32 v4, v198, v199
  v_mad_i32_i24 v4, v4, s50, v197
  v_lshl_add_u32 v198, v0, 1, 9
  v_add_u32 v199, 113, v0
  v_min_u32 v5, v198, v199
  v_mad_i32_i24 v5, v5, s50, v197
  v_lshl_add_u32 v198, v0, 1, 11
  v_add_u32 v199, 114, v0
  v_min_u32 v6, v198, v199
  v_mad_i32_i24 v6, v6, s50, v197
  v_add_u32 v6, v6, v255
  v_lshl_add_u32 v198, v0, 1, 13
  v_add_u32 v199, 115, v0
  v_min_u32 v7, v198, v199
  v_mad_i32_i24 v7, v7, s50, v197
  v_add_u32 v7, v7, v255
  v_lshl_add_u32 v198, v0, 1, 19
  v_add_u32 v199, 118, v0
  v_min_u32 v8, v198, v199
  v_mad_i32_i24 v8, v8, s50, v197
  s_cmp_lt_u32 s2, 108
  s_cbranch_scc1 M_hk9
  s_waitcnt vmcnt(3)
  s_add_u32 m0, s87, 62208
  s_nop 0
  buffer_load_dwordx4 v168, s[16:19], s85 offen offset:256 lds
M_hk9:
  v_lshl_add_u32 v198, v0, 1, 21
  v_add_u32 v199, 119, v0
  v_min_u32 v9, v198, v199
  v_mad_i32_i24 v9, v9, s50, v197
  v_lshl_add_u32 v198, v0, 1, 23
  v_add_u32 v199, 120, v0
  v_min_u32 v10, v198, v199
  v_mad_i32_i24 v10, v10, s50, v197
  v_lshl_add_u32 v198, v0, 1, 25
  v_add_u32 v199, 121, v0
  v_min_u32 v11, v198, v199
  v_mad_i32_i24 v11, v11, s50, v197
  v_bfe_i32 v66, v14, 0, 1
  v_and_b32 v65, s54, v66
  v_and_b32 v66, s54, v66
  v_or_b32 v64, v65, v12
  v_or_b32 v67, v65, v13
  v_bfe_i32 v70, v14, 2, 1
  v_and_b32 v69, s54, v70
  v_and_b32 v70, s54, v70
  v_or_b32 v68, v69, v12
  v_or_b32 v71, v69, v13
  v_bfe_i32 v74, v14, 4, 1
  v_and_b32 v73, s54, v74
  v_and_b32 v74, s54, v74
  v_or_b32 v72, v73, v12
  s_cmp_lt_u32 s2, 108
  s_cbranch_scc1 M_hk10
  s_waitcnt vmcnt(3)
  s_add_u32 m0, s87, 63232
  s_nop 0
  buffer_load_dwordx4 v169, s[16:19], s84 offen offset:256 lds
M_hk10:
  v_or_b32 v75, v73, v13
  v_bfe_i32 v78, v14, 6, 1
  v_and_b32 v77, s54, v78
  v_and_b32 v78, s54, v78
  v_or_b32 v76, v77, v12
  v_or_b32 v79, v77, v13
  v_bfe_i32 v82, v14, 8, 1
  v_and_b32 v81, s54, v82
  v_and_b32 v82, s54, v82
  v_or_b32 v80, v81, v12
  v_or_b32 v83, v81, v13
  v_bfe_i32 v86, v14, 10, 1
  v_and_b32 v85, s54, v86
  v_and_b32 v86, s54, v86
  v_or_b32 v84, v85, v12
  v_or_b32 v87, v85, v13
  v_bfe_i32 v90, v15, 6, 1
  v_and_b32 v89, s54, v90
  v_and_b32 v90, s54, v90
  v_or_b32 v88, v89, v12
  v_or_b32 v91, v89, v13
  v_bfe_i32 v94, v15, 8, 1
  v_and_b32 v93, s54, v94
  v_and_b32 v94, s54, v94
  v_or_b32 v92, v93, v12
  v_or_b32 v95, v93, v13
  s_cmp_lt_u32 s2, 108
  s_cbranch_scc1 M_hk11
  s_waitcnt vmcnt(3)
  s_add_u32 m0, s87, 64256
  s_nop 0
  buffer_load_dwordx4 v169, s[16:19], s85 offen offset:256 lds
M_hk11:
  v_bfe_i32 v98, v15, 10, 1
  v_and_b32 v97, s54, v98
  v_and_b32 v98, s54, v98
  v_or_b32 v96, v97, v12
  v_or_b32 v99, v97, v13
  v_bfe_i32 v102, v15, 12, 1
  v_and_b32 v101, s54, v102
  v_and_b32 v102, s54, v102
  v_or_b32 v100, v101, v12
  v_or_b32 v103, v101, v13
  v_bfe_i32 v106, v15, 14, 1
  v_and_b32 v105, s54, v106
  v_and_b32 v106, s54, v106
  v_or_b32 v104, v105, v12
  v_or_b32 v107, v105, v13
  v_bfe_i32 v110, v15, 16, 1
  v_and_b32 v109, s54, v110
  v_and_b32 v110, s54, v110
  v_or_b32 v108, v109, v12
  v_or_b32 v111, v109, v13
  v_bfe_i32 v114, v15, 18, 1
  v_and_b32 v113, s54, v114
  v_and_b32 v114, s54, v114
  v_or_b32 v112, v113, v12
  v_or_b32 v115, v113, v13
  v_and_b32 v170, 6, v3
  v_xor_b32 v170, v170, v2
  v_lshlrev_b32 v174, 7, v3
  v_xor_b32 v171, 4, v170
  v_lshl_add_u32 v170, v170, 4, v174
  v_lshl_add_u32 v171, v171, 4, v174
  v_add_u32 v172, s87, v170
  v_add_u32 v170, s86, v170
  v_add_u32 v173, s87, v171
  v_add_u32 v171, s86, v171
  s_cmp_ge_u32 s2, 36
  s_cbranch_scc1 M_x2
  s_barrier
  s_add_u32 m0, s86, 4480
  s_nop 0
  buffer_load_dwordx4 v168, s[16:19], s84 offen offset:128 lds
  s_add_u32 m0, s86, 5504
  s_nop 0
  buffer_load_dwordx4 v168, s[16:19], s85 offen offset:128 lds
  s_add_u32 m0, s86, 6528
  s_nop 0
  buffer_load_dwordx4 v169, s[16:19], s84 offen offset:128 lds
  s_add_u32 m0, s86, 7552
  s_nop 0
  buffer_load_dwordx4 v169, s[16:19], s85 offen offset:128 lds
  s_barrier
  s_add_u32 m0, s87, 61184
  s_nop 0
  buffer_load_dwordx4 v168, s[16:19], s84 offen offset:256 lds
  s_add_u32 m0, s87, 62208
  s_nop 0
  buffer_load_dwordx4 v168, s[16:19], s85 offen offset:256 lds
  s_add_u32 m0, s87, 63232
  s_nop 0
  buffer_load_dwordx4 v169, s[16:19], s84 offen offset:256 lds
  s_add_u32 m0, s87, 64256
  s_nop 0
  buffer_load_dwordx4 v169, s[16:19], s85 offen offset:256 lds
M_x2:
  s_waitcnt vmcnt(8)
  ds_read_b128 v[16:19], v170 offset:512
  ds_read_b128 v[20:23], v171 offset:512
  ds_read_b128 v[40:43], v170 offset:2560
  ds_read_b128 v[44:47], v171 offset:2560
  s_waitcnt vmcnt(4)
  ds_read_b128 v[24:27], v170 offset:4608
  ds_read_b128 v[28:31], v171 offset:4608
  ds_read_b128 v[48:51], v170 offset:6656
  ds_read_b128 v[52:55], v171 offset:6656
  s_waitcnt vmcnt(0)
  ds_read_b128 v[32:35], v172 offset:61440
  ds_read_b128 v[36:39], v173 offset:61440
  ds_read_b128 v[56:59], v172 offset:63488
  ds_read_b128 v[60:63], v173 offset:63488
  s_add_i32 s57, s45, s40
  s_lshl_b32 s57, s57, 1
  s_add_i32 s57, s57, s41
  s_max_i32 s57, s57, 0
  s_min_i32 s57, s57, 223
  s_mul_i32 s57, s57, 86016
  s_waitcnt lgkmcnt(0)
  s_barrier
  s_cmp_lt_u32 s40, 4
  s_cbranch_scc1 M_er
  s_add_u32 m0, s101, -61440
  s_nop 0
  buffer_load_dwordx4 v232, s[16:19], s57 offen lds
  s_add_u32 m0, s101, -60416
  s_nop 0
  buffer_load_dwordx4 v233, s[16:19], s57 offen lds
  s_add_u32 m0, s101, -59392
  s_nop 0
  buffer_load_dwordx4 v234, s[16:19], s57 offen lds
  s_add_u32 m0, s101, -58368
  s_nop 0
  buffer_load_dwordx4 v235, s[16:19], s57 offen lds
  s_add_u32 m0, s101, -57344
  s_nop 0
  buffer_load_dwordx4 v236, s[16:19], s57 offen lds
  s_add_u32 m0, s101, -56320
  s_nop 0
  buffer_load_dwordx4 v237, s[16:19], s57 offen lds
  s_add_u32 m0, s101, -55296
  s_nop 0
  buffer_load_dwordx4 v238, s[16:19], s57 offen lds
  s_add_u32 m0, s101, -54784
  s_nop 0
  buffer_load_dwordx4 v239, s[16:19], s57 offen lds
M_er:
  s_barrier
  s_cmp_lt_u32 s40, 4
  s_cbranch_scc1 M_xl
  s_setprio 1
  s_barrier
  s_branch M_pa
M_xl:
  s_lshl_b32 s55, s40, 10
  s_add_u32 s55, s55, 131072
  s_sub_u32 m0, s55, 40960
  s_nop 0
  buffer_load_dwordx4 v252, s[24:27], s55 offen sc1 lds
  s_add_u32 s55, s55, 4096
  s_sub_u32 m0, s55, 40960
  s_nop 0
  buffer_load_dwordx4 v252, s[24:27], s55 offen sc1 lds
  s_add_u32 s55, s55, 4096
  s_sub_u32 m0, s55, 40960
  s_nop 0
  buffer_load_dwordx4 v252, s[24:27], s55 offen sc1 lds
  s_add_u32 s55, s55, 4096
  s_sub_u32 m0, s55, 40960
  s_nop 0
  buffer_load_dwordx4 v252, s[24:27], s55 offen sc1 lds
  s_add_u32 s55, s55, 4096
  s_sub_u32 m0, s55, 40960
  s_nop 0
  buffer_load_dwordx4 v252, s[24:27], s55 offen sc1 lds
  s_add_u32 s55, s55, 4096
  s_sub_u32 m0, s55, 40960
  s_nop 0
  buffer_load_dwordx4 v252, s[24:27], s55 offen sc1 lds
  s_add_u32 s55, s55, 4096
  s_sub_u32 m0, s55, 40960
  s_nop 0
  buffer_load_dwordx4 v252, s[24:27], s55 offen sc1 lds
  s_add_u32 s55, s55, 4096
  s_sub_u32 m0, s55, 40960
  s_nop 0
  buffer_load_dwordx4 v252, s[24:27], s55 offen sc1 lds
  s_add_u32 s55, s55, 4096
  s_sub_u32 m0, s55, 40960
  s_nop 0
  buffer_load_dwordx4 v252, s[24:27], s55 offen sc1 lds
  s_add_u32 s55, s55, 4096
  s_sub_u32 m0, s55, 40960
  s_nop 0
  buffer_load_dwordx4 v252, s[24:27], s55 offen sc1 lds
  s_add_u32 s55, s55, 4096
  s_sub_u32 m0, s55, 40960
  s_nop 0
  buffer_load_dwordx4 v252, s[24:27], s55 offen sc1 lds
  s_add_u32 s55, s55, 4096
  s_sub_u32 m0, s55, 40960
  s_nop 0
  buffer_load_dwordx4 v252, s[24:27], s55 offen sc1 lds
  s_waitcnt vmcnt(6)
  s_barrier
  s_lshl_b32 s55, s40, 10
  s_add_u32 s55, s55, 180224
  s_sub_u32 m0, s55, 40960
  s_nop 0
  buffer_load_dwordx4 v252, s[24:27], s55 offen sc1 lds
  s_add_u32 s55, s55, 4096
  s_sub_u32 m0, s55, 40960
  s_nop 0
  buffer_load_dwordx4 v252, s[24:27], s55 offen sc1 lds
  s_add_u32 s55, s55, 4096
  s_sub_u32 m0, s55, 40960
  s_nop 0
  buffer_load_dwordx4 v252, s[24:27], s55 offen sc1 lds
  s_add_u32 s55, s55, 4096
  s_sub_u32 m0, s55, 40960
  s_nop 0
  buffer_load_dwordx4 v252, s[24:27], s55 offen sc1 lds
  s_add_u32 s55, s55, 4096
  s_sub_u32 m0, s55, 40960
  s_nop 0
  buffer_load_dwordx4 v252, s[24:27], s55 offen sc1 lds
  s_add_u32 s55, s55, 4096
  s_sub_u32 m0, s55, 40960
  s_nop 0
  buffer_load_dwordx4 v252, s[24:27], s55 offen sc1 lds
  s_cmp_ge_u32 s40, 4
  s_cbranch_scc1 M_pa
  s_add_u32 m0, s101, -61440
  s_nop 0
  buffer_load_dwordx4 v232, s[16:19], s57 offen lds
  s_add_u32 m0, s101, -60416
  s_nop 0
  buffer_load_dwordx4 v233, s[16:19], s57 offen lds
  s_add_u32 m0, s101, -59392
  s_nop 0
  buffer_load_dwordx4 v234, s[16:19], s57 offen lds
  s_add_u32 m0, s101, -58368
  s_nop 0
  buffer_load_dwordx4 v235, s[16:19], s57 offen lds
  s_add_u32 m0, s101, -57344
  s_nop 0
  buffer_load_dwordx4 v236, s[16:19], s57 offen lds
  s_add_u32 m0, s101, -56320
  s_nop 0
  buffer_load_dwordx4 v237, s[16:19], s57 offen lds
  s_add_u32 m0, s101, -55296
  s_nop 0
  buffer_load_dwordx4 v238, s[16:19], s57 offen lds
  s_add_u32 m0, s101, -54784
  s_nop 0
  buffer_load_dwordx4 v239, s[16:19], s57 offen lds
M_pa:
  ds_read_b128 v[200:203], v254 offset:0
  ds_read_b128 v[204:207], v254 offset:1024
  ds_read_b128 v[208:211], v254 offset:2048
  ds_read_b128 v[212:215], v254 offset:3072
  ds_read_b128 v[216:219], v254 offset:4096
  ds_read_b128 v[220:223], v254 offset:5120
  s_waitcnt lgkmcnt(5)
  v_mfma_f32_16x16x32_bf16 v[168:171], v[200:203], v[16:19], 0
  ds_read_b128 v[224:227], v254 offset:6144
  v_mfma_f32_16x16x32_bf16 v[176:179], v[200:203], v[40:43], 0
  s_waitcnt lgkmcnt(5)
  v_mfma_f32_16x16x32_bf16 v[172:175], v[204:207], v[16:19], 0
  ds_read_b128 v[228:231], v254 offset:7168
  v_mfma_f32_16x16x32_bf16 v[180:183], v[204:207], v[40:43], 0
  s_waitcnt lgkmcnt(5)
  v_mfma_f32_16x16x32_bf16 v[168:171], v[208:211], v[20:23], v[168:171]
  ds_read_b128 v[200:203], v254 offset:8192
  v_mfma_f32_16x16x32_bf16 v[176:179], v[208:211], v[44:47], v[176:179]
  s_waitcnt lgkmcnt(5)
  v_mfma_f32_16x16x32_bf16 v[172:175], v[212:215], v[20:23], v[172:175]
  ds_read_b128 v[204:207], v254 offset:9216
  v_mfma_f32_16x16x32_bf16 v[180:183], v[212:215], v[44:47], v[180:183]
  s_waitcnt lgkmcnt(5)
  v_mfma_f32_16x16x32_bf16 v[168:171], v[216:219], v[24:27], v[168:171]
  ds_read_b128 v[208:211], v254 offset:10240
  v_mfma_f32_16x16x32_bf16 v[176:179], v[216:219], v[48:51], v[176:179]
  s_waitcnt lgkmcnt(5)
  v_mfma_f32_16x16x32_bf16 v[172:175], v[220:223], v[24:27], v[172:175]
  ds_read_b128 v[212:215], v254 offset:11264
  v_mfma_f32_16x16x32_bf16 v[180:183], v[220:223], v[48:51], v[180:183]
  s_waitcnt lgkmcnt(5)
  v_mfma_f32_16x16x32_bf16 v[168:171], v[224:227], v[28:31], v[168:171]
  ds_read_b128 v[216:219], v254 offset:12288
  v_mfma_f32_16x16x32_bf16 v[176:179], v[224:227], v[52:55], v[176:179]
  s_waitcnt lgkmcnt(5)
  v_mfma_f32_16x16x32_bf16 v[172:175], v[228:231], v[28:31], v[172:175]
  ds_read_b128 v[220:223], v254 offset:13312
  v_mfma_f32_16x16x32_bf16 v[180:183], v[228:231], v[52:55], v[180:183]
  s_waitcnt lgkmcnt(5)
  v_mfma_f32_16x16x32_bf16 v[168:171], v[200:203], v[32:35], v[168:171]
  ds_read_b128 v[224:227], v254 offset:14336
  v_mfma_f32_16x16x32_bf16 v[176:179], v[200:203], v[56:59], v[176:179]
  s_waitcnt lgkmcnt(5)
  v_mfma_f32_16x16x32_bf16 v[172:175], v[204:207], v[32:35], v[172:175]
  ds_read_b128 v[228:231], v254 offset:15360
  v_mfma_f32_16x16x32_bf16 v[180:183], v[204:207], v[56:59], v[180:183]
  s_waitcnt lgkmcnt(5)
  v_mfma_f32_16x16x32_bf16 v[168:171], v[208:211], v[36:39], v[168:171]
  ds_read_b128 v[200:203], v254 offset:16384
  v_mfma_f32_16x16x32_bf16 v[176:179], v[208:211], v[60:63], v[176:179]
  s_waitcnt lgkmcnt(5)
  v_mfma_f32_16x16x32_bf16 v[172:175], v[212:215], v[36:39], v[172:175]
  ds_read_b128 v[204:207], v254 offset:17408
  v_mfma_f32_16x16x32_bf16 v[180:183], v[212:215], v[60:63], v[180:183]
  s_waitcnt lgkmcnt(5)
  v_mfma_f32_16x16x32_bf16 v[184:187], v[216:219], v[16:19], 0
  ds_read_b128 v[208:211], v254 offset:18432
  v_mfma_f32_16x16x32_bf16 v[192:195], v[216:219], v[40:43], 0
  s_waitcnt lgkmcnt(5)
  v_mfma_f32_16x16x32_bf16 v[188:191], v[220:223], v[16:19], 0
  ds_read_b128 v[212:215], v254 offset:19456
  v_cvt_pk_bf16_f32 v120, v168, v169
  v_mfma_f32_16x16x32_bf16 v[196:199], v[220:223], v[40:43], 0
  s_waitcnt lgkmcnt(5)
  v_cvt_pk_bf16_f32 v121, v170, v171
  v_cvt_pk_bf16_f32 v122, v172, v173
  v_mfma_f32_16x16x32_bf16 v[184:187], v[224:227], v[20:23], v[184:187]
  ds_read_b128 v[216:219], v254 offset:20480
  v_cvt_pk_bf16_f32 v123, v174, v175
  v_mfma_f32_16x16x32_bf16 v[192:195], v[224:227], v[44:47], v[192:195]
  s_waitcnt lgkmcnt(5)
  v_cvt_pk_bf16_f32 v144, v176, v177
  v_cvt_pk_bf16_f32 v145, v178, v179
  v_mfma_f32_16x16x32_bf16 v[188:191], v[228:231], v[20:23], v[188:191]
  ds_read_b128 v[220:223], v254 offset:21504
  v_cvt_pk_bf16_f32 v146, v180, v181
  v_mfma_f32_16x16x32_bf16 v[196:199], v[228:231], v[44:47], v[196:199]
  s_waitcnt lgkmcnt(5)
  v_cvt_pk_bf16_f32 v147, v182, v183
  v_mfma_f32_16x16x32_bf16 v[184:187], v[200:203], v[24:27], v[184:187]
  ds_read_b128 v[224:227], v254 offset:22528
  v_mfma_f32_16x16x32_bf16 v[192:195], v[200:203], v[48:51], v[192:195]
  s_waitcnt lgkmcnt(5)
  v_mfma_f32_16x16x32_bf16 v[188:191], v[204:207], v[24:27], v[188:191]
  ds_read_b128 v[228:231], v254 offset:23552
  v_mfma_f32_16x16x32_bf16 v[196:199], v[204:207], v[48:51], v[196:199]
  s_waitcnt vmcnt(8)
  s_barrier
  s_waitcnt lgkmcnt(5)
  v_mfma_f32_16x16x32_bf16 v[184:187], v[208:211], v[28:31], v[184:187]
  ds_read_b128 v[200:203], v254 offset:24576
  v_mfma_f32_16x16x32_bf16 v[192:195], v[208:211], v[52:55], v[192:195]
  s_waitcnt lgkmcnt(5)
  v_mfma_f32_16x16x32_bf16 v[188:191], v[212:215], v[28:31], v[188:191]
  ds_read_b128 v[204:207], v254 offset:25600
  v_mfma_f32_16x16x32_bf16 v[196:199], v[212:215], v[52:55], v[196:199]
  s_waitcnt lgkmcnt(5)
  v_mfma_f32_16x16x32_bf16 v[184:187], v[216:219], v[32:35], v[184:187]
  ds_read_b128 v[208:211], v254 offset:26624
  v_mfma_f32_16x16x32_bf16 v[192:195], v[216:219], v[56:59], v[192:195]
  s_waitcnt lgkmcnt(5)
  v_mfma_f32_16x16x32_bf16 v[188:191], v[220:223], v[32:35], v[188:191]
  ds_read_b128 v[212:215], v254 offset:27648
  v_mfma_f32_16x16x32_bf16 v[196:199], v[220:223], v[56:59], v[196:199]
  s_waitcnt lgkmcnt(5)
  v_mfma_f32_16x16x32_bf16 v[184:187], v[224:227], v[36:39], v[184:187]
  ds_read_b128 v[216:219], v254 offset:28672
  v_mfma_f32_16x16x32_bf16 v[192:195], v[224:227], v[60:63], v[192:195]
  s_waitcnt lgkmcnt(5)
  v_mfma_f32_16x16x32_bf16 v[188:191], v[228:231], v[36:39], v[188:191]
  ds_read_b128 v[220:223], v254 offset:29696
  v_mfma_f32_16x16x32_bf16 v[196:199], v[228:231], v[60:63], v[196:199]
  s_waitcnt lgkmcnt(5)
  v_mfma_f32_16x16x32_bf16 v[168:171], v[200:203], v[16:19], 0
  ds_read_b128 v[224:227], v254 offset:30720
  v_mfma_f32_16x16x32_bf16 v[176:179], v[200:203], v[40:43], 0
  s_waitcnt lgkmcnt(5)
  v_mfma_f32_16x16x32_bf16 v[172:175], v[204:207], v[16:19], 0
  ds_read_b128 v[228:231], v254 offset:31744
  v_cvt_pk_bf16_f32 v124, v184, v185
  v_mfma_f32_16x16x32_bf16 v[180:183], v[204:207], v[40:43], 0
  s_waitcnt lgkmcnt(5)
  v_cvt_pk_bf16_f32 v125, v186, v187
  v_cvt_pk_bf16_f32 v126, v188, v189
  v_mfma_f32_16x16x32_bf16 v[168:171], v[208:211], v[20:23], v[168:171]
  ds_read_b128 v[200:203], v254 offset:32768
  v_cvt_pk_bf16_f32 v127, v190, v191
  v_mfma_f32_16x16x32_bf16 v[176:179], v[208:211], v[44:47], v[176:179]
  s_waitcnt lgkmcnt(5)
  v_cvt_pk_bf16_f32 v148, v192, v193
  v_cvt_pk_bf16_f32 v149, v194, v195
  v_mfma_f32_16x16x32_bf16 v[172:175], v[212:215], v[20:23], v[172:175]
  ds_read_b128 v[204:207], v254 offset:33792
  v_cvt_pk_bf16_f32 v150, v196, v197
  v_mfma_f32_16x16x32_bf16 v[180:183], v[212:215], v[44:47], v[180:183]
  s_waitcnt lgkmcnt(5)
  v_cvt_pk_bf16_f32 v151, v198, v199
  v_mfma_f32_16x16x32_bf16 v[168:171], v[216:219], v[24:27], v[168:171]
  ds_read_b128 v[208:211], v254 offset:34816
  v_mfma_f32_16x16x32_bf16 v[176:179], v[216:219], v[48:51], v[176:179]
  s_waitcnt lgkmcnt(5)
  v_mfma_f32_16x16x32_bf16 v[172:175], v[220:223], v[24:27], v[172:175]
  ds_read_b128 v[212:215], v254 offset:35840
  v_mfma_f32_16x16x32_bf16 v[180:183], v[220:223], v[48:51], v[180:183]
  s_waitcnt lgkmcnt(5)
  v_mfma_f32_16x16x32_bf16 v[168:171], v[224:227], v[28:31], v[168:171]
  ds_read_b128 v[216:219], v254 offset:36864
  v_mfma_f32_16x16x32_bf16 v[176:179], v[224:227], v[52:55], v[176:179]
  s_waitcnt lgkmcnt(5)
  v_mfma_f32_16x16x32_bf16 v[172:175], v[228:231], v[28:31], v[172:175]
  ds_read_b128 v[220:223], v254 offset:37888
  v_mfma_f32_16x16x32_bf16 v[180:183], v[228:231], v[52:55], v[180:183]
  s_waitcnt lgkmcnt(5)
  v_mfma_f32_16x16x32_bf16 v[168:171], v[200:203], v[32:35], v[168:171]
  ds_read_b128 v[224:227], v254 offset:38912
  v_mfma_f32_16x16x32_bf16 v[176:179], v[200:203], v[56:59], v[176:179]
  s_waitcnt lgkmcnt(5)
  v_mfma_f32_16x16x32_bf16 v[172:175], v[204:207], v[32:35], v[172:175]
  ds_read_b128 v[228:231], v254 offset:39936
  v_mfma_f32_16x16x32_bf16 v[180:183], v[204:207], v[56:59], v[180:183]
  s_waitcnt lgkmcnt(5)
  v_mfma_f32_16x16x32_bf16 v[168:171], v[208:211], v[36:39], v[168:171]
  ds_read_b128 v[200:203], v254 offset:40960
  v_mfma_f32_16x16x32_bf16 v[176:179], v[208:211], v[60:63], v[176:179]
  s_waitcnt lgkmcnt(5)
  v_mfma_f32_16x16x32_bf16 v[172:175], v[212:215], v[36:39], v[172:175]
  ds_read_b128 v[204:207], v254 offset:41984
  v_mfma_f32_16x16x32_bf16 v[180:183], v[212:215], v[60:63], v[180:183]
  s_barrier
  s_waitcnt lgkmcnt(5)
  v_mfma_f32_16x16x32_bf16 v[184:187], v[216:219], v[16:19], 0
  ds_read_b128 v[208:211], v254 offset:43008
  v_mfma_f32_16x16x32_bf16 v[192:195], v[216:219], v[40:43], 0
  s_waitcnt lgkmcnt(5)
  v_mfma_f32_16x16x32_bf16 v[188:191], v[220:223], v[16:19], 0
  ds_read_b128 v[212:215], v254 offset:44032
  v_cvt_pk_bf16_f32 v128, v168, v169
  v_mfma_f32_16x16x32_bf16 v[196:199], v[220:223], v[40:43], 0
  s_waitcnt lgkmcnt(5)
  v_cvt_pk_bf16_f32 v129, v170, v171
  v_cvt_pk_bf16_f32 v130, v172, v173
  v_mfma_f32_16x16x32_bf16 v[184:187], v[224:227], v[20:23], v[184:187]
  ds_read_b128 v[216:219], v254 offset:45056
  v_cvt_pk_bf16_f32 v131, v174, v175
  v_mfma_f32_16x16x32_bf16 v[192:195], v[224:227], v[44:47], v[192:195]
  s_waitcnt lgkmcnt(5)
  v_cvt_pk_bf16_f32 v152, v176, v177
  v_cvt_pk_bf16_f32 v153, v178, v179
  v_mfma_f32_16x16x32_bf16 v[188:191], v[228:231], v[20:23], v[188:191]
  ds_read_b128 v[220:223], v254 offset:46080
  v_cvt_pk_bf16_f32 v154, v180, v181
  v_mfma_f32_16x16x32_bf16 v[196:199], v[228:231], v[44:47], v[196:199]
  s_waitcnt lgkmcnt(5)
  v_cvt_pk_bf16_f32 v155, v182, v183
  v_mfma_f32_16x16x32_bf16 v[184:187], v[200:203], v[24:27], v[184:187]
  ds_read_b128 v[224:227], v254 offset:47104
  v_mfma_f32_16x16x32_bf16 v[192:195], v[200:203], v[48:51], v[192:195]
  s_waitcnt lgkmcnt(5)
  v_mfma_f32_16x16x32_bf16 v[188:191], v[204:207], v[24:27], v[188:191]
  ds_read_b128 v[228:231], v254 offset:48128
  v_mfma_f32_16x16x32_bf16 v[196:199], v[204:207], v[48:51], v[196:199]
  s_waitcnt lgkmcnt(5)
  v_mfma_f32_16x16x32_bf16 v[184:187], v[208:211], v[28:31], v[184:187]
  ds_read_b128 v[200:203], v254 offset:49152
  v_mfma_f32_16x16x32_bf16 v[192:195], v[208:211], v[52:55], v[192:195]
  s_waitcnt lgkmcnt(5)
  v_mfma_f32_16x16x32_bf16 v[188:191], v[212:215], v[28:31], v[188:191]
  ds_read_b128 v[204:207], v254 offset:50176
  v_mfma_f32_16x16x32_bf16 v[196:199], v[212:215], v[52:55], v[196:199]
  s_waitcnt lgkmcnt(5)
  v_mfma_f32_16x16x32_bf16 v[184:187], v[216:219], v[32:35], v[184:187]
  ds_read_b128 v[208:211], v254 offset:51200
  v_mfma_f32_16x16x32_bf16 v[192:195], v[216:219], v[56:59], v[192:195]
  s_waitcnt lgkmcnt(5)
  v_mfma_f32_16x16x32_bf16 v[188:191], v[220:223], v[32:35], v[188:191]
  ds_read_b128 v[212:215], v254 offset:52224
  v_mfma_f32_16x16x32_bf16 v[196:199], v[220:223], v[56:59], v[196:199]
  s_waitcnt lgkmcnt(5)
  v_mfma_f32_16x16x32_bf16 v[184:187], v[224:227], v[36:39], v[184:187]
  ds_read_b128 v[216:219], v254 offset:53248
  v_mfma_f32_16x16x32_bf16 v[192:195], v[224:227], v[60:63], v[192:195]
  s_waitcnt lgkmcnt(5)
  v_mfma_f32_16x16x32_bf16 v[188:191], v[228:231], v[36:39], v[188:191]
  ds_read_b128 v[220:223], v254 offset:54272
  v_mfma_f32_16x16x32_bf16 v[196:199], v[228:231], v[60:63], v[196:199]
  s_waitcnt lgkmcnt(5)
  v_mfma_f32_16x16x32_bf16 v[168:171], v[200:203], v[16:19], 0
  ds_read_b128 v[224:227], v254 offset:55296
  v_mfma_f32_16x16x32_bf16 v[176:179], v[200:203], v[40:43], 0
  s_waitcnt lgkmcnt(5)
  ds_read_b128 v[232:235], v254 offset:61440
  v_mfma_f32_16x16x32_bf16 v[172:175], v[204:207], v[16:19], 0
  ds_read_b128 v[228:231], v254 offset:56320
  v_cvt_pk_bf16_f32 v132, v184, v185
  v_mfma_f32_16x16x32_bf16 v[180:183], v[204:207], v[40:43], 0
  s_waitcnt lgkmcnt(6)
  ds_read_b128 v[236:239], v254 offset:62464
  v_cvt_pk_bf16_f32 v133, v186, v187
  v_mfma_f32_16x16x32_bf16 v[168:171], v[208:211], v[20:23], v[168:171]
  ds_read_b128 v[200:203], v254 offset:57344
  v_cvt_pk_bf16_f32 v134, v188, v189
  v_mfma_f32_16x16x32_bf16 v[176:179], v[208:211], v[44:47], v[176:179]
  s_waitcnt lgkmcnt(7)
  v_cvt_pk_bf16_f32 v135, v190, v191
  v_cvt_pk_bf16_f32 v156, v192, v193
  v_mfma_f32_16x16x32_bf16 v[172:175], v[212:215], v[20:23], v[172:175]
  ds_read_b128 v[204:207], v254 offset:58368
  v_cvt_pk_bf16_f32 v157, v194, v195
  v_mfma_f32_16x16x32_bf16 v[180:183], v[212:215], v[44:47], v[180:183]
  s_waitcnt lgkmcnt(7)
  v_cvt_pk_bf16_f32 v158, v196, v197
  v_cvt_pk_bf16_f32 v159, v198, v199
  v_mfma_f32_16x16x32_bf16 v[168:171], v[216:219], v[24:27], v[168:171]
  ds_read_b128 v[208:211], v254 offset:59392
  v_mfma_f32_16x16x32_bf16 v[176:179], v[216:219], v[48:51], v[176:179]
  s_waitcnt lgkmcnt(7)
  v_mfma_f32_16x16x32_bf16 v[172:175], v[220:223], v[24:27], v[172:175]
  ds_read_b128 v[212:215], v254 offset:60416
  v_mfma_f32_16x16x32_bf16 v[180:183], v[220:223], v[48:51], v[180:183]
  s_waitcnt lgkmcnt(7)
  v_mfma_f32_16x16x32_bf16 v[168:171], v[224:227], v[28:31], v[168:171]
  v_mfma_f32_16x16x32_bf16 v[176:179], v[224:227], v[52:55], v[176:179]
  s_waitcnt lgkmcnt(5)
  v_mfma_f32_16x16x32_bf16 v[172:175], v[228:231], v[28:31], v[172:175]
  v_mfma_f32_16x16x32_bf16 v[180:183], v[228:231], v[52:55], v[180:183]
  s_waitcnt lgkmcnt(3)
  v_mfma_f32_16x16x32_bf16 v[168:171], v[200:203], v[32:35], v[168:171]
  ds_read_b128 v[224:227], v253 offset:0
  v_mfma_f32_16x16x32_bf16 v[176:179], v[200:203], v[56:59], v[176:179]
  s_waitcnt lgkmcnt(3)
  v_mfma_f32_16x16x32_bf16 v[172:175], v[204:207], v[32:35], v[172:175]
  ds_read_b128 v[228:231], v253 offset:1024
  v_mfma_f32_16x16x32_bf16 v[180:183], v[204:207], v[56:59], v[180:183]
  s_waitcnt lgkmcnt(3)
  v_mfma_f32_16x16x32_bf16 v[168:171], v[208:211], v[36:39], v[168:171]
  ds_read_b128 v[200:203], v253 offset:2048
  v_mfma_f32_16x16x32_bf16 v[176:179], v[208:211], v[60:63], v[176:179]
  s_waitcnt lgkmcnt(3)
  v_mfma_f32_16x16x32_bf16 v[172:175], v[212:215], v[36:39], v[172:175]
  ds_read_b128 v[204:207], v253 offset:3072
  v_mfma_f32_16x16x32_bf16 v[180:183], v[212:215], v[60:63], v[180:183]
  s_waitcnt vmcnt(0)
  s_barrier
  s_setprio 2
  s_cmp_lt_u32 s40, 4
  s_cbranch_scc1 M_pr1
  s_setprio 3
M_pr1:
  v_mfma_f32_16x16x32_bf16 v[184:187], v[232:235], v[16:19], 0
  ds_read_b128 v[208:211], v253 offset:4096
  v_mfma_f32_16x16x32_bf16 v[192:195], v[232:235], v[40:43], 0
  v_mfma_f32_16x16x32_bf16 v[188:191], v[236:239], v[16:19], 0
  ds_read_b128 v[212:215], v253 offset:5120
  v_cvt_pk_bf16_f32 v136, v168, v169
  v_mfma_f32_16x16x32_bf16 v[196:199], v[236:239], v[40:43], 0
  s_waitcnt lgkmcnt(5)
  v_cvt_pk_bf16_f32 v137, v170, v171
  v_cvt_pk_bf16_f32 v138, v172, v173
  v_mfma_f32_16x16x32_bf16 v[184:187], v[224:227], v[20:23], v[184:187]
  ds_read_b128 v[216:219], v253 offset:6144
  v_cvt_pk_bf16_f32 v139, v174, v175
  v_mfma_f32_16x16x32_bf16 v[192:195], v[224:227], v[44:47], v[192:195]
  s_waitcnt lgkmcnt(5)
  v_cvt_pk_bf16_f32 v160, v176, v177
  v_cvt_pk_bf16_f32 v161, v178, v179
  v_mfma_f32_16x16x32_bf16 v[188:191], v[228:231], v[20:23], v[188:191]
  ds_read_b128 v[220:223], v253 offset:7168
  v_cvt_pk_bf16_f32 v162, v180, v181
  v_mfma_f32_16x16x32_bf16 v[196:199], v[228:231], v[44:47], v[196:199]
  s_waitcnt lgkmcnt(5)
  v_cvt_pk_bf16_f32 v163, v182, v183
  v_mfma_f32_16x16x32_bf16 v[184:187], v[200:203], v[24:27], v[184:187]
  ds_read_b128 v[224:227], v253 offset:8192
  v_mfma_f32_16x16x32_bf16 v[192:195], v[200:203], v[48:51], v[192:195]
  s_waitcnt lgkmcnt(5)
  v_mfma_f32_16x16x32_bf16 v[188:191], v[204:207], v[24:27], v[188:191]
  ds_read_b128 v[228:231], v253 offset:9216
  v_mfma_f32_16x16x32_bf16 v[196:199], v[204:207], v[48:51], v[196:199]
  s_cmp_ge_u32 s40, 4
  s_cbranch_scc1 M_l1
  s_waitcnt lgkmcnt(0)
  s_barrier
M_l1:
  s_waitcnt lgkmcnt(5)
  v_mfma_f32_16x16x32_bf16 v[184:187], v[208:211], v[28:31], v[184:187]
  ds_read_b128 v[200:203], v240 offset:0
  v_mfma_f32_16x16x32_bf16 v[192:195], v[208:211], v[52:55], v[192:195]
  s_waitcnt lgkmcnt(5)
  v_mfma_f32_16x16x32_bf16 v[188:191], v[212:215], v[28:31], v[188:191]
  ds_read_b128 v[204:207], v240 offset:2304
  v_mfma_f32_16x16x32_bf16 v[196:199], v[212:215], v[52:55], v[196:199]
  s_waitcnt lgkmcnt(5)
  v_mfma_f32_16x16x32_bf16 v[184:187], v[216:219], v[32:35], v[184:187]
  ds_read_b128 v[208:211], v241 offset:0
  v_mfma_f32_16x16x32_bf16 v[192:195], v[216:219], v[56:59], v[192:195]
  s_waitcnt lgkmcnt(5)
  v_mfma_f32_16x16x32_bf16 v[188:191], v[220:223], v[32:35], v[188:191]
  ds_read_b128 v[212:215], v241 offset:2304
  v_mfma_f32_16x16x32_bf16 v[196:199], v[220:223], v[56:59], v[196:199]
  s_waitcnt lgkmcnt(5)
  v_mfma_f32_16x16x32_bf16 v[184:187], v[224:227], v[36:39], v[184:187]
  ds_read_b128 v[216:219], v242 offset:0
  v_mfma_f32_16x16x32_bf16 v[192:195], v[224:227], v[60:63], v[192:195]
  s_waitcnt lgkmcnt(5)
  v_mfma_f32_16x16x32_bf16 v[188:191], v[228:231], v[36:39], v[188:191]
  ds_read_b128 v[220:223], v242 offset:2304
  v_mfma_f32_16x16x32_bf16 v[196:199], v[228:231], v[60:63], v[196:199]
  ds_read_b128 v[224:227], v243 offset:0
  s_mov_b32 s56, 0xff7fffff
  s_waitcnt lgkmcnt(6)
  v_mfma_f32_16x16x32_bf16 v[64:67], v[200:203], v[120:123], v[64:67]
  s_waitcnt lgkmcnt(5)
  ds_read_b128 v[228:231], v243 offset:2304
  v_mov_b32 v32, 0
  v_mfma_f32_16x16x32_bf16 v[76:79], v[204:207], v[120:123], v[76:79]
  v_mov_b32 v33, 0
  v_mov_b32 v48, 0x3f803f80
  v_mfma_f32_16x16x32_bf16 v[88:91], v[204:207], v[144:147], v[88:91]
  s_waitcnt lgkmcnt(5)
  ds_read_b128 v[200:203], v240 offset:256
  v_mov_b32 v49, 0x3f803f80
  v_mfma_f32_16x16x32_bf16 v[64:67], v[208:211], v[124:127], v[64:67]
  s_waitcnt lgkmcnt(5)
  ds_read_b128 v[204:207], v240 offset:2560
  v_cvt_pk_bf16_f32 v140, v184, v185
  v_mfma_f32_16x16x32_bf16 v[76:79], v[212:215], v[124:127], v[76:79]
  v_cvt_pk_bf16_f32 v141, v186, v187
  v_cvt_pk_bf16_f32 v142, v188, v189
  v_mfma_f32_16x16x32_bf16 v[88:91], v[212:215], v[148:151], v[88:91]
  s_waitcnt lgkmcnt(5)
  ds_read_b128 v[208:211], v241 offset:256
  v_cvt_pk_bf16_f32 v143, v190, v191
  v_mfma_f32_16x16x32_bf16 v[64:67], v[216:219], v[128:131], v[64:67]
  s_waitcnt lgkmcnt(5)
  ds_read_b128 v[212:215], v241 offset:2560
  v_cvt_pk_bf16_f32 v164, v192, v193
  v_mfma_f32_16x16x32_bf16 v[76:79], v[220:223], v[128:131], v[76:79]
  v_cvt_pk_bf16_f32 v165, v194, v195
  v_cvt_pk_bf16_f32 v166, v196, v197
  v_mfma_f32_16x16x32_bf16 v[88:91], v[220:223], v[152:155], v[88:91]
  s_waitcnt lgkmcnt(5)
  ds_read_b128 v[216:219], v240 offset:768
  v_cvt_pk_bf16_f32 v167, v198, v199
  v_mfma_f32_16x16x32_bf16 v[64:67], v[224:227], v[132:135], v[64:67]
  s_waitcnt lgkmcnt(5)
  ds_read_b128 v[220:223], v240 offset:3072
  v_mov_b32 v50, 0x3f803f80
  v_mfma_f32_16x16x32_bf16 v[76:79], v[228:231], v[132:135], v[76:79]
  v_mov_b32 v51, 0x3f803f80
  v_mfma_f32_16x16x32_bf16 v[88:91], v[228:231], v[156:159], v[88:91]
  s_waitcnt lgkmcnt(5)
  ds_read_b128 v[224:227], v241 offset:768
  v_mfma_f32_16x16x32_bf16 v[64:67], v[200:203], v[136:139], v[64:67]
  s_waitcnt lgkmcnt(5)
  ds_read_b128 v[228:231], v241 offset:3072
  v_mfma_f32_16x16x32_bf16 v[76:79], v[204:207], v[136:139], v[76:79]
  v_mfma_f32_16x16x32_bf16 v[88:91], v[204:207], v[160:163], v[88:91]
  s_waitcnt lgkmcnt(5)
  ds_read_b128 v[200:203], v242 offset:768
  v_mfma_f32_16x16x32_bf16 v[64:67], v[208:211], v[140:143], v[64:67]
  s_waitcnt lgkmcnt(5)
  ds_read_b128 v[204:207], v242 offset:3072
  v_mfma_f32_16x16x32_bf16 v[76:79], v[212:215], v[140:143], v[76:79]
  v_mfma_f32_16x16x32_bf16 v[88:91], v[212:215], v[164:167], v[88:91]
  s_waitcnt lgkmcnt(5)
  ds_read_b128 v[208:211], v243 offset:768
  v_mfma_f32_16x16x32_bf16 v[68:71], v[216:219], v[120:123], v[68:71]
  s_waitcnt lgkmcnt(5)
  ds_read_b128 v[212:215], v243 offset:3072
  v_mfma_f32_16x16x32_bf16 v[80:83], v[220:223], v[120:123], v[80:83]
  v_max3_f32 v12, v64, v65, s56
  v_max3_f32 v12, v66, v67, v12
  v_mfma_f32_16x16x32_bf16 v[92:95], v[220:223], v[144:147], v[92:95]
  s_waitcnt lgkmcnt(5)
  ds_read_b128 v[216:219], v240 offset:1024
  v_max3_f32 v12, v76, v77, v12
  v_mfma_f32_16x16x32_bf16 v[68:71], v[224:227], v[124:127], v[68:71]
  s_waitcnt lgkmcnt(5)
  ds_read_b128 v[220:223], v240 offset:3328
  v_max3_f32 v12, v78, v79, v12
  v_mfma_f32_16x16x32_bf16 v[80:83], v[228:231], v[124:127], v[80:83]
  v_max3_f32 v13, v88, v89, s56
  v_max3_f32 v13, v90, v91, v13
  v_mfma_f32_16x16x32_bf16 v[92:95], v[228:231], v[148:151], v[92:95]
  s_waitcnt lgkmcnt(5)
  ds_read_b128 v[224:227], v241 offset:1024
  v_mfma_f32_16x16x32_bf16 v[68:71], v[200:203], v[128:131], v[68:71]
  s_waitcnt lgkmcnt(5)
  ds_read_b128 v[228:231], v241 offset:3328
  v_mfma_f32_16x16x32_bf16 v[80:83], v[204:207], v[128:131], v[80:83]
  v_mfma_f32_16x16x32_bf16 v[92:95], v[204:207], v[152:155], v[92:95]
  s_waitcnt lgkmcnt(5)
  ds_read_b128 v[200:203], v240 offset:1536
  v_mfma_f32_16x16x32_bf16 v[68:71], v[208:211], v[132:135], v[68:71]
  s_waitcnt lgkmcnt(5)
  ds_read_b128 v[204:207], v240 offset:3840
  v_mfma_f32_16x16x32_bf16 v[80:83], v[212:215], v[132:135], v[80:83]
  v_mfma_f32_16x16x32_bf16 v[92:95], v[212:215], v[156:159], v[92:95]
  s_waitcnt lgkmcnt(5)
  ds_read_b128 v[208:211], v241 offset:1536
  v_mfma_f32_16x16x32_bf16 v[68:71], v[216:219], v[136:139], v[68:71]
  s_waitcnt lgkmcnt(5)
  ds_read_b128 v[212:215], v241 offset:3840
  v_mfma_f32_16x16x32_bf16 v[80:83], v[220:223], v[136:139], v[80:83]
  v_mfma_f32_16x16x32_bf16 v[92:95], v[220:223], v[160:163], v[92:95]
  s_waitcnt lgkmcnt(5)
  ds_read_b128 v[216:219], v242 offset:1536
  v_mfma_f32_16x16x32_bf16 v[68:71], v[224:227], v[140:143], v[68:71]
  s_waitcnt lgkmcnt(5)
  ds_read_b128 v[220:223], v242 offset:3840
  v_mfma_f32_16x16x32_bf16 v[80:83], v[228:231], v[140:143], v[80:83]
  v_mfma_f32_16x16x32_bf16 v[92:95], v[228:231], v[164:167], v[92:95]
  s_waitcnt lgkmcnt(5)
  ds_read_b128 v[224:227], v243 offset:1536
  v_mfma_f32_16x16x32_bf16 v[72:75], v[200:203], v[120:123], v[72:75]
  s_waitcnt lgkmcnt(5)
  ds_read_b128 v[228:231], v243 offset:3840
  v_mfma_f32_16x16x32_bf16 v[84:87], v[204:207], v[120:123], v[84:87]
  v_max3_f32 v12, v68, v69, v12
  v_max3_f32 v12, v70, v71, v12
  v_mfma_f32_16x16x32_bf16 v[96:99], v[204:207], v[144:147], v[96:99]
  s_waitcnt lgkmcnt(5)
  ds_read_b128 v[200:203], v240 offset:1792
  v_max3_f32 v12, v80, v81, v12
  v_mfma_f32_16x16x32_bf16 v[72:75], v[208:211], v[124:127], v[72:75]
  s_waitcnt lgkmcnt(5)
  ds_read_b128 v[204:207], v240 offset:4096
  v_max3_f32 v12, v82, v83, v12
  v_mfma_f32_16x16x32_bf16 v[84:87], v[212:215], v[124:127], v[84:87]
  v_max3_f32 v13, v92, v93, v13
  v_max3_f32 v13, v94, v95, v13
  v_mfma_f32_16x16x32_bf16 v[96:99], v[212:215], v[148:151], v[96:99]
  s_waitcnt lgkmcnt(5)
  ds_read_b128 v[208:211], v241 offset:1792
  v_mfma_f32_16x16x32_bf16 v[72:75], v[216:219], v[128:131], v[72:75]
  s_waitcnt lgkmcnt(5)
  ds_read_b128 v[212:215], v241 offset:4096
  v_mfma_f32_16x16x32_bf16 v[84:87], v[220:223], v[128:131], v[84:87]
  v_mfma_f32_16x16x32_bf16 v[96:99], v[220:223], v[152:155], v[96:99]
  s_waitcnt lgkmcnt(5)
  ds_read_b128 v[216:219], v240 offset:4608
  v_mfma_f32_16x16x32_bf16 v[72:75], v[224:227], v[132:135], v[72:75]
  s_waitcnt lgkmcnt(5)
  ds_read_b128 v[220:223], v240 offset:5376
  v_mfma_f32_16x16x32_bf16 v[84:87], v[228:231], v[132:135], v[84:87]
  v_mfma_f32_16x16x32_bf16 v[96:99], v[228:231], v[156:159], v[96:99]
  s_waitcnt lgkmcnt(5)
  ds_read_b128 v[224:227], v241 offset:4608
  v_mfma_f32_16x16x32_bf16 v[72:75], v[200:203], v[136:139], v[72:75]
  s_waitcnt lgkmcnt(5)
  ds_read_b128 v[228:231], v241 offset:5376
  v_mfma_f32_16x16x32_bf16 v[84:87], v[204:207], v[136:139], v[84:87]
  v_mfma_f32_16x16x32_bf16 v[96:99], v[204:207], v[160:163], v[96:99]
  s_waitcnt lgkmcnt(5)
  ds_read_b128 v[200:203], v242 offset:4608
  v_mfma_f32_16x16x32_bf16 v[72:75], v[208:211], v[140:143], v[72:75]
  s_waitcnt lgkmcnt(5)
  ds_read_b128 v[204:207], v242 offset:5376
  v_mfma_f32_16x16x32_bf16 v[84:87], v[212:215], v[140:143], v[84:87]
  v_mfma_f32_16x16x32_bf16 v[96:99], v[212:215], v[164:167], v[96:99]
  s_waitcnt lgkmcnt(5)
  ds_read_b128 v[208:211], v243 offset:4608
  v_mfma_f32_16x16x32_bf16 v[100:103], v[216:219], v[144:147], v[100:103]
  s_waitcnt lgkmcnt(5)
  ds_read_b128 v[212:215], v243 offset:5376
  v_mfma_f32_16x16x32_bf16 v[104:107], v[220:223], v[144:147], v[104:107]
  s_waitcnt lgkmcnt(5)
  ds_read_b128 v[216:219], v240 offset:4864
  v_max3_f32 v12, v72, v73, v12
  v_mfma_f32_16x16x32_bf16 v[100:103], v[224:227], v[148:151], v[100:103]
  s_waitcnt lgkmcnt(5)
  ds_read_b128 v[220:223], v240 offset:5632
  v_max3_f32 v12, v74, v75, v12
  v_mfma_f32_16x16x32_bf16 v[104:107], v[228:231], v[148:151], v[104:107]
  s_waitcnt lgkmcnt(5)
  ds_read_b128 v[224:227], v241 offset:4864
  v_max3_f32 v12, v84, v85, v12
  v_mfma_f32_16x16x32_bf16 v[100:103], v[200:203], v[152:155], v[100:103]
  s_waitcnt lgkmcnt(5)
  ds_read_b128 v[228:231], v241 offset:5632
  v_max3_f32 v12, v86, v87, v12
  v_mfma_f32_16x16x32_bf16 v[104:107], v[204:207], v[152:155], v[104:107]
  s_waitcnt lgkmcnt(5)
  ds_read_b128 v[200:203], v240 offset:6144
  v_max3_f32 v13, v96, v97, v13
  v_mfma_f32_16x16x32_bf16 v[100:103], v[208:211], v[156:159], v[100:103]
  s_waitcnt lgkmcnt(5)
  ds_read_b128 v[204:207], v240 offset:6912
  v_max3_f32 v13, v98, v99, v13
  v_mfma_f32_16x16x32_bf16 v[104:107], v[212:215], v[156:159], v[104:107]
  s_waitcnt lgkmcnt(5)
  ds_read_b128 v[208:211], v241 offset:6144
  v_mov_b32 v14, v12
  v_mfma_f32_16x16x32_bf16 v[100:103], v[216:219], v[160:163], v[100:103]
  s_waitcnt lgkmcnt(5)
  ds_read_b128 v[212:215], v241 offset:6912
  v_permlane32_swap_b32 v12, v14
  v_mfma_f32_16x16x32_bf16 v[104:107], v[220:223], v[160:163], v[104:107]
  s_waitcnt lgkmcnt(5)
  ds_read_b128 v[216:219], v242 offset:6144
  v_max_f32 v12, v12, v14
  v_mfma_f32_16x16x32_bf16 v[100:103], v[224:227], v[164:167], v[100:103]
  s_waitcnt lgkmcnt(5)
  ds_read_b128 v[220:223], v242 offset:6912
  v_mov_b32 v14, v12
  v_mfma_f32_16x16x32_bf16 v[104:107], v[228:231], v[164:167], v[104:107]
  s_waitcnt lgkmcnt(5)
  ds_read_b128 v[224:227], v243 offset:6144
  v_permlane16_swap_b32 v12, v14
  v_mfma_f32_16x16x32_bf16 v[108:111], v[200:203], v[144:147], v[108:111]
  s_waitcnt lgkmcnt(5)
  ds_read_b128 v[228:231], v243 offset:6912
  v_max_f32 v12, v12, v14
  v_mfma_f32_16x16x32_bf16 v[112:115], v[204:207], v[144:147], v[112:115]
  s_waitcnt lgkmcnt(5)
  ds_read_b128 v[200:203], v240 offset:6400
  v_mul_f32 v12, s63, v12
  v_mfma_f32_16x16x32_bf16 v[108:111], v[208:211], v[148:151], v[108:111]
  s_waitcnt lgkmcnt(5)
  ds_read_b128 v[204:207], v240 offset:7168
  v_fma_f32 v64, v64, s63, -v12
  v_mfma_f32_16x16x32_bf16 v[112:115], v[212:215], v[148:151], v[112:115]
  s_waitcnt lgkmcnt(5)
  ds_read_b128 v[208:211], v241 offset:6400
  v_fma_f32 v65, v65, s63, -v12
  v_mfma_f32_16x16x32_bf16 v[108:111], v[216:219], v[152:155], v[108:111]
  s_waitcnt lgkmcnt(5)
  ds_read_b128 v[212:215], v241 offset:7168
  v_fma_f32 v66, v66, s63, -v12
  v_mfma_f32_16x16x32_bf16 v[112:115], v[220:223], v[152:155], v[112:115]
  s_waitcnt lgkmcnt(5)
  v_fma_f32 v67, v67, s63, -v12
  v_fma_f32 v68, v68, s63, -v12
  v_mfma_f32_16x16x32_bf16 v[108:111], v[224:227], v[156:159], v[108:111]
  s_waitcnt lgkmcnt(4)
  v_fma_f32 v69, v69, s63, -v12
  v_fma_f32 v70, v70, s63, -v12
  v_mfma_f32_16x16x32_bf16 v[112:115], v[228:231], v[156:159], v[112:115]
  s_waitcnt lgkmcnt(3)
  v_fma_f32 v71, v71, s63, -v12
  v_fma_f32 v72, v72, s63, -v12
  v_mfma_f32_16x16x32_bf16 v[108:111], v[200:203], v[160:163], v[108:111]
  s_waitcnt lgkmcnt(2)
  v_fma_f32 v73, v73, s63, -v12
  v_fma_f32 v74, v74, s63, -v12
  v_mfma_f32_16x16x32_bf16 v[112:115], v[204:207], v[160:163], v[112:115]
  s_waitcnt lgkmcnt(1)
  v_fma_f32 v75, v75, s63, -v12
  v_fma_f32 v76, v76, s63, -v12
  v_mfma_f32_16x16x32_bf16 v[108:111], v[208:211], v[164:167], v[108:111]
  s_waitcnt lgkmcnt(0)
  v_fma_f32 v77, v77, s63, -v12
  v_fma_f32 v78, v78, s63, -v12
  v_mfma_f32_16x16x32_bf16 v[112:115], v[212:215], v[164:167], v[112:115]
  v_fma_f32 v79, v79, s63, -v12
  v_fma_f32 v80, v80, s63, -v12
  s_setprio 0
  s_cmp_lt_u32 s40, 4
  s_cbranch_scc1 M_pr2
  s_setprio 1
M_pr2:
  v_fma_f32 v81, v81, s63, -v12
  v_fma_f32 v82, v82, s63, -v12
  v_fma_f32 v83, v83, s63, -v12
  v_fma_f32 v84, v84, s63, -v12
  v_fma_f32 v85, v85, s63, -v12
  v_fma_f32 v86, v86, s63, -v12
  v_fma_f32 v87, v87, s63, -v12
  v_max3_f32 v13, v100, v101, v13
  v_max3_f32 v13, v102, v103, v13
  v_max3_f32 v13, v104, v105, v13
  v_max3_f32 v13, v106, v107, v13
  v_max3_f32 v13, v108, v109, v13
  v_max3_f32 v13, v110, v111, v13
  v_max3_f32 v13, v112, v113, v13
  v_max3_f32 v13, v114, v115, v13
  v_mov_b32 v15, v13
  s_nop 1
  v_permlane32_swap_b32 v13, v15
  v_max_f32 v13, v13, v15
  v_mov_b32 v15, v13
  s_nop 1
  v_permlane16_swap_b32 v13, v15
  v_max_f32 v13, v13, v15
  v_mul_f32 v13, s63, v13
  v_exp_f32 v64, v64
  v_exp_f32 v65, v65
  v_exp_f32 v66, v66
  v_exp_f32 v67, v67
  v_fma_f32 v88, v88, s63, -v13
  v_fma_f32 v89, v89, s63, -v13
  v_fma_f32 v90, v90, s63, -v13
  v_fma_f32 v91, v91, s63, -v13
  v_exp_f32 v88, v88
  v_exp_f32 v89, v89
  v_exp_f32 v90, v90
  v_exp_f32 v91, v91
  v_cvt_pk_bf16_f32 v16, v64, v65
  v_cvt_pk_bf16_f32 v17, v66, v67
  v_cvt_pk_bf16_f32 v34, v88, v89
  v_cvt_pk_bf16_f32 v35, v90, v91
  v_exp_f32 v68, v68
  v_exp_f32 v69, v69
  v_exp_f32 v70, v70
  v_exp_f32 v71, v71
  v_fma_f32 v92, v92, s63, -v13
  v_fma_f32 v93, v93, s63, -v13
  v_fma_f32 v94, v94, s63, -v13
  v_fma_f32 v95, v95, s63, -v13
  v_exp_f32 v92, v92
  v_exp_f32 v93, v93
  v_exp_f32 v94, v94
  v_exp_f32 v95, v95
  v_cvt_pk_bf16_f32 v18, v68, v69
  v_cvt_pk_bf16_f32 v19, v70, v71
  v_cvt_pk_bf16_f32 v36, v92, v93
  v_cvt_pk_bf16_f32 v37, v94, v95
  s_cmp_lt_u32 s40, 4
  s_cbranch_scc1 M_e2
  s_barrier
M_e2:
  s_mov_b32 s55, 0
  buffer_load_dwordx4 v[64:67], v252, s[24:27], s55 offen offset:0 sc1
  buffer_load_dwordx4 v[88:91], v252, s[24:27], s55 offen offset:1024 sc1
  buffer_load_dwordx4 v[68:71], v252, s[24:27], s55 offen offset:2048 sc1
  buffer_load_dwordx4 v[92:95], v252, s[24:27], s55 offen offset:3072 sc1
  v_exp_f32 v72, v72
  v_exp_f32 v73, v73
  v_exp_f32 v74, v74
  v_exp_f32 v75, v75
  v_fma_f32 v96, v96, s63, -v13
  v_fma_f32 v97, v97, s63, -v13
  v_fma_f32 v98, v98, s63, -v13
  v_fma_f32 v99, v99, s63, -v13
  v_exp_f32 v96, v96
  v_exp_f32 v97, v97
  v_exp_f32 v98, v98
  v_exp_f32 v99, v99
  v_cvt_pk_bf16_f32 v20, v72, v73
  v_cvt_pk_bf16_f32 v21, v74, v75
  v_cvt_pk_bf16_f32 v38, v96, v97
  v_cvt_pk_bf16_f32 v39, v98, v99
  s_mov_b32 s55, 4096
  buffer_load_dwordx4 v[72:75], v252, s[24:27], s55 offen offset:0 sc1
  buffer_load_dwordx4 v[96:99], v252, s[24:27], s55 offen offset:1024 sc1
  v_exp_f32 v76, v76
  v_exp_f32 v77, v77
  v_exp_f32 v78, v78
  v_exp_f32 v79, v79
  v_fma_f32 v100, v100, s63, -v13
  v_fma_f32 v101, v101, s63, -v13
  v_fma_f32 v102, v102, s63, -v13
  v_fma_f32 v103, v103, s63, -v13
  v_exp_f32 v100, v100
  v_exp_f32 v101, v101
  v_exp_f32 v102, v102
  v_exp_f32 v103, v103
  v_cvt_pk_bf16_f32 v22, v76, v77
  v_cvt_pk_bf16_f32 v23, v78, v79
  v_cvt_pk_bf16_f32 v40, v100, v101
  v_cvt_pk_bf16_f32 v41, v102, v103
  buffer_load_dwordx4 v[76:79], v252, s[24:27], s55 offen offset:2048 sc1
  buffer_load_dwordx4 v[100:103], v252, s[24:27], s55 offen offset:3072 sc1
  v_exp_f32 v80, v80
  v_exp_f32 v81, v81
  v_exp_f32 v82, v82
  v_exp_f32 v83, v83
  v_fma_f32 v104, v104, s63, -v13
  v_fma_f32 v105, v105, s63, -v13
  v_fma_f32 v106, v106, s63, -v13
  v_fma_f32 v107, v107, s63, -v13
  v_exp_f32 v104, v104
  v_exp_f32 v105, v105
  v_exp_f32 v106, v106
  v_exp_f32 v107, v107
  v_cvt_pk_bf16_f32 v24, v80, v81
  v_cvt_pk_bf16_f32 v25, v82, v83
  v_cvt_pk_bf16_f32 v42, v104, v105
  v_cvt_pk_bf16_f32 v43, v106, v107
  s_mov_b32 s55, 8192
  buffer_load_dwordx4 v[80:83], v252, s[24:27], s55 offen offset:0 sc1
  buffer_load_dwordx4 v[104:107], v252, s[24:27], s55 offen offset:1024 sc1
  v_exp_f32 v84, v84
  v_exp_f32 v85, v85
  v_exp_f32 v86, v86
  v_exp_f32 v87, v87
  v_fma_f32 v108, v108, s63, -v13
  v_fma_f32 v109, v109, s63, -v13
  v_fma_f32 v110, v110, s63, -v13
  v_fma_f32 v111, v111, s63, -v13
  v_exp_f32 v108, v108
  v_exp_f32 v109, v109
  v_exp_f32 v110, v110
  v_exp_f32 v111, v111
  v_cvt_pk_bf16_f32 v26, v84, v85
  v_cvt_pk_bf16_f32 v27, v86, v87
  v_cvt_pk_bf16_f32 v44, v108, v109
  v_cvt_pk_bf16_f32 v45, v110, v111
  buffer_load_dwordx4 v[84:87], v252, s[24:27], s55 offen offset:2048 sc1
  buffer_load_dwordx4 v[108:111], v252, s[24:27], s55 offen offset:3072 sc1
  ds_read_b64_tr_b16 v[200:201], v244 offset:0
  ds_read_b64_tr_b16 v[202:203], v244 offset:768
  ds_read_b64_tr_b16 v[204:205], v245 offset:0
  ds_read_b64_tr_b16 v[206:207], v245 offset:768
  ds_read_b64_tr_b16 v[208:209], v244 offset:1536
  ds_read_b64_tr_b16 v[210:211], v244 offset:2304
  ds_read_b64_tr_b16 v[212:213], v245 offset:1536
  ds_read_b64_tr_b16 v[214:215], v245 offset:2304
  ds_read_b64_tr_b16 v[216:217], v244 offset:3072
  ds_read_b64_tr_b16 v[218:219], v244 offset:3840
  ds_read_b64_tr_b16 v[220:221], v245 offset:3072
  ds_read_b64_tr_b16 v[222:223], v245 offset:3840
  v_fma_f32 v112, v112, s63, -v13
  v_fma_f32 v113, v113, s63, -v13
  v_fma_f32 v114, v114, s63, -v13
  v_fma_f32 v115, v115, s63, -v13
  v_exp_f32 v112, v112
  v_exp_f32 v113, v113
  v_exp_f32 v114, v114
  v_exp_f32 v115, v115
  v_cvt_pk_bf16_f32 v46, v112, v113
  v_cvt_pk_bf16_f32 v47, v114, v115
  s_mov_b32 s55, 12288
  buffer_load_dwordx4 v[232:235], v252, s[24:27], s55 offen offset:0 sc1
  buffer_load_dwordx4 v[112:115], v252, s[24:27], s55 offen offset:1024 sc1
  s_cmp_ge_u32 s40, 4
  s_cbranch_scc1 M_l2
  s_barrier
M_l2:
  s_setprio 2
  s_cmp_lt_u32 s40, 4
  s_cbranch_scc1 M_pr3
  s_setprio 3
M_pr3:
  s_waitcnt lgkmcnt(10)
  v_mfma_f32_16x16x32_bf16 v[168:171], v[200:203], v[16:19], 0
  s_waitcnt lgkmcnt(8)
  ds_read_b64_tr_b16 v[224:225], v244 offset:4608
  ds_read_b64_tr_b16 v[226:227], v244 offset:5376
  v_mfma_f32_16x16x32_bf16 v[172:175], v[204:207], v[16:19], 0
  s_waitcnt lgkmcnt(8)
  ds_read_b64_tr_b16 v[228:229], v245 offset:4608
  v_mfma_f32_16x16x32_bf16 v[168:171], v[208:211], v[20:23], v[168:171]
  ds_read_b64_tr_b16 v[230:231], v245 offset:5376
  v_mfma_f32_16x16x32_bf16 v[176:179], v[208:211], v[32:35], 0
  s_waitcnt lgkmcnt(8)
  ds_read_b64_tr_b16 v[200:201], v244 offset:6144
  ds_read_b64_tr_b16 v[202:203], v244 offset:6912
  v_mfma_f32_16x16x32_bf16 v[172:175], v[212:215], v[20:23], v[172:175]
  ds_read_b64_tr_b16 v[204:205], v245 offset:6144
  v_mfma_f32_16x16x32_bf16 v[180:183], v[212:215], v[32:35], 0
  s_waitcnt lgkmcnt(9)
  ds_read_b64_tr_b16 v[206:207], v245 offset:6912
  v_mfma_f32_16x16x32_bf16 v[168:171], v[216:219], v[24:27], v[168:171]
  ds_read_b64_tr_b16 v[208:209], v246 offset:0
  v_mfma_f32_16x16x32_bf16 v[176:179], v[216:219], v[36:39], v[176:179]
  s_waitcnt lgkmcnt(9)
  ds_read_b64_tr_b16 v[210:211], v246 offset:768
  ds_read_b64_tr_b16 v[212:213], v247 offset:0
  v_mfma_f32_16x16x32_bf16 v[172:175], v[220:223], v[24:27], v[172:175]
  ds_read_b64_tr_b16 v[214:215], v247 offset:768
  v_mfma_f32_16x16x32_bf16 v[180:183], v[220:223], v[36:39], v[180:183]
  s_waitcnt lgkmcnt(10)
  ds_read_b64_tr_b16 v[216:217], v246 offset:1536
  v_mfma_f32_16x16x32_bf16 v[176:179], v[224:227], v[40:43], v[176:179]
  s_waitcnt lgkmcnt(9)
  ds_read_b64_tr_b16 v[218:219], v246 offset:2304
  v_mfma_f32_16x16x32_bf16 v[180:183], v[228:231], v[40:43], v[180:183]
  ds_read_b64_tr_b16 v[220:221], v247 offset:1536
  ds_read_b64_tr_b16 v[222:223], v247 offset:2304
  v_mfma_f32_16x16x32_bf16 v[56:59], v[16:19], v[48:51], 0
  s_waitcnt lgkmcnt(10)
  ds_read_b64_tr_b16 v[224:225], v246 offset:3072
  v_mfma_f32_16x16x32_bf16 v[176:179], v[200:203], v[44:47], v[176:179]
  s_waitcnt lgkmcnt(9)
  ds_read_b64_tr_b16 v[226:227], v246 offset:3840
  v_mfma_f32_16x16x32_bf16 v[180:183], v[204:207], v[44:47], v[180:183]
  s_waitcnt lgkmcnt(8)
  ds_read_b64_tr_b16 v[228:229], v247 offset:3072
  ds_read_b64_tr_b16 v[230:231], v247 offset:3840
  v_mfma_f32_16x16x32_bf16 v[184:187], v[208:211], v[16:19], 0
  s_waitcnt lgkmcnt(8)
  ds_read_b64_tr_b16 v[200:201], v246 offset:4608
  v_mfma_f32_16x16x32_bf16 v[188:191], v[212:215], v[16:19], 0
  ds_read_b64_tr_b16 v[202:203], v246 offset:5376
  v_mfma_f32_16x16x32_bf16 v[60:63], v[32:35], v[48:51], 0
  s_waitcnt lgkmcnt(8)
  ds_read_b64_tr_b16 v[204:205], v247 offset:4608
  v_mfma_f32_16x16x32_bf16 v[184:187], v[216:219], v[20:23], v[184:187]
  ds_read_b64_tr_b16 v[206:207], v247 offset:5376
  ds_read_b64_tr_b16 v[208:209], v246 offset:6144
  v_mfma_f32_16x16x32_bf16 v[192:195], v[216:219], v[32:35], 0
  s_waitcnt lgkmcnt(9)
  ds_read_b64_tr_b16 v[210:211], v246 offset:6912
  v_cvt_pk_bf16_f32 v120, v168, v169
  v_mfma_f32_16x16x32_bf16 v[188:191], v[220:223], v[20:23], v[188:191]
  ds_read_b64_tr_b16 v[212:213], v247 offset:6144
  v_cvt_pk_bf16_f32 v121, v170, v171
  v_mfma_f32_16x16x32_bf16 v[196:199], v[220:223], v[32:35], 0
  s_waitcnt lgkmcnt(9)
  ds_read_b64_tr_b16 v[214:215], v247 offset:6912
  v_cvt_pk_bf16_f32 v122, v172, v173
  v_mfma_f32_16x16x32_bf16 v[184:187], v[224:227], v[24:27], v[184:187]
  ds_read_b64_tr_b16 v[216:217], v248 offset:0
  ds_read_b64_tr_b16 v[218:219], v248 offset:768
  v_mfma_f32_16x16x32_bf16 v[192:195], v[224:227], v[36:39], v[192:195]
  s_waitcnt lgkmcnt(10)
  ds_read_b64_tr_b16 v[220:221], v249 offset:0
  v_cvt_pk_bf16_f32 v123, v174, v175
  v_mfma_f32_16x16x32_bf16 v[188:191], v[228:231], v[24:27], v[188:191]
  ds_read_b64_tr_b16 v[222:223], v249 offset:768
  v_cvt_pk_bf16_f32 v144, v176, v177
  v_mfma_f32_16x16x32_bf16 v[196:199], v[228:231], v[36:39], v[196:199]
  s_waitcnt lgkmcnt(10)
  ds_read_b64_tr_b16 v[224:225], v248 offset:1536
  ds_read_b64_tr_b16 v[226:227], v248 offset:2304
  v_mfma_f32_16x16x32_bf16 v[192:195], v[200:203], v[40:43], v[192:195]
  s_waitcnt lgkmcnt(10)
  ds_read_b64_tr_b16 v[228:229], v249 offset:1536
  v_cvt_pk_bf16_f32 v145, v178, v179
  v_mfma_f32_16x16x32_bf16 v[196:199], v[204:207], v[40:43], v[196:199]
  ds_read_b64_tr_b16 v[230:231], v249 offset:2304
  v_cvt_pk_bf16_f32 v146, v180, v181
  v_mfma_f32_16x16x32_bf16 v[56:59], v[20:23], v[48:51], v[56:59]
  s_waitcnt lgkmcnt(10)
  ds_read_b64_tr_b16 v[200:201], v248 offset:3072
  v_cvt_pk_bf16_f32 v147, v182, v183
  v_mfma_f32_16x16x32_bf16 v[192:195], v[208:211], v[44:47], v[192:195]
  s_waitcnt lgkmcnt(9)
  ds_read_b64_tr_b16 v[202:203], v248 offset:3840
  ds_read_b64_tr_b16 v[204:205], v249 offset:3072
  v_mfma_f32_16x16x32_bf16 v[196:199], v[212:215], v[44:47], v[196:199]
  ds_read_b64_tr_b16 v[206:207], v249 offset:3840
  s_cmp_ge_u32 s40, 4
  s_cbranch_scc1 M_l3
  s_barrier
M_l3:
  s_waitcnt lgkmcnt(10)
  v_mfma_f32_16x16x32_bf16 v[168:171], v[216:219], v[16:19], 0
  s_waitcnt lgkmcnt(8)
  ds_read_b64_tr_b16 v[208:209], v248 offset:4608
  v_mfma_f32_16x16x32_bf16 v[172:175], v[220:223], v[16:19], 0
  s_waitcnt lgkmcnt(7)
  ds_read_b64_tr_b16 v[210:211], v248 offset:5376
  v_mfma_f32_16x16x32_bf16 v[168:171], v[224:227], v[20:23], v[168:171]
  ds_read_b64_tr_b16 v[212:213], v249 offset:4608
  ds_read_b64_tr_b16 v[214:215], v249 offset:5376
  v_mfma_f32_16x16x32_bf16 v[176:179], v[224:227], v[32:35], 0
  s_waitcnt lgkmcnt(8)
  ds_read_b64_tr_b16 v[216:217], v248 offset:6144
  v_cvt_pk_bf16_f32 v124, v184, v185
  v_mfma_f32_16x16x32_bf16 v[172:175], v[228:231], v[20:23], v[172:175]
  ds_read_b64_tr_b16 v[218:219], v248 offset:6912
  v_cvt_pk_bf16_f32 v125, v186, v187
  v_mfma_f32_16x16x32_bf16 v[180:183], v[228:231], v[32:35], 0
  s_waitcnt lgkmcnt(8)
  ds_read_b64_tr_b16 v[220:221], v249 offset:6144
  ds_read_b64_tr_b16 v[222:223], v249 offset:6912
  v_mfma_f32_16x16x32_bf16 v[168:171], v[200:203], v[24:27], v[168:171]
  ds_read_b64_tr_b16 v[224:225], v250 offset:0
  v_cvt_pk_bf16_f32 v126, v188, v189
  v_mfma_f32_16x16x32_bf16 v[176:179], v[200:203], v[36:39], v[176:179]
  s_waitcnt lgkmcnt(9)
  ds_read_b64_tr_b16 v[226:227], v250 offset:768
  v_cvt_pk_bf16_f32 v127, v190, v191
  v_mfma_f32_16x16x32_bf16 v[172:175], v[204:207], v[24:27], v[172:175]
  ds_read_b64_tr_b16 v[228:229], v251 offset:0
  v_cvt_pk_bf16_f32 v148, v192, v193
  v_mfma_f32_16x16x32_bf16 v[180:183], v[204:207], v[36:39], v[180:183]
  s_waitcnt lgkmcnt(9)
  ds_read_b64_tr_b16 v[230:231], v251 offset:768
  ds_read_b64_tr_b16 v[200:201], v250 offset:1536
  v_mfma_f32_16x16x32_bf16 v[176:179], v[208:211], v[40:43], v[176:179]
  s_waitcnt lgkmcnt(9)
  ds_read_b64_tr_b16 v[202:203], v250 offset:2304
  v_cvt_pk_bf16_f32 v149, v194, v195
  v_mfma_f32_16x16x32_bf16 v[180:183], v[212:215], v[40:43], v[180:183]
  ds_read_b64_tr_b16 v[204:205], v251 offset:1536
  v_cvt_pk_bf16_f32 v150, v196, v197
  v_mfma_f32_16x16x32_bf16 v[60:63], v[36:39], v[48:51], v[60:63]
  s_waitcnt lgkmcnt(9)
  ds_read_b64_tr_b16 v[206:207], v251 offset:2304
  v_cvt_pk_bf16_f32 v151, v198, v199
  v_mfma_f32_16x16x32_bf16 v[176:179], v[216:219], v[44:47], v[176:179]
  s_waitcnt lgkmcnt(8)
  ds_read_b64_tr_b16 v[208:209], v250 offset:3072
  ds_read_b64_tr_b16 v[210:211], v250 offset:3840
  v_mfma_f32_16x16x32_bf16 v[180:183], v[220:223], v[44:47], v[180:183]
  s_waitcnt lgkmcnt(8)
  ds_read_b64_tr_b16 v[212:213], v251 offset:3072
  v_mfma_f32_16x16x32_bf16 v[184:187], v[224:227], v[16:19], 0
  s_waitcnt lgkmcnt(7)
  ds_read_b64_tr_b16 v[214:215], v251 offset:3840
  v_mfma_f32_16x16x32_bf16 v[188:191], v[228:231], v[16:19], 0
  s_waitcnt lgkmcnt(6)
  ds_read_b64_tr_b16 v[216:217], v250 offset:4608
  v_mfma_f32_16x16x32_bf16 v[184:187], v[200:203], v[20:23], v[184:187]
  ds_read_b64_tr_b16 v[218:219], v250 offset:5376
  ds_read_b64_tr_b16 v[220:221], v251 offset:4608
  v_mfma_f32_16x16x32_bf16 v[192:195], v[200:203], v[32:35], 0
  s_waitcnt lgkmcnt(7)
  ds_read_b64_tr_b16 v[222:223], v251 offset:5376
  v_cvt_pk_bf16_f32 v128, v168, v169
  v_mfma_f32_16x16x32_bf16 v[188:191], v[204:207], v[20:23], v[188:191]
  ds_read_b64_tr_b16 v[224:225], v250 offset:6144
  v_cvt_pk_bf16_f32 v129, v170, v171
  v_mfma_f32_16x16x32_bf16 v[196:199], v[204:207], v[32:35], 0
  s_waitcnt lgkmcnt(7)
  ds_read_b64_tr_b16 v[226:227], v250 offset:6912
  ds_read_b64_tr_b16 v[228:229], v251 offset:6144
  v_mfma_f32_16x16x32_bf16 v[184:187], v[208:211], v[24:27], v[184:187]
  ds_read_b64_tr_b16 v[230:231], v251 offset:6912
  v_cvt_pk_bf16_f32 v130, v172, v173
  v_mfma_f32_16x16x32_bf16 v[192:195], v[208:211], v[36:39], v[192:195]
  s_waitcnt lgkmcnt(8)
  ds_read_b64_tr_b16 v[200:201], v244 offset:256
  v_cvt_pk_bf16_f32 v131, v174, v175
  v_mfma_f32_16x16x32_bf16 v[188:191], v[212:215], v[24:27], v[188:191]
  ds_read_b64_tr_b16 v[202:203], v244 offset:1024
  v_cvt_pk_bf16_f32 v152, v176, v177
  v_mfma_f32_16x16x32_bf16 v[196:199], v[212:215], v[36:39], v[196:199]
  s_waitcnt lgkmcnt(8)
  ds_read_b64_tr_b16 v[204:205], v245 offset:256
  ds_read_b64_tr_b16 v[206:207], v245 offset:1024
  v_mfma_f32_16x16x32_bf16 v[192:195], v[216:219], v[40:43], v[192:195]
  s_waitcnt lgkmcnt(8)
  ds_read_b64_tr_b16 v[208:209], v244 offset:1792
  v_cvt_pk_bf16_f32 v153, v178, v179
  v_mfma_f32_16x16x32_bf16 v[196:199], v[220:223], v[40:43], v[196:199]
  ds_read_b64_tr_b16 v[210:211], v244 offset:2560
  v_cvt_pk_bf16_f32 v154, v180, v181
  v_mfma_f32_16x16x32_bf16 v[56:59], v[24:27], v[48:51], v[56:59]
  s_waitcnt lgkmcnt(8)
  ds_read_b64_tr_b16 v[212:213], v245 offset:1792
  v_cvt_pk_bf16_f32 v155, v182, v183
  v_mfma_f32_16x16x32_bf16 v[192:195], v[224:227], v[44:47], v[192:195]
  s_waitcnt lgkmcnt(7)
  ds_read_b64_tr_b16 v[214:215], v245 offset:2560
  ds_read_b64_tr_b16 v[216:217], v244 offset:3328
  v_mfma_f32_16x16x32_bf16 v[196:199], v[228:231], v[44:47], v[196:199]
  s_waitcnt lgkmcnt(7)
  ds_read_b64_tr_b16 v[218:219], v244 offset:4096
  v_mfma_f32_16x16x32_bf16 v[168:171], v[200:203], v[16:19], 0
  s_waitcnt lgkmcnt(6)
  ds_read_b64_tr_b16 v[220:221], v245 offset:3328
  v_mfma_f32_16x16x32_bf16 v[172:175], v[204:207], v[16:19], 0
  s_waitcnt lgkmcnt(5)
  ds_read_b64_tr_b16 v[222:223], v245 offset:4096
  ds_read_b64_tr_b16 v[224:225], v244 offset:4864
  v_mfma_f32_16x16x32_bf16 v[168:171], v[208:211], v[20:23], v[168:171]
  ds_read_b64_tr_b16 v[226:227], v244 offset:5632
  v_mfma_f32_16x16x32_bf16 v[176:179], v[208:211], v[32:35], 0
  s_waitcnt lgkmcnt(6)
  ds_read_b64_tr_b16 v[228:229], v245 offset:4864
  v_cvt_pk_bf16_f32 v132, v184, v185
  v_mfma_f32_16x16x32_bf16 v[172:175], v[212:215], v[20:23], v[172:175]
  ds_read_b64_tr_b16 v[230:231], v245 offset:5632
  v_cvt_pk_bf16_f32 v133, v186, v187
  v_mfma_f32_16x16x32_bf16 v[180:183], v[212:215], v[32:35], 0
  s_waitcnt lgkmcnt(6)
  ds_read_b64_tr_b16 v[200:201], v244 offset:6400
  ds_read_b64_tr_b16 v[202:203], v244 offset:7168
  v_mfma_f32_16x16x32_bf16 v[168:171], v[216:219], v[24:27], v[168:171]
  ds_read_b64_tr_b16 v[204:205], v245 offset:6400
  v_cvt_pk_bf16_f32 v134, v188, v189
  v_mfma_f32_16x16x32_bf16 v[176:179], v[216:219], v[36:39], v[176:179]
  s_waitcnt lgkmcnt(7)
  ds_read_b64_tr_b16 v[206:207], v245 offset:7168
  v_cvt_pk_bf16_f32 v135, v190, v191
  v_mfma_f32_16x16x32_bf16 v[172:175], v[220:223], v[24:27], v[172:175]
  ds_read_b64_tr_b16 v[208:209], v246 offset:256
  v_cvt_pk_bf16_f32 v156, v192, v193
  v_mfma_f32_16x16x32_bf16 v[180:183], v[220:223], v[36:39], v[180:183]
  s_waitcnt lgkmcnt(7)
  ds_read_b64_tr_b16 v[210:211], v246 offset:1024
  ds_read_b64_tr_b16 v[212:213], v247 offset:256
  v_mfma_f32_16x16x32_bf16 v[176:179], v[224:227], v[40:43], v[176:179]
  s_waitcnt lgkmcnt(7)
  ds_read_b64_tr_b16 v[214:215], v247 offset:1024
  v_cvt_pk_bf16_f32 v157, v194, v195
  v_mfma_f32_16x16x32_bf16 v[180:183], v[228:231], v[40:43], v[180:183]
  ds_read_b64_tr_b16 v[216:217], v246 offset:1792
  v_cvt_pk_bf16_f32 v158, v196, v197
  v_mfma_f32_16x16x32_bf16 v[60:63], v[40:43], v[48:51], v[60:63]
  s_waitcnt lgkmcnt(7)
  ds_read_b64_tr_b16 v[218:219], v246 offset:2560
  ds_read_b64_tr_b16 v[220:221], v247 offset:1792
  v_mfma_f32_16x16x32_bf16 v[176:179], v[200:203], v[44:47], v[176:179]
  s_waitcnt lgkmcnt(7)
  ds_read_b64_tr_b16 v[222:223], v247 offset:2560
  v_cvt_pk_bf16_f32 v159, v198, v199
  v_mfma_f32_16x16x32_bf16 v[180:183], v[204:207], v[44:47], v[180:183]
  s_waitcnt lgkmcnt(6)
  ds_read_b64_tr_b16 v[224:225], v246 offset:3328
  v_mfma_f32_16x16x32_bf16 v[184:187], v[208:211], v[16:19], 0
  s_waitcnt lgkmcnt(5)
  ds_read_b64_tr_b16 v[226:227], v246 offset:4096
  v_mfma_f32_16x16x32_bf16 v[188:191], v[212:215], v[16:19], 0
  s_waitcnt lgkmcnt(4)
  ds_read_b64_tr_b16 v[228:229], v247 offset:3328
  ds_read_b64_tr_b16 v[230:231], v247 offset:4096
  v_mfma_f32_16x16x32_bf16 v[184:187], v[216:219], v[20:23], v[184:187]
  ds_read_b64_tr_b16 v[200:201], v246 offset:4864
  v_mfma_f32_16x16x32_bf16 v[192:195], v[216:219], v[32:35], 0
  s_waitcnt lgkmcnt(5)
  ds_read_b64_tr_b16 v[202:203], v246 offset:5632
  v_cvt_pk_bf16_f32 v136, v168, v169
  v_mfma_f32_16x16x32_bf16 v[188:191], v[220:223], v[20:23], v[188:191]
  ds_read_b64_tr_b16 v[204:205], v247 offset:4864
  v_cvt_pk_bf16_f32 v137, v170, v171
  v_mfma_f32_16x16x32_bf16 v[196:199], v[220:223], v[32:35], 0
  s_waitcnt lgkmcnt(5)
  ds_read_b64_tr_b16 v[206:207], v247 offset:5632
  ds_read_b64_tr_b16 v[208:209], v246 offset:6400
  v_mfma_f32_16x16x32_bf16 v[184:187], v[224:227], v[24:27], v[184:187]
  ds_read_b64_tr_b16 v[210:211], v246 offset:7168
  v_cvt_pk_bf16_f32 v138, v172, v173
  v_mfma_f32_16x16x32_bf16 v[192:195], v[224:227], v[36:39], v[192:195]
  s_waitcnt lgkmcnt(6)
  ds_read_b64_tr_b16 v[212:213], v247 offset:6400
  v_cvt_pk_bf16_f32 v139, v174, v175
  v_mfma_f32_16x16x32_bf16 v[188:191], v[228:231], v[24:27], v[188:191]
  ds_read_b64_tr_b16 v[214:215], v247 offset:7168
  v_cvt_pk_bf16_f32 v160, v176, v177
  v_mfma_f32_16x16x32_bf16 v[196:199], v[228:231], v[36:39], v[196:199]
  s_waitcnt lgkmcnt(6)
  v_cvt_pk_bf16_f32 v161, v178, v179
  v_cvt_pk_bf16_f32 v162, v180, v181
  v_mfma_f32_16x16x32_bf16 v[192:195], v[200:203], v[40:43], v[192:195]
  s_waitcnt lgkmcnt(4)
  v_cvt_pk_bf16_f32 v163, v182, v183
  v_mfma_f32_16x16x32_bf16 v[196:199], v[204:207], v[40:43], v[196:199]
  v_mfma_f32_16x16x32_bf16 v[60:63], v[44:47], v[48:51], v[60:63]
  s_waitcnt lgkmcnt(2)
  v_mfma_f32_16x16x32_bf16 v[192:195], v[208:211], v[44:47], v[192:195]
  s_waitcnt lgkmcnt(0)
  v_mfma_f32_16x16x32_bf16 v[196:199], v[212:215], v[44:47], v[196:199]
  s_waitcnt vmcnt(0)
  s_cmp_lg_u32 s40, 4
  s_cbranch_scc1 M_e3b
  s_mov_b32 m0, 0
  s_mov_b32 s59, 24576
  buffer_load_dwordx4 v252, s[24:27], s59 offen offset:0 sc1 lds
  buffer_load_dwordx4 v252, s[24:27], s59 offen offset:1024 sc1 lds
  buffer_load_dwordx4 v252, s[24:27], s59 offen offset:2048 sc1 lds
  buffer_load_dwordx4 v252, s[24:27], s59 offen offset:3072 sc1 lds
  s_mov_b32 m0, 4096
  s_mov_b32 s59, 28672
  buffer_load_dwordx4 v252, s[24:27], s59 offen offset:0 sc1 lds
  buffer_load_dwordx4 v252, s[24:27], s59 offen offset:1024 sc1 lds
  buffer_load_dwordx4 v252, s[24:27], s59 offen offset:2048 sc1 lds
  buffer_load_dwordx4 v252, s[24:27], s59 offen offset:3072 sc1 lds
  s_mov_b32 m0, 8192
  s_mov_b32 s59, 32768
  buffer_load_dwordx4 v252, s[24:27], s59 offen offset:0 sc1 lds
  buffer_load_dwordx4 v252, s[24:27], s59 offen offset:1024 sc1 lds
  buffer_load_dwordx4 v252, s[24:27], s59 offen offset:2048 sc1 lds
  buffer_load_dwordx4 v252, s[24:27], s59 offen offset:3072 sc1 lds
  s_mov_b32 m0, 12288
  s_mov_b32 s59, 36864
  buffer_load_dwordx4 v252, s[24:27], s59 offen offset:0 sc1 lds
  buffer_load_dwordx4 v252, s[24:27], s59 offen offset:1024 sc1 lds
  buffer_load_dwordx4 v252, s[24:27], s59 offen offset:2048 sc1 lds
M_e3b:
  v_mfma_f32_16x16x32_bf16 v[168:171], v[120:123], v[64:67], 0
  v_rcp_f32 v56, v56
  v_mfma_f32_16x16x32_bf16 v[176:179], v[144:147], v[64:67], 0
  v_rcp_f32 v57, v57
  v_mfma_f32_16x16x32_bf16 v[172:175], v[120:123], v[88:91], 0
  v_rcp_f32 v58, v58
  v_mfma_f32_16x16x32_bf16 v[180:183], v[144:147], v[88:91], 0
  v_cvt_pk_bf16_f32 v140, v184, v185
  v_cvt_pk_bf16_f32 v141, v186, v187
  v_mfma_f32_16x16x32_bf16 v[168:171], v[124:127], v[68:71], v[168:171]
  v_cvt_pk_bf16_f32 v142, v188, v189
  v_cvt_pk_bf16_f32 v143, v190, v191
  v_mfma_f32_16x16x32_bf16 v[176:179], v[148:151], v[68:71], v[176:179]
  v_cvt_pk_bf16_f32 v164, v192, v193
  v_cvt_pk_bf16_f32 v165, v194, v195
  v_mfma_f32_16x16x32_bf16 v[172:175], v[124:127], v[92:95], v[172:175]
  v_cvt_pk_bf16_f32 v166, v196, v197
  v_cvt_pk_bf16_f32 v167, v198, v199
  v_mfma_f32_16x16x32_bf16 v[180:183], v[148:151], v[92:95], v[180:183]
  v_rcp_f32 v59, v59
  v_mfma_f32_16x16x32_bf16 v[168:171], v[128:131], v[72:75], v[168:171]
  v_rcp_f32 v60, v60
  v_mfma_f32_16x16x32_bf16 v[176:179], v[152:155], v[72:75], v[176:179]
  v_rcp_f32 v61, v61
  v_mfma_f32_16x16x32_bf16 v[172:175], v[128:131], v[96:99], v[172:175]
  v_rcp_f32 v62, v62
  v_mfma_f32_16x16x32_bf16 v[180:183], v[152:155], v[96:99], v[180:183]
  v_rcp_f32 v63, v63
  v_mfma_f32_16x16x32_bf16 v[168:171], v[132:135], v[76:79], v[168:171]
  v_mfma_f32_16x16x32_bf16 v[176:179], v[156:159], v[76:79], v[176:179]
  s_cmp_lt_u32 s40, 4
  s_cbranch_scc1 M_e3
  s_cmp_lg_u32 s40, 4
  s_cbranch_scc1 M_e3a
  s_waitcnt vmcnt(0)
  s_barrier
  s_mov_b32 m0, 15360
  s_mov_b32 s59, 39936
  buffer_load_dwordx4 v252, s[24:27], s59 offen offset:0 sc1 lds
  buffer_load_dwordx4 v252, s[24:27], s59 offen offset:1024 sc1 lds
  buffer_load_dwordx4 v252, s[24:27], s59 offen offset:2048 sc1 lds
  buffer_load_dwordx4 v252, s[24:27], s59 offen offset:3072 sc1 lds
  s_mov_b32 m0, 19456
  s_mov_b32 s59, 44032
  buffer_load_dwordx4 v252, s[24:27], s59 offen offset:0 sc1 lds
  buffer_load_dwordx4 v252, s[24:27], s59 offen offset:1024 sc1 lds
  buffer_load_dwordx4 v252, s[24:27], s59 offen offset:2048 sc1 lds
  buffer_load_dwordx4 v252, s[24:27], s59 offen offset:3072 sc1 lds
  s_mov_b32 m0, 23552
  s_mov_b32 s59, 48128
  buffer_load_dwordx4 v252, s[24:27], s59 offen offset:0 sc1 lds
  buffer_load_dwordx4 v252, s[24:27], s59 offen offset:1024 sc1 lds
  buffer_load_dwordx4 v252, s[24:27], s59 offen offset:2048 sc1 lds
  buffer_load_dwordx4 v252, s[24:27], s59 offen offset:3072 sc1 lds
  s_mov_b32 m0, 27648
  s_mov_b32 s59, 52224
  buffer_load_dwordx4 v252, s[24:27], s59 offen offset:0 sc1 lds
  buffer_load_dwordx4 v252, s[24:27], s59 offen offset:1024 sc1 lds
  buffer_load_dwordx4 v252, s[24:27], s59 offen offset:2048 sc1 lds
  buffer_load_dwordx4 v252, s[24:27], s59 offen offset:3072 sc1 lds
  s_branch M_e3
M_e3a:
  s_barrier
M_e3:
  v_mfma_f32_16x16x32_bf16 v[172:175], v[132:135], v[100:103], v[172:175]
  v_mfma_f32_16x16x32_bf16 v[180:183], v[156:159], v[100:103], v[180:183]
  v_mfma_f32_16x16x32_bf16 v[168:171], v[136:139], v[80:83], v[168:171]
  v_mfma_f32_16x16x32_bf16 v[176:179], v[160:163], v[80:83], v[176:179]
  v_mfma_f32_16x16x32_bf16 v[172:175], v[136:139], v[104:107], v[172:175]
  v_mfma_f32_16x16x32_bf16 v[180:183], v[160:163], v[104:107], v[180:183]
  v_mfma_f32_16x16x32_bf16 v[168:171], v[140:143], v[84:87], v[168:171]
  ds_read_b128 v[224:227], v253 offset:0
  v_mfma_f32_16x16x32_bf16 v[176:179], v[164:167], v[84:87], v[176:179]
  v_mfma_f32_16x16x32_bf16 v[172:175], v[140:143], v[108:111], v[172:175]
  ds_read_b128 v[228:231], v253 offset:1024
  v_mfma_f32_16x16x32_bf16 v[180:183], v[164:167], v[108:111], v[180:183]
  v_mfma_f32_16x16x32_bf16 v[184:187], v[120:123], v[232:235], 0
  ds_read_b128 v[200:203], v253 offset:2048
  v_mfma_f32_16x16x32_bf16 v[192:195], v[144:147], v[232:235], 0
  v_mfma_f32_16x16x32_bf16 v[188:191], v[120:123], v[112:115], 0
  ds_read_b128 v[204:207], v253 offset:3072
  v_mul_f32 v168, v168, v56
  v_mfma_f32_16x16x32_bf16 v[196:199], v[144:147], v[112:115], 0
  s_waitcnt lgkmcnt(3)
  v_mul_f32 v172, v172, v56
  v_cvt_pk_bf16_f32 v16, v168, v172
  v_mfma_f32_16x16x32_bf16 v[184:187], v[124:127], v[224:227], v[184:187]
  ds_read_b128 v[208:211], v253 offset:4096
  v_mul_f32 v169, v169, v57
  v_mfma_f32_16x16x32_bf16 v[192:195], v[148:151], v[224:227], v[192:195]
  s_waitcnt lgkmcnt(3)
  v_mul_f32 v173, v173, v57
  v_cvt_pk_bf16_f32 v18, v169, v173
  v_mfma_f32_16x16x32_bf16 v[188:191], v[124:127], v[228:231], v[188:191]
  ds_read_b128 v[212:215], v253 offset:5120
  v_mul_f32 v170, v170, v58
  v_mfma_f32_16x16x32_bf16 v[196:199], v[148:151], v[228:231], v[196:199]
  s_waitcnt lgkmcnt(3)
  v_mul_f32 v174, v174, v58
  v_cvt_pk_bf16_f32 v20, v170, v174
  v_mfma_f32_16x16x32_bf16 v[184:187], v[128:131], v[200:203], v[184:187]
  ds_read_b128 v[216:219], v253 offset:6144
  v_mul_f32 v171, v171, v59
  v_mfma_f32_16x16x32_bf16 v[192:195], v[152:155], v[200:203], v[192:195]
  s_waitcnt lgkmcnt(3)
  v_mul_f32 v175, v175, v59
  v_cvt_pk_bf16_f32 v22, v171, v175
  v_mfma_f32_16x16x32_bf16 v[188:191], v[128:131], v[204:207], v[188:191]
  ds_read_b128 v[220:223], v253 offset:7168
  v_mul_f32 v176, v176, v60
  v_mfma_f32_16x16x32_bf16 v[196:199], v[152:155], v[204:207], v[196:199]
  s_waitcnt lgkmcnt(3)
  v_mul_f32 v180, v180, v60
  v_cvt_pk_bf16_f32 v24, v176, v180
  v_mfma_f32_16x16x32_bf16 v[184:187], v[132:135], v[208:211], v[184:187]
  ds_read_b128 v[224:227], v253 offset:8192
  v_mul_f32 v177, v177, v61
  v_mfma_f32_16x16x32_bf16 v[192:195], v[156:159], v[208:211], v[192:195]
  s_waitcnt lgkmcnt(3)
  v_mul_f32 v181, v181, v61
  v_cvt_pk_bf16_f32 v26, v177, v181
  v_mfma_f32_16x16x32_bf16 v[188:191], v[132:135], v[212:215], v[188:191]
  ds_read_b128 v[228:231], v253 offset:9216
  v_mul_f32 v178, v178, v62
  v_mfma_f32_16x16x32_bf16 v[196:199], v[156:159], v[212:215], v[196:199]
  s_waitcnt lgkmcnt(3)
  v_mul_f32 v182, v182, v62
  v_cvt_pk_bf16_f32 v28, v178, v182
  v_mfma_f32_16x16x32_bf16 v[184:187], v[136:139], v[216:219], v[184:187]
  ds_read_b128 v[200:203], v252 offset:0
  v_mul_f32 v179, v179, v63
  v_mfma_f32_16x16x32_bf16 v[192:195], v[160:163], v[216:219], v[192:195]
  s_waitcnt lgkmcnt(3)
  v_mul_f32 v183, v183, v63
  v_cvt_pk_bf16_f32 v30, v179, v183
  v_mfma_f32_16x16x32_bf16 v[188:191], v[136:139], v[220:223], v[188:191]
  ds_read_b128 v[204:207], v252 offset:1024
  v_mfma_f32_16x16x32_bf16 v[196:199], v[160:163], v[220:223], v[196:199]
  s_waitcnt lgkmcnt(3)
  v_mfma_f32_16x16x32_bf16 v[184:187], v[140:143], v[224:227], v[184:187]
  ds_read_b128 v[208:211], v252 offset:2048
  v_mfma_f32_16x16x32_bf16 v[192:195], v[164:167], v[224:227], v[192:195]
  s_waitcnt lgkmcnt(3)
  v_mfma_f32_16x16x32_bf16 v[188:191], v[140:143], v[228:231], v[188:191]
  ds_read_b128 v[212:215], v252 offset:3072
  v_mfma_f32_16x16x32_bf16 v[196:199], v[164:167], v[228:231], v[196:199]
  s_waitcnt lgkmcnt(3)
  v_mfma_f32_16x16x32_bf16 v[168:171], v[120:123], v[200:203], 0
  ds_read_b128 v[216:219], v252 offset:4096
  v_mfma_f32_16x16x32_bf16 v[176:179], v[144:147], v[200:203], 0
  s_waitcnt lgkmcnt(3)
  v_mfma_f32_16x16x32_bf16 v[172:175], v[120:123], v[204:207], 0
  ds_read_b128 v[220:223], v252 offset:5120
  v_mul_f32 v184, v184, v56
  v_mfma_f32_16x16x32_bf16 v[180:183], v[144:147], v[204:207], 0
  s_waitcnt lgkmcnt(3)
  v_mul_f32 v188, v188, v56
  v_cvt_pk_bf16_f32 v17, v184, v188
  v_mfma_f32_16x16x32_bf16 v[168:171], v[124:127], v[208:211], v[168:171]
  ds_read_b128 v[224:227], v252 offset:6144
  v_mul_f32 v185, v185, v57
  v_mfma_f32_16x16x32_bf16 v[176:179], v[148:151], v[208:211], v[176:179]
  s_waitcnt lgkmcnt(3)
  buffer_store_dwordx2 v[16:17], v4, s[20:23], 0 offen offset:0 sc1
  v_mul_f32 v189, v189, v57
  v_mfma_f32_16x16x32_bf16 v[172:175], v[124:127], v[212:215], v[172:175]
  ds_read_b128 v[228:231], v252 offset:7168
  v_cvt_pk_bf16_f32 v19, v185, v189
  v_mfma_f32_16x16x32_bf16 v[180:183], v[148:151], v[212:215], v[180:183]
  s_waitcnt lgkmcnt(3)
  v_mul_f32 v186, v186, v58
  v_mul_f32 v190, v190, v58
  v_mfma_f32_16x16x32_bf16 v[168:171], v[128:131], v[216:219], v[168:171]
  ds_read_b128 v[200:203], v252 offset:8192
  v_cvt_pk_bf16_f32 v21, v186, v190
  v_mfma_f32_16x16x32_bf16 v[176:179], v[152:155], v[216:219], v[176:179]
  s_waitcnt lgkmcnt(3)
  buffer_store_dwordx2 v[18:19], v5, s[20:23], 0 offen offset:0 sc1
  v_mul_f32 v187, v187, v59
  v_mfma_f32_16x16x32_bf16 v[172:175], v[128:131], v[220:223], v[172:175]
  ds_read_b128 v[204:207], v252 offset:9216
  v_mul_f32 v191, v191, v59
  v_mfma_f32_16x16x32_bf16 v[180:183], v[152:155], v[220:223], v[180:183]
  s_waitcnt lgkmcnt(3)
  v_cvt_pk_bf16_f32 v23, v187, v191
  v_mul_f32 v192, v192, v60
  v_mfma_f32_16x16x32_bf16 v[168:171], v[132:135], v[224:227], v[168:171]
  ds_read_b128 v[208:211], v252 offset:10240
  v_mul_f32 v196, v196, v60
  v_mfma_f32_16x16x32_bf16 v[176:179], v[156:159], v[224:227], v[176:179]
  s_waitcnt lgkmcnt(3)
  buffer_store_dwordx2 v[20:21], v6, s[20:23], 0 offen offset:0 sc1
  v_cvt_pk_bf16_f32 v25, v192, v196
  v_mfma_f32_16x16x32_bf16 v[172:175], v[132:135], v[228:231], v[172:175]
  ds_read_b128 v[212:215], v252 offset:11264
  v_mul_f32 v193, v193, v61
  v_mfma_f32_16x16x32_bf16 v[180:183], v[156:159], v[228:231], v[180:183]
  s_waitcnt lgkmcnt(3)
  v_mul_f32 v197, v197, v61
  v_cvt_pk_bf16_f32 v27, v193, v197
  v_mfma_f32_16x16x32_bf16 v[168:171], v[136:139], v[200:203], v[168:171]
  ds_read_b128 v[216:219], v252 offset:12288
  v_mul_f32 v194, v194, v62
  v_mfma_f32_16x16x32_bf16 v[176:179], v[160:163], v[200:203], v[176:179]
  s_waitcnt lgkmcnt(3)
  buffer_store_dwordx2 v[22:23], v7, s[20:23], 0 offen offset:0 sc1
  v_mul_f32 v198, v198, v62
  v_mfma_f32_16x16x32_bf16 v[172:175], v[136:139], v[204:207], v[172:175]
  ds_read_b128 v[220:223], v252 offset:13312
  v_cvt_pk_bf16_f32 v29, v194, v198
  v_mfma_f32_16x16x32_bf16 v[180:183], v[160:163], v[204:207], v[180:183]
  s_waitcnt lgkmcnt(3)
  v_mul_f32 v195, v195, v63
  v_mul_f32 v199, v199, v63
  v_mfma_f32_16x16x32_bf16 v[168:171], v[140:143], v[208:211], v[168:171]
  ds_read_b128 v[224:227], v252 offset:14336
  v_cvt_pk_bf16_f32 v31, v195, v199
  v_mfma_f32_16x16x32_bf16 v[176:179], v[164:167], v[208:211], v[176:179]
  buffer_store_dwordx2 v[24:25], v8, s[20:23], 0 offen offset:0 sc1
  s_cmp_lt_u32 s40, 4
  s_cbranch_scc1 M_e4
  s_waitcnt vmcnt(5)
  s_barrier
M_e4:
  s_waitcnt lgkmcnt(3)
  v_mfma_f32_16x16x32_bf16 v[172:175], v[140:143], v[212:215], v[172:175]
  ds_read_b128 v[228:231], v252 offset:15360
  v_mfma_f32_16x16x32_bf16 v[180:183], v[164:167], v[212:215], v[180:183]
  s_waitcnt lgkmcnt(3)
  v_mfma_f32_16x16x32_bf16 v[184:187], v[120:123], v[216:219], 0
  ds_read_b128 v[200:203], v252 offset:16384
  v_mfma_f32_16x16x32_bf16 v[192:195], v[144:147], v[216:219], 0
  s_waitcnt lgkmcnt(3)
  buffer_store_dwordx2 v[26:27], v9, s[20:23], 0 offen offset:0 sc1
  v_mfma_f32_16x16x32_bf16 v[188:191], v[120:123], v[220:223], 0
  ds_read_b128 v[204:207], v252 offset:17408
  v_mul_f32 v168, v168, v56
  v_mfma_f32_16x16x32_bf16 v[196:199], v[144:147], v[220:223], 0
  s_waitcnt lgkmcnt(3)
  v_mul_f32 v172, v172, v56
  v_cvt_pk_bf16_f32 v16, v168, v172
  v_mfma_f32_16x16x32_bf16 v[184:187], v[124:127], v[224:227], v[184:187]
  ds_read_b128 v[208:211], v252 offset:18432
  v_mul_f32 v169, v169, v57
  v_mfma_f32_16x16x32_bf16 v[192:195], v[148:151], v[224:227], v[192:195]
  s_waitcnt lgkmcnt(3)
  buffer_store_dwordx2 v[28:29], v10, s[20:23], 0 offen offset:0 sc1
  v_mul_f32 v173, v173, v57
  v_mfma_f32_16x16x32_bf16 v[188:191], v[124:127], v[228:231], v[188:191]
  ds_read_b128 v[212:215], v252 offset:19456
  v_cvt_pk_bf16_f32 v18, v169, v173
  v_mfma_f32_16x16x32_bf16 v[196:199], v[148:151], v[228:231], v[196:199]
  s_waitcnt lgkmcnt(3)
  v_mul_f32 v170, v170, v58
  v_mul_f32 v174, v174, v58
  v_mfma_f32_16x16x32_bf16 v[184:187], v[128:131], v[200:203], v[184:187]
  ds_read_b128 v[216:219], v252 offset:20480
  v_cvt_pk_bf16_f32 v20, v170, v174
  v_mfma_f32_16x16x32_bf16 v[192:195], v[152:155], v[200:203], v[192:195]
  s_waitcnt lgkmcnt(3)
  buffer_store_dwordx2 v[30:31], v11, s[20:23], 0 offen offset:0 sc1
  v_mul_f32 v171, v171, v59
  v_mfma_f32_16x16x32_bf16 v[188:191], v[128:131], v[204:207], v[188:191]
  ds_read_b128 v[220:223], v252 offset:21504
  v_mul_f32 v175, v175, v59
  v_mfma_f32_16x16x32_bf16 v[196:199], v[152:155], v[204:207], v[196:199]
  s_waitcnt lgkmcnt(3)
  v_cvt_pk_bf16_f32 v22, v171, v175
  v_mul_f32 v176, v176, v60
  v_mfma_f32_16x16x32_bf16 v[184:187], v[132:135], v[208:211], v[184:187]
  ds_read_b128 v[224:227], v252 offset:22528
  v_mul_f32 v180, v180, v60
  v_mfma_f32_16x16x32_bf16 v[192:195], v[156:159], v[208:211], v[192:195]
  s_waitcnt lgkmcnt(3)
  v_cvt_pk_bf16_f32 v24, v176, v180
  v_mul_f32 v177, v177, v61
  v_mfma_f32_16x16x32_bf16 v[188:191], v[132:135], v[212:215], v[188:191]
  ds_read_b128 v[228:231], v252 offset:23552
  v_mul_f32 v181, v181, v61
  v_mfma_f32_16x16x32_bf16 v[196:199], v[156:159], v[212:215], v[196:199]
  s_waitcnt lgkmcnt(3)
  v_cvt_pk_bf16_f32 v26, v177, v181
  v_mul_f32 v178, v178, v62
  v_mfma_f32_16x16x32_bf16 v[184:187], v[136:139], v[216:219], v[184:187]
  ds_read_b128 v[200:203], v252 offset:24576
  v_mul_f32 v182, v182, v62
  v_mfma_f32_16x16x32_bf16 v[192:195], v[160:163], v[216:219], v[192:195]
  s_waitcnt lgkmcnt(3)
  v_cvt_pk_bf16_f32 v28, v178, v182
  v_mul_f32 v179, v179, v63
  v_mfma_f32_16x16x32_bf16 v[188:191], v[136:139], v[220:223], v[188:191]
  ds_read_b128 v[204:207], v252 offset:25600
  v_mul_f32 v183, v183, v63
  v_mfma_f32_16x16x32_bf16 v[196:199], v[160:163], v[220:223], v[196:199]
  s_waitcnt lgkmcnt(3)
  v_cvt_pk_bf16_f32 v30, v179, v183
  v_mfma_f32_16x16x32_bf16 v[184:187], v[140:143], v[224:227], v[184:187]
  ds_read_b128 v[208:211], v252 offset:26624
  v_mfma_f32_16x16x32_bf16 v[192:195], v[164:167], v[224:227], v[192:195]
  s_waitcnt lgkmcnt(3)
  v_mfma_f32_16x16x32_bf16 v[188:191], v[140:143], v[228:231], v[188:191]
  ds_read_b128 v[212:215], v252 offset:27648
  v_mfma_f32_16x16x32_bf16 v[196:199], v[164:167], v[228:231], v[196:199]
  s_waitcnt lgkmcnt(3)
  v_mfma_f32_16x16x32_bf16 v[168:171], v[120:123], v[200:203], 0
  ds_read_b128 v[216:219], v252 offset:28672
  v_mfma_f32_16x16x32_bf16 v[176:179], v[144:147], v[200:203], 0
  s_waitcnt lgkmcnt(3)
  v_mfma_f32_16x16x32_bf16 v[172:175], v[120:123], v[204:207], 0
  ds_read_b128 v[220:223], v252 offset:29696
  v_mul_f32 v184, v184, v56
  v_mfma_f32_16x16x32_bf16 v[180:183], v[144:147], v[204:207], 0
  s_waitcnt lgkmcnt(3)
  v_mul_f32 v188, v188, v56
  v_cvt_pk_bf16_f32 v17, v184, v188
  v_mfma_f32_16x16x32_bf16 v[168:171], v[124:127], v[208:211], v[168:171]
  ds_read_b128 v[224:227], v252 offset:30720
  v_mul_f32 v185, v185, v57
  v_mfma_f32_16x16x32_bf16 v[176:179], v[148:151], v[208:211], v[176:179]
  s_waitcnt lgkmcnt(3)
  buffer_store_dwordx2 v[16:17], v4, s[20:23], 0 offen offset:128 sc1
  v_mul_f32 v189, v189, v57
  v_mfma_f32_16x16x32_bf16 v[172:175], v[124:127], v[212:215], v[172:175]
  ds_read_b128 v[228:231], v252 offset:31744
  v_cvt_pk_bf16_f32 v19, v185, v189
  v_mfma_f32_16x16x32_bf16 v[180:183], v[148:151], v[212:215], v[180:183]
  s_waitcnt lgkmcnt(3)
  v_mul_f32 v186, v186, v58
  v_mul_f32 v190, v190, v58
  v_mfma_f32_16x16x32_bf16 v[168:171], v[128:131], v[216:219], v[168:171]
  ds_read_b128 v[200:203], v252 offset:32768
  v_cvt_pk_bf16_f32 v21, v186, v190
  v_mfma_f32_16x16x32_bf16 v[176:179], v[152:155], v[216:219], v[176:179]
  s_waitcnt lgkmcnt(3)
  buffer_store_dwordx2 v[18:19], v5, s[20:23], 0 offen offset:128 sc1
  v_mul_f32 v187, v187, v59
  v_mfma_f32_16x16x32_bf16 v[172:175], v[128:131], v[220:223], v[172:175]
  ds_read_b128 v[204:207], v252 offset:33792
  v_mul_f32 v191, v191, v59
  v_mfma_f32_16x16x32_bf16 v[180:183], v[152:155], v[220:223], v[180:183]
  s_waitcnt lgkmcnt(3)
  v_cvt_pk_bf16_f32 v23, v187, v191
  v_mul_f32 v192, v192, v60
  v_mfma_f32_16x16x32_bf16 v[168:171], v[132:135], v[224:227], v[168:171]
  ds_read_b128 v[208:211], v252 offset:34816
  v_mul_f32 v196, v196, v60
  v_mfma_f32_16x16x32_bf16 v[176:179], v[156:159], v[224:227], v[176:179]
  s_waitcnt lgkmcnt(3)
  buffer_store_dwordx2 v[20:21], v6, s[20:23], 0 offen offset:128 sc1
  v_cvt_pk_bf16_f32 v25, v192, v196
  v_mfma_f32_16x16x32_bf16 v[172:175], v[132:135], v[228:231], v[172:175]
  ds_read_b128 v[212:215], v252 offset:35840
  v_mul_f32 v193, v193, v61
  v_mfma_f32_16x16x32_bf16 v[180:183], v[156:159], v[228:231], v[180:183]
  s_waitcnt lgkmcnt(3)
  v_mul_f32 v197, v197, v61
  v_cvt_pk_bf16_f32 v27, v193, v197
  v_mfma_f32_16x16x32_bf16 v[168:171], v[136:139], v[200:203], v[168:171]
  ds_read_b128 v[64:67], v252 offset:36864
  v_mul_f32 v194, v194, v62
  v_mfma_f32_16x16x32_bf16 v[176:179], v[160:163], v[200:203], v[176:179]
  s_waitcnt lgkmcnt(3)
  ds_read_b128 v[68:71], v252 offset:37888
  v_mul_f32 v198, v198, v62
  v_mfma_f32_16x16x32_bf16 v[172:175], v[136:139], v[204:207], v[172:175]
  ds_read_b128 v[72:75], v252 offset:38912
  v_cvt_pk_bf16_f32 v29, v194, v198
  v_mfma_f32_16x16x32_bf16 v[180:183], v[160:163], v[204:207], v[180:183]
  s_waitcnt lgkmcnt(4)
  ds_read_b128 v[76:79], v252 offset:39936
  v_mul_f32 v195, v195, v63
  v_mfma_f32_16x16x32_bf16 v[168:171], v[140:143], v[208:211], v[168:171]
  ds_read_b128 v[80:83], v252 offset:40960
  v_mul_f32 v199, v199, v63
  v_mfma_f32_16x16x32_bf16 v[176:179], v[164:167], v[208:211], v[176:179]
  s_waitcnt lgkmcnt(5)
  ds_read_b128 v[84:87], v252 offset:41984
  v_cvt_pk_bf16_f32 v31, v195, v199
  v_mfma_f32_16x16x32_bf16 v[172:175], v[140:143], v[212:215], v[172:175]
  ds_read_b128 v[88:91], v252 offset:43008
  v_mfma_f32_16x16x32_bf16 v[180:183], v[164:167], v[212:215], v[180:183]
  s_waitcnt lgkmcnt(6)
  ds_read_b128 v[92:95], v252 offset:44032
  v_mfma_f32_16x16x32_bf16 v[184:187], v[120:123], v[64:67], 0
  s_waitcnt lgkmcnt(6)
  ds_read_b128 v[96:99], v252 offset:45056
  v_mfma_f32_16x16x32_bf16 v[188:191], v[120:123], v[68:71], 0
  s_waitcnt lgkmcnt(6)
  ds_read_b128 v[100:103], v252 offset:46080
  v_mfma_f32_16x16x32_bf16 v[184:187], v[124:127], v[72:75], v[184:187]
  s_waitcnt lgkmcnt(6)
  ds_read_b128 v[104:107], v252 offset:47104
  v_mul_f32 v168, v168, v56
  v_mfma_f32_16x16x32_bf16 v[188:191], v[124:127], v[76:79], v[188:191]
  s_waitcnt lgkmcnt(6)
  ds_read_b128 v[108:111], v252 offset:48128
  v_mul_f32 v172, v172, v56
  v_mfma_f32_16x16x32_bf16 v[184:187], v[128:131], v[80:83], v[184:187]
  s_waitcnt lgkmcnt(6)
  buffer_store_dwordx2 v[22:23], v7, s[20:23], 0 offen offset:128 sc1
  v_cvt_pk_bf16_f32 v16, v168, v172
  v_mfma_f32_16x16x32_bf16 v[188:191], v[128:131], v[84:87], v[188:191]
  s_waitcnt lgkmcnt(5)
  buffer_store_dwordx2 v[24:25], v8, s[20:23], 0 offen offset:128 sc1
  v_mul_f32 v169, v169, v57
  v_mfma_f32_16x16x32_bf16 v[184:187], v[132:135], v[88:91], v[184:187]
  s_waitcnt lgkmcnt(4)
  buffer_store_dwordx2 v[26:27], v9, s[20:23], 0 offen offset:128 sc1
  v_mul_f32 v173, v173, v57
  v_mfma_f32_16x16x32_bf16 v[188:191], v[132:135], v[92:95], v[188:191]
  s_waitcnt lgkmcnt(3)
  buffer_store_dwordx2 v[28:29], v10, s[20:23], 0 offen offset:128 sc1
  v_cvt_pk_bf16_f32 v18, v169, v173
  v_mfma_f32_16x16x32_bf16 v[184:187], v[136:139], v[96:99], v[184:187]
  s_waitcnt lgkmcnt(2)
  v_mul_f32 v170, v170, v58
  v_mul_f32 v174, v174, v58
  v_mfma_f32_16x16x32_bf16 v[188:191], v[136:139], v[100:103], v[188:191]
  s_waitcnt lgkmcnt(1)
  buffer_store_dwordx2 v[30:31], v11, s[20:23], 0 offen offset:128 sc1
  v_cvt_pk_bf16_f32 v20, v170, v174
  v_mfma_f32_16x16x32_bf16 v[184:187], v[140:143], v[104:107], v[184:187]
  s_waitcnt lgkmcnt(0)
  v_mul_f32 v171, v171, v59
  v_mul_f32 v175, v175, v59
  v_mfma_f32_16x16x32_bf16 v[188:191], v[140:143], v[108:111], v[188:191]
  v_cvt_pk_bf16_f32 v22, v171, v175
  v_mul_f32 v176, v176, v60
  v_mfma_f32_16x16x32_bf16 v[192:195], v[144:147], v[64:67], 0
  v_mul_f32 v180, v180, v60
  v_cvt_pk_bf16_f32 v24, v176, v180
  v_mfma_f32_16x16x32_bf16 v[196:199], v[144:147], v[68:71], 0
  v_mul_f32 v177, v177, v61
  v_mul_f32 v181, v181, v61
  v_mfma_f32_16x16x32_bf16 v[192:195], v[148:151], v[72:75], v[192:195]
  v_cvt_pk_bf16_f32 v26, v177, v181
  v_mul_f32 v178, v178, v62
  v_mfma_f32_16x16x32_bf16 v[196:199], v[148:151], v[76:79], v[196:199]
  v_mul_f32 v182, v182, v62
  v_cvt_pk_bf16_f32 v28, v178, v182
  v_mfma_f32_16x16x32_bf16 v[192:195], v[152:155], v[80:83], v[192:195]
  v_mul_f32 v179, v179, v63
  v_mul_f32 v183, v183, v63
  v_mfma_f32_16x16x32_bf16 v[196:199], v[152:155], v[84:87], v[196:199]
  v_cvt_pk_bf16_f32 v30, v179, v183
  v_mul_f32 v184, v184, v56
  v_mfma_f32_16x16x32_bf16 v[192:195], v[156:159], v[88:91], v[192:195]
  v_mul_f32 v188, v188, v56
  v_cvt_pk_bf16_f32 v17, v184, v188
  v_mfma_f32_16x16x32_bf16 v[196:199], v[156:159], v[92:95], v[196:199]
  buffer_store_dwordx2 v[16:17], v4, s[20:23], 0 offen offset:256 sc1
  v_mul_f32 v185, v185, v57
  v_mfma_f32_16x16x32_bf16 v[192:195], v[160:163], v[96:99], v[192:195]
  v_mul_f32 v189, v189, v57
  v_cvt_pk_bf16_f32 v19, v185, v189
  v_mfma_f32_16x16x32_bf16 v[196:199], v[160:163], v[100:103], v[196:199]
  buffer_store_dwordx2 v[18:19], v5, s[20:23], 0 offen offset:256 sc1
  v_mul_f32 v186, v186, v58
  v_mfma_f32_16x16x32_bf16 v[192:195], v[164:167], v[104:107], v[192:195]
  v_mul_f32 v190, v190, v58
  v_cvt_pk_bf16_f32 v21, v186, v190
  v_mfma_f32_16x16x32_bf16 v[196:199], v[164:167], v[108:111], v[196:199]
  buffer_store_dwordx2 v[20:21], v6, s[20:23], 0 offen offset:256 sc1
  v_mul_f32 v187, v187, v59
  v_mul_f32 v191, v191, v59
  v_cvt_pk_bf16_f32 v23, v187, v191
  buffer_store_dwordx2 v[22:23], v7, s[20:23], 0 offen offset:256 sc1
  v_mul_f32 v192, v192, v60
  s_nop 1
  v_mul_f32 v196, v196, v60
  v_cvt_pk_bf16_f32 v25, v192, v196
  buffer_store_dwordx2 v[24:25], v8, s[20:23], 0 offen offset:256 sc1
  v_mul_f32 v193, v193, v61
  v_mul_f32 v197, v197, v61
  v_cvt_pk_bf16_f32 v27, v193, v197
  buffer_store_dwordx2 v[26:27], v9, s[20:23], 0 offen offset:256 sc1
  v_mul_f32 v194, v194, v62
  v_mul_f32 v198, v198, v62
  v_cvt_pk_bf16_f32 v29, v194, v198
  buffer_store_dwordx2 v[28:29], v10, s[20:23], 0 offen offset:256 sc1
  v_mul_f32 v195, v195, v63
  v_mul_f32 v199, v199, v63
  v_cvt_pk_bf16_f32 v31, v195, v199
  buffer_store_dwordx2 v[30:31], v11, s[20:23], 0 offen offset:256 sc1
  s_endpgm
M_helper:
H_join:
  v_lshrrev_b32 v4, 3, v3
  v_lshlrev_b32 v4, 1, v4
  v_xor_b32 v4, v4, v2
  v_lshl_add_u32 v4, v3, 2, v4
  v_lshlrev_b32 v195, 4, v4
  v_add_u32 v195, 90112, v195
  s_sub_u32 s94, s2, 36
  v_mov_b32 v192, 1
  v_mov_b32 v193, 0
  v_bfe_u32 v180, v3, 1, 1
  v_mul_u32_u24 v180, 12288, v180
  v_and_b32 v181, 1, v3
  v_lshl_add_u32 v180, v181, 10, v180
  v_lshrrev_b32 v181, 2, v3
  v_lshl_add_u32 v180, v181, 4, v180
  v_lshl_add_u32 v180, v2, 8, v180
  v_lshlrev_b32 v181, 3, v3
  v_lshl_add_u32 v181, v2, 8, v181
  v_add_u32 v181, 102400, v181
  s_and_b32 s55, s2, 7
  s_lshr_b32 s56, s2, 3
  s_lshr_b32 s41, s55, 2
  s_bfe_u32 s42, s55, 0x10001
  s_and_b32 s55, s55, 1
  s_lshl_b32 s55, s55, 2
  s_lshr_b32 s43, s56, 3
  s_add_u32 s43, s43, s55
  s_and_b32 s44, s56, 7
  s_mul_i32 s43, s43, 14
  s_mul_i32 s44, s44, 14
  s_mul_i32 s61, s41, 13
  s_add_i32 s61, s61, -6
  s_cmp_eq_u32 s42, 0
  s_cselect_b32 s62, 85632, 0
  s_cselect_b32 s50, -1, 1
  s_mulk_i32 s50, 384
  s_cmp_ge_u32 s40, 4
  s_cselect_b32 s53, -4, 3
  s_add_i32 s53, s53, s40
  s_lshl_b32 s53, s53, 1
  s_add_u32 s88, s43, s53
  s_mov_b32 s89, 86016
  s_mul_i32 s55, s41, 6
  s_add_i32 s45, s43, s55
  s_add_i32 s45, s45, -6
  s_cmp_eq_i32 s45, -6
  s_cselect_b32 s47, 6, 0
  s_cmp_eq_i32 s45, 98
  s_cselect_b32 s48, 7, 13
  s_cselect_b32 s49, 2, 0
  s_sub_i32 s45, s45, s49
  s_cmp_eq_i32 s44, 98
  s_cselect_b32 s51, 7, 13
  s_lshl_b32 s56, s44, 1
  s_add_i32 s56, s56, 1
  s_mul_i32 s46, s56, s50
  s_add_i32 s46, s46, s62
  s_lshl_b32 s91, s50, 1
  s_lshl_b32 s3, s91, 3
  s_add_i32 s91, s91, -384
  s_max_i32 s92, s53, s47
  s_min_i32 s92, s92, s48
  s_and_b32 s92, s92, -2
  s_add_u32 s52, s92, s49
  s_mov_b32 s54, 4286578688
  s_mov_b32 s63, 1037384597
  s_and_b32 s93, s40, 1
  s_lshl_b32 s93, s93, 3
  s_and_b32 s56, s40, 6
  s_or_b32 s93, s93, s56
  s_add_u32 s56, s40, 8
  s_add_i32 s100, s45, s56
  s_lshl_b32 s100, s100, 1
  s_add_i32 s100, s100, s41
  s_max_i32 s100, s100, 0
  s_min_i32 s100, s100, 223
  s_mul_i32 s100, s100, 86016
  s_mul_i32 s101, s56, 7680
  v_add_u32 v4, 0, v1
  v_xor_b32 v4, 0, v4
  v_mul_u32_u24 v5, 2731, v4
  v_lshrrev_b32 v5, 16, v5
  v_mul_i32_i24 v5, s91, v5
  v_lshl_add_u32 v4, v4, 4, v5
  v_add_u32 v232, s46, v4
  v_add_u32 v235, s3, v232
  v_add_u32 v238, s3, v235
  v_add_u32 v4, 64, v1
  v_xor_b32 v4, 0, v4
  v_mul_u32_u24 v5, 2731, v4
  v_lshrrev_b32 v5, 16, v5
  v_mul_i32_i24 v5, s91, v5
  v_lshl_add_u32 v4, v4, 4, v5
  v_add_u32 v233, s46, v4
  v_add_u32 v236, s3, v233
  v_add_u32 v4, 128, v1
  v_xor_b32 v4, 0, v4
  v_mul_u32_u24 v5, 2731, v4
  v_lshrrev_b32 v5, 16, v5
  v_mul_i32_i24 v5, s91, v5
  v_lshl_add_u32 v4, v4, 4, v5
  v_add_u32 v234, s46, v4
  v_add_u32 v237, s3, v234
  v_add_u32 v4, 416, v1
  v_xor_b32 v4, 0, v4
  v_mul_u32_u24 v5, 2731, v4
  v_lshrrev_b32 v5, 16, v5
  v_mul_i32_i24 v5, s91, v5
  v_lshl_add_u32 v4, v4, 4, v5
  v_add_u32 v239, s46, v4
  v_max_i32 v237, 0, v237
  v_max_i32 v238, 0, v238
  v_max_i32 v239, 0, v239
  v_add_u32 v4, 0, v1
  v_xor_b32 v4, 8, v4
  v_mul_u32_u24 v5, 2731, v4
  v_lshrrev_b32 v5, 16, v5
  v_mul_i32_i24 v5, s91, v5
  v_lshl_add_u32 v4, v4, 4, v5
  v_add_u32 v244, s46, v4
  v_add_u32 v247, s3, v244
  v_add_u32 v250, s3, v247
  v_add_u32 v4, 64, v1
  v_xor_b32 v4, 8, v4
  v_mul_u32_u24 v5, 2731, v4
  v_lshrrev_b32 v5, 16, v5
  v_mul_i32_i24 v5, s91, v5
  v_lshl_add_u32 v4, v4, 4, v5
  v_add_u32 v245, s46, v4
  v_add_u32 v248, s3, v245
  v_add_u32 v4, 128, v1
  v_xor_b32 v4, 8, v4
  v_mul_u32_u24 v5, 2731, v4
  v_lshrrev_b32 v5, 16, v5
  v_mul_i32_i24 v5, s91, v5
  v_lshl_add_u32 v4, v4, 4, v5
  v_add_u32 v246, s46, v4
  v_add_u32 v249, s3, v246
  v_add_u32 v4, 416, v1
  v_xor_b32 v4, 8, v4
  v_mul_u32_u24 v5, 2731, v4
  v_lshrrev_b32 v5, 16, v5
  v_mul_i32_i24 v5, s91, v5
  v_lshl_add_u32 v4, v4, 4, v5
  v_add_u32 v251, s46, v4
  v_max_i32 v249, 0, v249
  v_max_i32 v250, 0, v250
  v_max_i32 v251, 0, v251
  s_cmp_ge_u32 s94, 72
  s_cbranch_scc1 H_v2
  s_mul_hi_u32 s55, s94, 0x15555556
  s_mul_i32 s56, s55, 12
  s_sub_u32 s56, s94, s56
  s_lshr_b32 s57, s56, 2
  s_mul_i32 s95, s57, 24576
  s_and_b32 s56, s56, 3
  s_lshl_b32 s56, s56, 6
  s_add_u32 s95, s95, s56
  s_lshl_b32 s56, s55, 11
  s_add_u32 s95, s95, s56
  s_waitcnt vmcnt(0)
  ds_read_b128 v[96:99], v195 offset:0
  ds_read_b128 v[100:103], v195 offset:1024
  ds_read_b128 v[104:107], v195 offset:2048
  ds_read_b128 v[108:111], v195 offset:3072
  ds_read_b128 v[112:115], v195 offset:4096
  ds_read_b128 v[116:119], v195 offset:5120
  ds_read_b128 v[120:123], v195 offset:6144
  ds_read_b128 v[124:127], v195 offset:7168
  ds_read_b128 v[128:131], v195 offset:8192
  ds_read_b128 v[132:135], v195 offset:9216
  ds_read_b128 v[136:139], v195 offset:10240
  ds_read_b128 v[140:143], v195 offset:11264
  s_waitcnt lgkmcnt(2)
  ds_read_b64_tr_b16 v[144:145], v181 offset:0
  ds_read_b64_tr_b16 v[146:147], v181 offset:128
  ds_read_b64_tr_b16 v[148:149], v181 offset:1024
  ds_read_b64_tr_b16 v[150:151], v181 offset:1152
  ds_read_b64_tr_b16 v[152:153], v181 offset:2048
  ds_read_b64_tr_b16 v[154:155], v181 offset:2176
  ds_read_b64_tr_b16 v[156:157], v181 offset:3072
  ds_read_b64_tr_b16 v[158:159], v181 offset:3200
  ds_read_b64_tr_b16 v[160:161], v181 offset:4096
  ds_read_b64_tr_b16 v[162:163], v181 offset:4224
  ds_read_b64_tr_b16 v[164:165], v181 offset:5120
  ds_read_b64_tr_b16 v[166:167], v181 offset:5248
  s_waitcnt lgkmcnt(0)
  v_mfma_f32_16x16x32_bf16 v[168:171], v[96:99], v[144:147], 0
  v_mfma_f32_16x16x32_bf16 v[172:175], v[120:123], v[144:147], 0
  v_mfma_f32_16x16x32_bf16 v[168:171], v[100:103], v[148:151], v[168:171]
  v_mfma_f32_16x16x32_bf16 v[172:175], v[124:127], v[148:151], v[172:175]
  v_mfma_f32_16x16x32_bf16 v[168:171], v[104:107], v[152:155], v[168:171]
  v_mfma_f32_16x16x32_bf16 v[172:175], v[128:131], v[152:155], v[172:175]
  v_mfma_f32_16x16x32_bf16 v[168:171], v[108:111], v[156:159], v[168:171]
  v_mfma_f32_16x16x32_bf16 v[172:175], v[132:135], v[156:159], v[172:175]
  v_mfma_f32_16x16x32_bf16 v[168:171], v[112:115], v[160:163], v[168:171]
  v_mfma_f32_16x16x32_bf16 v[172:175], v[136:139], v[160:163], v[172:175]
  v_mfma_f32_16x16x32_bf16 v[168:171], v[116:119], v[164:167], v[168:171]
  v_mfma_f32_16x16x32_bf16 v[172:175], v[140:143], v[164:167], v[172:175]
  s_nop 6
  v_cvt_pk_bf16_f32 v176, v168, v169
  v_cvt_pk_bf16_f32 v177, v170, v171
  v_cvt_pk_bf16_f32 v178, v172, v173
  v_cvt_pk_bf16_f32 v179, v174, v175
  buffer_store_dwordx4 v[176:179], v180, s[24:27], s95 offen sc1
H_v2:
  s_barrier
  v_mov_b32 v6, 0
  s_mov_b32 s59, 0
  s_mov_b64 exec, 1
H_pollM:
  buffer_load_dword v7, v6, s[36:39], 0 offen offset:128 sc1
  s_waitcnt vmcnt(0)
  v_cmp_gt_u32 vcc, 1, v7
  s_add_u32 s59, s59, 1
  s_cmp_gt_u32 s59, 200000
  s_cbranch_scc1 H_pollM_x
  s_cmp_lg_u64 vcc, 0
  s_cbranch_scc0 H_pollM_x
  s_sleep 2
  s_branch H_pollM
H_pollM_x:
  s_mov_b64 exec, -1
  s_lshr_b32 s55, s2, 3
  s_mul_i32 s55, s55, 2304
  s_add_u32 s55, s55, 131072
  buffer_load_dwordx4 v[80:83], v252, s[24:27], s55 offen offset:0 sc1
  buffer_load_dwordx4 v[84:87], v252, s[24:27], s55 offen offset:1024 sc1
  buffer_load_dwordx4 v[88:91], v252, s[24:27], s55 offen offset:2048 sc1
  s_barrier
  s_lshl_b32 s55, s40, 10
  s_add_u32 s55, s55, 131072
  s_sub_u32 m0, s55, 40960
  s_nop 0
  buffer_load_dwordx4 v252, s[24:27], s55 offen sc1 lds
  s_add_u32 s55, s55, 4096
  s_sub_u32 m0, s55, 40960
  s_nop 0
  buffer_load_dwordx4 v252, s[24:27], s55 offen sc1 lds
  s_add_u32 s55, s55, 4096
  s_sub_u32 m0, s55, 40960
  s_nop 0
  buffer_load_dwordx4 v252, s[24:27], s55 offen sc1 lds
  s_add_u32 s55, s55, 4096
  s_sub_u32 m0, s55, 40960
  s_nop 0
  buffer_load_dwordx4 v252, s[24:27], s55 offen sc1 lds
  s_add_u32 s55, s55, 4096
  s_sub_u32 m0, s55, 40960
  s_nop 0
  buffer_load_dwordx4 v252, s[24:27], s55 offen sc1 lds
  s_add_u32 s55, s55, 4096
  s_sub_u32 m0, s55, 40960
  s_nop 0
  buffer_load_dwordx4 v252, s[24:27], s55 offen sc1 lds
  s_add_u32 s55, s55, 4096
  s_sub_u32 m0, s55, 40960
  s_nop 0
  buffer_load_dwordx4 v252, s[24:27], s55 offen sc1 lds
  s_add_u32 s55, s55, 4096
  s_sub_u32 m0, s55, 40960
  s_nop 0
  buffer_load_dwordx4 v252, s[24:27], s55 offen sc1 lds
  s_add_u32 s55, s55, 4096
  s_sub_u32 m0, s55, 40960
  s_nop 0
  buffer_load_dwordx4 v252, s[24:27], s55 offen sc1 lds
  s_add_u32 s55, s55, 4096
  s_sub_u32 m0, s55, 40960
  s_nop 0
  buffer_load_dwordx4 v252, s[24:27], s55 offen sc1 lds
  s_add_u32 s55, s55, 4096
  s_sub_u32 m0, s55, 40960
  s_nop 0
  buffer_load_dwordx4 v252, s[24:27], s55 offen sc1 lds
  s_add_u32 s55, s55, 4096
  s_sub_u32 m0, s55, 40960
  s_nop 0
  buffer_load_dwordx4 v252, s[24:27], s55 offen sc1 lds
  s_waitcnt vmcnt(6)
  s_barrier
  s_lshl_b32 s55, s40, 10
  s_add_u32 s55, s55, 180224
  s_sub_u32 m0, s55, 40960
  s_nop 0
  buffer_load_dwordx4 v252, s[24:27], s55 offen sc1 lds
  s_add_u32 s55, s55, 4096
  s_sub_u32 m0, s55, 40960
  s_nop 0
  buffer_load_dwordx4 v252, s[24:27], s55 offen sc1 lds
  s_add_u32 s55, s55, 4096
  s_sub_u32 m0, s55, 40960
  s_nop 0
  buffer_load_dwordx4 v252, s[24:27], s55 offen sc1 lds
  s_add_u32 s55, s55, 4096
  s_sub_u32 m0, s55, 40960
  s_nop 0
  buffer_load_dwordx4 v252, s[24:27], s55 offen sc1 lds
  s_add_u32 s55, s55, 4096
  s_sub_u32 m0, s55, 40960
  s_nop 0
  buffer_load_dwordx4 v252, s[24:27], s55 offen sc1 lds
  s_add_u32 s55, s55, 4096
  s_sub_u32 m0, s55, 40960
  s_nop 0
  buffer_load_dwordx4 v252, s[24:27], s55 offen sc1 lds
  s_waitcnt vmcnt(0)
  s_cmp_ge_u32 s94, 72
  s_cbranch_scc1 H_v3
  s_mov_b64 exec, 1
  buffer_atomic_add v192, v193, s[36:39], 0 offen offset:4 sc1
  s_mov_b64 exec, -1
H_v3:
  s_add_i32 s56, s45, 0
  s_lshl_b32 s56, s56, 1
  s_add_i32 s56, s56, s41
  s_max_i32 s56, s56, 0
  s_min_i32 s56, s56, 223
  s_mul_i32 s56, s56, 86016
  s_mov_b32 m0, 0
  s_nop 0
  buffer_load_dwordx4 v232, s[16:19], s56 offen lds
  s_mov_b32 m0, 1024
  s_nop 0
  buffer_load_dwordx4 v233, s[16:19], s56 offen lds
  s_mov_b32 m0, 2048
  s_nop 0
  buffer_load_dwordx4 v234, s[16:19], s56 offen lds
  s_mov_b32 m0, 3072
  s_nop 0
  buffer_load_dwordx4 v235, s[16:19], s56 offen lds
  s_mov_b32 m0, 4096
  s_nop 0
  buffer_load_dwordx4 v236, s[16:19], s56 offen lds
  s_mov_b32 m0, 5120
  s_nop 0
  buffer_load_dwordx4 v237, s[16:19], s56 offen lds
  s_mov_b32 m0, 6144
  s_nop 0
  buffer_load_dwordx4 v238, s[16:19], s56 offen lds
  s_mov_b32 m0, 6656
  s_nop 0
  buffer_load_dwordx4 v239, s[16:19], s56 offen lds
  s_add_i32 s56, s45, 8
  s_lshl_b32 s56, s56, 1
  s_add_i32 s56, s56, s41
  s_max_i32 s56, s56, 0
  s_min_i32 s56, s56, 223
  s_mul_i32 s56, s56, 86016
  s_mov_b32 m0, 61440
  s_nop 0
  buffer_load_dwordx4 v232, s[16:19], s56 offen lds
  s_mov_b32 m0, 62464
  s_nop 0
  buffer_load_dwordx4 v233, s[16:19], s56 offen lds
  s_mov_b32 m0, 63488
  s_nop 0
  buffer_load_dwordx4 v234, s[16:19], s56 offen lds
  s_mov_b32 m0, 64512
  s_nop 0
  buffer_load_dwordx4 v235, s[16:19], s56 offen lds
  s_mov_b32 m0, 65536
  s_nop 0
  buffer_load_dwordx4 v236, s[16:19], s56 offen lds
  s_mov_b32 m0, 66560
  s_nop 0
  buffer_load_dwordx4 v237, s[16:19], s56 offen lds
  s_mov_b32 m0, 67584
  s_nop 0
  buffer_load_dwordx4 v238, s[16:19], s56 offen lds
  s_mov_b32 m0, 68096
  s_nop 0
  buffer_load_dwordx4 v239, s[16:19], s56 offen lds
  s_barrier
  s_add_i32 s56, s45, 9
  s_lshl_b32 s56, s56, 1
  s_add_i32 s56, s56, s41
  s_max_i32 s56, s56, 0
  s_min_i32 s56, s56, 223
  s_mul_i32 s56, s56, 86016
  s_mov_b32 m0, 69120
  s_nop 0
  buffer_load_dwordx4 v244, s[16:19], s56 offen lds
  s_mov_b32 m0, 70144
  s_nop 0
  buffer_load_dwordx4 v245, s[16:19], s56 offen lds
  s_mov_b32 m0, 71168
  s_nop 0
  buffer_load_dwordx4 v246, s[16:19], s56 offen lds
  s_mov_b32 m0, 72192
  s_nop 0
  buffer_load_dwordx4 v247, s[16:19], s56 offen lds
  s_mov_b32 m0, 73216
  s_nop 0
  buffer_load_dwordx4 v248, s[16:19], s56 offen lds
  s_mov_b32 m0, 74240
  s_nop 0
  buffer_load_dwordx4 v249, s[16:19], s56 offen lds
  s_mov_b32 m0, 75264
  s_nop 0
  buffer_load_dwordx4 v250, s[16:19], s56 offen lds
  s_mov_b32 m0, 75776
  s_nop 0
  buffer_load_dwordx4 v251, s[16:19], s56 offen lds
  s_add_i32 s56, s45, 10
  s_lshl_b32 s56, s56, 1
  s_add_i32 s56, s56, s41
  s_max_i32 s56, s56, 0
  s_min_i32 s56, s56, 223
  s_mul_i32 s56, s56, 86016
  v_xor_b32 v64, 32, v232
  s_mov_b32 m0, 76800
  s_nop 0
  buffer_load_dwordx4 v64, s[16:19], s56 offen lds
  v_xor_b32 v65, 32, v233
  s_mov_b32 m0, 77824
  s_nop 0
  buffer_load_dwordx4 v65, s[16:19], s56 offen lds
  v_xor_b32 v66, 32, v234
  s_mov_b32 m0, 78848
  s_nop 0
  buffer_load_dwordx4 v66, s[16:19], s56 offen lds
  v_xor_b32 v67, 32, v235
  s_mov_b32 m0, 79872
  s_nop 0
  buffer_load_dwordx4 v67, s[16:19], s56 offen lds
  v_xor_b32 v68, 32, v236
  s_mov_b32 m0, 80896
  s_nop 0
  buffer_load_dwordx4 v68, s[16:19], s56 offen lds
  v_xor_b32 v69, 32, v237
  s_mov_b32 m0, 81920
  s_nop 0
  buffer_load_dwordx4 v69, s[16:19], s56 offen lds
  v_xor_b32 v70, 32, v238
  s_mov_b32 m0, 82944
  s_nop 0
  buffer_load_dwordx4 v70, s[16:19], s56 offen lds
  v_xor_b32 v71, 32, v239
  s_mov_b32 m0, 83456
  s_nop 0
  buffer_load_dwordx4 v71, s[16:19], s56 offen lds
  s_barrier
  s_add_i32 s56, s45, 11
  s_lshl_b32 s56, s56, 1
  s_add_i32 s56, s56, s41
  s_max_i32 s56, s56, 0
  s_min_i32 s56, s56, 223
  s_mul_i32 s56, s56, 86016
  v_xor_b32 v64, 32, v244
  s_mov_b32 m0, 84480
  s_nop 0
  buffer_load_dwordx4 v64, s[16:19], s56 offen lds
  v_xor_b32 v65, 32, v245
  s_mov_b32 m0, 85504
  s_nop 0
  buffer_load_dwordx4 v65, s[16:19], s56 offen lds
  v_xor_b32 v66, 32, v246
  s_mov_b32 m0, 86528
  s_nop 0
  buffer_load_dwordx4 v66, s[16:19], s56 offen lds
  v_xor_b32 v67, 32, v247
  s_mov_b32 m0, 87552
  s_nop 0
  buffer_load_dwordx4 v67, s[16:19], s56 offen lds
  v_xor_b32 v68, 32, v248
  s_mov_b32 m0, 88576
  s_nop 0
  buffer_load_dwordx4 v68, s[16:19], s56 offen lds
  v_xor_b32 v69, 32, v249
  s_mov_b32 m0, 89600
  s_nop 0
  buffer_load_dwordx4 v69, s[16:19], s56 offen lds
  v_xor_b32 v70, 32, v250
  s_mov_b32 m0, 90624
  s_nop 0
  buffer_load_dwordx4 v70, s[16:19], s56 offen lds
  v_xor_b32 v71, 32, v251
  s_mov_b32 m0, 91136
  s_nop 0
  buffer_load_dwordx4 v71, s[16:19], s56 offen lds
  s_add_i32 s56, s45, 12
  s_lshl_b32 s56, s56, 1
  s_add_i32 s56, s56, s41
  s_max_i32 s56, s56, 0
  s_min_i32 s56, s56, 223
  s_mul_i32 s56, s56, 86016
  v_xor_b32 v64, 64, v232
  s_mov_b32 m0, 92160
  s_nop 0
  buffer_load_dwordx4 v64, s[16:19], s56 offen lds
  v_xor_b32 v65, 64, v233
  s_mov_b32 m0, 93184
  s_nop 0
  buffer_load_dwordx4 v65, s[16:19], s56 offen lds
  v_xor_b32 v66, 64, v234
  s_mov_b32 m0, 94208
  s_nop 0
  buffer_load_dwordx4 v66, s[16:19], s56 offen lds
  v_xor_b32 v67, 64, v235
  s_mov_b32 m0, 95232
  s_nop 0
  buffer_load_dwordx4 v67, s[16:19], s56 offen lds
  v_xor_b32 v68, 64, v236
  s_mov_b32 m0, 96256
  s_nop 0
  buffer_load_dwordx4 v68, s[16:19], s56 offen lds
  v_xor_b32 v69, 64, v237
  s_mov_b32 m0, 97280
  s_nop 0
  buffer_load_dwordx4 v69, s[16:19], s56 offen lds
  v_xor_b32 v70, 64, v238
  s_mov_b32 m0, 98304
  s_nop 0
  buffer_load_dwordx4 v70, s[16:19], s56 offen lds
  v_xor_b32 v71, 64, v239
  s_mov_b32 m0, 98816
  s_nop 0
  buffer_load_dwordx4 v71, s[16:19], s56 offen lds
  s_add_i32 s56, s45, 13
  s_lshl_b32 s56, s56, 1
  s_add_i32 s56, s56, s41
  s_max_i32 s56, s56, 0
  s_min_i32 s56, s56, 223
  s_mul_i32 s56, s56, 86016
  v_xor_b32 v64, 64, v244
  s_mov_b32 m0, 99840
  s_nop 0
  buffer_load_dwordx4 v64, s[16:19], s56 offen lds
  v_xor_b32 v65, 64, v245
  s_mov_b32 m0, 100864
  s_nop 0
  buffer_load_dwordx4 v65, s[16:19], s56 offen lds
  v_xor_b32 v66, 64, v246
  s_mov_b32 m0, 101888
  s_nop 0
  buffer_load_dwordx4 v66, s[16:19], s56 offen lds
  v_xor_b32 v67, 64, v247
  s_mov_b32 m0, 102912
  s_nop 0
  buffer_load_dwordx4 v67, s[16:19], s56 offen lds
  v_xor_b32 v68, 64, v248
  s_mov_b32 m0, 103936
  s_nop 0
  buffer_load_dwordx4 v68, s[16:19], s56 offen lds
  v_xor_b32 v69, 64, v249
  s_mov_b32 m0, 104960
  s_nop 0
  buffer_load_dwordx4 v69, s[16:19], s56 offen lds
  v_xor_b32 v70, 64, v250
  s_mov_b32 m0, 105984
  s_nop 0
  buffer_load_dwordx4 v70, s[16:19], s56 offen lds
  v_xor_b32 v71, 64, v251
  s_mov_b32 m0, 106496
  s_nop 0
  buffer_load_dwordx4 v71, s[16:19], s56 offen lds
  s_waitcnt vmcnt(40)
  s_add_i32 s56, s45, 14
  s_lshl_b32 s56, s56, 1
  s_add_i32 s56, s56, s41
  s_max_i32 s56, s56, 0
  s_min_i32 s56, s56, 223
  s_mul_i32 s56, s56, 86016
  v_xor_b32 v64, 96, v232
  s_mov_b32 m0, 107520
  s_nop 0
  buffer_load_dwordx4 v64, s[16:19], s56 offen lds
  v_xor_b32 v65, 96, v233
  s_mov_b32 m0, 108544
  s_nop 0
  buffer_load_dwordx4 v65, s[16:19], s56 offen lds
  v_xor_b32 v66, 96, v234
  s_mov_b32 m0, 109568
  s_nop 0
  buffer_load_dwordx4 v66, s[16:19], s56 offen lds
  v_xor_b32 v67, 96, v235
  s_mov_b32 m0, 110592
  s_nop 0
  buffer_load_dwordx4 v67, s[16:19], s56 offen lds
  v_xor_b32 v68, 96, v236
  s_mov_b32 m0, 111616
  s_nop 0
  buffer_load_dwordx4 v68, s[16:19], s56 offen lds
  v_xor_b32 v69, 96, v237
  s_mov_b32 m0, 112640
  s_nop 0
  buffer_load_dwordx4 v69, s[16:19], s56 offen lds
  v_xor_b32 v70, 96, v238
  s_mov_b32 m0, 113664
  s_nop 0
  buffer_load_dwordx4 v70, s[16:19], s56 offen lds
  v_xor_b32 v71, 96, v239
  s_mov_b32 m0, 114176
  s_nop 0
  buffer_load_dwordx4 v71, s[16:19], s56 offen lds
  s_add_i32 s56, s45, 15
  s_lshl_b32 s56, s56, 1
  s_add_i32 s56, s56, s41
  s_max_i32 s56, s56, 0
  s_min_i32 s56, s56, 223
  s_mul_i32 s56, s56, 86016
  v_xor_b32 v64, 96, v244
  s_mov_b32 m0, 115200
  s_nop 0
  buffer_load_dwordx4 v64, s[16:19], s56 offen lds
  v_xor_b32 v65, 96, v245
  s_mov_b32 m0, 116224
  s_nop 0
  buffer_load_dwordx4 v65, s[16:19], s56 offen lds
  v_xor_b32 v66, 96, v246
  s_mov_b32 m0, 117248
  s_nop 0
  buffer_load_dwordx4 v66, s[16:19], s56 offen lds
  v_xor_b32 v67, 96, v247
  s_mov_b32 m0, 118272
  s_nop 0
  buffer_load_dwordx4 v67, s[16:19], s56 offen lds
  v_xor_b32 v68, 96, v248
  s_mov_b32 m0, 119296
  s_nop 0
  buffer_load_dwordx4 v68, s[16:19], s56 offen lds
  v_xor_b32 v69, 96, v249
  s_mov_b32 m0, 120320
  s_nop 0
  buffer_load_dwordx4 v69, s[16:19], s56 offen lds
  v_xor_b32 v70, 96, v250
  s_mov_b32 m0, 121344
  s_nop 0
  buffer_load_dwordx4 v70, s[16:19], s56 offen lds
  v_xor_b32 v71, 96, v251
  s_mov_b32 m0, 121856
  s_nop 0
  buffer_load_dwordx4 v71, s[16:19], s56 offen lds
  s_waitcnt vmcnt(40)
  s_waitcnt vmcnt(0)
  s_barrier
  s_add_i32 s56, s45, 16
  s_lshl_b32 s56, s56, 1
  s_add_i32 s56, s56, s41
  s_max_i32 s56, s56, 0
  s_min_i32 s56, s56, 223
  s_mul_i32 s56, s56, 86016
  s_mov_b32 m0, 122880
  s_nop 0
  buffer_load_dwordx4 v232, s[16:19], s56 offen lds
  s_mov_b32 m0, 123904
  s_nop 0
  buffer_load_dwordx4 v233, s[16:19], s56 offen lds
  s_mov_b32 m0, 124928
  s_nop 0
  buffer_load_dwordx4 v234, s[16:19], s56 offen lds
  s_mov_b32 m0, 125952
  s_nop 0
  buffer_load_dwordx4 v235, s[16:19], s56 offen lds
  s_mov_b32 m0, 126976
  s_nop 0
  buffer_load_dwordx4 v236, s[16:19], s56 offen lds
  s_mov_b32 m0, 128000
  s_nop 0
  buffer_load_dwordx4 v237, s[16:19], s56 offen lds
  s_mov_b32 m0, 129024
  s_nop 0
  buffer_load_dwordx4 v238, s[16:19], s56 offen lds
  s_mov_b32 m0, 129536
  s_nop 0
  buffer_load_dwordx4 v239, s[16:19], s56 offen lds
  s_add_i32 s56, s45, 17
  s_lshl_b32 s56, s56, 1
  s_add_i32 s56, s56, s41
  s_max_i32 s56, s56, 0
  s_min_i32 s56, s56, 223
  s_mul_i32 s56, s56, 86016
  s_mov_b32 m0, 130560
  s_nop 0
  buffer_load_dwordx4 v244, s[16:19], s56 offen lds
  s_mov_b32 m0, 131584
  s_nop 0
  buffer_load_dwordx4 v245, s[16:19], s56 offen lds
  s_mov_b32 m0, 132608
  s_nop 0
  buffer_load_dwordx4 v246, s[16:19], s56 offen lds
  s_mov_b32 m0, 133632
  s_nop 0
  buffer_load_dwordx4 v247, s[16:19], s56 offen lds
  s_mov_b32 m0, 134656
  s_nop 0
  buffer_load_dwordx4 v248, s[16:19], s56 offen lds
  s_mov_b32 m0, 135680
  s_nop 0
  buffer_load_dwordx4 v249, s[16:19], s56 offen lds
  s_mov_b32 m0, 136704
  s_nop 0
  buffer_load_dwordx4 v250, s[16:19], s56 offen lds
  s_mov_b32 m0, 137216
  s_nop 0
  buffer_load_dwordx4 v251, s[16:19], s56 offen lds
  s_add_i32 s56, s45, 18
  s_lshl_b32 s56, s56, 1
  s_add_i32 s56, s56, s41
  s_max_i32 s56, s56, 0
  s_min_i32 s56, s56, 223
  s_mul_i32 s56, s56, 86016
  v_xor_b32 v64, 32, v232
  s_mov_b32 m0, 138240
  s_nop 0
  buffer_load_dwordx4 v64, s[16:19], s56 offen lds
  v_xor_b32 v65, 32, v233
  s_mov_b32 m0, 139264
  s_nop 0
  buffer_load_dwordx4 v65, s[16:19], s56 offen lds
  v_xor_b32 v66, 32, v234
  s_mov_b32 m0, 140288
  s_nop 0
  buffer_load_dwordx4 v66, s[16:19], s56 offen lds
  v_xor_b32 v67, 32, v235
  s_mov_b32 m0, 141312
  s_nop 0
  buffer_load_dwordx4 v67, s[16:19], s56 offen lds
  v_xor_b32 v68, 32, v236
  s_mov_b32 m0, 142336
  s_nop 0
  buffer_load_dwordx4 v68, s[16:19], s56 offen lds
  v_xor_b32 v69, 32, v237
  s_mov_b32 m0, 143360
  s_nop 0
  buffer_load_dwordx4 v69, s[16:19], s56 offen lds
  v_xor_b32 v70, 32, v238
  s_mov_b32 m0, 144384
  s_nop 0
  buffer_load_dwordx4 v70, s[16:19], s56 offen lds
  v_xor_b32 v71, 32, v239
  s_mov_b32 m0, 144896
  s_nop 0
  buffer_load_dwordx4 v71, s[16:19], s56 offen lds
  s_add_i32 s56, s45, 19
  s_lshl_b32 s56, s56, 1
  s_add_i32 s56, s56, s41
  s_max_i32 s56, s56, 0
  s_min_i32 s56, s56, 223
  s_mul_i32 s56, s56, 86016
  v_xor_b32 v64, 32, v244
  s_mov_b32 m0, 145920
  s_nop 0
  buffer_load_dwordx4 v64, s[16:19], s56 offen lds
  v_xor_b32 v65, 32, v245
  s_mov_b32 m0, 146944
  s_nop 0
  buffer_load_dwordx4 v65, s[16:19], s56 offen lds
  v_xor_b32 v66, 32, v246
  s_mov_b32 m0, 147968
  s_nop 0
  buffer_load_dwordx4 v66, s[16:19], s56 offen lds
  v_xor_b32 v67, 32, v247
  s_mov_b32 m0, 148992
  s_nop 0
  buffer_load_dwordx4 v67, s[16:19], s56 offen lds
  v_xor_b32 v68, 32, v248
  s_mov_b32 m0, 150016
  s_nop 0
  buffer_load_dwordx4 v68, s[16:19], s56 offen lds
  v_xor_b32 v69, 32, v249
  s_mov_b32 m0, 151040
  s_nop 0
  buffer_load_dwordx4 v69, s[16:19], s56 offen lds
  v_xor_b32 v70, 32, v250
  s_mov_b32 m0, 152064
  s_nop 0
  buffer_load_dwordx4 v70, s[16:19], s56 offen lds
  v_xor_b32 v71, 32, v251
  s_mov_b32 m0, 152576
  s_nop 0
  buffer_load_dwordx4 v71, s[16:19], s56 offen lds
  s_waitcnt vmcnt(0)
  v_mov_b32 v6, 0
  s_mov_b32 s59, 0
  s_mov_b64 exec, 1
H_pollV:
  buffer_load_dword v7, v6, s[36:39], 0 offen offset:4 sc1
  s_waitcnt vmcnt(0)
  v_cmp_gt_u32 vcc, 72, v7
  s_add_u32 s59, s59, 1
  s_cmp_gt_u32 s59, 200000
  s_cbranch_scc1 H_pollV_x
  s_cmp_lg_u64 vcc, 0
  s_cbranch_scc0 H_pollV_x
  s_sleep 2
  s_branch H_pollV
H_pollV_x:
  s_mov_b64 exec, -1
  s_lshr_b32 s55, s2, 3
  s_mul_i32 s55, s55, 2304
  buffer_load_dwordx4 v[80:83], v252, s[24:27], s55 offen offset:0 sc1
  buffer_load_dwordx4 v[84:87], v252, s[24:27], s55 offen offset:1024 sc1
  buffer_load_dwordx4 v[88:91], v252, s[24:27], s55 offen offset:2048 sc1
  s_barrier
  s_mov_b32 m0, 153600
  s_mov_b32 s59, 14336
  buffer_load_dwordx4 v252, s[24:27], s59 offen offset:0 sc1 lds
  buffer_load_dwordx4 v252, s[24:27], s59 offen offset:1024 sc1 lds
  buffer_load_dwordx4 v252, s[24:27], s59 offen offset:2048 sc1 lds
  buffer_load_dwordx4 v252, s[24:27], s59 offen offset:3072 sc1 lds
  s_mov_b32 m0, 157696
  s_mov_b32 s59, 18432
  buffer_load_dwordx4 v252, s[24:27], s59 offen offset:0 sc1 lds
  buffer_load_dwordx4 v252, s[24:27], s59 offen offset:1024 sc1 lds
  buffer_load_dwordx4 v252, s[24:27], s59 offen offset:2048 sc1 lds
  buffer_load_dwordx4 v252, s[24:27], s59 offen offset:3072 sc1 lds
  s_mov_b32 m0, 161792
  s_mov_b32 s59, 22528
  buffer_load_dwordx4 v252, s[24:27], s59 offen offset:0 sc1 lds
  buffer_load_dwordx4 v252, s[24:27], s59 offen offset:1024 sc1 lds
  s_waitcnt vmcnt(0)
  s_barrier
  s_mov_b32 m0, 31744
  s_mov_b32 s59, 56320
  buffer_load_dwordx4 v252, s[24:27], s59 offen offset:0 sc1 lds
  buffer_load_dwordx4 v252, s[24:27], s59 offen offset:1024 sc1 lds
  buffer_load_dwordx4 v252, s[24:27], s59 offen offset:2048 sc1 lds
  buffer_load_dwordx4 v252, s[24:27], s59 offen offset:3072 sc1 lds
  s_mov_b32 m0, 35840
  s_mov_b32 s59, 60416
  buffer_load_dwordx4 v252, s[24:27], s59 offen offset:0 sc1 lds
  buffer_load_dwordx4 v252, s[24:27], s59 offen offset:1024 sc1 lds
  buffer_load_dwordx4 v252, s[24:27], s59 offen offset:2048 sc1 lds
  buffer_load_dwordx4 v252, s[24:27], s59 offen offset:3072 sc1 lds
  s_mov_b32 m0, 39936
  s_mov_b32 s59, 64512
  buffer_load_dwordx4 v252, s[24:27], s59 offen offset:0 sc1 lds
  buffer_load_dwordx4 v252, s[24:27], s59 offen offset:1024 sc1 lds
  buffer_load_dwordx4 v252, s[24:27], s59 offen offset:2048 sc1 lds
  buffer_load_dwordx4 v252, s[24:27], s59 offen offset:3072 sc1 lds
  s_mov_b32 m0, 44032
  s_mov_b32 s59, 68608
  buffer_load_dwordx4 v252, s[24:27], s59 offen offset:0 sc1 lds
  buffer_load_dwordx4 v252, s[24:27], s59 offen offset:1024 sc1 lds
  buffer_load_dwordx4 v252, s[24:27], s59 offen offset:2048 sc1 lds
  buffer_load_dwordx4 v252, s[24:27], s59 offen offset:3072 sc1 lds
  s_mov_b32 m0, 48128
  s_mov_b32 s59, 72704
  buffer_load_dwordx4 v252, s[24:27], s59 offen offset:0 sc1 lds
  s_waitcnt vmcnt(0)
  s_barrier
M_done:
  s_endpgm
CODE_END:
.section .rodata,"a"
.p2align 6
.amdhsa_kernel standalone__neighborhood_nat__vision_kernel
  .amdhsa_next_free_vgpr 256
  .amdhsa_next_free_sgpr 102
  .amdhsa_accum_offset 256
  .amdhsa_group_segment_fixed_size 0
  .amdhsa_kernarg_size 48
  .amdhsa_user_sgpr_count 2
  .amdhsa_user_sgpr_kernarg_segment_ptr 1
  .amdhsa_system_sgpr_workgroup_id_x 1
.end_amdhsa_kernel
```
